```python
import torch

def _softmax(x, axis=-1):
    return torch.softmax(x, dim=axis)
def _gelu(x):
    return torch.nn.functional.gelu(x, approximate="tanh")
def _silu(x):
    return torch.nn.functional.silu(x)
def _sigmoid(x):
    return torch.sigmoid(x)
def _layernorm(x, axis=-1, eps=1e-5):
    m = x.mean(dim=axis, keepdim=True)
    v = x.var(dim=axis, keepdim=True, unbiased=False)
    return (x - m) / torch.sqrt(v + eps)
def _scatter_add(tgt, idx, src, axis=0):
    return tgt.clone().index_add_(axis, idx, src)
def _segment_sum(src, seg, n):
    out = torch.zeros((n,) + src.shape[1:], dtype=src.dtype)
    return out.index_add_(0, seg, src)
def _pad(x, pw):
    flat = tuple(v for pair in reversed(pw) for v in pair)
    return torch.nn.functional.pad(x, flat)

kernel_name = 'concat_heads__mha_block_cached__gqa_block_cached__near_ridge'

def setup_inputs():

    _w = (lambda a: (lambda t: t.to(torch.bfloat16) if t.is_floating_point() else t)(torch.as_tensor(a)))
    def _A_setup():
        B, Sq, D = 16, 96, 576
        H, Sk, Dh = 32, 512, 128
        return {
            "x": _w((lambda *s: torch.randn(*s, dtype=torch.bfloat16) * 0.8)(B, Sq, D)),
            "k_cache": _w((lambda *s: torch.randn(*s, dtype=torch.bfloat16) * 0.8)(B, H, Sk, Dh)),
            "v_cache": _w((lambda *s: torch.randn(*s, dtype=torch.bfloat16) * 0.05)(B, H, Sk, Dh)),
            "wq": _w((lambda *s: torch.randn(*s, dtype=torch.bfloat16) * 0.8)(D, H * Dh) * (D ** -0.5)),
            "wo": _w((lambda *s: torch.randn(*s, dtype=torch.bfloat16) * 0.05)(H * Dh, D) * ((H * Dh) ** -0.5)),
        }
    _A_in = _A_setup()

    def _B_setup():
        B, Sq, D = 16, 96, 576
        Hq, Hkv, Sk, Dh = 32, 32, 512, 128
        assert Hq % Hkv == 0, (Hq, Hkv)
        return {
            "x": _w((lambda *s: torch.randn(*s, dtype=torch.bfloat16) * 0.8)(B, Sq, D)),
            "k_cache": _w((lambda *s: torch.randn(*s, dtype=torch.bfloat16) * 0.8)(B, Hkv, Sk, Dh)),
            "v_cache": _w((lambda *s: torch.randn(*s, dtype=torch.bfloat16) * 0.05)(B, Hkv, Sk, Dh)),
            "wq": _w((lambda *s: torch.randn(*s, dtype=torch.bfloat16) * 0.8)(D, Hq * Dh) * (D ** -0.5)),
            "wo": _w((lambda *s: torch.randn(*s, dtype=torch.bfloat16) * 0.05)(Hq * Dh, D) * ((Hq * Dh) ** -0.5)),
        }
    _B_in = _B_setup()

    return {
        "A_x": _A_in["x"],
        "A_k_cache": _A_in["k_cache"],
        "A_v_cache": _A_in["v_cache"],
        "A_wq": _A_in["wq"],
        "A_wo": _A_in["wo"],
        "B_x": _B_in["x"],
        "B_k_cache": _B_in["k_cache"],
        "B_v_cache": _B_in["v_cache"],
        "B_wq": _B_in["wq"],
        "B_wo": _B_in["wo"],
    }

def reference(A_x, A_k_cache, A_v_cache, A_wq, A_wo, B_x, B_k_cache, B_v_cache, B_wq, B_wo):
    def _A_ref(x, k_cache, v_cache, wq, wo):
        B, Sq, D = x.shape
        H, Dh = 32, 128
        q = (lambda x, *d: x.permute(*d))((x @ wq).reshape(B, Sq, H, Dh), 0, 2, 1, 3)
        scores = torch.einsum("bhqd,bhkd->bhqk", q, k_cache) * (Dh ** -0.5)
        p = _softmax(scores, axis=-1)
        o = torch.einsum("bhqk,bhkd->bhqd", p, v_cache)
        return (lambda x, *d: x.permute(*d))(o, 0, 2, 1, 3).reshape(B, Sq, H * Dh) @ wo

    def _B_ref(x, k_cache, v_cache, wq, wo):
        B, Sq, D = x.shape
        Hq, Dh = 32, 128
        Hkv = k_cache.shape[1]
        rep = Hq // Hkv
        q = (lambda x, *d: x.permute(*d))((x @ wq).reshape(B, Sq, Hq, Dh), 0, 2, 1, 3)
        k = (lambda x, n, axis: torch.repeat_interleave(x, n, dim=axis))(k_cache, rep, axis=1)
        v = (lambda x, n, axis: torch.repeat_interleave(x, n, dim=axis))(v_cache, rep, axis=1)
        scores = torch.einsum("bhqd,bhkd->bhqk", q, k) * (Dh ** -0.5)
        p = _softmax(scores, axis=-1)
        o = torch.einsum("bhqk,bhkd->bhqd", p, v)
        return (lambda x, *d: x.permute(*d))(o, 0, 2, 1, 3).reshape(B, Sq, Hq * Dh) @ wo

    a = _A_ref(A_x, A_k_cache, A_v_cache, A_wq, A_wo)
    b = _B_ref(B_x, B_k_cache, B_v_cache, B_wq, B_wo)
    return torch.concatenate([a, b], axis=-1)
```

```asm
; @launch grid=(256,1,1) block=(256,1,1) lds=163840
.amdgcn_target "amdgcn-amd-amdhsa--gfx950"
.text
.globl concat_heads__mha_block_cached__gqa_block_cached__near_ridge_kernel
.p2align 8
.type concat_heads__mha_block_cached__gqa_block_cached__near_ridge_kernel,@function
concat_heads__mha_block_cached__gqa_block_cached__near_ridge_kernel:
 s_cmp_ge_u32 s2, 256
 s_cbranch_scc1 L_done
 v_lshrrev_b32 v1, 6, v0
 v_and_b32 v0, 63, v0
 v_readfirstlane_b32 s3, v1
 s_and_b32 s6, s2, 4
 s_mul_i32 s6, s6, 10
 s_add_u32 s6, s0, s6
 s_addc_u32 s7, s1, 0
 s_load_dwordx2 s[40:41], s[6:7], 0
 s_load_dwordx4 s[8:11], s[6:7], 8
 s_load_dwordx4 s[12:15], s[6:7], 24
 s_load_dwordx2 s[54:55], s[0:1], 96
 s_load_dwordx4 s[76:79], s[0:1], 80
 s_and_b32 s57, s2, 3
 s_lshr_b32 s52, s2, 3
 s_lshr_b32 s4, s52, 1
 s_and_b32 s5, s52, 1
 s_lshl_b32 s5, s5, 2
 s_lshl_b32 s57, s57, 3
 s_add_u32 s5, s5, s57
 s_lshl_b32 s42, s4, 22
 s_lshl_b32 s56, s5, 17
 s_add_u32 s42, s42, s56
 s_mul_i32 s43, s4, 110592
 s_lshl_b32 s44, s5, 8
 s_mul_i32 s45, s5, 147456
 s_and_b32 s56, s2, 4
 s_lshl_b32 s56, s56, 2
 s_add_u32 s53, s56, s4
 s_lshr_b32 s59, s5, 2
 s_add_u32 s56, s59, 1
 s_cmp_ge_u32 s56, 9
 s_cselect_b32 s57, 9, 0
 s_sub_u32 s56, s56, s57
 s_lshl_b32 s80, s56, 7
 s_add_u32 s56, s59, 2
 s_cmp_ge_u32 s56, 9
 s_cselect_b32 s57, 9, 0
 s_sub_u32 s56, s56, s57
 s_lshl_b32 s81, s56, 7
 s_add_u32 s56, s59, 3
 s_cmp_ge_u32 s56, 9
 s_cselect_b32 s57, 9, 0
 s_sub_u32 s56, s56, s57
 s_lshl_b32 s82, s56, 7
 s_add_u32 s56, s59, 4
 s_cmp_ge_u32 s56, 9
 s_cselect_b32 s57, 9, 0
 s_sub_u32 s56, s56, s57
 s_lshl_b32 s83, s56, 7
 s_add_u32 s56, s59, 5
 s_cmp_ge_u32 s56, 9
 s_cselect_b32 s57, 9, 0
 s_sub_u32 s56, s56, s57
 s_lshl_b32 s84, s56, 7
 s_add_u32 s56, s59, 6
 s_cmp_ge_u32 s56, 9
 s_cselect_b32 s57, 9, 0
 s_sub_u32 s56, s56, s57
 s_lshl_b32 s85, s56, 7
 s_add_u32 s56, s59, 7
 s_cmp_ge_u32 s56, 9
 s_cselect_b32 s57, 9, 0
 s_sub_u32 s56, s56, s57
 s_lshl_b32 s86, s56, 7
 s_add_u32 s56, s59, 8
 s_cmp_ge_u32 s56, 9
 s_cselect_b32 s57, 9, 0
 s_sub_u32 s56, s56, s57
 s_lshl_b32 s87, s56, 7
 s_add_u32 s56, s59, 9
 s_cmp_ge_u32 s56, 9
 s_cselect_b32 s57, 9, 0
 s_sub_u32 s56, s56, s57
 s_lshl_b32 s88, s56, 7
 s_mov_b32 s47, 0
 s_mov_b32 s48, 0x3e0293ee
 s_cmp_eq_u32 s3, 3
 s_cselect_b32 s56, s59, s3
 s_mul_i32 s57, s53, 3
 s_add_u32 s56, s56, s57
 s_lshl_b32 s56, s56, 12
 s_add_u32 s89, s56, 33554432
 s_and_b32 s56, s52, 1
 s_cbranch_scc1 M_entry
 s_cmp_eq_u32 s3, 3
 s_cbranch_scc1 L_loader
 s_lshl_b32 s50, s3, 12
 s_mov_b32 s49, 0x44800000
 v_mov_b32 v21, 0x7fffff00
 s_and_b32 s56, s4, 15
 s_mul_i32 s56, s56, 294912
 s_add_u32 s56, s56, s44
 v_lshrrev_b32 v16, 1, v0
 v_lshlrev_b32 v16, 13, v16
 v_and_b32 v17, 1, v0
 v_lshl_add_u32 v16, v17, 7, v16
 v_cmp_gt_u32 vcc, 36, v0
 s_and_b32 s57, s59, 1
 s_mul_i32 s57, s57, 55296
 s_add_u32 s57, s57, s43
 v_cndmask_b32 v16, v21, v16, vcc
 v_mul_u32_u24 v17, 1152, v0
 v_cmp_gt_u32 vcc, 48, v0
 s_and_b32 s58, s3, 2
 s_lshl_b32 s58, s58, 6
 s_add_u32 s57, s57, s58
 v_cndmask_b32 v17, v21, v17, vcc
 s_cmp_lg_u32 s3, 2
 s_cbranch_scc1 L_nopfc
 s_mov_b32 s60, s56
 s_mov_b32 s61, s57
 s_getpc_b64 s[56:57]
L_pc0:
 v_mov_b32 v52, (L_done-L_pc0+2047)/2048
 s_lshr_b32 s62, s52, 1
 v_mul_lo_u32 v53, v52, s62
 v_min_u32 v52, v52, v0
 v_add_u32 v52, v52, v53
 v_lshlrev_b32 v52, 7, v52
 v_min_u32 v52, L_done-L_pc0, v52
 v_mov_b32 v53, s57
 v_add_co_u32 v52, vcc, s56, v52
 s_nop 1
 v_addc_co_u32 v53, vcc, 0, v53, vcc
 global_load_dword v50, v[52:53], off
 s_mov_b32 s56, s60
 s_mov_b32 s57, s61
L_nopfc:
 s_waitcnt lgkmcnt(0)
 s_mov_b32 s24, s12
 s_mov_b32 s25, s13
 s_mov_b32 s26, 4718592
 s_mov_b32 s27, 0x20000
 s_mov_b32 s32, s40
 s_mov_b32 s33, s41
 s_mov_b32 s34, 1769472
 s_mov_b32 s35, 0x20000
 s_mov_b32 s36, s54
 s_mov_b32 s37, s55
 s_mov_b32 s38, 290848768
 s_mov_b32 s39, 0x20000
 s_mov_b32 s16, s8
 s_mov_b32 s17, s9
 s_mov_b32 s18, 67108864
 s_mov_b32 s19, 0x20000
 s_mov_b32 s20, s10
 s_mov_b32 s21, s11
 s_mov_b32 s22, 67108864
 s_mov_b32 s23, 0x20000
 s_mov_b32 s28, s14
 s_mov_b32 s29, s15
 s_mov_b32 s30, 4718592
 s_mov_b32 s31, 0x20000
 s_mov_b32 s92, s12
 s_mov_b32 s93, s13
 s_mov_b32 s94, 4718592
 s_mov_b32 s95, 0x20000
 s_mov_b32 s72, s76
 s_mov_b32 s73, s77
 s_mov_b32 s74, 3538944
 s_mov_b32 s75, 0x20000
 s_mov_b32 s68, s78
 s_mov_b32 s69, s79
 s_mov_b32 s70, 256
 s_mov_b32 s71, 0x20000
 s_cmp_lg_u32 s3, 0
 s_cbranch_scc1 L_tx
 buffer_load_dword v48, v16, s[24:27], s56 offen
 s_add_u32 s56, s56, 147456
 buffer_load_dword v48, v16, s[24:27], s56 offen
 s_add_u32 s56, s56, 147456
 s_branch L_tdone
L_tx:
L_tdone:
 v_and_b32 v1, 7, v0
 v_lshlrev_b32 v1, 2, v1
 buffer_load_dword v23, v1, s[36:39], s89 offen sc1
 v_lshrrev_b32 v1, 4, v0
 v_bfe_u32 v2, v0, 2, 2
 v_lshlrev_b32 v16, 10, v1
 v_lshl_add_u32 v16, v2, 7, v16
 v_lshrrev_b32 v2, 1, v2
 v_lshl_add_u32 v16, v2, 6, v16
 v_and_b32 v2, 1, v1
 v_lshl_add_u32 v16, v2, 5, v16
 v_and_b32 v2, 3, v0
 v_lshl_add_u32 v8, v2, 3, v16
 v_xor_b32 v9, 32, v8
 v_xor_b32 v12, 64, v8
 v_xor_b32 v13, 96, v8
 v_lshrrev_b32 v1, 4, v0
 v_and_b32 v2, 15, v0
 v_lshrrev_b32 v16, 1, v2
 v_xor_b32 v16, v16, v1
 v_lshlrev_b32 v2, 7, v2
 v_add_u32 v2, s50, v2
 v_lshl_add_u32 v4, v16, 4, v2
 v_xor_b32 v5, 64, v4
 v_lshrrev_b32 v1, 4, v0
 v_lshrrev_b32 v2, 2, v0
 v_and_b32 v2, 3, v2
 v_lshl_add_u32 v16, v1, 3, v2
 v_lshlrev_b32 v16, 7, v16
 v_lshrrev_b32 v2, 1, v2
 v_lshl_add_u32 v16, v2, 6, v16
 v_and_b32 v2, 1, v1
 v_lshl_add_u32 v16, v2, 5, v16
 v_and_b32 v2, 3, v0
 v_lshl_add_u32 v6, v2, 3, v16
 v_xor_b32 v7, 32, v6
 v_xor_b32 v10, 64, v6
 v_xor_b32 v11, 96, v6
 v_lshlrev_b32 v22, 4, v0
 v_add_u32 v3, s50, v22
 s_mul_i32 s56, s53, 884736
 s_lshl_b32 s57, s3, 15
 s_add_u32 s56, s56, s57
 s_lshl_b32 s57, s59, 12
 s_add_u32 s51, s56, s57
 v_lshrrev_b32 v1, 3, v0
 v_and_b32 v2, 7, v0
 v_lshrrev_b32 v16, 4, v0
 v_lshlrev_b32 v18, 8, v1
 v_mul_u32_u24 v19, 1152, v1
 v_and_b32 v17, 1, v16
 v_lshlrev_b32 v17, 2, v17
 v_xor_b32 v17, v17, v2
 v_lshrrev_b32 v18, 5, v0
 v_lshlrev_b32 v18, 1, v18
 v_xor_b32 v17, v17, v18
 v_lshl_add_u32 v250, v17, 4, v19
 v_lshrrev_b32 v1, 3, v0
 v_and_b32 v1, 3, v1
 v_and_b32 v2, 7, v0
 v_lshrrev_b32 v16, 5, v0
 v_lshlrev_b32 v16, 7, v16
 v_lshl_add_u32 v16, v1, 8, v16
 v_and_b32 v1, 2, v1
 v_xor_b32 v17, v1, v2
 v_lshl_add_u32 v248, v17, 4, v16
 v_lshlrev_b32 v1, 1, v1
 v_xor_b32 v17, v1, v2
 v_lshl_add_u32 v249, v17, 4, v16
 s_cmp_lt_u32 s3, 2
 s_cselect_b32 s96, s16, s20
 s_cselect_b32 s97, s17, s21
 s_mov_b32 s98, 0x4000000
 s_mov_b32 s99, 0x20000
 s_cselect_b32 s67, 16, 32
 s_cselect_b32 s100, 64, 0
 s_cselect_b64 vcc, -1, 0
 s_cselect_b32 s56, 1, 15
 s_lshl_b32 s56, s56, 13
 s_lshl_b32 s15, s59, 1
 s_add_u32 s15, s15, s4
 s_lshl_b32 s15, s15, 13
 s_add_u32 s90, s15, s56
 v_cndmask_b32 v251, v249, v248, vcc
 s_lshr_b32 s56, s3, 1
 s_lshl_b32 s56, s56, 13
 s_add_u32 s14, s15, s56
 s_and_b32 s56, s3, 1
 s_lshl_b32 s56, s56, 12
 s_add_u32 s91, s42, s56
 s_mul_i32 s56, s3, 36864
 s_add_u32 s66, s45, s56
 v_accvgpr_write_b32 a0, 0
 v_accvgpr_write_b32 a1, 0
 v_accvgpr_write_b32 a2, 0
 v_accvgpr_write_b32 a3, 0
 v_accvgpr_write_b32 a4, 0
 v_accvgpr_write_b32 a5, 0
 v_accvgpr_write_b32 a6, 0
 v_accvgpr_write_b32 a7, 0
 v_accvgpr_write_b32 a8, 0
 v_accvgpr_write_b32 a9, 0
 v_accvgpr_write_b32 a10, 0
 v_accvgpr_write_b32 a11, 0
 v_accvgpr_write_b32 a12, 0
 v_accvgpr_write_b32 a13, 0
 v_accvgpr_write_b32 a14, 0
 v_accvgpr_write_b32 a15, 0
 v_accvgpr_write_b32 a16, 0
 v_accvgpr_write_b32 a17, 0
 v_accvgpr_write_b32 a18, 0
 v_accvgpr_write_b32 a19, 0
 v_accvgpr_write_b32 a20, 0
 v_accvgpr_write_b32 a21, 0
 v_accvgpr_write_b32 a22, 0
 v_accvgpr_write_b32 a23, 0
 v_accvgpr_write_b32 a24, 0
 v_accvgpr_write_b32 a25, 0
 v_accvgpr_write_b32 a26, 0
 v_accvgpr_write_b32 a27, 0
 v_accvgpr_write_b32 a28, 0
 v_accvgpr_write_b32 a29, 0
 v_accvgpr_write_b32 a30, 0
 v_accvgpr_write_b32 a31, 0
 v_accvgpr_write_b32 a32, 0
 v_accvgpr_write_b32 a33, 0
 v_accvgpr_write_b32 a34, 0
 v_accvgpr_write_b32 a35, 0
 v_accvgpr_write_b32 a36, 0
 v_accvgpr_write_b32 a37, 0
 v_accvgpr_write_b32 a38, 0
 v_accvgpr_write_b32 a39, 0
 v_accvgpr_write_b32 a40, 0
 v_accvgpr_write_b32 a41, 0
 v_accvgpr_write_b32 a42, 0
 v_accvgpr_write_b32 a43, 0
 v_accvgpr_write_b32 a44, 0
 v_accvgpr_write_b32 a45, 0
 v_accvgpr_write_b32 a46, 0
 v_accvgpr_write_b32 a47, 0
 v_accvgpr_write_b32 a48, 0
 v_accvgpr_write_b32 a49, 0
 v_accvgpr_write_b32 a50, 0
 v_accvgpr_write_b32 a51, 0
 v_accvgpr_write_b32 a52, 0
 v_accvgpr_write_b32 a53, 0
 v_accvgpr_write_b32 a54, 0
 v_accvgpr_write_b32 a55, 0
 v_accvgpr_write_b32 a56, 0
 v_accvgpr_write_b32 a57, 0
 v_accvgpr_write_b32 a58, 0
 v_accvgpr_write_b32 a59, 0
 v_accvgpr_write_b32 a60, 0
 v_accvgpr_write_b32 a61, 0
 v_accvgpr_write_b32 a62, 0
 v_accvgpr_write_b32 a63, 0
 v_accvgpr_write_b32 a64, 0
 v_accvgpr_write_b32 a65, 0
 v_accvgpr_write_b32 a66, 0
 v_accvgpr_write_b32 a67, 0
 v_accvgpr_write_b32 a68, 0
 v_accvgpr_write_b32 a69, 0
 v_accvgpr_write_b32 a70, 0
 v_accvgpr_write_b32 a71, 0
 v_accvgpr_write_b32 a72, 0
 v_accvgpr_write_b32 a73, 0
 v_accvgpr_write_b32 a74, 0
 v_accvgpr_write_b32 a75, 0
 v_accvgpr_write_b32 a76, 0
 v_accvgpr_write_b32 a77, 0
 v_accvgpr_write_b32 a78, 0
 v_accvgpr_write_b32 a79, 0
 v_accvgpr_write_b32 a80, 0
 v_accvgpr_write_b32 a81, 0
 v_accvgpr_write_b32 a82, 0
 v_accvgpr_write_b32 a83, 0
 v_accvgpr_write_b32 a84, 0
 v_accvgpr_write_b32 a85, 0
 v_accvgpr_write_b32 a86, 0
 v_accvgpr_write_b32 a87, 0
 v_accvgpr_write_b32 a88, 0
 v_accvgpr_write_b32 a89, 0
 v_accvgpr_write_b32 a90, 0
 v_accvgpr_write_b32 a91, 0
 v_accvgpr_write_b32 a92, 0
 v_accvgpr_write_b32 a93, 0
 v_accvgpr_write_b32 a94, 0
 v_accvgpr_write_b32 a95, 0
 v_accvgpr_write_b32 a96, 0
 v_accvgpr_write_b32 a97, 0
 v_accvgpr_write_b32 a98, 0
 v_accvgpr_write_b32 a99, 0
 v_accvgpr_write_b32 a100, 0
 v_accvgpr_write_b32 a101, 0
 v_accvgpr_write_b32 a102, 0
 v_accvgpr_write_b32 a103, 0
 v_accvgpr_write_b32 a104, 0
 v_accvgpr_write_b32 a105, 0
 v_accvgpr_write_b32 a106, 0
 v_accvgpr_write_b32 a107, 0
 v_accvgpr_write_b32 a108, 0
 v_accvgpr_write_b32 a109, 0
 v_accvgpr_write_b32 a110, 0
 v_accvgpr_write_b32 a111, 0
 v_accvgpr_write_b32 a112, 0
 v_accvgpr_write_b32 a113, 0
 v_accvgpr_write_b32 a114, 0
 v_accvgpr_write_b32 a115, 0
 v_accvgpr_write_b32 a116, 0
 v_accvgpr_write_b32 a117, 0
 v_accvgpr_write_b32 a118, 0
 v_accvgpr_write_b32 a119, 0
 v_accvgpr_write_b32 a120, 0
 v_accvgpr_write_b32 a121, 0
 v_accvgpr_write_b32 a122, 0
 v_accvgpr_write_b32 a123, 0
 v_accvgpr_write_b32 a124, 0
 v_accvgpr_write_b32 a125, 0
 v_accvgpr_write_b32 a126, 0
 v_accvgpr_write_b32 a127, 0
 v_accvgpr_write_b32 a128, 0
 v_accvgpr_write_b32 a129, 0
 v_accvgpr_write_b32 a130, 0
 v_accvgpr_write_b32 a131, 0
 v_accvgpr_write_b32 a132, 0
 v_accvgpr_write_b32 a133, 0
 v_accvgpr_write_b32 a134, 0
 v_accvgpr_write_b32 a135, 0
 v_accvgpr_write_b32 a136, 0
 v_accvgpr_write_b32 a137, 0
 v_accvgpr_write_b32 a138, 0
 v_accvgpr_write_b32 a139, 0
 v_accvgpr_write_b32 a140, 0
 v_accvgpr_write_b32 a141, 0
 v_accvgpr_write_b32 a142, 0
 v_accvgpr_write_b32 a143, 0
 v_accvgpr_write_b32 a144, 0
 v_accvgpr_write_b32 a145, 0
 v_accvgpr_write_b32 a146, 0
 v_accvgpr_write_b32 a147, 0
 v_accvgpr_write_b32 a148, 0
 v_accvgpr_write_b32 a149, 0
 v_accvgpr_write_b32 a150, 0
 v_accvgpr_write_b32 a151, 0
 v_accvgpr_write_b32 a152, 0
 v_accvgpr_write_b32 a153, 0
 v_accvgpr_write_b32 a154, 0
 v_accvgpr_write_b32 a155, 0
 v_accvgpr_write_b32 a156, 0
 v_accvgpr_write_b32 a157, 0
 v_accvgpr_write_b32 a158, 0
 v_accvgpr_write_b32 a159, 0
 v_accvgpr_write_b32 a160, 0
 v_accvgpr_write_b32 a161, 0
 v_accvgpr_write_b32 a162, 0
 v_accvgpr_write_b32 a163, 0
 v_accvgpr_write_b32 a164, 0
 v_accvgpr_write_b32 a165, 0
 v_accvgpr_write_b32 a166, 0
 v_accvgpr_write_b32 a167, 0
 v_accvgpr_write_b32 a168, 0
 v_accvgpr_write_b32 a169, 0
 v_accvgpr_write_b32 a170, 0
 v_accvgpr_write_b32 a171, 0
 v_accvgpr_write_b32 a172, 0
 v_accvgpr_write_b32 a173, 0
 v_accvgpr_write_b32 a174, 0
 v_accvgpr_write_b32 a175, 0
 v_accvgpr_write_b32 a176, 0
 v_accvgpr_write_b32 a177, 0
 v_accvgpr_write_b32 a178, 0
 v_accvgpr_write_b32 a179, 0
 v_accvgpr_write_b32 a180, 0
 v_accvgpr_write_b32 a181, 0
 v_accvgpr_write_b32 a182, 0
 v_accvgpr_write_b32 a183, 0
 v_accvgpr_write_b32 a184, 0
 v_accvgpr_write_b32 a185, 0
 v_accvgpr_write_b32 a186, 0
 v_accvgpr_write_b32 a187, 0
 v_accvgpr_write_b32 a188, 0
 v_accvgpr_write_b32 a189, 0
 v_accvgpr_write_b32 a190, 0
 v_accvgpr_write_b32 a191, 0
 v_accvgpr_write_b32 a192, 0
 v_accvgpr_write_b32 a193, 0
 v_accvgpr_write_b32 a194, 0
 v_accvgpr_write_b32 a195, 0
 v_accvgpr_write_b32 a196, 0
 v_accvgpr_write_b32 a197, 0
 v_accvgpr_write_b32 a198, 0
 v_accvgpr_write_b32 a199, 0
 v_accvgpr_write_b32 a200, 0
 v_accvgpr_write_b32 a201, 0
 v_accvgpr_write_b32 a202, 0
 v_accvgpr_write_b32 a203, 0
 v_accvgpr_write_b32 a204, 0
 v_accvgpr_write_b32 a205, 0
 v_accvgpr_write_b32 a206, 0
 v_accvgpr_write_b32 a207, 0
 v_accvgpr_write_b32 a208, 0
 v_accvgpr_write_b32 a209, 0
 v_accvgpr_write_b32 a210, 0
 v_accvgpr_write_b32 a211, 0
 v_accvgpr_write_b32 a212, 0
 v_accvgpr_write_b32 a213, 0
 v_accvgpr_write_b32 a214, 0
 v_accvgpr_write_b32 a215, 0
 v_accvgpr_write_b32 a216, 0
 v_accvgpr_write_b32 a217, 0
 v_accvgpr_write_b32 a218, 0
 v_accvgpr_write_b32 a219, 0
 v_accvgpr_write_b32 a220, 0
 v_accvgpr_write_b32 a221, 0
 v_accvgpr_write_b32 a222, 0
 v_accvgpr_write_b32 a223, 0
 v_accvgpr_write_b32 a224, 0
 v_accvgpr_write_b32 a225, 0
 v_accvgpr_write_b32 a226, 0
 v_accvgpr_write_b32 a227, 0
 v_accvgpr_write_b32 a228, 0
 v_accvgpr_write_b32 a229, 0
 v_accvgpr_write_b32 a230, 0
 v_accvgpr_write_b32 a231, 0
 v_accvgpr_write_b32 a232, 0
 v_accvgpr_write_b32 a233, 0
 v_accvgpr_write_b32 a234, 0
 v_accvgpr_write_b32 a235, 0
 v_accvgpr_write_b32 a236, 0
 v_accvgpr_write_b32 a237, 0
 v_accvgpr_write_b32 a238, 0
 v_accvgpr_write_b32 a239, 0
 v_accvgpr_write_b32 a240, 0
 v_accvgpr_write_b32 a241, 0
 v_accvgpr_write_b32 a242, 0
 v_accvgpr_write_b32 a243, 0
 v_accvgpr_write_b32 a244, 0
 v_accvgpr_write_b32 a245, 0
 v_accvgpr_write_b32 a246, 0
 v_accvgpr_write_b32 a247, 0
 v_accvgpr_write_b32 a248, 0
 v_accvgpr_write_b32 a249, 0
 v_accvgpr_write_b32 a250, 0
 v_accvgpr_write_b32 a251, 0
 v_accvgpr_write_b32 a252, 0
 v_accvgpr_write_b32 a253, 0
 v_accvgpr_write_b32 a254, 0
 v_accvgpr_write_b32 a255, 0
 v_mov_b32 v208, 0
 v_mov_b32 v209, 0
 v_mov_b32 v210, 0
 v_mov_b32 v211, 0
 v_mov_b32 v212, 0
 v_mov_b32 v213, 0
 v_mov_b32 v214, 0
 v_mov_b32 v215, 0
 v_mov_b32 v216, 0
 v_mov_b32 v217, 0
 v_mov_b32 v218, 0
 v_mov_b32 v219, 0
 v_mov_b32 v220, 0
 v_mov_b32 v221, 0
 v_mov_b32 v222, 0
 v_mov_b32 v223, 0
 v_mov_b32 v224, 0
 v_mov_b32 v225, 0
 v_mov_b32 v226, 0
 v_mov_b32 v227, 0
 v_mov_b32 v228, 0
 v_mov_b32 v229, 0
 v_mov_b32 v230, 0
 v_mov_b32 v231, 0
 v_mov_b32 v232, 0
 v_mov_b32 v233, 0
 v_mov_b32 v234, 0
 v_mov_b32 v235, 0
 v_mov_b32 v236, 0
 v_mov_b32 v237, 0
 v_mov_b32 v238, 0
 v_mov_b32 v239, 0
 s_waitcnt vmcnt(0)
 s_waitcnt lgkmcnt(0)
 s_barrier
 v_add_u32 v4, 126976, v4
 ds_read_b128 v[64:67], v4 offset:0
 ds_read_b128 v[68:71], v4 offset:2048
 ds_read_b64_tr_b16 v[24:25], v6 offset:0
 ds_read_b64_tr_b16 v[26:27], v6 offset:512
 ds_read_b64_tr_b16 v[28:29], v7 offset:0
 ds_read_b64_tr_b16 v[30:31], v7 offset:512
 ds_read_b64_tr_b16 v[32:33], v10 offset:0
 ds_read_b64_tr_b16 v[34:35], v10 offset:512
 ds_read_b64_tr_b16 v[36:37], v11 offset:0
 ds_read_b64_tr_b16 v[38:39], v11 offset:512
 ds_read_b64_tr_b16 v[40:41], v6 offset:4096
 ds_read_b64_tr_b16 v[42:43], v6 offset:4608
 ds_read_b64_tr_b16 v[44:45], v7 offset:4096
 ds_read_b64_tr_b16 v[46:47], v7 offset:4608
 ds_read_b64_tr_b16 v[240:241], v10 offset:4096
 s_waitcnt lgkmcnt(5)
 v_mfma_f32_16x16x32_bf16 v[144:147], v[24:27], v[64:67], 0
 ds_read_b64_tr_b16 v[242:243], v10 offset:4608
 v_mfma_f32_16x16x32_bf16 v[148:151], v[24:27], v[68:71], 0
 ds_read_b64_tr_b16 v[244:245], v11 offset:4096
 v_mfma_f32_16x16x32_bf16 v[152:155], v[28:31], v[64:67], 0
 ds_read_b64_tr_b16 v[246:247], v11 offset:4608
 v_mfma_f32_16x16x32_bf16 v[156:159], v[28:31], v[68:71], 0
 v_add_u32 v5, 126976, v5
 ds_read_b128 v[72:75], v5 offset:0
 ds_read_b128 v[76:79], v5 offset:2048
 ds_read_b64_tr_b16 v[24:25], v6 offset:8192
 v_mfma_f32_16x16x32_bf16 v[160:163], v[32:35], v[64:67], 0
 ds_read_b64_tr_b16 v[26:27], v6 offset:8704
 v_mfma_f32_16x16x32_bf16 v[164:167], v[32:35], v[68:71], 0
 ds_read_b64_tr_b16 v[28:29], v7 offset:8192
 v_mfma_f32_16x16x32_bf16 v[168:171], v[36:39], v[64:67], 0
 ds_read_b64_tr_b16 v[30:31], v7 offset:8704
 v_mfma_f32_16x16x32_bf16 v[172:175], v[36:39], v[68:71], 0
 ds_read_b64_tr_b16 v[32:33], v10 offset:8192
 s_waitcnt lgkmcnt(7)
 v_mfma_f32_16x16x32_bf16 v[176:179], v[40:43], v[64:67], 0
 ds_read_b64_tr_b16 v[34:35], v10 offset:8704
 v_mfma_f32_16x16x32_bf16 v[180:183], v[40:43], v[68:71], 0
 ds_read_b64_tr_b16 v[36:37], v11 offset:8192
 v_mfma_f32_16x16x32_bf16 v[184:187], v[44:47], v[64:67], 0
 ds_read_b64_tr_b16 v[38:39], v11 offset:8704
 v_mfma_f32_16x16x32_bf16 v[188:191], v[44:47], v[68:71], 0
 ds_read_b64_tr_b16 v[40:41], v6 offset:12288
 v_mfma_f32_16x16x32_bf16 v[192:195], v[240:243], v[64:67], 0
 ds_read_b64_tr_b16 v[42:43], v6 offset:12800
 v_mfma_f32_16x16x32_bf16 v[196:199], v[240:243], v[68:71], 0
 ds_read_b64_tr_b16 v[44:45], v7 offset:12288
 v_mfma_f32_16x16x32_bf16 v[200:203], v[244:247], v[64:67], 0
 ds_read_b64_tr_b16 v[46:47], v7 offset:12800
 v_mfma_f32_16x16x32_bf16 v[204:207], v[244:247], v[68:71], 0
 ds_read_b64_tr_b16 v[240:241], v10 offset:12288
 s_waitcnt lgkmcnt(5)
 v_mfma_f32_16x16x32_bf16 v[144:147], v[24:27], v[72:75], v[144:147]
 ds_read_b64_tr_b16 v[242:243], v10 offset:12800
 v_mfma_f32_16x16x32_bf16 v[148:151], v[24:27], v[76:79], v[148:151]
 ds_read_b64_tr_b16 v[244:245], v11 offset:12288
 v_mfma_f32_16x16x32_bf16 v[152:155], v[28:31], v[72:75], v[152:155]
 ds_read_b64_tr_b16 v[246:247], v11 offset:12800
 v_mfma_f32_16x16x32_bf16 v[156:159], v[28:31], v[76:79], v[156:159]
 v_mfma_f32_16x16x32_bf16 v[160:163], v[32:35], v[72:75], v[160:163]
 v_mfma_f32_16x16x32_bf16 v[164:167], v[32:35], v[76:79], v[164:167]
 v_mfma_f32_16x16x32_bf16 v[168:171], v[36:39], v[72:75], v[168:171]
 v_mfma_f32_16x16x32_bf16 v[172:175], v[36:39], v[76:79], v[172:175]
 s_waitcnt lgkmcnt(0)
 s_barrier
 v_add_u32 v4, 4294938624, v4
 ds_read_b128 v[80:83], v4 offset:0
 ds_read_b128 v[84:87], v4 offset:2048
 ds_read_b64_tr_b16 v[24:25], v6 offset:16384
 ds_read_b64_tr_b16 v[28:29], v7 offset:16384
 ds_read_b64_tr_b16 v[26:27], v6 offset:16896
 ds_read_b64_tr_b16 v[32:33], v10 offset:16384
 ds_read_b64_tr_b16 v[30:31], v7 offset:16896
 v_mfma_f32_16x16x32_bf16 v[176:179], v[40:43], v[72:75], v[176:179]
 ds_read_b64_tr_b16 v[34:35], v10 offset:16896
 v_mfma_f32_16x16x32_bf16 v[180:183], v[40:43], v[76:79], v[180:183]
 ds_read_b64_tr_b16 v[36:37], v11 offset:16384
 v_mfma_f32_16x16x32_bf16 v[184:187], v[44:47], v[72:75], v[184:187]
 ds_read_b64_tr_b16 v[38:39], v11 offset:16896
 v_mfma_f32_16x16x32_bf16 v[188:191], v[44:47], v[76:79], v[188:191]
 ds_read_b64_tr_b16 v[40:41], v6 offset:20480
 v_mfma_f32_16x16x32_bf16 v[192:195], v[240:243], v[72:75], v[192:195]
 ds_read_b64_tr_b16 v[42:43], v6 offset:20992
 v_mfma_f32_16x16x32_bf16 v[196:199], v[240:243], v[76:79], v[196:199]
 ds_read_b64_tr_b16 v[44:45], v7 offset:20480
 v_mfma_f32_16x16x32_bf16 v[200:203], v[244:247], v[72:75], v[200:203]
 ds_read_b64_tr_b16 v[46:47], v7 offset:20992
 v_mfma_f32_16x16x32_bf16 v[204:207], v[244:247], v[76:79], v[204:207]
 ds_read_b64_tr_b16 v[240:241], v10 offset:20480
 s_waitcnt lgkmcnt(5)
 v_mfma_f32_16x16x32_bf16 v[144:147], v[24:27], v[80:83], v[144:147]
 ds_read_b64_tr_b16 v[242:243], v10 offset:20992
 v_mfma_f32_16x16x32_bf16 v[148:151], v[24:27], v[84:87], v[148:151]
 ds_read_b64_tr_b16 v[244:245], v11 offset:20480
 v_mfma_f32_16x16x32_bf16 v[152:155], v[28:31], v[80:83], v[152:155]
 ds_read_b64_tr_b16 v[246:247], v11 offset:20992
 v_mfma_f32_16x16x32_bf16 v[156:159], v[28:31], v[84:87], v[156:159]
 v_add_u32 v5, 4294938624, v5
 ds_read_b128 v[88:91], v5 offset:0
 ds_read_b128 v[92:95], v5 offset:2048
 ds_read_b64_tr_b16 v[24:25], v6 offset:24576
 v_mfma_f32_16x16x32_bf16 v[160:163], v[32:35], v[80:83], v[160:163]
 ds_read_b64_tr_b16 v[26:27], v6 offset:25088
 v_mfma_f32_16x16x32_bf16 v[164:167], v[32:35], v[84:87], v[164:167]
 ds_read_b64_tr_b16 v[28:29], v7 offset:24576
 v_mfma_f32_16x16x32_bf16 v[168:171], v[36:39], v[80:83], v[168:171]
 ds_read_b64_tr_b16 v[30:31], v7 offset:25088
 v_mfma_f32_16x16x32_bf16 v[172:175], v[36:39], v[84:87], v[172:175]
 ds_read_b64_tr_b16 v[32:33], v10 offset:24576
 s_waitcnt lgkmcnt(7)
 v_mfma_f32_16x16x32_bf16 v[176:179], v[40:43], v[80:83], v[176:179]
 ds_read_b64_tr_b16 v[34:35], v10 offset:25088
 v_mfma_f32_16x16x32_bf16 v[180:183], v[40:43], v[84:87], v[180:183]
 ds_read_b64_tr_b16 v[36:37], v11 offset:24576
 v_mfma_f32_16x16x32_bf16 v[184:187], v[44:47], v[80:83], v[184:187]
 ds_read_b64_tr_b16 v[38:39], v11 offset:25088
 v_mfma_f32_16x16x32_bf16 v[188:191], v[44:47], v[84:87], v[188:191]
 ds_read_b64_tr_b16 v[40:41], v6 offset:28672
 v_mfma_f32_16x16x32_bf16 v[192:195], v[240:243], v[80:83], v[192:195]
 ds_read_b64_tr_b16 v[42:43], v6 offset:29184
 v_mfma_f32_16x16x32_bf16 v[196:199], v[240:243], v[84:87], v[196:199]
 ds_read_b64_tr_b16 v[44:45], v7 offset:28672
 v_mfma_f32_16x16x32_bf16 v[200:203], v[244:247], v[80:83], v[200:203]
 ds_read_b64_tr_b16 v[46:47], v7 offset:29184
 v_mfma_f32_16x16x32_bf16 v[204:207], v[244:247], v[84:87], v[204:207]
 ds_read_b64_tr_b16 v[240:241], v10 offset:28672
 s_waitcnt lgkmcnt(5)
 v_mfma_f32_16x16x32_bf16 v[144:147], v[24:27], v[88:91], v[144:147]
 ds_read_b64_tr_b16 v[242:243], v10 offset:29184
 v_mfma_f32_16x16x32_bf16 v[148:151], v[24:27], v[92:95], v[148:151]
 ds_read_b64_tr_b16 v[244:245], v11 offset:28672
 v_mfma_f32_16x16x32_bf16 v[152:155], v[28:31], v[88:91], v[152:155]
 ds_read_b64_tr_b16 v[246:247], v11 offset:29184
 v_mfma_f32_16x16x32_bf16 v[156:159], v[28:31], v[92:95], v[156:159]
 v_mfma_f32_16x16x32_bf16 v[160:163], v[32:35], v[88:91], v[160:163]
 v_mfma_f32_16x16x32_bf16 v[164:167], v[32:35], v[92:95], v[164:167]
 v_mfma_f32_16x16x32_bf16 v[168:171], v[36:39], v[88:91], v[168:171]
 v_mfma_f32_16x16x32_bf16 v[172:175], v[36:39], v[92:95], v[172:175]
 s_waitcnt lgkmcnt(0)
 s_barrier
 ds_read_b128 v[64:67], v4 offset:12288
 ds_read_b128 v[68:71], v4 offset:14336
 ds_read_b64_tr_b16 v[24:25], v6 offset:32768
 ds_read_b64_tr_b16 v[28:29], v7 offset:32768
 ds_read_b64_tr_b16 v[26:27], v6 offset:33280
 ds_read_b64_tr_b16 v[32:33], v10 offset:32768
 ds_read_b64_tr_b16 v[30:31], v7 offset:33280
 v_mfma_f32_16x16x32_bf16 v[176:179], v[40:43], v[88:91], v[176:179]
 ds_read_b64_tr_b16 v[34:35], v10 offset:33280
 v_mfma_f32_16x16x32_bf16 v[180:183], v[40:43], v[92:95], v[180:183]
 ds_read_b64_tr_b16 v[36:37], v11 offset:32768
 v_mfma_f32_16x16x32_bf16 v[184:187], v[44:47], v[88:91], v[184:187]
 ds_read_b64_tr_b16 v[38:39], v11 offset:33280
 v_mfma_f32_16x16x32_bf16 v[188:191], v[44:47], v[92:95], v[188:191]
 ds_read_b64_tr_b16 v[40:41], v6 offset:36864
 v_mfma_f32_16x16x32_bf16 v[192:195], v[240:243], v[88:91], v[192:195]
 ds_read_b64_tr_b16 v[42:43], v6 offset:37376
 v_mfma_f32_16x16x32_bf16 v[196:199], v[240:243], v[92:95], v[196:199]
 ds_read_b64_tr_b16 v[44:45], v7 offset:36864
 v_mfma_f32_16x16x32_bf16 v[200:203], v[244:247], v[88:91], v[200:203]
 ds_read_b64_tr_b16 v[46:47], v7 offset:37376
 v_mfma_f32_16x16x32_bf16 v[204:207], v[244:247], v[92:95], v[204:207]
 ds_read_b64_tr_b16 v[240:241], v10 offset:36864
 s_waitcnt lgkmcnt(5)
 v_mfma_f32_16x16x32_bf16 v[144:147], v[24:27], v[64:67], v[144:147]
 ds_read_b64_tr_b16 v[242:243], v10 offset:37376
 v_mfma_f32_16x16x32_bf16 v[148:151], v[24:27], v[68:71], v[148:151]
 ds_read_b64_tr_b16 v[244:245], v11 offset:36864
 v_mfma_f32_16x16x32_bf16 v[152:155], v[28:31], v[64:67], v[152:155]
 ds_read_b64_tr_b16 v[246:247], v11 offset:37376
 v_mfma_f32_16x16x32_bf16 v[156:159], v[28:31], v[68:71], v[156:159]
 ds_read_b128 v[72:75], v5 offset:12288
 ds_read_b128 v[76:79], v5 offset:14336
 ds_read_b64_tr_b16 v[24:25], v6 offset:40960
 v_mfma_f32_16x16x32_bf16 v[160:163], v[32:35], v[64:67], v[160:163]
 ds_read_b64_tr_b16 v[26:27], v6 offset:41472
 v_mfma_f32_16x16x32_bf16 v[164:167], v[32:35], v[68:71], v[164:167]
 ds_read_b64_tr_b16 v[28:29], v7 offset:40960
 v_mfma_f32_16x16x32_bf16 v[168:171], v[36:39], v[64:67], v[168:171]
 ds_read_b64_tr_b16 v[30:31], v7 offset:41472
 v_mfma_f32_16x16x32_bf16 v[172:175], v[36:39], v[68:71], v[172:175]
 ds_read_b64_tr_b16 v[32:33], v10 offset:40960
 s_waitcnt lgkmcnt(7)
 v_mfma_f32_16x16x32_bf16 v[176:179], v[40:43], v[64:67], v[176:179]
 ds_read_b64_tr_b16 v[34:35], v10 offset:41472
 v_mfma_f32_16x16x32_bf16 v[180:183], v[40:43], v[68:71], v[180:183]
 ds_read_b64_tr_b16 v[36:37], v11 offset:40960
 v_mfma_f32_16x16x32_bf16 v[184:187], v[44:47], v[64:67], v[184:187]
 ds_read_b64_tr_b16 v[38:39], v11 offset:41472
 v_mfma_f32_16x16x32_bf16 v[188:191], v[44:47], v[68:71], v[188:191]
 ds_read_b64_tr_b16 v[40:41], v6 offset:45056
 v_mfma_f32_16x16x32_bf16 v[192:195], v[240:243], v[64:67], v[192:195]
 ds_read_b64_tr_b16 v[42:43], v6 offset:45568
 v_mfma_f32_16x16x32_bf16 v[196:199], v[240:243], v[68:71], v[196:199]
 ds_read_b64_tr_b16 v[44:45], v7 offset:45056
 v_mfma_f32_16x16x32_bf16 v[200:203], v[244:247], v[64:67], v[200:203]
 ds_read_b64_tr_b16 v[46:47], v7 offset:45568
 v_mfma_f32_16x16x32_bf16 v[204:207], v[244:247], v[68:71], v[204:207]
 ds_read_b64_tr_b16 v[240:241], v10 offset:45056
 s_waitcnt lgkmcnt(5)
 v_mfma_f32_16x16x32_bf16 v[144:147], v[24:27], v[72:75], v[144:147]
 ds_read_b64_tr_b16 v[242:243], v10 offset:45568
 v_mfma_f32_16x16x32_bf16 v[148:151], v[24:27], v[76:79], v[148:151]
 ds_read_b64_tr_b16 v[244:245], v11 offset:45056
 v_mfma_f32_16x16x32_bf16 v[152:155], v[28:31], v[72:75], v[152:155]
 ds_read_b64_tr_b16 v[246:247], v11 offset:45568
 v_mfma_f32_16x16x32_bf16 v[156:159], v[28:31], v[76:79], v[156:159]
 v_mfma_f32_16x16x32_bf16 v[160:163], v[32:35], v[72:75], v[160:163]
 v_mfma_f32_16x16x32_bf16 v[164:167], v[32:35], v[76:79], v[164:167]
 v_mfma_f32_16x16x32_bf16 v[168:171], v[36:39], v[72:75], v[168:171]
 v_mfma_f32_16x16x32_bf16 v[172:175], v[36:39], v[76:79], v[172:175]
 s_waitcnt lgkmcnt(0)
 s_barrier
 ds_read_b128 v[80:83], v4 offset:28672
 ds_read_b128 v[84:87], v4 offset:30720
 ds_read_b64_tr_b16 v[24:25], v6 offset:0
 ds_read_b64_tr_b16 v[28:29], v7 offset:0
 ds_read_b64_tr_b16 v[26:27], v6 offset:512
 ds_read_b64_tr_b16 v[32:33], v10 offset:0
 ds_read_b64_tr_b16 v[30:31], v7 offset:512
 v_mfma_f32_16x16x32_bf16 v[176:179], v[40:43], v[72:75], v[176:179]
 ds_read_b64_tr_b16 v[34:35], v10 offset:512
 v_mfma_f32_16x16x32_bf16 v[180:183], v[40:43], v[76:79], v[180:183]
 ds_read_b64_tr_b16 v[36:37], v11 offset:0
 v_mfma_f32_16x16x32_bf16 v[184:187], v[44:47], v[72:75], v[184:187]
 ds_read_b64_tr_b16 v[38:39], v11 offset:512
 v_mfma_f32_16x16x32_bf16 v[188:191], v[44:47], v[76:79], v[188:191]
 ds_read_b64_tr_b16 v[40:41], v6 offset:4096
 v_mfma_f32_16x16x32_bf16 v[192:195], v[240:243], v[72:75], v[192:195]
 ds_read_b64_tr_b16 v[42:43], v6 offset:4608
 v_mfma_f32_16x16x32_bf16 v[196:199], v[240:243], v[76:79], v[196:199]
 ds_read_b64_tr_b16 v[44:45], v7 offset:4096
 v_mfma_f32_16x16x32_bf16 v[200:203], v[244:247], v[72:75], v[200:203]
 ds_read_b64_tr_b16 v[46:47], v7 offset:4608
 v_mfma_f32_16x16x32_bf16 v[204:207], v[244:247], v[76:79], v[204:207]
 ds_read_b64_tr_b16 v[240:241], v10 offset:4096
 s_waitcnt lgkmcnt(5)
 v_mfma_f32_16x16x32_bf16 v[144:147], v[24:27], v[80:83], v[144:147]
 ds_read_b64_tr_b16 v[242:243], v10 offset:4608
 v_mfma_f32_16x16x32_bf16 v[148:151], v[24:27], v[84:87], v[148:151]
 ds_read_b64_tr_b16 v[244:245], v11 offset:4096
 v_mfma_f32_16x16x32_bf16 v[152:155], v[28:31], v[80:83], v[152:155]
 ds_read_b64_tr_b16 v[246:247], v11 offset:4608
 v_mfma_f32_16x16x32_bf16 v[156:159], v[28:31], v[84:87], v[156:159]
 ds_read_b128 v[88:91], v5 offset:28672
 ds_read_b128 v[92:95], v5 offset:30720
 ds_read_b64_tr_b16 v[24:25], v6 offset:8192
 v_mfma_f32_16x16x32_bf16 v[160:163], v[32:35], v[80:83], v[160:163]
 ds_read_b64_tr_b16 v[26:27], v6 offset:8704
 v_mfma_f32_16x16x32_bf16 v[164:167], v[32:35], v[84:87], v[164:167]
 ds_read_b64_tr_b16 v[28:29], v7 offset:8192
 v_mfma_f32_16x16x32_bf16 v[168:171], v[36:39], v[80:83], v[168:171]
 ds_read_b64_tr_b16 v[30:31], v7 offset:8704
 v_mfma_f32_16x16x32_bf16 v[172:175], v[36:39], v[84:87], v[172:175]
 ds_read_b64_tr_b16 v[32:33], v10 offset:8192
 s_waitcnt lgkmcnt(7)
 v_mfma_f32_16x16x32_bf16 v[176:179], v[40:43], v[80:83], v[176:179]
 ds_read_b64_tr_b16 v[34:35], v10 offset:8704
 v_mfma_f32_16x16x32_bf16 v[180:183], v[40:43], v[84:87], v[180:183]
 ds_read_b64_tr_b16 v[36:37], v11 offset:8192
 v_mfma_f32_16x16x32_bf16 v[184:187], v[44:47], v[80:83], v[184:187]
 ds_read_b64_tr_b16 v[38:39], v11 offset:8704
 v_mfma_f32_16x16x32_bf16 v[188:191], v[44:47], v[84:87], v[188:191]
 ds_read_b64_tr_b16 v[40:41], v6 offset:12288
 v_mfma_f32_16x16x32_bf16 v[192:195], v[240:243], v[80:83], v[192:195]
 ds_read_b64_tr_b16 v[42:43], v6 offset:12800
 v_mfma_f32_16x16x32_bf16 v[196:199], v[240:243], v[84:87], v[196:199]
 ds_read_b64_tr_b16 v[44:45], v7 offset:12288
 v_mfma_f32_16x16x32_bf16 v[200:203], v[244:247], v[80:83], v[200:203]
 ds_read_b64_tr_b16 v[46:47], v7 offset:12800
 v_mfma_f32_16x16x32_bf16 v[204:207], v[244:247], v[84:87], v[204:207]
 ds_read_b64_tr_b16 v[240:241], v10 offset:12288
 s_waitcnt lgkmcnt(5)
 v_mfma_f32_16x16x32_bf16 v[144:147], v[24:27], v[88:91], v[144:147]
 ds_read_b64_tr_b16 v[242:243], v10 offset:12800
 v_mfma_f32_16x16x32_bf16 v[148:151], v[24:27], v[92:95], v[148:151]
 ds_read_b64_tr_b16 v[244:245], v11 offset:12288
 v_mfma_f32_16x16x32_bf16 v[152:155], v[28:31], v[88:91], v[152:155]
 ds_read_b64_tr_b16 v[246:247], v11 offset:12800
 v_mfma_f32_16x16x32_bf16 v[156:159], v[28:31], v[92:95], v[156:159]
 v_mfma_f32_16x16x32_bf16 v[160:163], v[32:35], v[88:91], v[160:163]
 v_mfma_f32_16x16x32_bf16 v[164:167], v[32:35], v[92:95], v[164:167]
 v_mfma_f32_16x16x32_bf16 v[168:171], v[36:39], v[88:91], v[168:171]
 v_mfma_f32_16x16x32_bf16 v[172:175], v[36:39], v[92:95], v[172:175]
 s_waitcnt lgkmcnt(0)
 s_barrier
 ds_read_b128 v[64:67], v4 offset:0
 ds_read_b128 v[68:71], v4 offset:2048
 ds_read_b64_tr_b16 v[24:25], v6 offset:16384
 ds_read_b64_tr_b16 v[28:29], v7 offset:16384
 ds_read_b64_tr_b16 v[26:27], v6 offset:16896
 ds_read_b64_tr_b16 v[32:33], v10 offset:16384
 ds_read_b64_tr_b16 v[30:31], v7 offset:16896
 v_xor_b32 v252, 0, v248
 v_xor_b32 v253, 16, v248
 v_mfma_f32_16x16x32_bf16 v[176:179], v[40:43], v[88:91], v[176:179]
 ds_read_b64_tr_b16 v[34:35], v10 offset:16896
 v_xor_b32 v254, 64, v248
 v_xor_b32 v255, 80, v248
 s_add_u32 m0, s50, 49152
 s_add_u32 s46, s14, 0
 s_and_b32 s46, s46, 0x1ffff
 s_add_u32 s46, s46, s91
 buffer_load_dwordx4 v252, s[16:19], s46 offen offset:0 nt lds
 v_mfma_f32_16x16x32_bf16 v[180:183], v[40:43], v[92:95], v[180:183]
 ds_read_b64_tr_b16 v[36:37], v11 offset:16384
 v_mfma_f32_16x16x32_bf16 v[184:187], v[44:47], v[88:91], v[184:187]
 ds_read_b64_tr_b16 v[38:39], v11 offset:16896
 buffer_load_dwordx4 v253, s[16:19], s46 offen offset:1024 nt lds
 v_mfma_f32_16x16x32_bf16 v[188:191], v[44:47], v[92:95], v[188:191]
 ds_read_b64_tr_b16 v[40:41], v6 offset:20480
 v_mfma_f32_16x16x32_bf16 v[192:195], v[240:243], v[88:91], v[192:195]
 ds_read_b64_tr_b16 v[42:43], v6 offset:20992
 buffer_load_dwordx4 v254, s[16:19], s46 offen offset:2048 nt lds
 v_mfma_f32_16x16x32_bf16 v[196:199], v[240:243], v[92:95], v[196:199]
 ds_read_b64_tr_b16 v[44:45], v7 offset:20480
 v_mfma_f32_16x16x32_bf16 v[200:203], v[244:247], v[88:91], v[200:203]
 ds_read_b64_tr_b16 v[46:47], v7 offset:20992
 buffer_load_dwordx4 v255, s[16:19], s46 offen offset:3072 nt lds
 v_mfma_f32_16x16x32_bf16 v[204:207], v[244:247], v[92:95], v[204:207]
 ds_read_b64_tr_b16 v[240:241], v10 offset:20480
 s_waitcnt lgkmcnt(5)
 v_mfma_f32_16x16x32_bf16 v[144:147], v[24:27], v[64:67], v[144:147]
 ds_read_b64_tr_b16 v[242:243], v10 offset:20992
 v_mfma_f32_16x16x32_bf16 v[148:151], v[24:27], v[68:71], v[148:151]
 ds_read_b64_tr_b16 v[244:245], v11 offset:20480
 v_mfma_f32_16x16x32_bf16 v[152:155], v[28:31], v[64:67], v[152:155]
 ds_read_b64_tr_b16 v[246:247], v11 offset:20992
 v_mfma_f32_16x16x32_bf16 v[156:159], v[28:31], v[68:71], v[156:159]
 ds_read_b128 v[72:75], v5 offset:0
 ds_read_b128 v[76:79], v5 offset:2048
 ds_read_b64_tr_b16 v[24:25], v6 offset:24576
 v_mfma_f32_16x16x32_bf16 v[160:163], v[32:35], v[64:67], v[160:163]
 ds_read_b64_tr_b16 v[26:27], v6 offset:25088
 v_mfma_f32_16x16x32_bf16 v[164:167], v[32:35], v[68:71], v[164:167]
 ds_read_b64_tr_b16 v[28:29], v7 offset:24576
 v_mfma_f32_16x16x32_bf16 v[168:171], v[36:39], v[64:67], v[168:171]
 ds_read_b64_tr_b16 v[30:31], v7 offset:25088
 v_mfma_f32_16x16x32_bf16 v[172:175], v[36:39], v[68:71], v[172:175]
 ds_read_b64_tr_b16 v[32:33], v10 offset:24576
 s_waitcnt lgkmcnt(7)
 v_mfma_f32_16x16x32_bf16 v[176:179], v[40:43], v[64:67], v[176:179]
 ds_read_b64_tr_b16 v[34:35], v10 offset:25088
 v_mfma_f32_16x16x32_bf16 v[180:183], v[40:43], v[68:71], v[180:183]
 ds_read_b64_tr_b16 v[36:37], v11 offset:24576
 v_mfma_f32_16x16x32_bf16 v[184:187], v[44:47], v[64:67], v[184:187]
 ds_read_b64_tr_b16 v[38:39], v11 offset:25088
 v_mfma_f32_16x16x32_bf16 v[188:191], v[44:47], v[68:71], v[188:191]
 ds_read_b64_tr_b16 v[40:41], v6 offset:28672
 v_mfma_f32_16x16x32_bf16 v[192:195], v[240:243], v[64:67], v[192:195]
 ds_read_b64_tr_b16 v[42:43], v6 offset:29184
 v_mfma_f32_16x16x32_bf16 v[196:199], v[240:243], v[68:71], v[196:199]
 ds_read_b64_tr_b16 v[44:45], v7 offset:28672
 v_mfma_f32_16x16x32_bf16 v[200:203], v[244:247], v[64:67], v[200:203]
 ds_read_b64_tr_b16 v[46:47], v7 offset:29184
 v_mfma_f32_16x16x32_bf16 v[204:207], v[244:247], v[68:71], v[204:207]
 ds_read_b64_tr_b16 v[240:241], v10 offset:28672
 s_waitcnt lgkmcnt(5)
 v_mfma_f32_16x16x32_bf16 v[144:147], v[24:27], v[72:75], v[144:147]
 ds_read_b64_tr_b16 v[242:243], v10 offset:29184
 v_mfma_f32_16x16x32_bf16 v[148:151], v[24:27], v[76:79], v[148:151]
 ds_read_b64_tr_b16 v[244:245], v11 offset:28672
 v_mfma_f32_16x16x32_bf16 v[152:155], v[28:31], v[72:75], v[152:155]
 ds_read_b64_tr_b16 v[246:247], v11 offset:29184
 v_mfma_f32_16x16x32_bf16 v[156:159], v[28:31], v[76:79], v[156:159]
 v_mfma_f32_16x16x32_bf16 v[160:163], v[32:35], v[72:75], v[160:163]
 v_mfma_f32_16x16x32_bf16 v[164:167], v[32:35], v[76:79], v[164:167]
 v_mfma_f32_16x16x32_bf16 v[168:171], v[36:39], v[72:75], v[168:171]
 v_mfma_f32_16x16x32_bf16 v[172:175], v[36:39], v[76:79], v[172:175]
 s_waitcnt lgkmcnt(0)
 s_barrier
 ds_read_b128 v[80:83], v4 offset:12288
 ds_read_b128 v[84:87], v4 offset:14336
 ds_read_b64_tr_b16 v[24:25], v6 offset:32768
 ds_read_b64_tr_b16 v[28:29], v7 offset:32768
 ds_read_b64_tr_b16 v[26:27], v6 offset:33280
 ds_read_b64_tr_b16 v[32:33], v10 offset:32768
 ds_read_b64_tr_b16 v[30:31], v7 offset:33280
 v_mov_b32 v252, v251
 v_xor_b32 v253, s67, v251
 v_mfma_f32_16x16x32_bf16 v[176:179], v[40:43], v[72:75], v[176:179]
 ds_read_b64_tr_b16 v[34:35], v10 offset:33280
 v_xor_b32 v254, s100, v251
 v_xor_b32 v255, s100, v253
 s_add_u32 m0, s50, 65536
 s_add_u32 s46, s90, 8192
 s_and_b32 s46, s46, 0x1ffff
 s_add_u32 s46, s46, s91
 buffer_load_dwordx4 v252, s[96:99], s46 offen offset:0 nt lds
 v_mfma_f32_16x16x32_bf16 v[180:183], v[40:43], v[76:79], v[180:183]
 ds_read_b64_tr_b16 v[36:37], v11 offset:32768
 v_mfma_f32_16x16x32_bf16 v[184:187], v[44:47], v[72:75], v[184:187]
 ds_read_b64_tr_b16 v[38:39], v11 offset:33280
 buffer_load_dwordx4 v253, s[96:99], s46 offen offset:1024 nt lds
 v_mfma_f32_16x16x32_bf16 v[188:191], v[44:47], v[76:79], v[188:191]
 ds_read_b64_tr_b16 v[40:41], v6 offset:36864
 v_mfma_f32_16x16x32_bf16 v[192:195], v[240:243], v[72:75], v[192:195]
 ds_read_b64_tr_b16 v[42:43], v6 offset:37376
 buffer_load_dwordx4 v254, s[96:99], s46 offen offset:2048 nt lds
 v_mfma_f32_16x16x32_bf16 v[196:199], v[240:243], v[76:79], v[196:199]
 ds_read_b64_tr_b16 v[44:45], v7 offset:36864
 v_mfma_f32_16x16x32_bf16 v[200:203], v[244:247], v[72:75], v[200:203]
 ds_read_b64_tr_b16 v[46:47], v7 offset:37376
 buffer_load_dwordx4 v255, s[96:99], s46 offen offset:3072 nt lds
 v_mfma_f32_16x16x32_bf16 v[204:207], v[244:247], v[76:79], v[204:207]
 ds_read_b64_tr_b16 v[240:241], v10 offset:36864
 s_waitcnt lgkmcnt(5)
 v_mfma_f32_16x16x32_bf16 v[144:147], v[24:27], v[80:83], v[144:147]
 ds_read_b64_tr_b16 v[242:243], v10 offset:37376
 v_mfma_f32_16x16x32_bf16 v[148:151], v[24:27], v[84:87], v[148:151]
 ds_read_b64_tr_b16 v[244:245], v11 offset:36864
 v_mfma_f32_16x16x32_bf16 v[152:155], v[28:31], v[80:83], v[152:155]
 ds_read_b64_tr_b16 v[246:247], v11 offset:37376
 v_mfma_f32_16x16x32_bf16 v[156:159], v[28:31], v[84:87], v[156:159]
 ds_read_b128 v[88:91], v5 offset:12288
 ds_read_b128 v[92:95], v5 offset:14336
 ds_read_b64_tr_b16 v[24:25], v6 offset:40960
 v_mfma_f32_16x16x32_bf16 v[160:163], v[32:35], v[80:83], v[160:163]
 ds_read_b64_tr_b16 v[26:27], v6 offset:41472
 v_mfma_f32_16x16x32_bf16 v[164:167], v[32:35], v[84:87], v[164:167]
 ds_read_b64_tr_b16 v[28:29], v7 offset:40960
 v_mfma_f32_16x16x32_bf16 v[168:171], v[36:39], v[80:83], v[168:171]
 ds_read_b64_tr_b16 v[30:31], v7 offset:41472
 v_mfma_f32_16x16x32_bf16 v[172:175], v[36:39], v[84:87], v[172:175]
 ds_read_b64_tr_b16 v[32:33], v10 offset:40960
 s_waitcnt lgkmcnt(7)
 v_mfma_f32_16x16x32_bf16 v[176:179], v[40:43], v[80:83], v[176:179]
 ds_read_b64_tr_b16 v[34:35], v10 offset:41472
 v_mfma_f32_16x16x32_bf16 v[180:183], v[40:43], v[84:87], v[180:183]
 ds_read_b64_tr_b16 v[36:37], v11 offset:40960
 v_mfma_f32_16x16x32_bf16 v[184:187], v[44:47], v[80:83], v[184:187]
 ds_read_b64_tr_b16 v[38:39], v11 offset:41472
 v_mfma_f32_16x16x32_bf16 v[188:191], v[44:47], v[84:87], v[188:191]
 ds_read_b64_tr_b16 v[40:41], v6 offset:45056
 v_mfma_f32_16x16x32_bf16 v[192:195], v[240:243], v[80:83], v[192:195]
 ds_read_b64_tr_b16 v[42:43], v6 offset:45568
 v_mfma_f32_16x16x32_bf16 v[196:199], v[240:243], v[84:87], v[196:199]
 ds_read_b64_tr_b16 v[44:45], v7 offset:45056
 v_mfma_f32_16x16x32_bf16 v[200:203], v[244:247], v[80:83], v[200:203]
 ds_read_b64_tr_b16 v[46:47], v7 offset:45568
 v_mfma_f32_16x16x32_bf16 v[204:207], v[244:247], v[84:87], v[204:207]
 ds_read_b64_tr_b16 v[240:241], v10 offset:45056
 s_waitcnt lgkmcnt(5)
 v_mfma_f32_16x16x32_bf16 v[144:147], v[24:27], v[88:91], v[144:147]
 ds_read_b64_tr_b16 v[242:243], v10 offset:45568
 v_mfma_f32_16x16x32_bf16 v[148:151], v[24:27], v[92:95], v[148:151]
 ds_read_b64_tr_b16 v[244:245], v11 offset:45056
 v_mfma_f32_16x16x32_bf16 v[152:155], v[28:31], v[88:91], v[152:155]
 ds_read_b64_tr_b16 v[246:247], v11 offset:45568
 v_mfma_f32_16x16x32_bf16 v[156:159], v[28:31], v[92:95], v[156:159]
 v_mfma_f32_16x16x32_bf16 v[160:163], v[32:35], v[88:91], v[160:163]
 v_mfma_f32_16x16x32_bf16 v[164:167], v[32:35], v[92:95], v[164:167]
 v_mfma_f32_16x16x32_bf16 v[168:171], v[36:39], v[88:91], v[168:171]
 v_mfma_f32_16x16x32_bf16 v[172:175], v[36:39], v[92:95], v[172:175]
 s_waitcnt lgkmcnt(0)
 s_barrier
 ds_read_b128 v[64:67], v4 offset:28672
 ds_read_b128 v[68:71], v4 offset:30720
 ds_read_b64_tr_b16 v[24:25], v6 offset:0
 ds_read_b64_tr_b16 v[28:29], v7 offset:0
 ds_read_b64_tr_b16 v[26:27], v6 offset:512
 ds_read_b64_tr_b16 v[32:33], v10 offset:0
 ds_read_b64_tr_b16 v[30:31], v7 offset:512
 v_mfma_f32_16x16x32_bf16 v[176:179], v[40:43], v[88:91], v[176:179]
 ds_read_b64_tr_b16 v[34:35], v10 offset:512
 s_add_u32 m0, s50, 81920
 s_add_u32 s46, s90, 16384
 s_and_b32 s46, s46, 0x1ffff
 s_add_u32 s46, s46, s91
 buffer_load_dwordx4 v252, s[96:99], s46 offen offset:0 nt lds
 v_mfma_f32_16x16x32_bf16 v[180:183], v[40:43], v[92:95], v[180:183]
 ds_read_b64_tr_b16 v[36:37], v11 offset:0
 v_mfma_f32_16x16x32_bf16 v[184:187], v[44:47], v[88:91], v[184:187]
 ds_read_b64_tr_b16 v[38:39], v11 offset:512
 buffer_load_dwordx4 v253, s[96:99], s46 offen offset:1024 nt lds
 v_mfma_f32_16x16x32_bf16 v[188:191], v[44:47], v[92:95], v[188:191]
 ds_read_b64_tr_b16 v[40:41], v6 offset:4096
 v_mfma_f32_16x16x32_bf16 v[192:195], v[240:243], v[88:91], v[192:195]
 ds_read_b64_tr_b16 v[42:43], v6 offset:4608
 buffer_load_dwordx4 v254, s[96:99], s46 offen offset:2048 nt lds
 v_mfma_f32_16x16x32_bf16 v[196:199], v[240:243], v[92:95], v[196:199]
 ds_read_b64_tr_b16 v[44:45], v7 offset:4096
 v_mfma_f32_16x16x32_bf16 v[200:203], v[244:247], v[88:91], v[200:203]
 ds_read_b64_tr_b16 v[46:47], v7 offset:4608
 buffer_load_dwordx4 v255, s[96:99], s46 offen offset:3072 nt lds
 v_mfma_f32_16x16x32_bf16 v[204:207], v[244:247], v[92:95], v[204:207]
 ds_read_b64_tr_b16 v[240:241], v10 offset:4096
 s_waitcnt lgkmcnt(5)
 v_mfma_f32_16x16x32_bf16 v[144:147], v[24:27], v[64:67], v[144:147]
 ds_read_b64_tr_b16 v[242:243], v10 offset:4608
 v_mfma_f32_16x16x32_bf16 v[148:151], v[24:27], v[68:71], v[148:151]
 ds_read_b64_tr_b16 v[244:245], v11 offset:4096
 v_mfma_f32_16x16x32_bf16 v[152:155], v[28:31], v[64:67], v[152:155]
 ds_read_b64_tr_b16 v[246:247], v11 offset:4608
 v_mfma_f32_16x16x32_bf16 v[156:159], v[28:31], v[68:71], v[156:159]
 ds_read_b128 v[72:75], v5 offset:28672
 ds_read_b128 v[76:79], v5 offset:30720
 ds_read_b64_tr_b16 v[24:25], v6 offset:8192
 v_mfma_f32_16x16x32_bf16 v[160:163], v[32:35], v[64:67], v[160:163]
 ds_read_b64_tr_b16 v[26:27], v6 offset:8704
 v_mfma_f32_16x16x32_bf16 v[164:167], v[32:35], v[68:71], v[164:167]
 ds_read_b64_tr_b16 v[28:29], v7 offset:8192
 v_mfma_f32_16x16x32_bf16 v[168:171], v[36:39], v[64:67], v[168:171]
 ds_read_b64_tr_b16 v[30:31], v7 offset:8704
 v_mfma_f32_16x16x32_bf16 v[172:175], v[36:39], v[68:71], v[172:175]
 ds_read_b64_tr_b16 v[32:33], v10 offset:8192
 s_waitcnt lgkmcnt(7)
 v_mfma_f32_16x16x32_bf16 v[176:179], v[40:43], v[64:67], v[176:179]
 ds_read_b64_tr_b16 v[34:35], v10 offset:8704
 v_mfma_f32_16x16x32_bf16 v[180:183], v[40:43], v[68:71], v[180:183]
 ds_read_b64_tr_b16 v[36:37], v11 offset:8192
 v_mfma_f32_16x16x32_bf16 v[184:187], v[44:47], v[64:67], v[184:187]
 ds_read_b64_tr_b16 v[38:39], v11 offset:8704
 v_mfma_f32_16x16x32_bf16 v[188:191], v[44:47], v[68:71], v[188:191]
 ds_read_b64_tr_b16 v[40:41], v6 offset:12288
 v_mfma_f32_16x16x32_bf16 v[192:195], v[240:243], v[64:67], v[192:195]
 ds_read_b64_tr_b16 v[42:43], v6 offset:12800
 v_mfma_f32_16x16x32_bf16 v[196:199], v[240:243], v[68:71], v[196:199]
 ds_read_b64_tr_b16 v[44:45], v7 offset:12288
 v_mfma_f32_16x16x32_bf16 v[200:203], v[244:247], v[64:67], v[200:203]
 ds_read_b64_tr_b16 v[46:47], v7 offset:12800
 v_mfma_f32_16x16x32_bf16 v[204:207], v[244:247], v[68:71], v[204:207]
 ds_read_b64_tr_b16 v[240:241], v10 offset:12288
 s_waitcnt lgkmcnt(5)
 v_mfma_f32_16x16x32_bf16 v[144:147], v[24:27], v[72:75], v[144:147]
 ds_read_b64_tr_b16 v[242:243], v10 offset:12800
 v_mfma_f32_16x16x32_bf16 v[148:151], v[24:27], v[76:79], v[148:151]
 ds_read_b64_tr_b16 v[244:245], v11 offset:12288
 v_mfma_f32_16x16x32_bf16 v[152:155], v[28:31], v[72:75], v[152:155]
 ds_read_b64_tr_b16 v[246:247], v11 offset:12800
 v_mfma_f32_16x16x32_bf16 v[156:159], v[28:31], v[76:79], v[156:159]
 v_mfma_f32_16x16x32_bf16 v[160:163], v[32:35], v[72:75], v[160:163]
 v_mfma_f32_16x16x32_bf16 v[164:167], v[32:35], v[76:79], v[164:167]
 v_mfma_f32_16x16x32_bf16 v[168:171], v[36:39], v[72:75], v[168:171]
 v_mfma_f32_16x16x32_bf16 v[172:175], v[36:39], v[76:79], v[172:175]
 s_waitcnt lgkmcnt(0)
 s_barrier
 ds_read_b128 v[80:83], v4 offset:40960
 ds_read_b128 v[84:87], v4 offset:43008
 ds_read_b64_tr_b16 v[24:25], v6 offset:16384
 ds_read_b64_tr_b16 v[28:29], v7 offset:16384
 ds_read_b64_tr_b16 v[26:27], v6 offset:16896
 ds_read_b64_tr_b16 v[32:33], v10 offset:16384
 ds_read_b64_tr_b16 v[30:31], v7 offset:16896
 v_mfma_f32_16x16x32_bf16 v[176:179], v[40:43], v[72:75], v[176:179]
 ds_read_b64_tr_b16 v[34:35], v10 offset:16896
 s_add_u32 m0, s50, 0
 s_add_u32 s46, s90, 24576
 s_and_b32 s46, s46, 0x1ffff
 s_add_u32 s46, s46, s91
 buffer_load_dwordx4 v252, s[96:99], s46 offen offset:0 nt lds
 v_mfma_f32_16x16x32_bf16 v[180:183], v[40:43], v[76:79], v[180:183]
 ds_read_b64_tr_b16 v[36:37], v11 offset:16384
 v_mfma_f32_16x16x32_bf16 v[184:187], v[44:47], v[72:75], v[184:187]
 ds_read_b64_tr_b16 v[38:39], v11 offset:16896
 buffer_load_dwordx4 v253, s[96:99], s46 offen offset:1024 nt lds
 v_mfma_f32_16x16x32_bf16 v[188:191], v[44:47], v[76:79], v[188:191]
 ds_read_b64_tr_b16 v[40:41], v6 offset:20480
 v_mfma_f32_16x16x32_bf16 v[192:195], v[240:243], v[72:75], v[192:195]
 ds_read_b64_tr_b16 v[42:43], v6 offset:20992
 buffer_load_dwordx4 v254, s[96:99], s46 offen offset:2048 nt lds
 v_mfma_f32_16x16x32_bf16 v[196:199], v[240:243], v[76:79], v[196:199]
 ds_read_b64_tr_b16 v[44:45], v7 offset:20480
 v_mfma_f32_16x16x32_bf16 v[200:203], v[244:247], v[72:75], v[200:203]
 ds_read_b64_tr_b16 v[46:47], v7 offset:20992
 buffer_load_dwordx4 v255, s[96:99], s46 offen offset:3072 nt lds
 v_mfma_f32_16x16x32_bf16 v[204:207], v[244:247], v[76:79], v[204:207]
 ds_read_b64_tr_b16 v[240:241], v10 offset:20480
 s_waitcnt lgkmcnt(5)
 v_mfma_f32_16x16x32_bf16 v[144:147], v[24:27], v[80:83], v[144:147]
 ds_read_b64_tr_b16 v[242:243], v10 offset:20992
 v_mfma_f32_16x16x32_bf16 v[148:151], v[24:27], v[84:87], v[148:151]
 ds_read_b64_tr_b16 v[244:245], v11 offset:20480
 v_mfma_f32_16x16x32_bf16 v[152:155], v[28:31], v[80:83], v[152:155]
 ds_read_b64_tr_b16 v[246:247], v11 offset:20992
 v_mfma_f32_16x16x32_bf16 v[156:159], v[28:31], v[84:87], v[156:159]
 ds_read_b128 v[88:91], v5 offset:40960
 ds_read_b128 v[92:95], v5 offset:43008
 ds_read_b64_tr_b16 v[24:25], v6 offset:24576
 v_mfma_f32_16x16x32_bf16 v[160:163], v[32:35], v[80:83], v[160:163]
 ds_read_b64_tr_b16 v[26:27], v6 offset:25088
 v_mfma_f32_16x16x32_bf16 v[164:167], v[32:35], v[84:87], v[164:167]
 ds_read_b64_tr_b16 v[28:29], v7 offset:24576
 v_mfma_f32_16x16x32_bf16 v[168:171], v[36:39], v[80:83], v[168:171]
 ds_read_b64_tr_b16 v[30:31], v7 offset:25088
 v_mfma_f32_16x16x32_bf16 v[172:175], v[36:39], v[84:87], v[172:175]
 ds_read_b64_tr_b16 v[32:33], v10 offset:24576
 s_waitcnt lgkmcnt(7)
 v_mfma_f32_16x16x32_bf16 v[176:179], v[40:43], v[80:83], v[176:179]
 ds_read_b64_tr_b16 v[34:35], v10 offset:25088
 v_mfma_f32_16x16x32_bf16 v[180:183], v[40:43], v[84:87], v[180:183]
 ds_read_b64_tr_b16 v[36:37], v11 offset:24576
 v_mfma_f32_16x16x32_bf16 v[184:187], v[44:47], v[80:83], v[184:187]
 ds_read_b64_tr_b16 v[38:39], v11 offset:25088
 v_mfma_f32_16x16x32_bf16 v[188:191], v[44:47], v[84:87], v[188:191]
 ds_read_b64_tr_b16 v[40:41], v6 offset:28672
 v_mfma_f32_16x16x32_bf16 v[192:195], v[240:243], v[80:83], v[192:195]
 ds_read_b64_tr_b16 v[42:43], v6 offset:29184
 v_mfma_f32_16x16x32_bf16 v[196:199], v[240:243], v[84:87], v[196:199]
 ds_read_b64_tr_b16 v[44:45], v7 offset:28672
 v_mfma_f32_16x16x32_bf16 v[200:203], v[244:247], v[80:83], v[200:203]
 ds_read_b64_tr_b16 v[46:47], v7 offset:29184
 v_mfma_f32_16x16x32_bf16 v[204:207], v[244:247], v[84:87], v[204:207]
 ds_read_b64_tr_b16 v[240:241], v10 offset:28672
 s_waitcnt lgkmcnt(5)
 v_mfma_f32_16x16x32_bf16 v[144:147], v[24:27], v[88:91], v[144:147]
 ds_read_b64_tr_b16 v[242:243], v10 offset:29184
 v_mfma_f32_16x16x32_bf16 v[148:151], v[24:27], v[92:95], v[148:151]
 ds_read_b64_tr_b16 v[244:245], v11 offset:28672
 v_mfma_f32_16x16x32_bf16 v[152:155], v[28:31], v[88:91], v[152:155]
 ds_read_b64_tr_b16 v[246:247], v11 offset:29184
 v_mfma_f32_16x16x32_bf16 v[156:159], v[28:31], v[92:95], v[156:159]
 v_mfma_f32_16x16x32_bf16 v[160:163], v[32:35], v[88:91], v[160:163]
 v_mfma_f32_16x16x32_bf16 v[164:167], v[32:35], v[92:95], v[164:167]
 v_mfma_f32_16x16x32_bf16 v[168:171], v[36:39], v[88:91], v[168:171]
 v_mfma_f32_16x16x32_bf16 v[172:175], v[36:39], v[92:95], v[172:175]
 s_waitcnt lgkmcnt(0)
 s_barrier
 ds_read_b128 v[64:67], v4 offset:53248
 ds_read_b128 v[68:71], v4 offset:55296
 ds_read_b64_tr_b16 v[24:25], v6 offset:32768
 ds_read_b64_tr_b16 v[28:29], v7 offset:32768
 ds_read_b64_tr_b16 v[26:27], v6 offset:33280
 ds_read_b128 v[72:75], v5 offset:53248
 ds_read_b128 v[76:79], v5 offset:55296
 ds_read_b64_tr_b16 v[32:33], v6 offset:40960
 ds_read_b64_tr_b16 v[30:31], v7 offset:33280
 v_mfma_f32_16x16x32_bf16 v[176:179], v[40:43], v[88:91], v[176:179]
 ds_read_b64_tr_b16 v[34:35], v6 offset:41472
 s_add_u32 m0, s50, 16384
 s_add_u32 s46, s90, 32768
 s_and_b32 s46, s46, 0x1ffff
 s_add_u32 s46, s46, s91
 buffer_load_dwordx4 v252, s[96:99], s46 offen offset:0 nt lds
 v_mfma_f32_16x16x32_bf16 v[180:183], v[40:43], v[92:95], v[180:183]
 ds_read_b64_tr_b16 v[36:37], v7 offset:40960
 v_mfma_f32_16x16x32_bf16 v[184:187], v[44:47], v[88:91], v[184:187]
 ds_read_b64_tr_b16 v[38:39], v7 offset:41472
 buffer_load_dwordx4 v253, s[96:99], s46 offen offset:1024 nt lds
 v_mfma_f32_16x16x32_bf16 v[188:191], v[44:47], v[92:95], v[188:191]
 ds_read_b64_tr_b16 v[40:41], v10 offset:32768
 v_mfma_f32_16x16x32_bf16 v[192:195], v[240:243], v[88:91], v[192:195]
 ds_read_b64_tr_b16 v[42:43], v10 offset:33280
 buffer_load_dwordx4 v254, s[96:99], s46 offen offset:2048 nt lds
 v_mfma_f32_16x16x32_bf16 v[196:199], v[240:243], v[92:95], v[196:199]
 ds_read_b64_tr_b16 v[44:45], v11 offset:32768
 v_mfma_f32_16x16x32_bf16 v[200:203], v[244:247], v[88:91], v[200:203]
 ds_read_b64_tr_b16 v[46:47], v11 offset:33280
 s_waitcnt lgkmcnt(15)
 buffer_load_dwordx4 v255, s[96:99], s46 offen offset:3072 nt lds
 v_mfma_f32_16x16x32_bf16 v[204:207], v[244:247], v[92:95], v[204:207]
 ds_read_b64_tr_b16 v[240:241], v10 offset:40960
 s_waitcnt lgkmcnt(15)
 s_waitcnt lgkmcnt(5)
 v_mfma_f32_16x16x32_bf16 v[144:147], v[24:27], v[64:67], v[144:147]
 ds_read_b64_tr_b16 v[242:243], v10 offset:41472
 v_mfma_f32_16x16x32_bf16 v[148:151], v[24:27], v[68:71], v[148:151]
 ds_read_b64_tr_b16 v[244:245], v11 offset:40960
 v_mfma_f32_16x16x32_bf16 v[152:155], v[28:31], v[64:67], v[152:155]
 ds_read_b64_tr_b16 v[246:247], v11 offset:41472
 v_mfma_f32_16x16x32_bf16 v[156:159], v[28:31], v[68:71], v[156:159]
 ds_read_b64_tr_b16 v[24:25], v6 offset:36864
 v_mfma_f32_16x16x32_bf16 v[144:147], v[32:35], v[72:75], v[144:147]
 ds_read_b64_tr_b16 v[26:27], v6 offset:37376
 v_mfma_f32_16x16x32_bf16 v[148:151], v[32:35], v[76:79], v[148:151]
 ds_read_b64_tr_b16 v[28:29], v7 offset:36864
 v_mfma_f32_16x16x32_bf16 v[152:155], v[36:39], v[72:75], v[152:155]
 ds_read_b64_tr_b16 v[30:31], v7 offset:37376
 v_mfma_f32_16x16x32_bf16 v[156:159], v[36:39], v[76:79], v[156:159]
 ds_read_b64_tr_b16 v[32:33], v6 offset:45056
 s_waitcnt lgkmcnt(5)
 v_mfma_f32_16x16x32_bf16 v[160:163], v[40:43], v[64:67], v[160:163]
 ds_read_b64_tr_b16 v[34:35], v6 offset:45568
 v_mfma_f32_16x16x32_bf16 v[164:167], v[40:43], v[68:71], v[164:167]
 ds_read_b64_tr_b16 v[36:37], v7 offset:45056
 v_mfma_f32_16x16x32_bf16 v[168:171], v[44:47], v[64:67], v[168:171]
 ds_read_b64_tr_b16 v[38:39], v7 offset:45568
 v_mfma_f32_16x16x32_bf16 v[172:175], v[44:47], v[68:71], v[172:175]
 ds_read_b64_tr_b16 v[40:41], v10 offset:36864
 v_mul_f32 v144, s48, v144
 v_mul_f32 v145, s48, v145
 v_mul_f32 v146, s48, v146
 v_mfma_f32_16x16x32_bf16 v[160:163], v[240:243], v[72:75], v[160:163]
 ds_read_b64_tr_b16 v[42:43], v10 offset:37376
 v_mul_f32 v147, s48, v147
 v_cvt_pk_bf16_f32 v112, v144, v145
 v_cvt_pk_bf16_f32 v113, v146, v147
 v_mfma_f32_16x16x32_bf16 v[164:167], v[240:243], v[76:79], v[164:167]
 ds_read_b64_tr_b16 v[44:45], v11 offset:36864
 v_mul_f32 v152, s48, v152
 v_mul_f32 v153, s48, v153
 v_mfma_f32_16x16x32_bf16 v[168:171], v[244:247], v[72:75], v[168:171]
 ds_read_b64_tr_b16 v[46:47], v11 offset:37376
 v_mul_f32 v154, s48, v154
 v_mul_f32 v155, s48, v155
 v_cvt_pk_bf16_f32 v114, v152, v153
 v_mfma_f32_16x16x32_bf16 v[172:175], v[244:247], v[76:79], v[172:175]
 ds_read_b64_tr_b16 v[240:241], v10 offset:45056
 v_cvt_pk_bf16_f32 v115, v154, v155
 v_mul_f32 v148, s48, v148
 s_waitcnt lgkmcnt(5)
 v_mfma_f32_16x16x32_bf16 v[176:179], v[24:27], v[64:67], v[176:179]
 ds_read_b64_tr_b16 v[242:243], v10 offset:45568
 v_mul_f32 v149, s48, v149
 v_mul_f32 v150, s48, v150
 v_mul_f32 v151, s48, v151
 v_cvt_pk_bf16_f32 v116, v148, v149
 v_mfma_f32_16x16x32_bf16 v[180:183], v[24:27], v[68:71], v[180:183]
 ds_read_b64_tr_b16 v[244:245], v11 offset:45056
 v_cvt_pk_bf16_f32 v117, v150, v151
 v_mul_f32 v156, s48, v156
 v_mfma_f32_16x16x32_bf16 v[184:187], v[28:31], v[64:67], v[184:187]
 ds_read_b64_tr_b16 v[246:247], v11 offset:45568
 v_mul_f32 v157, s48, v157
 v_mul_f32 v158, s48, v158
 v_mul_f32 v159, s48, v159
 v_mfma_f32_16x16x32_bf16 v[188:191], v[28:31], v[68:71], v[188:191]
 v_cvt_pk_bf16_f32 v118, v156, v157
 v_cvt_pk_bf16_f32 v119, v158, v159
 v_permlane16_swap_b32 v112, v114
 v_mfma_f32_16x16x32_bf16 v[176:179], v[32:35], v[72:75], v[176:179]
 v_permlane16_swap_b32 v113, v115
 v_permlane16_swap_b32 v116, v118
 v_permlane16_swap_b32 v117, v119
 v_mfma_f32_16x16x32_bf16 v[180:183], v[32:35], v[76:79], v[180:183]
 v_mul_f32 v160, s48, v160
 v_mul_f32 v161, s48, v161
 v_mul_f32 v162, s48, v162
 v_mfma_f32_16x16x32_bf16 v[184:187], v[36:39], v[72:75], v[184:187]
 v_mul_f32 v163, s48, v163
 v_cvt_pk_bf16_f32 v120, v160, v161
 v_cvt_pk_bf16_f32 v121, v162, v163
 v_mfma_f32_16x16x32_bf16 v[188:191], v[36:39], v[76:79], v[188:191]
 v_mul_f32 v168, s48, v168
 v_mul_f32 v169, s48, v169
 s_waitcnt lgkmcnt(0)
 v_mfma_f32_16x16x32_bf16 v[192:195], v[40:43], v[64:67], v[192:195]
 v_mul_f32 v170, s48, v170
 v_mul_f32 v171, s48, v171
 v_cvt_pk_bf16_f32 v122, v168, v169
 v_mfma_f32_16x16x32_bf16 v[196:199], v[40:43], v[68:71], v[196:199]
 v_cvt_pk_bf16_f32 v123, v170, v171
 v_mul_f32 v164, s48, v164
 v_mul_f32 v165, s48, v165
 v_mfma_f32_16x16x32_bf16 v[200:203], v[44:47], v[64:67], v[200:203]
 v_mul_f32 v166, s48, v166
 v_mul_f32 v167, s48, v167
 v_cvt_pk_bf16_f32 v124, v164, v165
 v_mfma_f32_16x16x32_bf16 v[204:207], v[44:47], v[68:71], v[204:207]
 v_cvt_pk_bf16_f32 v125, v166, v167
 v_mul_f32 v172, s48, v172
 v_mfma_f32_16x16x32_bf16 v[192:195], v[240:243], v[72:75], v[192:195]
 v_mul_f32 v173, s48, v173
 v_mul_f32 v174, s48, v174
 v_mul_f32 v175, s48, v175
 v_mfma_f32_16x16x32_bf16 v[196:199], v[240:243], v[76:79], v[196:199]
 v_cvt_pk_bf16_f32 v126, v172, v173
 v_cvt_pk_bf16_f32 v127, v174, v175
 v_permlane16_swap_b32 v120, v122
 v_mfma_f32_16x16x32_bf16 v[200:203], v[244:247], v[72:75], v[200:203]
 v_permlane16_swap_b32 v121, v123
 v_permlane16_swap_b32 v124, v126
 v_permlane16_swap_b32 v125, v127
 v_mfma_f32_16x16x32_bf16 v[204:207], v[244:247], v[76:79], v[204:207]
 v_mul_f32 v176, s48, v176
 v_mul_f32 v177, s48, v177
 v_mul_f32 v178, s48, v178
 v_mul_f32 v179, s48, v179
 v_cvt_pk_bf16_f32 v128, v176, v177
 v_cvt_pk_bf16_f32 v129, v178, v179
 v_mul_f32 v184, s48, v184
 v_mul_f32 v185, s48, v185
 v_mul_f32 v186, s48, v186
 v_mul_f32 v187, s48, v187
 v_cvt_pk_bf16_f32 v130, v184, v185
 v_cvt_pk_bf16_f32 v131, v186, v187
 v_mul_f32 v180, s48, v180
 v_mul_f32 v181, s48, v181
 v_mul_f32 v182, s48, v182
 v_mul_f32 v183, s48, v183
 v_cvt_pk_bf16_f32 v132, v180, v181
 v_cvt_pk_bf16_f32 v133, v182, v183
 v_mul_f32 v188, s48, v188
 v_mul_f32 v189, s48, v189
 v_mul_f32 v190, s48, v190
 v_mul_f32 v191, s48, v191
 v_cvt_pk_bf16_f32 v134, v188, v189
 v_cvt_pk_bf16_f32 v135, v190, v191
 v_permlane16_swap_b32 v128, v130
 v_permlane16_swap_b32 v129, v131
 v_permlane16_swap_b32 v132, v134
 v_permlane16_swap_b32 v133, v135
 v_mul_f32 v192, s48, v192
 v_mul_f32 v193, s48, v193
 v_mul_f32 v194, s48, v194
 v_mul_f32 v195, s48, v195
 v_cvt_pk_bf16_f32 v136, v192, v193
 v_cvt_pk_bf16_f32 v137, v194, v195
 v_mul_f32 v200, s48, v200
 v_mul_f32 v201, s48, v201
 v_mul_f32 v202, s48, v202
 v_mul_f32 v203, s48, v203
 v_cvt_pk_bf16_f32 v138, v200, v201
 v_cvt_pk_bf16_f32 v139, v202, v203
 v_mul_f32 v196, s48, v196
 v_mul_f32 v197, s48, v197
 v_mul_f32 v198, s48, v198
 v_mul_f32 v199, s48, v199
 v_cvt_pk_bf16_f32 v140, v196, v197
 v_cvt_pk_bf16_f32 v141, v198, v199
 v_mul_f32 v204, s48, v204
 v_mul_f32 v205, s48, v205
 v_mul_f32 v206, s48, v206
 v_mul_f32 v207, s48, v207
 v_cvt_pk_bf16_f32 v142, v204, v205
 v_cvt_pk_bf16_f32 v143, v206, v207
 v_permlane16_swap_b32 v136, v138
 v_permlane16_swap_b32 v137, v139
 v_permlane16_swap_b32 v140, v142
 v_permlane16_swap_b32 v141, v143
 v_bfe_u32 v16, v0, 2, 2
 v_and_b32 v2, 3, v0
 v_lshlrev_b32 v2, 7, v2
 v_lshl_add_u32 v2, v16, 10, v2
 v_bfe_u32 v16, v0, 2, 1
 v_and_b32 v17, 2, v0
 v_or_b32 v16, v16, v17
 v_bfe_u32 v17, v0, 3, 1
 v_lshl_or_b32 v16, v17, 2, v16
 v_bfe_u32 v17, v0, 5, 1
 v_xor_b32 v16, v16, v17
 v_bfe_u32 v17, v0, 4, 1
 v_lshlrev_b32 v17, 1, v17
 v_xor_b32 v16, v16, v17
 v_lshl_add_u32 v4, v16, 4, v2
 v_xor_b32 v5, 64, v4
 v_lshrrev_b32 v16, 4, v0
 v_lshlrev_b32 v16, 9, v16
 v_sub_u32 v10, 0, v16
 v_add_u32 v3, 126976, v3
 s_waitcnt vmcnt(16) lgkmcnt(0)
 s_barrier
 ds_read_b128 v[24:27], v4 offset:49152
 ds_read_b128 v[28:31], v5 offset:49152
 ds_read_b128 v[32:35], v4 offset:49664
 ds_read_b128 v[36:39], v5 offset:49664
 ds_read_b128 v[40:43], v4 offset:53248
 ds_read_b128 v[44:47], v5 offset:53248
L_item:
 ds_read_b128 v[240:243], v4 offset:53760
 v_mov_b32 v252, v251
 v_xor_b32 v253, s67, v251
 v_xor_b32 v254, s100, v251
 v_xor_b32 v255, s100, v253
 s_add_u32 m0, s50, 32768
 s_waitcnt lgkmcnt(3)
 v_mfma_f32_16x16x32_bf16 v[144:147], v[24:27], v[112:115], 0
 s_add_u32 s46, s90, 40960
 s_and_b32 s46, s46, 0x1ffff
 s_add_u32 s46, s46, s91
 buffer_load_dwordx4 v252, s[96:99], s46 offen offset:0 nt lds
 v_mfma_f32_16x16x32_bf16 v[152:155], v[24:27], v[116:119], 0
 ds_read_b128 v[244:247], v5 offset:53760
 v_mfma_f32_16x16x32_bf16 v[144:147], v[28:31], v[120:123], v[144:147]
 buffer_load_dwordx4 v253, s[96:99], s46 offen offset:1024 nt lds
 v_mfma_f32_16x16x32_bf16 v[152:155], v[28:31], v[124:127], v[152:155]
 ds_read_b128 v[24:27], v4 offset:57344
 v_mfma_f32_16x16x32_bf16 v[144:147], v[32:35], v[128:131], v[144:147]
 buffer_load_dwordx4 v254, s[96:99], s46 offen offset:2048 nt lds
 v_mfma_f32_16x16x32_bf16 v[152:155], v[32:35], v[132:135], v[152:155]
 ds_read_b128 v[28:31], v5 offset:57344
 v_mfma_f32_16x16x32_bf16 v[144:147], v[36:39], v[136:139], v[144:147]
 buffer_load_dwordx4 v255, s[96:99], s46 offen offset:3072 nt lds
 v_mfma_f32_16x16x32_bf16 v[152:155], v[36:39], v[140:143], v[152:155]
 ds_read_b128 v[32:35], v4 offset:57856
 s_waitcnt lgkmcnt(3)
 v_mfma_f32_16x16x32_bf16 v[148:151], v[40:43], v[112:115], 0
 v_mfma_f32_16x16x32_bf16 v[156:159], v[40:43], v[116:119], 0
 ds_read_b128 v[36:39], v5 offset:57856
 v_mfma_f32_16x16x32_bf16 v[148:151], v[44:47], v[120:123], v[148:151]
 v_mfma_f32_16x16x32_bf16 v[156:159], v[44:47], v[124:127], v[156:159]
 ds_read_b128 v[40:43], v4 offset:61440
 v_mfma_f32_16x16x32_bf16 v[148:151], v[240:243], v[128:131], v[148:151]
 v_mfma_f32_16x16x32_bf16 v[156:159], v[240:243], v[132:135], v[156:159]
 ds_read_b128 v[44:47], v5 offset:61440
 v_mfma_f32_16x16x32_bf16 v[148:151], v[244:247], v[136:139], v[148:151]
 v_mfma_f32_16x16x32_bf16 v[156:159], v[244:247], v[140:143], v[156:159]
 ds_read_b128 v[240:243], v4 offset:61952
 s_waitcnt lgkmcnt(3)
 v_mfma_f32_16x16x32_bf16 v[80:83], v[24:27], v[112:115], 0
 v_mfma_f32_16x16x32_bf16 v[88:91], v[24:27], v[116:119], 0
 ds_read_b128 v[244:247], v5 offset:61952
 v_mfma_f32_16x16x32_bf16 v[80:83], v[28:31], v[120:123], v[80:83]
 v_mfma_f32_16x16x32_bf16 v[88:91], v[28:31], v[124:127], v[88:91]
 v_max3_f32 v20, v144, v145, v146
 v_max3_f32 v11, v152, v153, v154
 v_mfma_f32_16x16x32_bf16 v[80:83], v[32:35], v[128:131], v[80:83]
 v_max3_f32 v20, v20, v147, v148
 v_max3_f32 v11, v11, v155, v156
 v_mfma_f32_16x16x32_bf16 v[88:91], v[32:35], v[132:135], v[88:91]
 v_max3_f32 v20, v20, v149, v150
 v_max3_f32 v11, v11, v157, v158
 v_mfma_f32_16x16x32_bf16 v[80:83], v[36:39], v[136:139], v[80:83]
 v_max_f32 v20, v20, v151
 v_max_f32 v11, v11, v159
 v_mfma_f32_16x16x32_bf16 v[88:91], v[36:39], v[140:143], v[88:91]
 s_waitcnt vmcnt(16) lgkmcnt(0)
 s_barrier
 v_add_u32 v4, 65536, v4
 ds_read_b128 v[24:27], v4 offset:0
 v_add_u32 v5, 65536, v5
 ds_read_b128 v[28:31], v5 offset:0
 ds_read_b128 v[32:35], v4 offset:512
 s_add_u32 m0, s50, 49152
 s_add_u32 s46, s90, 49152
 s_and_b32 s46, s46, 0x1ffff
 s_add_u32 s46, s46, s91
 v_mfma_f32_16x16x32_bf16 v[84:87], v[40:43], v[112:115], 0
 buffer_load_dwordx4 v252, s[96:99], s46 offen offset:0 nt lds
 v_permlane16_swap_b32 v20, v11
 v_max_f32 v20, v20, v11
 v_mov_b32 v21, v20
 v_mfma_f32_16x16x32_bf16 v[92:95], v[40:43], v[116:119], 0
 ds_read_b128 v[36:39], v5 offset:512
 buffer_load_dwordx4 v253, s[96:99], s46 offen offset:1024 nt lds
 v_mfma_f32_16x16x32_bf16 v[84:87], v[44:47], v[120:123], v[84:87]
 v_permlane32_swap_b32 v20, v21
 v_max_f32 v20, v20, v21
 v_mov_b32 v11, v20
 s_nop 1
 v_permlane16_swap_b32 v20, v11
 v_mfma_f32_16x16x32_bf16 v[92:95], v[44:47], v[124:127], v[92:95]
 ds_read_b128 v[40:43], v4 offset:4096
 buffer_load_dwordx4 v254, s[96:99], s46 offen offset:2048 nt lds
 v_mfma_f32_16x16x32_bf16 v[84:87], v[240:243], v[128:131], v[84:87]
 v_sub_f32 v48, 0, v20
 v_sub_f32 v49, 0, v20
 v_sub_f32 v50, 0, v20
 v_sub_f32 v51, 0, v20
 v_mfma_f32_16x16x32_bf16 v[92:95], v[240:243], v[132:135], v[92:95]
 ds_read_b128 v[44:47], v5 offset:4096
 buffer_load_dwordx4 v255, s[96:99], s46 offen offset:3072 nt lds
 v_mfma_f32_16x16x32_bf16 v[84:87], v[244:247], v[136:139], v[84:87]
 v_sub_f32 v52, 0, v11
 v_sub_f32 v53, 0, v11
 v_sub_f32 v54, 0, v11
 v_sub_f32 v55, 0, v11
 v_mfma_f32_16x16x32_bf16 v[92:95], v[244:247], v[140:143], v[92:95]
 ds_read_b128 v[240:243], v4 offset:4608
 v_sub_f32 v144, v144, v20
 v_sub_f32 v145, v145, v20
 v_sub_f32 v146, v146, v20
 s_waitcnt lgkmcnt(3)
 v_mfma_f32_16x16x32_bf16 v[64:67], v[24:27], v[112:115], v[48:51]
 v_sub_f32 v147, v147, v20
 v_exp_f32 v16, v144
 v_sub_f32 v148, v148, v20
 v_exp_f32 v17, v145
 v_mfma_f32_16x16x32_bf16 v[72:75], v[24:27], v[116:119], v[52:55]
 ds_read_b128 v[244:247], v5 offset:4608
 v_sub_f32 v149, v149, v20
 v_exp_f32 v18, v146
 v_sub_f32 v150, v150, v20
 v_mfma_f32_16x16x32_bf16 v[64:67], v[28:31], v[120:123], v[64:67]
 v_add_f32 v15, v16, v17
 v_exp_f32 v19, v147
 v_sub_f32 v151, v151, v20
 v_cvt_pk_bf16_f32 v96, v16, v17
 v_mfma_f32_16x16x32_bf16 v[72:75], v[28:31], v[124:127], v[72:75]
 v_add_u32 v8, 73728, v8
 ds_read_b64_tr_b16 v[24:25], v8 offset:0
 v_exp_f32 v16, v148
 v_sub_f32 v152, v152, v11
 v_add_f32 v15, v15, v18
 v_mfma_f32_16x16x32_bf16 v[64:67], v[32:35], v[128:131], v[64:67]
 ds_read_b64_tr_b16 v[26:27], v8 offset:4096
 v_exp_f32 v17, v149
 v_sub_f32 v153, v153, v11
 v_cvt_pk_bf16_f32 v97, v18, v19
 v_add_f32 v15, v15, v19
 v_mfma_f32_16x16x32_bf16 v[72:75], v[32:35], v[132:135], v[72:75]
 v_add_u32 v9, 73728, v9
 ds_read_b64_tr_b16 v[28:29], v9 offset:0
 v_exp_f32 v18, v150
 v_sub_f32 v154, v154, v11
 v_add_f32 v15, v15, v16
 v_mfma_f32_16x16x32_bf16 v[64:67], v[36:39], v[136:139], v[64:67]
 ds_read_b64_tr_b16 v[30:31], v9 offset:4096
 v_exp_f32 v19, v151
 v_sub_f32 v155, v155, v11
 v_cvt_pk_bf16_f32 v98, v16, v17
 v_add_f32 v15, v15, v17
 v_mfma_f32_16x16x32_bf16 v[72:75], v[36:39], v[140:143], v[72:75]
 v_add_u32 v12, 73728, v12
 ds_read_b64_tr_b16 v[32:33], v12 offset:0
 v_exp_f32 v16, v152
 v_sub_f32 v156, v156, v11
 v_add_f32 v15, v15, v18
 s_waitcnt lgkmcnt(5)
 v_mfma_f32_16x16x32_bf16 v[68:71], v[40:43], v[112:115], v[48:51]
 ds_read_b64_tr_b16 v[34:35], v12 offset:4096
 v_exp_f32 v17, v153
 v_sub_f32 v157, v157, v11
 v_cvt_pk_bf16_f32 v99, v18, v19
 v_add_f32 v15, v15, v19
 v_mfma_f32_16x16x32_bf16 v[76:79], v[40:43], v[116:119], v[52:55]
 v_add_u32 v13, 73728, v13
 ds_read_b64_tr_b16 v[36:37], v13 offset:0
 v_exp_f32 v18, v154
 v_sub_f32 v158, v158, v11
 v_add_f32 v57, v16, v17
 v_mfma_f32_16x16x32_bf16 v[68:71], v[44:47], v[120:123], v[68:71]
 ds_read_b64_tr_b16 v[38:39], v13 offset:4096
 v_exp_f32 v19, v155
 v_sub_f32 v159, v159, v11
 v_cvt_pk_bf16_f32 v100, v16, v17
 v_mfma_f32_16x16x32_bf16 v[76:79], v[44:47], v[124:127], v[76:79]
 ds_read_b64_tr_b16 v[40:41], v8 offset:512
 v_exp_f32 v16, v156
 v_add_f32 v57, v57, v18
 v_exp_f32 v17, v157
 v_mfma_f32_16x16x32_bf16 v[68:71], v[240:243], v[128:131], v[68:71]
 ds_read_b64_tr_b16 v[42:43], v8 offset:4608
 v_cvt_pk_bf16_f32 v101, v18, v19
 v_add_f32 v57, v57, v19
 v_exp_f32 v18, v158
 v_add_f32 v57, v57, v16
 v_mfma_f32_16x16x32_bf16 v[76:79], v[240:243], v[132:135], v[76:79]
 ds_read_b64_tr_b16 v[44:45], v9 offset:512
 v_exp_f32 v19, v159
 v_cvt_pk_bf16_f32 v102, v16, v17
 v_add_f32 v57, v57, v17
 v_mfma_f32_16x16x32_bf16 v[68:71], v[244:247], v[136:139], v[68:71]
 ds_read_b64_tr_b16 v[46:47], v9 offset:4608
 v_add_f32 v57, v57, v18
 v_cvt_pk_bf16_f32 v103, v18, v19
 v_add_f32 v57, v57, v19
 v_mov_b32 v14, v15
 v_mov_b32 v56, v57
 v_mfma_f32_16x16x32_bf16 v[76:79], v[244:247], v[140:143], v[76:79]
 ds_read_b64_tr_b16 v[240:241], v12 offset:512
 v_sub_f32 v80, v80, v20
 v_sub_f32 v81, v81, v20
 v_sub_f32 v82, v82, v20
 v_sub_f32 v83, v83, v20
 s_waitcnt lgkmcnt(5)
 v_mfma_f32_16x16x32_bf16 v[144:147], v[24:27], v[96:99], 0
 ds_read_b64_tr_b16 v[242:243], v12 offset:4608
 v_exp_f32 v16, v80
 v_sub_f32 v84, v84, v20
 v_exp_f32 v17, v81
 v_mfma_f32_16x16x32_bf16 v[148:151], v[24:27], v[100:103], 0
 ds_read_b64_tr_b16 v[244:245], v13 offset:512
 v_sub_f32 v85, v85, v20
 v_exp_f32 v18, v82
 v_sub_f32 v86, v86, v20
 v_mfma_f32_16x16x32_bf16 v[152:155], v[28:31], v[96:99], 0
 ds_read_b64_tr_b16 v[246:247], v13 offset:4608
 v_add_f32 v15, v16, v17
 v_exp_f32 v19, v83
 v_sub_f32 v87, v87, v20
 v_cvt_pk_bf16_f32 v104, v16, v17
 v_mfma_f32_16x16x32_bf16 v[156:159], v[28:31], v[100:103], 0
 v_exp_f32 v16, v84
 v_sub_f32 v88, v88, v11
 v_add_f32 v15, v15, v18
 v_mfma_f32_16x16x32_bf16 v[160:163], v[32:35], v[96:99], 0
 v_exp_f32 v17, v85
 v_sub_f32 v89, v89, v11
 v_cvt_pk_bf16_f32 v105, v18, v19
 v_add_f32 v15, v15, v19
 v_mfma_f32_16x16x32_bf16 v[164:167], v[32:35], v[100:103], 0
 v_exp_f32 v18, v86
 v_sub_f32 v90, v90, v11
 v_add_f32 v15, v15, v16
 v_mfma_f32_16x16x32_bf16 v[168:171], v[36:39], v[96:99], 0
 v_exp_f32 v19, v87
 v_sub_f32 v91, v91, v11
 v_cvt_pk_bf16_f32 v106, v16, v17
 v_add_f32 v15, v15, v17
 v_mfma_f32_16x16x32_bf16 v[172:175], v[36:39], v[100:103], 0
 s_waitcnt vmcnt(16) lgkmcnt(0)
 s_barrier
 ds_read_b128 v[24:27], v4 offset:16384
 ds_read_b128 v[28:31], v5 offset:16384
 ds_read_b128 v[32:35], v4 offset:16896
 s_add_u32 m0, s50, 65536
 s_add_u32 s46, s90, 90112
 s_and_b32 s46, s46, 0x1ffff
 s_add_u32 s46, s46, s91
 buffer_load_dwordx4 v252, s[96:99], s46 offen offset:0 nt lds
 v_mfma_f32_16x16x32_bf16 v[176:179], v[40:43], v[96:99], 0
 v_exp_f32 v16, v88
 v_sub_f32 v92, v92, v11
 v_add_f32 v15, v15, v18
 v_exp_f32 v17, v89
 v_sub_f32 v93, v93, v11
 v_cvt_pk_bf16_f32 v107, v18, v19
 v_add_f32 v15, v15, v19
 v_mfma_f32_16x16x32_bf16 v[180:183], v[40:43], v[100:103], 0
 ds_read_b128 v[36:39], v5 offset:16896
 buffer_load_dwordx4 v253, s[96:99], s46 offen offset:1024 nt lds
 v_exp_f32 v18, v90
 v_mfma_f32_16x16x32_bf16 v[184:187], v[44:47], v[96:99], 0
 v_sub_f32 v94, v94, v11
 v_add_f32 v57, v16, v17
 v_exp_f32 v19, v91
 v_sub_f32 v95, v95, v11
 v_cvt_pk_bf16_f32 v108, v16, v17
 v_mfma_f32_16x16x32_bf16 v[188:191], v[44:47], v[100:103], 0
 ds_read_b128 v[40:43], v4 offset:20480
 buffer_load_dwordx4 v254, s[96:99], s46 offen offset:2048 nt lds
 v_exp_f32 v16, v92
 v_mfma_f32_16x16x32_bf16 v[192:195], v[240:243], v[96:99], 0
 v_add_f32 v57, v57, v18
 v_exp_f32 v17, v93
 v_cvt_pk_bf16_f32 v109, v18, v19
 v_add_f32 v57, v57, v19
 v_exp_f32 v18, v94
 v_add_f32 v57, v57, v16
 v_mfma_f32_16x16x32_bf16 v[196:199], v[240:243], v[100:103], 0
 ds_read_b128 v[44:47], v5 offset:20480
 buffer_load_dwordx4 v255, s[96:99], s46 offen offset:3072 nt lds
 v_exp_f32 v19, v95
 v_mfma_f32_16x16x32_bf16 v[200:203], v[244:247], v[96:99], 0
 v_cvt_pk_bf16_f32 v110, v16, v17
 v_add_f32 v57, v57, v17
 v_add_f32 v57, v57, v18
 v_cvt_pk_bf16_f32 v111, v18, v19
 v_add_f32 v57, v57, v19
 v_max_f32 v58, v15, v57
 v_cmp_lt_f32 vcc, s49, v58
 v_mfma_f32_16x16x32_bf16 v[204:207], v[244:247], v[100:103], 0
 s_cbranch_vccnz L_stub_1_0
L_back_1_0:
 v_add_f32 v14, v14, v15
 v_add_f32 v56, v56, v57
 ds_read_b128 v[240:243], v4 offset:20992
 s_waitcnt lgkmcnt(3)
 v_mfma_f32_16x16x32_bf16 v[80:83], v[24:27], v[112:115], v[48:51]
 v_exp_f32 v16, v64
 v_exp_f32 v17, v65
 v_mfma_f32_16x16x32_bf16 v[88:91], v[24:27], v[116:119], v[52:55]
 ds_read_b128 v[244:247], v5 offset:20992
 v_exp_f32 v18, v66
 v_mfma_f32_16x16x32_bf16 v[80:83], v[28:31], v[120:123], v[80:83]
 v_add_f32 v15, v16, v17
 v_exp_f32 v19, v67
 v_cvt_pk_bf16_f32 v96, v16, v17
 v_mfma_f32_16x16x32_bf16 v[88:91], v[28:31], v[124:127], v[88:91]
 ds_read_b64_tr_b16 v[24:25], v8 offset:16384
 v_exp_f32 v16, v68
 v_mfma_f32_16x16x32_bf16 v[80:83], v[32:35], v[128:131], v[80:83]
 ds_read_b64_tr_b16 v[26:27], v8 offset:20480
 v_add_f32 v15, v15, v18
 v_exp_f32 v17, v69
 v_mfma_f32_16x16x32_bf16 v[88:91], v[32:35], v[132:135], v[88:91]
 ds_read_b64_tr_b16 v[28:29], v9 offset:16384
 v_cvt_pk_bf16_f32 v97, v18, v19
 v_add_f32 v15, v15, v19
 v_mfma_f32_16x16x32_bf16 v[80:83], v[36:39], v[136:139], v[80:83]
 ds_read_b64_tr_b16 v[30:31], v9 offset:20480
 v_exp_f32 v18, v70
 v_mfma_f32_16x16x32_bf16 v[88:91], v[36:39], v[140:143], v[88:91]
 ds_read_b64_tr_b16 v[32:33], v12 offset:16384
 v_add_f32 v15, v15, v16
 s_waitcnt lgkmcnt(5)
 v_mfma_f32_16x16x32_bf16 v[84:87], v[40:43], v[112:115], v[48:51]
 ds_read_b64_tr_b16 v[34:35], v12 offset:20480
 v_exp_f32 v19, v71
 v_mfma_f32_16x16x32_bf16 v[92:95], v[40:43], v[116:119], v[52:55]
 ds_read_b64_tr_b16 v[36:37], v13 offset:16384
 v_cvt_pk_bf16_f32 v98, v16, v17
 v_add_f32 v15, v15, v17
 v_mfma_f32_16x16x32_bf16 v[84:87], v[44:47], v[120:123], v[84:87]
 ds_read_b64_tr_b16 v[38:39], v13 offset:20480
 v_exp_f32 v16, v72
 v_mfma_f32_16x16x32_bf16 v[92:95], v[44:47], v[124:127], v[92:95]
 ds_read_b64_tr_b16 v[40:41], v8 offset:16896
 v_add_f32 v15, v15, v18
 v_exp_f32 v17, v73
 v_mfma_f32_16x16x32_bf16 v[84:87], v[240:243], v[128:131], v[84:87]
 ds_read_b64_tr_b16 v[42:43], v8 offset:20992
 v_cvt_pk_bf16_f32 v99, v18, v19
 v_add_f32 v15, v15, v19
 v_mfma_f32_16x16x32_bf16 v[92:95], v[240:243], v[132:135], v[92:95]
 ds_read_b64_tr_b16 v[44:45], v9 offset:16896
 v_exp_f32 v18, v74
 v_mfma_f32_16x16x32_bf16 v[84:87], v[244:247], v[136:139], v[84:87]
 ds_read_b64_tr_b16 v[46:47], v9 offset:20992
 v_add_f32 v57, v16, v17
 v_exp_f32 v19, v75
 v_mfma_f32_16x16x32_bf16 v[92:95], v[244:247], v[140:143], v[92:95]
 ds_read_b64_tr_b16 v[240:241], v12 offset:16896
 v_cvt_pk_bf16_f32 v100, v16, v17
 s_waitcnt lgkmcnt(5)
 v_mfma_f32_16x16x32_bf16 v[144:147], v[24:27], v[104:107], v[144:147]
 ds_read_b64_tr_b16 v[242:243], v12 offset:20992
 v_exp_f32 v16, v76
 v_mfma_f32_16x16x32_bf16 v[148:151], v[24:27], v[108:111], v[148:151]
 ds_read_b64_tr_b16 v[244:245], v13 offset:16896
 v_add_f32 v57, v57, v18
 v_mfma_f32_16x16x32_bf16 v[152:155], v[28:31], v[104:107], v[152:155]
 ds_read_b64_tr_b16 v[246:247], v13 offset:20992
 v_exp_f32 v17, v77
 v_cvt_pk_bf16_f32 v101, v18, v19
 v_mfma_f32_16x16x32_bf16 v[156:159], v[28:31], v[108:111], v[156:159]
 v_add_f32 v57, v57, v19
 v_exp_f32 v18, v78
 v_mfma_f32_16x16x32_bf16 v[160:163], v[32:35], v[104:107], v[160:163]
 v_add_f32 v57, v57, v16
 v_exp_f32 v19, v79
 v_mfma_f32_16x16x32_bf16 v[164:167], v[32:35], v[108:111], v[164:167]
 v_cvt_pk_bf16_f32 v102, v16, v17
 v_add_f32 v57, v57, v17
 v_mfma_f32_16x16x32_bf16 v[168:171], v[36:39], v[104:107], v[168:171]
 v_add_f32 v57, v57, v18
 v_cvt_pk_bf16_f32 v103, v18, v19
 v_add_f32 v57, v57, v19
 v_mfma_f32_16x16x32_bf16 v[172:175], v[36:39], v[108:111], v[172:175]
 s_waitcnt vmcnt(16) lgkmcnt(0)
 s_barrier
 v_add_u32 v4, 4294901760, v4
 ds_read_b128 v[24:27], v4 offset:0
 v_add_u32 v5, 4294901760, v5
 ds_read_b128 v[28:31], v5 offset:0
 ds_read_b128 v[32:35], v4 offset:512
 s_add_u32 m0, s50, 81920
 v_mfma_f32_16x16x32_bf16 v[176:179], v[40:43], v[104:107], v[176:179]
 s_add_u32 s46, s90, 98304
 s_and_b32 s46, s46, 0x1ffff
 s_add_u32 s46, s46, s91
 buffer_load_dwordx4 v252, s[96:99], s46 offen offset:0 nt lds
 v_mfma_f32_16x16x32_bf16 v[180:183], v[40:43], v[108:111], v[180:183]
 ds_read_b128 v[36:39], v5 offset:512
 v_mfma_f32_16x16x32_bf16 v[184:187], v[44:47], v[104:107], v[184:187]
 buffer_load_dwordx4 v253, s[96:99], s46 offen offset:1024 nt lds
 v_mfma_f32_16x16x32_bf16 v[188:191], v[44:47], v[108:111], v[188:191]
 ds_read_b128 v[40:43], v4 offset:4096
 v_mfma_f32_16x16x32_bf16 v[192:195], v[240:243], v[104:107], v[192:195]
 buffer_load_dwordx4 v254, s[96:99], s46 offen offset:2048 nt lds
 v_max_f32 v58, v15, v57
 v_mfma_f32_16x16x32_bf16 v[196:199], v[240:243], v[108:111], v[196:199]
 ds_read_b128 v[44:47], v5 offset:4096
 v_mfma_f32_16x16x32_bf16 v[200:203], v[244:247], v[104:107], v[200:203]
 buffer_load_dwordx4 v255, s[96:99], s46 offen offset:3072 nt lds
 v_cmp_lt_f32 vcc, s49, v58
 v_mfma_f32_16x16x32_bf16 v[204:207], v[244:247], v[108:111], v[204:207]
 s_cbranch_vccnz L_stub_2_1
L_back_2_1:
 v_add_f32 v14, v14, v15
 v_add_f32 v56, v56, v57
 ds_read_b128 v[240:243], v4 offset:4608
 s_waitcnt lgkmcnt(3)
 v_mfma_f32_16x16x32_bf16 v[64:67], v[24:27], v[112:115], v[48:51]
 v_exp_f32 v16, v80
 v_exp_f32 v17, v81
 v_mfma_f32_16x16x32_bf16 v[72:75], v[24:27], v[116:119], v[52:55]
 ds_read_b128 v[244:247], v5 offset:4608
 v_exp_f32 v18, v82
 v_mfma_f32_16x16x32_bf16 v[64:67], v[28:31], v[120:123], v[64:67]
 v_add_f32 v15, v16, v17
 v_exp_f32 v19, v83
 v_cvt_pk_bf16_f32 v104, v16, v17
 v_mfma_f32_16x16x32_bf16 v[72:75], v[28:31], v[124:127], v[72:75]
 v_add_u32 v8, 4294901760, v8
 ds_read_b64_tr_b16 v[24:25], v8 offset:0
 v_exp_f32 v16, v84
 v_mfma_f32_16x16x32_bf16 v[64:67], v[32:35], v[128:131], v[64:67]
 ds_read_b64_tr_b16 v[26:27], v8 offset:4096
 v_add_f32 v15, v15, v18
 v_exp_f32 v17, v85
 v_mfma_f32_16x16x32_bf16 v[72:75], v[32:35], v[132:135], v[72:75]
 v_add_u32 v9, 4294901760, v9
 ds_read_b64_tr_b16 v[28:29], v9 offset:0
 v_cvt_pk_bf16_f32 v105, v18, v19
 v_add_f32 v15, v15, v19
 v_mfma_f32_16x16x32_bf16 v[64:67], v[36:39], v[136:139], v[64:67]
 ds_read_b64_tr_b16 v[30:31], v9 offset:4096
 v_exp_f32 v18, v86
 v_mfma_f32_16x16x32_bf16 v[72:75], v[36:39], v[140:143], v[72:75]
 v_add_u32 v12, 4294901760, v12
 ds_read_b64_tr_b16 v[32:33], v12 offset:0
 v_add_f32 v15, v15, v16
 s_waitcnt lgkmcnt(5)
 v_mfma_f32_16x16x32_bf16 v[68:71], v[40:43], v[112:115], v[48:51]
 ds_read_b64_tr_b16 v[34:35], v12 offset:4096
 v_exp_f32 v19, v87
 v_mfma_f32_16x16x32_bf16 v[76:79], v[40:43], v[116:119], v[52:55]
 v_add_u32 v13, 4294901760, v13
 ds_read_b64_tr_b16 v[36:37], v13 offset:0
 v_cvt_pk_bf16_f32 v106, v16, v17
 v_add_f32 v15, v15, v17
 v_mfma_f32_16x16x32_bf16 v[68:71], v[44:47], v[120:123], v[68:71]
 ds_read_b64_tr_b16 v[38:39], v13 offset:4096
 v_exp_f32 v16, v88
 v_mfma_f32_16x16x32_bf16 v[76:79], v[44:47], v[124:127], v[76:79]
 ds_read_b64_tr_b16 v[40:41], v8 offset:512
 v_add_f32 v15, v15, v18
 v_exp_f32 v17, v89
 v_mfma_f32_16x16x32_bf16 v[68:71], v[240:243], v[128:131], v[68:71]
 ds_read_b64_tr_b16 v[42:43], v8 offset:4608
 v_cvt_pk_bf16_f32 v107, v18, v19
 v_add_f32 v15, v15, v19
 v_mfma_f32_16x16x32_bf16 v[76:79], v[240:243], v[132:135], v[76:79]
 ds_read_b64_tr_b16 v[44:45], v9 offset:512
 v_exp_f32 v18, v90
 v_mfma_f32_16x16x32_bf16 v[68:71], v[244:247], v[136:139], v[68:71]
 ds_read_b64_tr_b16 v[46:47], v9 offset:4608
 v_add_f32 v57, v16, v17
 v_exp_f32 v19, v91
 v_mfma_f32_16x16x32_bf16 v[76:79], v[244:247], v[140:143], v[76:79]
 ds_read_b64_tr_b16 v[240:241], v12 offset:512
 v_cvt_pk_bf16_f32 v108, v16, v17
 s_waitcnt lgkmcnt(5)
 v_mfma_f32_16x16x32_bf16 v[144:147], v[24:27], v[96:99], v[144:147]
 ds_read_b64_tr_b16 v[242:243], v12 offset:4608
 v_exp_f32 v16, v92
 v_mfma_f32_16x16x32_bf16 v[148:151], v[24:27], v[100:103], v[148:151]
 ds_read_b64_tr_b16 v[244:245], v13 offset:512
 v_add_f32 v57, v57, v18
 v_mfma_f32_16x16x32_bf16 v[152:155], v[28:31], v[96:99], v[152:155]
 ds_read_b64_tr_b16 v[246:247], v13 offset:4608
 v_exp_f32 v17, v93
 v_cvt_pk_bf16_f32 v109, v18, v19
 v_mfma_f32_16x16x32_bf16 v[156:159], v[28:31], v[100:103], v[156:159]
 v_add_f32 v57, v57, v19
 v_exp_f32 v18, v94
 v_mfma_f32_16x16x32_bf16 v[160:163], v[32:35], v[96:99], v[160:163]
 v_add_f32 v57, v57, v16
 v_exp_f32 v19, v95
 v_mfma_f32_16x16x32_bf16 v[164:167], v[32:35], v[100:103], v[164:167]
 v_cvt_pk_bf16_f32 v110, v16, v17
 v_add_f32 v57, v57, v17
 v_mfma_f32_16x16x32_bf16 v[168:171], v[36:39], v[96:99], v[168:171]
 v_add_f32 v57, v57, v18
 v_cvt_pk_bf16_f32 v111, v18, v19
 v_add_f32 v57, v57, v19
 v_mfma_f32_16x16x32_bf16 v[172:175], v[36:39], v[100:103], v[172:175]
 s_waitcnt vmcnt(16) lgkmcnt(0)
 s_barrier
 ds_read_b128 v[24:27], v4 offset:16384
 ds_read_b128 v[28:31], v5 offset:16384
 ds_read_b128 v[32:35], v4 offset:16896
 s_add_u32 m0, s50, 0
 v_mfma_f32_16x16x32_bf16 v[176:179], v[40:43], v[96:99], v[176:179]
 s_add_u32 s46, s90, 57344
 s_and_b32 s46, s46, 0x1ffff
 s_add_u32 s46, s46, s91
 buffer_load_dwordx4 v252, s[96:99], s46 offen offset:0 nt lds
 v_mfma_f32_16x16x32_bf16 v[180:183], v[40:43], v[100:103], v[180:183]
 ds_read_b128 v[36:39], v5 offset:16896
 v_mfma_f32_16x16x32_bf16 v[184:187], v[44:47], v[96:99], v[184:187]
 buffer_load_dwordx4 v253, s[96:99], s46 offen offset:1024 nt lds
 v_mfma_f32_16x16x32_bf16 v[188:191], v[44:47], v[100:103], v[188:191]
 ds_read_b128 v[40:43], v4 offset:20480
 v_mfma_f32_16x16x32_bf16 v[192:195], v[240:243], v[96:99], v[192:195]
 buffer_load_dwordx4 v254, s[96:99], s46 offen offset:2048 nt lds
 v_max_f32 v58, v15, v57
 v_mfma_f32_16x16x32_bf16 v[196:199], v[240:243], v[100:103], v[196:199]
 ds_read_b128 v[44:47], v5 offset:20480
 v_mfma_f32_16x16x32_bf16 v[200:203], v[244:247], v[96:99], v[200:203]
 buffer_load_dwordx4 v255, s[96:99], s46 offen offset:3072 nt lds
 v_cmp_lt_f32 vcc, s49, v58
 v_mfma_f32_16x16x32_bf16 v[204:207], v[244:247], v[100:103], v[204:207]
 s_cbranch_vccnz L_stub_3_2
L_back_3_2:
 v_add_f32 v14, v14, v15
 v_add_f32 v56, v56, v57
 ds_read_b128 v[240:243], v4 offset:20992
 s_waitcnt lgkmcnt(3)
 v_mfma_f32_16x16x32_bf16 v[80:83], v[24:27], v[112:115], v[48:51]
 v_exp_f32 v16, v64
 v_exp_f32 v17, v65
 v_mfma_f32_16x16x32_bf16 v[88:91], v[24:27], v[116:119], v[52:55]
 ds_read_b128 v[244:247], v5 offset:20992
 v_exp_f32 v18, v66
 v_mfma_f32_16x16x32_bf16 v[80:83], v[28:31], v[120:123], v[80:83]
 v_add_f32 v15, v16, v17
 v_exp_f32 v19, v67
 v_cvt_pk_bf16_f32 v96, v16, v17
 v_mfma_f32_16x16x32_bf16 v[88:91], v[28:31], v[124:127], v[88:91]
 ds_read_b64_tr_b16 v[24:25], v8 offset:16384
 v_exp_f32 v16, v68
 v_mfma_f32_16x16x32_bf16 v[80:83], v[32:35], v[128:131], v[80:83]
 ds_read_b64_tr_b16 v[26:27], v8 offset:20480
 v_add_f32 v15, v15, v18
 v_exp_f32 v17, v69
 v_mfma_f32_16x16x32_bf16 v[88:91], v[32:35], v[132:135], v[88:91]
 ds_read_b64_tr_b16 v[28:29], v9 offset:16384
 v_cvt_pk_bf16_f32 v97, v18, v19
 v_add_f32 v15, v15, v19
 v_mfma_f32_16x16x32_bf16 v[80:83], v[36:39], v[136:139], v[80:83]
 ds_read_b64_tr_b16 v[30:31], v9 offset:20480
 v_exp_f32 v18, v70
 v_mfma_f32_16x16x32_bf16 v[88:91], v[36:39], v[140:143], v[88:91]
 ds_read_b64_tr_b16 v[32:33], v12 offset:16384
 v_add_f32 v15, v15, v16
 s_waitcnt lgkmcnt(5)
 v_mfma_f32_16x16x32_bf16 v[84:87], v[40:43], v[112:115], v[48:51]
 ds_read_b64_tr_b16 v[34:35], v12 offset:20480
 v_exp_f32 v19, v71
 v_mfma_f32_16x16x32_bf16 v[92:95], v[40:43], v[116:119], v[52:55]
 ds_read_b64_tr_b16 v[36:37], v13 offset:16384
 v_cvt_pk_bf16_f32 v98, v16, v17
 v_add_f32 v15, v15, v17
 v_mfma_f32_16x16x32_bf16 v[84:87], v[44:47], v[120:123], v[84:87]
 ds_read_b64_tr_b16 v[38:39], v13 offset:20480
 v_exp_f32 v16, v72
 v_mfma_f32_16x16x32_bf16 v[92:95], v[44:47], v[124:127], v[92:95]
 ds_read_b64_tr_b16 v[40:41], v8 offset:16896
 v_add_f32 v15, v15, v18
 v_exp_f32 v17, v73
 v_mfma_f32_16x16x32_bf16 v[84:87], v[240:243], v[128:131], v[84:87]
 ds_read_b64_tr_b16 v[42:43], v8 offset:20992
 v_cvt_pk_bf16_f32 v99, v18, v19
 v_add_f32 v15, v15, v19
 v_mfma_f32_16x16x32_bf16 v[92:95], v[240:243], v[132:135], v[92:95]
 ds_read_b64_tr_b16 v[44:45], v9 offset:16896
 v_exp_f32 v18, v74
 v_mfma_f32_16x16x32_bf16 v[84:87], v[244:247], v[136:139], v[84:87]
 ds_read_b64_tr_b16 v[46:47], v9 offset:20992
 v_add_f32 v57, v16, v17
 v_exp_f32 v19, v75
 v_mfma_f32_16x16x32_bf16 v[92:95], v[244:247], v[140:143], v[92:95]
 ds_read_b64_tr_b16 v[240:241], v12 offset:16896
 v_cvt_pk_bf16_f32 v100, v16, v17
 s_waitcnt lgkmcnt(5)
 v_mfma_f32_16x16x32_bf16 v[144:147], v[24:27], v[104:107], v[144:147]
 ds_read_b64_tr_b16 v[242:243], v12 offset:20992
 v_exp_f32 v16, v76
 v_mfma_f32_16x16x32_bf16 v[148:151], v[24:27], v[108:111], v[148:151]
 ds_read_b64_tr_b16 v[244:245], v13 offset:16896
 v_add_f32 v57, v57, v18
 v_mfma_f32_16x16x32_bf16 v[152:155], v[28:31], v[104:107], v[152:155]
 ds_read_b64_tr_b16 v[246:247], v13 offset:20992
 v_exp_f32 v17, v77
 v_cvt_pk_bf16_f32 v101, v18, v19
 v_mfma_f32_16x16x32_bf16 v[156:159], v[28:31], v[108:111], v[156:159]
 v_add_f32 v57, v57, v19
 v_exp_f32 v18, v78
 v_mfma_f32_16x16x32_bf16 v[160:163], v[32:35], v[104:107], v[160:163]
 v_add_f32 v57, v57, v16
 v_exp_f32 v19, v79
 v_mfma_f32_16x16x32_bf16 v[164:167], v[32:35], v[108:111], v[164:167]
 v_cvt_pk_bf16_f32 v102, v16, v17
 v_add_f32 v57, v57, v17
 v_mfma_f32_16x16x32_bf16 v[168:171], v[36:39], v[104:107], v[168:171]
 v_add_f32 v57, v57, v18
 v_cvt_pk_bf16_f32 v103, v18, v19
 v_add_f32 v57, v57, v19
 v_mfma_f32_16x16x32_bf16 v[172:175], v[36:39], v[108:111], v[172:175]
 s_waitcnt vmcnt(16) lgkmcnt(0)
 s_barrier
 ds_read_b128 v[24:27], v4 offset:32768
 ds_read_b128 v[28:31], v5 offset:32768
 ds_read_b128 v[32:35], v4 offset:33280
 s_add_u32 m0, s50, 16384
 v_mfma_f32_16x16x32_bf16 v[176:179], v[40:43], v[104:107], v[176:179]
 s_add_u32 s46, s90, 65536
 s_and_b32 s46, s46, 0x1ffff
 s_add_u32 s46, s46, s91
 buffer_load_dwordx4 v252, s[96:99], s46 offen offset:0 nt lds
 v_mfma_f32_16x16x32_bf16 v[180:183], v[40:43], v[108:111], v[180:183]
 ds_read_b128 v[36:39], v5 offset:33280
 v_mfma_f32_16x16x32_bf16 v[184:187], v[44:47], v[104:107], v[184:187]
 buffer_load_dwordx4 v253, s[96:99], s46 offen offset:1024 nt lds
 v_mfma_f32_16x16x32_bf16 v[188:191], v[44:47], v[108:111], v[188:191]
 ds_read_b128 v[40:43], v4 offset:36864
 v_mfma_f32_16x16x32_bf16 v[192:195], v[240:243], v[104:107], v[192:195]
 buffer_load_dwordx4 v254, s[96:99], s46 offen offset:2048 nt lds
 v_max_f32 v58, v15, v57
 v_mfma_f32_16x16x32_bf16 v[196:199], v[240:243], v[108:111], v[196:199]
 ds_read_b128 v[44:47], v5 offset:36864
 v_mfma_f32_16x16x32_bf16 v[200:203], v[244:247], v[104:107], v[200:203]
 buffer_load_dwordx4 v255, s[96:99], s46 offen offset:3072 nt lds
 v_cmp_lt_f32 vcc, s49, v58
 v_mfma_f32_16x16x32_bf16 v[204:207], v[244:247], v[108:111], v[204:207]
 s_cbranch_vccnz L_stub_4_3
L_back_4_3:
 v_add_f32 v14, v14, v15
 v_add_f32 v56, v56, v57
 ds_read_b128 v[240:243], v4 offset:37376
 s_waitcnt lgkmcnt(3)
 v_mfma_f32_16x16x32_bf16 v[64:67], v[24:27], v[112:115], v[48:51]
 v_exp_f32 v16, v80
 v_exp_f32 v17, v81
 v_mfma_f32_16x16x32_bf16 v[72:75], v[24:27], v[116:119], v[52:55]
 ds_read_b128 v[244:247], v5 offset:37376
 v_exp_f32 v18, v82
 v_mfma_f32_16x16x32_bf16 v[64:67], v[28:31], v[120:123], v[64:67]
 v_add_f32 v15, v16, v17
 v_exp_f32 v19, v83
 v_cvt_pk_bf16_f32 v104, v16, v17
 v_mfma_f32_16x16x32_bf16 v[72:75], v[28:31], v[124:127], v[72:75]
 ds_read_b64_tr_b16 v[24:25], v8 offset:32768
 v_exp_f32 v16, v84
 v_mfma_f32_16x16x32_bf16 v[64:67], v[32:35], v[128:131], v[64:67]
 ds_read_b64_tr_b16 v[26:27], v8 offset:36864
 v_add_f32 v15, v15, v18
 v_exp_f32 v17, v85
 v_mfma_f32_16x16x32_bf16 v[72:75], v[32:35], v[132:135], v[72:75]
 ds_read_b64_tr_b16 v[28:29], v9 offset:32768
 v_cvt_pk_bf16_f32 v105, v18, v19
 v_add_f32 v15, v15, v19
 v_mfma_f32_16x16x32_bf16 v[64:67], v[36:39], v[136:139], v[64:67]
 ds_read_b64_tr_b16 v[30:31], v9 offset:36864
 v_exp_f32 v18, v86
 v_mfma_f32_16x16x32_bf16 v[72:75], v[36:39], v[140:143], v[72:75]
 ds_read_b64_tr_b16 v[32:33], v12 offset:32768
 v_add_f32 v15, v15, v16
 s_waitcnt lgkmcnt(5)
 v_mfma_f32_16x16x32_bf16 v[68:71], v[40:43], v[112:115], v[48:51]
 ds_read_b64_tr_b16 v[34:35], v12 offset:36864
 v_exp_f32 v19, v87
 v_mfma_f32_16x16x32_bf16 v[76:79], v[40:43], v[116:119], v[52:55]
 ds_read_b64_tr_b16 v[36:37], v13 offset:32768
 v_cvt_pk_bf16_f32 v106, v16, v17
 v_add_f32 v15, v15, v17
 v_mfma_f32_16x16x32_bf16 v[68:71], v[44:47], v[120:123], v[68:71]
 ds_read_b64_tr_b16 v[38:39], v13 offset:36864
 v_exp_f32 v16, v88
 v_mfma_f32_16x16x32_bf16 v[76:79], v[44:47], v[124:127], v[76:79]
 ds_read_b64_tr_b16 v[40:41], v8 offset:33280
 v_add_f32 v15, v15, v18
 v_exp_f32 v17, v89
 v_mfma_f32_16x16x32_bf16 v[68:71], v[240:243], v[128:131], v[68:71]
 ds_read_b64_tr_b16 v[42:43], v8 offset:37376
 v_cvt_pk_bf16_f32 v107, v18, v19
 v_add_f32 v15, v15, v19
 v_mfma_f32_16x16x32_bf16 v[76:79], v[240:243], v[132:135], v[76:79]
 ds_read_b64_tr_b16 v[44:45], v9 offset:33280
 v_exp_f32 v18, v90
 v_mfma_f32_16x16x32_bf16 v[68:71], v[244:247], v[136:139], v[68:71]
 ds_read_b64_tr_b16 v[46:47], v9 offset:37376
 v_add_f32 v57, v16, v17
 v_exp_f32 v19, v91
 v_mfma_f32_16x16x32_bf16 v[76:79], v[244:247], v[140:143], v[76:79]
 ds_read_b64_tr_b16 v[240:241], v12 offset:33280
 v_cvt_pk_bf16_f32 v108, v16, v17
 s_waitcnt lgkmcnt(5)
 v_mfma_f32_16x16x32_bf16 v[144:147], v[24:27], v[96:99], v[144:147]
 ds_read_b64_tr_b16 v[242:243], v12 offset:37376
 v_exp_f32 v16, v92
 v_mfma_f32_16x16x32_bf16 v[148:151], v[24:27], v[100:103], v[148:151]
 ds_read_b64_tr_b16 v[244:245], v13 offset:33280
 v_add_f32 v57, v57, v18
 v_mfma_f32_16x16x32_bf16 v[152:155], v[28:31], v[96:99], v[152:155]
 ds_read_b64_tr_b16 v[246:247], v13 offset:37376
 v_exp_f32 v17, v93
 v_cvt_pk_bf16_f32 v109, v18, v19
 v_mfma_f32_16x16x32_bf16 v[156:159], v[28:31], v[100:103], v[156:159]
 v_add_f32 v57, v57, v19
 v_exp_f32 v18, v94
 v_mfma_f32_16x16x32_bf16 v[160:163], v[32:35], v[96:99], v[160:163]
 v_add_f32 v57, v57, v16
 v_exp_f32 v19, v95
 v_mfma_f32_16x16x32_bf16 v[164:167], v[32:35], v[100:103], v[164:167]
 v_cvt_pk_bf16_f32 v110, v16, v17
 v_add_f32 v57, v57, v17
 v_mfma_f32_16x16x32_bf16 v[168:171], v[36:39], v[96:99], v[168:171]
 v_add_f32 v57, v57, v18
 v_cvt_pk_bf16_f32 v111, v18, v19
 v_add_f32 v57, v57, v19
 v_mfma_f32_16x16x32_bf16 v[172:175], v[36:39], v[100:103], v[172:175]
 s_waitcnt vmcnt(16) lgkmcnt(0)
 s_barrier
 ds_read_b128 v[24:27], v4 offset:49152
 ds_read_b128 v[28:31], v5 offset:49152
 ds_read_b128 v[32:35], v4 offset:49664
 s_add_u32 m0, s50, 32768
 v_mfma_f32_16x16x32_bf16 v[176:179], v[40:43], v[96:99], v[176:179]
 s_add_u32 s46, s90, 73728
 s_and_b32 s46, s46, 0x1ffff
 s_add_u32 s46, s46, s91
 buffer_load_dwordx4 v252, s[96:99], s46 offen offset:0 nt lds
 v_mfma_f32_16x16x32_bf16 v[180:183], v[40:43], v[100:103], v[180:183]
 ds_read_b128 v[36:39], v5 offset:49664
 v_mfma_f32_16x16x32_bf16 v[184:187], v[44:47], v[96:99], v[184:187]
 buffer_load_dwordx4 v253, s[96:99], s46 offen offset:1024 nt lds
 v_mfma_f32_16x16x32_bf16 v[188:191], v[44:47], v[100:103], v[188:191]
 ds_read_b128 v[40:43], v4 offset:53248
 v_mfma_f32_16x16x32_bf16 v[192:195], v[240:243], v[96:99], v[192:195]
 buffer_load_dwordx4 v254, s[96:99], s46 offen offset:2048 nt lds
 v_max_f32 v58, v15, v57
 v_mfma_f32_16x16x32_bf16 v[196:199], v[240:243], v[100:103], v[196:199]
 ds_read_b128 v[44:47], v5 offset:53248
 v_mfma_f32_16x16x32_bf16 v[200:203], v[244:247], v[96:99], v[200:203]
 buffer_load_dwordx4 v255, s[96:99], s46 offen offset:3072 nt lds
 v_cmp_lt_f32 vcc, s49, v58
 v_mfma_f32_16x16x32_bf16 v[204:207], v[244:247], v[100:103], v[204:207]
 s_cbranch_vccnz L_stub_5_4
L_back_5_4:
 v_add_f32 v14, v14, v15
 v_add_f32 v56, v56, v57
 ds_read_b128 v[240:243], v4 offset:53760
 s_waitcnt lgkmcnt(3)
 v_mfma_f32_16x16x32_bf16 v[80:83], v[24:27], v[112:115], v[48:51]
 v_exp_f32 v16, v64
 v_exp_f32 v17, v65
 v_mfma_f32_16x16x32_bf16 v[88:91], v[24:27], v[116:119], v[52:55]
 ds_read_b128 v[244:247], v5 offset:53760
 v_exp_f32 v18, v66
 v_mfma_f32_16x16x32_bf16 v[80:83], v[28:31], v[120:123], v[80:83]
 v_add_f32 v15, v16, v17
 v_exp_f32 v19, v67
 v_cvt_pk_bf16_f32 v96, v16, v17
 v_mfma_f32_16x16x32_bf16 v[88:91], v[28:31], v[124:127], v[88:91]
 ds_read_b64_tr_b16 v[24:25], v8 offset:49152
 v_exp_f32 v16, v68
 v_mfma_f32_16x16x32_bf16 v[80:83], v[32:35], v[128:131], v[80:83]
 ds_read_b64_tr_b16 v[26:27], v8 offset:53248
 v_add_f32 v15, v15, v18
 v_exp_f32 v17, v69
 v_mfma_f32_16x16x32_bf16 v[88:91], v[32:35], v[132:135], v[88:91]
 ds_read_b64_tr_b16 v[28:29], v9 offset:49152
 v_cvt_pk_bf16_f32 v97, v18, v19
 v_add_f32 v15, v15, v19
 v_mfma_f32_16x16x32_bf16 v[80:83], v[36:39], v[136:139], v[80:83]
 ds_read_b64_tr_b16 v[30:31], v9 offset:53248
 v_exp_f32 v18, v70
 v_mfma_f32_16x16x32_bf16 v[88:91], v[36:39], v[140:143], v[88:91]
 ds_read_b64_tr_b16 v[32:33], v12 offset:49152
 v_add_f32 v15, v15, v16
 s_waitcnt lgkmcnt(5)
 v_mfma_f32_16x16x32_bf16 v[84:87], v[40:43], v[112:115], v[48:51]
 ds_read_b64_tr_b16 v[34:35], v12 offset:53248
 v_exp_f32 v19, v71
 v_mfma_f32_16x16x32_bf16 v[92:95], v[40:43], v[116:119], v[52:55]
 ds_read_b64_tr_b16 v[36:37], v13 offset:49152
 v_cvt_pk_bf16_f32 v98, v16, v17
 v_add_f32 v15, v15, v17
 v_mfma_f32_16x16x32_bf16 v[84:87], v[44:47], v[120:123], v[84:87]
 ds_read_b64_tr_b16 v[38:39], v13 offset:53248
 v_exp_f32 v16, v72
 v_mfma_f32_16x16x32_bf16 v[92:95], v[44:47], v[124:127], v[92:95]
 ds_read_b64_tr_b16 v[40:41], v8 offset:49664
 v_add_f32 v15, v15, v18
 v_exp_f32 v17, v73
 v_mfma_f32_16x16x32_bf16 v[84:87], v[240:243], v[128:131], v[84:87]
 ds_read_b64_tr_b16 v[42:43], v8 offset:53760
 v_cvt_pk_bf16_f32 v99, v18, v19
 v_add_f32 v15, v15, v19
 v_mfma_f32_16x16x32_bf16 v[92:95], v[240:243], v[132:135], v[92:95]
 ds_read_b64_tr_b16 v[44:45], v9 offset:49664
 v_exp_f32 v18, v74
 v_mfma_f32_16x16x32_bf16 v[84:87], v[244:247], v[136:139], v[84:87]
 ds_read_b64_tr_b16 v[46:47], v9 offset:53760
 v_add_f32 v57, v16, v17
 v_exp_f32 v19, v75
 v_mfma_f32_16x16x32_bf16 v[92:95], v[244:247], v[140:143], v[92:95]
 ds_read_b64_tr_b16 v[240:241], v12 offset:49664
 v_cvt_pk_bf16_f32 v100, v16, v17
 s_waitcnt lgkmcnt(5)
 v_mfma_f32_16x16x32_bf16 v[144:147], v[24:27], v[104:107], v[144:147]
 ds_read_b64_tr_b16 v[242:243], v12 offset:53760
 v_exp_f32 v16, v76
 v_mfma_f32_16x16x32_bf16 v[148:151], v[24:27], v[108:111], v[148:151]
 ds_read_b64_tr_b16 v[244:245], v13 offset:49664
 v_add_f32 v57, v57, v18
 v_mfma_f32_16x16x32_bf16 v[152:155], v[28:31], v[104:107], v[152:155]
 ds_read_b64_tr_b16 v[246:247], v13 offset:53760
 v_exp_f32 v17, v77
 v_cvt_pk_bf16_f32 v101, v18, v19
 v_mfma_f32_16x16x32_bf16 v[156:159], v[28:31], v[108:111], v[156:159]
 v_add_f32 v57, v57, v19
 v_exp_f32 v18, v78
 v_mfma_f32_16x16x32_bf16 v[160:163], v[32:35], v[104:107], v[160:163]
 v_add_f32 v57, v57, v16
 v_exp_f32 v19, v79
 v_mfma_f32_16x16x32_bf16 v[164:167], v[32:35], v[108:111], v[164:167]
 v_cvt_pk_bf16_f32 v102, v16, v17
 v_add_f32 v57, v57, v17
 v_mfma_f32_16x16x32_bf16 v[168:171], v[36:39], v[104:107], v[168:171]
 v_add_f32 v57, v57, v18
 v_cvt_pk_bf16_f32 v103, v18, v19
 v_add_f32 v57, v57, v19
 v_mfma_f32_16x16x32_bf16 v[172:175], v[36:39], v[108:111], v[172:175]
 s_waitcnt vmcnt(8) lgkmcnt(0)
 s_barrier
 ds_read_b128 v[24:27], v4 offset:0
 ds_read_b128 v[28:31], v5 offset:0
 ds_read_b128 v[32:35], v4 offset:512
 s_add_u32 m0, s50, 49152
 v_mfma_f32_16x16x32_bf16 v[176:179], v[40:43], v[104:107], v[176:179]
 s_add_u32 s46, s90, 81920
 s_and_b32 s46, s46, 0x1ffff
 s_add_u32 s46, s46, s91
 buffer_load_dwordx4 v252, s[96:99], s46 offen offset:0 nt lds
 v_mfma_f32_16x16x32_bf16 v[180:183], v[40:43], v[108:111], v[180:183]
 ds_read_b128 v[36:39], v5 offset:512
 v_mfma_f32_16x16x32_bf16 v[184:187], v[44:47], v[104:107], v[184:187]
 buffer_load_dwordx4 v253, s[96:99], s46 offen offset:1024 nt lds
 v_mfma_f32_16x16x32_bf16 v[188:191], v[44:47], v[108:111], v[188:191]
 ds_read_b128 v[40:43], v4 offset:4096
 v_mfma_f32_16x16x32_bf16 v[192:195], v[240:243], v[104:107], v[192:195]
 buffer_load_dwordx4 v254, s[96:99], s46 offen offset:2048 nt lds
 v_max_f32 v58, v15, v57
 v_mfma_f32_16x16x32_bf16 v[196:199], v[240:243], v[108:111], v[196:199]
 ds_read_b128 v[44:47], v5 offset:4096
 v_mfma_f32_16x16x32_bf16 v[200:203], v[244:247], v[104:107], v[200:203]
 buffer_load_dwordx4 v255, s[96:99], s46 offen offset:3072 nt lds
 v_cmp_lt_f32 vcc, s49, v58
 v_mfma_f32_16x16x32_bf16 v[204:207], v[244:247], v[108:111], v[204:207]
 s_cbranch_vccnz L_stub_6_5
L_back_6_5:
 v_add_f32 v14, v14, v15
 v_add_f32 v56, v56, v57
 ds_read_b128 v[240:243], v4 offset:4608
 s_waitcnt lgkmcnt(3)
 v_mfma_f32_16x16x32_bf16 v[64:67], v[24:27], v[112:115], v[48:51]
 v_exp_f32 v16, v80
 v_exp_f32 v17, v81
 v_mfma_f32_16x16x32_bf16 v[72:75], v[24:27], v[116:119], v[52:55]
 ds_read_b128 v[244:247], v5 offset:4608
 v_exp_f32 v18, v82
 v_mfma_f32_16x16x32_bf16 v[64:67], v[28:31], v[120:123], v[64:67]
 v_add_f32 v15, v16, v17
 v_exp_f32 v19, v83
 v_cvt_pk_bf16_f32 v104, v16, v17
 v_mfma_f32_16x16x32_bf16 v[72:75], v[28:31], v[124:127], v[72:75]
 ds_read_b64_tr_b16 v[24:25], v8 offset:0
 v_exp_f32 v16, v84
 v_mfma_f32_16x16x32_bf16 v[64:67], v[32:35], v[128:131], v[64:67]
 ds_read_b64_tr_b16 v[26:27], v8 offset:4096
 v_add_f32 v15, v15, v18
 v_exp_f32 v17, v85
 v_mfma_f32_16x16x32_bf16 v[72:75], v[32:35], v[132:135], v[72:75]
 ds_read_b64_tr_b16 v[28:29], v9 offset:0
 v_cvt_pk_bf16_f32 v105, v18, v19
 v_add_f32 v15, v15, v19
 v_mfma_f32_16x16x32_bf16 v[64:67], v[36:39], v[136:139], v[64:67]
 ds_read_b64_tr_b16 v[30:31], v9 offset:4096
 v_exp_f32 v18, v86
 v_mfma_f32_16x16x32_bf16 v[72:75], v[36:39], v[140:143], v[72:75]
 ds_read_b64_tr_b16 v[32:33], v12 offset:0
 v_add_f32 v15, v15, v16
 s_waitcnt lgkmcnt(5)
 v_mfma_f32_16x16x32_bf16 v[68:71], v[40:43], v[112:115], v[48:51]
 ds_read_b64_tr_b16 v[34:35], v12 offset:4096
 v_exp_f32 v19, v87
 v_mfma_f32_16x16x32_bf16 v[76:79], v[40:43], v[116:119], v[52:55]
 ds_read_b64_tr_b16 v[36:37], v13 offset:0
 v_cvt_pk_bf16_f32 v106, v16, v17
 v_add_f32 v15, v15, v17
 v_mfma_f32_16x16x32_bf16 v[68:71], v[44:47], v[120:123], v[68:71]
 ds_read_b64_tr_b16 v[38:39], v13 offset:4096
 v_exp_f32 v16, v88
 v_mfma_f32_16x16x32_bf16 v[76:79], v[44:47], v[124:127], v[76:79]
 ds_read_b64_tr_b16 v[40:41], v8 offset:512
 v_add_f32 v15, v15, v18
 v_exp_f32 v17, v89
 v_mfma_f32_16x16x32_bf16 v[68:71], v[240:243], v[128:131], v[68:71]
 ds_read_b64_tr_b16 v[42:43], v8 offset:4608
 v_cvt_pk_bf16_f32 v107, v18, v19
 v_add_f32 v15, v15, v19
 v_mfma_f32_16x16x32_bf16 v[76:79], v[240:243], v[132:135], v[76:79]
 ds_read_b64_tr_b16 v[44:45], v9 offset:512
 v_exp_f32 v18, v90
 v_mfma_f32_16x16x32_bf16 v[68:71], v[244:247], v[136:139], v[68:71]
 ds_read_b64_tr_b16 v[46:47], v9 offset:4608
 v_add_f32 v57, v16, v17
 v_exp_f32 v19, v91
 v_mfma_f32_16x16x32_bf16 v[76:79], v[244:247], v[140:143], v[76:79]
 ds_read_b64_tr_b16 v[240:241], v12 offset:512
 v_cvt_pk_bf16_f32 v108, v16, v17
 s_waitcnt lgkmcnt(5)
 v_mfma_f32_16x16x32_bf16 v[144:147], v[24:27], v[96:99], v[144:147]
 ds_read_b64_tr_b16 v[242:243], v12 offset:4608
 v_exp_f32 v16, v92
 v_mfma_f32_16x16x32_bf16 v[148:151], v[24:27], v[100:103], v[148:151]
 ds_read_b64_tr_b16 v[244:245], v13 offset:512
 v_add_f32 v57, v57, v18
 v_mfma_f32_16x16x32_bf16 v[152:155], v[28:31], v[96:99], v[152:155]
 ds_read_b64_tr_b16 v[246:247], v13 offset:4608
 v_exp_f32 v17, v93
 v_cvt_pk_bf16_f32 v109, v18, v19
 v_mfma_f32_16x16x32_bf16 v[156:159], v[28:31], v[100:103], v[156:159]
 v_add_f32 v57, v57, v19
 v_exp_f32 v18, v94
 v_mfma_f32_16x16x32_bf16 v[160:163], v[32:35], v[96:99], v[160:163]
 v_add_f32 v57, v57, v16
 v_exp_f32 v19, v95
 v_mfma_f32_16x16x32_bf16 v[164:167], v[32:35], v[100:103], v[164:167]
 v_cvt_pk_bf16_f32 v110, v16, v17
 v_add_f32 v57, v57, v17
 v_mfma_f32_16x16x32_bf16 v[168:171], v[36:39], v[96:99], v[168:171]
 v_add_f32 v57, v57, v18
 v_cvt_pk_bf16_f32 v111, v18, v19
 v_add_f32 v57, v57, v19
 v_mfma_f32_16x16x32_bf16 v[172:175], v[36:39], v[100:103], v[172:175]
 s_waitcnt vmcnt(8) lgkmcnt(0)
 s_barrier
 ds_read_b128 v[24:27], v4 offset:16384
 ds_read_b128 v[28:31], v5 offset:16384
 ds_read_b128 v[32:35], v4 offset:16896
 s_add_u32 m0, s50, 0
 v_mfma_f32_16x16x32_bf16 v[176:179], v[40:43], v[96:99], v[176:179]
 s_add_u32 s46, s90, 106496
 s_and_b32 s46, s46, 0x1ffff
 s_add_u32 s46, s46, s91
 buffer_load_dwordx4 v252, s[96:99], s46 offen offset:0 nt lds
 v_mfma_f32_16x16x32_bf16 v[180:183], v[40:43], v[100:103], v[180:183]
 ds_read_b128 v[36:39], v5 offset:16896
 v_mfma_f32_16x16x32_bf16 v[184:187], v[44:47], v[96:99], v[184:187]
 buffer_load_dwordx4 v253, s[96:99], s46 offen offset:1024 nt lds
 v_mfma_f32_16x16x32_bf16 v[188:191], v[44:47], v[100:103], v[188:191]
 ds_read_b128 v[40:43], v4 offset:20480
 v_mfma_f32_16x16x32_bf16 v[192:195], v[240:243], v[96:99], v[192:195]
 buffer_load_dwordx4 v254, s[96:99], s46 offen offset:2048 nt lds
 v_max_f32 v58, v15, v57
 v_mfma_f32_16x16x32_bf16 v[196:199], v[240:243], v[100:103], v[196:199]
 ds_read_b128 v[44:47], v5 offset:20480
 v_mfma_f32_16x16x32_bf16 v[200:203], v[244:247], v[96:99], v[200:203]
 buffer_load_dwordx4 v255, s[96:99], s46 offen offset:3072 nt lds
 v_cmp_lt_f32 vcc, s49, v58
 v_mfma_f32_16x16x32_bf16 v[204:207], v[244:247], v[100:103], v[204:207]
 s_cbranch_vccnz L_stub_7_6
L_back_7_6:
 v_add_f32 v14, v14, v15
 v_add_f32 v56, v56, v57
 ds_read_b128 v[240:243], v4 offset:20992
 s_waitcnt lgkmcnt(3)
 v_mfma_f32_16x16x32_bf16 v[80:83], v[24:27], v[112:115], v[48:51]
 v_exp_f32 v16, v64
 v_exp_f32 v17, v65
 v_mfma_f32_16x16x32_bf16 v[88:91], v[24:27], v[116:119], v[52:55]
 ds_read_b128 v[244:247], v5 offset:20992
 v_exp_f32 v18, v66
 v_mfma_f32_16x16x32_bf16 v[80:83], v[28:31], v[120:123], v[80:83]
 v_add_f32 v15, v16, v17
 v_exp_f32 v19, v67
 v_cvt_pk_bf16_f32 v96, v16, v17
 v_mfma_f32_16x16x32_bf16 v[88:91], v[28:31], v[124:127], v[88:91]
 ds_read_b64_tr_b16 v[24:25], v8 offset:16384
 v_exp_f32 v16, v68
 v_mfma_f32_16x16x32_bf16 v[80:83], v[32:35], v[128:131], v[80:83]
 ds_read_b64_tr_b16 v[26:27], v8 offset:20480
 v_add_f32 v15, v15, v18
 v_exp_f32 v17, v69
 v_mfma_f32_16x16x32_bf16 v[88:91], v[32:35], v[132:135], v[88:91]
 ds_read_b64_tr_b16 v[28:29], v9 offset:16384
 v_cvt_pk_bf16_f32 v97, v18, v19
 v_add_f32 v15, v15, v19
 v_mfma_f32_16x16x32_bf16 v[80:83], v[36:39], v[136:139], v[80:83]
 ds_read_b64_tr_b16 v[30:31], v9 offset:20480
 v_exp_f32 v18, v70
 v_mfma_f32_16x16x32_bf16 v[88:91], v[36:39], v[140:143], v[88:91]
 ds_read_b64_tr_b16 v[32:33], v12 offset:16384
 v_add_f32 v15, v15, v16
 s_waitcnt lgkmcnt(5)
 v_mfma_f32_16x16x32_bf16 v[84:87], v[40:43], v[112:115], v[48:51]
 ds_read_b64_tr_b16 v[34:35], v12 offset:20480
 v_exp_f32 v19, v71
 v_mfma_f32_16x16x32_bf16 v[92:95], v[40:43], v[116:119], v[52:55]
 ds_read_b64_tr_b16 v[36:37], v13 offset:16384
 v_cvt_pk_bf16_f32 v98, v16, v17
 v_add_f32 v15, v15, v17
 v_mfma_f32_16x16x32_bf16 v[84:87], v[44:47], v[120:123], v[84:87]
 ds_read_b64_tr_b16 v[38:39], v13 offset:20480
 v_exp_f32 v16, v72
 v_mfma_f32_16x16x32_bf16 v[92:95], v[44:47], v[124:127], v[92:95]
 ds_read_b64_tr_b16 v[40:41], v8 offset:16896
 v_add_f32 v15, v15, v18
 v_exp_f32 v17, v73
 v_mfma_f32_16x16x32_bf16 v[84:87], v[240:243], v[128:131], v[84:87]
 ds_read_b64_tr_b16 v[42:43], v8 offset:20992
 v_cvt_pk_bf16_f32 v99, v18, v19
 v_add_f32 v15, v15, v19
 v_mfma_f32_16x16x32_bf16 v[92:95], v[240:243], v[132:135], v[92:95]
 ds_read_b64_tr_b16 v[44:45], v9 offset:16896
 v_exp_f32 v18, v74
 v_mfma_f32_16x16x32_bf16 v[84:87], v[244:247], v[136:139], v[84:87]
 ds_read_b64_tr_b16 v[46:47], v9 offset:20992
 v_add_f32 v57, v16, v17
 v_exp_f32 v19, v75
 v_mfma_f32_16x16x32_bf16 v[92:95], v[244:247], v[140:143], v[92:95]
 ds_read_b64_tr_b16 v[240:241], v12 offset:16896
 v_cvt_pk_bf16_f32 v100, v16, v17
 s_waitcnt lgkmcnt(5)
 v_mfma_f32_16x16x32_bf16 v[144:147], v[24:27], v[104:107], v[144:147]
 ds_read_b64_tr_b16 v[242:243], v12 offset:20992
 v_exp_f32 v16, v76
 v_mfma_f32_16x16x32_bf16 v[148:151], v[24:27], v[108:111], v[148:151]
 ds_read_b64_tr_b16 v[244:245], v13 offset:16896
 v_add_f32 v57, v57, v18
 v_mfma_f32_16x16x32_bf16 v[152:155], v[28:31], v[104:107], v[152:155]
 ds_read_b64_tr_b16 v[246:247], v13 offset:20992
 v_exp_f32 v17, v77
 v_cvt_pk_bf16_f32 v101, v18, v19
 v_mfma_f32_16x16x32_bf16 v[156:159], v[28:31], v[108:111], v[156:159]
 v_add_f32 v57, v57, v19
 v_exp_f32 v18, v78
 v_mfma_f32_16x16x32_bf16 v[160:163], v[32:35], v[104:107], v[160:163]
 v_add_f32 v57, v57, v16
 v_exp_f32 v19, v79
 v_mfma_f32_16x16x32_bf16 v[164:167], v[32:35], v[108:111], v[164:167]
 v_cvt_pk_bf16_f32 v102, v16, v17
 v_add_f32 v57, v57, v17
 v_mfma_f32_16x16x32_bf16 v[168:171], v[36:39], v[104:107], v[168:171]
 v_add_f32 v57, v57, v18
 v_cvt_pk_bf16_f32 v103, v18, v19
 v_add_f32 v57, v57, v19
 v_mfma_f32_16x16x32_bf16 v[172:175], v[36:39], v[108:111], v[172:175]
 s_waitcnt vmcnt(8) lgkmcnt(0)
 s_barrier
 ds_read_b128 v[24:27], v4 offset:32768
 ds_read_b128 v[28:31], v5 offset:32768
 ds_read_b128 v[32:35], v4 offset:33280
 s_add_u32 m0, s50, 16384
 v_mfma_f32_16x16x32_bf16 v[176:179], v[40:43], v[104:107], v[176:179]
 s_add_u32 s46, s90, 114688
 s_and_b32 s46, s46, 0x1ffff
 s_add_u32 s46, s46, s91
 buffer_load_dwordx4 v252, s[96:99], s46 offen offset:0 nt lds
 v_mfma_f32_16x16x32_bf16 v[180:183], v[40:43], v[108:111], v[180:183]
 ds_read_b128 v[36:39], v5 offset:33280
 v_mfma_f32_16x16x32_bf16 v[184:187], v[44:47], v[104:107], v[184:187]
 buffer_load_dwordx4 v253, s[96:99], s46 offen offset:1024 nt lds
 v_mfma_f32_16x16x32_bf16 v[188:191], v[44:47], v[108:111], v[188:191]
 ds_read_b128 v[40:43], v4 offset:36864
 v_mfma_f32_16x16x32_bf16 v[192:195], v[240:243], v[104:107], v[192:195]
 buffer_load_dwordx4 v254, s[96:99], s46 offen offset:2048 nt lds
 v_max_f32 v58, v15, v57
 v_mfma_f32_16x16x32_bf16 v[196:199], v[240:243], v[108:111], v[196:199]
 ds_read_b128 v[44:47], v5 offset:36864
 v_mfma_f32_16x16x32_bf16 v[200:203], v[244:247], v[104:107], v[200:203]
 buffer_load_dwordx4 v255, s[96:99], s46 offen offset:3072 nt lds
 v_cmp_lt_f32 vcc, s49, v58
 v_mfma_f32_16x16x32_bf16 v[204:207], v[244:247], v[108:111], v[204:207]
 s_cbranch_vccnz L_stub_8_7
L_back_8_7:
 v_add_f32 v14, v14, v15
 v_add_f32 v56, v56, v57
 ds_read_b128 v[240:243], v4 offset:37376
 s_waitcnt lgkmcnt(3)
 v_mfma_f32_16x16x32_bf16 v[64:67], v[24:27], v[112:115], v[48:51]
 v_exp_f32 v16, v80
 v_exp_f32 v17, v81
 v_mfma_f32_16x16x32_bf16 v[72:75], v[24:27], v[116:119], v[52:55]
 ds_read_b128 v[244:247], v5 offset:37376
 v_exp_f32 v18, v82
 v_mfma_f32_16x16x32_bf16 v[64:67], v[28:31], v[120:123], v[64:67]
 v_add_f32 v15, v16, v17
 v_exp_f32 v19, v83
 v_cvt_pk_bf16_f32 v104, v16, v17
 v_mfma_f32_16x16x32_bf16 v[72:75], v[28:31], v[124:127], v[72:75]
 ds_read_b64_tr_b16 v[24:25], v8 offset:32768
 v_exp_f32 v16, v84
 v_mfma_f32_16x16x32_bf16 v[64:67], v[32:35], v[128:131], v[64:67]
 ds_read_b64_tr_b16 v[26:27], v8 offset:36864
 v_add_f32 v15, v15, v18
 v_exp_f32 v17, v85
 v_mfma_f32_16x16x32_bf16 v[72:75], v[32:35], v[132:135], v[72:75]
 ds_read_b64_tr_b16 v[28:29], v9 offset:32768
 v_cvt_pk_bf16_f32 v105, v18, v19
 v_add_f32 v15, v15, v19
 v_mfma_f32_16x16x32_bf16 v[64:67], v[36:39], v[136:139], v[64:67]
 ds_read_b64_tr_b16 v[30:31], v9 offset:36864
 v_exp_f32 v18, v86
 v_add_f32 v15, v15, v16
 v_mfma_f32_16x16x32_bf16 v[72:75], v[36:39], v[140:143], v[72:75]
 ds_read_b64_tr_b16 v[32:33], v12 offset:32768
 s_waitcnt lgkmcnt(5)
 v_mfma_f32_16x16x32_bf16 v[68:71], v[40:43], v[112:115], v[48:51]
 ds_read_b64_tr_b16 v[34:35], v12 offset:36864
 v_exp_f32 v19, v87
 v_cvt_pk_bf16_f32 v106, v16, v17
 v_mfma_f32_16x16x32_bf16 v[76:79], v[40:43], v[116:119], v[52:55]
 ds_read_b64_tr_b16 v[36:37], v13 offset:32768
 v_add_f32 v15, v15, v17
 v_mfma_f32_16x16x32_bf16 v[68:71], v[44:47], v[120:123], v[68:71]
 ds_read_b64_tr_b16 v[38:39], v13 offset:36864
 v_exp_f32 v16, v88
 v_add_f32 v15, v15, v18
 v_mfma_f32_16x16x32_bf16 v[76:79], v[44:47], v[124:127], v[76:79]
 ds_read_b64_tr_b16 v[40:41], v8 offset:33280
 v_exp_f32 v17, v89
 v_cvt_pk_bf16_f32 v107, v18, v19
 v_mfma_f32_16x16x32_bf16 v[68:71], v[240:243], v[128:131], v[68:71]
 ds_read_b64_tr_b16 v[42:43], v8 offset:37376
 v_add_f32 v15, v15, v19
 v_exp_f32 v18, v90
 v_mfma_f32_16x16x32_bf16 v[76:79], v[240:243], v[132:135], v[76:79]
 ds_read_b64_tr_b16 v[44:45], v9 offset:33280
 v_add_f32 v57, v16, v17
 v_mfma_f32_16x16x32_bf16 v[68:71], v[244:247], v[136:139], v[68:71]
 ds_read_b64_tr_b16 v[46:47], v9 offset:37376
 v_exp_f32 v19, v91
 v_cvt_pk_bf16_f32 v108, v16, v17
 v_mfma_f32_16x16x32_bf16 v[76:79], v[244:247], v[140:143], v[76:79]
 ds_read_b64_tr_b16 v[240:241], v12 offset:33280
 s_waitcnt lgkmcnt(5)
 v_mfma_f32_16x16x32_bf16 v[144:147], v[24:27], v[96:99], v[144:147]
 ds_read_b64_tr_b16 v[242:243], v12 offset:37376
 v_exp_f32 v16, v92
 v_add_f32 v57, v57, v18
 v_mfma_f32_16x16x32_bf16 v[148:151], v[24:27], v[100:103], v[148:151]
 ds_read_b64_tr_b16 v[244:245], v13 offset:33280
 v_exp_f32 v17, v93
 v_cvt_pk_bf16_f32 v109, v18, v19
 v_mfma_f32_16x16x32_bf16 v[152:155], v[28:31], v[96:99], v[152:155]
 ds_read_b64_tr_b16 v[246:247], v13 offset:37376
 v_add_f32 v57, v57, v19
 v_exp_f32 v18, v94
 v_mfma_f32_16x16x32_bf16 v[156:159], v[28:31], v[100:103], v[156:159]
 v_add_f32 v57, v57, v16
 v_exp_f32 v19, v95
 v_mfma_f32_16x16x32_bf16 v[160:163], v[32:35], v[96:99], v[160:163]
 v_cvt_pk_bf16_f32 v110, v16, v17
 v_add_f32 v57, v57, v17
 v_mfma_f32_16x16x32_bf16 v[164:167], v[32:35], v[100:103], v[164:167]
 v_add_f32 v57, v57, v18
 v_cvt_pk_bf16_f32 v111, v18, v19
 v_mfma_f32_16x16x32_bf16 v[168:171], v[36:39], v[96:99], v[168:171]
 v_add_f32 v57, v57, v19
 v_max_f32 v58, v15, v57
 v_cmp_lt_f32 vcc, s49, v58
 v_mfma_f32_16x16x32_bf16 v[172:175], v[36:39], v[100:103], v[172:175]
 s_waitcnt vmcnt(8) lgkmcnt(0)
 s_barrier
 ds_read_b128 v[24:27], v4 offset:49152
 ds_read_b128 v[28:31], v5 offset:49152
 ds_read_b128 v[32:35], v4 offset:49664
 v_xor_b32 v252, 0, v249
 v_xor_b32 v253, 32, v249
 v_xor_b32 v254, 0, v249
 v_xor_b32 v255, 32, v249
 v_mfma_f32_16x16x32_bf16 v[176:179], v[40:43], v[96:99], v[176:179]
 s_add_u32 m0, s50, 32768
 s_add_u32 s46, s14, 114688
 s_and_b32 s46, s46, 0x1ffff
 s_add_u32 s46, s46, s91
 buffer_load_dwordx4 v252, s[20:23], s46 offen offset:0 nt lds
 v_mfma_f32_16x16x32_bf16 v[180:183], v[40:43], v[100:103], v[180:183]
 ds_read_b128 v[36:39], v5 offset:49664
 v_mfma_f32_16x16x32_bf16 v[184:187], v[44:47], v[96:99], v[184:187]
 buffer_load_dwordx4 v253, s[20:23], s46 offen offset:1024 nt lds
 v_mfma_f32_16x16x32_bf16 v[188:191], v[44:47], v[100:103], v[188:191]
 ds_read_b128 v[40:43], v4 offset:53248
 v_mfma_f32_16x16x32_bf16 v[192:195], v[240:243], v[96:99], v[192:195]
 buffer_load_dwordx4 v254, s[20:23], s46 offen offset:2048 nt lds
 v_mfma_f32_16x16x32_bf16 v[196:199], v[240:243], v[100:103], v[196:199]
 ds_read_b128 v[44:47], v5 offset:53248
 v_mfma_f32_16x16x32_bf16 v[200:203], v[244:247], v[96:99], v[200:203]
 buffer_load_dwordx4 v255, s[20:23], s46 offen offset:3072 nt lds
 v_mfma_f32_16x16x32_bf16 v[204:207], v[244:247], v[100:103], v[204:207]
 s_cbranch_vccnz L_stub_9_8
L_back_9_8:
 v_add_f32 v14, v14, v15
 v_add_f32 v56, v56, v57
 ds_read_b128 v[240:243], v4 offset:53760
 s_waitcnt lgkmcnt(3)
 v_mfma_f32_16x16x32_bf16 v[80:83], v[24:27], v[112:115], v[48:51]
 v_exp_f32 v16, v64
 v_exp_f32 v17, v65
 v_mfma_f32_16x16x32_bf16 v[88:91], v[24:27], v[116:119], v[52:55]
 ds_read_b128 v[244:247], v5 offset:53760
 v_mfma_f32_16x16x32_bf16 v[80:83], v[28:31], v[120:123], v[80:83]
 v_exp_f32 v18, v66
 v_add_f32 v15, v16, v17
 v_mfma_f32_16x16x32_bf16 v[88:91], v[28:31], v[124:127], v[88:91]
 ds_read_b64_tr_b16 v[24:25], v8 offset:49152
 v_exp_f32 v19, v67
 v_mfma_f32_16x16x32_bf16 v[80:83], v[32:35], v[128:131], v[80:83]
 ds_read_b64_tr_b16 v[26:27], v8 offset:53248
 v_cvt_pk_bf16_f32 v96, v16, v17
 v_mfma_f32_16x16x32_bf16 v[88:91], v[32:35], v[132:135], v[88:91]
 ds_read_b64_tr_b16 v[28:29], v9 offset:49152
 v_exp_f32 v16, v68
 v_mfma_f32_16x16x32_bf16 v[80:83], v[36:39], v[136:139], v[80:83]
 ds_read_b64_tr_b16 v[30:31], v9 offset:53248
 v_add_f32 v15, v15, v18
 v_exp_f32 v17, v69
 v_mfma_f32_16x16x32_bf16 v[88:91], v[36:39], v[140:143], v[88:91]
 ds_read_b64_tr_b16 v[32:33], v12 offset:49152
 s_waitcnt lgkmcnt(5)
 v_mfma_f32_16x16x32_bf16 v[84:87], v[40:43], v[112:115], v[48:51]
 ds_read_b64_tr_b16 v[34:35], v12 offset:53248
 v_cvt_pk_bf16_f32 v97, v18, v19
 v_mfma_f32_16x16x32_bf16 v[92:95], v[40:43], v[116:119], v[52:55]
 ds_read_b64_tr_b16 v[36:37], v13 offset:49152
 v_add_f32 v15, v15, v19
 v_mfma_f32_16x16x32_bf16 v[84:87], v[44:47], v[120:123], v[84:87]
 ds_read_b64_tr_b16 v[38:39], v13 offset:53248
 v_exp_f32 v18, v70
 v_add_f32 v15, v15, v16
 v_mfma_f32_16x16x32_bf16 v[92:95], v[44:47], v[124:127], v[92:95]
 ds_read_b64_tr_b16 v[40:41], v8 offset:49664
 v_exp_f32 v19, v71
 v_mfma_f32_16x16x32_bf16 v[84:87], v[240:243], v[128:131], v[84:87]
 ds_read_b64_tr_b16 v[42:43], v8 offset:53760
 v_cvt_pk_bf16_f32 v98, v16, v17
 v_mfma_f32_16x16x32_bf16 v[92:95], v[240:243], v[132:135], v[92:95]
 ds_read_b64_tr_b16 v[44:45], v9 offset:49664
 v_add_f32 v15, v15, v17
 v_mfma_f32_16x16x32_bf16 v[84:87], v[244:247], v[136:139], v[84:87]
 ds_read_b64_tr_b16 v[46:47], v9 offset:53760
 v_exp_f32 v16, v72
 v_mfma_f32_16x16x32_bf16 v[92:95], v[244:247], v[140:143], v[92:95]
 ds_read_b64_tr_b16 v[240:241], v12 offset:49664
 v_add_f32 v15, v15, v18
 s_waitcnt lgkmcnt(5)
 v_mfma_f32_16x16x32_bf16 v[144:147], v[24:27], v[104:107], v[144:147]
 ds_read_b64_tr_b16 v[242:243], v12 offset:53760
 v_exp_f32 v17, v73
 v_mfma_f32_16x16x32_bf16 v[148:151], v[24:27], v[108:111], v[148:151]
 ds_read_b64_tr_b16 v[244:245], v13 offset:49664
 v_cvt_pk_bf16_f32 v99, v18, v19
 v_mfma_f32_16x16x32_bf16 v[152:155], v[28:31], v[104:107], v[152:155]
 ds_read_b64_tr_b16 v[246:247], v13 offset:53760
 v_add_f32 v15, v15, v19
 v_mfma_f32_16x16x32_bf16 v[156:159], v[28:31], v[108:111], v[156:159]
 v_exp_f32 v18, v74
 v_mfma_f32_16x16x32_bf16 v[160:163], v[32:35], v[104:107], v[160:163]
 v_add_f32 v57, v16, v17
 v_exp_f32 v19, v75
 v_mfma_f32_16x16x32_bf16 v[164:167], v[32:35], v[108:111], v[164:167]
 v_cvt_pk_bf16_f32 v100, v16, v17
 v_mfma_f32_16x16x32_bf16 v[168:171], v[36:39], v[104:107], v[168:171]
 v_exp_f32 v16, v76
 v_add_f32 v57, v57, v18
 v_mfma_f32_16x16x32_bf16 v[172:175], v[36:39], v[108:111], v[172:175]
 s_waitcnt vmcnt(32) lgkmcnt(0)
 s_barrier
 v_add_u32 v4, 65536, v4
 ds_read_b128 v[24:27], v4 offset:0
 v_add_u32 v5, 65536, v5
 ds_read_b128 v[28:31], v5 offset:0
 ds_read_b128 v[32:35], v4 offset:512
 v_mfma_f32_16x16x32_bf16 v[176:179], v[40:43], v[104:107], v[176:179]
 v_exp_f32 v17, v77
 v_cvt_pk_bf16_f32 v101, v18, v19
 v_mfma_f32_16x16x32_bf16 v[180:183], v[40:43], v[108:111], v[180:183]
 ds_read_b128 v[36:39], v5 offset:512
 v_add_f32 v57, v57, v19
 v_mfma_f32_16x16x32_bf16 v[184:187], v[44:47], v[104:107], v[184:187]
 v_exp_f32 v18, v78
 v_add_f32 v57, v57, v16
 v_mfma_f32_16x16x32_bf16 v[188:191], v[44:47], v[108:111], v[188:191]
 ds_read_b128 v[40:43], v4 offset:4096
 v_exp_f32 v19, v79
 v_mfma_f32_16x16x32_bf16 v[192:195], v[240:243], v[104:107], v[192:195]
 v_cvt_pk_bf16_f32 v102, v16, v17
 v_add_f32 v57, v57, v17
 v_add_f32 v57, v57, v18
 v_mfma_f32_16x16x32_bf16 v[196:199], v[240:243], v[108:111], v[196:199]
 ds_read_b128 v[44:47], v5 offset:4096
 v_cvt_pk_bf16_f32 v103, v18, v19
 v_mfma_f32_16x16x32_bf16 v[200:203], v[244:247], v[104:107], v[200:203]
 v_add_f32 v57, v57, v19
 v_max_f32 v58, v15, v57
 v_cmp_lt_f32 vcc, s49, v58
 v_mfma_f32_16x16x32_bf16 v[204:207], v[244:247], v[108:111], v[204:207]
 s_cbranch_vccnz L_stub_10_9
L_back_10_9:
 v_add_f32 v14, v14, v15
 v_add_f32 v56, v56, v57
 ds_read_b128 v[240:243], v4 offset:4608
 s_waitcnt lgkmcnt(3)
 v_mfma_f32_16x16x32_bf16 v[64:67], v[24:27], v[112:115], v[48:51]
 v_exp_f32 v16, v80
 v_exp_f32 v17, v81
 v_mfma_f32_16x16x32_bf16 v[72:75], v[24:27], v[116:119], v[52:55]
 ds_read_b128 v[244:247], v5 offset:4608
 v_mfma_f32_16x16x32_bf16 v[64:67], v[28:31], v[120:123], v[64:67]
 v_exp_f32 v18, v82
 v_add_f32 v15, v16, v17
 v_mfma_f32_16x16x32_bf16 v[72:75], v[28:31], v[124:127], v[72:75]
 v_add_u32 v8, 65536, v8
 ds_read_b64_tr_b16 v[24:25], v8 offset:0
 v_exp_f32 v19, v83
 v_mfma_f32_16x16x32_bf16 v[64:67], v[32:35], v[128:131], v[64:67]
 ds_read_b64_tr_b16 v[26:27], v8 offset:4096
 v_cvt_pk_bf16_f32 v104, v16, v17
 v_mfma_f32_16x16x32_bf16 v[72:75], v[32:35], v[132:135], v[72:75]
 v_add_u32 v9, 65536, v9
 ds_read_b64_tr_b16 v[28:29], v9 offset:0
 v_exp_f32 v16, v84
 v_mfma_f32_16x16x32_bf16 v[64:67], v[36:39], v[136:139], v[64:67]
 ds_read_b64_tr_b16 v[30:31], v9 offset:4096
 v_add_f32 v15, v15, v18
 v_exp_f32 v17, v85
 v_mfma_f32_16x16x32_bf16 v[72:75], v[36:39], v[140:143], v[72:75]
 v_add_u32 v12, 65536, v12
 ds_read_b64_tr_b16 v[32:33], v12 offset:0
 s_waitcnt lgkmcnt(5)
 v_mfma_f32_16x16x32_bf16 v[68:71], v[40:43], v[112:115], v[48:51]
 ds_read_b64_tr_b16 v[34:35], v12 offset:4096
 v_cvt_pk_bf16_f32 v105, v18, v19
 v_mfma_f32_16x16x32_bf16 v[76:79], v[40:43], v[116:119], v[52:55]
 v_add_u32 v13, 65536, v13
 ds_read_b64_tr_b16 v[36:37], v13 offset:0
 v_add_f32 v15, v15, v19
 v_mfma_f32_16x16x32_bf16 v[68:71], v[44:47], v[120:123], v[68:71]
 ds_read_b64_tr_b16 v[38:39], v13 offset:4096
 v_exp_f32 v18, v86
 v_add_f32 v15, v15, v16
 v_mfma_f32_16x16x32_bf16 v[76:79], v[44:47], v[124:127], v[76:79]
 ds_read_b64_tr_b16 v[40:41], v8 offset:512
 v_exp_f32 v19, v87
 v_mfma_f32_16x16x32_bf16 v[68:71], v[240:243], v[128:131], v[68:71]
 ds_read_b64_tr_b16 v[42:43], v8 offset:4608
 v_cvt_pk_bf16_f32 v106, v16, v17
 v_mfma_f32_16x16x32_bf16 v[76:79], v[240:243], v[132:135], v[76:79]
 ds_read_b64_tr_b16 v[44:45], v9 offset:512
 v_add_f32 v15, v15, v17
 v_mfma_f32_16x16x32_bf16 v[68:71], v[244:247], v[136:139], v[68:71]
 ds_read_b64_tr_b16 v[46:47], v9 offset:4608
 v_exp_f32 v16, v88
 v_mfma_f32_16x16x32_bf16 v[76:79], v[244:247], v[140:143], v[76:79]
 ds_read_b64_tr_b16 v[240:241], v12 offset:512
 v_add_f32 v15, v15, v18
 s_waitcnt lgkmcnt(5)
 v_mfma_f32_16x16x32_bf16 v[144:147], v[24:27], v[96:99], v[144:147]
 ds_read_b64_tr_b16 v[242:243], v12 offset:4608
 v_exp_f32 v17, v89
 v_mfma_f32_16x16x32_bf16 v[148:151], v[24:27], v[100:103], v[148:151]
 ds_read_b64_tr_b16 v[244:245], v13 offset:512
 v_cvt_pk_bf16_f32 v107, v18, v19
 v_mfma_f32_16x16x32_bf16 v[152:155], v[28:31], v[96:99], v[152:155]
 ds_read_b64_tr_b16 v[246:247], v13 offset:4608
 v_add_f32 v15, v15, v19
 v_mfma_f32_16x16x32_bf16 v[156:159], v[28:31], v[100:103], v[156:159]
 v_exp_f32 v18, v90
 v_mfma_f32_16x16x32_bf16 v[160:163], v[32:35], v[96:99], v[160:163]
 v_add_f32 v57, v16, v17
 v_exp_f32 v19, v91
 v_mfma_f32_16x16x32_bf16 v[164:167], v[32:35], v[100:103], v[164:167]
 v_cvt_pk_bf16_f32 v108, v16, v17
 v_mfma_f32_16x16x32_bf16 v[168:171], v[36:39], v[96:99], v[168:171]
 v_exp_f32 v16, v92
 v_add_f32 v57, v57, v18
 v_mfma_f32_16x16x32_bf16 v[172:175], v[36:39], v[100:103], v[172:175]
 s_waitcnt vmcnt(28) lgkmcnt(0)
 s_barrier
 ds_read_b128 v[24:27], v4 offset:16384
 ds_read_b128 v[28:31], v5 offset:16384
 ds_read_b128 v[32:35], v4 offset:16896
 v_mfma_f32_16x16x32_bf16 v[176:179], v[40:43], v[96:99], v[176:179]
 v_exp_f32 v17, v93
 v_cvt_pk_bf16_f32 v109, v18, v19
 v_mfma_f32_16x16x32_bf16 v[180:183], v[40:43], v[100:103], v[180:183]
 ds_read_b128 v[36:39], v5 offset:16896
 v_add_f32 v57, v57, v19
 v_mfma_f32_16x16x32_bf16 v[184:187], v[44:47], v[96:99], v[184:187]
 v_exp_f32 v18, v94
 v_add_f32 v57, v57, v16
 v_mfma_f32_16x16x32_bf16 v[188:191], v[44:47], v[100:103], v[188:191]
 ds_read_b128 v[40:43], v4 offset:20480
 v_exp_f32 v19, v95
 v_mfma_f32_16x16x32_bf16 v[192:195], v[240:243], v[96:99], v[192:195]
 v_cvt_pk_bf16_f32 v110, v16, v17
 v_add_f32 v57, v57, v17
 v_add_f32 v57, v57, v18
 v_mfma_f32_16x16x32_bf16 v[196:199], v[240:243], v[100:103], v[196:199]
 ds_read_b128 v[44:47], v5 offset:20480
 v_cvt_pk_bf16_f32 v111, v18, v19
 v_mfma_f32_16x16x32_bf16 v[200:203], v[244:247], v[96:99], v[200:203]
 v_add_f32 v57, v57, v19
 v_max_f32 v58, v15, v57
 v_cmp_lt_f32 vcc, s49, v58
 v_mfma_f32_16x16x32_bf16 v[204:207], v[244:247], v[100:103], v[204:207]
 s_cbranch_vccnz L_stub_11_10
L_back_11_10:
 v_add_f32 v14, v14, v15
 v_add_f32 v56, v56, v57
 ds_read_b128 v[240:243], v4 offset:20992
 s_waitcnt lgkmcnt(3)
 v_mfma_f32_16x16x32_bf16 v[80:83], v[24:27], v[112:115], v[48:51]
 v_exp_f32 v16, v64
 v_exp_f32 v17, v65
 v_mfma_f32_16x16x32_bf16 v[88:91], v[24:27], v[116:119], v[52:55]
 ds_read_b128 v[244:247], v5 offset:20992
 v_mfma_f32_16x16x32_bf16 v[80:83], v[28:31], v[120:123], v[80:83]
 v_exp_f32 v18, v66
 v_add_f32 v15, v16, v17
 v_mfma_f32_16x16x32_bf16 v[88:91], v[28:31], v[124:127], v[88:91]
 ds_read_b64_tr_b16 v[24:25], v8 offset:16384
 v_exp_f32 v19, v67
 v_mfma_f32_16x16x32_bf16 v[80:83], v[32:35], v[128:131], v[80:83]
 ds_read_b64_tr_b16 v[26:27], v8 offset:20480
 v_cvt_pk_bf16_f32 v96, v16, v17
 v_mfma_f32_16x16x32_bf16 v[88:91], v[32:35], v[132:135], v[88:91]
 ds_read_b64_tr_b16 v[28:29], v9 offset:16384
 v_exp_f32 v16, v68
 v_mfma_f32_16x16x32_bf16 v[80:83], v[36:39], v[136:139], v[80:83]
 ds_read_b64_tr_b16 v[30:31], v9 offset:20480
 v_add_f32 v15, v15, v18
 v_exp_f32 v17, v69
 v_mfma_f32_16x16x32_bf16 v[88:91], v[36:39], v[140:143], v[88:91]
 ds_read_b64_tr_b16 v[32:33], v12 offset:16384
 s_waitcnt lgkmcnt(5)
 v_mfma_f32_16x16x32_bf16 v[84:87], v[40:43], v[112:115], v[48:51]
 ds_read_b64_tr_b16 v[34:35], v12 offset:20480
 v_cvt_pk_bf16_f32 v97, v18, v19
 v_mfma_f32_16x16x32_bf16 v[92:95], v[40:43], v[116:119], v[52:55]
 ds_read_b64_tr_b16 v[36:37], v13 offset:16384
 v_add_f32 v15, v15, v19
 v_mfma_f32_16x16x32_bf16 v[84:87], v[44:47], v[120:123], v[84:87]
 ds_read_b64_tr_b16 v[38:39], v13 offset:20480
 v_exp_f32 v18, v70
 v_add_f32 v15, v15, v16
 v_mfma_f32_16x16x32_bf16 v[92:95], v[44:47], v[124:127], v[92:95]
 ds_read_b64_tr_b16 v[40:41], v8 offset:16896
 v_exp_f32 v19, v71
 v_mfma_f32_16x16x32_bf16 v[84:87], v[240:243], v[128:131], v[84:87]
 ds_read_b64_tr_b16 v[42:43], v8 offset:20992
 v_cvt_pk_bf16_f32 v98, v16, v17
 v_mfma_f32_16x16x32_bf16 v[92:95], v[240:243], v[132:135], v[92:95]
 ds_read_b64_tr_b16 v[44:45], v9 offset:16896
 v_add_f32 v15, v15, v17
 v_mfma_f32_16x16x32_bf16 v[84:87], v[244:247], v[136:139], v[84:87]
 ds_read_b64_tr_b16 v[46:47], v9 offset:20992
 v_exp_f32 v16, v72
 v_mfma_f32_16x16x32_bf16 v[92:95], v[244:247], v[140:143], v[92:95]
 ds_read_b64_tr_b16 v[240:241], v12 offset:16896
 v_add_f32 v15, v15, v18
 s_waitcnt lgkmcnt(5)
 v_mfma_f32_16x16x32_bf16 v[144:147], v[24:27], v[104:107], v[144:147]
 ds_read_b64_tr_b16 v[242:243], v12 offset:20992
 v_exp_f32 v17, v73
 v_mfma_f32_16x16x32_bf16 v[148:151], v[24:27], v[108:111], v[148:151]
 ds_read_b64_tr_b16 v[244:245], v13 offset:16896
 v_cvt_pk_bf16_f32 v99, v18, v19
 v_mfma_f32_16x16x32_bf16 v[152:155], v[28:31], v[104:107], v[152:155]
 ds_read_b64_tr_b16 v[246:247], v13 offset:20992
 v_add_f32 v15, v15, v19
 v_mfma_f32_16x16x32_bf16 v[156:159], v[28:31], v[108:111], v[156:159]
 v_exp_f32 v18, v74
 v_mfma_f32_16x16x32_bf16 v[160:163], v[32:35], v[104:107], v[160:163]
 v_add_f32 v57, v16, v17
 v_exp_f32 v19, v75
 v_mfma_f32_16x16x32_bf16 v[164:167], v[32:35], v[108:111], v[164:167]
 v_cvt_pk_bf16_f32 v100, v16, v17
 v_mfma_f32_16x16x32_bf16 v[168:171], v[36:39], v[104:107], v[168:171]
 v_exp_f32 v16, v76
 v_add_f32 v57, v57, v18
 v_mfma_f32_16x16x32_bf16 v[172:175], v[36:39], v[108:111], v[172:175]
 s_waitcnt vmcnt(8) lgkmcnt(0)
 s_barrier
 v_add_u32 v4, 4294901760, v4
 ds_read_b128 v[24:27], v4 offset:0
 v_add_u32 v5, 4294901760, v5
 ds_read_b128 v[28:31], v5 offset:0
 ds_read_b128 v[32:35], v4 offset:512
 v_mfma_f32_16x16x32_bf16 v[176:179], v[40:43], v[104:107], v[176:179]
 v_exp_f32 v17, v77
 v_cvt_pk_bf16_f32 v101, v18, v19
 v_mfma_f32_16x16x32_bf16 v[180:183], v[40:43], v[108:111], v[180:183]
 ds_read_b128 v[36:39], v5 offset:512
 v_add_f32 v57, v57, v19
 v_mfma_f32_16x16x32_bf16 v[184:187], v[44:47], v[104:107], v[184:187]
 v_exp_f32 v18, v78
 v_add_f32 v57, v57, v16
 v_mfma_f32_16x16x32_bf16 v[188:191], v[44:47], v[108:111], v[188:191]
 ds_read_b128 v[40:43], v4 offset:4096
 v_exp_f32 v19, v79
 v_mfma_f32_16x16x32_bf16 v[192:195], v[240:243], v[104:107], v[192:195]
 v_cvt_pk_bf16_f32 v102, v16, v17
 v_add_f32 v57, v57, v17
 v_add_f32 v57, v57, v18
 v_mfma_f32_16x16x32_bf16 v[196:199], v[240:243], v[108:111], v[196:199]
 ds_read_b128 v[44:47], v5 offset:4096
 v_cvt_pk_bf16_f32 v103, v18, v19
 v_mfma_f32_16x16x32_bf16 v[200:203], v[244:247], v[104:107], v[200:203]
 v_add_f32 v57, v57, v19
 v_max_f32 v58, v15, v57
 v_cmp_lt_f32 vcc, s49, v58
 v_mfma_f32_16x16x32_bf16 v[204:207], v[244:247], v[108:111], v[204:207]
 s_cbranch_vccnz L_stub_12_11
L_back_12_11:
 v_add_f32 v14, v14, v15
 v_add_f32 v56, v56, v57
 ds_read_b128 v[240:243], v4 offset:4608
 s_waitcnt lgkmcnt(3)
 v_mfma_f32_16x16x32_bf16 v[64:67], v[24:27], v[112:115], v[48:51]
 v_exp_f32 v16, v80
 v_exp_f32 v17, v81
 v_mfma_f32_16x16x32_bf16 v[72:75], v[24:27], v[116:119], v[52:55]
 ds_read_b128 v[244:247], v5 offset:4608
 v_exp_f32 v18, v82
 v_mfma_f32_16x16x32_bf16 v[64:67], v[28:31], v[120:123], v[64:67]
 v_add_f32 v15, v16, v17
 v_exp_f32 v19, v83
 v_cvt_pk_bf16_f32 v104, v16, v17
 v_mfma_f32_16x16x32_bf16 v[72:75], v[28:31], v[124:127], v[72:75]
 v_add_u32 v8, 4294901760, v8
 ds_read_b64_tr_b16 v[24:25], v8 offset:0
 v_exp_f32 v16, v84
 v_mfma_f32_16x16x32_bf16 v[64:67], v[32:35], v[128:131], v[64:67]
 ds_read_b64_tr_b16 v[26:27], v8 offset:4096
 v_add_f32 v15, v15, v18
 v_exp_f32 v17, v85
 v_mfma_f32_16x16x32_bf16 v[72:75], v[32:35], v[132:135], v[72:75]
 v_add_u32 v9, 4294901760, v9
 ds_read_b64_tr_b16 v[28:29], v9 offset:0
 v_cvt_pk_bf16_f32 v105, v18, v19
 v_add_f32 v15, v15, v19
 v_mfma_f32_16x16x32_bf16 v[64:67], v[36:39], v[136:139], v[64:67]
 ds_read_b64_tr_b16 v[30:31], v9 offset:4096
 v_exp_f32 v18, v86
 v_add_f32 v15, v15, v16
 v_mfma_f32_16x16x32_bf16 v[72:75], v[36:39], v[140:143], v[72:75]
 v_add_u32 v12, 4294901760, v12
 ds_read_b64_tr_b16 v[32:33], v12 offset:0
 s_waitcnt lgkmcnt(5)
 v_mfma_f32_16x16x32_bf16 v[68:71], v[40:43], v[112:115], v[48:51]
 ds_read_b64_tr_b16 v[34:35], v12 offset:4096
 v_exp_f32 v19, v87
 v_cvt_pk_bf16_f32 v106, v16, v17
 v_mfma_f32_16x16x32_bf16 v[76:79], v[40:43], v[116:119], v[52:55]
 v_add_u32 v13, 4294901760, v13
 ds_read_b64_tr_b16 v[36:37], v13 offset:0
 v_add_f32 v15, v15, v17
 v_mfma_f32_16x16x32_bf16 v[68:71], v[44:47], v[120:123], v[68:71]
 ds_read_b64_tr_b16 v[38:39], v13 offset:4096
 v_exp_f32 v16, v88
 v_add_f32 v15, v15, v18
 v_mfma_f32_16x16x32_bf16 v[76:79], v[44:47], v[124:127], v[76:79]
 ds_read_b64_tr_b16 v[40:41], v8 offset:512
 v_exp_f32 v17, v89
 v_cvt_pk_bf16_f32 v107, v18, v19
 v_mfma_f32_16x16x32_bf16 v[68:71], v[240:243], v[128:131], v[68:71]
 ds_read_b64_tr_b16 v[42:43], v8 offset:4608
 v_add_f32 v15, v15, v19
 v_exp_f32 v18, v90
 v_mfma_f32_16x16x32_bf16 v[76:79], v[240:243], v[132:135], v[76:79]
 ds_read_b64_tr_b16 v[44:45], v9 offset:512
 v_add_f32 v57, v16, v17
 v_mfma_f32_16x16x32_bf16 v[68:71], v[244:247], v[136:139], v[68:71]
 ds_read_b64_tr_b16 v[46:47], v9 offset:4608
 v_exp_f32 v19, v91
 v_cvt_pk_bf16_f32 v108, v16, v17
 v_mfma_f32_16x16x32_bf16 v[76:79], v[244:247], v[140:143], v[76:79]
 ds_read_b64_tr_b16 v[240:241], v12 offset:512
 s_waitcnt lgkmcnt(5)
 v_mfma_f32_16x16x32_bf16 v[144:147], v[24:27], v[96:99], v[144:147]
 ds_read_b64_tr_b16 v[242:243], v12 offset:4608
 v_exp_f32 v16, v92
 v_add_f32 v57, v57, v18
 v_mfma_f32_16x16x32_bf16 v[148:151], v[24:27], v[100:103], v[148:151]
 ds_read_b64_tr_b16 v[244:245], v13 offset:512
 v_exp_f32 v17, v93
 v_cvt_pk_bf16_f32 v109, v18, v19
 v_mfma_f32_16x16x32_bf16 v[152:155], v[28:31], v[96:99], v[152:155]
 ds_read_b64_tr_b16 v[246:247], v13 offset:4608
 v_add_f32 v57, v57, v19
 v_exp_f32 v18, v94
 v_mfma_f32_16x16x32_bf16 v[156:159], v[28:31], v[100:103], v[156:159]
 v_add_f32 v57, v57, v16
 v_exp_f32 v19, v95
 v_mfma_f32_16x16x32_bf16 v[160:163], v[32:35], v[96:99], v[160:163]
 v_cvt_pk_bf16_f32 v110, v16, v17
 v_add_f32 v57, v57, v17
 v_mfma_f32_16x16x32_bf16 v[164:167], v[32:35], v[100:103], v[164:167]
 v_add_f32 v57, v57, v18
 v_cvt_pk_bf16_f32 v111, v18, v19
 v_mfma_f32_16x16x32_bf16 v[168:171], v[36:39], v[96:99], v[168:171]
 v_add_f32 v57, v57, v19
 v_max_f32 v58, v15, v57
 v_cmp_lt_f32 vcc, s49, v58
 v_mfma_f32_16x16x32_bf16 v[172:175], v[36:39], v[100:103], v[172:175]
 s_waitcnt vmcnt(4) lgkmcnt(0)
 s_barrier
 ds_read_b128 v[24:27], v4 offset:16384
 ds_read_b128 v[28:31], v5 offset:16384
 ds_read_b128 v[32:35], v4 offset:16896
 v_add_u32 v252, 0, v250
 v_add_u32 v253, 8192, v250
 v_add_u32 v254, 16384, v250
 v_mfma_f32_16x16x32_bf16 v[176:179], v[40:43], v[96:99], v[176:179]
 v_add_u32 v255, 24576, v250
 s_add_u32 m0, s50, 0
 s_add_u32 s46, s66, s80
 buffer_load_dwordx4 v252, s[28:31], s46 offen offset:0 lds
 v_mfma_f32_16x16x32_bf16 v[180:183], v[40:43], v[100:103], v[180:183]
 ds_read_b128 v[36:39], v5 offset:16896
 v_mfma_f32_16x16x32_bf16 v[184:187], v[44:47], v[96:99], v[184:187]
 buffer_load_dwordx4 v253, s[28:31], s46 offen offset:1024 lds
 v_mfma_f32_16x16x32_bf16 v[188:191], v[44:47], v[100:103], v[188:191]
 ds_read_b128 v[40:43], v4 offset:20480
 v_mfma_f32_16x16x32_bf16 v[192:195], v[240:243], v[96:99], v[192:195]
 buffer_load_dwordx4 v254, s[28:31], s46 offen offset:2048 lds
 v_mfma_f32_16x16x32_bf16 v[196:199], v[240:243], v[100:103], v[196:199]
 ds_read_b128 v[44:47], v5 offset:20480
 v_mfma_f32_16x16x32_bf16 v[200:203], v[244:247], v[96:99], v[200:203]
 buffer_load_dwordx4 v255, s[28:31], s46 offen offset:3072 lds
 v_mfma_f32_16x16x32_bf16 v[204:207], v[244:247], v[100:103], v[204:207]
 s_cbranch_vccnz L_stub_13_12
L_back_13_12:
 v_add_f32 v14, v14, v15
 v_add_f32 v56, v56, v57
 ds_read_b128 v[240:243], v4 offset:20992
 s_add_u32 s91, s91, 0x20000
 s_cmp_eq_u32 s47, 3
 s_cselect_b32 s18, 0, s18
 s_cselect_b32 s98, 0, s98
 v_xor_b32 v252, 0, v248
 s_waitcnt lgkmcnt(3)
 v_mfma_f32_16x16x32_bf16 v[80:83], v[24:27], v[112:115], v[48:51]
 v_xor_b32 v253, 16, v248
 v_xor_b32 v254, 64, v248
 v_xor_b32 v255, 80, v248
 s_add_u32 m0, s50, 49152
 s_add_u32 s46, s14, 0
 s_and_b32 s46, s46, 0x1ffff
 s_add_u32 s46, s46, s91
 buffer_load_dwordx4 v252, s[16:19], s46 offen offset:0 nt lds
 v_mfma_f32_16x16x32_bf16 v[88:91], v[24:27], v[116:119], v[52:55]
 ds_read_b128 v[244:247], v5 offset:20992
 v_mfma_f32_16x16x32_bf16 v[80:83], v[28:31], v[120:123], v[80:83]
 buffer_load_dwordx4 v253, s[16:19], s46 offen offset:1024 nt lds
 v_mfma_f32_16x16x32_bf16 v[88:91], v[28:31], v[124:127], v[88:91]
 ds_read_b64_tr_b16 v[24:25], v8 offset:16384
 v_mfma_f32_16x16x32_bf16 v[80:83], v[32:35], v[128:131], v[80:83]
 ds_read_b64_tr_b16 v[26:27], v8 offset:20480
 buffer_load_dwordx4 v254, s[16:19], s46 offen offset:2048 nt lds
 v_mfma_f32_16x16x32_bf16 v[88:91], v[32:35], v[132:135], v[88:91]
 ds_read_b64_tr_b16 v[28:29], v9 offset:16384
 buffer_load_dwordx4 v255, s[16:19], s46 offen offset:3072 nt lds
 v_mfma_f32_16x16x32_bf16 v[80:83], v[36:39], v[136:139], v[80:83]
 ds_read_b64_tr_b16 v[30:31], v9 offset:20480
 v_exp_f32 v16, v64
 v_exp_f32 v17, v65
 v_mfma_f32_16x16x32_bf16 v[88:91], v[36:39], v[140:143], v[88:91]
 ds_read_b64_tr_b16 v[32:33], v12 offset:16384
 v_exp_f32 v18, v66
 s_waitcnt lgkmcnt(5)
 v_mfma_f32_16x16x32_bf16 v[84:87], v[40:43], v[112:115], v[48:51]
 ds_read_b64_tr_b16 v[34:35], v12 offset:20480
 v_add_f32 v15, v16, v17
 v_exp_f32 v19, v67
 v_mfma_f32_16x16x32_bf16 v[92:95], v[40:43], v[116:119], v[52:55]
 ds_read_b64_tr_b16 v[36:37], v13 offset:16384
 v_cvt_pk_bf16_f32 v96, v16, v17
 v_exp_f32 v16, v68
 v_mfma_f32_16x16x32_bf16 v[84:87], v[44:47], v[120:123], v[84:87]
 ds_read_b64_tr_b16 v[38:39], v13 offset:20480
 v_add_f32 v15, v15, v18
 v_exp_f32 v17, v69
 v_mfma_f32_16x16x32_bf16 v[92:95], v[44:47], v[124:127], v[92:95]
 ds_read_b64_tr_b16 v[40:41], v8 offset:16896
 v_cvt_pk_bf16_f32 v97, v18, v19
 v_add_f32 v15, v15, v19
 v_exp_f32 v18, v70
 v_mfma_f32_16x16x32_bf16 v[84:87], v[240:243], v[128:131], v[84:87]
 ds_read_b64_tr_b16 v[42:43], v8 offset:20992
 v_add_f32 v15, v15, v16
 v_exp_f32 v19, v71
 v_mfma_f32_16x16x32_bf16 v[92:95], v[240:243], v[132:135], v[92:95]
 ds_read_b64_tr_b16 v[44:45], v9 offset:16896
 v_cvt_pk_bf16_f32 v98, v16, v17
 v_add_f32 v15, v15, v17
 v_exp_f32 v16, v72
 v_mfma_f32_16x16x32_bf16 v[84:87], v[244:247], v[136:139], v[84:87]
 ds_read_b64_tr_b16 v[46:47], v9 offset:20992
 v_add_f32 v15, v15, v18
 v_exp_f32 v17, v73
 v_mfma_f32_16x16x32_bf16 v[92:95], v[244:247], v[140:143], v[92:95]
 ds_read_b64_tr_b16 v[240:241], v12 offset:16896
 v_cvt_pk_bf16_f32 v99, v18, v19
 v_add_f32 v15, v15, v19
 s_waitcnt lgkmcnt(5)
 v_mfma_f32_16x16x32_bf16 v[144:147], v[24:27], v[104:107], v[144:147]
 ds_read_b64_tr_b16 v[242:243], v12 offset:20992
 v_exp_f32 v18, v74
 v_add_f32 v57, v16, v17
 v_mfma_f32_16x16x32_bf16 v[148:151], v[24:27], v[108:111], v[148:151]
 ds_read_b64_tr_b16 v[244:245], v13 offset:16896
 v_exp_f32 v19, v75
 v_cvt_pk_bf16_f32 v100, v16, v17
 v_mfma_f32_16x16x32_bf16 v[152:155], v[28:31], v[104:107], v[152:155]
 ds_read_b64_tr_b16 v[246:247], v13 offset:20992
 v_exp_f32 v16, v76
 v_add_f32 v57, v57, v18
 v_mfma_f32_16x16x32_bf16 v[156:159], v[28:31], v[108:111], v[156:159]
 v_exp_f32 v17, v77
 v_cvt_pk_bf16_f32 v101, v18, v19
 v_mfma_f32_16x16x32_bf16 v[160:163], v[32:35], v[104:107], v[160:163]
 v_add_f32 v57, v57, v19
 v_exp_f32 v18, v78
 v_add_f32 v57, v57, v16
 v_mfma_f32_16x16x32_bf16 v[164:167], v[32:35], v[108:111], v[164:167]
 v_exp_f32 v19, v79
 v_cvt_pk_bf16_f32 v102, v16, v17
 v_mfma_f32_16x16x32_bf16 v[168:171], v[36:39], v[104:107], v[168:171]
 v_add_f32 v57, v57, v17
 v_add_f32 v57, v57, v18
 v_cvt_pk_bf16_f32 v103, v18, v19
 v_mfma_f32_16x16x32_bf16 v[172:175], v[36:39], v[108:111], v[172:175]
 s_waitcnt vmcnt(8) lgkmcnt(0)
 s_barrier
 ds_read_b64_tr_b16 v[24:25], v8 offset:24576
 ds_read_b64_tr_b16 v[28:29], v9 offset:24576
 ds_read_b64_tr_b16 v[26:27], v8 offset:28672
 ds_read_b64_tr_b16 v[32:33], v12 offset:24576
 ds_read_b64_tr_b16 v[30:31], v9 offset:28672
 v_add_u32 v252, 0, v250
 v_add_u32 v253, 8192, v250
 v_mfma_f32_16x16x32_bf16 v[176:179], v[40:43], v[104:107], v[176:179]
 ds_read_b64_tr_b16 v[34:35], v12 offset:28672
 v_add_u32 v254, 16384, v250
 v_add_u32 v255, 24576, v250
 s_add_u32 m0, s50, 16384
 s_add_u32 s46, s66, s81
 buffer_load_dwordx4 v252, s[28:31], s46 offen offset:0 lds
 v_mfma_f32_16x16x32_bf16 v[180:183], v[40:43], v[108:111], v[180:183]
 ds_read_b64_tr_b16 v[36:37], v13 offset:24576
 v_mfma_f32_16x16x32_bf16 v[184:187], v[44:47], v[104:107], v[184:187]
 ds_read_b64_tr_b16 v[38:39], v13 offset:28672
 buffer_load_dwordx4 v253, s[28:31], s46 offen offset:1024 lds
 v_mfma_f32_16x16x32_bf16 v[188:191], v[44:47], v[108:111], v[188:191]
 ds_read_b64_tr_b16 v[40:41], v8 offset:25088
 buffer_load_dwordx4 v254, s[28:31], s46 offen offset:2048 lds
 v_mfma_f32_16x16x32_bf16 v[192:195], v[240:243], v[104:107], v[192:195]
 ds_read_b64_tr_b16 v[42:43], v8 offset:29184
 v_add_f32 v57, v57, v19
 v_mfma_f32_16x16x32_bf16 v[196:199], v[240:243], v[108:111], v[196:199]
 ds_read_b64_tr_b16 v[44:45], v9 offset:25088
 buffer_load_dwordx4 v255, s[28:31], s46 offen offset:3072 lds
 v_mfma_f32_16x16x32_bf16 v[200:203], v[244:247], v[104:107], v[200:203]
 ds_read_b64_tr_b16 v[46:47], v9 offset:29184
 v_max_f32 v58, v15, v57
 v_cmp_lt_f32 vcc, s49, v58
 v_mfma_f32_16x16x32_bf16 v[204:207], v[244:247], v[108:111], v[204:207]
 s_cbranch_vccnz L_stub_14_13
L_back_14_13:
 v_add_f32 v14, v14, v15
 v_add_f32 v56, v56, v57
 ds_read_b64_tr_b16 v[240:241], v12 offset:25088
 v_exp_f32 v16, v80
 s_waitcnt lgkmcnt(5)
 v_mfma_f32_16x16x32_bf16 v[144:147], v[24:27], v[96:99], v[144:147]
 ds_read_b64_tr_b16 v[242:243], v12 offset:29184
 v_exp_f32 v17, v81
 v_exp_f32 v18, v82
 v_add_f32 v15, v16, v17
 v_mfma_f32_16x16x32_bf16 v[148:151], v[24:27], v[100:103], v[148:151]
 ds_read_b64_tr_b16 v[244:245], v13 offset:25088
 v_exp_f32 v19, v83
 v_cvt_pk_bf16_f32 v104, v16, v17
 v_mfma_f32_16x16x32_bf16 v[152:155], v[28:31], v[96:99], v[152:155]
 ds_read_b64_tr_b16 v[246:247], v13 offset:29184
 v_exp_f32 v16, v84
 v_add_f32 v15, v15, v18
 v_mfma_f32_16x16x32_bf16 v[156:159], v[28:31], v[100:103], v[156:159]
 ds_read_b64_tr_b16 v[24:25], v8 offset:32768
 v_exp_f32 v17, v85
 v_cvt_pk_bf16_f32 v105, v18, v19
 v_mfma_f32_16x16x32_bf16 v[160:163], v[32:35], v[96:99], v[160:163]
 ds_read_b64_tr_b16 v[26:27], v8 offset:36864
 v_add_f32 v15, v15, v19
 v_exp_f32 v18, v86
 v_add_f32 v15, v15, v16
 v_mfma_f32_16x16x32_bf16 v[164:167], v[32:35], v[100:103], v[164:167]
 ds_read_b64_tr_b16 v[28:29], v9 offset:32768
 v_exp_f32 v19, v87
 v_cvt_pk_bf16_f32 v106, v16, v17
 v_mfma_f32_16x16x32_bf16 v[168:171], v[36:39], v[96:99], v[168:171]
 ds_read_b64_tr_b16 v[30:31], v9 offset:36864
 v_add_f32 v15, v15, v17
 v_exp_f32 v16, v88
 v_add_f32 v15, v15, v18
 v_mfma_f32_16x16x32_bf16 v[172:175], v[36:39], v[100:103], v[172:175]
 ds_read_b64_tr_b16 v[32:33], v12 offset:32768
 v_exp_f32 v17, v89
 v_cvt_pk_bf16_f32 v107, v18, v19
 s_waitcnt lgkmcnt(5)
 v_mfma_f32_16x16x32_bf16 v[176:179], v[40:43], v[96:99], v[176:179]
 ds_read_b64_tr_b16 v[34:35], v12 offset:36864
 v_add_f32 v15, v15, v19
 v_exp_f32 v18, v90
 v_add_f32 v57, v16, v17
 v_mfma_f32_16x16x32_bf16 v[180:183], v[40:43], v[100:103], v[180:183]
 ds_read_b64_tr_b16 v[36:37], v13 offset:32768
 v_exp_f32 v19, v91
 v_cvt_pk_bf16_f32 v108, v16, v17
 v_mfma_f32_16x16x32_bf16 v[184:187], v[44:47], v[96:99], v[184:187]
 ds_read_b64_tr_b16 v[38:39], v13 offset:36864
 v_exp_f32 v16, v92
 v_add_f32 v57, v57, v18
 v_exp_f32 v17, v93
 v_mfma_f32_16x16x32_bf16 v[188:191], v[44:47], v[100:103], v[188:191]
 ds_read_b64_tr_b16 v[40:41], v8 offset:33280
 v_cvt_pk_bf16_f32 v109, v18, v19
 v_add_f32 v57, v57, v19
 v_exp_f32 v18, v94
 v_mfma_f32_16x16x32_bf16 v[192:195], v[240:243], v[96:99], v[192:195]
 ds_read_b64_tr_b16 v[42:43], v8 offset:37376
 v_add_f32 v57, v57, v16
 v_exp_f32 v19, v95
 v_mfma_f32_16x16x32_bf16 v[196:199], v[240:243], v[100:103], v[196:199]
 ds_read_b64_tr_b16 v[44:45], v9 offset:33280
 v_cvt_pk_bf16_f32 v110, v16, v17
 v_add_f32 v57, v57, v17
 v_add_f32 v57, v57, v18
 v_mfma_f32_16x16x32_bf16 v[200:203], v[244:247], v[96:99], v[200:203]
 ds_read_b64_tr_b16 v[46:47], v9 offset:37376
 v_cvt_pk_bf16_f32 v111, v18, v19
 v_add_f32 v57, v57, v19
 v_max_f32 v58, v15, v57
 v_cmp_lt_f32 vcc, s49, v58
 v_mfma_f32_16x16x32_bf16 v[204:207], v[244:247], v[100:103], v[204:207]
 s_cbranch_vccnz L_stub_15_14
L_back_15_14:
 v_add_f32 v14, v14, v15
 v_add_f32 v56, v56, v57
 ds_read_b64_tr_b16 v[240:241], v12 offset:33280
 s_waitcnt lgkmcnt(5)
 v_mfma_f32_16x16x32_bf16 v[144:147], v[24:27], v[104:107], v[144:147]
 ds_read_b64_tr_b16 v[242:243], v12 offset:37376
 v_mov_b32 v20, v14
 v_mov_b32 v11, v56
 v_mfma_f32_16x16x32_bf16 v[148:151], v[24:27], v[108:111], v[148:151]
 ds_read_b64_tr_b16 v[244:245], v13 offset:33280
 ds_read_b64_tr_b16 v[246:247], v13 offset:37376
 v_mfma_f32_16x16x32_bf16 v[152:155], v[28:31], v[104:107], v[152:155]
 v_permlane16_swap_b32 v20, v11
 v_add_f32 v20, v20, v11
 v_mfma_f32_16x16x32_bf16 v[156:159], v[28:31], v[108:111], v[156:159]
 v_mov_b32 v21, v20
 v_mfma_f32_16x16x32_bf16 v[160:163], v[32:35], v[104:107], v[160:163]
 s_nop 0
 v_permlane32_swap_b32 v20, v21
 v_mfma_f32_16x16x32_bf16 v[164:167], v[32:35], v[108:111], v[164:167]
 v_add_f32 v20, v20, v21
 v_mfma_f32_16x16x32_bf16 v[168:171], v[36:39], v[104:107], v[168:171]
 v_rcp_f32 v20, v20
 v_mfma_f32_16x16x32_bf16 v[172:175], v[36:39], v[108:111], v[172:175]
 s_waitcnt vmcnt(8) lgkmcnt(0)
 s_barrier
 v_add_u32 v8, v8, v10
 v_add_u32 v9, v9, v10
 v_add_u32 v12, v12, v10
 v_add_u32 v13, v13, v10
 v_add_u32 v8, 4294959104, v8
 ds_read_b64_tr_b16 v[24:25], v8 offset:0
 v_add_u32 v9, 4294959104, v9
 ds_read_b64_tr_b16 v[28:29], v9 offset:0
 ds_read_b64_tr_b16 v[26:27], v8 offset:2048
 v_add_u32 v12, 4294959104, v12
 ds_read_b64_tr_b16 v[32:33], v12 offset:0
 ds_read_b64_tr_b16 v[30:31], v9 offset:2048
 s_add_u32 m0, s50, 32768
 v_mfma_f32_16x16x32_bf16 v[176:179], v[40:43], v[104:107], v[176:179]
 ds_read_b64_tr_b16 v[34:35], v12 offset:2048
 s_add_u32 s46, s66, s82
 buffer_load_dwordx4 v252, s[28:31], s46 offen offset:0 lds
 v_mov_b32 v11, v20
 s_nop 1
 v_permlane16_swap_b32 v20, v11
 v_mfma_f32_16x16x32_bf16 v[180:183], v[40:43], v[108:111], v[180:183]
 v_add_u32 v13, 4294959104, v13
 ds_read_b64_tr_b16 v[36:37], v13 offset:0
 buffer_load_dwordx4 v253, s[28:31], s46 offen offset:1024 lds
 v_mul_f32 v144, v20, v144
 v_mul_f32 v145, v20, v145
 v_mfma_f32_16x16x32_bf16 v[184:187], v[44:47], v[104:107], v[184:187]
 ds_read_b64_tr_b16 v[38:39], v13 offset:2048
 v_mul_f32 v146, v20, v146
 v_mul_f32 v147, v20, v147
 v_cvt_pk_bf16_f32 v64, v144, v145
 v_cvt_pk_bf16_f32 v65, v146, v147
 v_mul_f32 v152, v20, v152
 v_mul_f32 v153, v20, v153
 v_mfma_f32_16x16x32_bf16 v[188:191], v[44:47], v[108:111], v[188:191]
 ds_read_b64_tr_b16 v[40:41], v8 offset:4096
 buffer_load_dwordx4 v254, s[28:31], s46 offen offset:2048 lds
 v_mul_f32 v154, v20, v154
 v_mul_f32 v155, v20, v155
 v_mfma_f32_16x16x32_bf16 v[192:195], v[240:243], v[104:107], v[192:195]
 ds_read_b64_tr_b16 v[42:43], v8 offset:6144
 v_cvt_pk_bf16_f32 v66, v152, v153
 v_cvt_pk_bf16_f32 v67, v154, v155
 v_mul_f32 v148, v11, v148
 v_mul_f32 v149, v11, v149
 v_mul_f32 v150, v11, v150
 v_mul_f32 v151, v11, v151
 v_mfma_f32_16x16x32_bf16 v[196:199], v[240:243], v[108:111], v[196:199]
 ds_read_b64_tr_b16 v[44:45], v9 offset:4096
 buffer_load_dwordx4 v255, s[28:31], s46 offen offset:3072 lds
 v_cvt_pk_bf16_f32 v68, v148, v149
 v_cvt_pk_bf16_f32 v69, v150, v151
 v_mfma_f32_16x16x32_bf16 v[200:203], v[244:247], v[104:107], v[200:203]
 ds_read_b64_tr_b16 v[46:47], v9 offset:6144
 v_mul_f32 v156, v11, v156
 v_mul_f32 v157, v11, v157
 v_mul_f32 v158, v11, v158
 v_mul_f32 v159, v11, v159
 v_cvt_pk_bf16_f32 v70, v156, v157
 v_cvt_pk_bf16_f32 v71, v158, v159
 v_mfma_f32_16x16x32_bf16 v[204:207], v[244:247], v[108:111], v[204:207]
 ds_read_b64_tr_b16 v[240:241], v12 offset:4096
 v_mov_b32 v252, v251
 v_xor_b32 v253, s67, v251
 v_xor_b32 v254, s100, v251
 v_xor_b32 v255, s100, v253
 s_add_u32 m0, s50, 65536
 s_add_u32 s46, s90, 8192
 s_and_b32 s46, s46, 0x1ffff
 s_add_u32 s46, s46, s91
 s_waitcnt lgkmcnt(5)
 v_mfma_f32_16x16x32_bf16 a[0:3], v[24:27], v[64:67], a[0:3]
 ds_read_b64_tr_b16 v[242:243], v12 offset:6144
 buffer_load_dwordx4 v252, s[96:99], s46 offen offset:0 nt lds
 v_mul_f32 v160, v20, v160
 v_mul_f32 v161, v20, v161
 v_mul_f32 v162, v20, v162
 v_mul_f32 v163, v20, v163
 v_cvt_pk_bf16_f32 v72, v160, v161
 v_cvt_pk_bf16_f32 v73, v162, v163
 v_mfma_f32_16x16x32_bf16 a[4:7], v[24:27], v[68:71], a[4:7]
 ds_read_b64_tr_b16 v[244:245], v13 offset:4096
 buffer_load_dwordx4 v253, s[96:99], s46 offen offset:1024 nt lds
 v_mul_f32 v168, v20, v168
 v_mfma_f32_16x16x32_bf16 a[8:11], v[28:31], v[64:67], a[8:11]
 ds_read_b64_tr_b16 v[246:247], v13 offset:6144
 v_mul_f32 v169, v20, v169
 v_mul_f32 v170, v20, v170
 v_mul_f32 v171, v20, v171
 v_cvt_pk_bf16_f32 v74, v168, v169
 v_cvt_pk_bf16_f32 v75, v170, v171
 v_mfma_f32_16x16x32_bf16 a[12:15], v[28:31], v[68:71], a[12:15]
 ds_read_b64_tr_b16 v[24:25], v8 offset:8192
 buffer_load_dwordx4 v254, s[96:99], s46 offen offset:2048 nt lds
 v_mul_f32 v164, v11, v164
 v_mfma_f32_16x16x32_bf16 a[16:19], v[32:35], v[64:67], a[16:19]
 ds_read_b64_tr_b16 v[26:27], v8 offset:10240
 v_mul_f32 v165, v11, v165
 v_mul_f32 v166, v11, v166
 v_mul_f32 v167, v11, v167
 v_cvt_pk_bf16_f32 v76, v164, v165
 v_cvt_pk_bf16_f32 v77, v166, v167
 v_mfma_f32_16x16x32_bf16 a[20:23], v[32:35], v[68:71], a[20:23]
 ds_read_b64_tr_b16 v[28:29], v9 offset:8192
 buffer_load_dwordx4 v255, s[96:99], s46 offen offset:3072 nt lds
 v_mul_f32 v172, v11, v172
 v_mfma_f32_16x16x32_bf16 a[24:27], v[36:39], v[64:67], a[24:27]
 ds_read_b64_tr_b16 v[30:31], v9 offset:10240
 v_mul_f32 v173, v11, v173
 v_mul_f32 v174, v11, v174
 v_mul_f32 v175, v11, v175
 v_cvt_pk_bf16_f32 v78, v172, v173
 v_cvt_pk_bf16_f32 v79, v174, v175
 v_mfma_f32_16x16x32_bf16 a[28:31], v[36:39], v[68:71], a[28:31]
 ds_read_b64_tr_b16 v[32:33], v12 offset:8192
 v_mul_f32 v176, v20, v176
 v_mul_f32 v177, v20, v177
 s_waitcnt lgkmcnt(5)
 v_mfma_f32_16x16x32_bf16 a[0:3], v[40:43], v[72:75], a[0:3]
 ds_read_b64_tr_b16 v[34:35], v12 offset:10240
 v_mul_f32 v178, v20, v178
 v_mul_f32 v179, v20, v179
 v_cvt_pk_bf16_f32 v80, v176, v177
 v_cvt_pk_bf16_f32 v81, v178, v179
 v_mfma_f32_16x16x32_bf16 a[4:7], v[40:43], v[76:79], a[4:7]
 ds_read_b64_tr_b16 v[36:37], v13 offset:8192
 v_mul_f32 v184, v20, v184
 v_mul_f32 v185, v20, v185
 v_mul_f32 v186, v20, v186
 v_mfma_f32_16x16x32_bf16 a[8:11], v[44:47], v[72:75], a[8:11]
 ds_read_b64_tr_b16 v[38:39], v13 offset:10240
 v_mul_f32 v187, v20, v187
 v_cvt_pk_bf16_f32 v82, v184, v185
 v_cvt_pk_bf16_f32 v83, v186, v187
 v_mfma_f32_16x16x32_bf16 a[12:15], v[44:47], v[76:79], a[12:15]
 ds_read_b64_tr_b16 v[40:41], v8 offset:12288
 v_mul_f32 v180, v11, v180
 v_mul_f32 v181, v11, v181
 v_mul_f32 v182, v11, v182
 v_mfma_f32_16x16x32_bf16 a[16:19], v[240:243], v[72:75], a[16:19]
 ds_read_b64_tr_b16 v[42:43], v8 offset:14336
 v_mul_f32 v183, v11, v183
 v_cvt_pk_bf16_f32 v84, v180, v181
 v_cvt_pk_bf16_f32 v85, v182, v183
 v_mfma_f32_16x16x32_bf16 a[20:23], v[240:243], v[76:79], a[20:23]
 ds_read_b64_tr_b16 v[44:45], v9 offset:12288
 v_mul_f32 v188, v11, v188
 v_mul_f32 v189, v11, v189
 v_mul_f32 v190, v11, v190
 v_mfma_f32_16x16x32_bf16 a[24:27], v[244:247], v[72:75], a[24:27]
 ds_read_b64_tr_b16 v[46:47], v9 offset:14336
 v_mul_f32 v191, v11, v191
 v_cvt_pk_bf16_f32 v86, v188, v189
 v_cvt_pk_bf16_f32 v87, v190, v191
 v_mfma_f32_16x16x32_bf16 a[28:31], v[244:247], v[76:79], a[28:31]
 ds_read_b64_tr_b16 v[240:241], v12 offset:12288
 v_mul_f32 v192, v20, v192
 v_mul_f32 v193, v20, v193
 s_waitcnt lgkmcnt(5)
 v_mfma_f32_16x16x32_bf16 a[0:3], v[24:27], v[80:83], a[0:3]
 ds_read_b64_tr_b16 v[242:243], v12 offset:14336
 v_mul_f32 v194, v20, v194
 v_mul_f32 v195, v20, v195
 v_cvt_pk_bf16_f32 v88, v192, v193
 v_cvt_pk_bf16_f32 v89, v194, v195
 v_mfma_f32_16x16x32_bf16 a[4:7], v[24:27], v[84:87], a[4:7]
 ds_read_b64_tr_b16 v[244:245], v13 offset:12288
 v_mul_f32 v200, v20, v200
 v_mul_f32 v201, v20, v201
 v_mul_f32 v202, v20, v202
 v_mfma_f32_16x16x32_bf16 a[8:11], v[28:31], v[80:83], a[8:11]
 ds_read_b64_tr_b16 v[246:247], v13 offset:14336
 v_mul_f32 v203, v20, v203
 v_cvt_pk_bf16_f32 v90, v200, v201
 v_cvt_pk_bf16_f32 v91, v202, v203
 v_mfma_f32_16x16x32_bf16 a[12:15], v[28:31], v[84:87], a[12:15]
 v_mul_f32 v196, v11, v196
 v_mul_f32 v197, v11, v197
 v_mul_f32 v198, v11, v198
 v_mfma_f32_16x16x32_bf16 a[16:19], v[32:35], v[80:83], a[16:19]
 v_mul_f32 v199, v11, v199
 v_cvt_pk_bf16_f32 v92, v196, v197
 v_cvt_pk_bf16_f32 v93, v198, v199
 v_mfma_f32_16x16x32_bf16 a[20:23], v[32:35], v[84:87], a[20:23]
 v_mul_f32 v204, v11, v204
 v_mul_f32 v205, v11, v205
 v_mul_f32 v206, v11, v206
 v_mfma_f32_16x16x32_bf16 a[24:27], v[36:39], v[80:83], a[24:27]
 v_mul_f32 v207, v11, v207
 v_cvt_pk_bf16_f32 v94, v204, v205
 v_cvt_pk_bf16_f32 v95, v206, v207
 v_mfma_f32_16x16x32_bf16 a[28:31], v[36:39], v[84:87], a[28:31]
 s_waitcnt vmcnt(8) lgkmcnt(0)
 s_barrier
 ds_read_b64_tr_b16 v[24:25], v8 offset:16384
 ds_read_b64_tr_b16 v[28:29], v9 offset:16384
 ds_read_b64_tr_b16 v[26:27], v8 offset:18432
 ds_read_b64_tr_b16 v[32:33], v12 offset:16384
 ds_read_b64_tr_b16 v[30:31], v9 offset:18432
 v_add_u32 v252, 0, v250
 v_add_u32 v253, 8192, v250
 v_mfma_f32_16x16x32_bf16 a[0:3], v[40:43], v[88:91], a[0:3]
 ds_read_b64_tr_b16 v[34:35], v12 offset:18432
 v_add_u32 v254, 16384, v250
 v_add_u32 v255, 24576, v250
 s_add_u32 m0, s50, 0
 s_add_u32 s46, s66, s83
 buffer_load_dwordx4 v252, s[28:31], s46 offen offset:0 lds
 v_mfma_f32_16x16x32_bf16 a[4:7], v[40:43], v[92:95], a[4:7]
 ds_read_b64_tr_b16 v[36:37], v13 offset:16384
 v_mfma_f32_16x16x32_bf16 a[8:11], v[44:47], v[88:91], a[8:11]
 ds_read_b64_tr_b16 v[38:39], v13 offset:18432
 buffer_load_dwordx4 v253, s[28:31], s46 offen offset:1024 lds
 v_mfma_f32_16x16x32_bf16 a[12:15], v[44:47], v[92:95], a[12:15]
 ds_read_b64_tr_b16 v[40:41], v8 offset:20480
 v_mfma_f32_16x16x32_bf16 a[16:19], v[240:243], v[88:91], a[16:19]
 ds_read_b64_tr_b16 v[42:43], v8 offset:22528
 buffer_load_dwordx4 v254, s[28:31], s46 offen offset:2048 lds
 v_mfma_f32_16x16x32_bf16 a[20:23], v[240:243], v[92:95], a[20:23]
 ds_read_b64_tr_b16 v[44:45], v9 offset:20480
 v_mfma_f32_16x16x32_bf16 a[24:27], v[244:247], v[88:91], a[24:27]
 ds_read_b64_tr_b16 v[46:47], v9 offset:22528
 buffer_load_dwordx4 v255, s[28:31], s46 offen offset:3072 lds
 v_mfma_f32_16x16x32_bf16 a[28:31], v[244:247], v[92:95], a[28:31]
 s_cmp_lg_u32 s47, 3
 s_cbranch_scc1 L_more
L_last:
 ds_read_b64_tr_b16 v[240:241], v12 offset:20480
 s_waitcnt lgkmcnt(5)
 v_mfma_f32_16x16x32_bf16 a[32:35], v[24:27], v[64:67], a[32:35]
 ds_read_b64_tr_b16 v[242:243], v12 offset:22528
 v_mfma_f32_16x16x32_bf16 a[36:39], v[24:27], v[68:71], a[36:39]
 ds_read_b64_tr_b16 v[244:245], v13 offset:20480
 v_mfma_f32_16x16x32_bf16 a[40:43], v[28:31], v[64:67], a[40:43]
 ds_read_b64_tr_b16 v[246:247], v13 offset:22528
 v_mfma_f32_16x16x32_bf16 a[44:47], v[28:31], v[68:71], a[44:47]
 ds_read_b64_tr_b16 v[24:25], v8 offset:24576
 v_mfma_f32_16x16x32_bf16 a[48:51], v[32:35], v[64:67], a[48:51]
 ds_read_b64_tr_b16 v[26:27], v8 offset:26624
 v_and_b32 v1, 7, v0
 v_lshlrev_b32 v1, 2, v1
 s_lshl_b32 s64, 1, s59
 s_mov_b32 s65, 0
 v_mfma_f32_16x16x32_bf16 a[52:55], v[32:35], v[68:71], a[52:55]
 ds_read_b64_tr_b16 v[28:29], v9 offset:24576
 s_mul_i32 s56, s80, 768
 s_add_u32 s56, s56, s51
 v_mfma_f32_16x16x32_bf16 a[56:59], v[36:39], v[64:67], a[56:59]
 ds_read_b64_tr_b16 v[30:31], v9 offset:26624
 v_accvgpr_read_b32 v112, a0
 v_accvgpr_read_b32 v113, a1
 v_mfma_f32_16x16x32_bf16 a[60:63], v[36:39], v[68:71], a[60:63]
 ds_read_b64_tr_b16 v[32:33], v12 offset:24576
 v_accvgpr_read_b32 v114, a2
 s_waitcnt lgkmcnt(5)
 v_mfma_f32_16x16x32_bf16 a[32:35], v[40:43], v[72:75], a[32:35]
 ds_read_b64_tr_b16 v[34:35], v12 offset:26624
 v_accvgpr_read_b32 v115, a3
 v_accvgpr_read_b32 v116, a8
 v_accvgpr_read_b32 v117, a9
 v_mfma_f32_16x16x32_bf16 a[36:39], v[40:43], v[76:79], a[36:39]
 ds_read_b64_tr_b16 v[36:37], v13 offset:24576
 v_accvgpr_read_b32 v118, a10
 v_accvgpr_read_b32 v119, a11
 v_mfma_f32_16x16x32_bf16 a[40:43], v[44:47], v[72:75], a[40:43]
 ds_read_b64_tr_b16 v[38:39], v13 offset:26624
 v_cvt_pk_bf16_f32 v96, v112, v113
 v_cvt_pk_bf16_f32 v97, v114, v115
 v_mfma_f32_16x16x32_bf16 a[44:47], v[44:47], v[76:79], a[44:47]
 ds_read_b64_tr_b16 v[40:41], v8 offset:28672
 v_cvt_pk_bf16_f32 v98, v116, v117
 v_cvt_pk_bf16_f32 v99, v118, v119
 v_mfma_f32_16x16x32_bf16 a[48:51], v[240:243], v[72:75], a[48:51]
 ds_read_b64_tr_b16 v[42:43], v8 offset:30720
 buffer_store_dwordx4 v[96:99], v22, s[36:39], s56 offen offset:0 sc1
 v_accvgpr_read_b32 v120, a4
 v_accvgpr_read_b32 v121, a5
 v_mfma_f32_16x16x32_bf16 a[52:55], v[240:243], v[76:79], a[52:55]
 ds_read_b64_tr_b16 v[44:45], v9 offset:28672
 v_accvgpr_read_b32 v122, a6
 v_accvgpr_read_b32 v123, a7
 v_mfma_f32_16x16x32_bf16 a[56:59], v[244:247], v[72:75], a[56:59]
 ds_read_b64_tr_b16 v[46:47], v9 offset:30720
 v_accvgpr_read_b32 v124, a12
 v_accvgpr_read_b32 v125, a13
 v_mfma_f32_16x16x32_bf16 a[60:63], v[244:247], v[76:79], a[60:63]
 ds_read_b64_tr_b16 v[240:241], v12 offset:28672
 v_accvgpr_read_b32 v126, a14
 s_waitcnt lgkmcnt(5)
 v_mfma_f32_16x16x32_bf16 a[32:35], v[24:27], v[80:83], a[32:35]
 ds_read_b64_tr_b16 v[242:243], v12 offset:30720
 v_accvgpr_read_b32 v127, a15
 v_cvt_pk_bf16_f32 v100, v120, v121
 v_cvt_pk_bf16_f32 v101, v122, v123
 v_mfma_f32_16x16x32_bf16 a[36:39], v[24:27], v[84:87], a[36:39]
 ds_read_b64_tr_b16 v[244:245], v13 offset:28672
 v_cvt_pk_bf16_f32 v102, v124, v125
 v_cvt_pk_bf16_f32 v103, v126, v127
 v_mfma_f32_16x16x32_bf16 a[40:43], v[28:31], v[80:83], a[40:43]
 ds_read_b64_tr_b16 v[246:247], v13 offset:30720
 buffer_store_dwordx4 v[100:103], v22, s[36:39], s56 offen offset:1024 sc1
 v_accvgpr_read_b32 v128, a16
 v_mfma_f32_16x16x32_bf16 a[44:47], v[28:31], v[84:87], a[44:47]
 v_accvgpr_read_b32 v129, a17
 v_accvgpr_read_b32 v130, a18
 v_mfma_f32_16x16x32_bf16 a[48:51], v[32:35], v[80:83], a[48:51]
 v_accvgpr_read_b32 v131, a19
 v_accvgpr_read_b32 v132, a24
 v_mfma_f32_16x16x32_bf16 a[52:55], v[32:35], v[84:87], a[52:55]
 v_accvgpr_read_b32 v133, a25
 v_accvgpr_read_b32 v134, a26
 v_mfma_f32_16x16x32_bf16 a[56:59], v[36:39], v[80:83], a[56:59]
 v_accvgpr_read_b32 v135, a27
 v_cvt_pk_bf16_f32 v104, v128, v129
 v_mfma_f32_16x16x32_bf16 a[60:63], v[36:39], v[84:87], a[60:63]
 s_waitcnt vmcnt(10) lgkmcnt(0)
 s_barrier
 ds_read_b64_tr_b16 v[24:25], v8 offset:32768
 ds_read_b64_tr_b16 v[28:29], v9 offset:32768
 ds_read_b64_tr_b16 v[26:27], v8 offset:34816
 ds_read_b64_tr_b16 v[32:33], v12 offset:32768
 ds_read_b64_tr_b16 v[30:31], v9 offset:34816
 v_add_u32 v252, 0, v250
 v_add_u32 v253, 8192, v250
 v_add_u32 v254, 16384, v250
 v_add_u32 v255, 24576, v250
 s_add_u32 m0, s50, 16384
 s_add_u32 s46, s66, s84
 v_mfma_f32_16x16x32_bf16 a[32:35], v[40:43], v[88:91], a[32:35]
 ds_read_b64_tr_b16 v[34:35], v12 offset:34816
 buffer_load_dwordx4 v252, s[28:31], s46 offen offset:0 lds
 v_cvt_pk_bf16_f32 v105, v130, v131
 v_cvt_pk_bf16_f32 v106, v132, v133
 v_cvt_pk_bf16_f32 v107, v134, v135
 buffer_store_dwordx4 v[104:107], v22, s[36:39], s56 offen offset:2048 sc1
 v_accvgpr_read_b32 v136, a20
 v_mfma_f32_16x16x32_bf16 a[36:39], v[40:43], v[92:95], a[36:39]
 ds_read_b64_tr_b16 v[36:37], v13 offset:32768
 buffer_load_dwordx4 v253, s[28:31], s46 offen offset:1024 lds
 v_mfma_f32_16x16x32_bf16 a[40:43], v[44:47], v[88:91], a[40:43]
 ds_read_b64_tr_b16 v[38:39], v13 offset:34816
 v_accvgpr_read_b32 v137, a21
 v_accvgpr_read_b32 v138, a22
 v_accvgpr_read_b32 v139, a23
 v_accvgpr_read_b32 v140, a28
 v_mfma_f32_16x16x32_bf16 a[44:47], v[44:47], v[92:95], a[44:47]
 ds_read_b64_tr_b16 v[40:41], v8 offset:36864
 buffer_load_dwordx4 v254, s[28:31], s46 offen offset:2048 lds
 v_mfma_f32_16x16x32_bf16 a[48:51], v[240:243], v[88:91], a[48:51]
 ds_read_b64_tr_b16 v[42:43], v8 offset:38912
 v_accvgpr_read_b32 v141, a29
 v_accvgpr_read_b32 v142, a30
 v_accvgpr_read_b32 v143, a31
 v_cvt_pk_bf16_f32 v108, v136, v137
 v_mfma_f32_16x16x32_bf16 a[52:55], v[240:243], v[92:95], a[52:55]
 ds_read_b64_tr_b16 v[44:45], v9 offset:36864
 buffer_load_dwordx4 v255, s[28:31], s46 offen offset:3072 lds
 v_cvt_pk_bf16_f32 v109, v138, v139
 v_mfma_f32_16x16x32_bf16 a[56:59], v[244:247], v[88:91], a[56:59]
 ds_read_b64_tr_b16 v[46:47], v9 offset:38912
 v_cvt_pk_bf16_f32 v110, v140, v141
 v_cvt_pk_bf16_f32 v111, v142, v143
 buffer_store_dwordx4 v[108:111], v22, s[36:39], s56 offen offset:3072 sc1
 v_mfma_f32_16x16x32_bf16 a[60:63], v[244:247], v[92:95], a[60:63]
 ds_read_b64_tr_b16 v[240:241], v12 offset:36864
 s_waitcnt lgkmcnt(5)
 v_mfma_f32_16x16x32_bf16 a[64:67], v[24:27], v[64:67], a[64:67]
 ds_read_b64_tr_b16 v[242:243], v12 offset:38912
 v_mfma_f32_16x16x32_bf16 a[68:71], v[24:27], v[68:71], a[68:71]
 ds_read_b64_tr_b16 v[244:245], v13 offset:36864
 v_mfma_f32_16x16x32_bf16 a[72:75], v[28:31], v[64:67], a[72:75]
 ds_read_b64_tr_b16 v[246:247], v13 offset:38912
 v_mfma_f32_16x16x32_bf16 a[76:79], v[28:31], v[68:71], a[76:79]
 ds_read_b64_tr_b16 v[24:25], v8 offset:40960
 v_mfma_f32_16x16x32_bf16 a[80:83], v[32:35], v[64:67], a[80:83]
 ds_read_b64_tr_b16 v[26:27], v8 offset:43008
 v_mfma_f32_16x16x32_bf16 a[84:87], v[32:35], v[68:71], a[84:87]
 ds_read_b64_tr_b16 v[28:29], v9 offset:40960
 s_mul_i32 s56, s81, 768
 s_add_u32 s56, s56, s51
 v_mfma_f32_16x16x32_bf16 a[88:91], v[36:39], v[64:67], a[88:91]
 ds_read_b64_tr_b16 v[30:31], v9 offset:43008
 v_accvgpr_read_b32 v112, a32
 v_accvgpr_read_b32 v113, a33
 v_mfma_f32_16x16x32_bf16 a[92:95], v[36:39], v[68:71], a[92:95]
 ds_read_b64_tr_b16 v[32:33], v12 offset:40960
 v_accvgpr_read_b32 v114, a34
 s_waitcnt lgkmcnt(5)
 v_mfma_f32_16x16x32_bf16 a[64:67], v[40:43], v[72:75], a[64:67]
 ds_read_b64_tr_b16 v[34:35], v12 offset:43008
 v_accvgpr_read_b32 v115, a35
 v_accvgpr_read_b32 v116, a40
 v_accvgpr_read_b32 v117, a41
 v_mfma_f32_16x16x32_bf16 a[68:71], v[40:43], v[76:79], a[68:71]
 ds_read_b64_tr_b16 v[36:37], v13 offset:40960
 v_accvgpr_read_b32 v118, a42
 v_accvgpr_read_b32 v119, a43
 v_mfma_f32_16x16x32_bf16 a[72:75], v[44:47], v[72:75], a[72:75]
 ds_read_b64_tr_b16 v[38:39], v13 offset:43008
 v_cvt_pk_bf16_f32 v96, v112, v113
 v_cvt_pk_bf16_f32 v97, v114, v115
 v_mfma_f32_16x16x32_bf16 a[76:79], v[44:47], v[76:79], a[76:79]
 ds_read_b64_tr_b16 v[40:41], v8 offset:45056
 v_cvt_pk_bf16_f32 v98, v116, v117
 v_cvt_pk_bf16_f32 v99, v118, v119
 v_mfma_f32_16x16x32_bf16 a[80:83], v[240:243], v[72:75], a[80:83]
 ds_read_b64_tr_b16 v[42:43], v8 offset:47104
 buffer_store_dwordx4 v[96:99], v22, s[36:39], s56 offen offset:0 sc1
 v_accvgpr_read_b32 v120, a36
 v_accvgpr_read_b32 v121, a37
 v_mfma_f32_16x16x32_bf16 a[84:87], v[240:243], v[76:79], a[84:87]
 ds_read_b64_tr_b16 v[44:45], v9 offset:45056
 v_accvgpr_read_b32 v122, a38
 v_accvgpr_read_b32 v123, a39
 v_mfma_f32_16x16x32_bf16 a[88:91], v[244:247], v[72:75], a[88:91]
 ds_read_b64_tr_b16 v[46:47], v9 offset:47104
 v_accvgpr_read_b32 v124, a44
 v_accvgpr_read_b32 v125, a45
 v_mfma_f32_16x16x32_bf16 a[92:95], v[244:247], v[76:79], a[92:95]
 ds_read_b64_tr_b16 v[240:241], v12 offset:45056
 v_accvgpr_read_b32 v126, a46
 s_waitcnt lgkmcnt(5)
 v_mfma_f32_16x16x32_bf16 a[64:67], v[24:27], v[80:83], a[64:67]
 ds_read_b64_tr_b16 v[242:243], v12 offset:47104
 v_accvgpr_read_b32 v127, a47
 v_cvt_pk_bf16_f32 v100, v120, v121
 v_cvt_pk_bf16_f32 v101, v122, v123
 v_mfma_f32_16x16x32_bf16 a[68:71], v[24:27], v[84:87], a[68:71]
 ds_read_b64_tr_b16 v[244:245], v13 offset:45056
 v_cvt_pk_bf16_f32 v102, v124, v125
 v_cvt_pk_bf16_f32 v103, v126, v127
 v_mfma_f32_16x16x32_bf16 a[72:75], v[28:31], v[80:83], a[72:75]
 ds_read_b64_tr_b16 v[246:247], v13 offset:47104
 buffer_store_dwordx4 v[100:103], v22, s[36:39], s56 offen offset:1024 sc1
 v_accvgpr_read_b32 v128, a48
 v_mfma_f32_16x16x32_bf16 a[76:79], v[28:31], v[84:87], a[76:79]
 v_accvgpr_read_b32 v129, a49
 v_accvgpr_read_b32 v130, a50
 v_mfma_f32_16x16x32_bf16 a[80:83], v[32:35], v[80:83], a[80:83]
 v_accvgpr_read_b32 v131, a51
 v_accvgpr_read_b32 v132, a56
 v_mfma_f32_16x16x32_bf16 a[84:87], v[32:35], v[84:87], a[84:87]
 v_accvgpr_read_b32 v133, a57
 v_accvgpr_read_b32 v134, a58
 v_mfma_f32_16x16x32_bf16 a[88:91], v[36:39], v[80:83], a[88:91]
 v_accvgpr_read_b32 v135, a59
 v_cvt_pk_bf16_f32 v104, v128, v129
 v_mfma_f32_16x16x32_bf16 a[92:95], v[36:39], v[84:87], a[92:95]
 s_waitcnt vmcnt(10) lgkmcnt(0)
 s_barrier
 ds_read_b64_tr_b16 v[24:25], v8 offset:0
 ds_read_b64_tr_b16 v[28:29], v9 offset:0
 ds_read_b64_tr_b16 v[26:27], v8 offset:2048
 ds_read_b64_tr_b16 v[32:33], v12 offset:0
 ds_read_b64_tr_b16 v[30:31], v9 offset:2048
 v_add_u32 v252, 0, v250
 v_add_u32 v253, 8192, v250
 v_add_u32 v254, 16384, v250
 v_add_u32 v255, 24576, v250
 s_add_u32 m0, s50, 32768
 s_add_u32 s46, s66, s85
 v_mfma_f32_16x16x32_bf16 a[64:67], v[40:43], v[88:91], a[64:67]
 ds_read_b64_tr_b16 v[34:35], v12 offset:2048
 buffer_load_dwordx4 v252, s[28:31], s46 offen offset:0 lds
 v_cvt_pk_bf16_f32 v105, v130, v131
 v_cvt_pk_bf16_f32 v106, v132, v133
 v_cvt_pk_bf16_f32 v107, v134, v135
 buffer_store_dwordx4 v[104:107], v22, s[36:39], s56 offen offset:2048 sc1
 v_accvgpr_read_b32 v136, a52
 v_mfma_f32_16x16x32_bf16 a[68:71], v[40:43], v[92:95], a[68:71]
 ds_read_b64_tr_b16 v[36:37], v13 offset:0
 buffer_load_dwordx4 v253, s[28:31], s46 offen offset:1024 lds
 v_mfma_f32_16x16x32_bf16 a[72:75], v[44:47], v[88:91], a[72:75]
 ds_read_b64_tr_b16 v[38:39], v13 offset:2048
 v_accvgpr_read_b32 v137, a53
 v_accvgpr_read_b32 v138, a54
 v_accvgpr_read_b32 v139, a55
 v_accvgpr_read_b32 v140, a60
 v_mfma_f32_16x16x32_bf16 a[76:79], v[44:47], v[92:95], a[76:79]
 ds_read_b64_tr_b16 v[40:41], v8 offset:4096
 buffer_load_dwordx4 v254, s[28:31], s46 offen offset:2048 lds
 v_mfma_f32_16x16x32_bf16 a[80:83], v[240:243], v[88:91], a[80:83]
 ds_read_b64_tr_b16 v[42:43], v8 offset:6144
 v_accvgpr_read_b32 v141, a61
 v_accvgpr_read_b32 v142, a62
 v_accvgpr_read_b32 v143, a63
 v_cvt_pk_bf16_f32 v108, v136, v137
 v_mfma_f32_16x16x32_bf16 a[84:87], v[240:243], v[92:95], a[84:87]
 ds_read_b64_tr_b16 v[44:45], v9 offset:4096
 buffer_load_dwordx4 v255, s[28:31], s46 offen offset:3072 lds
 v_cvt_pk_bf16_f32 v109, v138, v139
 v_mfma_f32_16x16x32_bf16 a[88:91], v[244:247], v[88:91], a[88:91]
 ds_read_b64_tr_b16 v[46:47], v9 offset:6144
 v_cvt_pk_bf16_f32 v110, v140, v141
 v_cvt_pk_bf16_f32 v111, v142, v143
 buffer_store_dwordx4 v[108:111], v22, s[36:39], s56 offen offset:3072 sc1
 v_mfma_f32_16x16x32_bf16 a[92:95], v[244:247], v[92:95], a[92:95]
 ds_read_b64_tr_b16 v[240:241], v12 offset:4096
 s_waitcnt lgkmcnt(5)
 v_mfma_f32_16x16x32_bf16 a[96:99], v[24:27], v[64:67], a[96:99]
 ds_read_b64_tr_b16 v[242:243], v12 offset:6144
 v_mfma_f32_16x16x32_bf16 a[100:103], v[24:27], v[68:71], a[100:103]
 ds_read_b64_tr_b16 v[244:245], v13 offset:4096
 v_mfma_f32_16x16x32_bf16 a[104:107], v[28:31], v[64:67], a[104:107]
 ds_read_b64_tr_b16 v[246:247], v13 offset:6144
 v_mfma_f32_16x16x32_bf16 a[108:111], v[28:31], v[68:71], a[108:111]
 ds_read_b64_tr_b16 v[24:25], v8 offset:8192
 v_mfma_f32_16x16x32_bf16 a[112:115], v[32:35], v[64:67], a[112:115]
 ds_read_b64_tr_b16 v[26:27], v8 offset:10240
 v_mfma_f32_16x16x32_bf16 a[116:119], v[32:35], v[68:71], a[116:119]
 ds_read_b64_tr_b16 v[28:29], v9 offset:8192
 s_mul_i32 s56, s82, 768
 s_add_u32 s56, s56, s51
 v_mfma_f32_16x16x32_bf16 a[120:123], v[36:39], v[64:67], a[120:123]
 ds_read_b64_tr_b16 v[30:31], v9 offset:10240
 v_accvgpr_read_b32 v112, a64
 v_accvgpr_read_b32 v113, a65
 v_mfma_f32_16x16x32_bf16 a[124:127], v[36:39], v[68:71], a[124:127]
 ds_read_b64_tr_b16 v[32:33], v12 offset:8192
 v_accvgpr_read_b32 v114, a66
 s_waitcnt lgkmcnt(5)
 v_mfma_f32_16x16x32_bf16 a[96:99], v[40:43], v[72:75], a[96:99]
 ds_read_b64_tr_b16 v[34:35], v12 offset:10240
 v_accvgpr_read_b32 v115, a67
 v_accvgpr_read_b32 v116, a72
 v_accvgpr_read_b32 v117, a73
 v_mfma_f32_16x16x32_bf16 a[100:103], v[40:43], v[76:79], a[100:103]
 ds_read_b64_tr_b16 v[36:37], v13 offset:8192
 v_accvgpr_read_b32 v118, a74
 v_accvgpr_read_b32 v119, a75
 v_mfma_f32_16x16x32_bf16 a[104:107], v[44:47], v[72:75], a[104:107]
 ds_read_b64_tr_b16 v[38:39], v13 offset:10240
 v_cvt_pk_bf16_f32 v96, v112, v113
 v_cvt_pk_bf16_f32 v97, v114, v115
 v_mfma_f32_16x16x32_bf16 a[108:111], v[44:47], v[76:79], a[108:111]
 ds_read_b64_tr_b16 v[40:41], v8 offset:12288
 v_cvt_pk_bf16_f32 v98, v116, v117
 v_cvt_pk_bf16_f32 v99, v118, v119
 v_mfma_f32_16x16x32_bf16 a[112:115], v[240:243], v[72:75], a[112:115]
 ds_read_b64_tr_b16 v[42:43], v8 offset:14336
 buffer_store_dwordx4 v[96:99], v22, s[36:39], s56 offen offset:0 sc1
 v_accvgpr_read_b32 v120, a68
 v_accvgpr_read_b32 v121, a69
 v_mfma_f32_16x16x32_bf16 a[116:119], v[240:243], v[76:79], a[116:119]
 ds_read_b64_tr_b16 v[44:45], v9 offset:12288
 v_accvgpr_read_b32 v122, a70
 v_accvgpr_read_b32 v123, a71
 v_mfma_f32_16x16x32_bf16 a[120:123], v[244:247], v[72:75], a[120:123]
 ds_read_b64_tr_b16 v[46:47], v9 offset:14336
 v_accvgpr_read_b32 v124, a76
 v_accvgpr_read_b32 v125, a77
 v_mfma_f32_16x16x32_bf16 a[124:127], v[244:247], v[76:79], a[124:127]
 ds_read_b64_tr_b16 v[240:241], v12 offset:12288
 v_accvgpr_read_b32 v126, a78
 s_waitcnt lgkmcnt(5)
 v_mfma_f32_16x16x32_bf16 a[96:99], v[24:27], v[80:83], a[96:99]
 ds_read_b64_tr_b16 v[242:243], v12 offset:14336
 v_accvgpr_read_b32 v127, a79
 v_cvt_pk_bf16_f32 v100, v120, v121
 v_cvt_pk_bf16_f32 v101, v122, v123
 v_mfma_f32_16x16x32_bf16 a[100:103], v[24:27], v[84:87], a[100:103]
 ds_read_b64_tr_b16 v[244:245], v13 offset:12288
 v_cvt_pk_bf16_f32 v102, v124, v125
 v_cvt_pk_bf16_f32 v103, v126, v127
 v_mfma_f32_16x16x32_bf16 a[104:107], v[28:31], v[80:83], a[104:107]
 ds_read_b64_tr_b16 v[246:247], v13 offset:14336
 buffer_store_dwordx4 v[100:103], v22, s[36:39], s56 offen offset:1024 sc1
 v_accvgpr_read_b32 v128, a80
 v_mfma_f32_16x16x32_bf16 a[108:111], v[28:31], v[84:87], a[108:111]
 v_accvgpr_read_b32 v129, a81
 v_accvgpr_read_b32 v130, a82
 v_mfma_f32_16x16x32_bf16 a[112:115], v[32:35], v[80:83], a[112:115]
 v_accvgpr_read_b32 v131, a83
 v_accvgpr_read_b32 v132, a88
 v_mfma_f32_16x16x32_bf16 a[116:119], v[32:35], v[84:87], a[116:119]
 v_accvgpr_read_b32 v133, a89
 v_accvgpr_read_b32 v134, a90
 v_mfma_f32_16x16x32_bf16 a[120:123], v[36:39], v[80:83], a[120:123]
 v_accvgpr_read_b32 v135, a91
 v_cvt_pk_bf16_f32 v104, v128, v129
 v_mfma_f32_16x16x32_bf16 a[124:127], v[36:39], v[84:87], a[124:127]
 s_waitcnt vmcnt(11) lgkmcnt(0)
 s_barrier
 ds_read_b64_tr_b16 v[24:25], v8 offset:16384
 ds_read_b64_tr_b16 v[28:29], v9 offset:16384
 ds_read_b64_tr_b16 v[26:27], v8 offset:18432
 ds_read_b64_tr_b16 v[32:33], v12 offset:16384
 ds_read_b64_tr_b16 v[30:31], v9 offset:18432
 v_add_u32 v252, 0, v250
 v_add_u32 v253, 8192, v250
 v_add_u32 v254, 16384, v250
 v_add_u32 v255, 24576, v250
 s_add_u32 m0, s50, 0
 s_add_u32 s46, s66, s86
 v_mfma_f32_16x16x32_bf16 a[96:99], v[40:43], v[88:91], a[96:99]
 ds_read_b64_tr_b16 v[34:35], v12 offset:18432
 buffer_load_dwordx4 v252, s[28:31], s46 offen offset:0 lds
 v_cvt_pk_bf16_f32 v105, v130, v131
 v_cvt_pk_bf16_f32 v106, v132, v133
 v_cvt_pk_bf16_f32 v107, v134, v135
 buffer_store_dwordx4 v[104:107], v22, s[36:39], s56 offen offset:2048 sc1
 v_accvgpr_read_b32 v136, a84
 v_mfma_f32_16x16x32_bf16 a[100:103], v[40:43], v[92:95], a[100:103]
 ds_read_b64_tr_b16 v[36:37], v13 offset:16384
 buffer_load_dwordx4 v253, s[28:31], s46 offen offset:1024 lds
 v_mfma_f32_16x16x32_bf16 a[104:107], v[44:47], v[88:91], a[104:107]
 ds_read_b64_tr_b16 v[38:39], v13 offset:18432
 v_accvgpr_read_b32 v137, a85
 v_accvgpr_read_b32 v138, a86
 v_accvgpr_read_b32 v139, a87
 v_accvgpr_read_b32 v140, a92
 v_mfma_f32_16x16x32_bf16 a[108:111], v[44:47], v[92:95], a[108:111]
 ds_read_b64_tr_b16 v[40:41], v8 offset:20480
 buffer_load_dwordx4 v254, s[28:31], s46 offen offset:2048 lds
 v_mfma_f32_16x16x32_bf16 a[112:115], v[240:243], v[88:91], a[112:115]
 ds_read_b64_tr_b16 v[42:43], v8 offset:22528
 v_accvgpr_read_b32 v141, a93
 v_accvgpr_read_b32 v142, a94
 v_accvgpr_read_b32 v143, a95
 v_cvt_pk_bf16_f32 v108, v136, v137
 v_mfma_f32_16x16x32_bf16 a[116:119], v[240:243], v[92:95], a[116:119]
 ds_read_b64_tr_b16 v[44:45], v9 offset:20480
 buffer_load_dwordx4 v255, s[28:31], s46 offen offset:3072 lds
 v_cvt_pk_bf16_f32 v109, v138, v139
 v_mfma_f32_16x16x32_bf16 a[120:123], v[244:247], v[88:91], a[120:123]
 ds_read_b64_tr_b16 v[46:47], v9 offset:22528
 v_cvt_pk_bf16_f32 v110, v140, v141
 v_cvt_pk_bf16_f32 v111, v142, v143
 buffer_store_dwordx4 v[108:111], v22, s[36:39], s56 offen offset:3072 sc1
 v_mfma_f32_16x16x32_bf16 a[124:127], v[244:247], v[92:95], a[124:127]
 ds_read_b64_tr_b16 v[240:241], v12 offset:20480
 s_waitcnt lgkmcnt(5)
 v_mfma_f32_16x16x32_bf16 a[128:131], v[24:27], v[64:67], a[128:131]
 ds_read_b64_tr_b16 v[242:243], v12 offset:22528
 v_mfma_f32_16x16x32_bf16 a[132:135], v[24:27], v[68:71], a[132:135]
 ds_read_b64_tr_b16 v[244:245], v13 offset:20480
 v_mfma_f32_16x16x32_bf16 a[136:139], v[28:31], v[64:67], a[136:139]
 ds_read_b64_tr_b16 v[246:247], v13 offset:22528
 v_mfma_f32_16x16x32_bf16 a[140:143], v[28:31], v[68:71], a[140:143]
 ds_read_b64_tr_b16 v[24:25], v8 offset:24576
 v_mfma_f32_16x16x32_bf16 a[144:147], v[32:35], v[64:67], a[144:147]
 ds_read_b64_tr_b16 v[26:27], v8 offset:26624
 v_mfma_f32_16x16x32_bf16 a[148:151], v[32:35], v[68:71], a[148:151]
 ds_read_b64_tr_b16 v[28:29], v9 offset:24576
 s_mul_i32 s56, s83, 768
 s_add_u32 s56, s56, s51
 v_mfma_f32_16x16x32_bf16 a[152:155], v[36:39], v[64:67], a[152:155]
 ds_read_b64_tr_b16 v[30:31], v9 offset:26624
 v_accvgpr_read_b32 v112, a96
 v_accvgpr_read_b32 v113, a97
 v_mfma_f32_16x16x32_bf16 a[156:159], v[36:39], v[68:71], a[156:159]
 ds_read_b64_tr_b16 v[32:33], v12 offset:24576
 v_accvgpr_read_b32 v114, a98
 s_waitcnt lgkmcnt(5)
 v_mfma_f32_16x16x32_bf16 a[128:131], v[40:43], v[72:75], a[128:131]
 ds_read_b64_tr_b16 v[34:35], v12 offset:26624
 v_accvgpr_read_b32 v115, a99
 v_accvgpr_read_b32 v116, a104
 v_accvgpr_read_b32 v117, a105
 v_mfma_f32_16x16x32_bf16 a[132:135], v[40:43], v[76:79], a[132:135]
 ds_read_b64_tr_b16 v[36:37], v13 offset:24576
 v_accvgpr_read_b32 v118, a106
 v_accvgpr_read_b32 v119, a107
 v_mfma_f32_16x16x32_bf16 a[136:139], v[44:47], v[72:75], a[136:139]
 ds_read_b64_tr_b16 v[38:39], v13 offset:26624
 v_cvt_pk_bf16_f32 v96, v112, v113
 v_cvt_pk_bf16_f32 v97, v114, v115
 v_mfma_f32_16x16x32_bf16 a[140:143], v[44:47], v[76:79], a[140:143]
 ds_read_b64_tr_b16 v[40:41], v8 offset:28672
 v_cvt_pk_bf16_f32 v98, v116, v117
 v_cvt_pk_bf16_f32 v99, v118, v119
 v_mfma_f32_16x16x32_bf16 a[144:147], v[240:243], v[72:75], a[144:147]
 ds_read_b64_tr_b16 v[42:43], v8 offset:30720
 buffer_store_dwordx4 v[96:99], v22, s[36:39], s56 offen offset:0 sc1
 v_accvgpr_read_b32 v120, a100
 v_accvgpr_read_b32 v121, a101
 v_mfma_f32_16x16x32_bf16 a[148:151], v[240:243], v[76:79], a[148:151]
 ds_read_b64_tr_b16 v[44:45], v9 offset:28672
 v_accvgpr_read_b32 v122, a102
 v_accvgpr_read_b32 v123, a103
 v_mfma_f32_16x16x32_bf16 a[152:155], v[244:247], v[72:75], a[152:155]
 ds_read_b64_tr_b16 v[46:47], v9 offset:30720
 v_accvgpr_read_b32 v124, a108
 v_accvgpr_read_b32 v125, a109
 v_mfma_f32_16x16x32_bf16 a[156:159], v[244:247], v[76:79], a[156:159]
 ds_read_b64_tr_b16 v[240:241], v12 offset:28672
 v_accvgpr_read_b32 v126, a110
 s_waitcnt lgkmcnt(5)
 v_mfma_f32_16x16x32_bf16 a[128:131], v[24:27], v[80:83], a[128:131]
 ds_read_b64_tr_b16 v[242:243], v12 offset:30720
 v_accvgpr_read_b32 v127, a111
 v_cvt_pk_bf16_f32 v100, v120, v121
 v_cvt_pk_bf16_f32 v101, v122, v123
 v_mfma_f32_16x16x32_bf16 a[132:135], v[24:27], v[84:87], a[132:135]
 ds_read_b64_tr_b16 v[244:245], v13 offset:28672
 v_cvt_pk_bf16_f32 v102, v124, v125
 v_cvt_pk_bf16_f32 v103, v126, v127
 v_mfma_f32_16x16x32_bf16 a[136:139], v[28:31], v[80:83], a[136:139]
 ds_read_b64_tr_b16 v[246:247], v13 offset:30720
 buffer_store_dwordx4 v[100:103], v22, s[36:39], s56 offen offset:1024 sc1
 v_accvgpr_read_b32 v128, a112
 v_mfma_f32_16x16x32_bf16 a[140:143], v[28:31], v[84:87], a[140:143]
 v_accvgpr_read_b32 v129, a113
 v_accvgpr_read_b32 v130, a114
 v_mfma_f32_16x16x32_bf16 a[144:147], v[32:35], v[80:83], a[144:147]
 v_accvgpr_read_b32 v131, a115
 v_accvgpr_read_b32 v132, a120
 v_mfma_f32_16x16x32_bf16 a[148:151], v[32:35], v[84:87], a[148:151]
 v_accvgpr_read_b32 v133, a121
 v_accvgpr_read_b32 v134, a122
 v_mfma_f32_16x16x32_bf16 a[152:155], v[36:39], v[80:83], a[152:155]
 v_accvgpr_read_b32 v135, a123
 v_cvt_pk_bf16_f32 v104, v128, v129
 v_mfma_f32_16x16x32_bf16 a[156:159], v[36:39], v[84:87], a[156:159]
 s_waitcnt vmcnt(11) lgkmcnt(0)
 s_barrier
 ds_read_b64_tr_b16 v[24:25], v8 offset:32768
 ds_read_b64_tr_b16 v[28:29], v9 offset:32768
 ds_read_b64_tr_b16 v[26:27], v8 offset:34816
 ds_read_b64_tr_b16 v[32:33], v12 offset:32768
 ds_read_b64_tr_b16 v[30:31], v9 offset:34816
 v_add_u32 v252, 0, v250
 v_add_u32 v253, 8192, v250
 v_add_u32 v254, 16384, v250
 v_add_u32 v255, 24576, v250
 s_add_u32 m0, s50, 16384
 s_add_u32 s46, s66, s87
 v_mfma_f32_16x16x32_bf16 a[128:131], v[40:43], v[88:91], a[128:131]
 ds_read_b64_tr_b16 v[34:35], v12 offset:34816
 buffer_load_dwordx4 v252, s[28:31], s46 offen offset:0 lds
 v_cvt_pk_bf16_f32 v105, v130, v131
 v_cvt_pk_bf16_f32 v106, v132, v133
 v_cvt_pk_bf16_f32 v107, v134, v135
 buffer_store_dwordx4 v[104:107], v22, s[36:39], s56 offen offset:2048 sc1
 v_accvgpr_read_b32 v136, a116
 v_mfma_f32_16x16x32_bf16 a[132:135], v[40:43], v[92:95], a[132:135]
 ds_read_b64_tr_b16 v[36:37], v13 offset:32768
 buffer_load_dwordx4 v253, s[28:31], s46 offen offset:1024 lds
 v_mfma_f32_16x16x32_bf16 a[136:139], v[44:47], v[88:91], a[136:139]
 ds_read_b64_tr_b16 v[38:39], v13 offset:34816
 v_accvgpr_read_b32 v137, a117
 v_accvgpr_read_b32 v138, a118
 v_accvgpr_read_b32 v139, a119
 v_accvgpr_read_b32 v140, a124
 v_mfma_f32_16x16x32_bf16 a[140:143], v[44:47], v[92:95], a[140:143]
 ds_read_b64_tr_b16 v[40:41], v8 offset:36864
 buffer_load_dwordx4 v254, s[28:31], s46 offen offset:2048 lds
 v_mfma_f32_16x16x32_bf16 a[144:147], v[240:243], v[88:91], a[144:147]
 ds_read_b64_tr_b16 v[42:43], v8 offset:38912
 v_accvgpr_read_b32 v141, a125
 v_accvgpr_read_b32 v142, a126
 v_accvgpr_read_b32 v143, a127
 v_cvt_pk_bf16_f32 v108, v136, v137
 v_mfma_f32_16x16x32_bf16 a[148:151], v[240:243], v[92:95], a[148:151]
 ds_read_b64_tr_b16 v[44:45], v9 offset:36864
 buffer_load_dwordx4 v255, s[28:31], s46 offen offset:3072 lds
 v_cvt_pk_bf16_f32 v109, v138, v139
 v_mfma_f32_16x16x32_bf16 a[152:155], v[244:247], v[88:91], a[152:155]
 ds_read_b64_tr_b16 v[46:47], v9 offset:38912
 v_cvt_pk_bf16_f32 v110, v140, v141
 v_cvt_pk_bf16_f32 v111, v142, v143
 buffer_store_dwordx4 v[108:111], v22, s[36:39], s56 offen offset:3072 sc1
 v_mfma_f32_16x16x32_bf16 a[156:159], v[244:247], v[92:95], a[156:159]
 ds_read_b64_tr_b16 v[240:241], v12 offset:36864
 s_waitcnt lgkmcnt(5)
 v_mfma_f32_16x16x32_bf16 a[160:163], v[24:27], v[64:67], a[160:163]
 ds_read_b64_tr_b16 v[242:243], v12 offset:38912
 v_mfma_f32_16x16x32_bf16 a[164:167], v[24:27], v[68:71], a[164:167]
 ds_read_b64_tr_b16 v[244:245], v13 offset:36864
 v_mfma_f32_16x16x32_bf16 a[168:171], v[28:31], v[64:67], a[168:171]
 ds_read_b64_tr_b16 v[246:247], v13 offset:38912
 v_mfma_f32_16x16x32_bf16 a[172:175], v[28:31], v[68:71], a[172:175]
 ds_read_b64_tr_b16 v[24:25], v8 offset:40960
 v_mfma_f32_16x16x32_bf16 a[176:179], v[32:35], v[64:67], a[176:179]
 ds_read_b64_tr_b16 v[26:27], v8 offset:43008
 v_mfma_f32_16x16x32_bf16 a[180:183], v[32:35], v[68:71], a[180:183]
 ds_read_b64_tr_b16 v[28:29], v9 offset:40960
 s_mul_i32 s56, s84, 768
 s_add_u32 s56, s56, s51
 v_mfma_f32_16x16x32_bf16 a[184:187], v[36:39], v[64:67], a[184:187]
 ds_read_b64_tr_b16 v[30:31], v9 offset:43008
 v_accvgpr_read_b32 v112, a128
 v_accvgpr_read_b32 v113, a129
 v_mfma_f32_16x16x32_bf16 a[188:191], v[36:39], v[68:71], a[188:191]
 ds_read_b64_tr_b16 v[32:33], v12 offset:40960
 v_accvgpr_read_b32 v114, a130
 s_waitcnt lgkmcnt(5)
 v_mfma_f32_16x16x32_bf16 a[160:163], v[40:43], v[72:75], a[160:163]
 ds_read_b64_tr_b16 v[34:35], v12 offset:43008
 v_accvgpr_read_b32 v115, a131
 v_accvgpr_read_b32 v116, a136
 v_accvgpr_read_b32 v117, a137
 v_mfma_f32_16x16x32_bf16 a[164:167], v[40:43], v[76:79], a[164:167]
 ds_read_b64_tr_b16 v[36:37], v13 offset:40960
 v_accvgpr_read_b32 v118, a138
 v_accvgpr_read_b32 v119, a139
 v_mfma_f32_16x16x32_bf16 a[168:171], v[44:47], v[72:75], a[168:171]
 ds_read_b64_tr_b16 v[38:39], v13 offset:43008
 v_cvt_pk_bf16_f32 v96, v112, v113
 v_cvt_pk_bf16_f32 v97, v114, v115
 v_mfma_f32_16x16x32_bf16 a[172:175], v[44:47], v[76:79], a[172:175]
 ds_read_b64_tr_b16 v[40:41], v8 offset:45056
 v_cvt_pk_bf16_f32 v98, v116, v117
 v_cvt_pk_bf16_f32 v99, v118, v119
 v_mfma_f32_16x16x32_bf16 a[176:179], v[240:243], v[72:75], a[176:179]
 ds_read_b64_tr_b16 v[42:43], v8 offset:47104
 buffer_store_dwordx4 v[96:99], v22, s[36:39], s56 offen offset:0 sc1
 v_accvgpr_read_b32 v120, a132
 v_accvgpr_read_b32 v121, a133
 v_mfma_f32_16x16x32_bf16 a[180:183], v[240:243], v[76:79], a[180:183]
 ds_read_b64_tr_b16 v[44:45], v9 offset:45056
 v_accvgpr_read_b32 v122, a134
 v_accvgpr_read_b32 v123, a135
 v_mfma_f32_16x16x32_bf16 a[184:187], v[244:247], v[72:75], a[184:187]
 ds_read_b64_tr_b16 v[46:47], v9 offset:47104
 v_accvgpr_read_b32 v124, a140
 v_accvgpr_read_b32 v125, a141
 v_mfma_f32_16x16x32_bf16 a[188:191], v[244:247], v[76:79], a[188:191]
 ds_read_b64_tr_b16 v[240:241], v12 offset:45056
 v_accvgpr_read_b32 v126, a142
 s_waitcnt lgkmcnt(5)
 v_mfma_f32_16x16x32_bf16 a[160:163], v[24:27], v[80:83], a[160:163]
 ds_read_b64_tr_b16 v[242:243], v12 offset:47104
 v_accvgpr_read_b32 v127, a143
 v_cvt_pk_bf16_f32 v100, v120, v121
 v_cvt_pk_bf16_f32 v101, v122, v123
 v_mfma_f32_16x16x32_bf16 a[164:167], v[24:27], v[84:87], a[164:167]
 ds_read_b64_tr_b16 v[244:245], v13 offset:45056
 v_cvt_pk_bf16_f32 v102, v124, v125
 v_cvt_pk_bf16_f32 v103, v126, v127
 v_mfma_f32_16x16x32_bf16 a[168:171], v[28:31], v[80:83], a[168:171]
 ds_read_b64_tr_b16 v[246:247], v13 offset:47104
 buffer_store_dwordx4 v[100:103], v22, s[36:39], s56 offen offset:1024 sc1
 v_accvgpr_read_b32 v128, a144
 v_mfma_f32_16x16x32_bf16 a[172:175], v[28:31], v[84:87], a[172:175]
 v_accvgpr_read_b32 v129, a145
 v_accvgpr_read_b32 v130, a146
 v_mfma_f32_16x16x32_bf16 a[176:179], v[32:35], v[80:83], a[176:179]
 v_accvgpr_read_b32 v131, a147
 v_accvgpr_read_b32 v132, a152
 v_mfma_f32_16x16x32_bf16 a[180:183], v[32:35], v[84:87], a[180:183]
 v_accvgpr_read_b32 v133, a153
 v_accvgpr_read_b32 v134, a154
 v_mfma_f32_16x16x32_bf16 a[184:187], v[36:39], v[80:83], a[184:187]
 v_accvgpr_read_b32 v135, a155
 v_cvt_pk_bf16_f32 v104, v128, v129
 v_mfma_f32_16x16x32_bf16 a[188:191], v[36:39], v[84:87], a[188:191]
 s_waitcnt vmcnt(11) lgkmcnt(0)
 s_barrier
 ds_read_b64_tr_b16 v[24:25], v8 offset:0
 ds_read_b64_tr_b16 v[28:29], v9 offset:0
 ds_read_b64_tr_b16 v[26:27], v8 offset:2048
 ds_read_b64_tr_b16 v[32:33], v12 offset:0
 ds_read_b64_tr_b16 v[30:31], v9 offset:2048
 v_add_u32 v252, 0, v250
 v_add_u32 v253, 8192, v250
 v_add_u32 v254, 16384, v250
 v_add_u32 v255, 24576, v250
 s_add_u32 m0, s50, 32768
 s_add_u32 s46, s66, s88
 v_mfma_f32_16x16x32_bf16 a[160:163], v[40:43], v[88:91], a[160:163]
 ds_read_b64_tr_b16 v[34:35], v12 offset:2048
 buffer_load_dwordx4 v252, s[28:31], s46 offen offset:0 lds
 v_cvt_pk_bf16_f32 v105, v130, v131
 v_cvt_pk_bf16_f32 v106, v132, v133
 v_cvt_pk_bf16_f32 v107, v134, v135
 buffer_store_dwordx4 v[104:107], v22, s[36:39], s56 offen offset:2048 sc1
 v_accvgpr_read_b32 v136, a148
 v_mfma_f32_16x16x32_bf16 a[164:167], v[40:43], v[92:95], a[164:167]
 ds_read_b64_tr_b16 v[36:37], v13 offset:0
 buffer_load_dwordx4 v253, s[28:31], s46 offen offset:1024 lds
 v_mfma_f32_16x16x32_bf16 a[168:171], v[44:47], v[88:91], a[168:171]
 ds_read_b64_tr_b16 v[38:39], v13 offset:2048
 v_accvgpr_read_b32 v137, a149
 v_accvgpr_read_b32 v138, a150
 v_accvgpr_read_b32 v139, a151
 v_accvgpr_read_b32 v140, a156
 v_mfma_f32_16x16x32_bf16 a[172:175], v[44:47], v[92:95], a[172:175]
 ds_read_b64_tr_b16 v[40:41], v8 offset:4096
 buffer_load_dwordx4 v254, s[28:31], s46 offen offset:2048 lds
 v_mfma_f32_16x16x32_bf16 a[176:179], v[240:243], v[88:91], a[176:179]
 ds_read_b64_tr_b16 v[42:43], v8 offset:6144
 v_accvgpr_read_b32 v141, a157
 v_accvgpr_read_b32 v142, a158
 v_accvgpr_read_b32 v143, a159
 v_cvt_pk_bf16_f32 v108, v136, v137
 v_mfma_f32_16x16x32_bf16 a[180:183], v[240:243], v[92:95], a[180:183]
 ds_read_b64_tr_b16 v[44:45], v9 offset:4096
 buffer_load_dwordx4 v255, s[28:31], s46 offen offset:3072 lds
 s_add_u32 s66, s66, 147456
 v_cvt_pk_bf16_f32 v109, v138, v139
 v_mfma_f32_16x16x32_bf16 a[184:187], v[244:247], v[88:91], a[184:187]
 ds_read_b64_tr_b16 v[46:47], v9 offset:6144
 v_cvt_pk_bf16_f32 v110, v140, v141
 v_cvt_pk_bf16_f32 v111, v142, v143
 buffer_store_dwordx4 v[108:111], v22, s[36:39], s56 offen offset:3072 sc1
 v_mfma_f32_16x16x32_bf16 a[188:191], v[244:247], v[92:95], a[188:191]
 ds_read_b64_tr_b16 v[240:241], v12 offset:4096
 s_waitcnt lgkmcnt(5)
 v_mfma_f32_16x16x32_bf16 a[192:195], v[24:27], v[64:67], a[192:195]
 ds_read_b64_tr_b16 v[242:243], v12 offset:6144
 v_mfma_f32_16x16x32_bf16 a[196:199], v[24:27], v[68:71], a[196:199]
 ds_read_b64_tr_b16 v[244:245], v13 offset:4096
 v_mfma_f32_16x16x32_bf16 a[200:203], v[28:31], v[64:67], a[200:203]
 ds_read_b64_tr_b16 v[246:247], v13 offset:6144
 v_mfma_f32_16x16x32_bf16 a[204:207], v[28:31], v[68:71], a[204:207]
 ds_read_b64_tr_b16 v[24:25], v8 offset:8192
 v_mfma_f32_16x16x32_bf16 a[208:211], v[32:35], v[64:67], a[208:211]
 ds_read_b64_tr_b16 v[26:27], v8 offset:10240
 v_mfma_f32_16x16x32_bf16 a[212:215], v[32:35], v[68:71], a[212:215]
 ds_read_b64_tr_b16 v[28:29], v9 offset:8192
 s_mul_i32 s56, s85, 768
 s_add_u32 s56, s56, s51
 v_mfma_f32_16x16x32_bf16 a[216:219], v[36:39], v[64:67], a[216:219]
 ds_read_b64_tr_b16 v[30:31], v9 offset:10240
 v_accvgpr_read_b32 v112, a160
 v_accvgpr_read_b32 v113, a161
 v_mfma_f32_16x16x32_bf16 a[220:223], v[36:39], v[68:71], a[220:223]
 ds_read_b64_tr_b16 v[32:33], v12 offset:8192
 v_accvgpr_read_b32 v114, a162
 s_waitcnt lgkmcnt(5)
 v_mfma_f32_16x16x32_bf16 a[192:195], v[40:43], v[72:75], a[192:195]
 ds_read_b64_tr_b16 v[34:35], v12 offset:10240
 v_accvgpr_read_b32 v115, a163
 v_accvgpr_read_b32 v116, a168
 v_accvgpr_read_b32 v117, a169
 v_mfma_f32_16x16x32_bf16 a[196:199], v[40:43], v[76:79], a[196:199]
 ds_read_b64_tr_b16 v[36:37], v13 offset:8192
 v_accvgpr_read_b32 v118, a170
 v_accvgpr_read_b32 v119, a171
 v_mfma_f32_16x16x32_bf16 a[200:203], v[44:47], v[72:75], a[200:203]
 ds_read_b64_tr_b16 v[38:39], v13 offset:10240
 v_cvt_pk_bf16_f32 v96, v112, v113
 v_cvt_pk_bf16_f32 v97, v114, v115
 v_mfma_f32_16x16x32_bf16 a[204:207], v[44:47], v[76:79], a[204:207]
 ds_read_b64_tr_b16 v[40:41], v8 offset:12288
 v_cvt_pk_bf16_f32 v98, v116, v117
 v_cvt_pk_bf16_f32 v99, v118, v119
 v_mfma_f32_16x16x32_bf16 a[208:211], v[240:243], v[72:75], a[208:211]
 ds_read_b64_tr_b16 v[42:43], v8 offset:14336
 buffer_store_dwordx4 v[96:99], v22, s[36:39], s56 offen offset:0 sc1
 v_accvgpr_read_b32 v120, a164
 v_accvgpr_read_b32 v121, a165
 v_mfma_f32_16x16x32_bf16 a[212:215], v[240:243], v[76:79], a[212:215]
 ds_read_b64_tr_b16 v[44:45], v9 offset:12288
 v_accvgpr_read_b32 v122, a166
 v_accvgpr_read_b32 v123, a167
 v_mfma_f32_16x16x32_bf16 a[216:219], v[244:247], v[72:75], a[216:219]
 ds_read_b64_tr_b16 v[46:47], v9 offset:14336
 v_accvgpr_read_b32 v124, a172
 v_accvgpr_read_b32 v125, a173
 v_mfma_f32_16x16x32_bf16 a[220:223], v[244:247], v[76:79], a[220:223]
 ds_read_b64_tr_b16 v[240:241], v12 offset:12288
 v_accvgpr_read_b32 v126, a174
 s_waitcnt lgkmcnt(5)
 v_mfma_f32_16x16x32_bf16 a[192:195], v[24:27], v[80:83], a[192:195]
 ds_read_b64_tr_b16 v[242:243], v12 offset:14336
 v_accvgpr_read_b32 v127, a175
 v_cvt_pk_bf16_f32 v100, v120, v121
 v_cvt_pk_bf16_f32 v101, v122, v123
 v_mfma_f32_16x16x32_bf16 a[196:199], v[24:27], v[84:87], a[196:199]
 ds_read_b64_tr_b16 v[244:245], v13 offset:12288
 v_cvt_pk_bf16_f32 v102, v124, v125
 v_cvt_pk_bf16_f32 v103, v126, v127
 v_mfma_f32_16x16x32_bf16 a[200:203], v[28:31], v[80:83], a[200:203]
 ds_read_b64_tr_b16 v[246:247], v13 offset:14336
 buffer_store_dwordx4 v[100:103], v22, s[36:39], s56 offen offset:1024 sc1
 v_accvgpr_read_b32 v128, a176
 v_mfma_f32_16x16x32_bf16 a[204:207], v[28:31], v[84:87], a[204:207]
 v_accvgpr_read_b32 v129, a177
 v_accvgpr_read_b32 v130, a178
 v_mfma_f32_16x16x32_bf16 a[208:211], v[32:35], v[80:83], a[208:211]
 v_accvgpr_read_b32 v131, a179
 v_accvgpr_read_b32 v132, a184
 v_mfma_f32_16x16x32_bf16 a[212:215], v[32:35], v[84:87], a[212:215]
 v_accvgpr_read_b32 v133, a185
 v_accvgpr_read_b32 v134, a186
 v_mfma_f32_16x16x32_bf16 a[216:219], v[36:39], v[80:83], a[216:219]
 v_accvgpr_read_b32 v135, a187
 v_cvt_pk_bf16_f32 v104, v128, v129
 v_mfma_f32_16x16x32_bf16 a[220:223], v[36:39], v[84:87], a[220:223]
 s_waitcnt vmcnt(11) lgkmcnt(0)
 s_barrier
 ds_read_b64_tr_b16 v[24:25], v8 offset:16384
 ds_read_b64_tr_b16 v[28:29], v9 offset:16384
 ds_read_b64_tr_b16 v[26:27], v8 offset:18432
 ds_read_b64_tr_b16 v[32:33], v12 offset:16384
 ds_read_b64_tr_b16 v[30:31], v9 offset:18432
 v_cvt_pk_bf16_f32 v105, v130, v131
 v_mfma_f32_16x16x32_bf16 a[192:195], v[40:43], v[88:91], a[192:195]
 ds_read_b64_tr_b16 v[34:35], v12 offset:18432
 v_cvt_pk_bf16_f32 v106, v132, v133
 v_cvt_pk_bf16_f32 v107, v134, v135
 buffer_store_dwordx4 v[104:107], v22, s[36:39], s56 offen offset:2048 sc1
 v_accvgpr_read_b32 v136, a180
 v_mfma_f32_16x16x32_bf16 a[196:199], v[40:43], v[92:95], a[196:199]
 ds_read_b64_tr_b16 v[36:37], v13 offset:16384
 v_accvgpr_read_b32 v137, a181
 v_accvgpr_read_b32 v138, a182
 v_mfma_f32_16x16x32_bf16 a[200:203], v[44:47], v[88:91], a[200:203]
 ds_read_b64_tr_b16 v[38:39], v13 offset:18432
 v_accvgpr_read_b32 v139, a183
 v_accvgpr_read_b32 v140, a188
 v_mfma_f32_16x16x32_bf16 a[204:207], v[44:47], v[92:95], a[204:207]
 ds_read_b64_tr_b16 v[40:41], v8 offset:20480
 v_accvgpr_read_b32 v141, a189
 v_accvgpr_read_b32 v142, a190
 v_mfma_f32_16x16x32_bf16 a[208:211], v[240:243], v[88:91], a[208:211]
 ds_read_b64_tr_b16 v[42:43], v8 offset:22528
 v_accvgpr_read_b32 v143, a191
 v_cvt_pk_bf16_f32 v108, v136, v137
 v_mfma_f32_16x16x32_bf16 a[212:215], v[240:243], v[92:95], a[212:215]
 ds_read_b64_tr_b16 v[44:45], v9 offset:20480
 v_cvt_pk_bf16_f32 v109, v138, v139
 v_cvt_pk_bf16_f32 v110, v140, v141
 v_cvt_pk_bf16_f32 v111, v142, v143
 v_mfma_f32_16x16x32_bf16 a[216:219], v[244:247], v[88:91], a[216:219]
 ds_read_b64_tr_b16 v[46:47], v9 offset:22528
 buffer_store_dwordx4 v[108:111], v22, s[36:39], s56 offen offset:3072 sc1
 v_mfma_f32_16x16x32_bf16 a[220:223], v[244:247], v[92:95], a[220:223]
 ds_read_b64_tr_b16 v[240:241], v12 offset:20480
 s_waitcnt lgkmcnt(5)
 v_mfma_f32_16x16x32_bf16 a[224:227], v[24:27], v[64:67], a[224:227]
 ds_read_b64_tr_b16 v[242:243], v12 offset:22528
 v_mfma_f32_16x16x32_bf16 a[228:231], v[24:27], v[68:71], a[228:231]
 ds_read_b64_tr_b16 v[244:245], v13 offset:20480
 v_mfma_f32_16x16x32_bf16 a[232:235], v[28:31], v[64:67], a[232:235]
 ds_read_b64_tr_b16 v[246:247], v13 offset:22528
 v_mfma_f32_16x16x32_bf16 a[236:239], v[28:31], v[68:71], a[236:239]
 ds_read_b64_tr_b16 v[24:25], v8 offset:24576
 v_mfma_f32_16x16x32_bf16 a[240:243], v[32:35], v[64:67], a[240:243]
 ds_read_b64_tr_b16 v[26:27], v8 offset:26624
 v_mfma_f32_16x16x32_bf16 a[244:247], v[32:35], v[68:71], a[244:247]
 ds_read_b64_tr_b16 v[28:29], v9 offset:24576
 s_mul_i32 s56, s86, 768
 s_add_u32 s56, s56, s51
 v_mfma_f32_16x16x32_bf16 a[248:251], v[36:39], v[64:67], a[248:251]
 ds_read_b64_tr_b16 v[30:31], v9 offset:26624
 v_accvgpr_read_b32 v112, a192
 v_accvgpr_read_b32 v113, a193
 v_mfma_f32_16x16x32_bf16 a[252:255], v[36:39], v[68:71], a[252:255]
 ds_read_b64_tr_b16 v[32:33], v12 offset:24576
 v_accvgpr_read_b32 v114, a194
 s_waitcnt lgkmcnt(5)
 v_mfma_f32_16x16x32_bf16 a[224:227], v[40:43], v[72:75], a[224:227]
 ds_read_b64_tr_b16 v[34:35], v12 offset:26624
 v_accvgpr_read_b32 v115, a195
 v_accvgpr_read_b32 v116, a200
 v_accvgpr_read_b32 v117, a201
 v_mfma_f32_16x16x32_bf16 a[228:231], v[40:43], v[76:79], a[228:231]
 ds_read_b64_tr_b16 v[36:37], v13 offset:24576
 v_accvgpr_read_b32 v118, a202
 v_accvgpr_read_b32 v119, a203
 v_mfma_f32_16x16x32_bf16 a[232:235], v[44:47], v[72:75], a[232:235]
 ds_read_b64_tr_b16 v[38:39], v13 offset:26624
 v_cvt_pk_bf16_f32 v96, v112, v113
 v_cvt_pk_bf16_f32 v97, v114, v115
 v_mfma_f32_16x16x32_bf16 a[236:239], v[44:47], v[76:79], a[236:239]
 ds_read_b64_tr_b16 v[40:41], v8 offset:28672
 v_cvt_pk_bf16_f32 v98, v116, v117
 v_cvt_pk_bf16_f32 v99, v118, v119
 v_mfma_f32_16x16x32_bf16 a[240:243], v[240:243], v[72:75], a[240:243]
 ds_read_b64_tr_b16 v[42:43], v8 offset:30720
 buffer_store_dwordx4 v[96:99], v22, s[36:39], s56 offen offset:0 sc1
 v_accvgpr_read_b32 v120, a196
 v_accvgpr_read_b32 v121, a197
 v_mfma_f32_16x16x32_bf16 a[244:247], v[240:243], v[76:79], a[244:247]
 ds_read_b64_tr_b16 v[44:45], v9 offset:28672
 v_accvgpr_read_b32 v122, a198
 v_accvgpr_read_b32 v123, a199
 v_mfma_f32_16x16x32_bf16 a[248:251], v[244:247], v[72:75], a[248:251]
 ds_read_b64_tr_b16 v[46:47], v9 offset:30720
 v_accvgpr_read_b32 v124, a204
 v_accvgpr_read_b32 v125, a205
 v_mfma_f32_16x16x32_bf16 a[252:255], v[244:247], v[76:79], a[252:255]
 ds_read_b64_tr_b16 v[240:241], v12 offset:28672
 v_accvgpr_read_b32 v126, a206
 s_waitcnt lgkmcnt(5)
 v_mfma_f32_16x16x32_bf16 a[224:227], v[24:27], v[80:83], a[224:227]
 ds_read_b64_tr_b16 v[242:243], v12 offset:30720
 v_accvgpr_read_b32 v127, a207
 v_cvt_pk_bf16_f32 v100, v120, v121
 v_cvt_pk_bf16_f32 v101, v122, v123
 v_mfma_f32_16x16x32_bf16 a[228:231], v[24:27], v[84:87], a[228:231]
 ds_read_b64_tr_b16 v[244:245], v13 offset:28672
 v_cvt_pk_bf16_f32 v102, v124, v125
 v_cvt_pk_bf16_f32 v103, v126, v127
 v_mfma_f32_16x16x32_bf16 a[232:235], v[28:31], v[80:83], a[232:235]
 ds_read_b64_tr_b16 v[246:247], v13 offset:30720
 buffer_store_dwordx4 v[100:103], v22, s[36:39], s56 offen offset:1024 sc1
 v_accvgpr_read_b32 v128, a208
 v_mfma_f32_16x16x32_bf16 a[236:239], v[28:31], v[84:87], a[236:239]
 v_accvgpr_read_b32 v129, a209
 v_accvgpr_read_b32 v130, a210
 v_mfma_f32_16x16x32_bf16 a[240:243], v[32:35], v[80:83], a[240:243]
 v_accvgpr_read_b32 v131, a211
 v_accvgpr_read_b32 v132, a216
 v_mfma_f32_16x16x32_bf16 a[244:247], v[32:35], v[84:87], a[244:247]
 v_accvgpr_read_b32 v133, a217
 v_accvgpr_read_b32 v134, a218
 v_mfma_f32_16x16x32_bf16 a[248:251], v[36:39], v[80:83], a[248:251]
 v_accvgpr_read_b32 v135, a219
 v_cvt_pk_bf16_f32 v104, v128, v129
 v_mfma_f32_16x16x32_bf16 a[252:255], v[36:39], v[84:87], a[252:255]
 s_waitcnt vmcnt(7) lgkmcnt(0)
 s_barrier
 ds_read_b64_tr_b16 v[24:25], v8 offset:32768
 ds_read_b64_tr_b16 v[28:29], v9 offset:32768
 ds_read_b64_tr_b16 v[26:27], v8 offset:34816
 ds_read_b64_tr_b16 v[32:33], v12 offset:32768
 ds_read_b64_tr_b16 v[30:31], v9 offset:34816
 v_cvt_pk_bf16_f32 v105, v130, v131
 v_mfma_f32_16x16x32_bf16 a[224:227], v[40:43], v[88:91], a[224:227]
 ds_read_b64_tr_b16 v[34:35], v12 offset:34816
 v_cvt_pk_bf16_f32 v106, v132, v133
 v_cvt_pk_bf16_f32 v107, v134, v135
 buffer_store_dwordx4 v[104:107], v22, s[36:39], s56 offen offset:2048 sc1
 v_accvgpr_read_b32 v136, a212
 v_mfma_f32_16x16x32_bf16 a[228:231], v[40:43], v[92:95], a[228:231]
 ds_read_b64_tr_b16 v[36:37], v13 offset:32768
 v_accvgpr_read_b32 v137, a213
 v_accvgpr_read_b32 v138, a214
 v_mfma_f32_16x16x32_bf16 a[232:235], v[44:47], v[88:91], a[232:235]
 ds_read_b64_tr_b16 v[38:39], v13 offset:34816
 v_accvgpr_read_b32 v139, a215
 v_accvgpr_read_b32 v140, a220
 v_mfma_f32_16x16x32_bf16 a[236:239], v[44:47], v[92:95], a[236:239]
 ds_read_b64_tr_b16 v[40:41], v8 offset:36864
 v_accvgpr_read_b32 v141, a221
 v_accvgpr_read_b32 v142, a222
 v_mfma_f32_16x16x32_bf16 a[240:243], v[240:243], v[88:91], a[240:243]
 ds_read_b64_tr_b16 v[42:43], v8 offset:38912
 v_accvgpr_read_b32 v143, a223
 v_cvt_pk_bf16_f32 v108, v136, v137
 v_mfma_f32_16x16x32_bf16 a[244:247], v[240:243], v[92:95], a[244:247]
 ds_read_b64_tr_b16 v[44:45], v9 offset:36864
 v_cvt_pk_bf16_f32 v109, v138, v139
 v_cvt_pk_bf16_f32 v110, v140, v141
 v_cvt_pk_bf16_f32 v111, v142, v143
 v_mfma_f32_16x16x32_bf16 a[248:251], v[244:247], v[88:91], a[248:251]
 ds_read_b64_tr_b16 v[46:47], v9 offset:38912
 buffer_store_dwordx4 v[108:111], v22, s[36:39], s56 offen offset:3072 sc1
 v_mfma_f32_16x16x32_bf16 a[252:255], v[244:247], v[92:95], a[252:255]
 ds_read_b64_tr_b16 v[240:241], v12 offset:36864
 s_waitcnt lgkmcnt(5)
 v_mfma_f32_16x16x32_bf16 v[208:211], v[24:27], v[64:67], v[208:211]
 ds_read_b64_tr_b16 v[242:243], v12 offset:38912
 v_mfma_f32_16x16x32_bf16 v[212:215], v[24:27], v[68:71], v[212:215]
 ds_read_b64_tr_b16 v[244:245], v13 offset:36864
 v_mfma_f32_16x16x32_bf16 v[216:219], v[28:31], v[64:67], v[216:219]
 ds_read_b64_tr_b16 v[246:247], v13 offset:38912
 v_mfma_f32_16x16x32_bf16 v[220:223], v[28:31], v[68:71], v[220:223]
 ds_read_b64_tr_b16 v[24:25], v8 offset:40960
 v_mfma_f32_16x16x32_bf16 v[224:227], v[32:35], v[64:67], v[224:227]
 ds_read_b64_tr_b16 v[26:27], v8 offset:43008
 v_mfma_f32_16x16x32_bf16 v[228:231], v[32:35], v[68:71], v[228:231]
 ds_read_b64_tr_b16 v[28:29], v9 offset:40960
 s_mul_i32 s56, s87, 768
 s_add_u32 s56, s56, s51
 v_mfma_f32_16x16x32_bf16 v[232:235], v[36:39], v[64:67], v[232:235]
 ds_read_b64_tr_b16 v[30:31], v9 offset:43008
 v_accvgpr_read_b32 v112, a224
 v_accvgpr_read_b32 v113, a225
 v_mfma_f32_16x16x32_bf16 v[236:239], v[36:39], v[68:71], v[236:239]
 ds_read_b64_tr_b16 v[32:33], v12 offset:40960
 v_accvgpr_read_b32 v114, a226
 s_waitcnt lgkmcnt(5)
 v_mfma_f32_16x16x32_bf16 v[208:211], v[40:43], v[72:75], v[208:211]
 ds_read_b64_tr_b16 v[34:35], v12 offset:43008
 v_accvgpr_read_b32 v115, a227
 v_accvgpr_read_b32 v116, a232
 v_accvgpr_read_b32 v117, a233
 v_mfma_f32_16x16x32_bf16 v[212:215], v[40:43], v[76:79], v[212:215]
 ds_read_b64_tr_b16 v[36:37], v13 offset:40960
 v_accvgpr_read_b32 v118, a234
 v_accvgpr_read_b32 v119, a235
 v_mfma_f32_16x16x32_bf16 v[216:219], v[44:47], v[72:75], v[216:219]
 ds_read_b64_tr_b16 v[38:39], v13 offset:43008
 v_cvt_pk_bf16_f32 v96, v112, v113
 v_cvt_pk_bf16_f32 v97, v114, v115
 v_mfma_f32_16x16x32_bf16 v[220:223], v[44:47], v[76:79], v[220:223]
 ds_read_b64_tr_b16 v[40:41], v8 offset:45056
 v_cvt_pk_bf16_f32 v98, v116, v117
 v_cvt_pk_bf16_f32 v99, v118, v119
 v_mfma_f32_16x16x32_bf16 v[224:227], v[240:243], v[72:75], v[224:227]
 ds_read_b64_tr_b16 v[42:43], v8 offset:47104
 buffer_store_dwordx4 v[96:99], v22, s[36:39], s56 offen offset:0 sc1
 v_accvgpr_read_b32 v120, a228
 v_accvgpr_read_b32 v121, a229
 v_mfma_f32_16x16x32_bf16 v[228:231], v[240:243], v[76:79], v[228:231]
 ds_read_b64_tr_b16 v[44:45], v9 offset:45056
 v_accvgpr_read_b32 v122, a230
 v_accvgpr_read_b32 v123, a231
 v_mfma_f32_16x16x32_bf16 v[232:235], v[244:247], v[72:75], v[232:235]
 ds_read_b64_tr_b16 v[46:47], v9 offset:47104
 v_accvgpr_read_b32 v124, a236
 v_accvgpr_read_b32 v125, a237
 v_mfma_f32_16x16x32_bf16 v[236:239], v[244:247], v[76:79], v[236:239]
 ds_read_b64_tr_b16 v[240:241], v12 offset:45056
 v_accvgpr_read_b32 v126, a238
 s_waitcnt lgkmcnt(5)
 v_mfma_f32_16x16x32_bf16 v[208:211], v[24:27], v[80:83], v[208:211]
 ds_read_b64_tr_b16 v[242:243], v12 offset:47104
 v_accvgpr_read_b32 v127, a239
 v_cvt_pk_bf16_f32 v100, v120, v121
 v_cvt_pk_bf16_f32 v101, v122, v123
 v_mfma_f32_16x16x32_bf16 v[212:215], v[24:27], v[84:87], v[212:215]
 ds_read_b64_tr_b16 v[244:245], v13 offset:45056
 v_cvt_pk_bf16_f32 v102, v124, v125
 v_cvt_pk_bf16_f32 v103, v126, v127
 v_mfma_f32_16x16x32_bf16 v[216:219], v[28:31], v[80:83], v[216:219]
 ds_read_b64_tr_b16 v[246:247], v13 offset:47104
 buffer_store_dwordx4 v[100:103], v22, s[36:39], s56 offen offset:1024 sc1
 v_accvgpr_read_b32 v128, a240
 v_mfma_f32_16x16x32_bf16 v[220:223], v[28:31], v[84:87], v[220:223]
 v_accvgpr_read_b32 v129, a241
 v_accvgpr_read_b32 v130, a242
 v_mfma_f32_16x16x32_bf16 v[224:227], v[32:35], v[80:83], v[224:227]
 v_accvgpr_read_b32 v131, a243
 v_accvgpr_read_b32 v132, a248
 v_mfma_f32_16x16x32_bf16 v[228:231], v[32:35], v[84:87], v[228:231]
 v_accvgpr_read_b32 v133, a249
 v_accvgpr_read_b32 v134, a250
 v_mfma_f32_16x16x32_bf16 v[232:235], v[36:39], v[80:83], v[232:235]
 v_accvgpr_read_b32 v135, a251
 v_cvt_pk_bf16_f32 v104, v128, v129
 v_mfma_f32_16x16x32_bf16 v[236:239], v[36:39], v[84:87], v[236:239]
 v_cvt_pk_bf16_f32 v105, v130, v131
 v_cvt_pk_bf16_f32 v106, v132, v133
 v_cvt_pk_bf16_f32 v107, v134, v135
 s_waitcnt lgkmcnt(0)
 v_mfma_f32_16x16x32_bf16 v[208:211], v[40:43], v[88:91], v[208:211]
 buffer_store_dwordx4 v[104:107], v22, s[36:39], s56 offen offset:2048 sc1
 v_accvgpr_read_b32 v136, a244
 v_mfma_f32_16x16x32_bf16 v[212:215], v[40:43], v[92:95], v[212:215]
 v_accvgpr_read_b32 v137, a245
 v_accvgpr_read_b32 v138, a246
 v_mfma_f32_16x16x32_bf16 v[216:219], v[44:47], v[88:91], v[216:219]
 v_accvgpr_read_b32 v139, a247
 v_accvgpr_read_b32 v140, a252
 v_mfma_f32_16x16x32_bf16 v[220:223], v[44:47], v[92:95], v[220:223]
 v_accvgpr_read_b32 v141, a253
 v_accvgpr_read_b32 v142, a254
 v_mfma_f32_16x16x32_bf16 v[224:227], v[240:243], v[88:91], v[224:227]
 v_accvgpr_read_b32 v143, a255
 v_cvt_pk_bf16_f32 v108, v136, v137
 v_mfma_f32_16x16x32_bf16 v[228:231], v[240:243], v[92:95], v[228:231]
 v_cvt_pk_bf16_f32 v109, v138, v139
 v_cvt_pk_bf16_f32 v110, v140, v141
 v_cvt_pk_bf16_f32 v111, v142, v143
 v_mfma_f32_16x16x32_bf16 v[232:235], v[244:247], v[88:91], v[232:235]
 buffer_store_dwordx4 v[108:111], v22, s[36:39], s56 offen offset:3072 sc1
 v_mfma_f32_16x16x32_bf16 v[236:239], v[244:247], v[92:95], v[236:239]
 v_and_b32 v10, 7, v0
 v_lshlrev_b32 v1, 2, v10
 v_lshlrev_b32 v6, 4, v0
 buffer_load_dword v2, v1, s[36:39], s89 offen sc1
 s_mul_i32 s56, s53, 884736
 s_mul_i32 s57, s59, 3
 s_add_u32 s57, s57, s3
 s_lshl_b32 s57, s57, 15
 s_add_u32 s56, s56, s57
 s_mul_i32 s60, s4, 96
 s_lshl_b32 s58, s3, 5
 s_add_u32 s60, s60, s58
 s_mul_i32 s60, s60, 2304
 s_lshl_b32 s58, s59, 7
 s_add_u32 s60, s60, s58
 s_and_b32 s58, s2, 4
 s_mul_i32 s58, s58, 288
 s_add_u32 s60, s60, s58
 v_and_b32 v7, 15, v0
 v_mul_u32_u24 v7, 2304, v7
 v_lshrrev_b32 v3, 5, v0
 v_lshl_add_u32 v7, v3, 4, v7
 v_bfe_u32 v3, v0, 4, 1
 v_lshl_add_u32 v7, v3, 5, v7
 v_sub_u32 v10, s59, v10
 v_add_u32 v3, 9, v10
 v_cmp_gt_i32 vcc, 1, v10
 s_nop 1
 v_cndmask_b32 v10, v10, v3, vcc
 s_mov_b32 s62, 254
 s_mov_b32 s58, 0
 s_mov_b32 s64, 7
 v_and_b32 v4, 15, v0
 v_lshrrev_b32 v5, 4, v0
 v_lshlrev_b32 v5, 2, v5
 v_sub_u32 v4, v4, v5
 v_mov_b32 v8, 0x3f80
 v_mov_b32 v9, 0x3f800000
 v_cmp_eq_u32 vcc, 0, v4
 v_cmp_eq_u32 s[66:67], 1, v4
 v_mov_b32 v5, 0
 v_cndmask_b32 v5, v5, v8, vcc
 v_cndmask_b32 v24, v5, v9, s[66:67]
 v_cmp_eq_u32 vcc, 2, v4
 v_cmp_eq_u32 s[66:67], 3, v4
 v_mov_b32 v5, 0
 v_cndmask_b32 v5, v5, v8, vcc
 v_cndmask_b32 v25, v5, v9, s[66:67]
 v_mov_b32 v26, 0
 v_mov_b32 v27, 0
 v_mov_b32 v28, v24
 v_mov_b32 v29, v25
 v_add_u32 v3, 8, v23
 s_lshl_b32 s66, 1, s59
 s_mov_b32 s67, 0
 s_waitcnt vmcnt(0)
 s_mov_b64 exec, s[66:67]
 buffer_store_dword v3, v1, s[36:39], s89 offen sc1
 s_mov_b64 exec, -1
 s_branch L_chkc
L_pollc:
 s_waitcnt vmcnt(0)
L_chkc:
 v_sub_u32 v3, v2, v23
 v_cmp_ge_u32 vcc, v3, v10
 s_nop 3
 s_and_b32 s63, vcc_lo, 0xffff
 s_lshr_b32 s63, s63, s59
 s_and_b32 s63, s63, s62
 s_cbranch_scc1 L_somec
 s_add_u32 s58, s58, 1
 s_cmp_gt_u32 s58, 0x100000
 s_cbranch_scc1 L_outc
 s_sleep 8
 buffer_load_dword v2, v1, s[36:39], s89 offen sc1
 s_branch L_pollc
L_somec:
 s_bitcmp1_b32 s63, 7
 s_cbranch_scc0 L_nlc7
 s_add_u32 s57, s59, 7
 s_and_b32 s57, s57, 7
 s_lshl_b32 s57, s57, 12
 s_add_u32 s57, s57, s56
 buffer_load_dwordx4 v[128:131], v6, s[36:39], s57 offen offset:0 sc1
 buffer_load_dwordx4 v[132:135], v6, s[36:39], s57 offen offset:1024 sc1
 buffer_load_dwordx4 v[136:139], v6, s[36:39], s57 offen offset:2048 sc1
 buffer_load_dwordx4 v[140:143], v6, s[36:39], s57 offen offset:3072 sc1
L_nlc7:
 s_bitcmp1_b32 s63, 6
 s_cbranch_scc0 L_nlc6
 s_add_u32 s57, s59, 6
 s_and_b32 s57, s57, 7
 s_lshl_b32 s57, s57, 12
 s_add_u32 s57, s57, s56
 buffer_load_dwordx4 v[112:115], v6, s[36:39], s57 offen offset:0 sc1
 buffer_load_dwordx4 v[116:119], v6, s[36:39], s57 offen offset:1024 sc1
 buffer_load_dwordx4 v[120:123], v6, s[36:39], s57 offen offset:2048 sc1
 buffer_load_dwordx4 v[124:127], v6, s[36:39], s57 offen offset:3072 sc1
L_nlc6:
 s_bitcmp1_b32 s63, 5
 s_cbranch_scc0 L_nlc5
 s_add_u32 s57, s59, 5
 s_and_b32 s57, s57, 7
 s_lshl_b32 s57, s57, 12
 s_add_u32 s57, s57, s56
 buffer_load_dwordx4 v[96:99], v6, s[36:39], s57 offen offset:0 sc1
 buffer_load_dwordx4 v[100:103], v6, s[36:39], s57 offen offset:1024 sc1
 buffer_load_dwordx4 v[104:107], v6, s[36:39], s57 offen offset:2048 sc1
 buffer_load_dwordx4 v[108:111], v6, s[36:39], s57 offen offset:3072 sc1
L_nlc5:
 s_bitcmp1_b32 s63, 4
 s_cbranch_scc0 L_nlc4
 s_add_u32 s57, s59, 4
 s_and_b32 s57, s57, 7
 s_lshl_b32 s57, s57, 12
 s_add_u32 s57, s57, s56
 buffer_load_dwordx4 v[80:83], v6, s[36:39], s57 offen offset:0 sc1
 buffer_load_dwordx4 v[84:87], v6, s[36:39], s57 offen offset:1024 sc1
 buffer_load_dwordx4 v[88:91], v6, s[36:39], s57 offen offset:2048 sc1
 buffer_load_dwordx4 v[92:95], v6, s[36:39], s57 offen offset:3072 sc1
L_nlc4:
 s_bitcmp1_b32 s63, 3
 s_cbranch_scc0 L_nlc3
 s_add_u32 s57, s59, 3
 s_and_b32 s57, s57, 7
 s_lshl_b32 s57, s57, 12
 s_add_u32 s57, s57, s56
 buffer_load_dwordx4 v[64:67], v6, s[36:39], s57 offen offset:0 sc1
 buffer_load_dwordx4 v[68:71], v6, s[36:39], s57 offen offset:1024 sc1
 buffer_load_dwordx4 v[72:75], v6, s[36:39], s57 offen offset:2048 sc1
 buffer_load_dwordx4 v[76:79], v6, s[36:39], s57 offen offset:3072 sc1
L_nlc3:
 s_bitcmp1_b32 s63, 2
 s_cbranch_scc0 L_nlc2
 s_add_u32 s57, s59, 2
 s_and_b32 s57, s57, 7
 s_lshl_b32 s57, s57, 12
 s_add_u32 s57, s57, s56
 buffer_load_dwordx4 v[48:51], v6, s[36:39], s57 offen offset:0 sc1
 buffer_load_dwordx4 v[52:55], v6, s[36:39], s57 offen offset:1024 sc1
 buffer_load_dwordx4 v[56:59], v6, s[36:39], s57 offen offset:2048 sc1
 buffer_load_dwordx4 v[60:63], v6, s[36:39], s57 offen offset:3072 sc1
L_nlc2:
 s_bitcmp1_b32 s63, 1
 s_cbranch_scc0 L_nlc1
 s_add_u32 s57, s59, 1
 s_and_b32 s57, s57, 7
 s_lshl_b32 s57, s57, 12
 s_add_u32 s57, s57, s56
 buffer_load_dwordx4 v[32:35], v6, s[36:39], s57 offen offset:0 sc1
 buffer_load_dwordx4 v[36:39], v6, s[36:39], s57 offen offset:1024 sc1
 buffer_load_dwordx4 v[40:43], v6, s[36:39], s57 offen offset:2048 sc1
 buffer_load_dwordx4 v[44:47], v6, s[36:39], s57 offen offset:3072 sc1
L_nlc1:
 buffer_load_dword v2, v1, s[36:39], s89 offen sc1
 s_andn2_b32 s62, s62, s63
 s_waitcnt vmcnt(1)
 s_cmp_lg_u32 s64, 7
 s_cbranch_scc1 L_nac7
 s_bitcmp1_b32 s62, 7
 s_cbranch_scc1 L_pollc
 v_mfma_f32_16x16x32_bf16 v[208:211], v[24:27], v[128:131], v[208:211]
 v_mfma_f32_16x16x32_bf16 v[212:215], v[24:27], v[132:135], v[212:215]
 v_mfma_f32_16x16x32_bf16 v[224:227], v[24:27], v[136:139], v[224:227]
 v_mfma_f32_16x16x32_bf16 v[228:231], v[24:27], v[140:143], v[228:231]
 v_mfma_f32_16x16x32_bf16 v[216:219], v[26:29], v[128:131], v[216:219]
 v_mfma_f32_16x16x32_bf16 v[220:223], v[26:29], v[132:135], v[220:223]
 v_mfma_f32_16x16x32_bf16 v[232:235], v[26:29], v[136:139], v[232:235]
 v_mfma_f32_16x16x32_bf16 v[236:239], v[26:29], v[140:143], v[236:239]
 s_mov_b32 s64, 6
L_nac7:
 s_cmp_lg_u32 s64, 6
 s_cbranch_scc1 L_nac6
 s_bitcmp1_b32 s62, 6
 s_cbranch_scc1 L_pollc
 v_mfma_f32_16x16x32_bf16 v[208:211], v[24:27], v[112:115], v[208:211]
 v_mfma_f32_16x16x32_bf16 v[212:215], v[24:27], v[116:119], v[212:215]
 v_mfma_f32_16x16x32_bf16 v[224:227], v[24:27], v[120:123], v[224:227]
 v_mfma_f32_16x16x32_bf16 v[228:231], v[24:27], v[124:127], v[228:231]
 v_mfma_f32_16x16x32_bf16 v[216:219], v[26:29], v[112:115], v[216:219]
 v_mfma_f32_16x16x32_bf16 v[220:223], v[26:29], v[116:119], v[220:223]
 v_mfma_f32_16x16x32_bf16 v[232:235], v[26:29], v[120:123], v[232:235]
 v_mfma_f32_16x16x32_bf16 v[236:239], v[26:29], v[124:127], v[236:239]
 s_mov_b32 s64, 5
L_nac6:
 s_cmp_lg_u32 s64, 5
 s_cbranch_scc1 L_nac5
 s_bitcmp1_b32 s62, 5
 s_cbranch_scc1 L_pollc
 v_mfma_f32_16x16x32_bf16 v[208:211], v[24:27], v[96:99], v[208:211]
 v_mfma_f32_16x16x32_bf16 v[212:215], v[24:27], v[100:103], v[212:215]
 v_mfma_f32_16x16x32_bf16 v[224:227], v[24:27], v[104:107], v[224:227]
 v_mfma_f32_16x16x32_bf16 v[228:231], v[24:27], v[108:111], v[228:231]
 v_mfma_f32_16x16x32_bf16 v[216:219], v[26:29], v[96:99], v[216:219]
 v_mfma_f32_16x16x32_bf16 v[220:223], v[26:29], v[100:103], v[220:223]
 v_mfma_f32_16x16x32_bf16 v[232:235], v[26:29], v[104:107], v[232:235]
 v_mfma_f32_16x16x32_bf16 v[236:239], v[26:29], v[108:111], v[236:239]
 s_mov_b32 s64, 4
L_nac5:
 s_cmp_lg_u32 s64, 4
 s_cbranch_scc1 L_nac4
 s_bitcmp1_b32 s62, 4
 s_cbranch_scc1 L_pollc
 v_mfma_f32_16x16x32_bf16 v[208:211], v[24:27], v[80:83], v[208:211]
 v_mfma_f32_16x16x32_bf16 v[212:215], v[24:27], v[84:87], v[212:215]
 v_mfma_f32_16x16x32_bf16 v[224:227], v[24:27], v[88:91], v[224:227]
 v_mfma_f32_16x16x32_bf16 v[228:231], v[24:27], v[92:95], v[228:231]
 v_mfma_f32_16x16x32_bf16 v[216:219], v[26:29], v[80:83], v[216:219]
 v_mfma_f32_16x16x32_bf16 v[220:223], v[26:29], v[84:87], v[220:223]
 v_mfma_f32_16x16x32_bf16 v[232:235], v[26:29], v[88:91], v[232:235]
 v_mfma_f32_16x16x32_bf16 v[236:239], v[26:29], v[92:95], v[236:239]
 s_mov_b32 s64, 3
L_nac4:
 s_cmp_lg_u32 s64, 3
 s_cbranch_scc1 L_nac3
 s_bitcmp1_b32 s62, 3
 s_cbranch_scc1 L_pollc
 v_mfma_f32_16x16x32_bf16 v[208:211], v[24:27], v[64:67], v[208:211]
 v_mfma_f32_16x16x32_bf16 v[212:215], v[24:27], v[68:71], v[212:215]
 v_mfma_f32_16x16x32_bf16 v[224:227], v[24:27], v[72:75], v[224:227]
 v_mfma_f32_16x16x32_bf16 v[228:231], v[24:27], v[76:79], v[228:231]
 v_mfma_f32_16x16x32_bf16 v[216:219], v[26:29], v[64:67], v[216:219]
 v_mfma_f32_16x16x32_bf16 v[220:223], v[26:29], v[68:71], v[220:223]
 v_mfma_f32_16x16x32_bf16 v[232:235], v[26:29], v[72:75], v[232:235]
 v_mfma_f32_16x16x32_bf16 v[236:239], v[26:29], v[76:79], v[236:239]
 s_mov_b32 s64, 2
L_nac3:
 s_cmp_lg_u32 s64, 2
 s_cbranch_scc1 L_nac2
 s_bitcmp1_b32 s62, 2
 s_cbranch_scc1 L_pollc
 v_mfma_f32_16x16x32_bf16 v[208:211], v[24:27], v[48:51], v[208:211]
 v_mfma_f32_16x16x32_bf16 v[212:215], v[24:27], v[52:55], v[212:215]
 v_mfma_f32_16x16x32_bf16 v[224:227], v[24:27], v[56:59], v[224:227]
 v_mfma_f32_16x16x32_bf16 v[228:231], v[24:27], v[60:63], v[228:231]
 v_mfma_f32_16x16x32_bf16 v[216:219], v[26:29], v[48:51], v[216:219]
 v_mfma_f32_16x16x32_bf16 v[220:223], v[26:29], v[52:55], v[220:223]
 v_mfma_f32_16x16x32_bf16 v[232:235], v[26:29], v[56:59], v[232:235]
 v_mfma_f32_16x16x32_bf16 v[236:239], v[26:29], v[60:63], v[236:239]
 s_mov_b32 s64, 1
L_nac2:
 s_cmp_lg_u32 s64, 1
 s_cbranch_scc1 L_nac1
 s_bitcmp1_b32 s62, 1
 s_cbranch_scc1 L_pollc
 v_mfma_f32_16x16x32_bf16 v[208:211], v[24:27], v[32:35], v[208:211]
 v_mfma_f32_16x16x32_bf16 v[212:215], v[24:27], v[36:39], v[212:215]
 v_mfma_f32_16x16x32_bf16 v[224:227], v[24:27], v[40:43], v[224:227]
 v_mfma_f32_16x16x32_bf16 v[228:231], v[24:27], v[44:47], v[228:231]
 v_mfma_f32_16x16x32_bf16 v[216:219], v[26:29], v[32:35], v[216:219]
 v_mfma_f32_16x16x32_bf16 v[220:223], v[26:29], v[36:39], v[220:223]
 v_mfma_f32_16x16x32_bf16 v[232:235], v[26:29], v[40:43], v[232:235]
 v_mfma_f32_16x16x32_bf16 v[236:239], v[26:29], v[44:47], v[236:239]
 s_mov_b32 s64, 0
L_nac1:
L_outc:
 s_nop 15
 v_cvt_pk_bf16_f32 v8, v208, v209
 v_cvt_pk_bf16_f32 v9, v210, v211
 v_cvt_pk_bf16_f32 v10, v216, v217
 v_cvt_pk_bf16_f32 v11, v218, v219
 v_cvt_pk_bf16_f32 v12, v212, v213
 v_cvt_pk_bf16_f32 v13, v214, v215
 v_cvt_pk_bf16_f32 v14, v220, v221
 v_cvt_pk_bf16_f32 v15, v222, v223
 v_cvt_pk_bf16_f32 v16, v224, v225
 v_cvt_pk_bf16_f32 v17, v226, v227
 v_cvt_pk_bf16_f32 v18, v232, v233
 v_cvt_pk_bf16_f32 v19, v234, v235
 v_cvt_pk_bf16_f32 v20, v228, v229
 v_cvt_pk_bf16_f32 v21, v230, v231
 v_cvt_pk_bf16_f32 v22, v236, v237
 v_cvt_pk_bf16_f32 v23, v238, v239
 s_add_u32 s57, s60, 36864
 v_permlane16_swap_b32 v8, v10
 v_permlane16_swap_b32 v9, v11
 buffer_store_dwordx4 v[8:11], v7, s[72:75], s60 offen offset:0
 v_permlane16_swap_b32 v12, v14
 v_permlane16_swap_b32 v13, v15
 buffer_store_dwordx4 v[12:15], v7, s[72:75], s57 offen offset:0
 v_permlane16_swap_b32 v16, v18
 v_permlane16_swap_b32 v17, v19
 buffer_store_dwordx4 v[16:19], v7, s[72:75], s60 offen offset:64
 v_permlane16_swap_b32 v20, v22
 v_permlane16_swap_b32 v21, v23
 buffer_store_dwordx4 v[20:23], v7, s[72:75], s57 offen offset:64
 s_endpgm
L_warm_more:
 s_setpc_b64 s[40:41]
L_more:
 ds_read_b64_tr_b16 v[240:241], v12 offset:20480
 s_waitcnt lgkmcnt(5)
 v_mfma_f32_16x16x32_bf16 a[32:35], v[24:27], v[64:67], a[32:35]
 ds_read_b64_tr_b16 v[242:243], v12 offset:22528
 v_mfma_f32_16x16x32_bf16 a[36:39], v[24:27], v[68:71], a[36:39]
 ds_read_b64_tr_b16 v[244:245], v13 offset:20480
 v_mfma_f32_16x16x32_bf16 a[40:43], v[28:31], v[64:67], a[40:43]
 ds_read_b64_tr_b16 v[246:247], v13 offset:22528
 v_mfma_f32_16x16x32_bf16 a[44:47], v[28:31], v[68:71], a[44:47]
 ds_read_b64_tr_b16 v[24:25], v8 offset:24576
 v_mfma_f32_16x16x32_bf16 a[48:51], v[32:35], v[64:67], a[48:51]
 ds_read_b64_tr_b16 v[26:27], v8 offset:26624
 v_mfma_f32_16x16x32_bf16 a[52:55], v[32:35], v[68:71], a[52:55]
 ds_read_b64_tr_b16 v[28:29], v9 offset:24576
 v_mfma_f32_16x16x32_bf16 a[56:59], v[36:39], v[64:67], a[56:59]
 ds_read_b64_tr_b16 v[30:31], v9 offset:26624
 v_mfma_f32_16x16x32_bf16 a[60:63], v[36:39], v[68:71], a[60:63]
 ds_read_b64_tr_b16 v[32:33], v12 offset:24576
 s_waitcnt lgkmcnt(5)
 v_mfma_f32_16x16x32_bf16 a[32:35], v[40:43], v[72:75], a[32:35]
 ds_read_b64_tr_b16 v[34:35], v12 offset:26624
 v_mfma_f32_16x16x32_bf16 a[36:39], v[40:43], v[76:79], a[36:39]
 ds_read_b64_tr_b16 v[36:37], v13 offset:24576
 v_mfma_f32_16x16x32_bf16 a[40:43], v[44:47], v[72:75], a[40:43]
 ds_read_b64_tr_b16 v[38:39], v13 offset:26624
 v_mfma_f32_16x16x32_bf16 a[44:47], v[44:47], v[76:79], a[44:47]
 ds_read_b64_tr_b16 v[40:41], v8 offset:28672
 v_mfma_f32_16x16x32_bf16 a[48:51], v[240:243], v[72:75], a[48:51]
 ds_read_b64_tr_b16 v[42:43], v8 offset:30720
 v_mfma_f32_16x16x32_bf16 a[52:55], v[240:243], v[76:79], a[52:55]
 ds_read_b64_tr_b16 v[44:45], v9 offset:28672
 v_mfma_f32_16x16x32_bf16 a[56:59], v[244:247], v[72:75], a[56:59]
 ds_read_b64_tr_b16 v[46:47], v9 offset:30720
 v_mfma_f32_16x16x32_bf16 a[60:63], v[244:247], v[76:79], a[60:63]
 ds_read_b64_tr_b16 v[240:241], v12 offset:28672
 s_waitcnt lgkmcnt(5)
 v_mfma_f32_16x16x32_bf16 a[32:35], v[24:27], v[80:83], a[32:35]
 ds_read_b64_tr_b16 v[242:243], v12 offset:30720
 v_mfma_f32_16x16x32_bf16 a[36:39], v[24:27], v[84:87], a[36:39]
 ds_read_b64_tr_b16 v[244:245], v13 offset:28672
 v_mfma_f32_16x16x32_bf16 a[40:43], v[28:31], v[80:83], a[40:43]
 ds_read_b64_tr_b16 v[246:247], v13 offset:30720
 v_mfma_f32_16x16x32_bf16 a[44:47], v[28:31], v[84:87], a[44:47]
 v_mfma_f32_16x16x32_bf16 a[48:51], v[32:35], v[80:83], a[48:51]
 v_mfma_f32_16x16x32_bf16 a[52:55], v[32:35], v[84:87], a[52:55]
 v_mfma_f32_16x16x32_bf16 a[56:59], v[36:39], v[80:83], a[56:59]
 v_mfma_f32_16x16x32_bf16 a[60:63], v[36:39], v[84:87], a[60:63]
 s_waitcnt vmcnt(8) lgkmcnt(0)
 s_barrier
 ds_read_b64_tr_b16 v[24:25], v8 offset:32768
 ds_read_b64_tr_b16 v[28:29], v9 offset:32768
 ds_read_b64_tr_b16 v[26:27], v8 offset:34816
 ds_read_b64_tr_b16 v[32:33], v12 offset:32768
 ds_read_b64_tr_b16 v[30:31], v9 offset:34816
 v_add_u32 v252, 0, v250
 v_add_u32 v253, 8192, v250
 v_mfma_f32_16x16x32_bf16 a[32:35], v[40:43], v[88:91], a[32:35]
 ds_read_b64_tr_b16 v[34:35], v12 offset:34816
 v_add_u32 v254, 16384, v250
 v_add_u32 v255, 24576, v250
 s_add_u32 m0, s50, 16384
 s_add_u32 s46, s66, s84
 buffer_load_dwordx4 v252, s[28:31], s46 offen offset:0 lds
 v_mfma_f32_16x16x32_bf16 a[36:39], v[40:43], v[92:95], a[36:39]
 ds_read_b64_tr_b16 v[36:37], v13 offset:32768
 v_mfma_f32_16x16x32_bf16 a[40:43], v[44:47], v[88:91], a[40:43]
 ds_read_b64_tr_b16 v[38:39], v13 offset:34816
 buffer_load_dwordx4 v253, s[28:31], s46 offen offset:1024 lds
 v_mfma_f32_16x16x32_bf16 a[44:47], v[44:47], v[92:95], a[44:47]
 ds_read_b64_tr_b16 v[40:41], v8 offset:36864
 v_mfma_f32_16x16x32_bf16 a[48:51], v[240:243], v[88:91], a[48:51]
 ds_read_b64_tr_b16 v[42:43], v8 offset:38912
 buffer_load_dwordx4 v254, s[28:31], s46 offen offset:2048 lds
 v_mfma_f32_16x16x32_bf16 a[52:55], v[240:243], v[92:95], a[52:55]
 ds_read_b64_tr_b16 v[44:45], v9 offset:36864
 v_mfma_f32_16x16x32_bf16 a[56:59], v[244:247], v[88:91], a[56:59]
 ds_read_b64_tr_b16 v[46:47], v9 offset:38912
 buffer_load_dwordx4 v255, s[28:31], s46 offen offset:3072 lds
 v_mfma_f32_16x16x32_bf16 a[60:63], v[244:247], v[92:95], a[60:63]
 ds_read_b64_tr_b16 v[240:241], v12 offset:36864
 v_mov_b32 v252, v251
 v_xor_b32 v253, s67, v251
 v_xor_b32 v254, s100, v251
 v_xor_b32 v255, s100, v253
 s_add_u32 m0, s50, 81920
 s_waitcnt lgkmcnt(5)
 v_mfma_f32_16x16x32_bf16 a[64:67], v[24:27], v[64:67], a[64:67]
 ds_read_b64_tr_b16 v[242:243], v12 offset:38912
 s_add_u32 s46, s90, 16384
 s_and_b32 s46, s46, 0x1ffff
 s_add_u32 s46, s46, s91
 buffer_load_dwordx4 v252, s[96:99], s46 offen offset:0 nt lds
 ds_read_b128 v[112:115], v3 offset:0
 v_mfma_f32_16x16x32_bf16 a[68:71], v[24:27], v[68:71], a[68:71]
 ds_read_b64_tr_b16 v[244:245], v13 offset:36864
 buffer_load_dwordx4 v253, s[96:99], s46 offen offset:1024 nt lds
 v_mfma_f32_16x16x32_bf16 a[72:75], v[28:31], v[64:67], a[72:75]
 ds_read_b64_tr_b16 v[246:247], v13 offset:38912
 ds_read_b128 v[116:119], v3 offset:1024
 v_mfma_f32_16x16x32_bf16 a[76:79], v[28:31], v[68:71], a[76:79]
 ds_read_b64_tr_b16 v[24:25], v8 offset:40960
 buffer_load_dwordx4 v254, s[96:99], s46 offen offset:2048 nt lds
 v_mfma_f32_16x16x32_bf16 a[80:83], v[32:35], v[64:67], a[80:83]
 ds_read_b64_tr_b16 v[26:27], v8 offset:43008
 ds_read_b128 v[120:123], v3 offset:2048
 v_mfma_f32_16x16x32_bf16 a[84:87], v[32:35], v[68:71], a[84:87]
 ds_read_b64_tr_b16 v[28:29], v9 offset:40960
 buffer_load_dwordx4 v255, s[96:99], s46 offen offset:3072 nt lds
 v_mfma_f32_16x16x32_bf16 a[88:91], v[36:39], v[64:67], a[88:91]
 ds_read_b64_tr_b16 v[30:31], v9 offset:43008
 ds_read_b128 v[124:127], v3 offset:3072
 s_waitcnt lgkmcnt(15)
 v_mfma_f32_16x16x32_bf16 a[92:95], v[36:39], v[68:71], a[92:95]
 ds_read_b64_tr_b16 v[32:33], v12 offset:40960
 s_waitcnt lgkmcnt(15)
 s_waitcnt lgkmcnt(8)
 v_mfma_f32_16x16x32_bf16 a[64:67], v[40:43], v[72:75], a[64:67]
 ds_read_b64_tr_b16 v[34:35], v12 offset:43008
 v_mfma_f32_16x16x32_bf16 a[68:71], v[40:43], v[76:79], a[68:71]
 ds_read_b64_tr_b16 v[36:37], v13 offset:40960
 v_mfma_f32_16x16x32_bf16 a[72:75], v[44:47], v[72:75], a[72:75]
 ds_read_b64_tr_b16 v[38:39], v13 offset:43008
 v_mfma_f32_16x16x32_bf16 a[76:79], v[44:47], v[76:79], a[76:79]
 ds_read_b64_tr_b16 v[40:41], v8 offset:45056
 v_mfma_f32_16x16x32_bf16 a[80:83], v[240:243], v[72:75], a[80:83]
 ds_read_b64_tr_b16 v[42:43], v8 offset:47104
 v_mfma_f32_16x16x32_bf16 a[84:87], v[240:243], v[76:79], a[84:87]
 ds_read_b64_tr_b16 v[44:45], v9 offset:45056
 v_mfma_f32_16x16x32_bf16 a[88:91], v[244:247], v[72:75], a[88:91]
 ds_read_b64_tr_b16 v[46:47], v9 offset:47104
 v_mfma_f32_16x16x32_bf16 a[92:95], v[244:247], v[76:79], a[92:95]
 ds_read_b64_tr_b16 v[240:241], v12 offset:45056
 s_waitcnt lgkmcnt(15)
 s_waitcnt lgkmcnt(5)
 v_mfma_f32_16x16x32_bf16 a[64:67], v[24:27], v[80:83], a[64:67]
 ds_read_b64_tr_b16 v[242:243], v12 offset:47104
 v_mfma_f32_16x16x32_bf16 a[68:71], v[24:27], v[84:87], a[68:71]
 ds_read_b64_tr_b16 v[244:245], v13 offset:45056
 v_mfma_f32_16x16x32_bf16 a[72:75], v[28:31], v[80:83], a[72:75]
 ds_read_b64_tr_b16 v[246:247], v13 offset:47104
 v_mfma_f32_16x16x32_bf16 a[76:79], v[28:31], v[84:87], a[76:79]
 v_mfma_f32_16x16x32_bf16 a[80:83], v[32:35], v[80:83], a[80:83]
 v_mfma_f32_16x16x32_bf16 a[84:87], v[32:35], v[84:87], a[84:87]
 v_mfma_f32_16x16x32_bf16 a[88:91], v[36:39], v[80:83], a[88:91]
 v_mfma_f32_16x16x32_bf16 a[92:95], v[36:39], v[84:87], a[92:95]
 s_waitcnt vmcnt(8) lgkmcnt(0)
 s_barrier
 ds_read_b64_tr_b16 v[24:25], v8 offset:0
 ds_read_b64_tr_b16 v[28:29], v9 offset:0
 ds_read_b64_tr_b16 v[26:27], v8 offset:2048
 ds_read_b64_tr_b16 v[32:33], v12 offset:0
 ds_read_b64_tr_b16 v[30:31], v9 offset:2048
 v_add_u32 v252, 0, v250
 v_add_u32 v253, 8192, v250
 v_mfma_f32_16x16x32_bf16 a[64:67], v[40:43], v[88:91], a[64:67]
 ds_read_b64_tr_b16 v[34:35], v12 offset:2048
 v_add_u32 v254, 16384, v250
 v_add_u32 v255, 24576, v250
 s_add_u32 m0, s50, 32768
 s_add_u32 s46, s66, s85
 buffer_load_dwordx4 v252, s[28:31], s46 offen offset:0 lds
 v_mfma_f32_16x16x32_bf16 a[68:71], v[40:43], v[92:95], a[68:71]
 ds_read_b64_tr_b16 v[36:37], v13 offset:0
 v_mfma_f32_16x16x32_bf16 a[72:75], v[44:47], v[88:91], a[72:75]
 ds_read_b64_tr_b16 v[38:39], v13 offset:2048
 buffer_load_dwordx4 v253, s[28:31], s46 offen offset:1024 lds
 v_mfma_f32_16x16x32_bf16 a[76:79], v[44:47], v[92:95], a[76:79]
 ds_read_b64_tr_b16 v[40:41], v8 offset:4096
 v_mfma_f32_16x16x32_bf16 a[80:83], v[240:243], v[88:91], a[80:83]
 ds_read_b64_tr_b16 v[42:43], v8 offset:6144
 buffer_load_dwordx4 v254, s[28:31], s46 offen offset:2048 lds
 v_mfma_f32_16x16x32_bf16 a[84:87], v[240:243], v[92:95], a[84:87]
 ds_read_b64_tr_b16 v[44:45], v9 offset:4096
 v_mfma_f32_16x16x32_bf16 a[88:91], v[244:247], v[88:91], a[88:91]
 ds_read_b64_tr_b16 v[46:47], v9 offset:6144
 buffer_load_dwordx4 v255, s[28:31], s46 offen offset:3072 lds
 v_mfma_f32_16x16x32_bf16 a[92:95], v[244:247], v[92:95], a[92:95]
 ds_read_b64_tr_b16 v[240:241], v12 offset:4096
 s_waitcnt lgkmcnt(5)
 v_mfma_f32_16x16x32_bf16 a[96:99], v[24:27], v[64:67], a[96:99]
 ds_read_b64_tr_b16 v[242:243], v12 offset:6144
 v_mfma_f32_16x16x32_bf16 a[100:103], v[24:27], v[68:71], a[100:103]
 ds_read_b64_tr_b16 v[244:245], v13 offset:4096
 v_mfma_f32_16x16x32_bf16 a[104:107], v[28:31], v[64:67], a[104:107]
 ds_read_b64_tr_b16 v[246:247], v13 offset:6144
 v_mfma_f32_16x16x32_bf16 a[108:111], v[28:31], v[68:71], a[108:111]
 ds_read_b64_tr_b16 v[24:25], v8 offset:8192
 v_mfma_f32_16x16x32_bf16 a[112:115], v[32:35], v[64:67], a[112:115]
 ds_read_b64_tr_b16 v[26:27], v8 offset:10240
 v_mfma_f32_16x16x32_bf16 a[116:119], v[32:35], v[68:71], a[116:119]
 ds_read_b64_tr_b16 v[28:29], v9 offset:8192
 v_mfma_f32_16x16x32_bf16 a[120:123], v[36:39], v[64:67], a[120:123]
 ds_read_b64_tr_b16 v[30:31], v9 offset:10240
 v_mfma_f32_16x16x32_bf16 a[124:127], v[36:39], v[68:71], a[124:127]
 ds_read_b64_tr_b16 v[32:33], v12 offset:8192
 s_waitcnt lgkmcnt(5)
 v_mfma_f32_16x16x32_bf16 a[96:99], v[40:43], v[72:75], a[96:99]
 ds_read_b64_tr_b16 v[34:35], v12 offset:10240
 v_mfma_f32_16x16x32_bf16 a[100:103], v[40:43], v[76:79], a[100:103]
 ds_read_b64_tr_b16 v[36:37], v13 offset:8192
 v_mfma_f32_16x16x32_bf16 a[104:107], v[44:47], v[72:75], a[104:107]
 ds_read_b64_tr_b16 v[38:39], v13 offset:10240
 v_mfma_f32_16x16x32_bf16 a[108:111], v[44:47], v[76:79], a[108:111]
 ds_read_b64_tr_b16 v[40:41], v8 offset:12288
 v_mfma_f32_16x16x32_bf16 a[112:115], v[240:243], v[72:75], a[112:115]
 ds_read_b64_tr_b16 v[42:43], v8 offset:14336
 v_mfma_f32_16x16x32_bf16 a[116:119], v[240:243], v[76:79], a[116:119]
 ds_read_b64_tr_b16 v[44:45], v9 offset:12288
 v_mfma_f32_16x16x32_bf16 a[120:123], v[244:247], v[72:75], a[120:123]
 ds_read_b64_tr_b16 v[46:47], v9 offset:14336
 v_mfma_f32_16x16x32_bf16 a[124:127], v[244:247], v[76:79], a[124:127]
 ds_read_b64_tr_b16 v[240:241], v12 offset:12288
 s_waitcnt lgkmcnt(5)
 v_mfma_f32_16x16x32_bf16 a[96:99], v[24:27], v[80:83], a[96:99]
 ds_read_b64_tr_b16 v[242:243], v12 offset:14336
 v_mfma_f32_16x16x32_bf16 a[100:103], v[24:27], v[84:87], a[100:103]
 ds_read_b64_tr_b16 v[244:245], v13 offset:12288
 v_mfma_f32_16x16x32_bf16 a[104:107], v[28:31], v[80:83], a[104:107]
 ds_read_b64_tr_b16 v[246:247], v13 offset:14336
 v_mfma_f32_16x16x32_bf16 a[108:111], v[28:31], v[84:87], a[108:111]
 v_mfma_f32_16x16x32_bf16 a[112:115], v[32:35], v[80:83], a[112:115]
 v_mfma_f32_16x16x32_bf16 a[116:119], v[32:35], v[84:87], a[116:119]
 v_mfma_f32_16x16x32_bf16 a[120:123], v[36:39], v[80:83], a[120:123]
 v_mfma_f32_16x16x32_bf16 a[124:127], v[36:39], v[84:87], a[124:127]
 s_waitcnt vmcnt(8) lgkmcnt(0)
 s_barrier
 ds_read_b64_tr_b16 v[24:25], v8 offset:16384
 ds_read_b64_tr_b16 v[28:29], v9 offset:16384
 ds_read_b64_tr_b16 v[26:27], v8 offset:18432
 ds_read_b64_tr_b16 v[32:33], v12 offset:16384
 ds_read_b64_tr_b16 v[30:31], v9 offset:18432
 v_add_u32 v252, 0, v250
 v_add_u32 v253, 8192, v250
 v_mfma_f32_16x16x32_bf16 a[96:99], v[40:43], v[88:91], a[96:99]
 ds_read_b64_tr_b16 v[34:35], v12 offset:18432
 v_add_u32 v254, 16384, v250
 v_add_u32 v255, 24576, v250
 s_add_u32 m0, s50, 0
 s_add_u32 s46, s66, s86
 buffer_load_dwordx4 v252, s[28:31], s46 offen offset:0 lds
 v_mfma_f32_16x16x32_bf16 a[100:103], v[40:43], v[92:95], a[100:103]
 ds_read_b64_tr_b16 v[36:37], v13 offset:16384
 v_mfma_f32_16x16x32_bf16 a[104:107], v[44:47], v[88:91], a[104:107]
 ds_read_b64_tr_b16 v[38:39], v13 offset:18432
 buffer_load_dwordx4 v253, s[28:31], s46 offen offset:1024 lds
 v_mfma_f32_16x16x32_bf16 a[108:111], v[44:47], v[92:95], a[108:111]
 ds_read_b64_tr_b16 v[40:41], v8 offset:20480
 v_mfma_f32_16x16x32_bf16 a[112:115], v[240:243], v[88:91], a[112:115]
 ds_read_b64_tr_b16 v[42:43], v8 offset:22528
 buffer_load_dwordx4 v254, s[28:31], s46 offen offset:2048 lds
 v_mfma_f32_16x16x32_bf16 a[116:119], v[240:243], v[92:95], a[116:119]
 ds_read_b64_tr_b16 v[44:45], v9 offset:20480
 v_mfma_f32_16x16x32_bf16 a[120:123], v[244:247], v[88:91], a[120:123]
 ds_read_b64_tr_b16 v[46:47], v9 offset:22528
 buffer_load_dwordx4 v255, s[28:31], s46 offen offset:3072 lds
 v_mfma_f32_16x16x32_bf16 a[124:127], v[244:247], v[92:95], a[124:127]
 ds_read_b64_tr_b16 v[240:241], v12 offset:20480
 s_waitcnt lgkmcnt(5)
 v_mfma_f32_16x16x32_bf16 a[128:131], v[24:27], v[64:67], a[128:131]
 ds_read_b64_tr_b16 v[242:243], v12 offset:22528
 v_mfma_f32_16x16x32_bf16 a[132:135], v[24:27], v[68:71], a[132:135]
 ds_read_b64_tr_b16 v[244:245], v13 offset:20480
 v_mfma_f32_16x16x32_bf16 a[136:139], v[28:31], v[64:67], a[136:139]
 ds_read_b64_tr_b16 v[246:247], v13 offset:22528
 v_mfma_f32_16x16x32_bf16 a[140:143], v[28:31], v[68:71], a[140:143]
 ds_read_b64_tr_b16 v[24:25], v8 offset:24576
 v_mfma_f32_16x16x32_bf16 a[144:147], v[32:35], v[64:67], a[144:147]
 ds_read_b64_tr_b16 v[26:27], v8 offset:26624
 v_mfma_f32_16x16x32_bf16 a[148:151], v[32:35], v[68:71], a[148:151]
 ds_read_b64_tr_b16 v[28:29], v9 offset:24576
 v_mfma_f32_16x16x32_bf16 a[152:155], v[36:39], v[64:67], a[152:155]
 ds_read_b64_tr_b16 v[30:31], v9 offset:26624
 v_mfma_f32_16x16x32_bf16 a[156:159], v[36:39], v[68:71], a[156:159]
 ds_read_b64_tr_b16 v[32:33], v12 offset:24576
 s_waitcnt lgkmcnt(5)
 v_mfma_f32_16x16x32_bf16 a[128:131], v[40:43], v[72:75], a[128:131]
 ds_read_b64_tr_b16 v[34:35], v12 offset:26624
 v_mfma_f32_16x16x32_bf16 a[132:135], v[40:43], v[76:79], a[132:135]
 ds_read_b64_tr_b16 v[36:37], v13 offset:24576
 v_mfma_f32_16x16x32_bf16 a[136:139], v[44:47], v[72:75], a[136:139]
 ds_read_b64_tr_b16 v[38:39], v13 offset:26624
 v_mfma_f32_16x16x32_bf16 a[140:143], v[44:47], v[76:79], a[140:143]
 ds_read_b64_tr_b16 v[40:41], v8 offset:28672
 v_mfma_f32_16x16x32_bf16 a[144:147], v[240:243], v[72:75], a[144:147]
 ds_read_b64_tr_b16 v[42:43], v8 offset:30720
 v_mfma_f32_16x16x32_bf16 a[148:151], v[240:243], v[76:79], a[148:151]
 ds_read_b64_tr_b16 v[44:45], v9 offset:28672
 v_mfma_f32_16x16x32_bf16 a[152:155], v[244:247], v[72:75], a[152:155]
 ds_read_b64_tr_b16 v[46:47], v9 offset:30720
 v_mfma_f32_16x16x32_bf16 a[156:159], v[244:247], v[76:79], a[156:159]
 ds_read_b64_tr_b16 v[240:241], v12 offset:28672
 s_waitcnt lgkmcnt(5)
 v_mfma_f32_16x16x32_bf16 a[128:131], v[24:27], v[80:83], a[128:131]
 ds_read_b64_tr_b16 v[242:243], v12 offset:30720
 v_mfma_f32_16x16x32_bf16 a[132:135], v[24:27], v[84:87], a[132:135]
 ds_read_b64_tr_b16 v[244:245], v13 offset:28672
 v_mfma_f32_16x16x32_bf16 a[136:139], v[28:31], v[80:83], a[136:139]
 ds_read_b64_tr_b16 v[246:247], v13 offset:30720
 v_mfma_f32_16x16x32_bf16 a[140:143], v[28:31], v[84:87], a[140:143]
 v_mfma_f32_16x16x32_bf16 a[144:147], v[32:35], v[80:83], a[144:147]
 v_mfma_f32_16x16x32_bf16 a[148:151], v[32:35], v[84:87], a[148:151]
 v_mfma_f32_16x16x32_bf16 a[152:155], v[36:39], v[80:83], a[152:155]
 v_mfma_f32_16x16x32_bf16 a[156:159], v[36:39], v[84:87], a[156:159]
 s_waitcnt vmcnt(4) lgkmcnt(0)
 s_barrier
 ds_read_b64_tr_b16 v[24:25], v8 offset:32768
 ds_read_b64_tr_b16 v[28:29], v9 offset:32768
 ds_read_b64_tr_b16 v[26:27], v8 offset:34816
 ds_read_b64_tr_b16 v[32:33], v12 offset:32768
 ds_read_b64_tr_b16 v[30:31], v9 offset:34816
 v_add_u32 v252, 0, v250
 v_add_u32 v253, 8192, v250
 v_mfma_f32_16x16x32_bf16 a[128:131], v[40:43], v[88:91], a[128:131]
 ds_read_b64_tr_b16 v[34:35], v12 offset:34816
 v_add_u32 v254, 16384, v250
 v_add_u32 v255, 24576, v250
 s_add_u32 m0, s50, 16384
 s_add_u32 s46, s66, s87
 buffer_load_dwordx4 v252, s[28:31], s46 offen offset:0 lds
 v_mfma_f32_16x16x32_bf16 a[132:135], v[40:43], v[92:95], a[132:135]
 ds_read_b64_tr_b16 v[36:37], v13 offset:32768
 v_mfma_f32_16x16x32_bf16 a[136:139], v[44:47], v[88:91], a[136:139]
 ds_read_b64_tr_b16 v[38:39], v13 offset:34816
 buffer_load_dwordx4 v253, s[28:31], s46 offen offset:1024 lds
 v_mfma_f32_16x16x32_bf16 a[140:143], v[44:47], v[92:95], a[140:143]
 ds_read_b64_tr_b16 v[40:41], v8 offset:36864
 v_mfma_f32_16x16x32_bf16 a[144:147], v[240:243], v[88:91], a[144:147]
 ds_read_b64_tr_b16 v[42:43], v8 offset:38912
 buffer_load_dwordx4 v254, s[28:31], s46 offen offset:2048 lds
 v_mfma_f32_16x16x32_bf16 a[148:151], v[240:243], v[92:95], a[148:151]
 ds_read_b64_tr_b16 v[44:45], v9 offset:36864
 v_mfma_f32_16x16x32_bf16 a[152:155], v[244:247], v[88:91], a[152:155]
 ds_read_b64_tr_b16 v[46:47], v9 offset:38912
 buffer_load_dwordx4 v255, s[28:31], s46 offen offset:3072 lds
 v_mfma_f32_16x16x32_bf16 a[156:159], v[244:247], v[92:95], a[156:159]
 ds_read_b64_tr_b16 v[240:241], v12 offset:36864
 s_waitcnt lgkmcnt(5)
 v_mfma_f32_16x16x32_bf16 a[160:163], v[24:27], v[64:67], a[160:163]
 ds_read_b64_tr_b16 v[242:243], v12 offset:38912
 v_mfma_f32_16x16x32_bf16 a[164:167], v[24:27], v[68:71], a[164:167]
 ds_read_b64_tr_b16 v[244:245], v13 offset:36864
 v_mfma_f32_16x16x32_bf16 a[168:171], v[28:31], v[64:67], a[168:171]
 ds_read_b64_tr_b16 v[246:247], v13 offset:38912
 v_mfma_f32_16x16x32_bf16 a[172:175], v[28:31], v[68:71], a[172:175]
 ds_read_b64_tr_b16 v[24:25], v8 offset:40960
 v_mfma_f32_16x16x32_bf16 a[176:179], v[32:35], v[64:67], a[176:179]
 ds_read_b64_tr_b16 v[26:27], v8 offset:43008
 v_mfma_f32_16x16x32_bf16 a[180:183], v[32:35], v[68:71], a[180:183]
 ds_read_b64_tr_b16 v[28:29], v9 offset:40960
 v_mfma_f32_16x16x32_bf16 a[184:187], v[36:39], v[64:67], a[184:187]
 ds_read_b64_tr_b16 v[30:31], v9 offset:43008
 v_mfma_f32_16x16x32_bf16 a[188:191], v[36:39], v[68:71], a[188:191]
 ds_read_b64_tr_b16 v[32:33], v12 offset:40960
 s_waitcnt lgkmcnt(5)
 v_mfma_f32_16x16x32_bf16 a[160:163], v[40:43], v[72:75], a[160:163]
 ds_read_b64_tr_b16 v[34:35], v12 offset:43008
 v_mfma_f32_16x16x32_bf16 a[164:167], v[40:43], v[76:79], a[164:167]
 ds_read_b64_tr_b16 v[36:37], v13 offset:40960
 v_mfma_f32_16x16x32_bf16 a[168:171], v[44:47], v[72:75], a[168:171]
 ds_read_b64_tr_b16 v[38:39], v13 offset:43008
 v_mfma_f32_16x16x32_bf16 a[172:175], v[44:47], v[76:79], a[172:175]
 ds_read_b64_tr_b16 v[40:41], v8 offset:45056
 v_mfma_f32_16x16x32_bf16 a[176:179], v[240:243], v[72:75], a[176:179]
 ds_read_b64_tr_b16 v[42:43], v8 offset:47104
 v_mfma_f32_16x16x32_bf16 a[180:183], v[240:243], v[76:79], a[180:183]
 ds_read_b64_tr_b16 v[44:45], v9 offset:45056
 v_mfma_f32_16x16x32_bf16 a[184:187], v[244:247], v[72:75], a[184:187]
 ds_read_b64_tr_b16 v[46:47], v9 offset:47104
 v_mfma_f32_16x16x32_bf16 a[188:191], v[244:247], v[76:79], a[188:191]
 ds_read_b64_tr_b16 v[240:241], v12 offset:45056
 s_waitcnt lgkmcnt(5)
 v_mfma_f32_16x16x32_bf16 a[160:163], v[24:27], v[80:83], a[160:163]
 ds_read_b64_tr_b16 v[242:243], v12 offset:47104
 v_mfma_f32_16x16x32_bf16 a[164:167], v[24:27], v[84:87], a[164:167]
 ds_read_b64_tr_b16 v[244:245], v13 offset:45056
 v_mfma_f32_16x16x32_bf16 a[168:171], v[28:31], v[80:83], a[168:171]
 ds_read_b64_tr_b16 v[246:247], v13 offset:47104
 v_mfma_f32_16x16x32_bf16 a[172:175], v[28:31], v[84:87], a[172:175]
 v_mfma_f32_16x16x32_bf16 a[176:179], v[32:35], v[80:83], a[176:179]
 v_mfma_f32_16x16x32_bf16 a[180:183], v[32:35], v[84:87], a[180:183]
 v_mfma_f32_16x16x32_bf16 a[184:187], v[36:39], v[80:83], a[184:187]
 v_mfma_f32_16x16x32_bf16 a[188:191], v[36:39], v[84:87], a[188:191]
 s_waitcnt vmcnt(4) lgkmcnt(0)
 s_barrier
 ds_read_b64_tr_b16 v[24:25], v8 offset:0
 ds_read_b64_tr_b16 v[28:29], v9 offset:0
 ds_read_b64_tr_b16 v[26:27], v8 offset:2048
 ds_read_b64_tr_b16 v[32:33], v12 offset:0
 ds_read_b64_tr_b16 v[30:31], v9 offset:2048
 v_add_u32 v252, 0, v250
 v_add_u32 v253, 8192, v250
 v_mfma_f32_16x16x32_bf16 a[160:163], v[40:43], v[88:91], a[160:163]
 ds_read_b64_tr_b16 v[34:35], v12 offset:2048
 v_add_u32 v254, 16384, v250
 v_add_u32 v255, 24576, v250
 s_add_u32 m0, s50, 32768
 s_add_u32 s46, s66, s88
 buffer_load_dwordx4 v252, s[28:31], s46 offen offset:0 lds
 v_mfma_f32_16x16x32_bf16 a[164:167], v[40:43], v[92:95], a[164:167]
 ds_read_b64_tr_b16 v[36:37], v13 offset:0
 v_mfma_f32_16x16x32_bf16 a[168:171], v[44:47], v[88:91], a[168:171]
 ds_read_b64_tr_b16 v[38:39], v13 offset:2048
 buffer_load_dwordx4 v253, s[28:31], s46 offen offset:1024 lds
 v_mfma_f32_16x16x32_bf16 a[172:175], v[44:47], v[92:95], a[172:175]
 ds_read_b64_tr_b16 v[40:41], v8 offset:4096
 v_mfma_f32_16x16x32_bf16 a[176:179], v[240:243], v[88:91], a[176:179]
 ds_read_b64_tr_b16 v[42:43], v8 offset:6144
 buffer_load_dwordx4 v254, s[28:31], s46 offen offset:2048 lds
 v_mfma_f32_16x16x32_bf16 a[180:183], v[240:243], v[92:95], a[180:183]
 ds_read_b64_tr_b16 v[44:45], v9 offset:4096
 buffer_load_dwordx4 v255, s[28:31], s46 offen offset:3072 lds
 v_mfma_f32_16x16x32_bf16 a[184:187], v[244:247], v[88:91], a[184:187]
 ds_read_b64_tr_b16 v[46:47], v9 offset:6144
 s_add_u32 s66, s66, 147456
 v_mfma_f32_16x16x32_bf16 a[188:191], v[244:247], v[92:95], a[188:191]
 ds_read_b64_tr_b16 v[240:241], v12 offset:4096
 s_waitcnt lgkmcnt(5)
 v_mfma_f32_16x16x32_bf16 a[192:195], v[24:27], v[64:67], a[192:195]
 ds_read_b64_tr_b16 v[242:243], v12 offset:6144
 v_mfma_f32_16x16x32_bf16 a[196:199], v[24:27], v[68:71], a[196:199]
 ds_read_b64_tr_b16 v[244:245], v13 offset:4096
 v_mfma_f32_16x16x32_bf16 a[200:203], v[28:31], v[64:67], a[200:203]
 ds_read_b64_tr_b16 v[246:247], v13 offset:6144
 v_mfma_f32_16x16x32_bf16 a[204:207], v[28:31], v[68:71], a[204:207]
 ds_read_b64_tr_b16 v[24:25], v8 offset:8192
 v_mfma_f32_16x16x32_bf16 a[208:211], v[32:35], v[64:67], a[208:211]
 ds_read_b64_tr_b16 v[26:27], v8 offset:10240
 v_mfma_f32_16x16x32_bf16 a[212:215], v[32:35], v[68:71], a[212:215]
 ds_read_b64_tr_b16 v[28:29], v9 offset:8192
 v_mfma_f32_16x16x32_bf16 a[216:219], v[36:39], v[64:67], a[216:219]
 ds_read_b64_tr_b16 v[30:31], v9 offset:10240
 v_mfma_f32_16x16x32_bf16 a[220:223], v[36:39], v[68:71], a[220:223]
 ds_read_b64_tr_b16 v[32:33], v12 offset:8192
 s_waitcnt lgkmcnt(5)
 v_mfma_f32_16x16x32_bf16 a[192:195], v[40:43], v[72:75], a[192:195]
 ds_read_b64_tr_b16 v[34:35], v12 offset:10240
 v_mfma_f32_16x16x32_bf16 a[196:199], v[40:43], v[76:79], a[196:199]
 ds_read_b64_tr_b16 v[36:37], v13 offset:8192
 v_mfma_f32_16x16x32_bf16 a[200:203], v[44:47], v[72:75], a[200:203]
 ds_read_b64_tr_b16 v[38:39], v13 offset:10240
 v_mfma_f32_16x16x32_bf16 a[204:207], v[44:47], v[76:79], a[204:207]
 ds_read_b64_tr_b16 v[40:41], v8 offset:12288
 v_mfma_f32_16x16x32_bf16 a[208:211], v[240:243], v[72:75], a[208:211]
 ds_read_b64_tr_b16 v[42:43], v8 offset:14336
 v_mfma_f32_16x16x32_bf16 a[212:215], v[240:243], v[76:79], a[212:215]
 ds_read_b64_tr_b16 v[44:45], v9 offset:12288
 v_mfma_f32_16x16x32_bf16 a[216:219], v[244:247], v[72:75], a[216:219]
 ds_read_b64_tr_b16 v[46:47], v9 offset:14336
 v_mfma_f32_16x16x32_bf16 a[220:223], v[244:247], v[76:79], a[220:223]
 ds_read_b64_tr_b16 v[240:241], v12 offset:12288
 s_waitcnt lgkmcnt(5)
 v_mfma_f32_16x16x32_bf16 a[192:195], v[24:27], v[80:83], a[192:195]
 ds_read_b64_tr_b16 v[242:243], v12 offset:14336
 v_mfma_f32_16x16x32_bf16 a[196:199], v[24:27], v[84:87], a[196:199]
 ds_read_b64_tr_b16 v[244:245], v13 offset:12288
 v_mfma_f32_16x16x32_bf16 a[200:203], v[28:31], v[80:83], a[200:203]
 ds_read_b64_tr_b16 v[246:247], v13 offset:14336
 v_mfma_f32_16x16x32_bf16 a[204:207], v[28:31], v[84:87], a[204:207]
 v_mfma_f32_16x16x32_bf16 a[208:211], v[32:35], v[80:83], a[208:211]
 v_mfma_f32_16x16x32_bf16 a[212:215], v[32:35], v[84:87], a[212:215]
 v_mfma_f32_16x16x32_bf16 a[216:219], v[36:39], v[80:83], a[216:219]
 v_mfma_f32_16x16x32_bf16 a[220:223], v[36:39], v[84:87], a[220:223]
 s_waitcnt vmcnt(4) lgkmcnt(0)
 s_barrier
 ds_read_b64_tr_b16 v[24:25], v8 offset:16384
 ds_read_b64_tr_b16 v[28:29], v9 offset:16384
 ds_read_b64_tr_b16 v[26:27], v8 offset:18432
 ds_read_b64_tr_b16 v[32:33], v12 offset:16384
 ds_read_b64_tr_b16 v[30:31], v9 offset:18432
 v_mov_b32 v252, v251
 v_xor_b32 v253, s67, v251
 v_xor_b32 v254, s100, v251
 v_mfma_f32_16x16x32_bf16 a[192:195], v[40:43], v[88:91], a[192:195]
 ds_read_b64_tr_b16 v[34:35], v12 offset:18432
 v_xor_b32 v255, s100, v253
 s_add_u32 m0, s50, 0
 s_add_u32 s46, s90, 24576
 s_and_b32 s46, s46, 0x1ffff
 s_add_u32 s46, s46, s91
 buffer_load_dwordx4 v252, s[96:99], s46 offen offset:0 nt lds
 v_mfma_f32_16x16x32_bf16 a[196:199], v[40:43], v[92:95], a[196:199]
 ds_read_b64_tr_b16 v[36:37], v13 offset:16384
 v_mfma_f32_16x16x32_bf16 a[200:203], v[44:47], v[88:91], a[200:203]
 ds_read_b64_tr_b16 v[38:39], v13 offset:18432
 buffer_load_dwordx4 v253, s[96:99], s46 offen offset:1024 nt lds
 v_mfma_f32_16x16x32_bf16 a[204:207], v[44:47], v[92:95], a[204:207]
 ds_read_b64_tr_b16 v[40:41], v8 offset:20480
 v_mfma_f32_16x16x32_bf16 a[208:211], v[240:243], v[88:91], a[208:211]
 ds_read_b64_tr_b16 v[42:43], v8 offset:22528
 buffer_load_dwordx4 v254, s[96:99], s46 offen offset:2048 nt lds
 v_mfma_f32_16x16x32_bf16 a[212:215], v[240:243], v[92:95], a[212:215]
 ds_read_b64_tr_b16 v[44:45], v9 offset:20480
 v_mfma_f32_16x16x32_bf16 a[216:219], v[244:247], v[88:91], a[216:219]
 ds_read_b64_tr_b16 v[46:47], v9 offset:22528
 buffer_load_dwordx4 v255, s[96:99], s46 offen offset:3072 nt lds
 v_mfma_f32_16x16x32_bf16 a[220:223], v[244:247], v[92:95], a[220:223]
 ds_read_b64_tr_b16 v[240:241], v12 offset:20480
 s_waitcnt lgkmcnt(5)
 v_mfma_f32_16x16x32_bf16 a[224:227], v[24:27], v[64:67], a[224:227]
 ds_read_b64_tr_b16 v[242:243], v12 offset:22528
 v_mfma_f32_16x16x32_bf16 a[228:231], v[24:27], v[68:71], a[228:231]
 ds_read_b64_tr_b16 v[244:245], v13 offset:20480
 v_mfma_f32_16x16x32_bf16 a[232:235], v[28:31], v[64:67], a[232:235]
 ds_read_b64_tr_b16 v[246:247], v13 offset:22528
 v_mfma_f32_16x16x32_bf16 a[236:239], v[28:31], v[68:71], a[236:239]
 ds_read_b64_tr_b16 v[24:25], v8 offset:24576
 v_mfma_f32_16x16x32_bf16 a[240:243], v[32:35], v[64:67], a[240:243]
 ds_read_b64_tr_b16 v[26:27], v8 offset:26624
 v_mfma_f32_16x16x32_bf16 a[244:247], v[32:35], v[68:71], a[244:247]
 ds_read_b64_tr_b16 v[28:29], v9 offset:24576
 v_mfma_f32_16x16x32_bf16 a[248:251], v[36:39], v[64:67], a[248:251]
 ds_read_b64_tr_b16 v[30:31], v9 offset:26624
 v_mfma_f32_16x16x32_bf16 a[252:255], v[36:39], v[68:71], a[252:255]
 ds_read_b64_tr_b16 v[32:33], v12 offset:24576
 s_waitcnt lgkmcnt(5)
 v_mfma_f32_16x16x32_bf16 a[224:227], v[40:43], v[72:75], a[224:227]
 ds_read_b64_tr_b16 v[34:35], v12 offset:26624
 v_mfma_f32_16x16x32_bf16 a[228:231], v[40:43], v[76:79], a[228:231]
 ds_read_b64_tr_b16 v[36:37], v13 offset:24576
 v_mfma_f32_16x16x32_bf16 a[232:235], v[44:47], v[72:75], a[232:235]
 ds_read_b64_tr_b16 v[38:39], v13 offset:26624
 v_mfma_f32_16x16x32_bf16 a[236:239], v[44:47], v[76:79], a[236:239]
 ds_read_b64_tr_b16 v[40:41], v8 offset:28672
 v_mfma_f32_16x16x32_bf16 a[240:243], v[240:243], v[72:75], a[240:243]
 ds_read_b64_tr_b16 v[42:43], v8 offset:30720
 v_mfma_f32_16x16x32_bf16 a[244:247], v[240:243], v[76:79], a[244:247]
 ds_read_b64_tr_b16 v[44:45], v9 offset:28672
 v_mfma_f32_16x16x32_bf16 a[248:251], v[244:247], v[72:75], a[248:251]
 ds_read_b64_tr_b16 v[46:47], v9 offset:30720
 v_mfma_f32_16x16x32_bf16 a[252:255], v[244:247], v[76:79], a[252:255]
 ds_read_b64_tr_b16 v[240:241], v12 offset:28672
 s_waitcnt lgkmcnt(5)
 v_mfma_f32_16x16x32_bf16 a[224:227], v[24:27], v[80:83], a[224:227]
 ds_read_b64_tr_b16 v[242:243], v12 offset:30720
 v_mfma_f32_16x16x32_bf16 a[228:231], v[24:27], v[84:87], a[228:231]
 ds_read_b64_tr_b16 v[244:245], v13 offset:28672
 v_mfma_f32_16x16x32_bf16 a[232:235], v[28:31], v[80:83], a[232:235]
 ds_read_b64_tr_b16 v[246:247], v13 offset:30720
 v_mfma_f32_16x16x32_bf16 a[236:239], v[28:31], v[84:87], a[236:239]
 v_mfma_f32_16x16x32_bf16 a[240:243], v[32:35], v[80:83], a[240:243]
 v_mfma_f32_16x16x32_bf16 a[244:247], v[32:35], v[84:87], a[244:247]
 v_mfma_f32_16x16x32_bf16 a[248:251], v[36:39], v[80:83], a[248:251]
 v_mfma_f32_16x16x32_bf16 a[252:255], v[36:39], v[84:87], a[252:255]
 s_waitcnt vmcnt(4) lgkmcnt(0)
 s_barrier
 ds_read_b64_tr_b16 v[24:25], v8 offset:32768
 ds_read_b64_tr_b16 v[28:29], v9 offset:32768
 ds_read_b64_tr_b16 v[26:27], v8 offset:34816
 ds_read_b64_tr_b16 v[32:33], v12 offset:32768
 ds_read_b64_tr_b16 v[30:31], v9 offset:34816
 v_mov_b32 v252, v251
 v_xor_b32 v253, s67, v251
 v_xor_b32 v254, s100, v251
 v_mfma_f32_16x16x32_bf16 a[224:227], v[40:43], v[88:91], a[224:227]
 ds_read_b64_tr_b16 v[34:35], v12 offset:34816
 v_xor_b32 v255, s100, v253
 s_add_u32 m0, s50, 16384
 s_add_u32 s46, s90, 32768
 s_and_b32 s46, s46, 0x1ffff
 s_add_u32 s46, s46, s91
 buffer_load_dwordx4 v252, s[96:99], s46 offen offset:0 nt lds
 v_mfma_f32_16x16x32_bf16 a[228:231], v[40:43], v[92:95], a[228:231]
 ds_read_b64_tr_b16 v[36:37], v13 offset:32768
 v_mfma_f32_16x16x32_bf16 a[232:235], v[44:47], v[88:91], a[232:235]
 ds_read_b64_tr_b16 v[38:39], v13 offset:34816
 buffer_load_dwordx4 v253, s[96:99], s46 offen offset:1024 nt lds
 v_mfma_f32_16x16x32_bf16 a[236:239], v[44:47], v[92:95], a[236:239]
 ds_read_b64_tr_b16 v[40:41], v8 offset:36864
 v_mfma_f32_16x16x32_bf16 a[240:243], v[240:243], v[88:91], a[240:243]
 ds_read_b64_tr_b16 v[42:43], v8 offset:38912
 buffer_load_dwordx4 v254, s[96:99], s46 offen offset:2048 nt lds
 v_mfma_f32_16x16x32_bf16 a[244:247], v[240:243], v[92:95], a[244:247]
 ds_read_b64_tr_b16 v[44:45], v9 offset:36864
 v_mfma_f32_16x16x32_bf16 a[248:251], v[244:247], v[88:91], a[248:251]
 ds_read_b64_tr_b16 v[46:47], v9 offset:38912
 buffer_load_dwordx4 v255, s[96:99], s46 offen offset:3072 nt lds
 v_mfma_f32_16x16x32_bf16 a[252:255], v[244:247], v[92:95], a[252:255]
 ds_read_b64_tr_b16 v[240:241], v12 offset:36864
 s_waitcnt lgkmcnt(5)
 v_mfma_f32_16x16x32_bf16 v[208:211], v[24:27], v[64:67], v[208:211]
 ds_read_b64_tr_b16 v[242:243], v12 offset:38912
 v_mfma_f32_16x16x32_bf16 v[212:215], v[24:27], v[68:71], v[212:215]
 ds_read_b64_tr_b16 v[244:245], v13 offset:36864
 v_mfma_f32_16x16x32_bf16 v[216:219], v[28:31], v[64:67], v[216:219]
 ds_read_b64_tr_b16 v[246:247], v13 offset:38912
 v_mfma_f32_16x16x32_bf16 v[220:223], v[28:31], v[68:71], v[220:223]
 ds_read_b64_tr_b16 v[24:25], v8 offset:40960
 v_mfma_f32_16x16x32_bf16 v[224:227], v[32:35], v[64:67], v[224:227]
 ds_read_b64_tr_b16 v[26:27], v8 offset:43008
 v_mfma_f32_16x16x32_bf16 v[228:231], v[32:35], v[68:71], v[228:231]
 ds_read_b64_tr_b16 v[28:29], v9 offset:40960
 v_mfma_f32_16x16x32_bf16 v[232:235], v[36:39], v[64:67], v[232:235]
 ds_read_b64_tr_b16 v[30:31], v9 offset:43008
 v_mfma_f32_16x16x32_bf16 v[236:239], v[36:39], v[68:71], v[236:239]
 ds_read_b64_tr_b16 v[32:33], v12 offset:40960
 s_waitcnt lgkmcnt(5)
 v_mfma_f32_16x16x32_bf16 v[208:211], v[40:43], v[72:75], v[208:211]
 ds_read_b64_tr_b16 v[34:35], v12 offset:43008
 v_mfma_f32_16x16x32_bf16 v[212:215], v[40:43], v[76:79], v[212:215]
 ds_read_b64_tr_b16 v[36:37], v13 offset:40960
 v_mfma_f32_16x16x32_bf16 v[216:219], v[44:47], v[72:75], v[216:219]
 ds_read_b64_tr_b16 v[38:39], v13 offset:43008
 v_mfma_f32_16x16x32_bf16 v[220:223], v[44:47], v[76:79], v[220:223]
 ds_read_b64_tr_b16 v[40:41], v8 offset:45056
 v_mfma_f32_16x16x32_bf16 v[224:227], v[240:243], v[72:75], v[224:227]
 ds_read_b64_tr_b16 v[42:43], v8 offset:47104
 s_add_u32 s47, s47, 1
 v_mfma_f32_16x16x32_bf16 v[228:231], v[240:243], v[76:79], v[228:231]
 ds_read_b64_tr_b16 v[44:45], v9 offset:45056
 v_mfma_f32_16x16x32_bf16 v[232:235], v[244:247], v[72:75], v[232:235]
 ds_read_b64_tr_b16 v[46:47], v9 offset:47104
 v_mfma_f32_16x16x32_bf16 v[236:239], v[244:247], v[76:79], v[236:239]
 ds_read_b64_tr_b16 v[240:241], v12 offset:45056
 s_waitcnt lgkmcnt(5)
 v_mfma_f32_16x16x32_bf16 v[208:211], v[24:27], v[80:83], v[208:211]
 ds_read_b64_tr_b16 v[242:243], v12 offset:47104
 v_mfma_f32_16x16x32_bf16 v[212:215], v[24:27], v[84:87], v[212:215]
 ds_read_b64_tr_b16 v[244:245], v13 offset:45056
 ds_read_b64_tr_b16 v[246:247], v13 offset:47104
 v_mfma_f32_16x16x32_bf16 v[216:219], v[28:31], v[80:83], v[216:219]
 v_mfma_f32_16x16x32_bf16 v[220:223], v[28:31], v[84:87], v[220:223]
 v_mfma_f32_16x16x32_bf16 v[224:227], v[32:35], v[80:83], v[224:227]
 v_mfma_f32_16x16x32_bf16 v[228:231], v[32:35], v[84:87], v[228:231]
 v_mfma_f32_16x16x32_bf16 v[232:235], v[36:39], v[80:83], v[232:235]
 v_mfma_f32_16x16x32_bf16 v[236:239], v[36:39], v[84:87], v[236:239]
 v_sub_u32 v8, v8, v10
 v_sub_u32 v9, v9, v10
 v_sub_u32 v12, v12, v10
 v_sub_u32 v13, v13, v10
 s_waitcnt vmcnt(48) lgkmcnt(0)
 s_barrier
 ds_read_b128 v[128:131], v3 offset:0
 ds_read_b128 v[132:135], v3 offset:1024
 ds_read_b128 v[136:139], v3 offset:2048
 ds_read_b128 v[140:143], v3 offset:3072
 ds_read_b128 v[24:27], v4 offset:49152
 ds_read_b128 v[28:31], v5 offset:49152
 ds_read_b128 v[32:35], v4 offset:49664
 v_mfma_f32_16x16x32_bf16 v[208:211], v[40:43], v[88:91], v[208:211]
 v_mfma_f32_16x16x32_bf16 v[212:215], v[40:43], v[92:95], v[212:215]
 ds_read_b128 v[36:39], v5 offset:49664
 v_mfma_f32_16x16x32_bf16 v[216:219], v[44:47], v[88:91], v[216:219]
 v_mfma_f32_16x16x32_bf16 v[220:223], v[44:47], v[92:95], v[220:223]
 ds_read_b128 v[40:43], v4 offset:53248
 v_mfma_f32_16x16x32_bf16 v[224:227], v[240:243], v[88:91], v[224:227]
 v_mfma_f32_16x16x32_bf16 v[228:231], v[240:243], v[92:95], v[228:231]
 ds_read_b128 v[44:47], v5 offset:53248
 v_mfma_f32_16x16x32_bf16 v[232:235], v[244:247], v[88:91], v[232:235]
 v_mfma_f32_16x16x32_bf16 v[236:239], v[244:247], v[92:95], v[236:239]
 s_branch L_item
L_stub_1_0:
 s_call_b64 s[40:41], L_rare1
 s_branch L_back_1_0
L_stub_2_1:
 s_call_b64 s[40:41], L_rare0
 s_branch L_back_2_1
L_stub_3_2:
 s_call_b64 s[40:41], L_rare1
 s_branch L_back_3_2
L_stub_4_3:
 s_call_b64 s[40:41], L_rare0
 s_branch L_back_4_3
L_stub_5_4:
 s_call_b64 s[40:41], L_rare1
 s_branch L_back_5_4
L_stub_6_5:
 s_call_b64 s[40:41], L_rare0
 s_branch L_back_6_5
L_stub_7_6:
 s_call_b64 s[40:41], L_rare1
 s_branch L_back_7_6
L_stub_8_7:
 s_call_b64 s[40:41], L_rare0
 s_branch L_back_8_7
L_stub_9_8:
 s_call_b64 s[40:41], L_rare1
 s_branch L_back_9_8
L_stub_10_9:
 s_call_b64 s[40:41], L_rare0
 s_branch L_back_10_9
L_stub_11_10:
 s_call_b64 s[40:41], L_rare1
 s_branch L_back_11_10
L_stub_12_11:
 s_call_b64 s[40:41], L_rare0
 s_branch L_back_12_11
L_stub_13_12:
 s_call_b64 s[40:41], L_rare1
 s_branch L_back_13_12
L_stub_14_13:
 s_call_b64 s[40:41], L_rare0
 s_branch L_back_14_13
L_stub_15_14:
 s_call_b64 s[40:41], L_rare1
 s_branch L_back_15_14
L_rare0:
 s_nop 15
 s_nop 15
 v_max3_f32 v20, v64, v65, v66
 v_max3_f32 v11, v72, v73, v74
 v_max3_f32 v20, v20, v67, v68
 v_max3_f32 v11, v11, v75, v76
 v_max3_f32 v20, v20, v69, v70
 v_max3_f32 v11, v11, v77, v78
 v_max_f32 v20, v20, v71
 v_max_f32 v11, v11, v79
 s_nop 1
 v_permlane16_swap_b32 v20, v11
 v_max_f32 v20, v20, v11
 v_mov_b32 v21, v20
 s_nop 1
 v_permlane32_swap_b32 v20, v21
 v_max_f32 v20, v20, v21
 v_mov_b32 v11, v20
 s_nop 1
 v_permlane16_swap_b32 v20, v11
 v_max_f32 v20, 0, v20
 v_max_f32 v11, 0, v11
 v_sub_f32 v48, v48, v20
 v_sub_f32 v49, v49, v20
 v_sub_f32 v50, v50, v20
 v_sub_f32 v51, v51, v20
 v_sub_f32 v52, v52, v11
 v_sub_f32 v53, v53, v11
 v_sub_f32 v54, v54, v11
 v_sub_f32 v55, v55, v11
 v_sub_f32 v64, v64, v20
 v_sub_f32 v80, v80, v20
 v_sub_f32 v65, v65, v20
 v_sub_f32 v81, v81, v20
 v_sub_f32 v66, v66, v20
 v_sub_f32 v82, v82, v20
 v_sub_f32 v67, v67, v20
 v_sub_f32 v83, v83, v20
 v_sub_f32 v68, v68, v20
 v_sub_f32 v84, v84, v20
 v_sub_f32 v69, v69, v20
 v_sub_f32 v85, v85, v20
 v_sub_f32 v70, v70, v20
 v_sub_f32 v86, v86, v20
 v_sub_f32 v71, v71, v20
 v_sub_f32 v87, v87, v20
 v_sub_f32 v72, v72, v11
 v_sub_f32 v88, v88, v11
 v_sub_f32 v73, v73, v11
 v_sub_f32 v89, v89, v11
 v_sub_f32 v74, v74, v11
 v_sub_f32 v90, v90, v11
 v_sub_f32 v75, v75, v11
 v_sub_f32 v91, v91, v11
 v_sub_f32 v76, v76, v11
 v_sub_f32 v92, v92, v11
 v_sub_f32 v77, v77, v11
 v_sub_f32 v93, v93, v11
 v_sub_f32 v78, v78, v11
 v_sub_f32 v94, v94, v11
 v_sub_f32 v79, v79, v11
 v_sub_f32 v95, v95, v11
 v_exp_f32 v20, -v20
 v_exp_f32 v11, -v11
 s_nop 0
 v_mul_f32 v14, v14, v20
 v_mul_f32 v56, v56, v11
 v_mul_f32 v144, v144, v20
 v_mul_f32 v145, v145, v20
 v_mul_f32 v146, v146, v20
 v_mul_f32 v147, v147, v20
 v_mul_f32 v148, v148, v11
 v_mul_f32 v149, v149, v11
 v_mul_f32 v150, v150, v11
 v_mul_f32 v151, v151, v11
 v_mul_f32 v152, v152, v20
 v_mul_f32 v153, v153, v20
 v_mul_f32 v154, v154, v20
 v_mul_f32 v155, v155, v20
 v_mul_f32 v156, v156, v11
 v_mul_f32 v157, v157, v11
 v_mul_f32 v158, v158, v11
 v_mul_f32 v159, v159, v11
 v_mul_f32 v160, v160, v20
 v_mul_f32 v161, v161, v20
 v_mul_f32 v162, v162, v20
 v_mul_f32 v163, v163, v20
 v_mul_f32 v164, v164, v11
 v_mul_f32 v165, v165, v11
 v_mul_f32 v166, v166, v11
 v_mul_f32 v167, v167, v11
 v_mul_f32 v168, v168, v20
 v_mul_f32 v169, v169, v20
 v_mul_f32 v170, v170, v20
 v_mul_f32 v171, v171, v20
 v_mul_f32 v172, v172, v11
 v_mul_f32 v173, v173, v11
 v_mul_f32 v174, v174, v11
 v_mul_f32 v175, v175, v11
 v_mul_f32 v176, v176, v20
 v_mul_f32 v177, v177, v20
 v_mul_f32 v178, v178, v20
 v_mul_f32 v179, v179, v20
 v_mul_f32 v180, v180, v11
 v_mul_f32 v181, v181, v11
 v_mul_f32 v182, v182, v11
 v_mul_f32 v183, v183, v11
 v_mul_f32 v184, v184, v20
 v_mul_f32 v185, v185, v20
 v_mul_f32 v186, v186, v20
 v_mul_f32 v187, v187, v20
 v_mul_f32 v188, v188, v11
 v_mul_f32 v189, v189, v11
 v_mul_f32 v190, v190, v11
 v_mul_f32 v191, v191, v11
 v_mul_f32 v192, v192, v20
 v_mul_f32 v193, v193, v20
 v_mul_f32 v194, v194, v20
 v_mul_f32 v195, v195, v20
 v_mul_f32 v196, v196, v11
 v_mul_f32 v197, v197, v11
 v_mul_f32 v198, v198, v11
 v_mul_f32 v199, v199, v11
 v_mul_f32 v200, v200, v20
 v_mul_f32 v201, v201, v20
 v_mul_f32 v202, v202, v20
 v_mul_f32 v203, v203, v20
 v_mul_f32 v204, v204, v11
 v_mul_f32 v205, v205, v11
 v_mul_f32 v206, v206, v11
 v_mul_f32 v207, v207, v11
 v_exp_f32 v16, v64
 v_exp_f32 v17, v65
 v_exp_f32 v18, v66
 v_add_f32 v15, v16, v17
 v_exp_f32 v19, v67
 v_cvt_pk_bf16_f32 v96, v16, v17
 v_exp_f32 v16, v68
 v_add_f32 v15, v15, v18
 v_exp_f32 v17, v69
 v_cvt_pk_bf16_f32 v97, v18, v19
 v_add_f32 v15, v15, v19
 v_exp_f32 v18, v70
 v_add_f32 v15, v15, v16
 v_exp_f32 v19, v71
 v_cvt_pk_bf16_f32 v98, v16, v17
 v_add_f32 v15, v15, v17
 v_exp_f32 v16, v72
 v_add_f32 v15, v15, v18
 v_exp_f32 v17, v73
 v_cvt_pk_bf16_f32 v99, v18, v19
 v_add_f32 v15, v15, v19
 v_exp_f32 v18, v74
 v_add_f32 v57, v16, v17
 v_exp_f32 v19, v75
 v_cvt_pk_bf16_f32 v100, v16, v17
 v_exp_f32 v16, v76
 v_add_f32 v57, v57, v18
 v_exp_f32 v17, v77
 v_cvt_pk_bf16_f32 v101, v18, v19
 v_add_f32 v57, v57, v19
 v_exp_f32 v18, v78
 v_add_f32 v57, v57, v16
 v_exp_f32 v19, v79
 v_cvt_pk_bf16_f32 v102, v16, v17
 v_add_f32 v57, v57, v17
 v_add_f32 v57, v57, v18
 v_cvt_pk_bf16_f32 v103, v18, v19
 v_add_f32 v57, v57, v19
 s_nop 3
 s_setpc_b64 s[40:41]
L_rare1:
 s_nop 15
 s_nop 15
 v_max3_f32 v20, v80, v81, v82
 v_max3_f32 v11, v88, v89, v90
 v_max3_f32 v20, v20, v83, v84
 v_max3_f32 v11, v11, v91, v92
 v_max3_f32 v20, v20, v85, v86
 v_max3_f32 v11, v11, v93, v94
 v_max_f32 v20, v20, v87
 v_max_f32 v11, v11, v95
 s_nop 1
 v_permlane16_swap_b32 v20, v11
 v_max_f32 v20, v20, v11
 v_mov_b32 v21, v20
 s_nop 1
 v_permlane32_swap_b32 v20, v21
 v_max_f32 v20, v20, v21
 v_mov_b32 v11, v20
 s_nop 1
 v_permlane16_swap_b32 v20, v11
 v_max_f32 v20, 0, v20
 v_max_f32 v11, 0, v11
 v_sub_f32 v48, v48, v20
 v_sub_f32 v49, v49, v20
 v_sub_f32 v50, v50, v20
 v_sub_f32 v51, v51, v20
 v_sub_f32 v52, v52, v11
 v_sub_f32 v53, v53, v11
 v_sub_f32 v54, v54, v11
 v_sub_f32 v55, v55, v11
 v_sub_f32 v80, v80, v20
 v_sub_f32 v64, v64, v20
 v_sub_f32 v81, v81, v20
 v_sub_f32 v65, v65, v20
 v_sub_f32 v82, v82, v20
 v_sub_f32 v66, v66, v20
 v_sub_f32 v83, v83, v20
 v_sub_f32 v67, v67, v20
 v_sub_f32 v84, v84, v20
 v_sub_f32 v68, v68, v20
 v_sub_f32 v85, v85, v20
 v_sub_f32 v69, v69, v20
 v_sub_f32 v86, v86, v20
 v_sub_f32 v70, v70, v20
 v_sub_f32 v87, v87, v20
 v_sub_f32 v71, v71, v20
 v_sub_f32 v88, v88, v11
 v_sub_f32 v72, v72, v11
 v_sub_f32 v89, v89, v11
 v_sub_f32 v73, v73, v11
 v_sub_f32 v90, v90, v11
 v_sub_f32 v74, v74, v11
 v_sub_f32 v91, v91, v11
 v_sub_f32 v75, v75, v11
 v_sub_f32 v92, v92, v11
 v_sub_f32 v76, v76, v11
 v_sub_f32 v93, v93, v11
 v_sub_f32 v77, v77, v11
 v_sub_f32 v94, v94, v11
 v_sub_f32 v78, v78, v11
 v_sub_f32 v95, v95, v11
 v_sub_f32 v79, v79, v11
 v_exp_f32 v20, -v20
 v_exp_f32 v11, -v11
 s_nop 0
 v_mul_f32 v14, v14, v20
 v_mul_f32 v56, v56, v11
 v_mul_f32 v144, v144, v20
 v_mul_f32 v145, v145, v20
 v_mul_f32 v146, v146, v20
 v_mul_f32 v147, v147, v20
 v_mul_f32 v148, v148, v11
 v_mul_f32 v149, v149, v11
 v_mul_f32 v150, v150, v11
 v_mul_f32 v151, v151, v11
 v_mul_f32 v152, v152, v20
 v_mul_f32 v153, v153, v20
 v_mul_f32 v154, v154, v20
 v_mul_f32 v155, v155, v20
 v_mul_f32 v156, v156, v11
 v_mul_f32 v157, v157, v11
 v_mul_f32 v158, v158, v11
 v_mul_f32 v159, v159, v11
 v_mul_f32 v160, v160, v20
 v_mul_f32 v161, v161, v20
 v_mul_f32 v162, v162, v20
 v_mul_f32 v163, v163, v20
 v_mul_f32 v164, v164, v11
 v_mul_f32 v165, v165, v11
 v_mul_f32 v166, v166, v11
 v_mul_f32 v167, v167, v11
 v_mul_f32 v168, v168, v20
 v_mul_f32 v169, v169, v20
 v_mul_f32 v170, v170, v20
 v_mul_f32 v171, v171, v20
 v_mul_f32 v172, v172, v11
 v_mul_f32 v173, v173, v11
 v_mul_f32 v174, v174, v11
 v_mul_f32 v175, v175, v11
 v_mul_f32 v176, v176, v20
 v_mul_f32 v177, v177, v20
 v_mul_f32 v178, v178, v20
 v_mul_f32 v179, v179, v20
 v_mul_f32 v180, v180, v11
 v_mul_f32 v181, v181, v11
 v_mul_f32 v182, v182, v11
 v_mul_f32 v183, v183, v11
 v_mul_f32 v184, v184, v20
 v_mul_f32 v185, v185, v20
 v_mul_f32 v186, v186, v20
 v_mul_f32 v187, v187, v20
 v_mul_f32 v188, v188, v11
 v_mul_f32 v189, v189, v11
 v_mul_f32 v190, v190, v11
 v_mul_f32 v191, v191, v11
 v_mul_f32 v192, v192, v20
 v_mul_f32 v193, v193, v20
 v_mul_f32 v194, v194, v20
 v_mul_f32 v195, v195, v20
 v_mul_f32 v196, v196, v11
 v_mul_f32 v197, v197, v11
 v_mul_f32 v198, v198, v11
 v_mul_f32 v199, v199, v11
 v_mul_f32 v200, v200, v20
 v_mul_f32 v201, v201, v20
 v_mul_f32 v202, v202, v20
 v_mul_f32 v203, v203, v20
 v_mul_f32 v204, v204, v11
 v_mul_f32 v205, v205, v11
 v_mul_f32 v206, v206, v11
 v_mul_f32 v207, v207, v11
 v_exp_f32 v16, v80
 v_exp_f32 v17, v81
 v_exp_f32 v18, v82
 v_add_f32 v15, v16, v17
 v_exp_f32 v19, v83
 v_cvt_pk_bf16_f32 v104, v16, v17
 v_exp_f32 v16, v84
 v_add_f32 v15, v15, v18
 v_exp_f32 v17, v85
 v_cvt_pk_bf16_f32 v105, v18, v19
 v_add_f32 v15, v15, v19
 v_exp_f32 v18, v86
 v_add_f32 v15, v15, v16
 v_exp_f32 v19, v87
 v_cvt_pk_bf16_f32 v106, v16, v17
 v_add_f32 v15, v15, v17
 v_exp_f32 v16, v88
 v_add_f32 v15, v15, v18
 v_exp_f32 v17, v89
 v_cvt_pk_bf16_f32 v107, v18, v19
 v_add_f32 v15, v15, v19
 v_exp_f32 v18, v90
 v_add_f32 v57, v16, v17
 v_exp_f32 v19, v91
 v_cvt_pk_bf16_f32 v108, v16, v17
 v_exp_f32 v16, v92
 v_add_f32 v57, v57, v18
 v_exp_f32 v17, v93
 v_cvt_pk_bf16_f32 v109, v18, v19
 v_add_f32 v57, v57, v19
 v_exp_f32 v18, v94
 v_add_f32 v57, v57, v16
 v_exp_f32 v19, v95
 v_cvt_pk_bf16_f32 v110, v16, v17
 v_add_f32 v57, v57, v17
 v_add_f32 v57, v57, v18
 v_cvt_pk_bf16_f32 v111, v18, v19
 v_add_f32 v57, v57, v19
 s_nop 3
 s_setpc_b64 s[40:41]
L_loader:
 v_lshrrev_b32 v1, 4, v0
 v_and_b32 v2, 15, v0
 v_lshrrev_b32 v16, 1, v2
 v_xor_b32 v16, v16, v1
 v_lshlrev_b32 v2, 7, v2
 v_lshl_add_u32 v4, v16, 4, v2
 v_xor_b32 v5, 64, v4
 v_lshrrev_b32 v1, 4, v0
 v_lshrrev_b32 v2, 2, v0
 v_and_b32 v2, 3, v2
 v_lshl_add_u32 v16, v1, 3, v2
 v_lshlrev_b32 v16, 7, v16
 v_lshrrev_b32 v2, 1, v2
 v_lshl_add_u32 v16, v2, 6, v16
 v_and_b32 v2, 1, v1
 v_lshl_add_u32 v16, v2, 5, v16
 v_and_b32 v2, 3, v0
 v_lshl_add_u32 v6, v2, 3, v16
 v_xor_b32 v7, 32, v6
 v_xor_b32 v8, 64, v6
 v_xor_b32 v9, 96, v6
 v_lshlrev_b32 v22, 4, v0
 v_lshrrev_b32 v1, 3, v0
 v_and_b32 v2, 7, v0
 v_lshrrev_b32 v3, 4, v0
 v_and_b32 v16, 1, v3
 v_lshlrev_b32 v16, 2, v16
 v_xor_b32 v16, v16, v2
 v_lshlrev_b32 v16, 4, v16
 v_lshlrev_b32 v18, 8, v1
 v_lshlrev_b32 v19, 13, v1
 v_mul_u32_u24 v20, 1152, v1
 v_add_u32 v17, 0, v3
 v_and_b32 v17, 7, v17
 v_xor_b32 v17, v17, v2
 v_lshlrev_b32 v17, 4, v17
 v_add_u32 v17, 0, v17
 v_add_u32 v176, v17, v20
 v_xor_b32 v17, 0, v16
 v_add_u32 v17, 0, v17
 v_add_u32 v32, v17, v19
 v_lshrrev_b32 v21, 5, v0
 v_lshlrev_b32 v21, 5, v21
 v_xor_b32 v21, v21, v16
 v_add_u32 v17, 0, v21
 v_add_u32 v36, v17, v20
 v_add_u32 v17, 4, v3
 v_and_b32 v17, 7, v17
 v_xor_b32 v17, v17, v2
 v_lshlrev_b32 v17, 4, v17
 v_add_u32 v17, 8192, v17
 v_add_u32 v177, v17, v20
 v_xor_b32 v17, 32, v16
 v_add_u32 v17, 64512, v17
 v_add_u32 v33, v17, v19
 v_lshrrev_b32 v21, 5, v0
 v_lshlrev_b32 v21, 5, v21
 v_xor_b32 v21, v21, v16
 v_add_u32 v17, 8192, v21
 v_add_u32 v37, v17, v20
 v_add_u32 v17, 8, v3
 v_and_b32 v17, 7, v17
 v_xor_b32 v17, v17, v2
 v_lshlrev_b32 v17, 4, v17
 v_add_u32 v17, 16384, v17
 v_add_u32 v178, v17, v20
 v_xor_b32 v17, 0, v16
 v_add_u32 v17, 129024, v17
 v_add_u32 v34, v17, v19
 v_lshrrev_b32 v21, 5, v0
 v_lshlrev_b32 v21, 5, v21
 v_xor_b32 v21, v21, v16
 v_add_u32 v17, 16384, v21
 v_add_u32 v38, v17, v20
 v_add_u32 v17, 12, v3
 v_and_b32 v17, 7, v17
 v_xor_b32 v17, v17, v2
 v_lshlrev_b32 v17, 4, v17
 v_add_u32 v17, 24576, v17
 v_add_u32 v179, v17, v20
 v_xor_b32 v17, 32, v16
 v_add_u32 v17, 193536, v17
 v_add_u32 v35, v17, v19
 v_lshrrev_b32 v21, 5, v0
 v_lshlrev_b32 v21, 5, v21
 v_xor_b32 v21, v21, v16
 v_add_u32 v17, 24576, v21
 v_add_u32 v39, v17, v20
 v_lshrrev_b32 v1, 3, v0
 v_and_b32 v1, 3, v1
 v_and_b32 v2, 7, v0
 v_lshrrev_b32 v16, 5, v0
 v_lshlrev_b32 v16, 7, v16
 v_lshl_add_u32 v16, v1, 8, v16
 v_and_b32 v1, 2, v1
 v_xor_b32 v17, v1, v2
 v_lshl_add_u32 v24, v17, 4, v16
 v_lshlrev_b32 v1, 1, v1
 v_xor_b32 v17, v1, v2
 v_lshl_add_u32 v28, v17, 4, v16
 v_xor_b32 v25, 16, v24
 v_xor_b32 v29, 32, v28
 v_xor_b32 v26, 64, v24
 v_xor_b32 v30, 0, v28
 v_xor_b32 v27, 80, v24
 v_xor_b32 v31, 32, v28
 s_and_b32 s56, s4, 15
 v_mov_b32 v21, 0x7fffff00
 v_cmp_gt_u32 vcc, 36, v0
 v_lshrrev_b32 v12, 1, v0
 v_lshlrev_b32 v12, 13, v12
 v_and_b32 v17, 1, v0
 v_lshlrev_b32 v17, 7, v17
 v_add_u32 v12, v12, v17
 s_mul_i32 s57, s56, 294912
 v_add_u32 v12, s57, v12
 v_cndmask_b32 v12, v21, v12, vcc
 v_lshlrev_b32 v13, 7, v0
 s_mul_i32 s57, s56, 9216
 v_add_u32 v13, s57, v13
 v_cndmask_b32 v13, v21, v13, vcc
 v_cmp_gt_u32 vcc, 54, v0
 v_lshlrev_b32 v14, 7, v0
 s_and_b32 s57, s59, 1
 s_mul_i32 s57, s57, 55296
 v_add_u32 v14, s57, v14
 v_cndmask_b32 v14, v21, v14, vcc
 s_waitcnt lgkmcnt(0)
 s_mov_b32 s24, s12
 s_mov_b32 s25, s13
 s_mov_b32 s26, 4718592
 s_mov_b32 s27, 0x20000
 s_mov_b32 s32, s40
 s_mov_b32 s33, s41
 s_mov_b32 s34, 1769472
 s_mov_b32 s35, 0x20000
 s_mov_b32 s36, s54
 s_mov_b32 s37, s55
 s_mov_b32 s38, 290848768
 s_mov_b32 s39, 0x20000
 s_mov_b32 s16, s8
 s_mov_b32 s17, s9
 s_mov_b32 s18, 67108864
 s_mov_b32 s19, 0x20000
 s_mov_b32 s20, s10
 s_mov_b32 s21, s11
 s_mov_b32 s22, 67108864
 s_mov_b32 s23, 0x20000
 s_mov_b32 s28, s14
 s_mov_b32 s29, s15
 s_mov_b32 s30, 4718592
 s_mov_b32 s31, 0x20000
 s_mov_b32 s92, s12
 s_mov_b32 s93, s13
 s_mov_b32 s94, 4718592
 s_mov_b32 s95, 0x20000
 s_mov_b32 s72, s76
 s_mov_b32 s73, s77
 s_mov_b32 s74, 3538944
 s_mov_b32 s75, 0x20000
 s_mov_b32 s68, s78
 s_mov_b32 s69, s79
 s_mov_b32 s70, 256
 s_mov_b32 s71, 0x20000
 s_lshl_b32 s15, s59, 1
 s_add_u32 s15, s15, s4
 s_lshl_b32 s15, s15, 13
 s_mov_b32 m0, 0
 s_add_u32 s46, s44, 0
 buffer_load_dwordx4 v32, s[24:27], s46 offen offset:0 lds
 buffer_load_dwordx4 v33, s[24:27], s46 offen offset:1024 lds
 buffer_load_dwordx4 v34, s[24:27], s46 offen offset:2048 lds
 buffer_load_dwordx4 v35, s[24:27], s46 offen offset:3072 lds
 s_mov_b32 m0, 4096
 s_add_u32 s46, s44, 128
 buffer_load_dwordx4 v32, s[24:27], s46 offen offset:0 lds
 buffer_load_dwordx4 v33, s[24:27], s46 offen offset:1024 lds
 buffer_load_dwordx4 v34, s[24:27], s46 offen offset:2048 lds
 buffer_load_dwordx4 v35, s[24:27], s46 offen offset:3072 lds
 s_mov_b32 m0, 8192
 s_add_u32 s46, s44, 262144
 buffer_load_dwordx4 v32, s[24:27], s46 offen offset:0 lds
 buffer_load_dwordx4 v33, s[24:27], s46 offen offset:1024 lds
 buffer_load_dwordx4 v34, s[24:27], s46 offen offset:2048 lds
 buffer_load_dwordx4 v35, s[24:27], s46 offen offset:3072 lds
 s_mov_b32 m0, 12288
 s_add_u32 s46, s44, 262272
 buffer_load_dwordx4 v32, s[24:27], s46 offen offset:0 lds
 buffer_load_dwordx4 v33, s[24:27], s46 offen offset:1024 lds
 buffer_load_dwordx4 v34, s[24:27], s46 offen offset:2048 lds
 buffer_load_dwordx4 v35, s[24:27], s46 offen offset:3072 lds
 s_mov_b32 m0, 126976
 s_add_u32 s46, s43, 0
 buffer_load_dwordx4 v176, s[32:35], s46 offen offset:0 lds
 buffer_load_dwordx4 v177, s[32:35], s46 offen offset:1024 lds
 buffer_load_dwordx4 v178, s[32:35], s46 offen offset:2048 lds
 buffer_load_dwordx4 v179, s[32:35], s46 offen offset:3072 lds
 s_mov_b32 m0, 131072
 s_add_u32 s46, s43, 36864
 buffer_load_dwordx4 v176, s[32:35], s46 offen offset:0 lds
 buffer_load_dwordx4 v177, s[32:35], s46 offen offset:1024 lds
 buffer_load_dwordx4 v178, s[32:35], s46 offen offset:2048 lds
 buffer_load_dwordx4 v179, s[32:35], s46 offen offset:3072 lds
 s_mov_b32 m0, 135168
 s_add_u32 s46, s43, 73728
 buffer_load_dwordx4 v176, s[32:35], s46 offen offset:0 lds
 buffer_load_dwordx4 v177, s[32:35], s46 offen offset:1024 lds
 buffer_load_dwordx4 v178, s[32:35], s46 offen offset:2048 lds
 buffer_load_dwordx4 v179, s[32:35], s46 offen offset:3072 lds
 v_and_b32 v1, 7, v0
 v_lshlrev_b32 v1, 2, v1
 buffer_load_dword v23, v1, s[36:39], s89 offen sc1
 s_mov_b32 m0, 16384
 s_add_u32 s46, s44, 524288
 buffer_load_dwordx4 v32, s[24:27], s46 offen offset:0 lds
 buffer_load_dwordx4 v33, s[24:27], s46 offen offset:1024 lds
 buffer_load_dwordx4 v34, s[24:27], s46 offen offset:2048 lds
 buffer_load_dwordx4 v35, s[24:27], s46 offen offset:3072 lds
 s_mov_b32 m0, 20480
 s_add_u32 s46, s44, 524416
 buffer_load_dwordx4 v32, s[24:27], s46 offen offset:0 lds
 buffer_load_dwordx4 v33, s[24:27], s46 offen offset:1024 lds
 buffer_load_dwordx4 v34, s[24:27], s46 offen offset:2048 lds
 buffer_load_dwordx4 v35, s[24:27], s46 offen offset:3072 lds
 s_mov_b32 m0, 24576
 s_add_u32 s46, s44, 786432
 buffer_load_dwordx4 v32, s[24:27], s46 offen offset:0 lds
 buffer_load_dwordx4 v33, s[24:27], s46 offen offset:1024 lds
 buffer_load_dwordx4 v34, s[24:27], s46 offen offset:2048 lds
 buffer_load_dwordx4 v35, s[24:27], s46 offen offset:3072 lds
 s_mov_b32 m0, 28672
 s_add_u32 s46, s44, 786560
 buffer_load_dwordx4 v32, s[24:27], s46 offen offset:0 lds
 buffer_load_dwordx4 v33, s[24:27], s46 offen offset:1024 lds
 buffer_load_dwordx4 v34, s[24:27], s46 offen offset:2048 lds
 buffer_load_dwordx4 v35, s[24:27], s46 offen offset:3072 lds
 s_mov_b32 m0, 98304
 s_add_u32 s46, s43, 128
 buffer_load_dwordx4 v176, s[32:35], s46 offen offset:0 lds
 buffer_load_dwordx4 v177, s[32:35], s46 offen offset:1024 lds
 buffer_load_dwordx4 v178, s[32:35], s46 offen offset:2048 lds
 buffer_load_dwordx4 v179, s[32:35], s46 offen offset:3072 lds
 s_mov_b32 m0, 102400
 s_add_u32 s46, s43, 36992
 buffer_load_dwordx4 v176, s[32:35], s46 offen offset:0 lds
 buffer_load_dwordx4 v177, s[32:35], s46 offen offset:1024 lds
 buffer_load_dwordx4 v178, s[32:35], s46 offen offset:2048 lds
 buffer_load_dwordx4 v179, s[32:35], s46 offen offset:3072 lds
 s_mov_b32 m0, 106496
 s_add_u32 s46, s43, 73856
 buffer_load_dwordx4 v176, s[32:35], s46 offen offset:0 lds
 buffer_load_dwordx4 v177, s[32:35], s46 offen offset:1024 lds
 buffer_load_dwordx4 v178, s[32:35], s46 offen offset:2048 lds
 buffer_load_dwordx4 v179, s[32:35], s46 offen offset:3072 lds
 s_mov_b32 m0, 32768
 s_add_u32 s46, s44, 1048576
 buffer_load_dwordx4 v32, s[24:27], s46 offen offset:0 lds
 buffer_load_dwordx4 v33, s[24:27], s46 offen offset:1024 lds
 buffer_load_dwordx4 v34, s[24:27], s46 offen offset:2048 lds
 buffer_load_dwordx4 v35, s[24:27], s46 offen offset:3072 lds
 s_mov_b32 m0, 36864
 s_add_u32 s46, s44, 1048704
 buffer_load_dwordx4 v32, s[24:27], s46 offen offset:0 lds
 buffer_load_dwordx4 v33, s[24:27], s46 offen offset:1024 lds
 buffer_load_dwordx4 v34, s[24:27], s46 offen offset:2048 lds
 buffer_load_dwordx4 v35, s[24:27], s46 offen offset:3072 lds
 s_mov_b32 m0, 40960
 s_add_u32 s46, s44, 1310720
 buffer_load_dwordx4 v32, s[24:27], s46 offen offset:0 lds
 buffer_load_dwordx4 v33, s[24:27], s46 offen offset:1024 lds
 buffer_load_dwordx4 v34, s[24:27], s46 offen offset:2048 lds
 buffer_load_dwordx4 v35, s[24:27], s46 offen offset:3072 lds
 s_mov_b32 m0, 45056
 s_add_u32 s46, s44, 1310848
 buffer_load_dwordx4 v32, s[24:27], s46 offen offset:0 lds
 buffer_load_dwordx4 v33, s[24:27], s46 offen offset:1024 lds
 buffer_load_dwordx4 v34, s[24:27], s46 offen offset:2048 lds
 buffer_load_dwordx4 v35, s[24:27], s46 offen offset:3072 lds
 s_mov_b32 m0, 110592
 s_add_u32 s46, s43, 256
 buffer_load_dwordx4 v176, s[32:35], s46 offen offset:0 lds
 buffer_load_dwordx4 v177, s[32:35], s46 offen offset:1024 lds
 buffer_load_dwordx4 v178, s[32:35], s46 offen offset:2048 lds
 buffer_load_dwordx4 v179, s[32:35], s46 offen offset:3072 lds
 s_mov_b32 m0, 114688
 s_add_u32 s46, s43, 37120
 buffer_load_dwordx4 v176, s[32:35], s46 offen offset:0 lds
 buffer_load_dwordx4 v177, s[32:35], s46 offen offset:1024 lds
 buffer_load_dwordx4 v178, s[32:35], s46 offen offset:2048 lds
 buffer_load_dwordx4 v179, s[32:35], s46 offen offset:3072 lds
 s_mov_b32 m0, 118784
 s_add_u32 s46, s43, 73984
 buffer_load_dwordx4 v176, s[32:35], s46 offen offset:0 lds
 buffer_load_dwordx4 v177, s[32:35], s46 offen offset:1024 lds
 buffer_load_dwordx4 v178, s[32:35], s46 offen offset:2048 lds
 buffer_load_dwordx4 v179, s[32:35], s46 offen offset:3072 lds
 s_waitcnt vmcnt(56)
 s_waitcnt lgkmcnt(0)
 s_barrier
 s_lshl_b32 s56, s53, 2
 v_mov_b32 v16, s56
 v_mov_b32 v17, 1
 s_mov_b64 exec, 1
 buffer_atomic_add v17, v16, s[68:71], 0 offen offset:0 sc1
 s_mov_b64 exec, -1
 v_add_u32 v4, 126976, v4
 ds_read_b128 a[0:3], v4 offset:0
 ds_read_b128 a[4:7], v4 offset:2048
 ds_read_b128 a[8:11], v4 offset:4096
 ds_read_b128 a[12:15], v4 offset:6144
 ds_read_b128 a[16:19], v4 offset:8192
 ds_read_b128 a[20:23], v4 offset:10240
 v_add_u32 v5, 126976, v5
 ds_read_b128 a[24:27], v5 offset:0
 ds_read_b128 a[28:31], v5 offset:2048
 ds_read_b128 a[32:35], v5 offset:4096
 ds_read_b128 a[36:39], v5 offset:6144
 ds_read_b128 a[40:43], v5 offset:8192
 ds_read_b128 a[44:47], v5 offset:10240
 s_waitcnt vmcnt(29)
 s_waitcnt lgkmcnt(0)
 s_barrier
 v_add_u32 v4, 4294938624, v4
 ds_read_b128 a[48:51], v4 offset:0
 ds_read_b128 a[52:55], v4 offset:2048
 ds_read_b128 a[56:59], v4 offset:4096
 ds_read_b128 a[60:63], v4 offset:6144
 ds_read_b128 a[64:67], v4 offset:8192
 ds_read_b128 a[68:71], v4 offset:10240
 v_add_u32 v5, 4294938624, v5
 ds_read_b128 a[72:75], v5 offset:0
 ds_read_b128 a[76:79], v5 offset:2048
 ds_read_b128 a[80:83], v5 offset:4096
 ds_read_b128 a[84:87], v5 offset:6144
 ds_read_b128 a[88:91], v5 offset:8192
 ds_read_b128 a[92:95], v5 offset:10240
 s_add_u32 s46, s44, 256
 buffer_load_dword v15, v12, s[24:27], s46 offen
 s_add_u32 s46, s44, 147712
 buffer_load_dword v15, v12, s[24:27], s46 offen
 s_mov_b32 m0, 0
 s_add_u32 s46, s44, 1572864
 buffer_load_dwordx4 v32, s[24:27], s46 offen offset:0 lds
 buffer_load_dwordx4 v33, s[24:27], s46 offen offset:1024 lds
 buffer_load_dwordx4 v34, s[24:27], s46 offen offset:2048 lds
 buffer_load_dwordx4 v35, s[24:27], s46 offen offset:3072 lds
 s_mov_b32 m0, 4096
 s_add_u32 s46, s44, 1572992
 buffer_load_dwordx4 v32, s[24:27], s46 offen offset:0 lds
 buffer_load_dwordx4 v33, s[24:27], s46 offen offset:1024 lds
 buffer_load_dwordx4 v34, s[24:27], s46 offen offset:2048 lds
 buffer_load_dwordx4 v35, s[24:27], s46 offen offset:3072 lds
 s_mov_b32 m0, 8192
 s_add_u32 s46, s44, 1835008
 buffer_load_dwordx4 v32, s[24:27], s46 offen offset:0 lds
 buffer_load_dwordx4 v33, s[24:27], s46 offen offset:1024 lds
 buffer_load_dwordx4 v34, s[24:27], s46 offen offset:2048 lds
 buffer_load_dwordx4 v35, s[24:27], s46 offen offset:3072 lds
 s_mov_b32 m0, 12288
 s_add_u32 s46, s44, 1835136
 buffer_load_dwordx4 v32, s[24:27], s46 offen offset:0 lds
 buffer_load_dwordx4 v33, s[24:27], s46 offen offset:1024 lds
 buffer_load_dwordx4 v34, s[24:27], s46 offen offset:2048 lds
 buffer_load_dwordx4 v35, s[24:27], s46 offen offset:3072 lds
 s_mov_b32 m0, 126976
 s_add_u32 s46, s43, 384
 buffer_load_dwordx4 v176, s[32:35], s46 offen offset:0 lds
 buffer_load_dwordx4 v177, s[32:35], s46 offen offset:1024 lds
 buffer_load_dwordx4 v178, s[32:35], s46 offen offset:2048 lds
 buffer_load_dwordx4 v179, s[32:35], s46 offen offset:3072 lds
 s_mov_b32 m0, 131072
 s_add_u32 s46, s43, 37248
 buffer_load_dwordx4 v176, s[32:35], s46 offen offset:0 lds
 buffer_load_dwordx4 v177, s[32:35], s46 offen offset:1024 lds
 buffer_load_dwordx4 v178, s[32:35], s46 offen offset:2048 lds
 buffer_load_dwordx4 v179, s[32:35], s46 offen offset:3072 lds
 s_mov_b32 m0, 135168
 s_add_u32 s46, s43, 74112
 buffer_load_dwordx4 v176, s[32:35], s46 offen offset:0 lds
 buffer_load_dwordx4 v177, s[32:35], s46 offen offset:1024 lds
 buffer_load_dwordx4 v178, s[32:35], s46 offen offset:2048 lds
 buffer_load_dwordx4 v179, s[32:35], s46 offen offset:3072 lds
 s_waitcnt vmcnt(31)
 s_waitcnt lgkmcnt(0)
 s_barrier
 ds_read_b128 a[96:99], v4 offset:12288
 ds_read_b128 a[100:103], v4 offset:14336
 ds_read_b128 a[104:107], v4 offset:16384
 ds_read_b128 a[108:111], v4 offset:18432
 ds_read_b128 a[112:115], v4 offset:20480
 ds_read_b128 a[116:119], v4 offset:22528
 ds_read_b128 a[120:123], v5 offset:12288
 ds_read_b128 a[124:127], v5 offset:14336
 ds_read_b128 a[128:131], v5 offset:16384
 ds_read_b128 a[132:135], v5 offset:18432
 ds_read_b128 a[136:139], v5 offset:20480
 ds_read_b128 a[140:143], v5 offset:22528
 s_mov_b32 m0, 16384
 s_add_u32 s46, s44, 2097152
 buffer_load_dwordx4 v32, s[24:27], s46 offen offset:0 lds
 buffer_load_dwordx4 v33, s[24:27], s46 offen offset:1024 lds
 buffer_load_dwordx4 v34, s[24:27], s46 offen offset:2048 lds
 buffer_load_dwordx4 v35, s[24:27], s46 offen offset:3072 lds
 s_mov_b32 m0, 20480
 s_add_u32 s46, s44, 2097280
 buffer_load_dwordx4 v32, s[24:27], s46 offen offset:0 lds
 buffer_load_dwordx4 v33, s[24:27], s46 offen offset:1024 lds
 buffer_load_dwordx4 v34, s[24:27], s46 offen offset:2048 lds
 buffer_load_dwordx4 v35, s[24:27], s46 offen offset:3072 lds
 s_mov_b32 m0, 24576
 s_add_u32 s46, s44, 2359296
 buffer_load_dwordx4 v32, s[24:27], s46 offen offset:0 lds
 buffer_load_dwordx4 v33, s[24:27], s46 offen offset:1024 lds
 buffer_load_dwordx4 v34, s[24:27], s46 offen offset:2048 lds
 buffer_load_dwordx4 v35, s[24:27], s46 offen offset:3072 lds
 s_mov_b32 m0, 28672
 s_add_u32 s46, s44, 2359424
 buffer_load_dwordx4 v32, s[24:27], s46 offen offset:0 lds
 buffer_load_dwordx4 v33, s[24:27], s46 offen offset:1024 lds
 buffer_load_dwordx4 v34, s[24:27], s46 offen offset:2048 lds
 buffer_load_dwordx4 v35, s[24:27], s46 offen offset:3072 lds
 s_mov_b32 m0, 98304
 s_add_u32 s46, s43, 512
 buffer_load_dwordx4 v176, s[32:35], s46 offen offset:0 lds
 buffer_load_dwordx4 v177, s[32:35], s46 offen offset:1024 lds
 buffer_load_dwordx4 v178, s[32:35], s46 offen offset:2048 lds
 buffer_load_dwordx4 v179, s[32:35], s46 offen offset:3072 lds
 s_mov_b32 m0, 102400
 s_add_u32 s46, s43, 37376
 buffer_load_dwordx4 v176, s[32:35], s46 offen offset:0 lds
 buffer_load_dwordx4 v177, s[32:35], s46 offen offset:1024 lds
 buffer_load_dwordx4 v178, s[32:35], s46 offen offset:2048 lds
 buffer_load_dwordx4 v179, s[32:35], s46 offen offset:3072 lds
 s_mov_b32 m0, 106496
 s_add_u32 s46, s43, 74240
 buffer_load_dwordx4 v176, s[32:35], s46 offen offset:0 lds
 buffer_load_dwordx4 v177, s[32:35], s46 offen offset:1024 lds
 buffer_load_dwordx4 v178, s[32:35], s46 offen offset:2048 lds
 buffer_load_dwordx4 v179, s[32:35], s46 offen offset:3072 lds
 s_waitcnt vmcnt(28)
 s_waitcnt lgkmcnt(0)
 s_barrier
 ds_read_b128 a[144:147], v4 offset:28672
 ds_read_b128 a[148:151], v4 offset:30720
 ds_read_b128 a[152:155], v4 offset:32768
 ds_read_b128 a[156:159], v4 offset:34816
 ds_read_b128 a[160:163], v4 offset:36864
 ds_read_b128 a[164:167], v4 offset:38912
 ds_read_b128 a[168:171], v5 offset:28672
 ds_read_b128 a[172:175], v5 offset:30720
 ds_read_b128 a[176:179], v5 offset:32768
 ds_read_b128 a[180:183], v5 offset:34816
 ds_read_b128 a[184:187], v5 offset:36864
 ds_read_b128 a[188:191], v5 offset:38912
 s_mov_b32 m0, 32768
 s_add_u32 s46, s44, 2621440
 buffer_load_dwordx4 v32, s[24:27], s46 offen offset:0 lds
 buffer_load_dwordx4 v33, s[24:27], s46 offen offset:1024 lds
 buffer_load_dwordx4 v34, s[24:27], s46 offen offset:2048 lds
 buffer_load_dwordx4 v35, s[24:27], s46 offen offset:3072 lds
 s_mov_b32 m0, 36864
 s_add_u32 s46, s44, 2621568
 buffer_load_dwordx4 v32, s[24:27], s46 offen offset:0 lds
 buffer_load_dwordx4 v33, s[24:27], s46 offen offset:1024 lds
 buffer_load_dwordx4 v34, s[24:27], s46 offen offset:2048 lds
 buffer_load_dwordx4 v35, s[24:27], s46 offen offset:3072 lds
 s_mov_b32 m0, 40960
 s_add_u32 s46, s44, 2883584
 buffer_load_dwordx4 v32, s[24:27], s46 offen offset:0 lds
 buffer_load_dwordx4 v33, s[24:27], s46 offen offset:1024 lds
 buffer_load_dwordx4 v34, s[24:27], s46 offen offset:2048 lds
 buffer_load_dwordx4 v35, s[24:27], s46 offen offset:3072 lds
 s_mov_b32 m0, 45056
 s_add_u32 s46, s44, 2883712
 buffer_load_dwordx4 v32, s[24:27], s46 offen offset:0 lds
 buffer_load_dwordx4 v33, s[24:27], s46 offen offset:1024 lds
 buffer_load_dwordx4 v34, s[24:27], s46 offen offset:2048 lds
 buffer_load_dwordx4 v35, s[24:27], s46 offen offset:3072 lds
 s_mov_b32 m0, 110592
 s_add_u32 s46, s43, 640
 buffer_load_dwordx4 v176, s[32:35], s46 offen offset:0 lds
 buffer_load_dwordx4 v177, s[32:35], s46 offen offset:1024 lds
 buffer_load_dwordx4 v178, s[32:35], s46 offen offset:2048 lds
 buffer_load_dwordx4 v179, s[32:35], s46 offen offset:3072 lds
 s_mov_b32 m0, 114688
 s_add_u32 s46, s43, 37504
 buffer_load_dwordx4 v176, s[32:35], s46 offen offset:0 lds
 buffer_load_dwordx4 v177, s[32:35], s46 offen offset:1024 lds
 buffer_load_dwordx4 v178, s[32:35], s46 offen offset:2048 lds
 buffer_load_dwordx4 v179, s[32:35], s46 offen offset:3072 lds
 s_mov_b32 m0, 118784
 s_add_u32 s46, s43, 74368
 buffer_load_dwordx4 v176, s[32:35], s46 offen offset:0 lds
 buffer_load_dwordx4 v177, s[32:35], s46 offen offset:1024 lds
 buffer_load_dwordx4 v178, s[32:35], s46 offen offset:2048 lds
 buffer_load_dwordx4 v179, s[32:35], s46 offen offset:3072 lds
 s_waitcnt vmcnt(28)
 s_waitcnt lgkmcnt(0)
 s_barrier
 ds_read_b128 a[192:195], v4 offset:0
 ds_read_b128 a[196:199], v4 offset:2048
 ds_read_b128 a[200:203], v4 offset:4096
 ds_read_b128 a[204:207], v4 offset:6144
 ds_read_b128 a[208:211], v4 offset:8192
 ds_read_b128 a[212:215], v4 offset:10240
 ds_read_b128 a[216:219], v5 offset:0
 ds_read_b128 a[220:223], v5 offset:2048
 ds_read_b128 a[224:227], v5 offset:4096
 ds_read_b128 a[228:231], v5 offset:6144
 ds_read_b128 a[232:235], v5 offset:8192
 ds_read_b128 a[236:239], v5 offset:10240
 s_mov_b32 m0, 0
 s_add_u32 s46, s44, 3145728
 buffer_load_dwordx4 v32, s[24:27], s46 offen offset:0 lds
 buffer_load_dwordx4 v33, s[24:27], s46 offen offset:1024 lds
 buffer_load_dwordx4 v34, s[24:27], s46 offen offset:2048 lds
 buffer_load_dwordx4 v35, s[24:27], s46 offen offset:3072 lds
 s_mov_b32 m0, 4096
 s_add_u32 s46, s44, 3145856
 buffer_load_dwordx4 v32, s[24:27], s46 offen offset:0 lds
 buffer_load_dwordx4 v33, s[24:27], s46 offen offset:1024 lds
 buffer_load_dwordx4 v34, s[24:27], s46 offen offset:2048 lds
 buffer_load_dwordx4 v35, s[24:27], s46 offen offset:3072 lds
 s_mov_b32 m0, 8192
 s_add_u32 s46, s44, 3407872
 buffer_load_dwordx4 v32, s[24:27], s46 offen offset:0 lds
 buffer_load_dwordx4 v33, s[24:27], s46 offen offset:1024 lds
 buffer_load_dwordx4 v34, s[24:27], s46 offen offset:2048 lds
 buffer_load_dwordx4 v35, s[24:27], s46 offen offset:3072 lds
 s_mov_b32 m0, 12288
 s_add_u32 s46, s44, 3408000
 buffer_load_dwordx4 v32, s[24:27], s46 offen offset:0 lds
 buffer_load_dwordx4 v33, s[24:27], s46 offen offset:1024 lds
 buffer_load_dwordx4 v34, s[24:27], s46 offen offset:2048 lds
 buffer_load_dwordx4 v35, s[24:27], s46 offen offset:3072 lds
 s_mov_b32 m0, 126976
 s_add_u32 s46, s43, 768
 buffer_load_dwordx4 v176, s[32:35], s46 offen offset:0 lds
 buffer_load_dwordx4 v177, s[32:35], s46 offen offset:1024 lds
 buffer_load_dwordx4 v178, s[32:35], s46 offen offset:2048 lds
 buffer_load_dwordx4 v179, s[32:35], s46 offen offset:3072 lds
 s_mov_b32 m0, 131072
 s_add_u32 s46, s43, 37632
 buffer_load_dwordx4 v176, s[32:35], s46 offen offset:0 lds
 buffer_load_dwordx4 v177, s[32:35], s46 offen offset:1024 lds
 buffer_load_dwordx4 v178, s[32:35], s46 offen offset:2048 lds
 buffer_load_dwordx4 v179, s[32:35], s46 offen offset:3072 lds
 s_mov_b32 m0, 135168
 s_add_u32 s46, s43, 74496
 buffer_load_dwordx4 v176, s[32:35], s46 offen offset:0 lds
 buffer_load_dwordx4 v177, s[32:35], s46 offen offset:1024 lds
 buffer_load_dwordx4 v178, s[32:35], s46 offen offset:2048 lds
 buffer_load_dwordx4 v179, s[32:35], s46 offen offset:3072 lds
 s_add_u32 s46, s15, 8192
 s_and_b32 s46, s46, 0x1ffff
 s_add_u32 s46, s46, s42
 s_mov_b32 m0, 61440
 s_add_u32 s46, s46, 4096
 buffer_load_dwordx4 v24, s[16:19], s46 offen offset:0 nt lds
 buffer_load_dwordx4 v25, s[16:19], s46 offen offset:1024 nt lds
 buffer_load_dwordx4 v26, s[16:19], s46 offen offset:2048 nt lds
 buffer_load_dwordx4 v27, s[16:19], s46 offen offset:3072 nt lds
 s_waitcnt vmcnt(32)
 s_waitcnt lgkmcnt(0)
 s_barrier
 ds_read_b128 a[240:243], v4 offset:12288
 ds_read_b128 a[244:247], v4 offset:14336
 ds_read_b128 a[248:251], v4 offset:16384
 ds_read_b128 a[252:255], v4 offset:18432
 ds_read_b128 v[76:79], v4 offset:20480
 ds_read_b128 v[80:83], v4 offset:22528
 ds_read_b128 v[84:87], v5 offset:12288
 ds_read_b128 v[88:91], v5 offset:14336
 ds_read_b128 v[92:95], v5 offset:16384
 ds_read_b128 v[96:99], v5 offset:18432
 ds_read_b128 v[100:103], v5 offset:20480
 ds_read_b128 v[104:107], v5 offset:22528
 s_mov_b32 m0, 16384
 s_add_u32 s46, s44, 3670016
 buffer_load_dwordx4 v32, s[24:27], s46 offen offset:0 lds
 buffer_load_dwordx4 v33, s[24:27], s46 offen offset:1024 lds
 buffer_load_dwordx4 v34, s[24:27], s46 offen offset:2048 lds
 buffer_load_dwordx4 v35, s[24:27], s46 offen offset:3072 lds
 s_mov_b32 m0, 20480
 s_add_u32 s46, s44, 3670144
 buffer_load_dwordx4 v32, s[24:27], s46 offen offset:0 lds
 buffer_load_dwordx4 v33, s[24:27], s46 offen offset:1024 lds
 buffer_load_dwordx4 v34, s[24:27], s46 offen offset:2048 lds
 buffer_load_dwordx4 v35, s[24:27], s46 offen offset:3072 lds
 s_mov_b32 m0, 24576
 s_add_u32 s46, s44, 3932160
 buffer_load_dwordx4 v32, s[24:27], s46 offen offset:0 lds
 buffer_load_dwordx4 v33, s[24:27], s46 offen offset:1024 lds
 buffer_load_dwordx4 v34, s[24:27], s46 offen offset:2048 lds
 buffer_load_dwordx4 v35, s[24:27], s46 offen offset:3072 lds
 s_mov_b32 m0, 28672
 s_add_u32 s46, s44, 3932288
 buffer_load_dwordx4 v32, s[24:27], s46 offen offset:0 lds
 buffer_load_dwordx4 v33, s[24:27], s46 offen offset:1024 lds
 buffer_load_dwordx4 v34, s[24:27], s46 offen offset:2048 lds
 buffer_load_dwordx4 v35, s[24:27], s46 offen offset:3072 lds
 s_mov_b32 m0, 139264
 s_add_u32 s46, s43, 896
 buffer_load_dwordx4 v176, s[32:35], s46 offen offset:0 lds
 buffer_load_dwordx4 v177, s[32:35], s46 offen offset:1024 lds
 buffer_load_dwordx4 v178, s[32:35], s46 offen offset:2048 lds
 buffer_load_dwordx4 v179, s[32:35], s46 offen offset:3072 lds
 s_mov_b32 m0, 143360
 s_add_u32 s46, s43, 37760
 buffer_load_dwordx4 v176, s[32:35], s46 offen offset:0 lds
 buffer_load_dwordx4 v177, s[32:35], s46 offen offset:1024 lds
 buffer_load_dwordx4 v178, s[32:35], s46 offen offset:2048 lds
 buffer_load_dwordx4 v179, s[32:35], s46 offen offset:3072 lds
 s_mov_b32 m0, 147456
 s_add_u32 s46, s43, 74624
 buffer_load_dwordx4 v176, s[32:35], s46 offen offset:0 lds
 buffer_load_dwordx4 v177, s[32:35], s46 offen offset:1024 lds
 buffer_load_dwordx4 v178, s[32:35], s46 offen offset:2048 lds
 buffer_load_dwordx4 v179, s[32:35], s46 offen offset:3072 lds
 s_add_u32 s46, s15, 0
 s_and_b32 s46, s46, 0x1ffff
 s_add_u32 s46, s46, s42
 s_mov_b32 m0, 77824
 s_add_u32 s46, s46, 4096
 buffer_load_dwordx4 v28, s[20:23], s46 offen offset:0 nt lds
 buffer_load_dwordx4 v29, s[20:23], s46 offen offset:1024 nt lds
 buffer_load_dwordx4 v30, s[20:23], s46 offen offset:2048 nt lds
 buffer_load_dwordx4 v31, s[20:23], s46 offen offset:3072 nt lds
 s_waitcnt vmcnt(36)
 s_waitcnt lgkmcnt(0)
 s_barrier
 ds_read_b128 v[108:111], v4 offset:28672
 ds_read_b128 v[112:115], v4 offset:30720
 ds_read_b128 v[116:119], v4 offset:32768
 ds_read_b128 v[120:123], v4 offset:34816
 ds_read_b128 v[124:127], v4 offset:36864
 ds_read_b128 v[128:131], v4 offset:38912
 ds_read_b128 v[132:135], v5 offset:28672
 ds_read_b128 v[136:139], v5 offset:30720
 ds_read_b128 v[140:143], v5 offset:32768
 ds_read_b128 v[144:147], v5 offset:34816
 ds_read_b128 v[148:151], v5 offset:36864
 ds_read_b128 v[152:155], v5 offset:38912
 s_mov_b32 m0, 32768
 s_add_u32 s46, s44, 4194304
 buffer_load_dwordx4 v32, s[24:27], s46 offen offset:0 lds
 buffer_load_dwordx4 v33, s[24:27], s46 offen offset:1024 lds
 buffer_load_dwordx4 v34, s[24:27], s46 offen offset:2048 lds
 buffer_load_dwordx4 v35, s[24:27], s46 offen offset:3072 lds
 s_mov_b32 m0, 36864
 s_add_u32 s46, s44, 4194432
 buffer_load_dwordx4 v32, s[24:27], s46 offen offset:0 lds
 buffer_load_dwordx4 v33, s[24:27], s46 offen offset:1024 lds
 buffer_load_dwordx4 v34, s[24:27], s46 offen offset:2048 lds
 buffer_load_dwordx4 v35, s[24:27], s46 offen offset:3072 lds
 s_mov_b32 m0, 40960
 s_add_u32 s46, s44, 4456448
 buffer_load_dwordx4 v32, s[24:27], s46 offen offset:0 lds
 buffer_load_dwordx4 v33, s[24:27], s46 offen offset:1024 lds
 buffer_load_dwordx4 v34, s[24:27], s46 offen offset:2048 lds
 buffer_load_dwordx4 v35, s[24:27], s46 offen offset:3072 lds
 s_mov_b32 m0, 45056
 s_add_u32 s46, s44, 4456576
 buffer_load_dwordx4 v32, s[24:27], s46 offen offset:0 lds
 buffer_load_dwordx4 v33, s[24:27], s46 offen offset:1024 lds
 buffer_load_dwordx4 v34, s[24:27], s46 offen offset:2048 lds
 buffer_load_dwordx4 v35, s[24:27], s46 offen offset:3072 lds
 s_mov_b32 m0, 151552
 s_add_u32 s46, s43, 1024
 buffer_load_dwordx4 v176, s[32:35], s46 offen offset:0 lds
 buffer_load_dwordx4 v177, s[32:35], s46 offen offset:1024 lds
 buffer_load_dwordx4 v178, s[32:35], s46 offen offset:2048 lds
 buffer_load_dwordx4 v179, s[32:35], s46 offen offset:3072 lds
 s_mov_b32 m0, 155648
 s_add_u32 s46, s43, 37888
 buffer_load_dwordx4 v176, s[32:35], s46 offen offset:0 lds
 buffer_load_dwordx4 v177, s[32:35], s46 offen offset:1024 lds
 buffer_load_dwordx4 v178, s[32:35], s46 offen offset:2048 lds
 buffer_load_dwordx4 v179, s[32:35], s46 offen offset:3072 lds
 s_mov_b32 m0, 159744
 s_add_u32 s46, s43, 74752
 buffer_load_dwordx4 v176, s[32:35], s46 offen offset:0 lds
 buffer_load_dwordx4 v177, s[32:35], s46 offen offset:1024 lds
 buffer_load_dwordx4 v178, s[32:35], s46 offen offset:2048 lds
 buffer_load_dwordx4 v179, s[32:35], s46 offen offset:3072 lds
 s_add_u32 s46, s15, 8192
 s_and_b32 s46, s46, 0x1ffff
 s_add_u32 s46, s46, s42
 s_mov_b32 m0, 94208
 s_add_u32 s46, s46, 4096
 buffer_load_dwordx4 v28, s[20:23], s46 offen offset:0 nt lds
 buffer_load_dwordx4 v29, s[20:23], s46 offen offset:1024 nt lds
 buffer_load_dwordx4 v30, s[20:23], s46 offen offset:2048 nt lds
 buffer_load_dwordx4 v31, s[20:23], s46 offen offset:3072 nt lds
 s_mov_b32 m0, 98304
 s_add_u32 s46, s44, 256
 buffer_load_dwordx4 v32, s[24:27], s46 offen offset:0 lds
 buffer_load_dwordx4 v33, s[24:27], s46 offen offset:1024 lds
 buffer_load_dwordx4 v34, s[24:27], s46 offen offset:2048 lds
 buffer_load_dwordx4 v35, s[24:27], s46 offen offset:3072 lds
 s_mov_b32 m0, 102400
 s_add_u32 s46, s44, 262400
 buffer_load_dwordx4 v32, s[24:27], s46 offen offset:0 lds
 buffer_load_dwordx4 v33, s[24:27], s46 offen offset:1024 lds
 buffer_load_dwordx4 v34, s[24:27], s46 offen offset:2048 lds
 buffer_load_dwordx4 v35, s[24:27], s46 offen offset:3072 lds
 s_mov_b32 m0, 106496
 s_add_u32 s46, s44, 524544
 buffer_load_dwordx4 v32, s[24:27], s46 offen offset:0 lds
 buffer_load_dwordx4 v33, s[24:27], s46 offen offset:1024 lds
 buffer_load_dwordx4 v34, s[24:27], s46 offen offset:2048 lds
 buffer_load_dwordx4 v35, s[24:27], s46 offen offset:3072 lds
 s_mov_b32 m0, 110592
 s_add_u32 s46, s44, 786688
 buffer_load_dwordx4 v32, s[24:27], s46 offen offset:0 lds
 buffer_load_dwordx4 v33, s[24:27], s46 offen offset:1024 lds
 buffer_load_dwordx4 v34, s[24:27], s46 offen offset:2048 lds
 buffer_load_dwordx4 v35, s[24:27], s46 offen offset:3072 lds
 s_waitcnt vmcnt(52)
 s_waitcnt lgkmcnt(0)
 s_barrier
 s_add_u32 s46, s15, 16384
 s_and_b32 s46, s46, 0x1ffff
 s_add_u32 s46, s46, s42
 s_mov_b32 m0, 12288
 s_add_u32 s46, s46, 4096
 buffer_load_dwordx4 v28, s[20:23], s46 offen offset:0 nt lds
 buffer_load_dwordx4 v29, s[20:23], s46 offen offset:1024 nt lds
 buffer_load_dwordx4 v30, s[20:23], s46 offen offset:2048 nt lds
 buffer_load_dwordx4 v31, s[20:23], s46 offen offset:3072 nt lds
 s_mov_b32 m0, 114688
 s_add_u32 s46, s44, 1048832
 buffer_load_dwordx4 v32, s[24:27], s46 offen offset:0 lds
 buffer_load_dwordx4 v33, s[24:27], s46 offen offset:1024 lds
 buffer_load_dwordx4 v34, s[24:27], s46 offen offset:2048 lds
 buffer_load_dwordx4 v35, s[24:27], s46 offen offset:3072 lds
 s_mov_b32 m0, 118784
 s_add_u32 s46, s44, 1310976
 buffer_load_dwordx4 v32, s[24:27], s46 offen offset:0 lds
 buffer_load_dwordx4 v33, s[24:27], s46 offen offset:1024 lds
 buffer_load_dwordx4 v34, s[24:27], s46 offen offset:2048 lds
 buffer_load_dwordx4 v35, s[24:27], s46 offen offset:3072 lds
 s_waitcnt vmcnt(32)
 s_waitcnt lgkmcnt(0)
 s_barrier
 s_add_u32 s46, s15, 24576
 s_and_b32 s46, s46, 0x1ffff
 s_add_u32 s46, s46, s42
 s_mov_b32 m0, 28672
 s_add_u32 s46, s46, 4096
 buffer_load_dwordx4 v28, s[20:23], s46 offen offset:0 nt lds
 buffer_load_dwordx4 v29, s[20:23], s46 offen offset:1024 nt lds
 buffer_load_dwordx4 v30, s[20:23], s46 offen offset:2048 nt lds
 buffer_load_dwordx4 v31, s[20:23], s46 offen offset:3072 nt lds
 v_add_u32 v4, 40960, v4
 v_add_u32 v5, 40960, v5
 v_add_u32 v6, 98304, v6
 v_add_u32 v7, 98304, v7
 v_add_u32 v8, 98304, v8
 v_add_u32 v9, 98304, v9
 v_add_u32 v22, 126976, v22
 s_waitcnt lgkmcnt(0)
L_w3loop:
 s_waitcnt vmcnt(40)
 s_barrier
 s_waitcnt vmcnt(28)
 ds_read_b64_tr_b16 v[40:41], v6 offset:0
 ds_read_b64_tr_b16 v[42:43], v6 offset:512
 ds_read_b64_tr_b16 v[44:45], v7 offset:0
 ds_read_b64_tr_b16 v[46:47], v7 offset:512
 s_waitcnt lgkmcnt(2)
 v_mfma_f32_16x16x32_bf16 v[160:163], v[40:43], a[0:3], 0
 s_add_u32 s46, s15, 32768
 s_and_b32 s46, s46, 0x1ffff
 s_add_u32 s46, s46, s42
 s_mov_b32 m0, 45056
 s_add_u32 s46, s46, 4096
 buffer_load_dwordx4 v28, s[20:23], s46 offen offset:0 nt lds
 v_mfma_f32_16x16x32_bf16 v[164:167], v[40:43], a[4:7], 0
 s_waitcnt vmcnt(25)
 ds_read_b64_tr_b16 v[48:49], v6 offset:4096
 ds_read_b64_tr_b16 v[50:51], v6 offset:4608
 v_mfma_f32_16x16x32_bf16 v[168:171], v[40:43], a[8:11], 0
 buffer_load_dwordx4 v29, s[20:23], s46 offen offset:1024 nt lds
 v_mfma_f32_16x16x32_bf16 v[172:175], v[40:43], a[12:15], 0
 v_mfma_f32_16x16x32_bf16 v[176:179], v[40:43], a[16:19], 0
 buffer_load_dwordx4 v30, s[20:23], s46 offen offset:2048 nt lds
 v_mfma_f32_16x16x32_bf16 v[180:183], v[40:43], a[20:23], 0
 s_waitcnt lgkmcnt(2)
 v_mfma_f32_16x16x32_bf16 v[184:187], v[44:47], a[0:3], 0
 buffer_load_dwordx4 v31, s[20:23], s46 offen offset:3072 nt lds
 v_mfma_f32_16x16x32_bf16 v[188:191], v[44:47], a[4:7], 0
 ds_read_b64_tr_b16 v[40:41], v7 offset:4096
 ds_read_b64_tr_b16 v[42:43], v7 offset:4608
 v_mfma_f32_16x16x32_bf16 v[192:195], v[44:47], a[8:11], 0
 v_mfma_f32_16x16x32_bf16 v[196:199], v[44:47], a[12:15], 0
 v_mfma_f32_16x16x32_bf16 v[200:203], v[44:47], a[16:19], 0
 v_mfma_f32_16x16x32_bf16 v[204:207], v[44:47], a[20:23], 0
 s_waitcnt lgkmcnt(2)
 v_mfma_f32_16x16x32_bf16 v[160:163], v[48:51], a[24:27], v[160:163]
 v_mfma_f32_16x16x32_bf16 v[164:167], v[48:51], a[28:31], v[164:167]
 ds_read_b64_tr_b16 v[44:45], v8 offset:0
 ds_read_b64_tr_b16 v[46:47], v8 offset:512
 v_mfma_f32_16x16x32_bf16 v[168:171], v[48:51], a[32:35], v[168:171]
 v_mfma_f32_16x16x32_bf16 v[172:175], v[48:51], a[36:39], v[172:175]
 v_mfma_f32_16x16x32_bf16 v[176:179], v[48:51], a[40:43], v[176:179]
 v_mfma_f32_16x16x32_bf16 v[180:183], v[48:51], a[44:47], v[180:183]
 s_waitcnt lgkmcnt(2)
 v_mfma_f32_16x16x32_bf16 v[184:187], v[40:43], a[24:27], v[184:187]
 v_mfma_f32_16x16x32_bf16 v[188:191], v[40:43], a[28:31], v[188:191]
 ds_read_b64_tr_b16 v[48:49], v9 offset:0
 ds_read_b64_tr_b16 v[50:51], v9 offset:512
 v_mfma_f32_16x16x32_bf16 v[192:195], v[40:43], a[32:35], v[192:195]
 v_mfma_f32_16x16x32_bf16 v[196:199], v[40:43], a[36:39], v[196:199]
 v_mfma_f32_16x16x32_bf16 v[200:203], v[40:43], a[40:43], v[200:203]
 v_mfma_f32_16x16x32_bf16 v[204:207], v[40:43], a[44:47], v[204:207]
 s_waitcnt lgkmcnt(2)
 v_mfma_f32_16x16x32_bf16 v[208:211], v[44:47], a[0:3], 0
 v_mfma_f32_16x16x32_bf16 v[212:215], v[44:47], a[4:7], 0
 ds_read_b64_tr_b16 v[40:41], v8 offset:4096
 ds_read_b64_tr_b16 v[42:43], v8 offset:4608
 v_mfma_f32_16x16x32_bf16 v[216:219], v[44:47], a[8:11], 0
 v_mfma_f32_16x16x32_bf16 v[220:223], v[44:47], a[12:15], 0
 v_mfma_f32_16x16x32_bf16 v[224:227], v[44:47], a[16:19], 0
 v_mfma_f32_16x16x32_bf16 v[228:231], v[44:47], a[20:23], 0
 s_waitcnt lgkmcnt(2)
 v_mfma_f32_16x16x32_bf16 v[232:235], v[48:51], a[0:3], 0
 v_mfma_f32_16x16x32_bf16 v[236:239], v[48:51], a[4:7], 0
 s_waitcnt vmcnt(40)
 s_barrier
 ds_read_b64_tr_b16 v[44:45], v9 offset:4096
 ds_read_b64_tr_b16 v[46:47], v9 offset:4608
 v_mfma_f32_16x16x32_bf16 v[240:243], v[48:51], a[8:11], 0
 s_add_u32 s46, s15, 40960
 s_and_b32 s46, s46, 0x1ffff
 s_add_u32 s46, s46, s42
 s_mov_b32 m0, 61440
 s_add_u32 s46, s46, 4096
 buffer_load_dwordx4 v28, s[20:23], s46 offen offset:0 nt lds
 v_mfma_f32_16x16x32_bf16 v[244:247], v[48:51], a[12:15], 0
 v_mfma_f32_16x16x32_bf16 v[248:251], v[48:51], a[16:19], 0
 buffer_load_dwordx4 v29, s[20:23], s46 offen offset:1024 nt lds
 v_mfma_f32_16x16x32_bf16 v[252:255], v[48:51], a[20:23], 0
 s_waitcnt lgkmcnt(2)
 v_mfma_f32_16x16x32_bf16 v[208:211], v[40:43], a[24:27], v[208:211]
 buffer_load_dwordx4 v30, s[20:23], s46 offen offset:2048 nt lds
 v_mfma_f32_16x16x32_bf16 v[212:215], v[40:43], a[28:31], v[212:215]
 s_waitcnt vmcnt(27)
 ds_read_b64_tr_b16 v[48:49], v6 offset:8192
 ds_read_b64_tr_b16 v[50:51], v6 offset:8704
 v_mfma_f32_16x16x32_bf16 v[216:219], v[40:43], a[32:35], v[216:219]
 buffer_load_dwordx4 v31, s[20:23], s46 offen offset:3072 nt lds
 v_mfma_f32_16x16x32_bf16 v[220:223], v[40:43], a[36:39], v[220:223]
 v_mfma_f32_16x16x32_bf16 v[224:227], v[40:43], a[40:43], v[224:227]
 s_add_u32 s46, s45, 0
 buffer_load_dword v15, v13, s[28:31], s46 offen
 v_mfma_f32_16x16x32_bf16 v[228:231], v[40:43], a[44:47], v[228:231]
 s_waitcnt lgkmcnt(2)
 v_mfma_f32_16x16x32_bf16 v[232:235], v[44:47], a[24:27], v[232:235]
 s_add_u32 s46, s45, 4608
 buffer_load_dword v15, v13, s[28:31], s46 offen
 v_mfma_f32_16x16x32_bf16 v[236:239], v[44:47], a[28:31], v[236:239]
 ds_read_b64_tr_b16 v[40:41], v8 offset:8192
 ds_read_b64_tr_b16 v[42:43], v8 offset:8704
 v_mfma_f32_16x16x32_bf16 v[240:243], v[44:47], a[32:35], v[240:243]
 s_mov_b32 m0, 98304
 s_add_u32 s46, s44, 3670272
 buffer_load_dwordx4 v32, s[24:27], s46 offen offset:0 lds
 v_mfma_f32_16x16x32_bf16 v[244:247], v[44:47], a[36:39], v[244:247]
 v_mfma_f32_16x16x32_bf16 v[248:251], v[44:47], a[40:43], v[248:251]
 buffer_load_dwordx4 v33, s[24:27], s46 offen offset:1024 lds
 v_mfma_f32_16x16x32_bf16 v[252:255], v[44:47], a[44:47], v[252:255]
 s_waitcnt lgkmcnt(2)
 v_mfma_f32_16x16x32_bf16 v[160:163], v[48:51], a[48:51], v[160:163]
 buffer_load_dwordx4 v34, s[24:27], s46 offen offset:2048 lds
 v_mfma_f32_16x16x32_bf16 v[164:167], v[48:51], a[52:55], v[164:167]
 ds_read_b64_tr_b16 v[44:45], v7 offset:8192
 ds_read_b64_tr_b16 v[46:47], v7 offset:8704
 v_mfma_f32_16x16x32_bf16 v[168:171], v[48:51], a[56:59], v[168:171]
 buffer_load_dwordx4 v35, s[24:27], s46 offen offset:3072 lds
 v_mfma_f32_16x16x32_bf16 v[172:175], v[48:51], a[60:63], v[172:175]
 v_mfma_f32_16x16x32_bf16 v[176:179], v[48:51], a[64:67], v[176:179]
 s_mov_b32 m0, 102400
 s_add_u32 s46, s44, 3932416
 buffer_load_dwordx4 v32, s[24:27], s46 offen offset:0 lds
 v_mfma_f32_16x16x32_bf16 v[180:183], v[48:51], a[68:71], v[180:183]
 s_waitcnt lgkmcnt(2)
 v_mfma_f32_16x16x32_bf16 v[208:211], v[40:43], a[48:51], v[208:211]
 buffer_load_dwordx4 v33, s[24:27], s46 offen offset:1024 lds
 v_mfma_f32_16x16x32_bf16 v[212:215], v[40:43], a[52:55], v[212:215]
 ds_read_b64_tr_b16 v[48:49], v9 offset:8192
 ds_read_b64_tr_b16 v[50:51], v9 offset:8704
 v_mfma_f32_16x16x32_bf16 v[216:219], v[40:43], a[56:59], v[216:219]
 buffer_load_dwordx4 v34, s[24:27], s46 offen offset:2048 lds
 v_mfma_f32_16x16x32_bf16 v[220:223], v[40:43], a[60:63], v[220:223]
 v_mfma_f32_16x16x32_bf16 v[224:227], v[40:43], a[64:67], v[224:227]
 buffer_load_dwordx4 v35, s[24:27], s46 offen offset:3072 lds
 v_mfma_f32_16x16x32_bf16 v[228:231], v[40:43], a[68:71], v[228:231]
 s_waitcnt lgkmcnt(2)
 v_mfma_f32_16x16x32_bf16 v[184:187], v[44:47], a[48:51], v[184:187]
 v_mfma_f32_16x16x32_bf16 v[188:191], v[44:47], a[52:55], v[188:191]
 s_waitcnt vmcnt(34)
 ds_read_b64_tr_b16 v[40:41], v6 offset:12288
 ds_read_b64_tr_b16 v[42:43], v6 offset:12800
 v_mfma_f32_16x16x32_bf16 v[192:195], v[44:47], a[56:59], v[192:195]
 v_mfma_f32_16x16x32_bf16 v[196:199], v[44:47], a[60:63], v[196:199]
 v_mfma_f32_16x16x32_bf16 v[200:203], v[44:47], a[64:67], v[200:203]
 v_mfma_f32_16x16x32_bf16 v[204:207], v[44:47], a[68:71], v[204:207]
 s_waitcnt lgkmcnt(2)
 v_mfma_f32_16x16x32_bf16 v[232:235], v[48:51], a[48:51], v[232:235]
 v_mfma_f32_16x16x32_bf16 v[236:239], v[48:51], a[52:55], v[236:239]
 ds_read_b64_tr_b16 v[44:45], v8 offset:12288
 ds_read_b64_tr_b16 v[46:47], v8 offset:12800
 v_mfma_f32_16x16x32_bf16 v[240:243], v[48:51], a[56:59], v[240:243]
 s_mov_b32 m0, 106496
 s_add_u32 s46, s44, 4194560
 buffer_load_dwordx4 v32, s[24:27], s46 offen offset:0 lds
 v_mfma_f32_16x16x32_bf16 v[244:247], v[48:51], a[60:63], v[244:247]
 v_mfma_f32_16x16x32_bf16 v[248:251], v[48:51], a[64:67], v[248:251]
 buffer_load_dwordx4 v33, s[24:27], s46 offen offset:1024 lds
 v_mfma_f32_16x16x32_bf16 v[252:255], v[48:51], a[68:71], v[252:255]
 s_waitcnt lgkmcnt(2)
 v_mfma_f32_16x16x32_bf16 v[160:163], v[40:43], a[72:75], v[160:163]
 buffer_load_dwordx4 v34, s[24:27], s46 offen offset:2048 lds
 v_mfma_f32_16x16x32_bf16 v[164:167], v[40:43], a[76:79], v[164:167]
 ds_read_b64_tr_b16 v[48:49], v7 offset:12288
 ds_read_b64_tr_b16 v[50:51], v7 offset:12800
 v_mfma_f32_16x16x32_bf16 v[168:171], v[40:43], a[80:83], v[168:171]
 buffer_load_dwordx4 v35, s[24:27], s46 offen offset:3072 lds
 v_mfma_f32_16x16x32_bf16 v[172:175], v[40:43], a[84:87], v[172:175]
 v_mfma_f32_16x16x32_bf16 v[176:179], v[40:43], a[88:91], v[176:179]
 v_mfma_f32_16x16x32_bf16 v[180:183], v[40:43], a[92:95], v[180:183]
 s_waitcnt lgkmcnt(2)
 v_mfma_f32_16x16x32_bf16 v[208:211], v[44:47], a[72:75], v[208:211]
 v_mfma_f32_16x16x32_bf16 v[212:215], v[44:47], a[76:79], v[212:215]
 ds_read_b64_tr_b16 v[40:41], v9 offset:12288
 ds_read_b64_tr_b16 v[42:43], v9 offset:12800
 v_mfma_f32_16x16x32_bf16 v[216:219], v[44:47], a[80:83], v[216:219]
 v_mfma_f32_16x16x32_bf16 v[220:223], v[44:47], a[84:87], v[220:223]
 v_mfma_f32_16x16x32_bf16 v[224:227], v[44:47], a[88:91], v[224:227]
 v_mfma_f32_16x16x32_bf16 v[228:231], v[44:47], a[92:95], v[228:231]
 s_waitcnt lgkmcnt(2)
 v_mfma_f32_16x16x32_bf16 v[184:187], v[48:51], a[72:75], v[184:187]
 v_mfma_f32_16x16x32_bf16 v[188:191], v[48:51], a[76:79], v[188:191]
 s_waitcnt vmcnt(54)
 s_barrier
 s_waitcnt vmcnt(30)
 ds_read_b64_tr_b16 v[44:45], v6 offset:16384
 ds_read_b64_tr_b16 v[46:47], v6 offset:16896
 v_mfma_f32_16x16x32_bf16 v[192:195], v[48:51], a[80:83], v[192:195]
 s_add_u32 s46, s15, 81920
 s_and_b32 s46, s46, 0x1ffff
 s_add_u32 s46, s46, s42
 s_mov_b32 m0, 77824
 s_add_u32 s46, s46, 4096
 buffer_load_dwordx4 v28, s[20:23], s46 offen offset:0 nt lds
 v_mfma_f32_16x16x32_bf16 v[196:199], v[48:51], a[84:87], v[196:199]
 v_mfma_f32_16x16x32_bf16 v[200:203], v[48:51], a[88:91], v[200:203]
 buffer_load_dwordx4 v29, s[20:23], s46 offen offset:1024 nt lds
 v_mfma_f32_16x16x32_bf16 v[204:207], v[48:51], a[92:95], v[204:207]
 s_waitcnt lgkmcnt(2)
 v_mfma_f32_16x16x32_bf16 v[232:235], v[40:43], a[72:75], v[232:235]
 buffer_load_dwordx4 v30, s[20:23], s46 offen offset:2048 nt lds
 v_mfma_f32_16x16x32_bf16 v[236:239], v[40:43], a[76:79], v[236:239]
 ds_read_b64_tr_b16 v[48:49], v8 offset:16384
 ds_read_b64_tr_b16 v[50:51], v8 offset:16896
 v_mfma_f32_16x16x32_bf16 v[240:243], v[40:43], a[80:83], v[240:243]
 buffer_load_dwordx4 v31, s[20:23], s46 offen offset:3072 nt lds
 v_mfma_f32_16x16x32_bf16 v[244:247], v[40:43], a[84:87], v[244:247]
 v_mfma_f32_16x16x32_bf16 v[248:251], v[40:43], a[88:91], v[248:251]
 s_mov_b32 m0, 110592
 s_add_u32 s46, s44, 4456704
 buffer_load_dwordx4 v32, s[24:27], s46 offen offset:0 lds
 v_mfma_f32_16x16x32_bf16 v[252:255], v[40:43], a[92:95], v[252:255]
 s_waitcnt lgkmcnt(2)
 v_mfma_f32_16x16x32_bf16 v[160:163], v[44:47], a[96:99], v[160:163]
 buffer_load_dwordx4 v33, s[24:27], s46 offen offset:1024 lds
 v_mfma_f32_16x16x32_bf16 v[164:167], v[44:47], a[100:103], v[164:167]
 ds_read_b64_tr_b16 v[40:41], v7 offset:16384
 ds_read_b64_tr_b16 v[42:43], v7 offset:16896
 v_mfma_f32_16x16x32_bf16 v[168:171], v[44:47], a[104:107], v[168:171]
 buffer_load_dwordx4 v34, s[24:27], s46 offen offset:2048 lds
 v_mfma_f32_16x16x32_bf16 v[172:175], v[44:47], a[108:111], v[172:175]
 v_mfma_f32_16x16x32_bf16 v[176:179], v[44:47], a[112:115], v[176:179]
 buffer_load_dwordx4 v35, s[24:27], s46 offen offset:3072 lds
 v_mfma_f32_16x16x32_bf16 v[180:183], v[44:47], a[116:119], v[180:183]
 s_waitcnt lgkmcnt(2)
 v_mfma_f32_16x16x32_bf16 v[208:211], v[48:51], a[96:99], v[208:211]
 v_mfma_f32_16x16x32_bf16 v[212:215], v[48:51], a[100:103], v[212:215]
 ds_read_b64_tr_b16 v[44:45], v9 offset:16384
 ds_read_b64_tr_b16 v[46:47], v9 offset:16896
 v_mfma_f32_16x16x32_bf16 v[216:219], v[48:51], a[104:107], v[216:219]
 v_mfma_f32_16x16x32_bf16 v[220:223], v[48:51], a[108:111], v[220:223]
 v_mfma_f32_16x16x32_bf16 v[224:227], v[48:51], a[112:115], v[224:227]
 v_mfma_f32_16x16x32_bf16 v[228:231], v[48:51], a[116:119], v[228:231]
 s_waitcnt lgkmcnt(2)
 v_mfma_f32_16x16x32_bf16 v[184:187], v[40:43], a[96:99], v[184:187]
 v_mfma_f32_16x16x32_bf16 v[188:191], v[40:43], a[100:103], v[188:191]
 s_waitcnt vmcnt(34)
 ds_read_b64_tr_b16 v[48:49], v6 offset:20480
 ds_read_b64_tr_b16 v[50:51], v6 offset:20992
 v_mfma_f32_16x16x32_bf16 v[192:195], v[40:43], a[104:107], v[192:195]
 v_mfma_f32_16x16x32_bf16 v[196:199], v[40:43], a[108:111], v[196:199]
 v_mfma_f32_16x16x32_bf16 v[200:203], v[40:43], a[112:115], v[200:203]
 v_mfma_f32_16x16x32_bf16 v[204:207], v[40:43], a[116:119], v[204:207]
 s_waitcnt lgkmcnt(2)
 v_mfma_f32_16x16x32_bf16 v[232:235], v[44:47], a[96:99], v[232:235]
 v_mfma_f32_16x16x32_bf16 v[236:239], v[44:47], a[100:103], v[236:239]
 ds_read_b64_tr_b16 v[40:41], v8 offset:20480
 ds_read_b64_tr_b16 v[42:43], v8 offset:20992
 v_mfma_f32_16x16x32_bf16 v[240:243], v[44:47], a[104:107], v[240:243]
 s_mov_b32 m0, 114688
 s_add_u32 s46, s44, 1573120
 buffer_load_dwordx4 v32, s[24:27], s46 offen offset:0 lds
 v_mfma_f32_16x16x32_bf16 v[244:247], v[44:47], a[108:111], v[244:247]
 v_mfma_f32_16x16x32_bf16 v[248:251], v[44:47], a[112:115], v[248:251]
 buffer_load_dwordx4 v33, s[24:27], s46 offen offset:1024 lds
 v_mfma_f32_16x16x32_bf16 v[252:255], v[44:47], a[116:119], v[252:255]
 s_waitcnt lgkmcnt(2)
 v_mfma_f32_16x16x32_bf16 v[160:163], v[48:51], a[120:123], v[160:163]
 buffer_load_dwordx4 v34, s[24:27], s46 offen offset:2048 lds
 v_mfma_f32_16x16x32_bf16 v[164:167], v[48:51], a[124:127], v[164:167]
 ds_read_b64_tr_b16 v[44:45], v7 offset:20480
 ds_read_b64_tr_b16 v[46:47], v7 offset:20992
 v_mfma_f32_16x16x32_bf16 v[168:171], v[48:51], a[128:131], v[168:171]
 buffer_load_dwordx4 v35, s[24:27], s46 offen offset:3072 lds
 v_mfma_f32_16x16x32_bf16 v[172:175], v[48:51], a[132:135], v[172:175]
 v_mfma_f32_16x16x32_bf16 v[176:179], v[48:51], a[136:139], v[176:179]
 v_mfma_f32_16x16x32_bf16 v[180:183], v[48:51], a[140:143], v[180:183]
 s_waitcnt lgkmcnt(2)
 v_mfma_f32_16x16x32_bf16 v[208:211], v[40:43], a[120:123], v[208:211]
 v_mfma_f32_16x16x32_bf16 v[212:215], v[40:43], a[124:127], v[212:215]
 ds_read_b64_tr_b16 v[48:49], v9 offset:20480
 ds_read_b64_tr_b16 v[50:51], v9 offset:20992
 v_mfma_f32_16x16x32_bf16 v[216:219], v[40:43], a[128:131], v[216:219]
 v_mfma_f32_16x16x32_bf16 v[220:223], v[40:43], a[132:135], v[220:223]
 v_mfma_f32_16x16x32_bf16 v[224:227], v[40:43], a[136:139], v[224:227]
 v_mfma_f32_16x16x32_bf16 v[228:231], v[40:43], a[140:143], v[228:231]
 s_waitcnt vmcnt(46)
 s_barrier
 s_waitcnt lgkmcnt(2)
 v_mfma_f32_16x16x32_bf16 v[184:187], v[44:47], a[120:123], v[184:187]
 s_add_u32 s46, s15, 90112
 s_and_b32 s46, s46, 0x1ffff
 s_add_u32 s46, s46, s42
 s_mov_b32 m0, 94208
 s_add_u32 s46, s46, 4096
 buffer_load_dwordx4 v28, s[20:23], s46 offen offset:0 nt lds
 v_mfma_f32_16x16x32_bf16 v[188:191], v[44:47], a[124:127], v[188:191]
 s_waitcnt vmcnt(21)
 ds_read_b64_tr_b16 v[40:41], v6 offset:0
 ds_read_b64_tr_b16 v[42:43], v6 offset:512
 v_mfma_f32_16x16x32_bf16 v[192:195], v[44:47], a[128:131], v[192:195]
 buffer_load_dwordx4 v29, s[20:23], s46 offen offset:1024 nt lds
 v_mfma_f32_16x16x32_bf16 v[196:199], v[44:47], a[132:135], v[196:199]
 v_mfma_f32_16x16x32_bf16 v[200:203], v[44:47], a[136:139], v[200:203]
 buffer_load_dwordx4 v30, s[20:23], s46 offen offset:2048 nt lds
 v_mfma_f32_16x16x32_bf16 v[204:207], v[44:47], a[140:143], v[204:207]
 s_waitcnt lgkmcnt(2)
 v_mfma_f32_16x16x32_bf16 v[232:235], v[48:51], a[120:123], v[232:235]
 buffer_load_dwordx4 v31, s[20:23], s46 offen offset:3072 nt lds
 v_mfma_f32_16x16x32_bf16 v[236:239], v[48:51], a[124:127], v[236:239]
 ds_read_b64_tr_b16 v[44:45], v8 offset:0
 ds_read_b64_tr_b16 v[46:47], v8 offset:512
 ds_read_b128 v[52:55], v4 offset:0
 ds_read_b128 v[56:59], v4 offset:2048
 v_mfma_f32_16x16x32_bf16 v[240:243], v[48:51], a[128:131], v[240:243]
 s_mov_b32 m0, 118784
 s_add_u32 s46, s44, 1835264
 buffer_load_dwordx4 v32, s[24:27], s46 offen offset:0 lds
 v_mfma_f32_16x16x32_bf16 v[244:247], v[48:51], a[132:135], v[244:247]
 ds_read_b128 v[60:63], v4 offset:4096
 ds_read_b128 v[64:67], v4 offset:6144
 v_mfma_f32_16x16x32_bf16 v[248:251], v[48:51], a[136:139], v[248:251]
 buffer_load_dwordx4 v33, s[24:27], s46 offen offset:1024 lds
 v_mfma_f32_16x16x32_bf16 v[252:255], v[48:51], a[140:143], v[252:255]
 ds_read_b128 v[68:71], v4 offset:8192
 ds_read_b128 v[72:75], v4 offset:10240
 s_waitcnt lgkmcnt(5)
 v_mfma_f32_16x16x32_bf16 v[160:163], v[40:43], v[52:55], v[160:163]
 buffer_load_dwordx4 v34, s[24:27], s46 offen offset:2048 lds
 s_waitcnt lgkmcnt(4)
 v_mfma_f32_16x16x32_bf16 v[164:167], v[40:43], v[56:59], v[164:167]
 ds_read_b64_tr_b16 v[48:49], v7 offset:0
 ds_read_b64_tr_b16 v[50:51], v7 offset:512
 s_waitcnt lgkmcnt(5)
 v_mfma_f32_16x16x32_bf16 v[168:171], v[40:43], v[60:63], v[168:171]
 buffer_load_dwordx4 v35, s[24:27], s46 offen offset:3072 lds
 s_waitcnt lgkmcnt(4)
 v_mfma_f32_16x16x32_bf16 v[172:175], v[40:43], v[64:67], v[172:175]
 s_waitcnt lgkmcnt(3)
 v_mfma_f32_16x16x32_bf16 v[176:179], v[40:43], v[68:71], v[176:179]
 s_waitcnt lgkmcnt(2)
 v_mfma_f32_16x16x32_bf16 v[180:183], v[40:43], v[72:75], v[180:183]
 v_mfma_f32_16x16x32_bf16 v[208:211], v[44:47], v[52:55], v[208:211]
 v_mfma_f32_16x16x32_bf16 v[212:215], v[44:47], v[56:59], v[212:215]
 ds_read_b64_tr_b16 v[40:41], v9 offset:0
 ds_read_b64_tr_b16 v[42:43], v9 offset:512
 v_mfma_f32_16x16x32_bf16 v[216:219], v[44:47], v[60:63], v[216:219]
 v_mfma_f32_16x16x32_bf16 v[220:223], v[44:47], v[64:67], v[220:223]
 v_mfma_f32_16x16x32_bf16 v[224:227], v[44:47], v[68:71], v[224:227]
 v_mfma_f32_16x16x32_bf16 v[228:231], v[44:47], v[72:75], v[228:231]
 s_waitcnt lgkmcnt(2)
 v_mfma_f32_16x16x32_bf16 v[184:187], v[48:51], v[52:55], v[184:187]
 v_mfma_f32_16x16x32_bf16 v[188:191], v[48:51], v[56:59], v[188:191]
 s_waitcnt vmcnt(24)
 ds_read_b64_tr_b16 v[44:45], v6 offset:4096
 ds_read_b64_tr_b16 v[46:47], v6 offset:4608
 v_mfma_f32_16x16x32_bf16 v[192:195], v[48:51], v[60:63], v[192:195]
 v_mfma_f32_16x16x32_bf16 v[196:199], v[48:51], v[64:67], v[196:199]
 v_mfma_f32_16x16x32_bf16 v[200:203], v[48:51], v[68:71], v[200:203]
 v_mfma_f32_16x16x32_bf16 v[204:207], v[48:51], v[72:75], v[204:207]
 s_waitcnt lgkmcnt(2)
 v_mfma_f32_16x16x32_bf16 v[232:235], v[40:43], v[52:55], v[232:235]
 v_mfma_f32_16x16x32_bf16 v[236:239], v[40:43], v[56:59], v[236:239]
 ds_read_b64_tr_b16 v[48:49], v8 offset:4096
 ds_read_b64_tr_b16 v[50:51], v8 offset:4608
 ds_read_b128 v[52:55], v5 offset:0
 ds_read_b128 v[56:59], v5 offset:2048
 v_mfma_f32_16x16x32_bf16 v[240:243], v[40:43], v[60:63], v[240:243]
 s_mov_b32 m0, 98304
 s_add_u32 s46, s44, 2097408
 buffer_load_dwordx4 v32, s[24:27], s46 offen offset:0 lds
 v_mfma_f32_16x16x32_bf16 v[244:247], v[40:43], v[64:67], v[244:247]
 ds_read_b128 v[60:63], v5 offset:4096
 ds_read_b128 v[64:67], v5 offset:6144
 v_mfma_f32_16x16x32_bf16 v[248:251], v[40:43], v[68:71], v[248:251]
 buffer_load_dwordx4 v33, s[24:27], s46 offen offset:1024 lds
 v_mfma_f32_16x16x32_bf16 v[252:255], v[40:43], v[72:75], v[252:255]
 ds_read_b128 v[68:71], v5 offset:8192
 ds_read_b128 v[72:75], v5 offset:10240
 s_waitcnt lgkmcnt(5)
 v_mfma_f32_16x16x32_bf16 v[160:163], v[44:47], v[52:55], v[160:163]
 buffer_load_dwordx4 v34, s[24:27], s46 offen offset:2048 lds
 s_waitcnt lgkmcnt(4)
 v_mfma_f32_16x16x32_bf16 v[164:167], v[44:47], v[56:59], v[164:167]
 s_waitcnt vmcnt(45)
 s_barrier
 ds_read_b64_tr_b16 v[40:41], v7 offset:4096
 ds_read_b64_tr_b16 v[42:43], v7 offset:4608
 s_waitcnt lgkmcnt(5)
 v_mfma_f32_16x16x32_bf16 v[168:171], v[44:47], v[60:63], v[168:171]
 buffer_load_dwordx4 v35, s[24:27], s46 offen offset:3072 lds
 s_waitcnt lgkmcnt(4)
 v_mfma_f32_16x16x32_bf16 v[172:175], v[44:47], v[64:67], v[172:175]
 s_waitcnt lgkmcnt(3)
 v_mfma_f32_16x16x32_bf16 v[176:179], v[44:47], v[68:71], v[176:179]
 s_add_u32 s46, s15, 49152
 s_and_b32 s46, s46, 0x1ffff
 s_add_u32 s46, s46, s42
 s_mov_b32 m0, 12288
 s_add_u32 s46, s46, 4096
 buffer_load_dwordx4 v28, s[20:23], s46 offen offset:0 nt lds
 s_waitcnt lgkmcnt(2)
 v_mfma_f32_16x16x32_bf16 v[180:183], v[44:47], v[72:75], v[180:183]
 v_mfma_f32_16x16x32_bf16 v[208:211], v[48:51], v[52:55], v[208:211]
 buffer_load_dwordx4 v29, s[20:23], s46 offen offset:1024 nt lds
 v_mfma_f32_16x16x32_bf16 v[212:215], v[48:51], v[56:59], v[212:215]
 ds_read_b64_tr_b16 v[44:45], v9 offset:4096
 ds_read_b64_tr_b16 v[46:47], v9 offset:4608
 v_mfma_f32_16x16x32_bf16 v[216:219], v[48:51], v[60:63], v[216:219]
 buffer_load_dwordx4 v30, s[20:23], s46 offen offset:2048 nt lds
 v_mfma_f32_16x16x32_bf16 v[220:223], v[48:51], v[64:67], v[220:223]
 v_mfma_f32_16x16x32_bf16 v[224:227], v[48:51], v[68:71], v[224:227]
 buffer_load_dwordx4 v31, s[20:23], s46 offen offset:3072 nt lds
 v_mfma_f32_16x16x32_bf16 v[228:231], v[48:51], v[72:75], v[228:231]
 s_waitcnt lgkmcnt(2)
 v_mfma_f32_16x16x32_bf16 v[184:187], v[40:43], v[52:55], v[184:187]
 v_mfma_f32_16x16x32_bf16 v[188:191], v[40:43], v[56:59], v[188:191]
 s_waitcnt vmcnt(28)
 ds_read_b64_tr_b16 v[48:49], v6 offset:8192
 ds_read_b64_tr_b16 v[50:51], v6 offset:8704
 v_mfma_f32_16x16x32_bf16 v[192:195], v[40:43], v[60:63], v[192:195]
 v_mfma_f32_16x16x32_bf16 v[196:199], v[40:43], v[64:67], v[196:199]
 v_mfma_f32_16x16x32_bf16 v[200:203], v[40:43], v[68:71], v[200:203]
 v_mfma_f32_16x16x32_bf16 v[204:207], v[40:43], v[72:75], v[204:207]
 s_waitcnt lgkmcnt(2)
 v_mfma_f32_16x16x32_bf16 v[232:235], v[44:47], v[52:55], v[232:235]
 v_mfma_f32_16x16x32_bf16 v[236:239], v[44:47], v[56:59], v[236:239]
 ds_read_b64_tr_b16 v[40:41], v8 offset:8192
 ds_read_b64_tr_b16 v[42:43], v8 offset:8704
 ds_read_b128 v[52:55], v4 offset:12288
 ds_read_b128 v[56:59], v4 offset:14336
 v_mfma_f32_16x16x32_bf16 v[240:243], v[44:47], v[60:63], v[240:243]
 s_mov_b32 m0, 102400
 s_add_u32 s46, s44, 2359552
 buffer_load_dwordx4 v32, s[24:27], s46 offen offset:0 lds
 v_mfma_f32_16x16x32_bf16 v[244:247], v[44:47], v[64:67], v[244:247]
 ds_read_b128 v[60:63], v4 offset:16384
 ds_read_b128 v[64:67], v4 offset:18432
 v_mfma_f32_16x16x32_bf16 v[248:251], v[44:47], v[68:71], v[248:251]
 buffer_load_dwordx4 v33, s[24:27], s46 offen offset:1024 lds
 v_mfma_f32_16x16x32_bf16 v[252:255], v[44:47], v[72:75], v[252:255]
 ds_read_b128 v[68:71], v4 offset:20480
 ds_read_b128 v[72:75], v4 offset:22528
 s_waitcnt lgkmcnt(5)
 v_mfma_f32_16x16x32_bf16 v[160:163], v[48:51], v[52:55], v[160:163]
 buffer_load_dwordx4 v34, s[24:27], s46 offen offset:2048 lds
 s_waitcnt lgkmcnt(4)
 v_mfma_f32_16x16x32_bf16 v[164:167], v[48:51], v[56:59], v[164:167]
 ds_read_b64_tr_b16 v[44:45], v7 offset:8192
 ds_read_b64_tr_b16 v[46:47], v7 offset:8704
 s_waitcnt lgkmcnt(5)
 v_mfma_f32_16x16x32_bf16 v[168:171], v[48:51], v[60:63], v[168:171]
 buffer_load_dwordx4 v35, s[24:27], s46 offen offset:3072 lds
 s_waitcnt lgkmcnt(4)
 v_mfma_f32_16x16x32_bf16 v[172:175], v[48:51], v[64:67], v[172:175]
 s_waitcnt lgkmcnt(3)
 v_mfma_f32_16x16x32_bf16 v[176:179], v[48:51], v[68:71], v[176:179]
 s_waitcnt lgkmcnt(2)
 v_mfma_f32_16x16x32_bf16 v[180:183], v[48:51], v[72:75], v[180:183]
 v_mfma_f32_16x16x32_bf16 v[208:211], v[40:43], v[52:55], v[208:211]
 v_mfma_f32_16x16x32_bf16 v[212:215], v[40:43], v[56:59], v[212:215]
 ds_read_b64_tr_b16 v[48:49], v9 offset:8192
 ds_read_b64_tr_b16 v[50:51], v9 offset:8704
 v_mfma_f32_16x16x32_bf16 v[216:219], v[40:43], v[60:63], v[216:219]
 v_mfma_f32_16x16x32_bf16 v[220:223], v[40:43], v[64:67], v[220:223]
 v_mfma_f32_16x16x32_bf16 v[224:227], v[40:43], v[68:71], v[224:227]
 v_mfma_f32_16x16x32_bf16 v[228:231], v[40:43], v[72:75], v[228:231]
 s_waitcnt lgkmcnt(2)
 v_mfma_f32_16x16x32_bf16 v[184:187], v[44:47], v[52:55], v[184:187]
 v_mfma_f32_16x16x32_bf16 v[188:191], v[44:47], v[56:59], v[188:191]
 s_waitcnt vmcnt(50)
 s_barrier
 s_waitcnt vmcnt(24)
 ds_read_b64_tr_b16 v[40:41], v6 offset:12288
 ds_read_b64_tr_b16 v[42:43], v6 offset:12800
 v_mfma_f32_16x16x32_bf16 v[192:195], v[44:47], v[60:63], v[192:195]
 s_add_u32 s46, s15, 57344
 s_and_b32 s46, s46, 0x1ffff
 s_add_u32 s46, s46, s42
 s_mov_b32 m0, 28672
 s_add_u32 s46, s46, 4096
 buffer_load_dwordx4 v28, s[20:23], s46 offen offset:0 nt lds
 v_mfma_f32_16x16x32_bf16 v[196:199], v[44:47], v[64:67], v[196:199]
 v_mfma_f32_16x16x32_bf16 v[200:203], v[44:47], v[68:71], v[200:203]
 buffer_load_dwordx4 v29, s[20:23], s46 offen offset:1024 nt lds
 v_mfma_f32_16x16x32_bf16 v[204:207], v[44:47], v[72:75], v[204:207]
 s_waitcnt lgkmcnt(2)
 v_mfma_f32_16x16x32_bf16 v[232:235], v[48:51], v[52:55], v[232:235]
 buffer_load_dwordx4 v30, s[20:23], s46 offen offset:2048 nt lds
 v_mfma_f32_16x16x32_bf16 v[236:239], v[48:51], v[56:59], v[236:239]
 ds_read_b64_tr_b16 v[44:45], v8 offset:12288
 ds_read_b64_tr_b16 v[46:47], v8 offset:12800
 ds_read_b128 v[52:55], v5 offset:12288
 ds_read_b128 v[56:59], v5 offset:14336
 v_mfma_f32_16x16x32_bf16 v[240:243], v[48:51], v[60:63], v[240:243]
 buffer_load_dwordx4 v31, s[20:23], s46 offen offset:3072 nt lds
 v_mfma_f32_16x16x32_bf16 v[244:247], v[48:51], v[64:67], v[244:247]
 ds_read_b128 v[60:63], v5 offset:16384
 ds_read_b128 v[64:67], v5 offset:18432
 v_mfma_f32_16x16x32_bf16 v[248:251], v[48:51], v[68:71], v[248:251]
 s_mov_b32 m0, 106496
 s_add_u32 s46, s44, 2621696
 buffer_load_dwordx4 v32, s[24:27], s46 offen offset:0 lds
 v_mfma_f32_16x16x32_bf16 v[252:255], v[48:51], v[72:75], v[252:255]
 ds_read_b128 v[68:71], v5 offset:20480
 ds_read_b128 v[72:75], v5 offset:22528
 s_waitcnt lgkmcnt(5)
 v_mfma_f32_16x16x32_bf16 v[160:163], v[40:43], v[52:55], v[160:163]
 buffer_load_dwordx4 v33, s[24:27], s46 offen offset:1024 lds
 s_waitcnt lgkmcnt(4)
 v_mfma_f32_16x16x32_bf16 v[164:167], v[40:43], v[56:59], v[164:167]
 ds_read_b64_tr_b16 v[48:49], v7 offset:12288
 ds_read_b64_tr_b16 v[50:51], v7 offset:12800
 s_waitcnt lgkmcnt(5)
 v_mfma_f32_16x16x32_bf16 v[168:171], v[40:43], v[60:63], v[168:171]
 buffer_load_dwordx4 v34, s[24:27], s46 offen offset:2048 lds
 s_waitcnt lgkmcnt(4)
 v_mfma_f32_16x16x32_bf16 v[172:175], v[40:43], v[64:67], v[172:175]
 s_waitcnt lgkmcnt(3)
 v_mfma_f32_16x16x32_bf16 v[176:179], v[40:43], v[68:71], v[176:179]
 buffer_load_dwordx4 v35, s[24:27], s46 offen offset:3072 lds
 s_waitcnt lgkmcnt(2)
 v_mfma_f32_16x16x32_bf16 v[180:183], v[40:43], v[72:75], v[180:183]
 v_mfma_f32_16x16x32_bf16 v[208:211], v[44:47], v[52:55], v[208:211]
 v_mfma_f32_16x16x32_bf16 v[212:215], v[44:47], v[56:59], v[212:215]
 ds_read_b64_tr_b16 v[40:41], v9 offset:12288
 ds_read_b64_tr_b16 v[42:43], v9 offset:12800
 v_mfma_f32_16x16x32_bf16 v[216:219], v[44:47], v[60:63], v[216:219]
 v_mfma_f32_16x16x32_bf16 v[220:223], v[44:47], v[64:67], v[220:223]
 v_mfma_f32_16x16x32_bf16 v[224:227], v[44:47], v[68:71], v[224:227]
 v_mfma_f32_16x16x32_bf16 v[228:231], v[44:47], v[72:75], v[228:231]
 s_waitcnt lgkmcnt(2)
 v_mfma_f32_16x16x32_bf16 v[184:187], v[48:51], v[52:55], v[184:187]
 v_mfma_f32_16x16x32_bf16 v[188:191], v[48:51], v[56:59], v[188:191]
 s_waitcnt vmcnt(28)
 ds_read_b64_tr_b16 v[44:45], v6 offset:16384
 ds_read_b64_tr_b16 v[46:47], v6 offset:16896
 v_mfma_f32_16x16x32_bf16 v[192:195], v[48:51], v[60:63], v[192:195]
 v_mfma_f32_16x16x32_bf16 v[196:199], v[48:51], v[64:67], v[196:199]
 v_mfma_f32_16x16x32_bf16 v[200:203], v[48:51], v[68:71], v[200:203]
 v_mfma_f32_16x16x32_bf16 v[204:207], v[48:51], v[72:75], v[204:207]
 s_waitcnt lgkmcnt(2)
 v_mfma_f32_16x16x32_bf16 v[232:235], v[40:43], v[52:55], v[232:235]
 v_mfma_f32_16x16x32_bf16 v[236:239], v[40:43], v[56:59], v[236:239]
 ds_read_b64_tr_b16 v[48:49], v8 offset:16384
 ds_read_b64_tr_b16 v[50:51], v8 offset:16896
 v_mfma_f32_16x16x32_bf16 v[240:243], v[40:43], v[60:63], v[240:243]
 s_mov_b32 m0, 110592
 s_add_u32 s46, s44, 2883840
 buffer_load_dwordx4 v32, s[24:27], s46 offen offset:0 lds
 v_mfma_f32_16x16x32_bf16 v[244:247], v[40:43], v[64:67], v[244:247]
 v_mfma_f32_16x16x32_bf16 v[248:251], v[40:43], v[68:71], v[248:251]
 buffer_load_dwordx4 v33, s[24:27], s46 offen offset:1024 lds
 v_mfma_f32_16x16x32_bf16 v[252:255], v[40:43], v[72:75], v[252:255]
 s_waitcnt lgkmcnt(2)
 v_mfma_f32_16x16x32_bf16 v[160:163], v[44:47], a[144:147], v[160:163]
 buffer_load_dwordx4 v34, s[24:27], s46 offen offset:2048 lds
 v_mfma_f32_16x16x32_bf16 v[164:167], v[44:47], a[148:151], v[164:167]
 s_waitcnt vmcnt(57)
 s_barrier
 ds_read_b64_tr_b16 v[40:41], v7 offset:16384
 ds_read_b64_tr_b16 v[42:43], v7 offset:16896
 v_mfma_f32_16x16x32_bf16 v[168:171], v[44:47], a[152:155], v[168:171]
 buffer_load_dwordx4 v35, s[24:27], s46 offen offset:3072 lds
 v_mfma_f32_16x16x32_bf16 v[172:175], v[44:47], a[156:159], v[172:175]
 v_mfma_f32_16x16x32_bf16 v[176:179], v[44:47], a[160:163], v[176:179]
 s_add_u32 s46, s15, 65536
 s_and_b32 s46, s46, 0x1ffff
 s_add_u32 s46, s46, s42
 s_mov_b32 m0, 45056
 s_add_u32 s46, s46, 4096
 buffer_load_dwordx4 v28, s[20:23], s46 offen offset:0 nt lds
 v_mfma_f32_16x16x32_bf16 v[180:183], v[44:47], a[164:167], v[180:183]
 s_waitcnt lgkmcnt(2)
 v_mfma_f32_16x16x32_bf16 v[208:211], v[48:51], a[144:147], v[208:211]
 buffer_load_dwordx4 v29, s[20:23], s46 offen offset:1024 nt lds
 v_mfma_f32_16x16x32_bf16 v[212:215], v[48:51], a[148:151], v[212:215]
 ds_read_b64_tr_b16 v[44:45], v9 offset:16384
 ds_read_b64_tr_b16 v[46:47], v9 offset:16896
 v_mfma_f32_16x16x32_bf16 v[216:219], v[48:51], a[152:155], v[216:219]
 buffer_load_dwordx4 v30, s[20:23], s46 offen offset:2048 nt lds
 v_mfma_f32_16x16x32_bf16 v[220:223], v[48:51], a[156:159], v[220:223]
 v_mfma_f32_16x16x32_bf16 v[224:227], v[48:51], a[160:163], v[224:227]
 buffer_load_dwordx4 v31, s[20:23], s46 offen offset:3072 nt lds
 v_mfma_f32_16x16x32_bf16 v[228:231], v[48:51], a[164:167], v[228:231]
 s_waitcnt lgkmcnt(2)
 v_mfma_f32_16x16x32_bf16 v[184:187], v[40:43], a[144:147], v[184:187]
 v_mfma_f32_16x16x32_bf16 v[188:191], v[40:43], a[148:151], v[188:191]
 s_waitcnt vmcnt(28)
 ds_read_b64_tr_b16 v[48:49], v6 offset:20480
 ds_read_b64_tr_b16 v[50:51], v6 offset:20992
 v_mfma_f32_16x16x32_bf16 v[192:195], v[40:43], a[152:155], v[192:195]
 v_mfma_f32_16x16x32_bf16 v[196:199], v[40:43], a[156:159], v[196:199]
 v_mfma_f32_16x16x32_bf16 v[200:203], v[40:43], a[160:163], v[200:203]
 v_mfma_f32_16x16x32_bf16 v[204:207], v[40:43], a[164:167], v[204:207]
 s_waitcnt lgkmcnt(2)
 v_mfma_f32_16x16x32_bf16 v[232:235], v[44:47], a[144:147], v[232:235]
 v_mfma_f32_16x16x32_bf16 v[236:239], v[44:47], a[148:151], v[236:239]
 ds_read_b64_tr_b16 v[40:41], v8 offset:20480
 ds_read_b64_tr_b16 v[42:43], v8 offset:20992
 v_mfma_f32_16x16x32_bf16 v[240:243], v[44:47], a[152:155], v[240:243]
 s_mov_b32 m0, 114688
 s_add_u32 s46, s44, 3145984
 buffer_load_dwordx4 v32, s[24:27], s46 offen offset:0 lds
 v_mfma_f32_16x16x32_bf16 v[244:247], v[44:47], a[156:159], v[244:247]
 v_mfma_f32_16x16x32_bf16 v[248:251], v[44:47], a[160:163], v[248:251]
 buffer_load_dwordx4 v33, s[24:27], s46 offen offset:1024 lds
 v_mfma_f32_16x16x32_bf16 v[252:255], v[44:47], a[164:167], v[252:255]
 s_waitcnt lgkmcnt(2)
 v_mfma_f32_16x16x32_bf16 v[160:163], v[48:51], a[168:171], v[160:163]
 buffer_load_dwordx4 v34, s[24:27], s46 offen offset:2048 lds
 v_mfma_f32_16x16x32_bf16 v[164:167], v[48:51], a[172:175], v[164:167]
 ds_read_b64_tr_b16 v[44:45], v7 offset:20480
 ds_read_b64_tr_b16 v[46:47], v7 offset:20992
 v_mfma_f32_16x16x32_bf16 v[168:171], v[48:51], a[176:179], v[168:171]
 buffer_load_dwordx4 v35, s[24:27], s46 offen offset:3072 lds
 v_mfma_f32_16x16x32_bf16 v[172:175], v[48:51], a[180:183], v[172:175]
 v_mfma_f32_16x16x32_bf16 v[176:179], v[48:51], a[184:187], v[176:179]
 v_mfma_f32_16x16x32_bf16 v[180:183], v[48:51], a[188:191], v[180:183]
 s_waitcnt lgkmcnt(2)
 v_mfma_f32_16x16x32_bf16 v[208:211], v[40:43], a[168:171], v[208:211]
 v_mfma_f32_16x16x32_bf16 v[212:215], v[40:43], a[172:175], v[212:215]
 ds_read_b64_tr_b16 v[48:49], v9 offset:20480
 ds_read_b64_tr_b16 v[50:51], v9 offset:20992
 v_mfma_f32_16x16x32_bf16 v[216:219], v[40:43], a[176:179], v[216:219]
 v_mfma_f32_16x16x32_bf16 v[220:223], v[40:43], a[180:183], v[220:223]
 v_mfma_f32_16x16x32_bf16 v[224:227], v[40:43], a[184:187], v[224:227]
 v_mfma_f32_16x16x32_bf16 v[228:231], v[40:43], a[188:191], v[228:231]
 s_waitcnt lgkmcnt(2)
 v_mfma_f32_16x16x32_bf16 v[184:187], v[44:47], a[168:171], v[184:187]
 v_mfma_f32_16x16x32_bf16 v[188:191], v[44:47], a[172:175], v[188:191]
 s_waitcnt vmcnt(28)
 ds_read_b64_tr_b16 v[40:41], v6 offset:0
 ds_read_b64_tr_b16 v[42:43], v6 offset:512
 v_mfma_f32_16x16x32_bf16 v[192:195], v[44:47], a[176:179], v[192:195]
 v_mfma_f32_16x16x32_bf16 v[196:199], v[44:47], a[180:183], v[196:199]
 v_mfma_f32_16x16x32_bf16 v[200:203], v[44:47], a[184:187], v[200:203]
 v_mfma_f32_16x16x32_bf16 v[204:207], v[44:47], a[188:191], v[204:207]
 s_waitcnt vmcnt(24)
 s_barrier
 s_waitcnt lgkmcnt(2)
 v_mfma_f32_16x16x32_bf16 v[232:235], v[48:51], a[168:171], v[232:235]
 s_add_u32 s46, s15, 73728
 s_and_b32 s46, s46, 0x1ffff
 s_add_u32 s46, s46, s42
 s_mov_b32 m0, 61440
 s_add_u32 s46, s46, 4096
 buffer_load_dwordx4 v28, s[20:23], s46 offen offset:0 nt lds
 v_mfma_f32_16x16x32_bf16 v[236:239], v[48:51], a[172:175], v[236:239]
 ds_read_b64_tr_b16 v[44:45], v8 offset:0
 ds_read_b64_tr_b16 v[46:47], v8 offset:512
 v_mfma_f32_16x16x32_bf16 v[240:243], v[48:51], a[176:179], v[240:243]
 buffer_load_dwordx4 v29, s[20:23], s46 offen offset:1024 nt lds
 v_mfma_f32_16x16x32_bf16 v[244:247], v[48:51], a[180:183], v[244:247]
 v_mfma_f32_16x16x32_bf16 v[248:251], v[48:51], a[184:187], v[248:251]
 buffer_load_dwordx4 v30, s[20:23], s46 offen offset:2048 nt lds
 v_mfma_f32_16x16x32_bf16 v[252:255], v[48:51], a[188:191], v[252:255]
 s_waitcnt lgkmcnt(2)
 v_mfma_f32_16x16x32_bf16 v[160:163], v[40:43], a[192:195], v[160:163]
 buffer_load_dwordx4 v31, s[20:23], s46 offen offset:3072 nt lds
 v_mfma_f32_16x16x32_bf16 v[164:167], v[40:43], a[196:199], v[164:167]
 ds_read_b64_tr_b16 v[48:49], v7 offset:0
 ds_read_b64_tr_b16 v[50:51], v7 offset:512
 v_mfma_f32_16x16x32_bf16 v[168:171], v[40:43], a[200:203], v[168:171]
 s_mov_b32 m0, 118784
 s_add_u32 s46, s44, 3408128
 buffer_load_dwordx4 v32, s[24:27], s46 offen offset:0 lds
 v_mfma_f32_16x16x32_bf16 v[172:175], v[40:43], a[204:207], v[172:175]
 v_mfma_f32_16x16x32_bf16 v[176:179], v[40:43], a[208:211], v[176:179]
 buffer_load_dwordx4 v33, s[24:27], s46 offen offset:1024 lds
 v_mfma_f32_16x16x32_bf16 v[180:183], v[40:43], a[212:215], v[180:183]
 s_waitcnt lgkmcnt(2)
 v_mfma_f32_16x16x32_bf16 v[208:211], v[44:47], a[192:195], v[208:211]
 buffer_load_dwordx4 v34, s[24:27], s46 offen offset:2048 lds
 v_mfma_f32_16x16x32_bf16 v[212:215], v[44:47], a[196:199], v[212:215]
 ds_read_b64_tr_b16 v[40:41], v9 offset:0
 ds_read_b64_tr_b16 v[42:43], v9 offset:512
 v_mfma_f32_16x16x32_bf16 v[216:219], v[44:47], a[200:203], v[216:219]
 buffer_load_dwordx4 v35, s[24:27], s46 offen offset:3072 lds
 v_mfma_f32_16x16x32_bf16 v[220:223], v[44:47], a[204:207], v[220:223]
 v_mfma_f32_16x16x32_bf16 v[224:227], v[44:47], a[208:211], v[224:227]
 v_mfma_f32_16x16x32_bf16 v[228:231], v[44:47], a[212:215], v[228:231]
 s_waitcnt lgkmcnt(2)
 v_mfma_f32_16x16x32_bf16 v[184:187], v[48:51], a[192:195], v[184:187]
 v_mfma_f32_16x16x32_bf16 v[188:191], v[48:51], a[196:199], v[188:191]
 s_waitcnt vmcnt(28)
 ds_read_b64_tr_b16 v[44:45], v6 offset:4096
 ds_read_b64_tr_b16 v[46:47], v6 offset:4608
 v_mfma_f32_16x16x32_bf16 v[192:195], v[48:51], a[200:203], v[192:195]
 v_mfma_f32_16x16x32_bf16 v[196:199], v[48:51], a[204:207], v[196:199]
 v_mfma_f32_16x16x32_bf16 v[200:203], v[48:51], a[208:211], v[200:203]
 v_mfma_f32_16x16x32_bf16 v[204:207], v[48:51], a[212:215], v[204:207]
 s_waitcnt lgkmcnt(2)
 v_mfma_f32_16x16x32_bf16 v[232:235], v[40:43], a[192:195], v[232:235]
 v_mfma_f32_16x16x32_bf16 v[236:239], v[40:43], a[196:199], v[236:239]
 ds_read_b64_tr_b16 v[48:49], v8 offset:4096
 ds_read_b64_tr_b16 v[50:51], v8 offset:4608
 v_mfma_f32_16x16x32_bf16 v[240:243], v[40:43], a[200:203], v[240:243]
 s_mov_b32 m0, 98304
 s_add_u32 s46, s44, 384
 buffer_load_dwordx4 v32, s[24:27], s46 offen offset:0 lds
 v_mfma_f32_16x16x32_bf16 v[244:247], v[40:43], a[204:207], v[244:247]
 v_mfma_f32_16x16x32_bf16 v[248:251], v[40:43], a[208:211], v[248:251]
 buffer_load_dwordx4 v33, s[24:27], s46 offen offset:1024 lds
 v_mfma_f32_16x16x32_bf16 v[252:255], v[40:43], a[212:215], v[252:255]
 s_waitcnt lgkmcnt(2)
 v_mfma_f32_16x16x32_bf16 v[160:163], v[44:47], a[216:219], v[160:163]
 buffer_load_dwordx4 v34, s[24:27], s46 offen offset:2048 lds
 v_mfma_f32_16x16x32_bf16 v[164:167], v[44:47], a[220:223], v[164:167]
 ds_read_b64_tr_b16 v[40:41], v7 offset:4096
 ds_read_b64_tr_b16 v[42:43], v7 offset:4608
 v_mfma_f32_16x16x32_bf16 v[168:171], v[44:47], a[224:227], v[168:171]
 buffer_load_dwordx4 v35, s[24:27], s46 offen offset:3072 lds
 v_mfma_f32_16x16x32_bf16 v[172:175], v[44:47], a[228:231], v[172:175]
 v_mfma_f32_16x16x32_bf16 v[176:179], v[44:47], a[232:235], v[176:179]
 v_mfma_f32_16x16x32_bf16 v[180:183], v[44:47], a[236:239], v[180:183]
 s_waitcnt lgkmcnt(2)
 v_mfma_f32_16x16x32_bf16 v[208:211], v[48:51], a[216:219], v[208:211]
 v_mfma_f32_16x16x32_bf16 v[212:215], v[48:51], a[220:223], v[212:215]
 s_waitcnt vmcnt(28)
 s_barrier
 ds_read_b64_tr_b16 v[44:45], v9 offset:4096
 ds_read_b64_tr_b16 v[46:47], v9 offset:4608
 v_mfma_f32_16x16x32_bf16 v[216:219], v[48:51], a[224:227], v[216:219]
 s_add_u32 s46, s15, 98304
 s_and_b32 s46, s46, 0x1ffff
 s_add_u32 s46, s46, s42
 s_mov_b32 m0, 12288
 s_add_u32 s46, s46, 4096
 buffer_load_dwordx4 v28, s[20:23], s46 offen offset:0 nt lds
 v_mfma_f32_16x16x32_bf16 v[220:223], v[48:51], a[228:231], v[220:223]
 v_mfma_f32_16x16x32_bf16 v[224:227], v[48:51], a[232:235], v[224:227]
 buffer_load_dwordx4 v29, s[20:23], s46 offen offset:1024 nt lds
 v_mfma_f32_16x16x32_bf16 v[228:231], v[48:51], a[236:239], v[228:231]
 s_waitcnt lgkmcnt(2)
 v_mfma_f32_16x16x32_bf16 v[184:187], v[40:43], a[216:219], v[184:187]
 buffer_load_dwordx4 v30, s[20:23], s46 offen offset:2048 nt lds
 v_mfma_f32_16x16x32_bf16 v[188:191], v[40:43], a[220:223], v[188:191]
 s_waitcnt vmcnt(27)
 ds_read_b64_tr_b16 v[48:49], v6 offset:8192
 ds_read_b64_tr_b16 v[50:51], v6 offset:8704
 v_mfma_f32_16x16x32_bf16 v[192:195], v[40:43], a[224:227], v[192:195]
 buffer_load_dwordx4 v31, s[20:23], s46 offen offset:3072 nt lds
 v_mfma_f32_16x16x32_bf16 v[196:199], v[40:43], a[228:231], v[196:199]
 v_mfma_f32_16x16x32_bf16 v[200:203], v[40:43], a[232:235], v[200:203]
 v_mfma_f32_16x16x32_bf16 v[204:207], v[40:43], a[236:239], v[204:207]
 s_waitcnt lgkmcnt(2)
 v_mfma_f32_16x16x32_bf16 v[232:235], v[44:47], a[216:219], v[232:235]
 v_mfma_f32_16x16x32_bf16 v[236:239], v[44:47], a[220:223], v[236:239]
 ds_read_b64_tr_b16 v[40:41], v8 offset:8192
 ds_read_b64_tr_b16 v[42:43], v8 offset:8704
 v_mfma_f32_16x16x32_bf16 v[240:243], v[44:47], a[224:227], v[240:243]
 s_mov_b32 m0, 102400
 s_add_u32 s46, s44, 262528
 buffer_load_dwordx4 v32, s[24:27], s46 offen offset:0 lds
 v_mfma_f32_16x16x32_bf16 v[244:247], v[44:47], a[228:231], v[244:247]
 v_mfma_f32_16x16x32_bf16 v[248:251], v[44:47], a[232:235], v[248:251]
 buffer_load_dwordx4 v33, s[24:27], s46 offen offset:1024 lds
 v_mfma_f32_16x16x32_bf16 v[252:255], v[44:47], a[236:239], v[252:255]
 s_waitcnt lgkmcnt(2)
 v_mfma_f32_16x16x32_bf16 v[160:163], v[48:51], a[240:243], v[160:163]
 buffer_load_dwordx4 v34, s[24:27], s46 offen offset:2048 lds
 v_mfma_f32_16x16x32_bf16 v[164:167], v[48:51], a[244:247], v[164:167]
 ds_read_b64_tr_b16 v[44:45], v7 offset:8192
 ds_read_b64_tr_b16 v[46:47], v7 offset:8704
 v_mfma_f32_16x16x32_bf16 v[168:171], v[48:51], a[248:251], v[168:171]
 buffer_load_dwordx4 v35, s[24:27], s46 offen offset:3072 lds
 v_mfma_f32_16x16x32_bf16 v[172:175], v[48:51], a[252:255], v[172:175]
 v_mfma_f32_16x16x32_bf16 v[176:179], v[48:51], v[76:79], v[176:179]
 v_mfma_f32_16x16x32_bf16 v[180:183], v[48:51], v[80:83], v[180:183]
 s_waitcnt lgkmcnt(2)
 v_mfma_f32_16x16x32_bf16 v[208:211], v[40:43], a[240:243], v[208:211]
 v_mfma_f32_16x16x32_bf16 v[212:215], v[40:43], a[244:247], v[212:215]
 ds_read_b64_tr_b16 v[48:49], v9 offset:8192
 ds_read_b64_tr_b16 v[50:51], v9 offset:8704
 v_mfma_f32_16x16x32_bf16 v[216:219], v[40:43], a[248:251], v[216:219]
 v_mfma_f32_16x16x32_bf16 v[220:223], v[40:43], a[252:255], v[220:223]
 v_mfma_f32_16x16x32_bf16 v[224:227], v[40:43], v[76:79], v[224:227]
 v_mfma_f32_16x16x32_bf16 v[228:231], v[40:43], v[80:83], v[228:231]
 s_waitcnt lgkmcnt(2)
 v_mfma_f32_16x16x32_bf16 v[184:187], v[44:47], a[240:243], v[184:187]
 v_mfma_f32_16x16x32_bf16 v[188:191], v[44:47], a[244:247], v[188:191]
 s_waitcnt vmcnt(28)
 ds_read_b64_tr_b16 v[40:41], v6 offset:12288
 ds_read_b64_tr_b16 v[42:43], v6 offset:12800
 v_mfma_f32_16x16x32_bf16 v[192:195], v[44:47], a[248:251], v[192:195]
 v_mfma_f32_16x16x32_bf16 v[196:199], v[44:47], a[252:255], v[196:199]
 v_mfma_f32_16x16x32_bf16 v[200:203], v[44:47], v[76:79], v[200:203]
 v_mfma_f32_16x16x32_bf16 v[204:207], v[44:47], v[80:83], v[204:207]
 s_waitcnt lgkmcnt(2)
 v_mfma_f32_16x16x32_bf16 v[232:235], v[48:51], a[240:243], v[232:235]
 v_mfma_f32_16x16x32_bf16 v[236:239], v[48:51], a[244:247], v[236:239]
 ds_read_b64_tr_b16 v[44:45], v8 offset:12288
 ds_read_b64_tr_b16 v[46:47], v8 offset:12800
 v_mfma_f32_16x16x32_bf16 v[240:243], v[48:51], a[248:251], v[240:243]
 v_mfma_f32_16x16x32_bf16 v[244:247], v[48:51], a[252:255], v[244:247]
 v_mfma_f32_16x16x32_bf16 v[248:251], v[48:51], v[76:79], v[248:251]
 v_mfma_f32_16x16x32_bf16 v[252:255], v[48:51], v[80:83], v[252:255]
 s_waitcnt vmcnt(24)
 s_barrier
 s_waitcnt lgkmcnt(2)
 v_mfma_f32_16x16x32_bf16 v[160:163], v[40:43], v[84:87], v[160:163]
 s_add_u32 s46, s15, 106496
 s_and_b32 s46, s46, 0x1ffff
 s_add_u32 s46, s46, s42
 s_mov_b32 m0, 28672
 s_add_u32 s46, s46, 4096
 buffer_load_dwordx4 v28, s[20:23], s46 offen offset:0 nt lds
 v_mfma_f32_16x16x32_bf16 v[164:167], v[40:43], v[88:91], v[164:167]
 ds_read_b64_tr_b16 v[48:49], v7 offset:12288
 ds_read_b64_tr_b16 v[50:51], v7 offset:12800
 v_mfma_f32_16x16x32_bf16 v[168:171], v[40:43], v[92:95], v[168:171]
 buffer_load_dwordx4 v29, s[20:23], s46 offen offset:1024 nt lds
 v_mfma_f32_16x16x32_bf16 v[172:175], v[40:43], v[96:99], v[172:175]
 v_mfma_f32_16x16x32_bf16 v[176:179], v[40:43], v[100:103], v[176:179]
 buffer_load_dwordx4 v30, s[20:23], s46 offen offset:2048 nt lds
 v_mfma_f32_16x16x32_bf16 v[180:183], v[40:43], v[104:107], v[180:183]
 s_waitcnt lgkmcnt(2)
 v_mfma_f32_16x16x32_bf16 v[208:211], v[44:47], v[84:87], v[208:211]
 buffer_load_dwordx4 v31, s[20:23], s46 offen offset:3072 nt lds
 v_mfma_f32_16x16x32_bf16 v[212:215], v[44:47], v[88:91], v[212:215]
 ds_read_b64_tr_b16 v[40:41], v9 offset:12288
 ds_read_b64_tr_b16 v[42:43], v9 offset:12800
 v_mfma_f32_16x16x32_bf16 v[216:219], v[44:47], v[92:95], v[216:219]
 s_call_b64 s[40:41], L_warm_more
 s_mov_b32 m0, 106496
 s_add_u32 s46, s44, 524672
 buffer_load_dwordx4 v32, s[24:27], s46 offen offset:0 lds
 v_mfma_f32_16x16x32_bf16 v[220:223], v[44:47], v[96:99], v[220:223]
 v_mfma_f32_16x16x32_bf16 v[224:227], v[44:47], v[100:103], v[224:227]
 buffer_load_dwordx4 v33, s[24:27], s46 offen offset:1024 lds
 v_mfma_f32_16x16x32_bf16 v[228:231], v[44:47], v[104:107], v[228:231]
 s_waitcnt lgkmcnt(2)
 v_mfma_f32_16x16x32_bf16 v[184:187], v[48:51], v[84:87], v[184:187]
 buffer_load_dwordx4 v34, s[24:27], s46 offen offset:2048 lds
 v_mfma_f32_16x16x32_bf16 v[188:191], v[48:51], v[88:91], v[188:191]
 s_waitcnt vmcnt(27)
 ds_read_b64_tr_b16 v[44:45], v6 offset:16384
 ds_read_b64_tr_b16 v[46:47], v6 offset:16896
 v_mfma_f32_16x16x32_bf16 v[192:195], v[48:51], v[92:95], v[192:195]
 buffer_load_dwordx4 v35, s[24:27], s46 offen offset:3072 lds
 v_mfma_f32_16x16x32_bf16 v[196:199], v[48:51], v[96:99], v[196:199]
 v_mfma_f32_16x16x32_bf16 v[200:203], v[48:51], v[100:103], v[200:203]
 v_mfma_f32_16x16x32_bf16 v[204:207], v[48:51], v[104:107], v[204:207]
 s_waitcnt lgkmcnt(2)
 v_mfma_f32_16x16x32_bf16 v[232:235], v[40:43], v[84:87], v[232:235]
 v_mfma_f32_16x16x32_bf16 v[236:239], v[40:43], v[88:91], v[236:239]
 ds_read_b64_tr_b16 v[48:49], v7 offset:16384
 ds_read_b64_tr_b16 v[50:51], v7 offset:16896
 v_mfma_f32_16x16x32_bf16 v[240:243], v[40:43], v[92:95], v[240:243]
 s_mov_b32 m0, 110592
 s_add_u32 s46, s44, 786816
 buffer_load_dwordx4 v32, s[24:27], s46 offen offset:0 lds
 v_mfma_f32_16x16x32_bf16 v[244:247], v[40:43], v[96:99], v[244:247]
 v_mfma_f32_16x16x32_bf16 v[248:251], v[40:43], v[100:103], v[248:251]
 buffer_load_dwordx4 v33, s[24:27], s46 offen offset:1024 lds
 v_mfma_f32_16x16x32_bf16 v[252:255], v[40:43], v[104:107], v[252:255]
 s_waitcnt lgkmcnt(2)
 v_mfma_f32_16x16x32_bf16 v[160:163], v[44:47], v[108:111], v[160:163]
 buffer_load_dwordx4 v34, s[24:27], s46 offen offset:2048 lds
 v_mfma_f32_16x16x32_bf16 v[164:167], v[44:47], v[112:115], v[164:167]
 s_waitcnt vmcnt(23)
 ds_read_b64_tr_b16 v[40:41], v6 offset:20480
 ds_read_b64_tr_b16 v[42:43], v6 offset:20992
 v_mfma_f32_16x16x32_bf16 v[168:171], v[44:47], v[116:119], v[168:171]
 buffer_load_dwordx4 v35, s[24:27], s46 offen offset:3072 lds
 v_mfma_f32_16x16x32_bf16 v[172:175], v[44:47], v[120:123], v[172:175]
 v_mfma_f32_16x16x32_bf16 v[176:179], v[44:47], v[124:127], v[176:179]
 v_mfma_f32_16x16x32_bf16 v[180:183], v[44:47], v[128:131], v[180:183]
 s_waitcnt lgkmcnt(2)
 v_mfma_f32_16x16x32_bf16 v[184:187], v[48:51], v[108:111], v[184:187]
 v_mfma_f32_16x16x32_bf16 v[188:191], v[48:51], v[112:115], v[188:191]
 ds_read_b64_tr_b16 v[44:45], v7 offset:20480
 ds_read_b64_tr_b16 v[46:47], v7 offset:20992
 v_mfma_f32_16x16x32_bf16 v[192:195], v[48:51], v[116:119], v[192:195]
 v_mfma_f32_16x16x32_bf16 v[196:199], v[48:51], v[120:123], v[196:199]
 v_mfma_f32_16x16x32_bf16 v[200:203], v[48:51], v[124:127], v[200:203]
 v_mfma_f32_16x16x32_bf16 v[204:207], v[48:51], v[128:131], v[204:207]
 s_waitcnt lgkmcnt(2)
 v_mfma_f32_16x16x32_bf16 v[160:163], v[40:43], v[132:135], v[160:163]
 v_mfma_f32_16x16x32_bf16 v[164:167], v[40:43], v[136:139], v[164:167]
 s_waitcnt vmcnt(28)
 s_barrier
 ds_read_b64_tr_b16 v[48:49], v8 offset:16384
 ds_read_b64_tr_b16 v[50:51], v8 offset:16896
 v_mfma_f32_16x16x32_bf16 v[168:171], v[40:43], v[140:143], v[168:171]
 s_add_u32 s46, s15, 122880
 s_and_b32 s46, s46, 0x1ffff
 s_add_u32 s46, s46, s42
 s_mov_b32 m0, 45056
 s_add_u32 s46, s46, 4096
 buffer_load_dwordx4 v28, s[20:23], s46 offen offset:0 nt lds
 v_mfma_f32_16x16x32_bf16 v[172:175], v[40:43], v[144:147], v[172:175]
 v_mfma_f32_16x16x32_bf16 v[176:179], v[40:43], v[148:151], v[176:179]
 buffer_load_dwordx4 v29, s[20:23], s46 offen offset:1024 nt lds
 v_mfma_f32_16x16x32_bf16 v[180:183], v[40:43], v[152:155], v[180:183]
 s_waitcnt lgkmcnt(2)
 v_mfma_f32_16x16x32_bf16 v[184:187], v[44:47], v[132:135], v[184:187]
 buffer_load_dwordx4 v30, s[20:23], s46 offen offset:2048 nt lds
 v_mfma_f32_16x16x32_bf16 v[188:191], v[44:47], v[136:139], v[188:191]
 ds_read_b64_tr_b16 v[40:41], v9 offset:16384
 ds_read_b64_tr_b16 v[42:43], v9 offset:16896
 v_mfma_f32_16x16x32_bf16 v[192:195], v[44:47], v[140:143], v[192:195]
 buffer_load_dwordx4 v31, s[20:23], s46 offen offset:3072 nt lds
 v_mfma_f32_16x16x32_bf16 v[196:199], v[44:47], v[144:147], v[196:199]
 v_mfma_f32_16x16x32_bf16 v[200:203], v[44:47], v[148:151], v[200:203]
 v_mfma_f32_16x16x32_bf16 v[204:207], v[44:47], v[152:155], v[204:207]
 s_waitcnt lgkmcnt(2)
 v_mfma_f32_16x16x32_bf16 v[208:211], v[48:51], v[108:111], v[208:211]
 v_mfma_f32_16x16x32_bf16 v[212:215], v[48:51], v[112:115], v[212:215]
 ds_read_b64_tr_b16 v[44:45], v8 offset:20480
 ds_read_b64_tr_b16 v[46:47], v8 offset:20992
 v_mfma_f32_16x16x32_bf16 v[216:219], v[48:51], v[116:119], v[216:219]
 v_mfma_f32_16x16x32_bf16 v[220:223], v[48:51], v[120:123], v[220:223]
 v_mfma_f32_16x16x32_bf16 v[224:227], v[48:51], v[124:127], v[224:227]
 v_mfma_f32_16x16x32_bf16 v[228:231], v[48:51], v[128:131], v[228:231]
 v_mul_f32 v52, s48, v160
 v_mul_f32 v53, s48, v161
 v_mul_f32 v54, s48, v162
 v_mul_f32 v55, s48, v163
 v_cvt_pk_bf16_f32 v56, v52, v53
 s_waitcnt lgkmcnt(2)
 v_mfma_f32_16x16x32_bf16 v[232:235], v[40:43], v[108:111], v[232:235]
 v_cvt_pk_bf16_f32 v57, v54, v55
 v_mul_f32 v52, s48, v184
 v_mul_f32 v53, s48, v185
 v_mul_f32 v54, s48, v186
 v_mul_f32 v55, s48, v187
 v_cvt_pk_bf16_f32 v58, v52, v53
 v_mfma_f32_16x16x32_bf16 v[236:239], v[40:43], v[112:115], v[236:239]
 ds_read_b64_tr_b16 v[48:49], v9 offset:20480
 ds_read_b64_tr_b16 v[50:51], v9 offset:20992
 v_cvt_pk_bf16_f32 v59, v54, v55
 s_nop 0
 v_permlane16_swap_b32 v56, v58
 v_permlane16_swap_b32 v57, v59
 ds_write_b128 v22, v[56:59] offset:0
 v_mfma_f32_16x16x32_bf16 v[240:243], v[40:43], v[116:119], v[240:243]
 s_mov_b32 m0, 114688
 s_add_u32 s46, s44, 1048960
 buffer_load_dwordx4 v32, s[24:27], s46 offen offset:0 lds
 v_mul_f32 v52, s48, v164
 v_mul_f32 v53, s48, v165
 v_mul_f32 v54, s48, v166
 v_mul_f32 v55, s48, v167
 v_cvt_pk_bf16_f32 v60, v52, v53
 v_mfma_f32_16x16x32_bf16 v[244:247], v[40:43], v[120:123], v[244:247]
 v_cvt_pk_bf16_f32 v61, v54, v55
 v_mul_f32 v52, s48, v188
 v_mul_f32 v53, s48, v189
 v_mul_f32 v54, s48, v190
 v_mul_f32 v55, s48, v191
 v_mfma_f32_16x16x32_bf16 v[248:251], v[40:43], v[124:127], v[248:251]
 buffer_load_dwordx4 v33, s[24:27], s46 offen offset:1024 lds
 v_cvt_pk_bf16_f32 v62, v52, v53
 v_cvt_pk_bf16_f32 v63, v54, v55
 s_nop 0
 v_permlane16_swap_b32 v60, v62
 v_permlane16_swap_b32 v61, v63
 ds_write_b128 v22, v[60:63] offset:1024
 v_mfma_f32_16x16x32_bf16 v[252:255], v[40:43], v[128:131], v[252:255]
 v_mul_f32 v52, s48, v168
 v_mul_f32 v53, s48, v169
 v_mul_f32 v54, s48, v170
 v_mul_f32 v55, s48, v171
 v_cvt_pk_bf16_f32 v56, v52, v53
 s_waitcnt lgkmcnt(4)
 v_mfma_f32_16x16x32_bf16 v[208:211], v[44:47], v[132:135], v[208:211]
 buffer_load_dwordx4 v34, s[24:27], s46 offen offset:2048 lds
 v_cvt_pk_bf16_f32 v57, v54, v55
 v_mul_f32 v52, s48, v192
 v_mul_f32 v53, s48, v193
 v_mul_f32 v54, s48, v194
 v_mul_f32 v55, s48, v195
 v_cvt_pk_bf16_f32 v58, v52, v53
 v_mfma_f32_16x16x32_bf16 v[212:215], v[44:47], v[136:139], v[212:215]
 s_waitcnt vmcnt(63)
 s_barrier
 s_waitcnt vmcnt(27)
 ds_read_b64_tr_b16 v[40:41], v6 offset:0
 ds_read_b64_tr_b16 v[42:43], v6 offset:512
 v_cvt_pk_bf16_f32 v59, v54, v55
 s_nop 0
 v_permlane16_swap_b32 v56, v58
 v_permlane16_swap_b32 v57, v59
 ds_write_b128 v22, v[56:59] offset:4096
 v_mfma_f32_16x16x32_bf16 v[216:219], v[44:47], v[140:143], v[216:219]
 buffer_load_dwordx4 v35, s[24:27], s46 offen offset:3072 lds
 v_mul_f32 v52, s48, v172
 v_mul_f32 v53, s48, v173
 v_mul_f32 v54, s48, v174
 v_mul_f32 v55, s48, v175
 v_cvt_pk_bf16_f32 v60, v52, v53
 v_mfma_f32_16x16x32_bf16 v[220:223], v[44:47], v[144:147], v[220:223]
 v_cvt_pk_bf16_f32 v61, v54, v55
 v_mul_f32 v52, s48, v196
 v_mul_f32 v53, s48, v197
 v_mul_f32 v54, s48, v198
 v_mul_f32 v55, s48, v199
 v_mfma_f32_16x16x32_bf16 v[224:227], v[44:47], v[148:151], v[224:227]
 v_cvt_pk_bf16_f32 v62, v52, v53
 v_cvt_pk_bf16_f32 v63, v54, v55
 s_nop 0
 v_permlane16_swap_b32 v60, v62
 v_permlane16_swap_b32 v61, v63
 ds_write_b128 v22, v[60:63] offset:5120
 v_mfma_f32_16x16x32_bf16 v[228:231], v[44:47], v[152:155], v[228:231]
 v_mul_f32 v52, s48, v176
 v_mul_f32 v53, s48, v177
 v_mul_f32 v54, s48, v178
 v_mul_f32 v55, s48, v179
 v_cvt_pk_bf16_f32 v56, v52, v53
 s_waitcnt lgkmcnt(6)
 v_mfma_f32_16x16x32_bf16 v[232:235], v[48:51], v[132:135], v[232:235]
 v_cvt_pk_bf16_f32 v57, v54, v55
 v_mul_f32 v52, s48, v200
 v_mul_f32 v53, s48, v201
 v_mul_f32 v54, s48, v202
 v_mul_f32 v55, s48, v203
 v_cvt_pk_bf16_f32 v58, v52, v53
 v_mfma_f32_16x16x32_bf16 v[236:239], v[48:51], v[136:139], v[236:239]
 ds_read_b64_tr_b16 v[44:45], v7 offset:0
 ds_read_b64_tr_b16 v[46:47], v7 offset:512
 v_cvt_pk_bf16_f32 v59, v54, v55
 s_nop 0
 v_permlane16_swap_b32 v56, v58
 v_permlane16_swap_b32 v57, v59
 ds_write_b128 v22, v[56:59] offset:8192
 v_mfma_f32_16x16x32_bf16 v[240:243], v[48:51], v[140:143], v[240:243]
 s_mov_b32 m0, 118784
 s_add_u32 s46, s44, 1311104
 buffer_load_dwordx4 v32, s[24:27], s46 offen offset:0 lds
 v_mul_f32 v52, s48, v180
 v_mul_f32 v53, s48, v181
 v_mul_f32 v54, s48, v182
 v_mul_f32 v55, s48, v183
 v_cvt_pk_bf16_f32 v60, v52, v53
 v_mfma_f32_16x16x32_bf16 v[244:247], v[48:51], v[144:147], v[244:247]
 v_cvt_pk_bf16_f32 v61, v54, v55
 v_mul_f32 v52, s48, v204
 v_mul_f32 v53, s48, v205
 v_mul_f32 v54, s48, v206
 v_mul_f32 v55, s48, v207
 v_mfma_f32_16x16x32_bf16 v[248:251], v[48:51], v[148:151], v[248:251]
 buffer_load_dwordx4 v33, s[24:27], s46 offen offset:1024 lds
 v_cvt_pk_bf16_f32 v62, v52, v53
 v_cvt_pk_bf16_f32 v63, v54, v55
 s_nop 0
 v_permlane16_swap_b32 v60, v62
 v_permlane16_swap_b32 v61, v63
 ds_write_b128 v22, v[60:63] offset:9216
 v_mfma_f32_16x16x32_bf16 v[252:255], v[48:51], v[152:155], v[252:255]
 s_waitcnt lgkmcnt(6)
 v_mfma_f32_16x16x32_bf16 v[160:163], v[40:43], a[0:3], 0
 buffer_load_dwordx4 v34, s[24:27], s46 offen offset:2048 lds
 v_mfma_f32_16x16x32_bf16 v[164:167], v[40:43], a[4:7], 0
 s_waitcnt vmcnt(23)
 ds_read_b64_tr_b16 v[48:49], v6 offset:4096
 ds_read_b64_tr_b16 v[50:51], v6 offset:4608
 v_mfma_f32_16x16x32_bf16 v[168:171], v[40:43], a[8:11], 0
 buffer_load_dwordx4 v35, s[24:27], s46 offen offset:3072 lds
 v_mfma_f32_16x16x32_bf16 v[172:175], v[40:43], a[12:15], 0
 v_mfma_f32_16x16x32_bf16 v[176:179], v[40:43], a[16:19], 0
 v_mfma_f32_16x16x32_bf16 v[180:183], v[40:43], a[20:23], 0
 v_mul_f32 v52, s48, v208
 v_mul_f32 v53, s48, v209
 v_mul_f32 v54, s48, v210
 v_mul_f32 v55, s48, v211
 v_cvt_pk_bf16_f32 v56, v52, v53
 s_waitcnt lgkmcnt(4)
 v_mfma_f32_16x16x32_bf16 v[184:187], v[44:47], a[0:3], 0
 v_cvt_pk_bf16_f32 v57, v54, v55
 v_mul_f32 v52, s48, v232
 v_mul_f32 v53, s48, v233
 v_mul_f32 v54, s48, v234
 v_mul_f32 v55, s48, v235
 v_cvt_pk_bf16_f32 v58, v52, v53
 v_mfma_f32_16x16x32_bf16 v[188:191], v[44:47], a[4:7], 0
 ds_read_b64_tr_b16 v[40:41], v7 offset:4096
 ds_read_b64_tr_b16 v[42:43], v7 offset:4608
 v_cvt_pk_bf16_f32 v59, v54, v55
 s_nop 0
 v_permlane16_swap_b32 v56, v58
 v_permlane16_swap_b32 v57, v59
 ds_write_b128 v22, v[56:59] offset:2048
 v_mfma_f32_16x16x32_bf16 v[192:195], v[44:47], a[8:11], 0
 v_mul_f32 v52, s48, v212
 v_mul_f32 v53, s48, v213
 v_mul_f32 v54, s48, v214
 v_mul_f32 v55, s48, v215
 v_cvt_pk_bf16_f32 v60, v52, v53
 v_mfma_f32_16x16x32_bf16 v[196:199], v[44:47], a[12:15], 0
 s_waitcnt vmcnt(63)
 s_barrier
 v_cvt_pk_bf16_f32 v61, v54, v55
 v_mul_f32 v52, s48, v236
 v_mul_f32 v53, s48, v237
 v_mul_f32 v54, s48, v238
 v_mul_f32 v55, s48, v239
 v_mfma_f32_16x16x32_bf16 v[200:203], v[44:47], a[16:19], 0
 s_cmp_eq_u32 s47, 2
 s_cselect_b32 s94, 0, s94
 s_add_u32 s46, s44, 512
 buffer_load_dword v15, v12, s[92:95], s46 offen
 v_cvt_pk_bf16_f32 v62, v52, v53
 v_cvt_pk_bf16_f32 v63, v54, v55
 s_nop 0
 v_permlane16_swap_b32 v60, v62
 v_permlane16_swap_b32 v61, v63
 ds_write_b128 v22, v[60:63] offset:3072
 v_mfma_f32_16x16x32_bf16 v[204:207], v[44:47], a[20:23], 0
 v_mul_f32 v52, s48, v216
 v_mul_f32 v53, s48, v217
 v_mul_f32 v54, s48, v218
 v_mul_f32 v55, s48, v219
 v_cvt_pk_bf16_f32 v56, v52, v53
 s_waitcnt lgkmcnt(4)
 v_mfma_f32_16x16x32_bf16 v[160:163], v[48:51], a[24:27], v[160:163]
 s_add_u32 s46, s44, 147968
 buffer_load_dword v15, v12, s[92:95], s46 offen
 v_cvt_pk_bf16_f32 v57, v54, v55
 v_mul_f32 v52, s48, v240
 v_mul_f32 v53, s48, v241
 v_mul_f32 v54, s48, v242
 v_mul_f32 v55, s48, v243
 v_cvt_pk_bf16_f32 v58, v52, v53
 v_mfma_f32_16x16x32_bf16 v[164:167], v[48:51], a[28:31], v[164:167]
 ds_read_b64_tr_b16 v[44:45], v8 offset:0
 ds_read_b64_tr_b16 v[46:47], v8 offset:512
 v_cvt_pk_bf16_f32 v59, v54, v55
 s_nop 0
 v_permlane16_swap_b32 v56, v58
 v_permlane16_swap_b32 v57, v59
 ds_write_b128 v22, v[56:59] offset:6144
 v_mfma_f32_16x16x32_bf16 v[168:171], v[48:51], a[32:35], v[168:171]
 v_mul_f32 v52, s48, v220
 v_mul_f32 v53, s48, v221
 v_mul_f32 v54, s48, v222
 v_mul_f32 v55, s48, v223
 v_cvt_pk_bf16_f32 v60, v52, v53
 v_mfma_f32_16x16x32_bf16 v[172:175], v[48:51], a[36:39], v[172:175]
 v_cvt_pk_bf16_f32 v61, v54, v55
 v_mul_f32 v52, s48, v244
 v_mul_f32 v53, s48, v245
 v_mul_f32 v54, s48, v246
 v_mul_f32 v55, s48, v247
 v_mfma_f32_16x16x32_bf16 v[176:179], v[48:51], a[40:43], v[176:179]
 v_cvt_pk_bf16_f32 v62, v52, v53
 v_cvt_pk_bf16_f32 v63, v54, v55
 s_nop 0
 v_permlane16_swap_b32 v60, v62
 v_permlane16_swap_b32 v61, v63
 ds_write_b128 v22, v[60:63] offset:7168
 v_mfma_f32_16x16x32_bf16 v[180:183], v[48:51], a[44:47], v[180:183]
 v_mul_f32 v52, s48, v224
 v_mul_f32 v53, s48, v225
 v_mul_f32 v54, s48, v226
 v_mul_f32 v55, s48, v227
 v_cvt_pk_bf16_f32 v56, v52, v53
 s_waitcnt lgkmcnt(6)
 v_mfma_f32_16x16x32_bf16 v[184:187], v[40:43], a[24:27], v[184:187]
 v_cvt_pk_bf16_f32 v57, v54, v55
 v_mul_f32 v52, s48, v248
 v_mul_f32 v53, s48, v249
 v_mul_f32 v54, s48, v250
 v_mul_f32 v55, s48, v251
 v_cvt_pk_bf16_f32 v58, v52, v53
 v_mfma_f32_16x16x32_bf16 v[188:191], v[40:43], a[28:31], v[188:191]
 ds_read_b64_tr_b16 v[48:49], v9 offset:0
 ds_read_b64_tr_b16 v[50:51], v9 offset:512
 v_cvt_pk_bf16_f32 v59, v54, v55
 s_nop 0
 v_permlane16_swap_b32 v56, v58
 v_permlane16_swap_b32 v57, v59
 ds_write_b128 v22, v[56:59] offset:10240
 v_mfma_f32_16x16x32_bf16 v[192:195], v[40:43], a[32:35], v[192:195]
 v_mul_f32 v52, s48, v228
 v_mul_f32 v53, s48, v229
 v_mul_f32 v54, s48, v230
 v_mul_f32 v55, s48, v231
 v_cvt_pk_bf16_f32 v60, v52, v53
 v_mfma_f32_16x16x32_bf16 v[196:199], v[40:43], a[36:39], v[196:199]
 v_cvt_pk_bf16_f32 v61, v54, v55
 v_mul_f32 v52, s48, v252
 v_mul_f32 v53, s48, v253
 v_mul_f32 v54, s48, v254
 v_mul_f32 v55, s48, v255
 v_mfma_f32_16x16x32_bf16 v[200:203], v[40:43], a[40:43], v[200:203]
 v_cvt_pk_bf16_f32 v62, v52, v53
 v_cvt_pk_bf16_f32 v63, v54, v55
 s_nop 0
 v_permlane16_swap_b32 v60, v62
 v_permlane16_swap_b32 v61, v63
 ds_write_b128 v22, v[60:63] offset:11264
 v_mfma_f32_16x16x32_bf16 v[204:207], v[40:43], a[44:47], v[204:207]
 s_waitcnt lgkmcnt(6)
 v_mfma_f32_16x16x32_bf16 v[208:211], v[44:47], a[0:3], 0
 v_mfma_f32_16x16x32_bf16 v[212:215], v[44:47], a[4:7], 0
 ds_read_b64_tr_b16 v[40:41], v8 offset:4096
 ds_read_b64_tr_b16 v[42:43], v8 offset:4608
 v_mfma_f32_16x16x32_bf16 v[216:219], v[44:47], a[8:11], 0
 v_mfma_f32_16x16x32_bf16 v[220:223], v[44:47], a[12:15], 0
 v_mfma_f32_16x16x32_bf16 v[224:227], v[44:47], a[16:19], 0
 v_mfma_f32_16x16x32_bf16 v[228:231], v[44:47], a[20:23], 0
 s_waitcnt lgkmcnt(4)
 v_mfma_f32_16x16x32_bf16 v[232:235], v[48:51], a[0:3], 0
 v_mfma_f32_16x16x32_bf16 v[236:239], v[48:51], a[4:7], 0
 ds_read_b64_tr_b16 v[44:45], v9 offset:4096
 ds_read_b64_tr_b16 v[46:47], v9 offset:4608
 v_mfma_f32_16x16x32_bf16 v[240:243], v[48:51], a[8:11], 0
 s_mov_b32 m0, 98304
 s_add_u32 s46, s44, 3670400
 buffer_load_dwordx4 v32, s[24:27], s46 offen offset:0 lds
 v_mfma_f32_16x16x32_bf16 v[244:247], v[48:51], a[12:15], 0
 s_waitcnt vmcnt(31)
 s_barrier
 v_mfma_f32_16x16x32_bf16 v[248:251], v[48:51], a[16:19], 0
 buffer_load_dwordx4 v33, s[24:27], s46 offen offset:1024 lds
 v_mfma_f32_16x16x32_bf16 v[252:255], v[48:51], a[20:23], 0
 s_waitcnt lgkmcnt(2)
 v_mfma_f32_16x16x32_bf16 v[208:211], v[40:43], a[24:27], v[208:211]
 buffer_load_dwordx4 v34, s[24:27], s46 offen offset:2048 lds
 v_mfma_f32_16x16x32_bf16 v[212:215], v[40:43], a[28:31], v[212:215]
 s_waitcnt vmcnt(21)
 ds_read_b64_tr_b16 v[48:49], v6 offset:8192
 ds_read_b64_tr_b16 v[50:51], v6 offset:8704
 v_mfma_f32_16x16x32_bf16 v[216:219], v[40:43], a[32:35], v[216:219]
 buffer_load_dwordx4 v35, s[24:27], s46 offen offset:3072 lds
 v_mfma_f32_16x16x32_bf16 v[220:223], v[40:43], a[36:39], v[220:223]
 v_mfma_f32_16x16x32_bf16 v[224:227], v[40:43], a[40:43], v[224:227]
 v_mfma_f32_16x16x32_bf16 v[228:231], v[40:43], a[44:47], v[228:231]
 s_waitcnt lgkmcnt(2)
 v_mfma_f32_16x16x32_bf16 v[232:235], v[44:47], a[24:27], v[232:235]
 v_mfma_f32_16x16x32_bf16 v[236:239], v[44:47], a[28:31], v[236:239]
 ds_read_b64_tr_b16 v[40:41], v8 offset:8192
 ds_read_b64_tr_b16 v[42:43], v8 offset:8704
 v_mfma_f32_16x16x32_bf16 v[240:243], v[44:47], a[32:35], v[240:243]
 s_mov_b32 m0, 102400
 s_add_u32 s46, s44, 3932544
 buffer_load_dwordx4 v32, s[24:27], s46 offen offset:0 lds
 v_mfma_f32_16x16x32_bf16 v[244:247], v[44:47], a[36:39], v[244:247]
 v_mfma_f32_16x16x32_bf16 v[248:251], v[44:47], a[40:43], v[248:251]
 buffer_load_dwordx4 v33, s[24:27], s46 offen offset:1024 lds
 v_mfma_f32_16x16x32_bf16 v[252:255], v[44:47], a[44:47], v[252:255]
 s_waitcnt lgkmcnt(2)
 v_mfma_f32_16x16x32_bf16 v[160:163], v[48:51], a[48:51], v[160:163]
 buffer_load_dwordx4 v34, s[24:27], s46 offen offset:2048 lds
 v_mfma_f32_16x16x32_bf16 v[164:167], v[48:51], a[52:55], v[164:167]
 ds_read_b64_tr_b16 v[44:45], v7 offset:8192
 ds_read_b64_tr_b16 v[46:47], v7 offset:8704
 v_mfma_f32_16x16x32_bf16 v[168:171], v[48:51], a[56:59], v[168:171]
 buffer_load_dwordx4 v35, s[24:27], s46 offen offset:3072 lds
 v_mfma_f32_16x16x32_bf16 v[172:175], v[48:51], a[60:63], v[172:175]
 v_mfma_f32_16x16x32_bf16 v[176:179], v[48:51], a[64:67], v[176:179]
 v_mfma_f32_16x16x32_bf16 v[180:183], v[48:51], a[68:71], v[180:183]
 s_waitcnt lgkmcnt(2)
 v_mfma_f32_16x16x32_bf16 v[208:211], v[40:43], a[48:51], v[208:211]
 v_mfma_f32_16x16x32_bf16 v[212:215], v[40:43], a[52:55], v[212:215]
 ds_read_b64_tr_b16 v[48:49], v9 offset:8192
 ds_read_b64_tr_b16 v[50:51], v9 offset:8704
 v_mfma_f32_16x16x32_bf16 v[216:219], v[40:43], a[56:59], v[216:219]
 v_mfma_f32_16x16x32_bf16 v[220:223], v[40:43], a[60:63], v[220:223]
 v_mfma_f32_16x16x32_bf16 v[224:227], v[40:43], a[64:67], v[224:227]
 v_mfma_f32_16x16x32_bf16 v[228:231], v[40:43], a[68:71], v[228:231]
 s_waitcnt lgkmcnt(2)
 v_mfma_f32_16x16x32_bf16 v[184:187], v[44:47], a[48:51], v[184:187]
 v_mfma_f32_16x16x32_bf16 v[188:191], v[44:47], a[52:55], v[188:191]
 s_waitcnt vmcnt(22)
 ds_read_b64_tr_b16 v[40:41], v6 offset:12288
 ds_read_b64_tr_b16 v[42:43], v6 offset:12800
 v_mfma_f32_16x16x32_bf16 v[192:195], v[44:47], a[56:59], v[192:195]
 v_mfma_f32_16x16x32_bf16 v[196:199], v[44:47], a[60:63], v[196:199]
 v_mfma_f32_16x16x32_bf16 v[200:203], v[44:47], a[64:67], v[200:203]
 v_mfma_f32_16x16x32_bf16 v[204:207], v[44:47], a[68:71], v[204:207]
 s_waitcnt lgkmcnt(2)
 v_mfma_f32_16x16x32_bf16 v[232:235], v[48:51], a[48:51], v[232:235]
 v_mfma_f32_16x16x32_bf16 v[236:239], v[48:51], a[52:55], v[236:239]
 ds_read_b64_tr_b16 v[44:45], v8 offset:12288
 ds_read_b64_tr_b16 v[46:47], v8 offset:12800
 v_mfma_f32_16x16x32_bf16 v[240:243], v[48:51], a[56:59], v[240:243]
 s_mov_b32 m0, 106496
 s_add_u32 s46, s44, 4194688
 buffer_load_dwordx4 v32, s[24:27], s46 offen offset:0 lds
 v_mfma_f32_16x16x32_bf16 v[244:247], v[48:51], a[60:63], v[244:247]
 v_mfma_f32_16x16x32_bf16 v[248:251], v[48:51], a[64:67], v[248:251]
 buffer_load_dwordx4 v33, s[24:27], s46 offen offset:1024 lds
 v_mfma_f32_16x16x32_bf16 v[252:255], v[48:51], a[68:71], v[252:255]
 s_waitcnt lgkmcnt(2)
 v_mfma_f32_16x16x32_bf16 v[160:163], v[40:43], a[72:75], v[160:163]
 buffer_load_dwordx4 v34, s[24:27], s46 offen offset:2048 lds
 v_mfma_f32_16x16x32_bf16 v[164:167], v[40:43], a[76:79], v[164:167]
 s_waitcnt vmcnt(33)
 s_barrier
 ds_read_b64_tr_b16 v[48:49], v7 offset:12288
 ds_read_b64_tr_b16 v[50:51], v7 offset:12800
 v_mfma_f32_16x16x32_bf16 v[168:171], v[40:43], a[80:83], v[168:171]
 buffer_load_dwordx4 v35, s[24:27], s46 offen offset:3072 lds
 v_mfma_f32_16x16x32_bf16 v[172:175], v[40:43], a[84:87], v[172:175]
 v_mfma_f32_16x16x32_bf16 v[176:179], v[40:43], a[88:91], v[176:179]
 s_add_u32 s46, s45, s80
 s_mov_b32 m0, 12288
 s_add_u32 s46, s46, 110592
 buffer_load_dwordx4 v36, s[28:31], s46 offen offset:0 lds
 v_mfma_f32_16x16x32_bf16 v[180:183], v[40:43], a[92:95], v[180:183]
 s_waitcnt lgkmcnt(2)
 v_mfma_f32_16x16x32_bf16 v[208:211], v[44:47], a[72:75], v[208:211]
 buffer_load_dwordx4 v37, s[28:31], s46 offen offset:1024 lds
 v_mfma_f32_16x16x32_bf16 v[212:215], v[44:47], a[76:79], v[212:215]
 ds_read_b64_tr_b16 v[40:41], v9 offset:12288
 ds_read_b64_tr_b16 v[42:43], v9 offset:12800
 v_mfma_f32_16x16x32_bf16 v[216:219], v[44:47], a[80:83], v[216:219]
 buffer_load_dwordx4 v38, s[28:31], s46 offen offset:2048 lds
 v_mfma_f32_16x16x32_bf16 v[220:223], v[44:47], a[84:87], v[220:223]
 v_mfma_f32_16x16x32_bf16 v[224:227], v[44:47], a[88:91], v[224:227]
 buffer_load_dwordx4 v39, s[28:31], s46 offen offset:3072 lds
 v_mfma_f32_16x16x32_bf16 v[228:231], v[44:47], a[92:95], v[228:231]
 s_waitcnt lgkmcnt(2)
 v_mfma_f32_16x16x32_bf16 v[184:187], v[48:51], a[72:75], v[184:187]
 s_add_u32 s42, s42, 0x20000
 s_add_u32 s46, s15, 8192
 s_and_b32 s46, s46, 0x1ffff
 s_add_u32 s46, s46, s42
 s_mov_b32 m0, 61440
 s_add_u32 s46, s46, 4096
 buffer_load_dwordx4 v24, s[16:19], s46 offen offset:0 nt lds
 v_mfma_f32_16x16x32_bf16 v[188:191], v[48:51], a[76:79], v[188:191]
 s_waitcnt vmcnt(23)
 ds_read_b64_tr_b16 v[44:45], v6 offset:16384
 ds_read_b64_tr_b16 v[46:47], v6 offset:16896
 v_mfma_f32_16x16x32_bf16 v[192:195], v[48:51], a[80:83], v[192:195]
 buffer_load_dwordx4 v25, s[16:19], s46 offen offset:1024 nt lds
 v_mfma_f32_16x16x32_bf16 v[196:199], v[48:51], a[84:87], v[196:199]
 v_mfma_f32_16x16x32_bf16 v[200:203], v[48:51], a[88:91], v[200:203]
 buffer_load_dwordx4 v26, s[16:19], s46 offen offset:2048 nt lds
 v_mfma_f32_16x16x32_bf16 v[204:207], v[48:51], a[92:95], v[204:207]
 s_waitcnt lgkmcnt(2)
 v_mfma_f32_16x16x32_bf16 v[232:235], v[40:43], a[72:75], v[232:235]
 buffer_load_dwordx4 v27, s[16:19], s46 offen offset:3072 nt lds
 v_mfma_f32_16x16x32_bf16 v[236:239], v[40:43], a[76:79], v[236:239]
 ds_read_b64_tr_b16 v[48:49], v8 offset:16384
 ds_read_b64_tr_b16 v[50:51], v8 offset:16896
 v_mfma_f32_16x16x32_bf16 v[240:243], v[40:43], a[80:83], v[240:243]
 s_mov_b32 m0, 110592
 s_add_u32 s46, s44, 4456832
 buffer_load_dwordx4 v32, s[24:27], s46 offen offset:0 lds
 v_mfma_f32_16x16x32_bf16 v[244:247], v[40:43], a[84:87], v[244:247]
 v_mfma_f32_16x16x32_bf16 v[248:251], v[40:43], a[88:91], v[248:251]
 buffer_load_dwordx4 v33, s[24:27], s46 offen offset:1024 lds
 v_mfma_f32_16x16x32_bf16 v[252:255], v[40:43], a[92:95], v[252:255]
 s_waitcnt lgkmcnt(2)
 v_mfma_f32_16x16x32_bf16 v[160:163], v[44:47], a[96:99], v[160:163]
 buffer_load_dwordx4 v34, s[24:27], s46 offen offset:2048 lds
 v_mfma_f32_16x16x32_bf16 v[164:167], v[44:47], a[100:103], v[164:167]
 ds_read_b64_tr_b16 v[40:41], v7 offset:16384
 ds_read_b64_tr_b16 v[42:43], v7 offset:16896
 v_mfma_f32_16x16x32_bf16 v[168:171], v[44:47], a[104:107], v[168:171]
 buffer_load_dwordx4 v35, s[24:27], s46 offen offset:3072 lds
 v_mfma_f32_16x16x32_bf16 v[172:175], v[44:47], a[108:111], v[172:175]
 v_mfma_f32_16x16x32_bf16 v[176:179], v[44:47], a[112:115], v[176:179]
 v_mfma_f32_16x16x32_bf16 v[180:183], v[44:47], a[116:119], v[180:183]
 s_waitcnt lgkmcnt(2)
 v_mfma_f32_16x16x32_bf16 v[208:211], v[48:51], a[96:99], v[208:211]
 v_mfma_f32_16x16x32_bf16 v[212:215], v[48:51], a[100:103], v[212:215]
 ds_read_b64_tr_b16 v[44:45], v9 offset:16384
 ds_read_b64_tr_b16 v[46:47], v9 offset:16896
 v_mfma_f32_16x16x32_bf16 v[216:219], v[48:51], a[104:107], v[216:219]
 v_mfma_f32_16x16x32_bf16 v[220:223], v[48:51], a[108:111], v[220:223]
 v_mfma_f32_16x16x32_bf16 v[224:227], v[48:51], a[112:115], v[224:227]
 v_mfma_f32_16x16x32_bf16 v[228:231], v[48:51], a[116:119], v[228:231]
 s_waitcnt lgkmcnt(2)
 v_mfma_f32_16x16x32_bf16 v[184:187], v[40:43], a[96:99], v[184:187]
 v_mfma_f32_16x16x32_bf16 v[188:191], v[40:43], a[100:103], v[188:191]
 s_waitcnt vmcnt(26)
 ds_read_b64_tr_b16 v[48:49], v6 offset:20480
 ds_read_b64_tr_b16 v[50:51], v6 offset:20992
 v_mfma_f32_16x16x32_bf16 v[192:195], v[40:43], a[104:107], v[192:195]
 v_mfma_f32_16x16x32_bf16 v[196:199], v[40:43], a[108:111], v[196:199]
 v_mfma_f32_16x16x32_bf16 v[200:203], v[40:43], a[112:115], v[200:203]
 v_mfma_f32_16x16x32_bf16 v[204:207], v[40:43], a[116:119], v[204:207]
 s_waitcnt lgkmcnt(2)
 v_mfma_f32_16x16x32_bf16 v[232:235], v[44:47], a[96:99], v[232:235]
 v_mfma_f32_16x16x32_bf16 v[236:239], v[44:47], a[100:103], v[236:239]
 s_waitcnt vmcnt(34)
 s_barrier
 ds_read_b64_tr_b16 v[40:41], v8 offset:20480
 ds_read_b64_tr_b16 v[42:43], v8 offset:20992
 v_mfma_f32_16x16x32_bf16 v[240:243], v[44:47], a[104:107], v[240:243]
 s_add_u32 s46, s45, s81
 s_mov_b32 m0, 28672
 s_add_u32 s46, s46, 110592
 buffer_load_dwordx4 v36, s[28:31], s46 offen offset:0 lds
 v_mfma_f32_16x16x32_bf16 v[244:247], v[44:47], a[108:111], v[244:247]
 v_mfma_f32_16x16x32_bf16 v[248:251], v[44:47], a[112:115], v[248:251]
 buffer_load_dwordx4 v37, s[28:31], s46 offen offset:1024 lds
 v_mfma_f32_16x16x32_bf16 v[252:255], v[44:47], a[116:119], v[252:255]
 s_waitcnt lgkmcnt(2)
 v_mfma_f32_16x16x32_bf16 v[160:163], v[48:51], a[120:123], v[160:163]
 buffer_load_dwordx4 v38, s[28:31], s46 offen offset:2048 lds
 v_mfma_f32_16x16x32_bf16 v[164:167], v[48:51], a[124:127], v[164:167]
 ds_read_b64_tr_b16 v[44:45], v7 offset:20480
 ds_read_b64_tr_b16 v[46:47], v7 offset:20992
 v_mfma_f32_16x16x32_bf16 v[168:171], v[48:51], a[128:131], v[168:171]
 buffer_load_dwordx4 v39, s[28:31], s46 offen offset:3072 lds
 v_mfma_f32_16x16x32_bf16 v[172:175], v[48:51], a[132:135], v[172:175]
 v_mfma_f32_16x16x32_bf16 v[176:179], v[48:51], a[136:139], v[176:179]
 s_mov_b32 m0, 114688
 s_add_u32 s46, s44, 1573248
 buffer_load_dwordx4 v32, s[24:27], s46 offen offset:0 lds
 v_mfma_f32_16x16x32_bf16 v[180:183], v[48:51], a[140:143], v[180:183]
 s_waitcnt lgkmcnt(2)
 v_mfma_f32_16x16x32_bf16 v[208:211], v[40:43], a[120:123], v[208:211]
 buffer_load_dwordx4 v33, s[24:27], s46 offen offset:1024 lds
 v_mfma_f32_16x16x32_bf16 v[212:215], v[40:43], a[124:127], v[212:215]
 ds_read_b64_tr_b16 v[48:49], v9 offset:20480
 ds_read_b64_tr_b16 v[50:51], v9 offset:20992
 v_mfma_f32_16x16x32_bf16 v[216:219], v[40:43], a[128:131], v[216:219]
 buffer_load_dwordx4 v34, s[24:27], s46 offen offset:2048 lds
 v_mfma_f32_16x16x32_bf16 v[220:223], v[40:43], a[132:135], v[220:223]
 v_mfma_f32_16x16x32_bf16 v[224:227], v[40:43], a[136:139], v[224:227]
 buffer_load_dwordx4 v35, s[24:27], s46 offen offset:3072 lds
 v_mfma_f32_16x16x32_bf16 v[228:231], v[40:43], a[140:143], v[228:231]
 s_waitcnt lgkmcnt(2)
 v_mfma_f32_16x16x32_bf16 v[184:187], v[44:47], a[120:123], v[184:187]
 v_mfma_f32_16x16x32_bf16 v[188:191], v[44:47], a[124:127], v[188:191]
 s_waitcnt vmcnt(28)
 ds_read_b64_tr_b16 v[40:41], v6 offset:0
 ds_read_b64_tr_b16 v[42:43], v6 offset:512
 v_mfma_f32_16x16x32_bf16 v[192:195], v[44:47], a[128:131], v[192:195]
 v_mfma_f32_16x16x32_bf16 v[196:199], v[44:47], a[132:135], v[196:199]
 v_mfma_f32_16x16x32_bf16 v[200:203], v[44:47], a[136:139], v[200:203]
 v_mfma_f32_16x16x32_bf16 v[204:207], v[44:47], a[140:143], v[204:207]
 s_waitcnt lgkmcnt(2)
 v_mfma_f32_16x16x32_bf16 v[232:235], v[48:51], a[120:123], v[232:235]
 v_mfma_f32_16x16x32_bf16 v[236:239], v[48:51], a[124:127], v[236:239]
 ds_read_b64_tr_b16 v[44:45], v8 offset:0
 ds_read_b64_tr_b16 v[46:47], v8 offset:512
 ds_read_b128 v[52:55], v4 offset:0
 ds_read_b128 v[56:59], v4 offset:2048
 v_mfma_f32_16x16x32_bf16 v[240:243], v[48:51], a[128:131], v[240:243]
 s_mov_b32 m0, 118784
 s_add_u32 s46, s44, 1835392
 buffer_load_dwordx4 v32, s[24:27], s46 offen offset:0 lds
 v_mfma_f32_16x16x32_bf16 v[244:247], v[48:51], a[132:135], v[244:247]
 ds_read_b128 v[60:63], v4 offset:4096
 ds_read_b128 v[64:67], v4 offset:6144
 v_mfma_f32_16x16x32_bf16 v[248:251], v[48:51], a[136:139], v[248:251]
 buffer_load_dwordx4 v33, s[24:27], s46 offen offset:1024 lds
 v_mfma_f32_16x16x32_bf16 v[252:255], v[48:51], a[140:143], v[252:255]
 ds_read_b128 v[68:71], v4 offset:8192
 ds_read_b128 v[72:75], v4 offset:10240
 s_waitcnt lgkmcnt(5)
 v_mfma_f32_16x16x32_bf16 v[160:163], v[40:43], v[52:55], v[160:163]
 buffer_load_dwordx4 v34, s[24:27], s46 offen offset:2048 lds
 s_waitcnt lgkmcnt(4)
 v_mfma_f32_16x16x32_bf16 v[164:167], v[40:43], v[56:59], v[164:167]
 ds_read_b64_tr_b16 v[48:49], v7 offset:0
 ds_read_b64_tr_b16 v[50:51], v7 offset:512
 s_waitcnt lgkmcnt(5)
 v_mfma_f32_16x16x32_bf16 v[168:171], v[40:43], v[60:63], v[168:171]
 buffer_load_dwordx4 v35, s[24:27], s46 offen offset:3072 lds
 s_waitcnt lgkmcnt(4)
 v_mfma_f32_16x16x32_bf16 v[172:175], v[40:43], v[64:67], v[172:175]
 s_waitcnt lgkmcnt(3)
 v_mfma_f32_16x16x32_bf16 v[176:179], v[40:43], v[68:71], v[176:179]
 s_waitcnt lgkmcnt(2)
 v_mfma_f32_16x16x32_bf16 v[180:183], v[40:43], v[72:75], v[180:183]
 v_mfma_f32_16x16x32_bf16 v[208:211], v[44:47], v[52:55], v[208:211]
 v_mfma_f32_16x16x32_bf16 v[212:215], v[44:47], v[56:59], v[212:215]
 ds_read_b64_tr_b16 v[40:41], v9 offset:0
 ds_read_b64_tr_b16 v[42:43], v9 offset:512
 v_mfma_f32_16x16x32_bf16 v[216:219], v[44:47], v[60:63], v[216:219]
 v_mfma_f32_16x16x32_bf16 v[220:223], v[44:47], v[64:67], v[220:223]
 v_mfma_f32_16x16x32_bf16 v[224:227], v[44:47], v[68:71], v[224:227]
 v_mfma_f32_16x16x32_bf16 v[228:231], v[44:47], v[72:75], v[228:231]
 s_waitcnt lgkmcnt(2)
 v_mfma_f32_16x16x32_bf16 v[184:187], v[48:51], v[52:55], v[184:187]
 v_mfma_f32_16x16x32_bf16 v[188:191], v[48:51], v[56:59], v[188:191]
 s_waitcnt vmcnt(28)
 ds_read_b64_tr_b16 v[44:45], v6 offset:4096
 ds_read_b64_tr_b16 v[46:47], v6 offset:4608
 v_mfma_f32_16x16x32_bf16 v[192:195], v[48:51], v[60:63], v[192:195]
 v_mfma_f32_16x16x32_bf16 v[196:199], v[48:51], v[64:67], v[196:199]
 s_waitcnt vmcnt(20)
 s_barrier
 v_mfma_f32_16x16x32_bf16 v[200:203], v[48:51], v[68:71], v[200:203]
 s_add_u32 s46, s45, s82
 s_mov_b32 m0, 45056
 s_add_u32 s46, s46, 110592
 buffer_load_dwordx4 v36, s[28:31], s46 offen offset:0 lds
 v_mfma_f32_16x16x32_bf16 v[204:207], v[48:51], v[72:75], v[204:207]
 s_waitcnt lgkmcnt(2)
 v_mfma_f32_16x16x32_bf16 v[232:235], v[40:43], v[52:55], v[232:235]
 buffer_load_dwordx4 v37, s[28:31], s46 offen offset:1024 lds
 v_mfma_f32_16x16x32_bf16 v[236:239], v[40:43], v[56:59], v[236:239]
 ds_read_b64_tr_b16 v[48:49], v8 offset:4096
 ds_read_b64_tr_b16 v[50:51], v8 offset:4608
 ds_read_b128 v[52:55], v5 offset:0
 ds_read_b128 v[56:59], v5 offset:2048
 v_mfma_f32_16x16x32_bf16 v[240:243], v[40:43], v[60:63], v[240:243]
 buffer_load_dwordx4 v38, s[28:31], s46 offen offset:2048 lds
 v_mfma_f32_16x16x32_bf16 v[244:247], v[40:43], v[64:67], v[244:247]
 ds_read_b128 v[60:63], v5 offset:4096
 ds_read_b128 v[64:67], v5 offset:6144
 v_mfma_f32_16x16x32_bf16 v[248:251], v[40:43], v[68:71], v[248:251]
 buffer_load_dwordx4 v39, s[28:31], s46 offen offset:3072 lds
 v_mfma_f32_16x16x32_bf16 v[252:255], v[40:43], v[72:75], v[252:255]
 ds_read_b128 v[68:71], v5 offset:8192
 ds_read_b128 v[72:75], v5 offset:10240
 s_waitcnt lgkmcnt(5)
 v_mfma_f32_16x16x32_bf16 v[160:163], v[44:47], v[52:55], v[160:163]
 s_add_u32 s46, s15, 0
 s_and_b32 s46, s46, 0x1ffff
 s_add_u32 s46, s46, s42
 s_mov_b32 m0, 77824
 s_add_u32 s46, s46, 4096
 buffer_load_dwordx4 v28, s[20:23], s46 offen offset:0 nt lds
 s_waitcnt lgkmcnt(4)
 v_mfma_f32_16x16x32_bf16 v[164:167], v[44:47], v[56:59], v[164:167]
 ds_read_b64_tr_b16 v[40:41], v7 offset:4096
 ds_read_b64_tr_b16 v[42:43], v7 offset:4608
 s_waitcnt lgkmcnt(5)
 v_mfma_f32_16x16x32_bf16 v[168:171], v[44:47], v[60:63], v[168:171]
 buffer_load_dwordx4 v29, s[20:23], s46 offen offset:1024 nt lds
 s_waitcnt lgkmcnt(4)
 v_mfma_f32_16x16x32_bf16 v[172:175], v[44:47], v[64:67], v[172:175]
 s_waitcnt lgkmcnt(3)
 v_mfma_f32_16x16x32_bf16 v[176:179], v[44:47], v[68:71], v[176:179]
 buffer_load_dwordx4 v30, s[20:23], s46 offen offset:2048 nt lds
 s_waitcnt lgkmcnt(2)
 v_mfma_f32_16x16x32_bf16 v[180:183], v[44:47], v[72:75], v[180:183]
 v_mfma_f32_16x16x32_bf16 v[208:211], v[48:51], v[52:55], v[208:211]
 buffer_load_dwordx4 v31, s[20:23], s46 offen offset:3072 nt lds
 v_mfma_f32_16x16x32_bf16 v[212:215], v[48:51], v[56:59], v[212:215]
 ds_read_b64_tr_b16 v[44:45], v9 offset:4096
 ds_read_b64_tr_b16 v[46:47], v9 offset:4608
 v_mfma_f32_16x16x32_bf16 v[216:219], v[48:51], v[60:63], v[216:219]
 s_mov_b32 m0, 98304
 s_add_u32 s46, s44, 2097536
 buffer_load_dwordx4 v32, s[24:27], s46 offen offset:0 lds
 v_mfma_f32_16x16x32_bf16 v[220:223], v[48:51], v[64:67], v[220:223]
 v_mfma_f32_16x16x32_bf16 v[224:227], v[48:51], v[68:71], v[224:227]
 buffer_load_dwordx4 v33, s[24:27], s46 offen offset:1024 lds
 v_mfma_f32_16x16x32_bf16 v[228:231], v[48:51], v[72:75], v[228:231]
 s_waitcnt lgkmcnt(2)
 v_mfma_f32_16x16x32_bf16 v[184:187], v[40:43], v[52:55], v[184:187]
 buffer_load_dwordx4 v34, s[24:27], s46 offen offset:2048 lds
 v_mfma_f32_16x16x32_bf16 v[188:191], v[40:43], v[56:59], v[188:191]
 s_waitcnt vmcnt(35)
 ds_read_b64_tr_b16 v[48:49], v6 offset:8192
 ds_read_b64_tr_b16 v[50:51], v6 offset:8704
 v_mfma_f32_16x16x32_bf16 v[192:195], v[40:43], v[60:63], v[192:195]
 buffer_load_dwordx4 v35, s[24:27], s46 offen offset:3072 lds
 v_mfma_f32_16x16x32_bf16 v[196:199], v[40:43], v[64:67], v[196:199]
 v_mfma_f32_16x16x32_bf16 v[200:203], v[40:43], v[68:71], v[200:203]
 v_mfma_f32_16x16x32_bf16 v[204:207], v[40:43], v[72:75], v[204:207]
 s_waitcnt lgkmcnt(2)
 v_mfma_f32_16x16x32_bf16 v[232:235], v[44:47], v[52:55], v[232:235]
 v_mfma_f32_16x16x32_bf16 v[236:239], v[44:47], v[56:59], v[236:239]
 ds_read_b64_tr_b16 v[40:41], v8 offset:8192
 ds_read_b64_tr_b16 v[42:43], v8 offset:8704
 ds_read_b128 v[52:55], v4 offset:12288
 ds_read_b128 v[56:59], v4 offset:14336
 v_mfma_f32_16x16x32_bf16 v[240:243], v[44:47], v[60:63], v[240:243]
 s_mov_b32 m0, 102400
 s_add_u32 s46, s44, 2359680
 buffer_load_dwordx4 v32, s[24:27], s46 offen offset:0 lds
 v_mfma_f32_16x16x32_bf16 v[244:247], v[44:47], v[64:67], v[244:247]
 ds_read_b128 v[60:63], v4 offset:16384
 ds_read_b128 v[64:67], v4 offset:18432
 v_mfma_f32_16x16x32_bf16 v[248:251], v[44:47], v[68:71], v[248:251]
 buffer_load_dwordx4 v33, s[24:27], s46 offen offset:1024 lds
 v_mfma_f32_16x16x32_bf16 v[252:255], v[44:47], v[72:75], v[252:255]
 ds_read_b128 v[68:71], v4 offset:20480
 ds_read_b128 v[72:75], v4 offset:22528
 s_waitcnt lgkmcnt(5)
 v_mfma_f32_16x16x32_bf16 v[160:163], v[48:51], v[52:55], v[160:163]
 buffer_load_dwordx4 v34, s[24:27], s46 offen offset:2048 lds
 s_waitcnt lgkmcnt(4)
 v_mfma_f32_16x16x32_bf16 v[164:167], v[48:51], v[56:59], v[164:167]
 ds_read_b64_tr_b16 v[44:45], v7 offset:8192
 ds_read_b64_tr_b16 v[46:47], v7 offset:8704
 s_waitcnt lgkmcnt(5)
 v_mfma_f32_16x16x32_bf16 v[168:171], v[48:51], v[60:63], v[168:171]
 buffer_load_dwordx4 v35, s[24:27], s46 offen offset:3072 lds
 s_waitcnt lgkmcnt(4)
 v_mfma_f32_16x16x32_bf16 v[172:175], v[48:51], v[64:67], v[172:175]
 s_waitcnt lgkmcnt(3)
 v_mfma_f32_16x16x32_bf16 v[176:179], v[48:51], v[68:71], v[176:179]
 s_waitcnt lgkmcnt(2)
 v_mfma_f32_16x16x32_bf16 v[180:183], v[48:51], v[72:75], v[180:183]
 v_mfma_f32_16x16x32_bf16 v[208:211], v[40:43], v[52:55], v[208:211]
 v_mfma_f32_16x16x32_bf16 v[212:215], v[40:43], v[56:59], v[212:215]
 ds_read_b64_tr_b16 v[48:49], v9 offset:8192
 ds_read_b64_tr_b16 v[50:51], v9 offset:8704
 v_mfma_f32_16x16x32_bf16 v[216:219], v[40:43], v[60:63], v[216:219]
 v_mfma_f32_16x16x32_bf16 v[220:223], v[40:43], v[64:67], v[220:223]
 v_mfma_f32_16x16x32_bf16 v[224:227], v[40:43], v[68:71], v[224:227]
 v_mfma_f32_16x16x32_bf16 v[228:231], v[40:43], v[72:75], v[228:231]
 s_waitcnt lgkmcnt(2)
 v_mfma_f32_16x16x32_bf16 v[184:187], v[44:47], v[52:55], v[184:187]
 v_mfma_f32_16x16x32_bf16 v[188:191], v[44:47], v[56:59], v[188:191]
 s_waitcnt vmcnt(28)
 ds_read_b64_tr_b16 v[40:41], v6 offset:12288
 ds_read_b64_tr_b16 v[42:43], v6 offset:12800
 v_mfma_f32_16x16x32_bf16 v[192:195], v[44:47], v[60:63], v[192:195]
 v_mfma_f32_16x16x32_bf16 v[196:199], v[44:47], v[64:67], v[196:199]
 v_mfma_f32_16x16x32_bf16 v[200:203], v[44:47], v[68:71], v[200:203]
 v_mfma_f32_16x16x32_bf16 v[204:207], v[44:47], v[72:75], v[204:207]
 s_waitcnt lgkmcnt(2)
 v_mfma_f32_16x16x32_bf16 v[232:235], v[48:51], v[52:55], v[232:235]
 v_mfma_f32_16x16x32_bf16 v[236:239], v[48:51], v[56:59], v[236:239]
 s_waitcnt vmcnt(24)
 s_barrier
 ds_read_b64_tr_b16 v[44:45], v8 offset:12288
 ds_read_b64_tr_b16 v[46:47], v8 offset:12800
 ds_read_b128 v[52:55], v5 offset:12288
 ds_read_b128 v[56:59], v5 offset:14336
 v_mfma_f32_16x16x32_bf16 v[240:243], v[48:51], v[60:63], v[240:243]
 s_add_u32 s46, s45, s83
 s_mov_b32 m0, 12288
 s_add_u32 s46, s46, 110592
 buffer_load_dwordx4 v36, s[28:31], s46 offen offset:0 lds
 v_mfma_f32_16x16x32_bf16 v[244:247], v[48:51], v[64:67], v[244:247]
 ds_read_b128 v[60:63], v5 offset:16384
 ds_read_b128 v[64:67], v5 offset:18432
 v_mfma_f32_16x16x32_bf16 v[248:251], v[48:51], v[68:71], v[248:251]
 buffer_load_dwordx4 v37, s[28:31], s46 offen offset:1024 lds
 v_mfma_f32_16x16x32_bf16 v[252:255], v[48:51], v[72:75], v[252:255]
 ds_read_b128 v[68:71], v5 offset:20480
 ds_read_b128 v[72:75], v5 offset:22528
 s_waitcnt lgkmcnt(5)
 v_mfma_f32_16x16x32_bf16 v[160:163], v[40:43], v[52:55], v[160:163]
 buffer_load_dwordx4 v38, s[28:31], s46 offen offset:2048 lds
 s_waitcnt lgkmcnt(4)
 v_mfma_f32_16x16x32_bf16 v[164:167], v[40:43], v[56:59], v[164:167]
 ds_read_b64_tr_b16 v[48:49], v7 offset:12288
 ds_read_b64_tr_b16 v[50:51], v7 offset:12800
 s_waitcnt lgkmcnt(5)
 v_mfma_f32_16x16x32_bf16 v[168:171], v[40:43], v[60:63], v[168:171]
 buffer_load_dwordx4 v39, s[28:31], s46 offen offset:3072 lds
 s_waitcnt lgkmcnt(4)
 v_mfma_f32_16x16x32_bf16 v[172:175], v[40:43], v[64:67], v[172:175]
 s_waitcnt lgkmcnt(3)
 v_mfma_f32_16x16x32_bf16 v[176:179], v[40:43], v[68:71], v[176:179]
 s_mov_b32 m0, 106496
 s_add_u32 s46, s44, 2621824
 buffer_load_dwordx4 v32, s[24:27], s46 offen offset:0 lds
 s_waitcnt lgkmcnt(2)
 v_mfma_f32_16x16x32_bf16 v[180:183], v[40:43], v[72:75], v[180:183]
 v_mfma_f32_16x16x32_bf16 v[208:211], v[44:47], v[52:55], v[208:211]
 buffer_load_dwordx4 v33, s[24:27], s46 offen offset:1024 lds
 v_mfma_f32_16x16x32_bf16 v[212:215], v[44:47], v[56:59], v[212:215]
 ds_read_b64_tr_b16 v[40:41], v9 offset:12288
 ds_read_b64_tr_b16 v[42:43], v9 offset:12800
 v_mfma_f32_16x16x32_bf16 v[216:219], v[44:47], v[60:63], v[216:219]
 buffer_load_dwordx4 v34, s[24:27], s46 offen offset:2048 lds
 v_mfma_f32_16x16x32_bf16 v[220:223], v[44:47], v[64:67], v[220:223]
 v_mfma_f32_16x16x32_bf16 v[224:227], v[44:47], v[68:71], v[224:227]
 buffer_load_dwordx4 v35, s[24:27], s46 offen offset:3072 lds
 v_mfma_f32_16x16x32_bf16 v[228:231], v[44:47], v[72:75], v[228:231]
 s_waitcnt lgkmcnt(2)
 v_mfma_f32_16x16x32_bf16 v[184:187], v[48:51], v[52:55], v[184:187]
 v_mfma_f32_16x16x32_bf16 v[188:191], v[48:51], v[56:59], v[188:191]
 s_waitcnt vmcnt(28)
 ds_read_b64_tr_b16 v[44:45], v6 offset:16384
 ds_read_b64_tr_b16 v[46:47], v6 offset:16896
 v_mfma_f32_16x16x32_bf16 v[192:195], v[48:51], v[60:63], v[192:195]
 v_mfma_f32_16x16x32_bf16 v[196:199], v[48:51], v[64:67], v[196:199]
 v_mfma_f32_16x16x32_bf16 v[200:203], v[48:51], v[68:71], v[200:203]
 v_mfma_f32_16x16x32_bf16 v[204:207], v[48:51], v[72:75], v[204:207]
 s_waitcnt lgkmcnt(2)
 v_mfma_f32_16x16x32_bf16 v[232:235], v[40:43], v[52:55], v[232:235]
 v_mfma_f32_16x16x32_bf16 v[236:239], v[40:43], v[56:59], v[236:239]
 ds_read_b64_tr_b16 v[48:49], v8 offset:16384
 ds_read_b64_tr_b16 v[50:51], v8 offset:16896
 v_mfma_f32_16x16x32_bf16 v[240:243], v[40:43], v[60:63], v[240:243]
 s_mov_b32 m0, 110592
 s_add_u32 s46, s44, 2883968
 buffer_load_dwordx4 v32, s[24:27], s46 offen offset:0 lds
 v_mfma_f32_16x16x32_bf16 v[244:247], v[40:43], v[64:67], v[244:247]
 v_mfma_f32_16x16x32_bf16 v[248:251], v[40:43], v[68:71], v[248:251]
 buffer_load_dwordx4 v33, s[24:27], s46 offen offset:1024 lds
 v_mfma_f32_16x16x32_bf16 v[252:255], v[40:43], v[72:75], v[252:255]
 s_waitcnt lgkmcnt(2)
 v_mfma_f32_16x16x32_bf16 v[160:163], v[44:47], a[144:147], v[160:163]
 buffer_load_dwordx4 v34, s[24:27], s46 offen offset:2048 lds
 v_mfma_f32_16x16x32_bf16 v[164:167], v[44:47], a[148:151], v[164:167]
 ds_read_b64_tr_b16 v[40:41], v7 offset:16384
 ds_read_b64_tr_b16 v[42:43], v7 offset:16896
 v_mfma_f32_16x16x32_bf16 v[168:171], v[44:47], a[152:155], v[168:171]
 buffer_load_dwordx4 v35, s[24:27], s46 offen offset:3072 lds
 v_mfma_f32_16x16x32_bf16 v[172:175], v[44:47], a[156:159], v[172:175]
 s_waitcnt vmcnt(24)
 s_barrier
 v_mfma_f32_16x16x32_bf16 v[176:179], v[44:47], a[160:163], v[176:179]
 s_add_u32 s46, s45, s84
 s_mov_b32 m0, 28672
 s_add_u32 s46, s46, 110592
 buffer_load_dwordx4 v36, s[28:31], s46 offen offset:0 lds
 v_mfma_f32_16x16x32_bf16 v[180:183], v[44:47], a[164:167], v[180:183]
 s_waitcnt lgkmcnt(2)
 v_mfma_f32_16x16x32_bf16 v[208:211], v[48:51], a[144:147], v[208:211]
 buffer_load_dwordx4 v37, s[28:31], s46 offen offset:1024 lds
 v_mfma_f32_16x16x32_bf16 v[212:215], v[48:51], a[148:151], v[212:215]
 ds_read_b64_tr_b16 v[44:45], v9 offset:16384
 ds_read_b64_tr_b16 v[46:47], v9 offset:16896
 v_mfma_f32_16x16x32_bf16 v[216:219], v[48:51], a[152:155], v[216:219]
 buffer_load_dwordx4 v38, s[28:31], s46 offen offset:2048 lds
 v_mfma_f32_16x16x32_bf16 v[220:223], v[48:51], a[156:159], v[220:223]
 v_mfma_f32_16x16x32_bf16 v[224:227], v[48:51], a[160:163], v[224:227]
 buffer_load_dwordx4 v39, s[28:31], s46 offen offset:3072 lds
 v_mfma_f32_16x16x32_bf16 v[228:231], v[48:51], a[164:167], v[228:231]
 s_waitcnt lgkmcnt(2)
 v_mfma_f32_16x16x32_bf16 v[184:187], v[40:43], a[144:147], v[184:187]
 s_add_u32 s46, s15, 8192
 s_and_b32 s46, s46, 0x1ffff
 s_add_u32 s46, s46, s42
 s_mov_b32 m0, 94208
 s_add_u32 s46, s46, 4096
 buffer_load_dwordx4 v28, s[20:23], s46 offen offset:0 nt lds
 v_mfma_f32_16x16x32_bf16 v[188:191], v[40:43], a[148:151], v[188:191]
 s_waitcnt vmcnt(33)
 ds_read_b64_tr_b16 v[48:49], v6 offset:20480
 ds_read_b64_tr_b16 v[50:51], v6 offset:20992
 v_mfma_f32_16x16x32_bf16 v[192:195], v[40:43], a[152:155], v[192:195]
 buffer_load_dwordx4 v29, s[20:23], s46 offen offset:1024 nt lds
 v_mfma_f32_16x16x32_bf16 v[196:199], v[40:43], a[156:159], v[196:199]
 v_mfma_f32_16x16x32_bf16 v[200:203], v[40:43], a[160:163], v[200:203]
 buffer_load_dwordx4 v30, s[20:23], s46 offen offset:2048 nt lds
 v_mfma_f32_16x16x32_bf16 v[204:207], v[40:43], a[164:167], v[204:207]
 s_waitcnt lgkmcnt(2)
 v_mfma_f32_16x16x32_bf16 v[232:235], v[44:47], a[144:147], v[232:235]
 buffer_load_dwordx4 v31, s[20:23], s46 offen offset:3072 nt lds
 v_mfma_f32_16x16x32_bf16 v[236:239], v[44:47], a[148:151], v[236:239]
 ds_read_b64_tr_b16 v[40:41], v8 offset:20480
 ds_read_b64_tr_b16 v[42:43], v8 offset:20992
 v_mfma_f32_16x16x32_bf16 v[240:243], v[44:47], a[152:155], v[240:243]
 s_mov_b32 m0, 114688
 s_add_u32 s46, s44, 3146112
 buffer_load_dwordx4 v32, s[24:27], s46 offen offset:0 lds
 v_mfma_f32_16x16x32_bf16 v[244:247], v[44:47], a[156:159], v[244:247]
 v_mfma_f32_16x16x32_bf16 v[248:251], v[44:47], a[160:163], v[248:251]
 buffer_load_dwordx4 v33, s[24:27], s46 offen offset:1024 lds
 v_mfma_f32_16x16x32_bf16 v[252:255], v[44:47], a[164:167], v[252:255]
 s_waitcnt lgkmcnt(2)
 v_mfma_f32_16x16x32_bf16 v[160:163], v[48:51], a[168:171], v[160:163]
 buffer_load_dwordx4 v34, s[24:27], s46 offen offset:2048 lds
 v_mfma_f32_16x16x32_bf16 v[164:167], v[48:51], a[172:175], v[164:167]
 ds_read_b64_tr_b16 v[44:45], v7 offset:20480
 ds_read_b64_tr_b16 v[46:47], v7 offset:20992
 v_mfma_f32_16x16x32_bf16 v[168:171], v[48:51], a[176:179], v[168:171]
 buffer_load_dwordx4 v35, s[24:27], s46 offen offset:3072 lds
 v_mfma_f32_16x16x32_bf16 v[172:175], v[48:51], a[180:183], v[172:175]
 v_mfma_f32_16x16x32_bf16 v[176:179], v[48:51], a[184:187], v[176:179]
 v_mfma_f32_16x16x32_bf16 v[180:183], v[48:51], a[188:191], v[180:183]
 s_waitcnt lgkmcnt(2)
 v_mfma_f32_16x16x32_bf16 v[208:211], v[40:43], a[168:171], v[208:211]
 v_mfma_f32_16x16x32_bf16 v[212:215], v[40:43], a[172:175], v[212:215]
 ds_read_b64_tr_b16 v[48:49], v9 offset:20480
 ds_read_b64_tr_b16 v[50:51], v9 offset:20992
 v_mfma_f32_16x16x32_bf16 v[216:219], v[40:43], a[176:179], v[216:219]
 v_mfma_f32_16x16x32_bf16 v[220:223], v[40:43], a[180:183], v[220:223]
 v_mfma_f32_16x16x32_bf16 v[224:227], v[40:43], a[184:187], v[224:227]
 v_mfma_f32_16x16x32_bf16 v[228:231], v[40:43], a[188:191], v[228:231]
 s_waitcnt lgkmcnt(2)
 v_mfma_f32_16x16x32_bf16 v[184:187], v[44:47], a[168:171], v[184:187]
 v_mfma_f32_16x16x32_bf16 v[188:191], v[44:47], a[172:175], v[188:191]
 s_waitcnt vmcnt(28)
 ds_read_b64_tr_b16 v[40:41], v6 offset:0
 ds_read_b64_tr_b16 v[42:43], v6 offset:512
 v_mfma_f32_16x16x32_bf16 v[192:195], v[44:47], a[176:179], v[192:195]
 v_mfma_f32_16x16x32_bf16 v[196:199], v[44:47], a[180:183], v[196:199]
 v_mfma_f32_16x16x32_bf16 v[200:203], v[44:47], a[184:187], v[200:203]
 v_mfma_f32_16x16x32_bf16 v[204:207], v[44:47], a[188:191], v[204:207]
 s_waitcnt vmcnt(20)
 s_barrier
 s_waitcnt lgkmcnt(2)
 v_mfma_f32_16x16x32_bf16 v[232:235], v[48:51], a[168:171], v[232:235]
 s_add_u32 s46, s45, s85
 s_mov_b32 m0, 45056
 s_add_u32 s46, s46, 110592
 buffer_load_dwordx4 v36, s[28:31], s46 offen offset:0 lds
 v_mfma_f32_16x16x32_bf16 v[236:239], v[48:51], a[172:175], v[236:239]
 ds_read_b64_tr_b16 v[44:45], v8 offset:0
 ds_read_b64_tr_b16 v[46:47], v8 offset:512
 v_mfma_f32_16x16x32_bf16 v[240:243], v[48:51], a[176:179], v[240:243]
 buffer_load_dwordx4 v37, s[28:31], s46 offen offset:1024 lds
 v_mfma_f32_16x16x32_bf16 v[244:247], v[48:51], a[180:183], v[244:247]
 v_mfma_f32_16x16x32_bf16 v[248:251], v[48:51], a[184:187], v[248:251]
 buffer_load_dwordx4 v38, s[28:31], s46 offen offset:2048 lds
 v_mfma_f32_16x16x32_bf16 v[252:255], v[48:51], a[188:191], v[252:255]
 s_waitcnt lgkmcnt(2)
 v_mfma_f32_16x16x32_bf16 v[160:163], v[40:43], a[192:195], v[160:163]
 buffer_load_dwordx4 v39, s[28:31], s46 offen offset:3072 lds
 v_mfma_f32_16x16x32_bf16 v[164:167], v[40:43], a[196:199], v[164:167]
 ds_read_b64_tr_b16 v[48:49], v7 offset:0
 ds_read_b64_tr_b16 v[50:51], v7 offset:512
 v_mfma_f32_16x16x32_bf16 v[168:171], v[40:43], a[200:203], v[168:171]
 s_mov_b32 m0, 118784
 s_add_u32 s46, s44, 3408256
 buffer_load_dwordx4 v32, s[24:27], s46 offen offset:0 lds
 v_mfma_f32_16x16x32_bf16 v[172:175], v[40:43], a[204:207], v[172:175]
 v_mfma_f32_16x16x32_bf16 v[176:179], v[40:43], a[208:211], v[176:179]
 buffer_load_dwordx4 v33, s[24:27], s46 offen offset:1024 lds
 v_mfma_f32_16x16x32_bf16 v[180:183], v[40:43], a[212:215], v[180:183]
 s_waitcnt lgkmcnt(2)
 v_mfma_f32_16x16x32_bf16 v[208:211], v[44:47], a[192:195], v[208:211]
 buffer_load_dwordx4 v34, s[24:27], s46 offen offset:2048 lds
 v_mfma_f32_16x16x32_bf16 v[212:215], v[44:47], a[196:199], v[212:215]
 ds_read_b64_tr_b16 v[40:41], v9 offset:0
 ds_read_b64_tr_b16 v[42:43], v9 offset:512
 v_mfma_f32_16x16x32_bf16 v[216:219], v[44:47], a[200:203], v[216:219]
 buffer_load_dwordx4 v35, s[24:27], s46 offen offset:3072 lds
 v_mfma_f32_16x16x32_bf16 v[220:223], v[44:47], a[204:207], v[220:223]
 v_mfma_f32_16x16x32_bf16 v[224:227], v[44:47], a[208:211], v[224:227]
 v_mfma_f32_16x16x32_bf16 v[228:231], v[44:47], a[212:215], v[228:231]
 s_waitcnt lgkmcnt(2)
 v_mfma_f32_16x16x32_bf16 v[184:187], v[48:51], a[192:195], v[184:187]
 v_mfma_f32_16x16x32_bf16 v[188:191], v[48:51], a[196:199], v[188:191]
 s_waitcnt vmcnt(32)
 ds_read_b64_tr_b16 v[44:45], v6 offset:4096
 ds_read_b64_tr_b16 v[46:47], v6 offset:4608
 v_mfma_f32_16x16x32_bf16 v[192:195], v[48:51], a[200:203], v[192:195]
 v_mfma_f32_16x16x32_bf16 v[196:199], v[48:51], a[204:207], v[196:199]
 v_mfma_f32_16x16x32_bf16 v[200:203], v[48:51], a[208:211], v[200:203]
 v_mfma_f32_16x16x32_bf16 v[204:207], v[48:51], a[212:215], v[204:207]
 s_waitcnt lgkmcnt(2)
 v_mfma_f32_16x16x32_bf16 v[232:235], v[40:43], a[192:195], v[232:235]
 v_mfma_f32_16x16x32_bf16 v[236:239], v[40:43], a[196:199], v[236:239]
 ds_read_b64_tr_b16 v[48:49], v8 offset:4096
 ds_read_b64_tr_b16 v[50:51], v8 offset:4608
 v_mfma_f32_16x16x32_bf16 v[240:243], v[40:43], a[200:203], v[240:243]
 v_mfma_f32_16x16x32_bf16 v[244:247], v[40:43], a[204:207], v[244:247]
 v_mfma_f32_16x16x32_bf16 v[248:251], v[40:43], a[208:211], v[248:251]
 v_mfma_f32_16x16x32_bf16 v[252:255], v[40:43], a[212:215], v[252:255]
 s_waitcnt lgkmcnt(2)
 v_mfma_f32_16x16x32_bf16 v[160:163], v[44:47], a[216:219], v[160:163]
 v_mfma_f32_16x16x32_bf16 v[164:167], v[44:47], a[220:223], v[164:167]
 ds_read_b64_tr_b16 v[40:41], v7 offset:4096
 ds_read_b64_tr_b16 v[42:43], v7 offset:4608
 v_mfma_f32_16x16x32_bf16 v[168:171], v[44:47], a[224:227], v[168:171]
 v_mfma_f32_16x16x32_bf16 v[172:175], v[44:47], a[228:231], v[172:175]
 s_waitcnt vmcnt(16)
 s_barrier
 v_mfma_f32_16x16x32_bf16 v[176:179], v[44:47], a[232:235], v[176:179]
 s_add_u32 s46, s45, s86
 s_mov_b32 m0, 12288
 s_add_u32 s46, s46, 110592
 buffer_load_dwordx4 v36, s[28:31], s46 offen offset:0 lds
 v_mfma_f32_16x16x32_bf16 v[180:183], v[44:47], a[236:239], v[180:183]
 s_waitcnt lgkmcnt(2)
 v_mfma_f32_16x16x32_bf16 v[208:211], v[48:51], a[216:219], v[208:211]
 buffer_load_dwordx4 v37, s[28:31], s46 offen offset:1024 lds
 v_mfma_f32_16x16x32_bf16 v[212:215], v[48:51], a[220:223], v[212:215]
 ds_read_b64_tr_b16 v[44:45], v9 offset:4096
 ds_read_b64_tr_b16 v[46:47], v9 offset:4608
 v_mfma_f32_16x16x32_bf16 v[216:219], v[48:51], a[224:227], v[216:219]
 buffer_load_dwordx4 v38, s[28:31], s46 offen offset:2048 lds
 v_mfma_f32_16x16x32_bf16 v[220:223], v[48:51], a[228:231], v[220:223]
 v_mfma_f32_16x16x32_bf16 v[224:227], v[48:51], a[232:235], v[224:227]
 buffer_load_dwordx4 v39, s[28:31], s46 offen offset:3072 lds
 v_mfma_f32_16x16x32_bf16 v[228:231], v[48:51], a[236:239], v[228:231]
 s_waitcnt lgkmcnt(2)
 v_mfma_f32_16x16x32_bf16 v[184:187], v[40:43], a[216:219], v[184:187]
 v_mfma_f32_16x16x32_bf16 v[188:191], v[40:43], a[220:223], v[188:191]
 s_waitcnt vmcnt(28)
 ds_read_b64_tr_b16 v[48:49], v6 offset:8192
 ds_read_b64_tr_b16 v[50:51], v6 offset:8704
 v_mfma_f32_16x16x32_bf16 v[192:195], v[40:43], a[224:227], v[192:195]
 v_mfma_f32_16x16x32_bf16 v[196:199], v[40:43], a[228:231], v[196:199]
 v_mfma_f32_16x16x32_bf16 v[200:203], v[40:43], a[232:235], v[200:203]
 v_mfma_f32_16x16x32_bf16 v[204:207], v[40:43], a[236:239], v[204:207]
 s_waitcnt lgkmcnt(2)
 v_mfma_f32_16x16x32_bf16 v[232:235], v[44:47], a[216:219], v[232:235]
 v_mfma_f32_16x16x32_bf16 v[236:239], v[44:47], a[220:223], v[236:239]
 ds_read_b64_tr_b16 v[40:41], v8 offset:8192
 ds_read_b64_tr_b16 v[42:43], v8 offset:8704
 v_mfma_f32_16x16x32_bf16 v[240:243], v[44:47], a[224:227], v[240:243]
 v_mfma_f32_16x16x32_bf16 v[244:247], v[44:47], a[228:231], v[244:247]
 v_mfma_f32_16x16x32_bf16 v[248:251], v[44:47], a[232:235], v[248:251]
 v_mfma_f32_16x16x32_bf16 v[252:255], v[44:47], a[236:239], v[252:255]
 s_waitcnt lgkmcnt(2)
 v_mfma_f32_16x16x32_bf16 v[160:163], v[48:51], a[240:243], v[160:163]
 v_mfma_f32_16x16x32_bf16 v[164:167], v[48:51], a[244:247], v[164:167]
 ds_read_b64_tr_b16 v[44:45], v7 offset:8192
 ds_read_b64_tr_b16 v[46:47], v7 offset:8704
 v_mfma_f32_16x16x32_bf16 v[168:171], v[48:51], a[248:251], v[168:171]
 v_mfma_f32_16x16x32_bf16 v[172:175], v[48:51], a[252:255], v[172:175]
 v_mfma_f32_16x16x32_bf16 v[176:179], v[48:51], v[76:79], v[176:179]
 v_mfma_f32_16x16x32_bf16 v[180:183], v[48:51], v[80:83], v[180:183]
 s_waitcnt lgkmcnt(2)
 v_mfma_f32_16x16x32_bf16 v[208:211], v[40:43], a[240:243], v[208:211]
 v_mfma_f32_16x16x32_bf16 v[212:215], v[40:43], a[244:247], v[212:215]
 ds_read_b64_tr_b16 v[48:49], v9 offset:8192
 ds_read_b64_tr_b16 v[50:51], v9 offset:8704
 v_mfma_f32_16x16x32_bf16 v[216:219], v[40:43], a[248:251], v[216:219]
 v_mfma_f32_16x16x32_bf16 v[220:223], v[40:43], a[252:255], v[220:223]
 v_mfma_f32_16x16x32_bf16 v[224:227], v[40:43], v[76:79], v[224:227]
 v_mfma_f32_16x16x32_bf16 v[228:231], v[40:43], v[80:83], v[228:231]
 s_waitcnt lgkmcnt(2)
 v_mfma_f32_16x16x32_bf16 v[184:187], v[44:47], a[240:243], v[184:187]
 v_mfma_f32_16x16x32_bf16 v[188:191], v[44:47], a[244:247], v[188:191]
 s_waitcnt vmcnt(24)
 ds_read_b64_tr_b16 v[40:41], v6 offset:12288
 ds_read_b64_tr_b16 v[42:43], v6 offset:12800
 v_mfma_f32_16x16x32_bf16 v[192:195], v[44:47], a[248:251], v[192:195]
 v_mfma_f32_16x16x32_bf16 v[196:199], v[44:47], a[252:255], v[196:199]
 s_waitcnt vmcnt(8)
 s_barrier
 v_mfma_f32_16x16x32_bf16 v[200:203], v[44:47], v[76:79], v[200:203]
 s_add_u32 s46, s45, s87
 s_mov_b32 m0, 28672
 s_add_u32 s46, s46, 110592
 buffer_load_dwordx4 v36, s[28:31], s46 offen offset:0 lds
 v_mfma_f32_16x16x32_bf16 v[204:207], v[44:47], v[80:83], v[204:207]
 s_waitcnt lgkmcnt(2)
 v_mfma_f32_16x16x32_bf16 v[232:235], v[48:51], a[240:243], v[232:235]
 buffer_load_dwordx4 v37, s[28:31], s46 offen offset:1024 lds
 v_mfma_f32_16x16x32_bf16 v[236:239], v[48:51], a[244:247], v[236:239]
 ds_read_b64_tr_b16 v[44:45], v8 offset:12288
 ds_read_b64_tr_b16 v[46:47], v8 offset:12800
 v_mfma_f32_16x16x32_bf16 v[240:243], v[48:51], a[248:251], v[240:243]
 buffer_load_dwordx4 v38, s[28:31], s46 offen offset:2048 lds
 v_mfma_f32_16x16x32_bf16 v[244:247], v[48:51], a[252:255], v[244:247]
 v_mfma_f32_16x16x32_bf16 v[248:251], v[48:51], v[76:79], v[248:251]
 buffer_load_dwordx4 v39, s[28:31], s46 offen offset:3072 lds
 v_mfma_f32_16x16x32_bf16 v[252:255], v[48:51], v[80:83], v[252:255]
 s_waitcnt lgkmcnt(2)
 v_mfma_f32_16x16x32_bf16 v[160:163], v[40:43], v[84:87], v[160:163]
 s_add_u32 s44, s44, 256
 s_mov_b32 m0, 98304
 s_add_u32 s46, s44, 256
 buffer_load_dwordx4 v32, s[92:95], s46 offen offset:0 lds
 v_mfma_f32_16x16x32_bf16 v[164:167], v[40:43], v[88:91], v[164:167]
 ds_read_b64_tr_b16 v[48:49], v7 offset:12288
 ds_read_b64_tr_b16 v[50:51], v7 offset:12800
 v_mfma_f32_16x16x32_bf16 v[168:171], v[40:43], v[92:95], v[168:171]
 buffer_load_dwordx4 v33, s[92:95], s46 offen offset:1024 lds
 v_mfma_f32_16x16x32_bf16 v[172:175], v[40:43], v[96:99], v[172:175]
 v_mfma_f32_16x16x32_bf16 v[176:179], v[40:43], v[100:103], v[176:179]
 buffer_load_dwordx4 v34, s[92:95], s46 offen offset:2048 lds
 v_mfma_f32_16x16x32_bf16 v[180:183], v[40:43], v[104:107], v[180:183]
 s_waitcnt lgkmcnt(2)
 v_mfma_f32_16x16x32_bf16 v[208:211], v[44:47], v[84:87], v[208:211]
 buffer_load_dwordx4 v35, s[92:95], s46 offen offset:3072 lds
 v_mfma_f32_16x16x32_bf16 v[212:215], v[44:47], v[88:91], v[212:215]
 ds_read_b64_tr_b16 v[40:41], v9 offset:12288
 ds_read_b64_tr_b16 v[42:43], v9 offset:12800
 v_mfma_f32_16x16x32_bf16 v[216:219], v[44:47], v[92:95], v[216:219]
 s_mov_b32 m0, 102400
 s_add_u32 s46, s44, 262400
 buffer_load_dwordx4 v32, s[92:95], s46 offen offset:0 lds
 v_mfma_f32_16x16x32_bf16 v[220:223], v[44:47], v[96:99], v[220:223]
 v_mfma_f32_16x16x32_bf16 v[224:227], v[44:47], v[100:103], v[224:227]
 buffer_load_dwordx4 v33, s[92:95], s46 offen offset:1024 lds
 v_mfma_f32_16x16x32_bf16 v[228:231], v[44:47], v[104:107], v[228:231]
 s_waitcnt lgkmcnt(2)
 v_mfma_f32_16x16x32_bf16 v[184:187], v[48:51], v[84:87], v[184:187]
 buffer_load_dwordx4 v34, s[92:95], s46 offen offset:2048 lds
 v_mfma_f32_16x16x32_bf16 v[188:191], v[48:51], v[88:91], v[188:191]
 s_waitcnt vmcnt(23)
 ds_read_b64_tr_b16 v[44:45], v6 offset:16384
 ds_read_b64_tr_b16 v[46:47], v6 offset:16896
 v_mfma_f32_16x16x32_bf16 v[192:195], v[48:51], v[92:95], v[192:195]
 buffer_load_dwordx4 v35, s[92:95], s46 offen offset:3072 lds
 v_mfma_f32_16x16x32_bf16 v[196:199], v[48:51], v[96:99], v[196:199]
 v_mfma_f32_16x16x32_bf16 v[200:203], v[48:51], v[100:103], v[200:203]
 v_mfma_f32_16x16x32_bf16 v[204:207], v[48:51], v[104:107], v[204:207]
 s_waitcnt lgkmcnt(2)
 v_mfma_f32_16x16x32_bf16 v[232:235], v[40:43], v[84:87], v[232:235]
 v_mfma_f32_16x16x32_bf16 v[236:239], v[40:43], v[88:91], v[236:239]
 ds_read_b64_tr_b16 v[48:49], v7 offset:16384
 ds_read_b64_tr_b16 v[50:51], v7 offset:16896
 v_mfma_f32_16x16x32_bf16 v[240:243], v[40:43], v[92:95], v[240:243]
 v_mfma_f32_16x16x32_bf16 v[244:247], v[40:43], v[96:99], v[244:247]
 v_mfma_f32_16x16x32_bf16 v[248:251], v[40:43], v[100:103], v[248:251]
 v_mfma_f32_16x16x32_bf16 v[252:255], v[40:43], v[104:107], v[252:255]
 s_waitcnt vmcnt(12)
 s_barrier
 s_waitcnt lgkmcnt(2)
 v_mfma_f32_16x16x32_bf16 v[160:163], v[44:47], v[108:111], v[160:163]
 s_add_u32 s46, s45, s88
 s_mov_b32 m0, 45056
 s_add_u32 s46, s46, 110592
 buffer_load_dwordx4 v36, s[28:31], s46 offen offset:0 lds
 v_mfma_f32_16x16x32_bf16 v[164:167], v[44:47], v[112:115], v[164:167]
 s_waitcnt vmcnt(17)
 ds_read_b64_tr_b16 v[40:41], v6 offset:20480
 ds_read_b64_tr_b16 v[42:43], v6 offset:20992
 v_mfma_f32_16x16x32_bf16 v[168:171], v[44:47], v[116:119], v[168:171]
 buffer_load_dwordx4 v37, s[28:31], s46 offen offset:1024 lds
 v_mfma_f32_16x16x32_bf16 v[172:175], v[44:47], v[120:123], v[172:175]
 v_mfma_f32_16x16x32_bf16 v[176:179], v[44:47], v[124:127], v[176:179]
 buffer_load_dwordx4 v38, s[28:31], s46 offen offset:2048 lds
 v_mfma_f32_16x16x32_bf16 v[180:183], v[44:47], v[128:131], v[180:183]
 s_waitcnt lgkmcnt(2)
 v_mfma_f32_16x16x32_bf16 v[184:187], v[48:51], v[108:111], v[184:187]
 buffer_load_dwordx4 v39, s[28:31], s46 offen offset:3072 lds
 v_mfma_f32_16x16x32_bf16 v[188:191], v[48:51], v[112:115], v[188:191]
 ds_read_b64_tr_b16 v[44:45], v7 offset:20480
 ds_read_b64_tr_b16 v[46:47], v7 offset:20992
 v_mfma_f32_16x16x32_bf16 v[192:195], v[48:51], v[116:119], v[192:195]
 s_mov_b32 m0, 106496
 s_add_u32 s46, s44, 524544
 buffer_load_dwordx4 v32, s[92:95], s46 offen offset:0 lds
 v_mfma_f32_16x16x32_bf16 v[196:199], v[48:51], v[120:123], v[196:199]
 v_mfma_f32_16x16x32_bf16 v[200:203], v[48:51], v[124:127], v[200:203]
 buffer_load_dwordx4 v33, s[92:95], s46 offen offset:1024 lds
 v_mfma_f32_16x16x32_bf16 v[204:207], v[48:51], v[128:131], v[204:207]
 s_waitcnt lgkmcnt(2)
 v_mfma_f32_16x16x32_bf16 v[160:163], v[40:43], v[132:135], v[160:163]
 buffer_load_dwordx4 v34, s[92:95], s46 offen offset:2048 lds
 v_mfma_f32_16x16x32_bf16 v[164:167], v[40:43], v[136:139], v[164:167]
 ds_read_b64_tr_b16 v[48:49], v8 offset:16384
 ds_read_b64_tr_b16 v[50:51], v8 offset:16896
 v_mfma_f32_16x16x32_bf16 v[168:171], v[40:43], v[140:143], v[168:171]
 buffer_load_dwordx4 v35, s[92:95], s46 offen offset:3072 lds
 v_mfma_f32_16x16x32_bf16 v[172:175], v[40:43], v[144:147], v[172:175]
 v_mfma_f32_16x16x32_bf16 v[176:179], v[40:43], v[148:151], v[176:179]
 s_mov_b32 m0, 110592
 s_add_u32 s46, s44, 786688
 buffer_load_dwordx4 v32, s[92:95], s46 offen offset:0 lds
 v_mfma_f32_16x16x32_bf16 v[180:183], v[40:43], v[152:155], v[180:183]
 s_waitcnt lgkmcnt(2)
 v_mfma_f32_16x16x32_bf16 v[184:187], v[44:47], v[132:135], v[184:187]
 buffer_load_dwordx4 v33, s[92:95], s46 offen offset:1024 lds
 v_mfma_f32_16x16x32_bf16 v[188:191], v[44:47], v[136:139], v[188:191]
 ds_read_b64_tr_b16 v[40:41], v9 offset:16384
 ds_read_b64_tr_b16 v[42:43], v9 offset:16896
 v_mfma_f32_16x16x32_bf16 v[192:195], v[44:47], v[140:143], v[192:195]
 buffer_load_dwordx4 v34, s[92:95], s46 offen offset:2048 lds
 v_mfma_f32_16x16x32_bf16 v[196:199], v[44:47], v[144:147], v[196:199]
 v_mfma_f32_16x16x32_bf16 v[200:203], v[44:47], v[148:151], v[200:203]
 buffer_load_dwordx4 v35, s[92:95], s46 offen offset:3072 lds
 v_mfma_f32_16x16x32_bf16 v[204:207], v[44:47], v[152:155], v[204:207]
 s_waitcnt lgkmcnt(2)
 v_mfma_f32_16x16x32_bf16 v[208:211], v[48:51], v[108:111], v[208:211]
 v_mfma_f32_16x16x32_bf16 v[212:215], v[48:51], v[112:115], v[212:215]
 ds_read_b64_tr_b16 v[44:45], v8 offset:20480
 ds_read_b64_tr_b16 v[46:47], v8 offset:20992
 v_mfma_f32_16x16x32_bf16 v[216:219], v[48:51], v[116:119], v[216:219]
 v_mfma_f32_16x16x32_bf16 v[220:223], v[48:51], v[120:123], v[220:223]
 v_mfma_f32_16x16x32_bf16 v[224:227], v[48:51], v[124:127], v[224:227]
 v_mfma_f32_16x16x32_bf16 v[228:231], v[48:51], v[128:131], v[228:231]
 s_waitcnt vmcnt(20)
 s_barrier
 v_mul_f32 v52, s48, v160
 v_mul_f32 v53, s48, v161
 v_mul_f32 v54, s48, v162
 v_mul_f32 v55, s48, v163
 v_cvt_pk_bf16_f32 v56, v52, v53
 s_waitcnt lgkmcnt(2)
 v_mfma_f32_16x16x32_bf16 v[232:235], v[40:43], v[108:111], v[232:235]
 s_add_u32 s46, s15, 16384
 s_and_b32 s46, s46, 0x1ffff
 s_add_u32 s46, s46, s42
 s_mov_b32 m0, 12288
 s_add_u32 s46, s46, 4096
 buffer_load_dwordx4 v28, s[20:23], s46 offen offset:0 nt lds
 v_cvt_pk_bf16_f32 v57, v54, v55
 v_mul_f32 v52, s48, v184
 v_mul_f32 v53, s48, v185
 v_mul_f32 v54, s48, v186
 v_mul_f32 v55, s48, v187
 v_cvt_pk_bf16_f32 v58, v52, v53
 v_mfma_f32_16x16x32_bf16 v[236:239], v[40:43], v[112:115], v[236:239]
 ds_read_b64_tr_b16 v[48:49], v9 offset:20480
 ds_read_b64_tr_b16 v[50:51], v9 offset:20992
 v_cvt_pk_bf16_f32 v59, v54, v55
 s_nop 0
 v_permlane16_swap_b32 v56, v58
 v_permlane16_swap_b32 v57, v59
 ds_write_b128 v22, v[56:59] offset:0
 v_mfma_f32_16x16x32_bf16 v[240:243], v[40:43], v[116:119], v[240:243]
 buffer_load_dwordx4 v29, s[20:23], s46 offen offset:1024 nt lds
 v_mul_f32 v52, s48, v164
 v_mul_f32 v53, s48, v165
 v_mul_f32 v54, s48, v166
 v_mul_f32 v55, s48, v167
 v_cvt_pk_bf16_f32 v60, v52, v53
 v_mfma_f32_16x16x32_bf16 v[244:247], v[40:43], v[120:123], v[244:247]
 v_cvt_pk_bf16_f32 v61, v54, v55
 v_mul_f32 v52, s48, v188
 v_mul_f32 v53, s48, v189
 v_mul_f32 v54, s48, v190
 v_mul_f32 v55, s48, v191
 v_mfma_f32_16x16x32_bf16 v[248:251], v[40:43], v[124:127], v[248:251]
 buffer_load_dwordx4 v30, s[20:23], s46 offen offset:2048 nt lds
 v_cvt_pk_bf16_f32 v62, v52, v53
 v_cvt_pk_bf16_f32 v63, v54, v55
 s_nop 0
 v_permlane16_swap_b32 v60, v62
 v_permlane16_swap_b32 v61, v63
 ds_write_b128 v22, v[60:63] offset:1024
 v_mfma_f32_16x16x32_bf16 v[252:255], v[40:43], v[128:131], v[252:255]
 v_mul_f32 v52, s48, v168
 v_mul_f32 v53, s48, v169
 v_mul_f32 v54, s48, v170
 v_mul_f32 v55, s48, v171
 v_cvt_pk_bf16_f32 v56, v52, v53
 s_waitcnt lgkmcnt(4)
 v_mfma_f32_16x16x32_bf16 v[208:211], v[44:47], v[132:135], v[208:211]
 buffer_load_dwordx4 v31, s[20:23], s46 offen offset:3072 nt lds
 v_cvt_pk_bf16_f32 v57, v54, v55
 v_mul_f32 v52, s48, v192
 v_mul_f32 v53, s48, v193
 v_mul_f32 v54, s48, v194
 v_mul_f32 v55, s48, v195
 v_cvt_pk_bf16_f32 v58, v52, v53
 v_mfma_f32_16x16x32_bf16 v[212:215], v[44:47], v[136:139], v[212:215]
 v_cvt_pk_bf16_f32 v59, v54, v55
 s_nop 0
 v_permlane16_swap_b32 v56, v58
 v_permlane16_swap_b32 v57, v59
 ds_write_b128 v22, v[56:59] offset:4096
 v_mfma_f32_16x16x32_bf16 v[216:219], v[44:47], v[140:143], v[216:219]
 s_mov_b32 m0, 114688
 s_add_u32 s46, s44, 1048832
 buffer_load_dwordx4 v32, s[92:95], s46 offen offset:0 lds
 v_mul_f32 v52, s48, v172
 v_mul_f32 v53, s48, v173
 v_mul_f32 v54, s48, v174
 v_mul_f32 v55, s48, v175
 v_cvt_pk_bf16_f32 v60, v52, v53
 v_mfma_f32_16x16x32_bf16 v[220:223], v[44:47], v[144:147], v[220:223]
 v_cvt_pk_bf16_f32 v61, v54, v55
 v_mul_f32 v52, s48, v196
 v_mul_f32 v53, s48, v197
 v_mul_f32 v54, s48, v198
 v_mul_f32 v55, s48, v199
 v_mfma_f32_16x16x32_bf16 v[224:227], v[44:47], v[148:151], v[224:227]
 buffer_load_dwordx4 v33, s[92:95], s46 offen offset:1024 lds
 v_cvt_pk_bf16_f32 v62, v52, v53
 v_cvt_pk_bf16_f32 v63, v54, v55
 s_nop 0
 v_permlane16_swap_b32 v60, v62
 v_permlane16_swap_b32 v61, v63
 ds_write_b128 v22, v[60:63] offset:5120
 v_mfma_f32_16x16x32_bf16 v[228:231], v[44:47], v[152:155], v[228:231]
 v_mul_f32 v52, s48, v176
 v_mul_f32 v53, s48, v177
 v_mul_f32 v54, s48, v178
 v_mul_f32 v55, s48, v179
 v_cvt_pk_bf16_f32 v56, v52, v53
 s_waitcnt lgkmcnt(4)
 v_mfma_f32_16x16x32_bf16 v[232:235], v[48:51], v[132:135], v[232:235]
 buffer_load_dwordx4 v34, s[92:95], s46 offen offset:2048 lds
 v_cvt_pk_bf16_f32 v57, v54, v55
 v_mul_f32 v52, s48, v200
 v_mul_f32 v53, s48, v201
 v_mul_f32 v54, s48, v202
 v_mul_f32 v55, s48, v203
 v_cvt_pk_bf16_f32 v58, v52, v53
 v_mfma_f32_16x16x32_bf16 v[236:239], v[48:51], v[136:139], v[236:239]
 v_cvt_pk_bf16_f32 v59, v54, v55
 s_nop 0
 v_permlane16_swap_b32 v56, v58
 v_permlane16_swap_b32 v57, v59
 ds_write_b128 v22, v[56:59] offset:8192
 v_mfma_f32_16x16x32_bf16 v[240:243], v[48:51], v[140:143], v[240:243]
 buffer_load_dwordx4 v35, s[92:95], s46 offen offset:3072 lds
 v_mul_f32 v52, s48, v180
 v_mul_f32 v53, s48, v181
 v_mul_f32 v54, s48, v182
 v_mul_f32 v55, s48, v183
 v_cvt_pk_bf16_f32 v60, v52, v53
 v_mfma_f32_16x16x32_bf16 v[244:247], v[48:51], v[144:147], v[244:247]
 s_waitcnt vmcnt(16)
 s_barrier
 v_cvt_pk_bf16_f32 v61, v54, v55
 v_mul_f32 v52, s48, v204
 v_mul_f32 v53, s48, v205
 v_mul_f32 v54, s48, v206
 v_mul_f32 v55, s48, v207
 v_mfma_f32_16x16x32_bf16 v[248:251], v[48:51], v[148:151], v[248:251]
 s_mov_b32 m0, 118784
 s_add_u32 s46, s44, 1310976
 buffer_load_dwordx4 v32, s[92:95], s46 offen offset:0 lds
 v_cvt_pk_bf16_f32 v62, v52, v53
 v_cvt_pk_bf16_f32 v63, v54, v55
 s_nop 0
 v_permlane16_swap_b32 v60, v62
 v_permlane16_swap_b32 v61, v63
 ds_write_b128 v22, v[60:63] offset:9216
 v_mfma_f32_16x16x32_bf16 v[252:255], v[48:51], v[152:155], v[252:255]
 buffer_load_dwordx4 v33, s[92:95], s46 offen offset:1024 lds
 buffer_load_dwordx4 v34, s[92:95], s46 offen offset:2048 lds
 buffer_load_dwordx4 v35, s[92:95], s46 offen offset:3072 lds
 s_add_u32 s46, s15, 24576
 s_and_b32 s46, s46, 0x1ffff
 s_add_u32 s46, s46, s42
 s_mov_b32 m0, 28672
 s_add_u32 s46, s46, 4096
 buffer_load_dwordx4 v28, s[20:23], s46 offen offset:0 nt lds
 buffer_load_dwordx4 v29, s[20:23], s46 offen offset:1024 nt lds
 buffer_load_dwordx4 v30, s[20:23], s46 offen offset:2048 nt lds
 buffer_load_dwordx4 v31, s[20:23], s46 offen offset:3072 nt lds
 v_mul_f32 v52, s48, v208
 v_mul_f32 v53, s48, v209
 v_mul_f32 v54, s48, v210
 v_mul_f32 v55, s48, v211
 v_cvt_pk_bf16_f32 v56, v52, v53
 v_cvt_pk_bf16_f32 v57, v54, v55
 v_mul_f32 v52, s48, v232
 v_mul_f32 v53, s48, v233
 v_mul_f32 v54, s48, v234
 v_mul_f32 v55, s48, v235
 v_cvt_pk_bf16_f32 v58, v52, v53
 v_cvt_pk_bf16_f32 v59, v54, v55
 s_nop 0
 v_permlane16_swap_b32 v56, v58
 v_permlane16_swap_b32 v57, v59
 ds_write_b128 v22, v[56:59] offset:2048
 v_mul_f32 v52, s48, v212
 v_mul_f32 v53, s48, v213
 v_mul_f32 v54, s48, v214
 v_mul_f32 v55, s48, v215
 v_cvt_pk_bf16_f32 v60, v52, v53
 v_cvt_pk_bf16_f32 v61, v54, v55
 v_mul_f32 v52, s48, v236
 v_mul_f32 v53, s48, v237
 v_mul_f32 v54, s48, v238
 v_mul_f32 v55, s48, v239
 v_cvt_pk_bf16_f32 v62, v52, v53
 v_cvt_pk_bf16_f32 v63, v54, v55
 s_nop 0
 v_permlane16_swap_b32 v60, v62
 v_permlane16_swap_b32 v61, v63
 ds_write_b128 v22, v[60:63] offset:3072
 v_mul_f32 v52, s48, v216
 v_mul_f32 v53, s48, v217
 v_mul_f32 v54, s48, v218
 v_mul_f32 v55, s48, v219
 v_cvt_pk_bf16_f32 v56, v52, v53
 v_cvt_pk_bf16_f32 v57, v54, v55
 v_mul_f32 v52, s48, v240
 v_mul_f32 v53, s48, v241
 v_mul_f32 v54, s48, v242
 v_mul_f32 v55, s48, v243
 v_cvt_pk_bf16_f32 v58, v52, v53
 v_cvt_pk_bf16_f32 v59, v54, v55
 s_nop 0
 v_permlane16_swap_b32 v56, v58
 v_permlane16_swap_b32 v57, v59
 ds_write_b128 v22, v[56:59] offset:6144
 v_mul_f32 v52, s48, v220
 v_mul_f32 v53, s48, v221
 v_mul_f32 v54, s48, v222
 v_mul_f32 v55, s48, v223
 v_cvt_pk_bf16_f32 v60, v52, v53
 v_cvt_pk_bf16_f32 v61, v54, v55
 v_mul_f32 v52, s48, v244
 v_mul_f32 v53, s48, v245
 v_mul_f32 v54, s48, v246
 v_mul_f32 v55, s48, v247
 v_cvt_pk_bf16_f32 v62, v52, v53
 v_cvt_pk_bf16_f32 v63, v54, v55
 s_nop 0
 v_permlane16_swap_b32 v60, v62
 v_permlane16_swap_b32 v61, v63
 ds_write_b128 v22, v[60:63] offset:7168
 v_mul_f32 v52, s48, v224
 v_mul_f32 v53, s48, v225
 v_mul_f32 v54, s48, v226
 v_mul_f32 v55, s48, v227
 v_cvt_pk_bf16_f32 v56, v52, v53
 v_cvt_pk_bf16_f32 v57, v54, v55
 v_mul_f32 v52, s48, v248
 v_mul_f32 v53, s48, v249
 v_mul_f32 v54, s48, v250
 v_mul_f32 v55, s48, v251
 v_cvt_pk_bf16_f32 v58, v52, v53
 v_cvt_pk_bf16_f32 v59, v54, v55
 s_nop 0
 v_permlane16_swap_b32 v56, v58
 v_permlane16_swap_b32 v57, v59
 ds_write_b128 v22, v[56:59] offset:10240
 v_mul_f32 v52, s48, v228
 v_mul_f32 v53, s48, v229
 v_mul_f32 v54, s48, v230
 v_mul_f32 v55, s48, v231
 v_cvt_pk_bf16_f32 v60, v52, v53
 v_cvt_pk_bf16_f32 v61, v54, v55
 v_mul_f32 v52, s48, v252
 v_mul_f32 v53, s48, v253
 v_mul_f32 v54, s48, v254
 v_mul_f32 v55, s48, v255
 v_cvt_pk_bf16_f32 v62, v52, v53
 v_cvt_pk_bf16_f32 v63, v54, v55
 s_nop 0
 v_permlane16_swap_b32 v60, v62
 v_permlane16_swap_b32 v61, v63
 ds_write_b128 v22, v[60:63] offset:11264
 s_waitcnt lgkmcnt(0)
 s_add_u32 s45, s45, 147456
 s_add_u32 s47, s47, 1
 s_cmp_lt_u32 s47, 3
 s_cbranch_scc1 L_w3loop
 s_waitcnt vmcnt(40)
 s_barrier
 s_add_u32 s46, s15, 32768
 s_and_b32 s46, s46, 0x1ffff
 s_add_u32 s46, s46, s42
 s_mov_b32 m0, 45056
 s_add_u32 s46, s46, 4096
 buffer_load_dwordx4 v28, s[20:23], s46 offen offset:0 nt lds
 buffer_load_dwordx4 v29, s[20:23], s46 offen offset:1024 nt lds
 buffer_load_dwordx4 v30, s[20:23], s46 offen offset:2048 nt lds
 buffer_load_dwordx4 v31, s[20:23], s46 offen offset:3072 nt lds
 s_waitcnt vmcnt(40)
 s_barrier
 s_add_u32 s46, s15, 40960
 s_and_b32 s46, s46, 0x1ffff
 s_add_u32 s46, s46, s42
 s_mov_b32 m0, 61440
 s_add_u32 s46, s46, 4096
 buffer_load_dwordx4 v28, s[20:23], s46 offen offset:0 nt lds
 buffer_load_dwordx4 v29, s[20:23], s46 offen offset:1024 nt lds
 buffer_load_dwordx4 v30, s[20:23], s46 offen offset:2048 nt lds
 buffer_load_dwordx4 v31, s[20:23], s46 offen offset:3072 nt lds
 s_add_u32 s46, s45, 0
 buffer_load_dword v15, v13, s[28:31], s46 offen
 s_add_u32 s46, s45, 4608
 buffer_load_dword v15, v13, s[28:31], s46 offen
 s_waitcnt vmcnt(42)
 s_barrier
 s_add_u32 s46, s15, 81920
 s_and_b32 s46, s46, 0x1ffff
 s_add_u32 s46, s46, s42
 s_mov_b32 m0, 77824
 s_add_u32 s46, s46, 4096
 buffer_load_dwordx4 v28, s[20:23], s46 offen offset:0 nt lds
 buffer_load_dwordx4 v29, s[20:23], s46 offen offset:1024 nt lds
 buffer_load_dwordx4 v30, s[20:23], s46 offen offset:2048 nt lds
 buffer_load_dwordx4 v31, s[20:23], s46 offen offset:3072 nt lds
 s_lshl_b32 s56, s53, 2
 v_mov_b32 v16, s56
 buffer_load_dword v17, v16, s[68:71], 0 offen offset:0 sc1
 s_waitcnt vmcnt(27)
 s_barrier
 s_add_u32 s46, s15, 90112
 s_and_b32 s46, s46, 0x1ffff
 s_add_u32 s46, s46, s42
 s_mov_b32 m0, 94208
 s_add_u32 s46, s46, 4096
 buffer_load_dwordx4 v28, s[20:23], s46 offen offset:0 nt lds
 buffer_load_dwordx4 v29, s[20:23], s46 offen offset:1024 nt lds
 buffer_load_dwordx4 v30, s[20:23], s46 offen offset:2048 nt lds
 buffer_load_dwordx4 v31, s[20:23], s46 offen offset:3072 nt lds
 s_waitcnt vmcnt(19)
 s_barrier
 s_add_u32 s46, s15, 49152
 s_and_b32 s46, s46, 0x1ffff
 s_add_u32 s46, s46, s42
 s_mov_b32 m0, 12288
 s_add_u32 s46, s46, 4096
 buffer_load_dwordx4 v28, s[20:23], s46 offen offset:0 nt lds
 buffer_load_dwordx4 v29, s[20:23], s46 offen offset:1024 nt lds
 buffer_load_dwordx4 v30, s[20:23], s46 offen offset:2048 nt lds
 buffer_load_dwordx4 v31, s[20:23], s46 offen offset:3072 nt lds
 s_waitcnt vmcnt(19)
 s_barrier
 s_add_u32 s46, s15, 57344
 s_and_b32 s46, s46, 0x1ffff
 s_add_u32 s46, s46, s42
 s_mov_b32 m0, 28672
 s_add_u32 s46, s46, 4096
 buffer_load_dwordx4 v28, s[20:23], s46 offen offset:0 nt lds
 buffer_load_dwordx4 v29, s[20:23], s46 offen offset:1024 nt lds
 buffer_load_dwordx4 v30, s[20:23], s46 offen offset:2048 nt lds
 buffer_load_dwordx4 v31, s[20:23], s46 offen offset:3072 nt lds
 s_waitcnt vmcnt(19)
 s_barrier
 s_add_u32 s46, s15, 65536
 s_and_b32 s46, s46, 0x1ffff
 s_add_u32 s46, s46, s42
 s_mov_b32 m0, 45056
 s_add_u32 s46, s46, 4096
 buffer_load_dwordx4 v28, s[20:23], s46 offen offset:0 nt lds
 buffer_load_dwordx4 v29, s[20:23], s46 offen offset:1024 nt lds
 buffer_load_dwordx4 v30, s[20:23], s46 offen offset:2048 nt lds
 buffer_load_dwordx4 v31, s[20:23], s46 offen offset:3072 nt lds
 s_waitcnt vmcnt(8)
 s_barrier
 s_add_u32 s46, s15, 73728
 s_and_b32 s46, s46, 0x1ffff
 s_add_u32 s46, s46, s42
 s_mov_b32 m0, 61440
 s_add_u32 s46, s46, 4096
 buffer_load_dwordx4 v28, s[20:23], s46 offen offset:0 nt lds
 buffer_load_dwordx4 v29, s[20:23], s46 offen offset:1024 nt lds
 buffer_load_dwordx4 v30, s[20:23], s46 offen offset:2048 nt lds
 buffer_load_dwordx4 v31, s[20:23], s46 offen offset:3072 nt lds
 s_waitcnt vmcnt(8)
 s_barrier
 s_add_u32 s46, s15, 98304
 s_and_b32 s46, s46, 0x1ffff
 s_add_u32 s46, s46, s42
 s_mov_b32 m0, 12288
 s_add_u32 s46, s46, 4096
 buffer_load_dwordx4 v28, s[20:23], s46 offen offset:0 nt lds
 buffer_load_dwordx4 v29, s[20:23], s46 offen offset:1024 nt lds
 buffer_load_dwordx4 v30, s[20:23], s46 offen offset:2048 nt lds
 buffer_load_dwordx4 v31, s[20:23], s46 offen offset:3072 nt lds
 s_waitcnt vmcnt(8)
 s_barrier
 s_add_u32 s46, s15, 106496
 s_and_b32 s46, s46, 0x1ffff
 s_add_u32 s46, s46, s42
 s_mov_b32 m0, 28672
 s_add_u32 s46, s46, 4096
 buffer_load_dwordx4 v28, s[20:23], s46 offen offset:0 nt lds
 buffer_load_dwordx4 v29, s[20:23], s46 offen offset:1024 nt lds
 buffer_load_dwordx4 v30, s[20:23], s46 offen offset:2048 nt lds
 buffer_load_dwordx4 v31, s[20:23], s46 offen offset:3072 nt lds
 s_waitcnt vmcnt(8)
 s_barrier
 s_add_u32 s46, s15, 122880
 s_and_b32 s46, s46, 0x1ffff
 s_add_u32 s46, s46, s42
 s_mov_b32 m0, 45056
 s_add_u32 s46, s46, 4096
 buffer_load_dwordx4 v28, s[20:23], s46 offen offset:0 nt lds
 buffer_load_dwordx4 v29, s[20:23], s46 offen offset:1024 nt lds
 buffer_load_dwordx4 v30, s[20:23], s46 offen offset:2048 nt lds
 buffer_load_dwordx4 v31, s[20:23], s46 offen offset:3072 nt lds
 s_waitcnt vmcnt(33)
 s_barrier
 s_waitcnt vmcnt(28)
 s_barrier
 s_waitcnt vmcnt(8)
 s_barrier
 s_waitcnt vmcnt(4)
 s_barrier
 s_add_u32 s46, s45, s80
 s_mov_b32 m0, 12288
 s_add_u32 s46, s46, 110592
 buffer_load_dwordx4 v36, s[28:31], s46 offen offset:0 lds
 buffer_load_dwordx4 v37, s[28:31], s46 offen offset:1024 lds
 buffer_load_dwordx4 v38, s[28:31], s46 offen offset:2048 lds
 buffer_load_dwordx4 v39, s[28:31], s46 offen offset:3072 lds
 s_add_u32 s42, s42, 0x20000
 s_waitcnt vmcnt(4)
 s_barrier
 s_add_u32 s46, s45, s81
 s_mov_b32 m0, 28672
 s_add_u32 s46, s46, 110592
 buffer_load_dwordx4 v36, s[28:31], s46 offen offset:0 lds
 buffer_load_dwordx4 v37, s[28:31], s46 offen offset:1024 lds
 buffer_load_dwordx4 v38, s[28:31], s46 offen offset:2048 lds
 buffer_load_dwordx4 v39, s[28:31], s46 offen offset:3072 lds
 s_waitcnt vmcnt(4)
 v_readfirstlane_b32 s57, v17
 s_mov_b32 s58, 0
L_chk:
 s_nop 2
 s_cmp_ge_u32 s57, 8
 s_cbranch_scc1 L_chkend
 buffer_load_dword v17, v16, s[68:71], 0 offen offset:0 sc1
 s_add_u32 s58, s58, 1
 s_waitcnt vmcnt(0)
 v_readfirstlane_b32 s57, v17
 s_cmp_lt_u32 s58, 0x80000
 s_cbranch_scc1 L_chk
L_chkend:
 s_barrier
 s_add_u32 s46, s45, s82
 s_mov_b32 m0, 45056
 s_add_u32 s46, s46, 110592
 buffer_load_dwordx4 v36, s[28:31], s46 offen offset:0 lds
 buffer_load_dwordx4 v37, s[28:31], s46 offen offset:1024 lds
 buffer_load_dwordx4 v38, s[28:31], s46 offen offset:2048 lds
 buffer_load_dwordx4 v39, s[28:31], s46 offen offset:3072 lds
 s_waitcnt vmcnt(4)
 s_barrier
 s_add_u32 s46, s45, s83
 s_mov_b32 m0, 12288
 s_add_u32 s46, s46, 110592
 buffer_load_dwordx4 v36, s[28:31], s46 offen offset:0 lds
 buffer_load_dwordx4 v37, s[28:31], s46 offen offset:1024 lds
 buffer_load_dwordx4 v38, s[28:31], s46 offen offset:2048 lds
 buffer_load_dwordx4 v39, s[28:31], s46 offen offset:3072 lds
 s_waitcnt vmcnt(4)
 s_barrier
 s_add_u32 s46, s45, s84
 s_mov_b32 m0, 28672
 s_add_u32 s46, s46, 110592
 buffer_load_dwordx4 v36, s[28:31], s46 offen offset:0 lds
 buffer_load_dwordx4 v37, s[28:31], s46 offen offset:1024 lds
 buffer_load_dwordx4 v38, s[28:31], s46 offen offset:2048 lds
 buffer_load_dwordx4 v39, s[28:31], s46 offen offset:3072 lds
 s_waitcnt vmcnt(4)
 s_barrier
 s_add_u32 s46, s45, s85
 s_mov_b32 m0, 45056
 s_add_u32 s46, s46, 110592
 buffer_load_dwordx4 v36, s[28:31], s46 offen offset:0 lds
 buffer_load_dwordx4 v37, s[28:31], s46 offen offset:1024 lds
 buffer_load_dwordx4 v38, s[28:31], s46 offen offset:2048 lds
 buffer_load_dwordx4 v39, s[28:31], s46 offen offset:3072 lds
 s_waitcnt vmcnt(4)
 s_barrier
 s_add_u32 s46, s45, s86
 s_mov_b32 m0, 12288
 s_add_u32 s46, s46, 110592
 buffer_load_dwordx4 v36, s[28:31], s46 offen offset:0 lds
 buffer_load_dwordx4 v37, s[28:31], s46 offen offset:1024 lds
 buffer_load_dwordx4 v38, s[28:31], s46 offen offset:2048 lds
 buffer_load_dwordx4 v39, s[28:31], s46 offen offset:3072 lds
 s_waitcnt vmcnt(4)
 s_barrier
 s_add_u32 s46, s45, s87
 s_mov_b32 m0, 28672
 s_add_u32 s46, s46, 110592
 buffer_load_dwordx4 v36, s[28:31], s46 offen offset:0 lds
 buffer_load_dwordx4 v37, s[28:31], s46 offen offset:1024 lds
 buffer_load_dwordx4 v38, s[28:31], s46 offen offset:2048 lds
 buffer_load_dwordx4 v39, s[28:31], s46 offen offset:3072 lds
 s_waitcnt vmcnt(4)
 s_barrier
 s_add_u32 s46, s45, s88
 s_mov_b32 m0, 45056
 s_add_u32 s46, s46, 110592
 buffer_load_dwordx4 v36, s[28:31], s46 offen offset:0 lds
 buffer_load_dwordx4 v37, s[28:31], s46 offen offset:1024 lds
 buffer_load_dwordx4 v38, s[28:31], s46 offen offset:2048 lds
 buffer_load_dwordx4 v39, s[28:31], s46 offen offset:3072 lds
 s_waitcnt vmcnt(4)
 s_barrier
 s_waitcnt vmcnt(0)
 s_barrier
 s_cmp_ge_u32 s59, 3
 s_cbranch_scc1 L_done
 s_mov_b32 s61, 8
 v_and_b32 v10, 7, v0
 v_lshlrev_b32 v1, 2, v10
 v_lshlrev_b32 v6, 4, v0
 buffer_load_dword v2, v1, s[36:39], s89 offen sc1
 s_mul_i32 s56, s53, 884736
 s_mul_i32 s57, s61, 3
 s_add_u32 s57, s57, s59
 s_lshl_b32 s57, s57, 15
 s_add_u32 s56, s56, s57
 s_mul_i32 s60, s4, 96
 s_lshl_b32 s58, s59, 5
 s_add_u32 s60, s60, s58
 s_mul_i32 s60, s60, 2304
 s_lshl_b32 s58, s61, 7
 s_add_u32 s60, s60, s58
 s_and_b32 s58, s2, 4
 s_mul_i32 s58, s58, 288
 s_add_u32 s60, s60, s58
 v_and_b32 v7, 15, v0
 v_mul_u32_u24 v7, 2304, v7
 v_lshrrev_b32 v3, 5, v0
 v_lshl_add_u32 v7, v3, 4, v7
 v_bfe_u32 v3, v0, 4, 1
 v_lshl_add_u32 v7, v3, 5, v7
 v_sub_u32 v10, s61, v10
 v_add_u32 v3, 9, v10
 v_cmp_gt_i32 vcc, 1, v10
 s_nop 1
 v_cndmask_b32 v10, v10, v3, vcc
 s_mov_b32 s62, 510
 s_mov_b32 s58, 0
 s_mov_b32 s64, 8
 v_mov_b32 v192, 0
 v_mov_b32 v193, 0
 v_mov_b32 v194, 0
 v_mov_b32 v195, 0
 v_mov_b32 v196, 0
 v_mov_b32 v197, 0
 v_mov_b32 v198, 0
 v_mov_b32 v199, 0
 v_mov_b32 v200, 0
 v_mov_b32 v201, 0
 v_mov_b32 v202, 0
 v_mov_b32 v203, 0
 v_mov_b32 v204, 0
 v_mov_b32 v205, 0
 v_mov_b32 v206, 0
 v_mov_b32 v207, 0
 v_mov_b32 v208, 0
 v_mov_b32 v209, 0
 v_mov_b32 v210, 0
 v_mov_b32 v211, 0
 v_mov_b32 v212, 0
 v_mov_b32 v213, 0
 v_mov_b32 v214, 0
 v_mov_b32 v215, 0
 v_mov_b32 v216, 0
 v_mov_b32 v217, 0
 v_mov_b32 v218, 0
 v_mov_b32 v219, 0
 v_mov_b32 v220, 0
 v_mov_b32 v221, 0
 v_mov_b32 v222, 0
 v_mov_b32 v223, 0
 v_and_b32 v4, 15, v0
 v_lshrrev_b32 v5, 4, v0
 v_lshlrev_b32 v5, 2, v5
 v_sub_u32 v4, v4, v5
 v_mov_b32 v8, 0x3f80
 v_mov_b32 v9, 0x3f800000
 v_cmp_eq_u32 vcc, 0, v4
 v_cmp_eq_u32 s[66:67], 1, v4
 v_mov_b32 v5, 0
 v_cndmask_b32 v5, v5, v8, vcc
 v_cndmask_b32 v24, v5, v9, s[66:67]
 v_cmp_eq_u32 vcc, 2, v4
 v_cmp_eq_u32 s[66:67], 3, v4
 v_mov_b32 v5, 0
 v_cndmask_b32 v5, v5, v8, vcc
 v_cndmask_b32 v25, v5, v9, s[66:67]
 v_mov_b32 v26, 0
 v_mov_b32 v27, 0
 v_mov_b32 v28, v24
 v_mov_b32 v29, v25
L_pollw3:
 s_waitcnt vmcnt(0)
L_chkw3:
 v_sub_u32 v3, v2, v23
 v_cmp_ge_u32 vcc, v3, v10
 s_nop 3
 s_and_b32 s63, vcc_lo, 0xffff
 s_lshr_b32 s63, s63, s59
 s_and_b32 s63, s63, s62
 s_cbranch_scc1 L_somew3
 s_add_u32 s58, s58, 1
 s_cmp_gt_u32 s58, 0x100000
 s_cbranch_scc1 L_outw3
 s_sleep 8
 buffer_load_dword v2, v1, s[36:39], s89 offen sc1
 s_branch L_pollw3
L_somew3:
 s_bitcmp1_b32 s63, 8
 s_cbranch_scc0 L_nlw38
 s_add_u32 s57, s59, 8
 s_and_b32 s57, s57, 7
 s_lshl_b32 s57, s57, 12
 s_add_u32 s57, s57, s56
 buffer_load_dwordx4 v[144:147], v6, s[36:39], s57 offen offset:0 sc1
 buffer_load_dwordx4 v[148:151], v6, s[36:39], s57 offen offset:1024 sc1
 buffer_load_dwordx4 v[152:155], v6, s[36:39], s57 offen offset:2048 sc1
 buffer_load_dwordx4 v[156:159], v6, s[36:39], s57 offen offset:3072 sc1
L_nlw38:
 s_bitcmp1_b32 s63, 7
 s_cbranch_scc0 L_nlw37
 s_add_u32 s57, s59, 7
 s_and_b32 s57, s57, 7
 s_lshl_b32 s57, s57, 12
 s_add_u32 s57, s57, s56
 buffer_load_dwordx4 v[128:131], v6, s[36:39], s57 offen offset:0 sc1
 buffer_load_dwordx4 v[132:135], v6, s[36:39], s57 offen offset:1024 sc1
 buffer_load_dwordx4 v[136:139], v6, s[36:39], s57 offen offset:2048 sc1
 buffer_load_dwordx4 v[140:143], v6, s[36:39], s57 offen offset:3072 sc1
L_nlw37:
 s_bitcmp1_b32 s63, 6
 s_cbranch_scc0 L_nlw36
 s_add_u32 s57, s59, 6
 s_and_b32 s57, s57, 7
 s_lshl_b32 s57, s57, 12
 s_add_u32 s57, s57, s56
 buffer_load_dwordx4 v[112:115], v6, s[36:39], s57 offen offset:0 sc1
 buffer_load_dwordx4 v[116:119], v6, s[36:39], s57 offen offset:1024 sc1
 buffer_load_dwordx4 v[120:123], v6, s[36:39], s57 offen offset:2048 sc1
 buffer_load_dwordx4 v[124:127], v6, s[36:39], s57 offen offset:3072 sc1
L_nlw36:
 s_bitcmp1_b32 s63, 5
 s_cbranch_scc0 L_nlw35
 s_add_u32 s57, s59, 5
 s_and_b32 s57, s57, 7
 s_lshl_b32 s57, s57, 12
 s_add_u32 s57, s57, s56
 buffer_load_dwordx4 v[96:99], v6, s[36:39], s57 offen offset:0 sc1
 buffer_load_dwordx4 v[100:103], v6, s[36:39], s57 offen offset:1024 sc1
 buffer_load_dwordx4 v[104:107], v6, s[36:39], s57 offen offset:2048 sc1
 buffer_load_dwordx4 v[108:111], v6, s[36:39], s57 offen offset:3072 sc1
L_nlw35:
 s_bitcmp1_b32 s63, 4
 s_cbranch_scc0 L_nlw34
 s_add_u32 s57, s59, 4
 s_and_b32 s57, s57, 7
 s_lshl_b32 s57, s57, 12
 s_add_u32 s57, s57, s56
 buffer_load_dwordx4 v[80:83], v6, s[36:39], s57 offen offset:0 sc1
 buffer_load_dwordx4 v[84:87], v6, s[36:39], s57 offen offset:1024 sc1
 buffer_load_dwordx4 v[88:91], v6, s[36:39], s57 offen offset:2048 sc1
 buffer_load_dwordx4 v[92:95], v6, s[36:39], s57 offen offset:3072 sc1
L_nlw34:
 s_bitcmp1_b32 s63, 3
 s_cbranch_scc0 L_nlw33
 s_add_u32 s57, s59, 3
 s_and_b32 s57, s57, 7
 s_lshl_b32 s57, s57, 12
 s_add_u32 s57, s57, s56
 buffer_load_dwordx4 v[64:67], v6, s[36:39], s57 offen offset:0 sc1
 buffer_load_dwordx4 v[68:71], v6, s[36:39], s57 offen offset:1024 sc1
 buffer_load_dwordx4 v[72:75], v6, s[36:39], s57 offen offset:2048 sc1
 buffer_load_dwordx4 v[76:79], v6, s[36:39], s57 offen offset:3072 sc1
L_nlw33:
 s_bitcmp1_b32 s63, 2
 s_cbranch_scc0 L_nlw32
 s_add_u32 s57, s59, 2
 s_and_b32 s57, s57, 7
 s_lshl_b32 s57, s57, 12
 s_add_u32 s57, s57, s56
 buffer_load_dwordx4 v[48:51], v6, s[36:39], s57 offen offset:0 sc1
 buffer_load_dwordx4 v[52:55], v6, s[36:39], s57 offen offset:1024 sc1
 buffer_load_dwordx4 v[56:59], v6, s[36:39], s57 offen offset:2048 sc1
 buffer_load_dwordx4 v[60:63], v6, s[36:39], s57 offen offset:3072 sc1
L_nlw32:
 s_bitcmp1_b32 s63, 1
 s_cbranch_scc0 L_nlw31
 s_add_u32 s57, s59, 1
 s_and_b32 s57, s57, 7
 s_lshl_b32 s57, s57, 12
 s_add_u32 s57, s57, s56
 buffer_load_dwordx4 v[32:35], v6, s[36:39], s57 offen offset:0 sc1
 buffer_load_dwordx4 v[36:39], v6, s[36:39], s57 offen offset:1024 sc1
 buffer_load_dwordx4 v[40:43], v6, s[36:39], s57 offen offset:2048 sc1
 buffer_load_dwordx4 v[44:47], v6, s[36:39], s57 offen offset:3072 sc1
L_nlw31:
 buffer_load_dword v2, v1, s[36:39], s89 offen sc1
 s_andn2_b32 s62, s62, s63
 s_waitcnt vmcnt(1)
 s_cmp_lg_u32 s64, 8
 s_cbranch_scc1 L_naw38
 s_bitcmp1_b32 s62, 8
 s_cbranch_scc1 L_pollw3
 v_mfma_f32_16x16x32_bf16 v[192:195], v[24:27], v[144:147], v[192:195]
 v_mfma_f32_16x16x32_bf16 v[196:199], v[24:27], v[148:151], v[196:199]
 v_mfma_f32_16x16x32_bf16 v[208:211], v[24:27], v[152:155], v[208:211]
 v_mfma_f32_16x16x32_bf16 v[212:215], v[24:27], v[156:159], v[212:215]
 v_mfma_f32_16x16x32_bf16 v[200:203], v[26:29], v[144:147], v[200:203]
 v_mfma_f32_16x16x32_bf16 v[204:207], v[26:29], v[148:151], v[204:207]
 v_mfma_f32_16x16x32_bf16 v[216:219], v[26:29], v[152:155], v[216:219]
 v_mfma_f32_16x16x32_bf16 v[220:223], v[26:29], v[156:159], v[220:223]
 s_mov_b32 s64, 7
L_naw38:
 s_cmp_lg_u32 s64, 7
 s_cbranch_scc1 L_naw37
 s_bitcmp1_b32 s62, 7
 s_cbranch_scc1 L_pollw3
 v_mfma_f32_16x16x32_bf16 v[192:195], v[24:27], v[128:131], v[192:195]
 v_mfma_f32_16x16x32_bf16 v[196:199], v[24:27], v[132:135], v[196:199]
 v_mfma_f32_16x16x32_bf16 v[208:211], v[24:27], v[136:139], v[208:211]
 v_mfma_f32_16x16x32_bf16 v[212:215], v[24:27], v[140:143], v[212:215]
 v_mfma_f32_16x16x32_bf16 v[200:203], v[26:29], v[128:131], v[200:203]
 v_mfma_f32_16x16x32_bf16 v[204:207], v[26:29], v[132:135], v[204:207]
 v_mfma_f32_16x16x32_bf16 v[216:219], v[26:29], v[136:139], v[216:219]
 v_mfma_f32_16x16x32_bf16 v[220:223], v[26:29], v[140:143], v[220:223]
 s_mov_b32 s64, 6
L_naw37:
 s_cmp_lg_u32 s64, 6
 s_cbranch_scc1 L_naw36
 s_bitcmp1_b32 s62, 6
 s_cbranch_scc1 L_pollw3
 v_mfma_f32_16x16x32_bf16 v[192:195], v[24:27], v[112:115], v[192:195]
 v_mfma_f32_16x16x32_bf16 v[196:199], v[24:27], v[116:119], v[196:199]
 v_mfma_f32_16x16x32_bf16 v[208:211], v[24:27], v[120:123], v[208:211]
 v_mfma_f32_16x16x32_bf16 v[212:215], v[24:27], v[124:127], v[212:215]
 v_mfma_f32_16x16x32_bf16 v[200:203], v[26:29], v[112:115], v[200:203]
 v_mfma_f32_16x16x32_bf16 v[204:207], v[26:29], v[116:119], v[204:207]
 v_mfma_f32_16x16x32_bf16 v[216:219], v[26:29], v[120:123], v[216:219]
 v_mfma_f32_16x16x32_bf16 v[220:223], v[26:29], v[124:127], v[220:223]
 s_mov_b32 s64, 5
L_naw36:
 s_cmp_lg_u32 s64, 5
 s_cbranch_scc1 L_naw35
 s_bitcmp1_b32 s62, 5
 s_cbranch_scc1 L_pollw3
 v_mfma_f32_16x16x32_bf16 v[192:195], v[24:27], v[96:99], v[192:195]
 v_mfma_f32_16x16x32_bf16 v[196:199], v[24:27], v[100:103], v[196:199]
 v_mfma_f32_16x16x32_bf16 v[208:211], v[24:27], v[104:107], v[208:211]
 v_mfma_f32_16x16x32_bf16 v[212:215], v[24:27], v[108:111], v[212:215]
 v_mfma_f32_16x16x32_bf16 v[200:203], v[26:29], v[96:99], v[200:203]
 v_mfma_f32_16x16x32_bf16 v[204:207], v[26:29], v[100:103], v[204:207]
 v_mfma_f32_16x16x32_bf16 v[216:219], v[26:29], v[104:107], v[216:219]
 v_mfma_f32_16x16x32_bf16 v[220:223], v[26:29], v[108:111], v[220:223]
 s_mov_b32 s64, 4
L_naw35:
 s_cmp_lg_u32 s64, 4
 s_cbranch_scc1 L_naw34
 s_bitcmp1_b32 s62, 4
 s_cbranch_scc1 L_pollw3
 v_mfma_f32_16x16x32_bf16 v[192:195], v[24:27], v[80:83], v[192:195]
 v_mfma_f32_16x16x32_bf16 v[196:199], v[24:27], v[84:87], v[196:199]
 v_mfma_f32_16x16x32_bf16 v[208:211], v[24:27], v[88:91], v[208:211]
 v_mfma_f32_16x16x32_bf16 v[212:215], v[24:27], v[92:95], v[212:215]
 v_mfma_f32_16x16x32_bf16 v[200:203], v[26:29], v[80:83], v[200:203]
 v_mfma_f32_16x16x32_bf16 v[204:207], v[26:29], v[84:87], v[204:207]
 v_mfma_f32_16x16x32_bf16 v[216:219], v[26:29], v[88:91], v[216:219]
 v_mfma_f32_16x16x32_bf16 v[220:223], v[26:29], v[92:95], v[220:223]
 s_mov_b32 s64, 3
L_naw34:
 s_cmp_lg_u32 s64, 3
 s_cbranch_scc1 L_naw33
 s_bitcmp1_b32 s62, 3
 s_cbranch_scc1 L_pollw3
 v_mfma_f32_16x16x32_bf16 v[192:195], v[24:27], v[64:67], v[192:195]
 v_mfma_f32_16x16x32_bf16 v[196:199], v[24:27], v[68:71], v[196:199]
 v_mfma_f32_16x16x32_bf16 v[208:211], v[24:27], v[72:75], v[208:211]
 v_mfma_f32_16x16x32_bf16 v[212:215], v[24:27], v[76:79], v[212:215]
 v_mfma_f32_16x16x32_bf16 v[200:203], v[26:29], v[64:67], v[200:203]
 v_mfma_f32_16x16x32_bf16 v[204:207], v[26:29], v[68:71], v[204:207]
 v_mfma_f32_16x16x32_bf16 v[216:219], v[26:29], v[72:75], v[216:219]
 v_mfma_f32_16x16x32_bf16 v[220:223], v[26:29], v[76:79], v[220:223]
 s_mov_b32 s64, 2
L_naw33:
 s_cmp_lg_u32 s64, 2
 s_cbranch_scc1 L_naw32
 s_bitcmp1_b32 s62, 2
 s_cbranch_scc1 L_pollw3
 v_mfma_f32_16x16x32_bf16 v[192:195], v[24:27], v[48:51], v[192:195]
 v_mfma_f32_16x16x32_bf16 v[196:199], v[24:27], v[52:55], v[196:199]
 v_mfma_f32_16x16x32_bf16 v[208:211], v[24:27], v[56:59], v[208:211]
 v_mfma_f32_16x16x32_bf16 v[212:215], v[24:27], v[60:63], v[212:215]
 v_mfma_f32_16x16x32_bf16 v[200:203], v[26:29], v[48:51], v[200:203]
 v_mfma_f32_16x16x32_bf16 v[204:207], v[26:29], v[52:55], v[204:207]
 v_mfma_f32_16x16x32_bf16 v[216:219], v[26:29], v[56:59], v[216:219]
 v_mfma_f32_16x16x32_bf16 v[220:223], v[26:29], v[60:63], v[220:223]
 s_mov_b32 s64, 1
L_naw32:
 s_cmp_lg_u32 s64, 1
 s_cbranch_scc1 L_naw31
 s_bitcmp1_b32 s62, 1
 s_cbranch_scc1 L_pollw3
 v_mfma_f32_16x16x32_bf16 v[192:195], v[24:27], v[32:35], v[192:195]
 v_mfma_f32_16x16x32_bf16 v[196:199], v[24:27], v[36:39], v[196:199]
 v_mfma_f32_16x16x32_bf16 v[208:211], v[24:27], v[40:43], v[208:211]
 v_mfma_f32_16x16x32_bf16 v[212:215], v[24:27], v[44:47], v[212:215]
 v_mfma_f32_16x16x32_bf16 v[200:203], v[26:29], v[32:35], v[200:203]
 v_mfma_f32_16x16x32_bf16 v[204:207], v[26:29], v[36:39], v[204:207]
 v_mfma_f32_16x16x32_bf16 v[216:219], v[26:29], v[40:43], v[216:219]
 v_mfma_f32_16x16x32_bf16 v[220:223], v[26:29], v[44:47], v[220:223]
 s_mov_b32 s64, 0
L_naw31:
L_outw3:
 s_nop 15
 v_cvt_pk_bf16_f32 v8, v192, v193
 v_cvt_pk_bf16_f32 v9, v194, v195
 v_cvt_pk_bf16_f32 v10, v200, v201
 v_cvt_pk_bf16_f32 v11, v202, v203
 v_cvt_pk_bf16_f32 v12, v196, v197
 v_cvt_pk_bf16_f32 v13, v198, v199
 v_cvt_pk_bf16_f32 v14, v204, v205
 v_cvt_pk_bf16_f32 v15, v206, v207
 v_cvt_pk_bf16_f32 v16, v208, v209
 v_cvt_pk_bf16_f32 v17, v210, v211
 v_cvt_pk_bf16_f32 v18, v216, v217
 v_cvt_pk_bf16_f32 v19, v218, v219
 v_cvt_pk_bf16_f32 v20, v212, v213
 v_cvt_pk_bf16_f32 v21, v214, v215
 v_cvt_pk_bf16_f32 v22, v220, v221
 v_cvt_pk_bf16_f32 v23, v222, v223
 s_add_u32 s57, s60, 36864
 v_permlane16_swap_b32 v8, v10
 v_permlane16_swap_b32 v9, v11
 buffer_store_dwordx4 v[8:11], v7, s[72:75], s60 offen offset:0
 v_permlane16_swap_b32 v12, v14
 v_permlane16_swap_b32 v13, v15
 buffer_store_dwordx4 v[12:15], v7, s[72:75], s57 offen offset:0
 v_permlane16_swap_b32 v16, v18
 v_permlane16_swap_b32 v17, v19
 buffer_store_dwordx4 v[16:19], v7, s[72:75], s60 offen offset:64
 v_permlane16_swap_b32 v20, v22
 v_permlane16_swap_b32 v21, v23
 buffer_store_dwordx4 v[20:23], v7, s[72:75], s57 offen offset:64
 s_endpgm
L_done:
    s_endpgm
M_entry:
 s_cmp_eq_u32 s3, 3
 s_cbranch_scc1 M_loader
 s_lshl_b32 s50, s3, 12
 s_mov_b32 s49, 0x44800000
 s_lshl_b32 s56, s3, 16
 s_add_u32 s90, s44, s56
 s_mul_i32 s56, s3, 36864
 s_add_u32 s91, s43, s56
 s_mov_b32 s96, s48
 s_mov_b32 s97, s48
 v_lshrrev_b32 v1, 5, v0
 v_and_b32 v2, 31, v0
 v_lshlrev_b32 v16, 2, v1
 v_xor_b32 v2, v2, v16
 s_and_b32 s56, s3, 1
 s_lshl_b32 s56, s56, 1
 v_xor_b32 v2, s56, v2
 v_lshlrev_b32 v2, 4, v2
 v_lshl_add_u32 v2, v1, 13, v2
 v_xor_b32 v17, 0, v2
 v_add_u32 v96, 0, v17
 v_xor_b32 v17, 128, v2
 v_add_u32 v97, 15360, v17
 v_xor_b32 v17, 0, v2
 v_add_u32 v98, 30720, v17
 v_xor_b32 v17, 128, v2
 v_add_u32 v99, 46080, v17
 v_lshrrev_b32 v1, 3, v0
 v_and_b32 v2, 7, v0
 v_lshrrev_b32 v3, 4, v0
 v_mul_u32_u24 v20, 1152, v1
 v_add_u32 v17, 0, v3
 v_and_b32 v17, 7, v17
 v_xor_b32 v17, v17, v2
 v_lshlrev_b32 v17, 4, v17
 v_add_u32 v17, 0, v17
 v_add_u32 v100, v17, v20
 v_add_u32 v17, 4, v3
 v_and_b32 v17, 7, v17
 v_xor_b32 v17, v17, v2
 v_lshlrev_b32 v17, 4, v17
 v_add_u32 v17, 8192, v17
 v_add_u32 v101, v17, v20
 v_add_u32 v17, 8, v3
 v_and_b32 v17, 7, v17
 v_xor_b32 v17, v17, v2
 v_lshlrev_b32 v17, 4, v17
 v_add_u32 v17, 16384, v17
 v_add_u32 v102, v17, v20
 v_add_u32 v17, 12, v3
 v_and_b32 v17, 7, v17
 v_xor_b32 v17, v17, v2
 v_lshlrev_b32 v17, 4, v17
 v_add_u32 v17, 24576, v17
 v_add_u32 v103, v17, v20
 v_lshrrev_b32 v16, 3, v0
 v_lshlrev_b32 v16, 13, v16
 v_and_b32 v17, 7, v0
 v_lshl_add_u32 v16, v17, 7, v16
 s_and_b32 s56, s4, 15
 s_mul_i32 s56, s56, 3
 s_add_u32 s56, s56, s3
 s_mul_i32 s56, s56, 32768
 s_add_u32 s98, s56, s44
 v_mov_b32 v17, 0x7fffff00
 v_cmp_gt_u32 vcc, 32, v0
 s_nop 0
 s_nop 0
 v_cndmask_b32 v106, v17, v16, vcc
 s_cmp_lg_u32 s3, 2
 s_cbranch_scc1 M_nopfc
 s_getpc_b64 s[56:57]
M_pc0:
 v_mov_b32 v52, (M_done-M_pc0+2047)/2048
 s_lshr_b32 s62, s52, 1
 v_mul_lo_u32 v53, v52, s62
 v_min_u32 v52, v52, v0
 v_add_u32 v52, v52, v53
 v_lshlrev_b32 v52, 7, v52
 v_min_u32 v52, M_done-M_pc0, v52
 v_mov_b32 v53, s57
 v_add_co_u32 v52, vcc, s56, v52
 s_nop 1
 v_addc_co_u32 v53, vcc, 0, v53, vcc
 global_load_dword v50, v[52:53], off
M_nopfc:
 s_waitcnt lgkmcnt(0)
 s_mov_b32 s24, s12
 s_mov_b32 s25, s13
 s_mov_b32 s26, 4718592
 s_mov_b32 s27, 0x20000
 s_mov_b32 s32, s40
 s_mov_b32 s33, s41
 s_mov_b32 s34, 1769472
 s_mov_b32 s35, 0x20000
 s_mov_b32 s36, s54
 s_mov_b32 s37, s55
 s_mov_b32 s38, 290848768
 s_mov_b32 s39, 0x20000
 s_mov_b32 s16, s8
 s_mov_b32 s17, s9
 s_mov_b32 s18, 67108864
 s_mov_b32 s19, 0x20000
 s_mov_b32 s20, s10
 s_mov_b32 s21, s11
 s_mov_b32 s22, 67108864
 s_mov_b32 s23, 0x20000
 s_mov_b32 s28, s14
 s_mov_b32 s29, s15
 s_mov_b32 s30, 4718592
 s_mov_b32 s31, 0x20000
 s_mov_b32 s92, s12
 s_mov_b32 s93, s13
 s_mov_b32 s94, 4718592
 s_mov_b32 s95, 0x20000
 s_mov_b32 s72, s76
 s_mov_b32 s73, s77
 s_mov_b32 s74, 3538944
 s_mov_b32 s75, 0x20000
 s_mov_b32 s68, s78
 s_mov_b32 s69, s79
 s_mov_b32 s70, 256
 s_mov_b32 s71, 0x20000
 s_add_u32 s99, s98, 0
 buffer_load_dword v48, v106, s[24:27], s99 offen
 s_add_u32 m0, s50, 49152
 s_add_u32 s46, s90, 0
 buffer_load_dwordx4 v96, s[24:27], s46 offen offset:0 lds
 buffer_load_dwordx4 v97, s[24:27], s46 offen offset:1024 lds
 buffer_load_dwordx4 v98, s[24:27], s46 offen offset:2048 lds
 buffer_load_dwordx4 v99, s[24:27], s46 offen offset:3072 lds
 s_add_u32 m0, s50, 147456
 s_add_u32 s46, s91, 0
 buffer_load_dwordx4 v100, s[32:35], s46 offen offset:0 lds
 buffer_load_dwordx4 v101, s[32:35], s46 offen offset:1024 lds
 buffer_load_dwordx4 v102, s[32:35], s46 offen offset:2048 lds
 buffer_load_dwordx4 v103, s[32:35], s46 offen offset:3072 lds
 s_add_u32 m0, s50, 81920
 s_add_u32 s46, s90, 512
 buffer_load_dwordx4 v96, s[24:27], s46 offen offset:0 lds
 buffer_load_dwordx4 v97, s[24:27], s46 offen offset:1024 lds
 buffer_load_dwordx4 v98, s[24:27], s46 offen offset:2048 lds
 buffer_load_dwordx4 v99, s[24:27], s46 offen offset:3072 lds
 v_and_b32 v108, 7, v0
 v_lshlrev_b32 v108, 2, v108
 buffer_load_dword v23, v108, s[36:39], s89 offen sc1
 v_lshrrev_b32 v1, 4, v0
 v_bfe_u32 v2, v0, 2, 2
 v_lshlrev_b32 v16, 10, v1
 v_lshl_add_u32 v16, v2, 7, v16
 v_lshrrev_b32 v2, 1, v2
 v_lshl_add_u32 v16, v2, 6, v16
 v_and_b32 v2, 1, v1
 v_lshl_add_u32 v16, v2, 5, v16
 v_and_b32 v2, 3, v0
 v_lshl_add_u32 v8, v2, 3, v16
 v_xor_b32 v9, 32, v8
 v_xor_b32 v12, 64, v8
 v_xor_b32 v13, 96, v8
 v_lshrrev_b32 v1, 4, v0
 v_and_b32 v2, 15, v0
 v_lshrrev_b32 v16, 1, v2
 v_xor_b32 v16, v16, v1
 v_lshlrev_b32 v2, 7, v2
 v_add_u32 v2, s50, v2
 v_lshl_add_u32 v4, v16, 4, v2
 v_xor_b32 v5, 64, v4
 v_lshrrev_b32 v1, 4, v0
 v_bfe_u32 v2, v0, 2, 2
 v_lshl_add_u32 v16, v1, 3, v2
 v_lshlrev_b32 v16, 9, v16
 v_lshl_add_u32 v16, v2, 6, v16
 v_and_b32 v2, 1, v1
 v_lshl_add_u32 v16, v2, 5, v16
 v_and_b32 v2, 3, v0
 v_lshl_add_u32 v6, v2, 3, v16
 v_xor_b32 v7, 32, v6
 v_xor_b32 v10, 64, v6
 v_xor_b32 v11, 96, v6
 v_xor_b32 v208, 128, v6
 v_xor_b32 v209, 160, v6
 v_xor_b32 v210, 192, v6
 v_xor_b32 v211, 224, v6
 v_lshlrev_b32 v22, 4, v0
 v_add_u32 v3, s50, v22
 s_mul_i32 s56, s53, 884736
 s_lshl_b32 s57, s3, 15
 s_add_u32 s56, s56, s57
 s_lshl_b32 s57, s59, 12
 s_add_u32 s51, s56, s57
 v_mov_b32 v60, 0
 v_mov_b32 v61, 0
 v_mov_b32 v62, 0
 v_mov_b32 v63, 0
 s_nop 1
 v_mfma_f32_32x32x16_bf16 a[128:143], v[60:63], v[60:63], 0
 v_mfma_f32_32x32x16_bf16 a[144:159], v[60:63], v[60:63], 0
 v_mfma_f32_32x32x16_bf16 a[160:175], v[60:63], v[60:63], 0
 v_mfma_f32_32x32x16_bf16 a[176:191], v[60:63], v[60:63], 0
 v_mfma_f32_32x32x16_bf16 a[192:207], v[60:63], v[60:63], 0
 v_mfma_f32_32x32x16_bf16 a[208:223], v[60:63], v[60:63], 0
 v_mov_b32 v212, 0
 v_mov_b32 v213, 0
 v_mov_b32 v214, 0
 v_mov_b32 v215, 0
 v_mov_b32 v216, 0
 v_mov_b32 v217, 0
 v_mov_b32 v218, 0
 v_mov_b32 v219, 0
 v_mov_b32 v220, 0
 v_mov_b32 v221, 0
 v_mov_b32 v222, 0
 v_mov_b32 v223, 0
 v_mov_b32 v224, 0
 v_mov_b32 v225, 0
 v_mov_b32 v226, 0
 v_mov_b32 v227, 0
 v_mov_b32 v228, 0
 v_mov_b32 v229, 0
 v_mov_b32 v230, 0
 v_mov_b32 v231, 0
 v_mov_b32 v232, 0
 v_mov_b32 v233, 0
 v_mov_b32 v234, 0
 v_mov_b32 v235, 0
 v_mov_b32 v236, 0
 v_mov_b32 v237, 0
 v_mov_b32 v238, 0
 v_mov_b32 v239, 0
 s_waitcnt vmcnt(1) lgkmcnt(0)
 s_barrier
 v_add_u32 v4, 147456, v4
 ds_read_b128 v[64:67], v4 offset:0
 ds_read_b128 v[68:71], v4 offset:2048
 ds_read_b64_tr_b16 v[24:25], v6 offset:49408
 ds_read_b64_tr_b16 v[26:27], v6 offset:51456
 ds_read_b64_tr_b16 v[28:29], v7 offset:49408
 ds_read_b64_tr_b16 v[30:31], v7 offset:51456
 s_add_u32 m0, s50, 65536
 s_add_u32 s46, s90, 262144
 buffer_load_dwordx4 v96, s[24:27], s46 offen offset:0 lds
 ds_read_b64_tr_b16 v[32:33], v10 offset:49408
 ds_read_b64_tr_b16 v[34:35], v10 offset:51456
 buffer_load_dwordx4 v97, s[24:27], s46 offen offset:1024 lds
 ds_read_b64_tr_b16 v[36:37], v11 offset:49408
 ds_read_b64_tr_b16 v[38:39], v11 offset:51456
 buffer_load_dwordx4 v98, s[24:27], s46 offen offset:2048 lds
 ds_read_b64_tr_b16 v[40:41], v208 offset:49408
 ds_read_b64_tr_b16 v[42:43], v208 offset:51456
 buffer_load_dwordx4 v99, s[24:27], s46 offen offset:3072 lds
 ds_read_b64_tr_b16 v[44:45], v209 offset:49408
 ds_read_b64_tr_b16 v[46:47], v209 offset:51456
 s_add_u32 m0, s50, 114688
 s_add_u32 s46, s90, 262656
 buffer_load_dwordx4 v96, s[24:27], s46 offen offset:0 lds
 ds_read_b64_tr_b16 v[240:241], v210 offset:49408
 s_waitcnt lgkmcnt(5)
 v_mfma_f32_16x16x32_bf16 a[0:3], v[24:27], v[64:67], 0
 ds_read_b64_tr_b16 v[242:243], v210 offset:51456
 buffer_load_dwordx4 v97, s[24:27], s46 offen offset:1024 lds
 v_mfma_f32_16x16x32_bf16 a[4:7], v[24:27], v[68:71], 0
 ds_read_b64_tr_b16 v[244:245], v211 offset:49408
 v_mfma_f32_16x16x32_bf16 a[8:11], v[28:31], v[64:67], 0
 ds_read_b64_tr_b16 v[246:247], v211 offset:51456
 buffer_load_dwordx4 v98, s[24:27], s46 offen offset:2048 lds
 v_mfma_f32_16x16x32_bf16 a[12:15], v[28:31], v[68:71], 0
 v_add_u32 v6, 81920, v6
 ds_read_b64_tr_b16 v[24:25], v6 offset:0
 v_mfma_f32_16x16x32_bf16 a[16:19], v[32:35], v[64:67], 0
 ds_read_b64_tr_b16 v[26:27], v6 offset:2048
 buffer_load_dwordx4 v99, s[24:27], s46 offen offset:3072 lds
 v_mfma_f32_16x16x32_bf16 a[20:23], v[32:35], v[68:71], 0
 v_add_u32 v7, 81920, v7
 ds_read_b64_tr_b16 v[28:29], v7 offset:0
 s_add_u32 m0, s50, 98304
 s_add_u32 s46, s90, 524288
 v_mfma_f32_16x16x32_bf16 a[24:27], v[36:39], v[64:67], 0
 ds_read_b64_tr_b16 v[30:31], v7 offset:2048
 buffer_load_dwordx4 v96, s[24:27], s46 offen offset:0 lds
 v_mfma_f32_16x16x32_bf16 a[28:31], v[36:39], v[68:71], 0
 v_add_u32 v10, 81920, v10
 ds_read_b64_tr_b16 v[32:33], v10 offset:0
 s_waitcnt lgkmcnt(5)
 v_mfma_f32_16x16x32_bf16 a[32:35], v[40:43], v[64:67], 0
 ds_read_b64_tr_b16 v[34:35], v10 offset:2048
 buffer_load_dwordx4 v97, s[24:27], s46 offen offset:1024 lds
 v_mfma_f32_16x16x32_bf16 a[36:39], v[40:43], v[68:71], 0
 v_add_u32 v11, 81920, v11
 ds_read_b64_tr_b16 v[36:37], v11 offset:0
 v_mfma_f32_16x16x32_bf16 a[40:43], v[44:47], v[64:67], 0
 ds_read_b64_tr_b16 v[38:39], v11 offset:2048
 buffer_load_dwordx4 v98, s[24:27], s46 offen offset:2048 lds
 v_mfma_f32_16x16x32_bf16 a[44:47], v[44:47], v[68:71], 0
 v_add_u32 v208, 81920, v208
 ds_read_b64_tr_b16 v[40:41], v208 offset:0
 v_mfma_f32_16x16x32_bf16 a[48:51], v[240:243], v[64:67], 0
 ds_read_b64_tr_b16 v[42:43], v208 offset:2048
 buffer_load_dwordx4 v99, s[24:27], s46 offen offset:3072 lds
 v_mfma_f32_16x16x32_bf16 a[52:55], v[240:243], v[68:71], 0
 v_add_u32 v209, 81920, v209
 ds_read_b64_tr_b16 v[44:45], v209 offset:0
 s_add_u32 m0, s50, 131072
 s_add_u32 s46, s90, 524800
 v_mfma_f32_16x16x32_bf16 a[56:59], v[244:247], v[64:67], 0
 ds_read_b64_tr_b16 v[46:47], v209 offset:2048
 buffer_load_dwordx4 v96, s[24:27], s46 offen offset:0 lds
 v_mfma_f32_16x16x32_bf16 a[60:63], v[244:247], v[68:71], 0
 v_add_u32 v210, 81920, v210
 ds_read_b64_tr_b16 v[240:241], v210 offset:0
 s_waitcnt lgkmcnt(5)
 v_mfma_f32_16x16x32_bf16 a[64:67], v[24:27], v[64:67], 0
 ds_read_b64_tr_b16 v[242:243], v210 offset:2048
 buffer_load_dwordx4 v97, s[24:27], s46 offen offset:1024 lds
 v_mfma_f32_16x16x32_bf16 a[68:71], v[24:27], v[68:71], 0
 v_add_u32 v211, 81920, v211
 ds_read_b64_tr_b16 v[244:245], v211 offset:0
 v_mfma_f32_16x16x32_bf16 a[72:75], v[28:31], v[64:67], 0
 ds_read_b64_tr_b16 v[246:247], v211 offset:2048
 buffer_load_dwordx4 v98, s[24:27], s46 offen offset:2048 lds
 v_mfma_f32_16x16x32_bf16 a[76:79], v[28:31], v[68:71], 0
 v_add_u32 v6, 4294934528, v6
 ds_read_b64_tr_b16 v[24:25], v6 offset:0
 v_mfma_f32_16x16x32_bf16 a[80:83], v[32:35], v[64:67], 0
 ds_read_b64_tr_b16 v[26:27], v6 offset:2048
 buffer_load_dwordx4 v99, s[24:27], s46 offen offset:3072 lds
 v_mfma_f32_16x16x32_bf16 a[84:87], v[32:35], v[68:71], 0
 v_add_u32 v7, 4294934528, v7
 ds_read_b64_tr_b16 v[28:29], v7 offset:0
 s_add_u32 m0, s50, 32768
 s_add_u32 s46, s91, 128
 v_mfma_f32_16x16x32_bf16 a[88:91], v[36:39], v[64:67], 0
 ds_read_b64_tr_b16 v[30:31], v7 offset:2048
 buffer_load_dwordx4 v100, s[32:35], s46 offen offset:0 lds
 v_mfma_f32_16x16x32_bf16 a[92:95], v[36:39], v[68:71], 0
 v_add_u32 v10, 4294934528, v10
 ds_read_b64_tr_b16 v[32:33], v10 offset:0
 s_waitcnt lgkmcnt(5)
 v_mfma_f32_16x16x32_bf16 a[96:99], v[40:43], v[64:67], 0
 ds_read_b64_tr_b16 v[34:35], v10 offset:2048
 buffer_load_dwordx4 v101, s[32:35], s46 offen offset:1024 lds
 v_mfma_f32_16x16x32_bf16 a[100:103], v[40:43], v[68:71], 0
 v_add_u32 v11, 4294934528, v11
 ds_read_b64_tr_b16 v[36:37], v11 offset:0
 v_mfma_f32_16x16x32_bf16 a[104:107], v[44:47], v[64:67], 0
 ds_read_b64_tr_b16 v[38:39], v11 offset:2048
 buffer_load_dwordx4 v102, s[32:35], s46 offen offset:2048 lds
 v_mfma_f32_16x16x32_bf16 a[108:111], v[44:47], v[68:71], 0
 v_add_u32 v208, 4294934528, v208
 ds_read_b64_tr_b16 v[40:41], v208 offset:0
 v_mfma_f32_16x16x32_bf16 a[112:115], v[240:243], v[64:67], 0
 ds_read_b64_tr_b16 v[42:43], v208 offset:2048
 buffer_load_dwordx4 v103, s[32:35], s46 offen offset:3072 lds
 v_mfma_f32_16x16x32_bf16 a[116:119], v[240:243], v[68:71], 0
 v_add_u32 v209, 4294934528, v209
 ds_read_b64_tr_b16 v[44:45], v209 offset:0
 v_mfma_f32_16x16x32_bf16 a[120:123], v[244:247], v[64:67], 0
 ds_read_b64_tr_b16 v[46:47], v209 offset:2048
 v_mfma_f32_16x16x32_bf16 a[124:127], v[244:247], v[68:71], 0
 v_add_u32 v210, 4294934528, v210
 ds_read_b64_tr_b16 v[240:241], v210 offset:0
 s_waitcnt lgkmcnt(5)
 v_mfma_f32_16x16x32_bf16 v[144:147], v[24:27], v[64:67], 0
 ds_read_b64_tr_b16 v[242:243], v210 offset:2048
 v_mfma_f32_16x16x32_bf16 v[148:151], v[24:27], v[68:71], 0
 v_add_u32 v211, 4294934528, v211
 ds_read_b64_tr_b16 v[244:245], v211 offset:0
 v_mfma_f32_16x16x32_bf16 v[152:155], v[28:31], v[64:67], 0
 ds_read_b64_tr_b16 v[246:247], v211 offset:2048
 v_mfma_f32_16x16x32_bf16 v[156:159], v[28:31], v[68:71], 0
 v_mfma_f32_16x16x32_bf16 v[160:163], v[32:35], v[64:67], 0
 v_mfma_f32_16x16x32_bf16 v[164:167], v[32:35], v[68:71], 0
 v_mfma_f32_16x16x32_bf16 v[168:171], v[36:39], v[64:67], 0
 v_mfma_f32_16x16x32_bf16 v[172:175], v[36:39], v[68:71], 0
 s_waitcnt vmcnt(12) lgkmcnt(0)
 s_barrier
 v_add_u32 v5, 147456, v5
 ds_read_b128 v[72:75], v5 offset:0
 ds_read_b128 v[76:79], v5 offset:2048
 ds_read_b64_tr_b16 v[24:25], v6 offset:16640
 ds_read_b64_tr_b16 v[28:29], v7 offset:16640
 ds_read_b64_tr_b16 v[26:27], v6 offset:18688
 ds_read_b64_tr_b16 v[32:33], v10 offset:16640
 ds_read_b64_tr_b16 v[30:31], v7 offset:18688
 v_mfma_f32_16x16x32_bf16 v[176:179], v[40:43], v[64:67], 0
 ds_read_b64_tr_b16 v[34:35], v10 offset:18688
 s_add_u32 m0, s50, 49152
 s_add_u32 s46, s90, 786432
 buffer_load_dwordx4 v96, s[24:27], s46 offen offset:0 lds
 v_mfma_f32_16x16x32_bf16 v[180:183], v[40:43], v[68:71], 0
 ds_read_b64_tr_b16 v[36:37], v11 offset:16640
 v_mfma_f32_16x16x32_bf16 v[184:187], v[44:47], v[64:67], 0
 ds_read_b64_tr_b16 v[38:39], v11 offset:18688
 v_mfma_f32_16x16x32_bf16 v[188:191], v[44:47], v[68:71], 0
 ds_read_b64_tr_b16 v[40:41], v208 offset:16640
 v_mfma_f32_16x16x32_bf16 v[192:195], v[240:243], v[64:67], 0
 ds_read_b64_tr_b16 v[42:43], v208 offset:18688
 buffer_load_dwordx4 v97, s[24:27], s46 offen offset:1024 lds
 v_mfma_f32_16x16x32_bf16 v[196:199], v[240:243], v[68:71], 0
 ds_read_b64_tr_b16 v[44:45], v209 offset:16640
 v_mfma_f32_16x16x32_bf16 v[200:203], v[244:247], v[64:67], 0
 ds_read_b64_tr_b16 v[46:47], v209 offset:18688
 v_mfma_f32_16x16x32_bf16 v[204:207], v[244:247], v[68:71], 0
 ds_read_b64_tr_b16 v[240:241], v210 offset:16640
 s_waitcnt lgkmcnt(5)
 v_mfma_f32_16x16x32_bf16 a[0:3], v[24:27], v[72:75], a[0:3]
 ds_read_b64_tr_b16 v[242:243], v210 offset:18688
 buffer_load_dwordx4 v98, s[24:27], s46 offen offset:2048 lds
 v_mfma_f32_16x16x32_bf16 a[4:7], v[24:27], v[76:79], a[4:7]
 ds_read_b64_tr_b16 v[244:245], v211 offset:16640
 v_mfma_f32_16x16x32_bf16 a[8:11], v[28:31], v[72:75], a[8:11]
 ds_read_b64_tr_b16 v[246:247], v211 offset:18688
 v_mfma_f32_16x16x32_bf16 a[12:15], v[28:31], v[76:79], a[12:15]
 v_add_u32 v6, 65536, v6
 ds_read_b64_tr_b16 v[24:25], v6 offset:0
 v_mfma_f32_16x16x32_bf16 a[16:19], v[32:35], v[72:75], a[16:19]
 ds_read_b64_tr_b16 v[26:27], v6 offset:2048
 buffer_load_dwordx4 v99, s[24:27], s46 offen offset:3072 lds
 v_mfma_f32_16x16x32_bf16 a[20:23], v[32:35], v[76:79], a[20:23]
 v_add_u32 v7, 65536, v7
 ds_read_b64_tr_b16 v[28:29], v7 offset:0
 v_mfma_f32_16x16x32_bf16 a[24:27], v[36:39], v[72:75], a[24:27]
 ds_read_b64_tr_b16 v[30:31], v7 offset:2048
 v_mfma_f32_16x16x32_bf16 a[28:31], v[36:39], v[76:79], a[28:31]
 v_add_u32 v10, 65536, v10
 ds_read_b64_tr_b16 v[32:33], v10 offset:0
 s_add_u32 m0, s50, 81920
 s_add_u32 s46, s90, 786944
 s_waitcnt lgkmcnt(5)
 v_mfma_f32_16x16x32_bf16 a[32:35], v[40:43], v[72:75], a[32:35]
 ds_read_b64_tr_b16 v[34:35], v10 offset:2048
 buffer_load_dwordx4 v96, s[24:27], s46 offen offset:0 lds
 v_mfma_f32_16x16x32_bf16 a[36:39], v[40:43], v[76:79], a[36:39]
 v_add_u32 v11, 65536, v11
 ds_read_b64_tr_b16 v[36:37], v11 offset:0
 v_mfma_f32_16x16x32_bf16 a[40:43], v[44:47], v[72:75], a[40:43]
 ds_read_b64_tr_b16 v[38:39], v11 offset:2048
 v_mfma_f32_16x16x32_bf16 a[44:47], v[44:47], v[76:79], a[44:47]
 v_add_u32 v208, 65536, v208
 ds_read_b64_tr_b16 v[40:41], v208 offset:0
 v_mfma_f32_16x16x32_bf16 a[48:51], v[240:243], v[72:75], a[48:51]
 ds_read_b64_tr_b16 v[42:43], v208 offset:2048
 buffer_load_dwordx4 v97, s[24:27], s46 offen offset:1024 lds
 v_mfma_f32_16x16x32_bf16 a[52:55], v[240:243], v[76:79], a[52:55]
 v_add_u32 v209, 65536, v209
 ds_read_b64_tr_b16 v[44:45], v209 offset:0
 v_mfma_f32_16x16x32_bf16 a[56:59], v[244:247], v[72:75], a[56:59]
 ds_read_b64_tr_b16 v[46:47], v209 offset:2048
 v_mfma_f32_16x16x32_bf16 a[60:63], v[244:247], v[76:79], a[60:63]
 v_add_u32 v210, 65536, v210
 ds_read_b64_tr_b16 v[240:241], v210 offset:0
 s_waitcnt lgkmcnt(5)
 v_mfma_f32_16x16x32_bf16 a[64:67], v[24:27], v[72:75], a[64:67]
 ds_read_b64_tr_b16 v[242:243], v210 offset:2048
 buffer_load_dwordx4 v98, s[24:27], s46 offen offset:2048 lds
 v_mfma_f32_16x16x32_bf16 a[68:71], v[24:27], v[76:79], a[68:71]
 v_add_u32 v211, 65536, v211
 ds_read_b64_tr_b16 v[244:245], v211 offset:0
 v_mfma_f32_16x16x32_bf16 a[72:75], v[28:31], v[72:75], a[72:75]
 ds_read_b64_tr_b16 v[246:247], v211 offset:2048
 v_mfma_f32_16x16x32_bf16 a[76:79], v[28:31], v[76:79], a[76:79]
 v_add_u32 v6, 4294918144, v6
 ds_read_b64_tr_b16 v[24:25], v6 offset:0
 v_mfma_f32_16x16x32_bf16 a[80:83], v[32:35], v[72:75], a[80:83]
 ds_read_b64_tr_b16 v[26:27], v6 offset:2048
 buffer_load_dwordx4 v99, s[24:27], s46 offen offset:3072 lds
 v_mfma_f32_16x16x32_bf16 a[84:87], v[32:35], v[76:79], a[84:87]
 v_add_u32 v7, 4294918144, v7
 ds_read_b64_tr_b16 v[28:29], v7 offset:0
 v_mfma_f32_16x16x32_bf16 a[88:91], v[36:39], v[72:75], a[88:91]
 ds_read_b64_tr_b16 v[30:31], v7 offset:2048
 v_mfma_f32_16x16x32_bf16 a[92:95], v[36:39], v[76:79], a[92:95]
 v_add_u32 v10, 4294918144, v10
 ds_read_b64_tr_b16 v[32:33], v10 offset:0
 s_waitcnt lgkmcnt(5)
 v_mfma_f32_16x16x32_bf16 a[96:99], v[40:43], v[72:75], a[96:99]
 ds_read_b64_tr_b16 v[34:35], v10 offset:2048
 v_mfma_f32_16x16x32_bf16 a[100:103], v[40:43], v[76:79], a[100:103]
 v_add_u32 v11, 4294918144, v11
 ds_read_b64_tr_b16 v[36:37], v11 offset:0
 v_mfma_f32_16x16x32_bf16 a[104:107], v[44:47], v[72:75], a[104:107]
 ds_read_b64_tr_b16 v[38:39], v11 offset:2048
 v_mfma_f32_16x16x32_bf16 a[108:111], v[44:47], v[76:79], a[108:111]
 v_add_u32 v208, 4294918144, v208
 ds_read_b64_tr_b16 v[40:41], v208 offset:0
 v_mfma_f32_16x16x32_bf16 a[112:115], v[240:243], v[72:75], a[112:115]
 ds_read_b64_tr_b16 v[42:43], v208 offset:2048
 v_mfma_f32_16x16x32_bf16 a[116:119], v[240:243], v[76:79], a[116:119]
 v_add_u32 v209, 4294918144, v209
 ds_read_b64_tr_b16 v[44:45], v209 offset:0
 v_mfma_f32_16x16x32_bf16 a[120:123], v[244:247], v[72:75], a[120:123]
 ds_read_b64_tr_b16 v[46:47], v209 offset:2048
 v_mfma_f32_16x16x32_bf16 a[124:127], v[244:247], v[76:79], a[124:127]
 v_add_u32 v210, 4294918144, v210
 ds_read_b64_tr_b16 v[240:241], v210 offset:0
 s_waitcnt lgkmcnt(5)
 v_mfma_f32_16x16x32_bf16 v[144:147], v[24:27], v[72:75], v[144:147]
 ds_read_b64_tr_b16 v[242:243], v210 offset:2048
 v_mfma_f32_16x16x32_bf16 v[148:151], v[24:27], v[76:79], v[148:151]
 v_add_u32 v211, 4294918144, v211
 ds_read_b64_tr_b16 v[244:245], v211 offset:0
 v_mfma_f32_16x16x32_bf16 v[152:155], v[28:31], v[72:75], v[152:155]
 ds_read_b64_tr_b16 v[246:247], v211 offset:2048
 v_mfma_f32_16x16x32_bf16 v[156:159], v[28:31], v[76:79], v[156:159]
 v_mfma_f32_16x16x32_bf16 v[160:163], v[32:35], v[72:75], v[160:163]
 v_mfma_f32_16x16x32_bf16 v[164:167], v[32:35], v[76:79], v[164:167]
 v_mfma_f32_16x16x32_bf16 v[168:171], v[36:39], v[72:75], v[168:171]
 v_mfma_f32_16x16x32_bf16 v[172:175], v[36:39], v[76:79], v[172:175]
 s_waitcnt vmcnt(8) lgkmcnt(0)
 s_barrier
 v_add_u32 v4, 4294852608, v4
 ds_read_b128 v[80:83], v4 offset:0
 ds_read_b128 v[84:87], v4 offset:2048
 ds_read_b64_tr_b16 v[24:25], v6 offset:33024
 ds_read_b64_tr_b16 v[28:29], v7 offset:33024
 ds_read_b64_tr_b16 v[26:27], v6 offset:35072
 ds_read_b64_tr_b16 v[32:33], v10 offset:33024
 ds_read_b64_tr_b16 v[30:31], v7 offset:35072
 v_mfma_f32_16x16x32_bf16 v[176:179], v[40:43], v[72:75], v[176:179]
 ds_read_b64_tr_b16 v[34:35], v10 offset:35072
 s_add_u32 m0, s50, 65536
 s_add_u32 s46, s90, 1048576
 buffer_load_dwordx4 v96, s[24:27], s46 offen offset:0 lds
 v_mfma_f32_16x16x32_bf16 v[180:183], v[40:43], v[76:79], v[180:183]
 ds_read_b64_tr_b16 v[36:37], v11 offset:33024
 v_mfma_f32_16x16x32_bf16 v[184:187], v[44:47], v[72:75], v[184:187]
 ds_read_b64_tr_b16 v[38:39], v11 offset:35072
 buffer_load_dwordx4 v97, s[24:27], s46 offen offset:1024 lds
 v_mfma_f32_16x16x32_bf16 v[188:191], v[44:47], v[76:79], v[188:191]
 ds_read_b64_tr_b16 v[40:41], v208 offset:33024
 v_mfma_f32_16x16x32_bf16 v[192:195], v[240:243], v[72:75], v[192:195]
 ds_read_b64_tr_b16 v[42:43], v208 offset:35072
 v_mfma_f32_16x16x32_bf16 v[196:199], v[240:243], v[76:79], v[196:199]
 ds_read_b64_tr_b16 v[44:45], v209 offset:33024
 v_mfma_f32_16x16x32_bf16 v[200:203], v[244:247], v[72:75], v[200:203]
 ds_read_b64_tr_b16 v[46:47], v209 offset:35072
 buffer_load_dwordx4 v98, s[24:27], s46 offen offset:2048 lds
 v_mfma_f32_16x16x32_bf16 v[204:207], v[244:247], v[76:79], v[204:207]
 ds_read_b64_tr_b16 v[240:241], v210 offset:33024
 s_waitcnt lgkmcnt(5)
 v_mfma_f32_16x16x32_bf16 a[0:3], v[24:27], v[80:83], a[0:3]
 ds_read_b64_tr_b16 v[242:243], v210 offset:35072
 v_mfma_f32_16x16x32_bf16 a[4:7], v[24:27], v[84:87], a[4:7]
 ds_read_b64_tr_b16 v[244:245], v211 offset:33024
 v_mfma_f32_16x16x32_bf16 a[8:11], v[28:31], v[80:83], a[8:11]
 ds_read_b64_tr_b16 v[246:247], v211 offset:35072
 buffer_load_dwordx4 v99, s[24:27], s46 offen offset:3072 lds
 v_mfma_f32_16x16x32_bf16 a[12:15], v[28:31], v[84:87], a[12:15]
 v_add_u32 v6, 65536, v6
 ds_read_b64_tr_b16 v[24:25], v6 offset:0
 v_mfma_f32_16x16x32_bf16 a[16:19], v[32:35], v[80:83], a[16:19]
 ds_read_b64_tr_b16 v[26:27], v6 offset:2048
 v_mfma_f32_16x16x32_bf16 a[20:23], v[32:35], v[84:87], a[20:23]
 v_add_u32 v7, 65536, v7
 ds_read_b64_tr_b16 v[28:29], v7 offset:0
 s_add_u32 m0, s50, 114688
 s_add_u32 s46, s90, 1049088
 v_mfma_f32_16x16x32_bf16 a[24:27], v[36:39], v[80:83], a[24:27]
 ds_read_b64_tr_b16 v[30:31], v7 offset:2048
 buffer_load_dwordx4 v96, s[24:27], s46 offen offset:0 lds
 v_mfma_f32_16x16x32_bf16 a[28:31], v[36:39], v[84:87], a[28:31]
 v_add_u32 v10, 65536, v10
 ds_read_b64_tr_b16 v[32:33], v10 offset:0
 s_waitcnt lgkmcnt(5)
 v_mfma_f32_16x16x32_bf16 a[32:35], v[40:43], v[80:83], a[32:35]
 ds_read_b64_tr_b16 v[34:35], v10 offset:2048
 buffer_load_dwordx4 v97, s[24:27], s46 offen offset:1024 lds
 v_mfma_f32_16x16x32_bf16 a[36:39], v[40:43], v[84:87], a[36:39]
 v_add_u32 v11, 65536, v11
 ds_read_b64_tr_b16 v[36:37], v11 offset:0
 v_mfma_f32_16x16x32_bf16 a[40:43], v[44:47], v[80:83], a[40:43]
 ds_read_b64_tr_b16 v[38:39], v11 offset:2048
 v_mfma_f32_16x16x32_bf16 a[44:47], v[44:47], v[84:87], a[44:47]
 v_add_u32 v208, 65536, v208
 ds_read_b64_tr_b16 v[40:41], v208 offset:0
 v_mfma_f32_16x16x32_bf16 a[48:51], v[240:243], v[80:83], a[48:51]
 ds_read_b64_tr_b16 v[42:43], v208 offset:2048
 buffer_load_dwordx4 v98, s[24:27], s46 offen offset:2048 lds
 v_mfma_f32_16x16x32_bf16 a[52:55], v[240:243], v[84:87], a[52:55]
 v_add_u32 v209, 65536, v209
 ds_read_b64_tr_b16 v[44:45], v209 offset:0
 v_mfma_f32_16x16x32_bf16 a[56:59], v[244:247], v[80:83], a[56:59]
 ds_read_b64_tr_b16 v[46:47], v209 offset:2048
 v_mfma_f32_16x16x32_bf16 a[60:63], v[244:247], v[84:87], a[60:63]
 v_add_u32 v210, 65536, v210
 ds_read_b64_tr_b16 v[240:241], v210 offset:0
 s_waitcnt lgkmcnt(5)
 v_mfma_f32_16x16x32_bf16 a[64:67], v[24:27], v[80:83], a[64:67]
 ds_read_b64_tr_b16 v[242:243], v210 offset:2048
 buffer_load_dwordx4 v99, s[24:27], s46 offen offset:3072 lds
 v_mfma_f32_16x16x32_bf16 a[68:71], v[24:27], v[84:87], a[68:71]
 v_add_u32 v211, 65536, v211
 ds_read_b64_tr_b16 v[244:245], v211 offset:0
 v_mfma_f32_16x16x32_bf16 a[72:75], v[28:31], v[80:83], a[72:75]
 ds_read_b64_tr_b16 v[246:247], v211 offset:2048
 v_mfma_f32_16x16x32_bf16 a[76:79], v[28:31], v[84:87], a[76:79]
 v_add_u32 v6, 4294934528, v6
 ds_read_b64_tr_b16 v[24:25], v6 offset:0
 s_add_u32 m0, s50, 147456
 s_add_u32 s46, s91, 256
 v_mfma_f32_16x16x32_bf16 a[80:83], v[32:35], v[80:83], a[80:83]
 ds_read_b64_tr_b16 v[26:27], v6 offset:2048
 buffer_load_dwordx4 v100, s[32:35], s46 offen offset:0 lds
 v_mfma_f32_16x16x32_bf16 a[84:87], v[32:35], v[84:87], a[84:87]
 v_add_u32 v7, 4294934528, v7
 ds_read_b64_tr_b16 v[28:29], v7 offset:0
 v_mfma_f32_16x16x32_bf16 a[88:91], v[36:39], v[80:83], a[88:91]
 ds_read_b64_tr_b16 v[30:31], v7 offset:2048
 buffer_load_dwordx4 v101, s[32:35], s46 offen offset:1024 lds
 v_mfma_f32_16x16x32_bf16 a[92:95], v[36:39], v[84:87], a[92:95]
 v_add_u32 v10, 4294934528, v10
 ds_read_b64_tr_b16 v[32:33], v10 offset:0
 s_waitcnt lgkmcnt(5)
 v_mfma_f32_16x16x32_bf16 a[96:99], v[40:43], v[80:83], a[96:99]
 ds_read_b64_tr_b16 v[34:35], v10 offset:2048
 v_mfma_f32_16x16x32_bf16 a[100:103], v[40:43], v[84:87], a[100:103]
 v_add_u32 v11, 4294934528, v11
 ds_read_b64_tr_b16 v[36:37], v11 offset:0
 v_mfma_f32_16x16x32_bf16 a[104:107], v[44:47], v[80:83], a[104:107]
 ds_read_b64_tr_b16 v[38:39], v11 offset:2048
 buffer_load_dwordx4 v102, s[32:35], s46 offen offset:2048 lds
 v_mfma_f32_16x16x32_bf16 a[108:111], v[44:47], v[84:87], a[108:111]
 v_add_u32 v208, 4294934528, v208
 ds_read_b64_tr_b16 v[40:41], v208 offset:0
 v_mfma_f32_16x16x32_bf16 a[112:115], v[240:243], v[80:83], a[112:115]
 ds_read_b64_tr_b16 v[42:43], v208 offset:2048
 v_mfma_f32_16x16x32_bf16 a[116:119], v[240:243], v[84:87], a[116:119]
 v_add_u32 v209, 4294934528, v209
 ds_read_b64_tr_b16 v[44:45], v209 offset:0
 v_mfma_f32_16x16x32_bf16 a[120:123], v[244:247], v[80:83], a[120:123]
 ds_read_b64_tr_b16 v[46:47], v209 offset:2048
 buffer_load_dwordx4 v103, s[32:35], s46 offen offset:3072 lds
 v_mfma_f32_16x16x32_bf16 a[124:127], v[244:247], v[84:87], a[124:127]
 v_add_u32 v210, 4294934528, v210
 ds_read_b64_tr_b16 v[240:241], v210 offset:0
 s_waitcnt lgkmcnt(5)
 v_mfma_f32_16x16x32_bf16 v[144:147], v[24:27], v[80:83], v[144:147]
 ds_read_b64_tr_b16 v[242:243], v210 offset:2048
 v_mfma_f32_16x16x32_bf16 v[148:151], v[24:27], v[84:87], v[148:151]
 v_add_u32 v211, 4294934528, v211
 ds_read_b64_tr_b16 v[244:245], v211 offset:0
 s_add_u32 s99, s98, 1572864
 v_mfma_f32_16x16x32_bf16 v[152:155], v[28:31], v[80:83], v[152:155]
 ds_read_b64_tr_b16 v[246:247], v211 offset:2048
 buffer_load_dword v48, v106, s[24:27], s99 offen
 v_mfma_f32_16x16x32_bf16 v[156:159], v[28:31], v[84:87], v[156:159]
 v_mfma_f32_16x16x32_bf16 v[160:163], v[32:35], v[80:83], v[160:163]
 v_mfma_f32_16x16x32_bf16 v[164:167], v[32:35], v[84:87], v[164:167]
 v_mfma_f32_16x16x32_bf16 v[168:171], v[36:39], v[80:83], v[168:171]
 v_mfma_f32_16x16x32_bf16 v[172:175], v[36:39], v[84:87], v[172:175]
 s_waitcnt vmcnt(13) lgkmcnt(0)
 s_barrier
 v_add_u32 v5, 4294852608, v5
 ds_read_b128 v[88:91], v5 offset:0
 ds_read_b128 v[92:95], v5 offset:2048
 v_add_u32 v6, 4294918144, v6
 ds_read_b64_tr_b16 v[24:25], v6 offset:256
 v_add_u32 v7, 4294918144, v7
 ds_read_b64_tr_b16 v[28:29], v7 offset:256
 ds_read_b64_tr_b16 v[26:27], v6 offset:2304
 v_add_u32 v10, 4294918144, v10
 ds_read_b64_tr_b16 v[32:33], v10 offset:256
 ds_read_b64_tr_b16 v[30:31], v7 offset:2304
 v_mfma_f32_16x16x32_bf16 v[176:179], v[40:43], v[80:83], v[176:179]
 ds_read_b64_tr_b16 v[34:35], v10 offset:2304
 s_add_u32 m0, s50, 98304
 s_add_u32 s46, s90, 1310720
 buffer_load_dwordx4 v96, s[24:27], s46 offen offset:0 lds
 v_mfma_f32_16x16x32_bf16 v[180:183], v[40:43], v[84:87], v[180:183]
 v_add_u32 v11, 4294918144, v11
 ds_read_b64_tr_b16 v[36:37], v11 offset:256
 v_mfma_f32_16x16x32_bf16 v[184:187], v[44:47], v[80:83], v[184:187]
 ds_read_b64_tr_b16 v[38:39], v11 offset:2304
 v_mfma_f32_16x16x32_bf16 v[188:191], v[44:47], v[84:87], v[188:191]
 v_add_u32 v208, 4294918144, v208
 ds_read_b64_tr_b16 v[40:41], v208 offset:256
 v_mfma_f32_16x16x32_bf16 v[192:195], v[240:243], v[80:83], v[192:195]
 ds_read_b64_tr_b16 v[42:43], v208 offset:2304
 buffer_load_dwordx4 v97, s[24:27], s46 offen offset:1024 lds
 v_mfma_f32_16x16x32_bf16 v[196:199], v[240:243], v[84:87], v[196:199]
 v_add_u32 v209, 4294918144, v209
 ds_read_b64_tr_b16 v[44:45], v209 offset:256
 v_mfma_f32_16x16x32_bf16 v[200:203], v[244:247], v[80:83], v[200:203]
 ds_read_b64_tr_b16 v[46:47], v209 offset:2304
 v_mfma_f32_16x16x32_bf16 v[204:207], v[244:247], v[84:87], v[204:207]
 v_add_u32 v210, 4294918144, v210
 ds_read_b64_tr_b16 v[240:241], v210 offset:256
 s_waitcnt lgkmcnt(5)
 v_mfma_f32_16x16x32_bf16 a[0:3], v[24:27], v[88:91], a[0:3]
 ds_read_b64_tr_b16 v[242:243], v210 offset:2304
 buffer_load_dwordx4 v98, s[24:27], s46 offen offset:2048 lds
 v_mfma_f32_16x16x32_bf16 a[4:7], v[24:27], v[92:95], a[4:7]
 v_add_u32 v211, 4294918144, v211
 ds_read_b64_tr_b16 v[244:245], v211 offset:256
 v_mfma_f32_16x16x32_bf16 a[8:11], v[28:31], v[88:91], a[8:11]
 ds_read_b64_tr_b16 v[246:247], v211 offset:2304
 v_mfma_f32_16x16x32_bf16 a[12:15], v[28:31], v[92:95], a[12:15]
 ds_read_b64_tr_b16 v[24:25], v6 offset:32768
 v_mfma_f32_16x16x32_bf16 a[16:19], v[32:35], v[88:91], a[16:19]
 ds_read_b64_tr_b16 v[26:27], v6 offset:34816
 buffer_load_dwordx4 v99, s[24:27], s46 offen offset:3072 lds
 v_mfma_f32_16x16x32_bf16 a[20:23], v[32:35], v[92:95], a[20:23]
 ds_read_b64_tr_b16 v[28:29], v7 offset:32768
 v_mfma_f32_16x16x32_bf16 a[24:27], v[36:39], v[88:91], a[24:27]
 ds_read_b64_tr_b16 v[30:31], v7 offset:34816
 v_mfma_f32_16x16x32_bf16 a[28:31], v[36:39], v[92:95], a[28:31]
 ds_read_b64_tr_b16 v[32:33], v10 offset:32768
 s_add_u32 m0, s50, 131072
 s_add_u32 s46, s90, 1311232
 s_waitcnt lgkmcnt(5)
 v_mfma_f32_16x16x32_bf16 a[32:35], v[40:43], v[88:91], a[32:35]
 ds_read_b64_tr_b16 v[34:35], v10 offset:34816
 buffer_load_dwordx4 v96, s[24:27], s46 offen offset:0 lds
 v_mfma_f32_16x16x32_bf16 a[36:39], v[40:43], v[92:95], a[36:39]
 ds_read_b64_tr_b16 v[36:37], v11 offset:32768
 v_mfma_f32_16x16x32_bf16 a[40:43], v[44:47], v[88:91], a[40:43]
 ds_read_b64_tr_b16 v[38:39], v11 offset:34816
 v_mfma_f32_16x16x32_bf16 a[44:47], v[44:47], v[92:95], a[44:47]
 ds_read_b64_tr_b16 v[40:41], v208 offset:32768
 v_mfma_f32_16x16x32_bf16 a[48:51], v[240:243], v[88:91], a[48:51]
 ds_read_b64_tr_b16 v[42:43], v208 offset:34816
 buffer_load_dwordx4 v97, s[24:27], s46 offen offset:1024 lds
 v_mfma_f32_16x16x32_bf16 a[52:55], v[240:243], v[92:95], a[52:55]
 ds_read_b64_tr_b16 v[44:45], v209 offset:32768
 v_mfma_f32_16x16x32_bf16 a[56:59], v[244:247], v[88:91], a[56:59]
 ds_read_b64_tr_b16 v[46:47], v209 offset:34816
 v_mfma_f32_16x16x32_bf16 a[60:63], v[244:247], v[92:95], a[60:63]
 ds_read_b64_tr_b16 v[240:241], v210 offset:32768
 s_waitcnt lgkmcnt(5)
 v_mfma_f32_16x16x32_bf16 a[64:67], v[24:27], v[88:91], a[64:67]
 ds_read_b64_tr_b16 v[242:243], v210 offset:34816
 buffer_load_dwordx4 v98, s[24:27], s46 offen offset:2048 lds
 v_mfma_f32_16x16x32_bf16 a[68:71], v[24:27], v[92:95], a[68:71]
 ds_read_b64_tr_b16 v[244:245], v211 offset:32768
 v_mfma_f32_16x16x32_bf16 a[72:75], v[28:31], v[88:91], a[72:75]
 ds_read_b64_tr_b16 v[246:247], v211 offset:34816
 v_mfma_f32_16x16x32_bf16 a[76:79], v[28:31], v[92:95], a[76:79]
 ds_read_b64_tr_b16 v[24:25], v6 offset:0
 v_mfma_f32_16x16x32_bf16 a[80:83], v[32:35], v[88:91], a[80:83]
 ds_read_b64_tr_b16 v[26:27], v6 offset:2048
 buffer_load_dwordx4 v99, s[24:27], s46 offen offset:3072 lds
 v_mfma_f32_16x16x32_bf16 a[84:87], v[32:35], v[92:95], a[84:87]
 ds_read_b64_tr_b16 v[28:29], v7 offset:0
 v_mfma_f32_16x16x32_bf16 a[88:91], v[36:39], v[88:91], a[88:91]
 ds_read_b64_tr_b16 v[30:31], v7 offset:2048
 v_mfma_f32_16x16x32_bf16 a[92:95], v[36:39], v[92:95], a[92:95]
 ds_read_b64_tr_b16 v[32:33], v10 offset:0
 s_waitcnt lgkmcnt(5)
 v_mfma_f32_16x16x32_bf16 a[96:99], v[40:43], v[88:91], a[96:99]
 ds_read_b64_tr_b16 v[34:35], v10 offset:2048
 v_mfma_f32_16x16x32_bf16 a[100:103], v[40:43], v[92:95], a[100:103]
 ds_read_b64_tr_b16 v[36:37], v11 offset:0
 v_mfma_f32_16x16x32_bf16 a[104:107], v[44:47], v[88:91], a[104:107]
 ds_read_b64_tr_b16 v[38:39], v11 offset:2048
 v_mfma_f32_16x16x32_bf16 a[108:111], v[44:47], v[92:95], a[108:111]
 ds_read_b64_tr_b16 v[40:41], v208 offset:0
 v_mfma_f32_16x16x32_bf16 a[112:115], v[240:243], v[88:91], a[112:115]
 ds_read_b64_tr_b16 v[42:43], v208 offset:2048
 v_mfma_f32_16x16x32_bf16 a[116:119], v[240:243], v[92:95], a[116:119]
 ds_read_b64_tr_b16 v[44:45], v209 offset:0
 v_mfma_f32_16x16x32_bf16 a[120:123], v[244:247], v[88:91], a[120:123]
 ds_read_b64_tr_b16 v[46:47], v209 offset:2048
 v_mfma_f32_16x16x32_bf16 a[124:127], v[244:247], v[92:95], a[124:127]
 ds_read_b64_tr_b16 v[240:241], v210 offset:0
 s_waitcnt lgkmcnt(5)
 v_mfma_f32_16x16x32_bf16 v[144:147], v[24:27], v[88:91], v[144:147]
 ds_read_b64_tr_b16 v[242:243], v210 offset:2048
 v_mfma_f32_16x16x32_bf16 v[148:151], v[24:27], v[92:95], v[148:151]
 ds_read_b64_tr_b16 v[244:245], v211 offset:0
 v_mfma_f32_16x16x32_bf16 v[152:155], v[28:31], v[88:91], v[152:155]
 ds_read_b64_tr_b16 v[246:247], v211 offset:2048
 v_mfma_f32_16x16x32_bf16 v[156:159], v[28:31], v[92:95], v[156:159]
 v_mfma_f32_16x16x32_bf16 v[160:163], v[32:35], v[88:91], v[160:163]
 v_mfma_f32_16x16x32_bf16 v[164:167], v[32:35], v[92:95], v[164:167]
 v_mfma_f32_16x16x32_bf16 v[168:171], v[36:39], v[88:91], v[168:171]
 v_mfma_f32_16x16x32_bf16 v[172:175], v[36:39], v[92:95], v[172:175]
 s_waitcnt vmcnt(9) lgkmcnt(0)
 s_barrier
 v_add_u32 v4, 114688, v4
 ds_read_b128 v[64:67], v4 offset:0
 ds_read_b128 v[68:71], v4 offset:2048
 ds_read_b64_tr_b16 v[24:25], v6 offset:16640
 ds_read_b64_tr_b16 v[28:29], v7 offset:16640
 ds_read_b64_tr_b16 v[26:27], v6 offset:18688
 ds_read_b64_tr_b16 v[32:33], v10 offset:16640
 ds_read_b64_tr_b16 v[30:31], v7 offset:18688
 v_mfma_f32_16x16x32_bf16 v[176:179], v[40:43], v[88:91], v[176:179]
 ds_read_b64_tr_b16 v[34:35], v10 offset:18688
 s_add_u32 m0, s50, 49152
 s_add_u32 s46, s90, 1572864
 buffer_load_dwordx4 v96, s[24:27], s46 offen offset:0 lds
 v_mfma_f32_16x16x32_bf16 v[180:183], v[40:43], v[92:95], v[180:183]
 ds_read_b64_tr_b16 v[36:37], v11 offset:16640
 v_mfma_f32_16x16x32_bf16 v[184:187], v[44:47], v[88:91], v[184:187]
 ds_read_b64_tr_b16 v[38:39], v11 offset:18688
 buffer_load_dwordx4 v97, s[24:27], s46 offen offset:1024 lds
 v_mfma_f32_16x16x32_bf16 v[188:191], v[44:47], v[92:95], v[188:191]
 ds_read_b64_tr_b16 v[40:41], v208 offset:16640
 v_mfma_f32_16x16x32_bf16 v[192:195], v[240:243], v[88:91], v[192:195]
 ds_read_b64_tr_b16 v[42:43], v208 offset:18688
 v_mfma_f32_16x16x32_bf16 v[196:199], v[240:243], v[92:95], v[196:199]
 ds_read_b64_tr_b16 v[44:45], v209 offset:16640
 v_mfma_f32_16x16x32_bf16 v[200:203], v[244:247], v[88:91], v[200:203]
 ds_read_b64_tr_b16 v[46:47], v209 offset:18688
 buffer_load_dwordx4 v98, s[24:27], s46 offen offset:2048 lds
 v_mfma_f32_16x16x32_bf16 v[204:207], v[244:247], v[92:95], v[204:207]
 ds_read_b64_tr_b16 v[240:241], v210 offset:16640
 s_waitcnt lgkmcnt(5)
 v_mfma_f32_16x16x32_bf16 a[0:3], v[24:27], v[64:67], a[0:3]
 ds_read_b64_tr_b16 v[242:243], v210 offset:18688
 v_mfma_f32_16x16x32_bf16 a[4:7], v[24:27], v[68:71], a[4:7]
 ds_read_b64_tr_b16 v[244:245], v211 offset:16640
 v_mfma_f32_16x16x32_bf16 a[8:11], v[28:31], v[64:67], a[8:11]
 ds_read_b64_tr_b16 v[246:247], v211 offset:18688
 buffer_load_dwordx4 v99, s[24:27], s46 offen offset:3072 lds
 v_mfma_f32_16x16x32_bf16 a[12:15], v[28:31], v[68:71], a[12:15]
 v_add_u32 v6, 65536, v6
 ds_read_b64_tr_b16 v[24:25], v6 offset:0
 v_mfma_f32_16x16x32_bf16 a[16:19], v[32:35], v[64:67], a[16:19]
 ds_read_b64_tr_b16 v[26:27], v6 offset:2048
 v_mfma_f32_16x16x32_bf16 a[20:23], v[32:35], v[68:71], a[20:23]
 v_add_u32 v7, 65536, v7
 ds_read_b64_tr_b16 v[28:29], v7 offset:0
 s_add_u32 m0, s50, 81920
 s_add_u32 s46, s90, 1573376
 v_mfma_f32_16x16x32_bf16 a[24:27], v[36:39], v[64:67], a[24:27]
 ds_read_b64_tr_b16 v[30:31], v7 offset:2048
 buffer_load_dwordx4 v96, s[24:27], s46 offen offset:0 lds
 v_mfma_f32_16x16x32_bf16 a[28:31], v[36:39], v[68:71], a[28:31]
 v_add_u32 v10, 65536, v10
 ds_read_b64_tr_b16 v[32:33], v10 offset:0
 s_waitcnt lgkmcnt(5)
 v_mfma_f32_16x16x32_bf16 a[32:35], v[40:43], v[64:67], a[32:35]
 ds_read_b64_tr_b16 v[34:35], v10 offset:2048
 v_mfma_f32_16x16x32_bf16 a[36:39], v[40:43], v[68:71], a[36:39]
 v_add_u32 v11, 65536, v11
 ds_read_b64_tr_b16 v[36:37], v11 offset:0
 v_mfma_f32_16x16x32_bf16 a[40:43], v[44:47], v[64:67], a[40:43]
 ds_read_b64_tr_b16 v[38:39], v11 offset:2048
 buffer_load_dwordx4 v97, s[24:27], s46 offen offset:1024 lds
 v_mfma_f32_16x16x32_bf16 a[44:47], v[44:47], v[68:71], a[44:47]
 v_add_u32 v208, 65536, v208
 ds_read_b64_tr_b16 v[40:41], v208 offset:0
 v_mfma_f32_16x16x32_bf16 a[48:51], v[240:243], v[64:67], a[48:51]
 ds_read_b64_tr_b16 v[42:43], v208 offset:2048
 v_mfma_f32_16x16x32_bf16 a[52:55], v[240:243], v[68:71], a[52:55]
 v_add_u32 v209, 65536, v209
 ds_read_b64_tr_b16 v[44:45], v209 offset:0
 v_mfma_f32_16x16x32_bf16 a[56:59], v[244:247], v[64:67], a[56:59]
 ds_read_b64_tr_b16 v[46:47], v209 offset:2048
 buffer_load_dwordx4 v98, s[24:27], s46 offen offset:2048 lds
 v_mfma_f32_16x16x32_bf16 a[60:63], v[244:247], v[68:71], a[60:63]
 v_add_u32 v210, 65536, v210
 ds_read_b64_tr_b16 v[240:241], v210 offset:0
 s_waitcnt lgkmcnt(5)
 v_mfma_f32_16x16x32_bf16 a[64:67], v[24:27], v[64:67], a[64:67]
 ds_read_b64_tr_b16 v[242:243], v210 offset:2048
 v_mfma_f32_16x16x32_bf16 a[68:71], v[24:27], v[68:71], a[68:71]
 v_add_u32 v211, 65536, v211
 ds_read_b64_tr_b16 v[244:245], v211 offset:0
 v_mfma_f32_16x16x32_bf16 a[72:75], v[28:31], v[64:67], a[72:75]
 ds_read_b64_tr_b16 v[246:247], v211 offset:2048
 buffer_load_dwordx4 v99, s[24:27], s46 offen offset:3072 lds
 v_mfma_f32_16x16x32_bf16 a[76:79], v[28:31], v[68:71], a[76:79]
 v_add_u32 v6, 4294918144, v6
 ds_read_b64_tr_b16 v[24:25], v6 offset:0
 v_mfma_f32_16x16x32_bf16 a[80:83], v[32:35], v[64:67], a[80:83]
 ds_read_b64_tr_b16 v[26:27], v6 offset:2048
 v_mfma_f32_16x16x32_bf16 a[84:87], v[32:35], v[68:71], a[84:87]
 v_add_u32 v7, 4294918144, v7
 ds_read_b64_tr_b16 v[28:29], v7 offset:0
 s_add_u32 m0, s50, 32768
 s_add_u32 s46, s91, 384
 v_mfma_f32_16x16x32_bf16 a[88:91], v[36:39], v[64:67], a[88:91]
 ds_read_b64_tr_b16 v[30:31], v7 offset:2048
 buffer_load_dwordx4 v100, s[32:35], s46 offen offset:0 lds
 v_mfma_f32_16x16x32_bf16 a[92:95], v[36:39], v[68:71], a[92:95]
 v_add_u32 v10, 4294918144, v10
 ds_read_b64_tr_b16 v[32:33], v10 offset:0
 s_waitcnt lgkmcnt(5)
 v_mfma_f32_16x16x32_bf16 a[96:99], v[40:43], v[64:67], a[96:99]
 ds_read_b64_tr_b16 v[34:35], v10 offset:2048
 v_mfma_f32_16x16x32_bf16 a[100:103], v[40:43], v[68:71], a[100:103]
 v_add_u32 v11, 4294918144, v11
 ds_read_b64_tr_b16 v[36:37], v11 offset:0
 v_mfma_f32_16x16x32_bf16 a[104:107], v[44:47], v[64:67], a[104:107]
 ds_read_b64_tr_b16 v[38:39], v11 offset:2048
 buffer_load_dwordx4 v101, s[32:35], s46 offen offset:1024 lds
 v_mfma_f32_16x16x32_bf16 a[108:111], v[44:47], v[68:71], a[108:111]
 v_add_u32 v208, 4294918144, v208
 ds_read_b64_tr_b16 v[40:41], v208 offset:0
 v_mfma_f32_16x16x32_bf16 a[112:115], v[240:243], v[64:67], a[112:115]
 ds_read_b64_tr_b16 v[42:43], v208 offset:2048
 v_mfma_f32_16x16x32_bf16 a[116:119], v[240:243], v[68:71], a[116:119]
 v_add_u32 v209, 4294918144, v209
 ds_read_b64_tr_b16 v[44:45], v209 offset:0
 v_mfma_f32_16x16x32_bf16 a[120:123], v[244:247], v[64:67], a[120:123]
 ds_read_b64_tr_b16 v[46:47], v209 offset:2048
 buffer_load_dwordx4 v102, s[32:35], s46 offen offset:2048 lds
 v_mfma_f32_16x16x32_bf16 a[124:127], v[244:247], v[68:71], a[124:127]
 v_add_u32 v210, 4294918144, v210
 ds_read_b64_tr_b16 v[240:241], v210 offset:0
 s_waitcnt lgkmcnt(5)
 v_mfma_f32_16x16x32_bf16 v[144:147], v[24:27], v[64:67], v[144:147]
 ds_read_b64_tr_b16 v[242:243], v210 offset:2048
 v_mfma_f32_16x16x32_bf16 v[148:151], v[24:27], v[68:71], v[148:151]
 v_add_u32 v211, 4294918144, v211
 ds_read_b64_tr_b16 v[244:245], v211 offset:0
 v_mfma_f32_16x16x32_bf16 v[152:155], v[28:31], v[64:67], v[152:155]
 ds_read_b64_tr_b16 v[246:247], v211 offset:2048
 buffer_load_dwordx4 v103, s[32:35], s46 offen offset:3072 lds
 v_mfma_f32_16x16x32_bf16 v[156:159], v[28:31], v[68:71], v[156:159]
 v_mfma_f32_16x16x32_bf16 v[160:163], v[32:35], v[64:67], v[160:163]
 v_mfma_f32_16x16x32_bf16 v[164:167], v[32:35], v[68:71], v[164:167]
 v_mfma_f32_16x16x32_bf16 v[168:171], v[36:39], v[64:67], v[168:171]
 v_mfma_f32_16x16x32_bf16 v[172:175], v[36:39], v[68:71], v[172:175]
 s_waitcnt vmcnt(12) lgkmcnt(0)
 s_barrier
 v_add_u32 v5, 114688, v5
 ds_read_b128 v[72:75], v5 offset:0
 ds_read_b128 v[76:79], v5 offset:2048
 ds_read_b64_tr_b16 v[24:25], v6 offset:33024
 ds_read_b64_tr_b16 v[28:29], v7 offset:33024
 ds_read_b64_tr_b16 v[26:27], v6 offset:35072
 ds_read_b64_tr_b16 v[32:33], v10 offset:33024
 ds_read_b64_tr_b16 v[30:31], v7 offset:35072
 v_mfma_f32_16x16x32_bf16 v[176:179], v[40:43], v[64:67], v[176:179]
 ds_read_b64_tr_b16 v[34:35], v10 offset:35072
 s_add_u32 m0, s50, 65536
 s_add_u32 s46, s90, 1835008
 buffer_load_dwordx4 v96, s[24:27], s46 offen offset:0 lds
 v_mfma_f32_16x16x32_bf16 v[180:183], v[40:43], v[68:71], v[180:183]
 ds_read_b64_tr_b16 v[36:37], v11 offset:33024
 v_mfma_f32_16x16x32_bf16 v[184:187], v[44:47], v[64:67], v[184:187]
 ds_read_b64_tr_b16 v[38:39], v11 offset:35072
 v_mfma_f32_16x16x32_bf16 v[188:191], v[44:47], v[68:71], v[188:191]
 ds_read_b64_tr_b16 v[40:41], v208 offset:33024
 v_mfma_f32_16x16x32_bf16 v[192:195], v[240:243], v[64:67], v[192:195]
 ds_read_b64_tr_b16 v[42:43], v208 offset:35072
 buffer_load_dwordx4 v97, s[24:27], s46 offen offset:1024 lds
 v_mfma_f32_16x16x32_bf16 v[196:199], v[240:243], v[68:71], v[196:199]
 ds_read_b64_tr_b16 v[44:45], v209 offset:33024
 v_mfma_f32_16x16x32_bf16 v[200:203], v[244:247], v[64:67], v[200:203]
 ds_read_b64_tr_b16 v[46:47], v209 offset:35072
 v_mfma_f32_16x16x32_bf16 v[204:207], v[244:247], v[68:71], v[204:207]
 ds_read_b64_tr_b16 v[240:241], v210 offset:33024
 s_waitcnt lgkmcnt(5)
 v_mfma_f32_16x16x32_bf16 a[0:3], v[24:27], v[72:75], a[0:3]
 ds_read_b64_tr_b16 v[242:243], v210 offset:35072
 buffer_load_dwordx4 v98, s[24:27], s46 offen offset:2048 lds
 v_mfma_f32_16x16x32_bf16 a[4:7], v[24:27], v[76:79], a[4:7]
 ds_read_b64_tr_b16 v[244:245], v211 offset:33024
 v_mfma_f32_16x16x32_bf16 a[8:11], v[28:31], v[72:75], a[8:11]
 ds_read_b64_tr_b16 v[246:247], v211 offset:35072
 v_mfma_f32_16x16x32_bf16 a[12:15], v[28:31], v[76:79], a[12:15]
 v_add_u32 v6, 65536, v6
 ds_read_b64_tr_b16 v[24:25], v6 offset:0
 v_mfma_f32_16x16x32_bf16 a[16:19], v[32:35], v[72:75], a[16:19]
 ds_read_b64_tr_b16 v[26:27], v6 offset:2048
 buffer_load_dwordx4 v99, s[24:27], s46 offen offset:3072 lds
 v_mfma_f32_16x16x32_bf16 a[20:23], v[32:35], v[76:79], a[20:23]
 v_add_u32 v7, 65536, v7
 ds_read_b64_tr_b16 v[28:29], v7 offset:0
 v_mfma_f32_16x16x32_bf16 a[24:27], v[36:39], v[72:75], a[24:27]
 ds_read_b64_tr_b16 v[30:31], v7 offset:2048
 v_mfma_f32_16x16x32_bf16 a[28:31], v[36:39], v[76:79], a[28:31]
 v_add_u32 v10, 65536, v10
 ds_read_b64_tr_b16 v[32:33], v10 offset:0
 s_add_u32 m0, s50, 114688
 s_add_u32 s46, s90, 1835520
 s_waitcnt lgkmcnt(5)
 v_mfma_f32_16x16x32_bf16 a[32:35], v[40:43], v[72:75], a[32:35]
 ds_read_b64_tr_b16 v[34:35], v10 offset:2048
 buffer_load_dwordx4 v96, s[24:27], s46 offen offset:0 lds
 v_mfma_f32_16x16x32_bf16 a[36:39], v[40:43], v[76:79], a[36:39]
 v_add_u32 v11, 65536, v11
 ds_read_b64_tr_b16 v[36:37], v11 offset:0
 v_mfma_f32_16x16x32_bf16 a[40:43], v[44:47], v[72:75], a[40:43]
 ds_read_b64_tr_b16 v[38:39], v11 offset:2048
 v_mfma_f32_16x16x32_bf16 a[44:47], v[44:47], v[76:79], a[44:47]
 v_add_u32 v208, 65536, v208
 ds_read_b64_tr_b16 v[40:41], v208 offset:0
 v_mfma_f32_16x16x32_bf16 a[48:51], v[240:243], v[72:75], a[48:51]
 ds_read_b64_tr_b16 v[42:43], v208 offset:2048
 buffer_load_dwordx4 v97, s[24:27], s46 offen offset:1024 lds
 v_mfma_f32_16x16x32_bf16 a[52:55], v[240:243], v[76:79], a[52:55]
 v_add_u32 v209, 65536, v209
 ds_read_b64_tr_b16 v[44:45], v209 offset:0
 v_mfma_f32_16x16x32_bf16 a[56:59], v[244:247], v[72:75], a[56:59]
 ds_read_b64_tr_b16 v[46:47], v209 offset:2048
 v_mfma_f32_16x16x32_bf16 a[60:63], v[244:247], v[76:79], a[60:63]
 v_add_u32 v210, 65536, v210
 ds_read_b64_tr_b16 v[240:241], v210 offset:0
 s_waitcnt lgkmcnt(5)
 v_mfma_f32_16x16x32_bf16 a[64:67], v[24:27], v[72:75], a[64:67]
 ds_read_b64_tr_b16 v[242:243], v210 offset:2048
 buffer_load_dwordx4 v98, s[24:27], s46 offen offset:2048 lds
 v_mfma_f32_16x16x32_bf16 a[68:71], v[24:27], v[76:79], a[68:71]
 v_add_u32 v211, 65536, v211
 ds_read_b64_tr_b16 v[244:245], v211 offset:0
 v_mfma_f32_16x16x32_bf16 a[72:75], v[28:31], v[72:75], a[72:75]
 ds_read_b64_tr_b16 v[246:247], v211 offset:2048
 v_mfma_f32_16x16x32_bf16 a[76:79], v[28:31], v[76:79], a[76:79]
 v_add_u32 v6, 4294934528, v6
 ds_read_b64_tr_b16 v[24:25], v6 offset:0
 v_mfma_f32_16x16x32_bf16 a[80:83], v[32:35], v[72:75], a[80:83]
 ds_read_b64_tr_b16 v[26:27], v6 offset:2048
 buffer_load_dwordx4 v99, s[24:27], s46 offen offset:3072 lds
 v_mfma_f32_16x16x32_bf16 a[84:87], v[32:35], v[76:79], a[84:87]
 v_add_u32 v7, 4294934528, v7
 ds_read_b64_tr_b16 v[28:29], v7 offset:0
 v_mfma_f32_16x16x32_bf16 a[88:91], v[36:39], v[72:75], a[88:91]
 ds_read_b64_tr_b16 v[30:31], v7 offset:2048
 v_mfma_f32_16x16x32_bf16 a[92:95], v[36:39], v[76:79], a[92:95]
 v_add_u32 v10, 4294934528, v10
 ds_read_b64_tr_b16 v[32:33], v10 offset:0
 s_waitcnt lgkmcnt(5)
 v_mfma_f32_16x16x32_bf16 a[96:99], v[40:43], v[72:75], a[96:99]
 ds_read_b64_tr_b16 v[34:35], v10 offset:2048
 v_mfma_f32_16x16x32_bf16 a[100:103], v[40:43], v[76:79], a[100:103]
 v_add_u32 v11, 4294934528, v11
 ds_read_b64_tr_b16 v[36:37], v11 offset:0
 v_mfma_f32_16x16x32_bf16 a[104:107], v[44:47], v[72:75], a[104:107]
 ds_read_b64_tr_b16 v[38:39], v11 offset:2048
 v_mfma_f32_16x16x32_bf16 a[108:111], v[44:47], v[76:79], a[108:111]
 v_add_u32 v208, 4294934528, v208
 ds_read_b64_tr_b16 v[40:41], v208 offset:0
 v_mfma_f32_16x16x32_bf16 a[112:115], v[240:243], v[72:75], a[112:115]
 ds_read_b64_tr_b16 v[42:43], v208 offset:2048
 v_mfma_f32_16x16x32_bf16 a[116:119], v[240:243], v[76:79], a[116:119]
 v_add_u32 v209, 4294934528, v209
 ds_read_b64_tr_b16 v[44:45], v209 offset:0
 v_mfma_f32_16x16x32_bf16 a[120:123], v[244:247], v[72:75], a[120:123]
 ds_read_b64_tr_b16 v[46:47], v209 offset:2048
 v_mfma_f32_16x16x32_bf16 a[124:127], v[244:247], v[76:79], a[124:127]
 v_add_u32 v210, 4294934528, v210
 ds_read_b64_tr_b16 v[240:241], v210 offset:0
 s_waitcnt lgkmcnt(5)
 v_mfma_f32_16x16x32_bf16 v[144:147], v[24:27], v[72:75], v[144:147]
 ds_read_b64_tr_b16 v[242:243], v210 offset:2048
 v_mfma_f32_16x16x32_bf16 v[148:151], v[24:27], v[76:79], v[148:151]
 v_add_u32 v211, 4294934528, v211
 ds_read_b64_tr_b16 v[244:245], v211 offset:0
 v_mfma_f32_16x16x32_bf16 v[152:155], v[28:31], v[72:75], v[152:155]
 ds_read_b64_tr_b16 v[246:247], v211 offset:2048
 v_mfma_f32_16x16x32_bf16 v[156:159], v[28:31], v[76:79], v[156:159]
 v_mfma_f32_16x16x32_bf16 v[160:163], v[32:35], v[72:75], v[160:163]
 v_mfma_f32_16x16x32_bf16 v[164:167], v[32:35], v[76:79], v[164:167]
 v_mfma_f32_16x16x32_bf16 v[168:171], v[36:39], v[72:75], v[168:171]
 v_mfma_f32_16x16x32_bf16 v[172:175], v[36:39], v[76:79], v[172:175]
 s_waitcnt vmcnt(8) lgkmcnt(0)
 s_barrier
 v_add_u32 v4, 4294852608, v4
 ds_read_b128 v[80:83], v4 offset:0
 ds_read_b128 v[84:87], v4 offset:2048
 v_add_u32 v6, 4294918144, v6
 ds_read_b64_tr_b16 v[24:25], v6 offset:256
 v_add_u32 v7, 4294918144, v7
 ds_read_b64_tr_b16 v[28:29], v7 offset:256
 ds_read_b64_tr_b16 v[26:27], v6 offset:2304
 v_add_u32 v10, 4294918144, v10
 ds_read_b64_tr_b16 v[32:33], v10 offset:256
 ds_read_b64_tr_b16 v[30:31], v7 offset:2304
 v_mfma_f32_16x16x32_bf16 v[176:179], v[40:43], v[72:75], v[176:179]
 ds_read_b64_tr_b16 v[34:35], v10 offset:2304
 s_add_u32 m0, s50, 98304
 s_add_u32 s46, s90, 2097152
 buffer_load_dwordx4 v96, s[24:27], s46 offen offset:0 lds
 v_mfma_f32_16x16x32_bf16 v[180:183], v[40:43], v[76:79], v[180:183]
 v_add_u32 v11, 4294918144, v11
 ds_read_b64_tr_b16 v[36:37], v11 offset:256
 v_mfma_f32_16x16x32_bf16 v[184:187], v[44:47], v[72:75], v[184:187]
 ds_read_b64_tr_b16 v[38:39], v11 offset:2304
 buffer_load_dwordx4 v97, s[24:27], s46 offen offset:1024 lds
 v_mfma_f32_16x16x32_bf16 v[188:191], v[44:47], v[76:79], v[188:191]
 v_add_u32 v208, 4294918144, v208
 ds_read_b64_tr_b16 v[40:41], v208 offset:256
 v_mfma_f32_16x16x32_bf16 v[192:195], v[240:243], v[72:75], v[192:195]
 ds_read_b64_tr_b16 v[42:43], v208 offset:2304
 v_mfma_f32_16x16x32_bf16 v[196:199], v[240:243], v[76:79], v[196:199]
 v_add_u32 v209, 4294918144, v209
 ds_read_b64_tr_b16 v[44:45], v209 offset:256
 v_mfma_f32_16x16x32_bf16 v[200:203], v[244:247], v[72:75], v[200:203]
 ds_read_b64_tr_b16 v[46:47], v209 offset:2304
 buffer_load_dwordx4 v98, s[24:27], s46 offen offset:2048 lds
 v_mfma_f32_16x16x32_bf16 v[204:207], v[244:247], v[76:79], v[204:207]
 v_add_u32 v210, 4294918144, v210
 ds_read_b64_tr_b16 v[240:241], v210 offset:256
 s_waitcnt lgkmcnt(5)
 v_mfma_f32_16x16x32_bf16 a[0:3], v[24:27], v[80:83], a[0:3]
 ds_read_b64_tr_b16 v[242:243], v210 offset:2304
 v_mfma_f32_16x16x32_bf16 a[4:7], v[24:27], v[84:87], a[4:7]
 v_add_u32 v211, 4294918144, v211
 ds_read_b64_tr_b16 v[244:245], v211 offset:256
 v_mfma_f32_16x16x32_bf16 a[8:11], v[28:31], v[80:83], a[8:11]
 ds_read_b64_tr_b16 v[246:247], v211 offset:2304
 buffer_load_dwordx4 v99, s[24:27], s46 offen offset:3072 lds
 v_mfma_f32_16x16x32_bf16 a[12:15], v[28:31], v[84:87], a[12:15]
 ds_read_b64_tr_b16 v[24:25], v6 offset:32768
 v_mfma_f32_16x16x32_bf16 a[16:19], v[32:35], v[80:83], a[16:19]
 ds_read_b64_tr_b16 v[26:27], v6 offset:34816
 v_mfma_f32_16x16x32_bf16 a[20:23], v[32:35], v[84:87], a[20:23]
 ds_read_b64_tr_b16 v[28:29], v7 offset:32768
 s_add_u32 m0, s50, 131072
 s_add_u32 s46, s90, 2097664
 v_mfma_f32_16x16x32_bf16 a[24:27], v[36:39], v[80:83], a[24:27]
 ds_read_b64_tr_b16 v[30:31], v7 offset:34816
 buffer_load_dwordx4 v96, s[24:27], s46 offen offset:0 lds
 v_mfma_f32_16x16x32_bf16 a[28:31], v[36:39], v[84:87], a[28:31]
 ds_read_b64_tr_b16 v[32:33], v10 offset:32768
 s_waitcnt lgkmcnt(5)
 v_mfma_f32_16x16x32_bf16 a[32:35], v[40:43], v[80:83], a[32:35]
 ds_read_b64_tr_b16 v[34:35], v10 offset:34816
 v_mfma_f32_16x16x32_bf16 a[36:39], v[40:43], v[84:87], a[36:39]
 ds_read_b64_tr_b16 v[36:37], v11 offset:32768
 v_mfma_f32_16x16x32_bf16 a[40:43], v[44:47], v[80:83], a[40:43]
 ds_read_b64_tr_b16 v[38:39], v11 offset:34816
 buffer_load_dwordx4 v97, s[24:27], s46 offen offset:1024 lds
 v_mfma_f32_16x16x32_bf16 a[44:47], v[44:47], v[84:87], a[44:47]
 ds_read_b64_tr_b16 v[40:41], v208 offset:32768
 v_mfma_f32_16x16x32_bf16 a[48:51], v[240:243], v[80:83], a[48:51]
 ds_read_b64_tr_b16 v[42:43], v208 offset:34816
 v_mfma_f32_16x16x32_bf16 a[52:55], v[240:243], v[84:87], a[52:55]
 ds_read_b64_tr_b16 v[44:45], v209 offset:32768
 v_mfma_f32_16x16x32_bf16 a[56:59], v[244:247], v[80:83], a[56:59]
 ds_read_b64_tr_b16 v[46:47], v209 offset:34816
 buffer_load_dwordx4 v98, s[24:27], s46 offen offset:2048 lds
 v_mfma_f32_16x16x32_bf16 a[60:63], v[244:247], v[84:87], a[60:63]
 ds_read_b64_tr_b16 v[240:241], v210 offset:32768
 s_waitcnt lgkmcnt(5)
 v_mfma_f32_16x16x32_bf16 a[64:67], v[24:27], v[80:83], a[64:67]
 ds_read_b64_tr_b16 v[242:243], v210 offset:34816
 v_mfma_f32_16x16x32_bf16 a[68:71], v[24:27], v[84:87], a[68:71]
 ds_read_b64_tr_b16 v[244:245], v211 offset:32768
 v_mfma_f32_16x16x32_bf16 a[72:75], v[28:31], v[80:83], a[72:75]
 ds_read_b64_tr_b16 v[246:247], v211 offset:34816
 buffer_load_dwordx4 v99, s[24:27], s46 offen offset:3072 lds
 v_mfma_f32_16x16x32_bf16 a[76:79], v[28:31], v[84:87], a[76:79]
 ds_read_b64_tr_b16 v[24:25], v6 offset:0
 v_mfma_f32_16x16x32_bf16 a[80:83], v[32:35], v[80:83], a[80:83]
 ds_read_b64_tr_b16 v[26:27], v6 offset:2048
 v_mfma_f32_16x16x32_bf16 a[84:87], v[32:35], v[84:87], a[84:87]
 ds_read_b64_tr_b16 v[28:29], v7 offset:0
 s_add_u32 m0, s50, 147456
 s_add_u32 s46, s91, 512
 v_mfma_f32_16x16x32_bf16 a[88:91], v[36:39], v[80:83], a[88:91]
 ds_read_b64_tr_b16 v[30:31], v7 offset:2048
 buffer_load_dwordx4 v100, s[32:35], s46 offen offset:0 lds
 v_mfma_f32_16x16x32_bf16 a[92:95], v[36:39], v[84:87], a[92:95]
 ds_read_b64_tr_b16 v[32:33], v10 offset:0
 s_waitcnt lgkmcnt(5)
 v_mfma_f32_16x16x32_bf16 a[96:99], v[40:43], v[80:83], a[96:99]
 ds_read_b64_tr_b16 v[34:35], v10 offset:2048
 v_mfma_f32_16x16x32_bf16 a[100:103], v[40:43], v[84:87], a[100:103]
 ds_read_b64_tr_b16 v[36:37], v11 offset:0
 v_mfma_f32_16x16x32_bf16 a[104:107], v[44:47], v[80:83], a[104:107]
 ds_read_b64_tr_b16 v[38:39], v11 offset:2048
 buffer_load_dwordx4 v101, s[32:35], s46 offen offset:1024 lds
 v_mfma_f32_16x16x32_bf16 a[108:111], v[44:47], v[84:87], a[108:111]
 ds_read_b64_tr_b16 v[40:41], v208 offset:0
 v_mfma_f32_16x16x32_bf16 a[112:115], v[240:243], v[80:83], a[112:115]
 ds_read_b64_tr_b16 v[42:43], v208 offset:2048
 v_mfma_f32_16x16x32_bf16 a[116:119], v[240:243], v[84:87], a[116:119]
 ds_read_b64_tr_b16 v[44:45], v209 offset:0
 v_mfma_f32_16x16x32_bf16 a[120:123], v[244:247], v[80:83], a[120:123]
 ds_read_b64_tr_b16 v[46:47], v209 offset:2048
 buffer_load_dwordx4 v102, s[32:35], s46 offen offset:2048 lds
 v_mfma_f32_16x16x32_bf16 a[124:127], v[244:247], v[84:87], a[124:127]
 ds_read_b64_tr_b16 v[240:241], v210 offset:0
 s_waitcnt lgkmcnt(5)
 v_mfma_f32_16x16x32_bf16 v[144:147], v[24:27], v[80:83], v[144:147]
 ds_read_b64_tr_b16 v[242:243], v210 offset:2048
 v_mfma_f32_16x16x32_bf16 v[148:151], v[24:27], v[84:87], v[148:151]
 ds_read_b64_tr_b16 v[244:245], v211 offset:0
 v_mfma_f32_16x16x32_bf16 v[152:155], v[28:31], v[80:83], v[152:155]
 ds_read_b64_tr_b16 v[246:247], v211 offset:2048
 buffer_load_dwordx4 v103, s[32:35], s46 offen offset:3072 lds
 v_mfma_f32_16x16x32_bf16 v[156:159], v[28:31], v[84:87], v[156:159]
 v_mfma_f32_16x16x32_bf16 v[160:163], v[32:35], v[80:83], v[160:163]
 v_mfma_f32_16x16x32_bf16 v[164:167], v[32:35], v[84:87], v[164:167]
 v_mfma_f32_16x16x32_bf16 v[168:171], v[36:39], v[80:83], v[168:171]
 v_mfma_f32_16x16x32_bf16 v[172:175], v[36:39], v[84:87], v[172:175]
 s_waitcnt vmcnt(12) lgkmcnt(0)
 s_barrier
 v_add_u32 v5, 4294852608, v5
 ds_read_b128 v[88:91], v5 offset:0
 ds_read_b128 v[92:95], v5 offset:2048
 ds_read_b64_tr_b16 v[24:25], v6 offset:16640
 ds_read_b64_tr_b16 v[28:29], v7 offset:16640
 ds_read_b64_tr_b16 v[26:27], v6 offset:18688
 ds_read_b64_tr_b16 v[32:33], v10 offset:16640
 ds_read_b64_tr_b16 v[30:31], v7 offset:18688
 v_mfma_f32_16x16x32_bf16 v[176:179], v[40:43], v[80:83], v[176:179]
 ds_read_b64_tr_b16 v[34:35], v10 offset:18688
 s_add_u32 m0, s50, 49152
 s_add_u32 s46, s90, 2359296
 buffer_load_dwordx4 v96, s[24:27], s46 offen offset:0 lds
 v_mfma_f32_16x16x32_bf16 v[180:183], v[40:43], v[84:87], v[180:183]
 ds_read_b64_tr_b16 v[36:37], v11 offset:16640
 v_mfma_f32_16x16x32_bf16 v[184:187], v[44:47], v[80:83], v[184:187]
 ds_read_b64_tr_b16 v[38:39], v11 offset:18688
 v_mfma_f32_16x16x32_bf16 v[188:191], v[44:47], v[84:87], v[188:191]
 ds_read_b64_tr_b16 v[40:41], v208 offset:16640
 v_mfma_f32_16x16x32_bf16 v[192:195], v[240:243], v[80:83], v[192:195]
 ds_read_b64_tr_b16 v[42:43], v208 offset:18688
 buffer_load_dwordx4 v97, s[24:27], s46 offen offset:1024 lds
 v_mfma_f32_16x16x32_bf16 v[196:199], v[240:243], v[84:87], v[196:199]
 ds_read_b64_tr_b16 v[44:45], v209 offset:16640
 v_mfma_f32_16x16x32_bf16 v[200:203], v[244:247], v[80:83], v[200:203]
 ds_read_b64_tr_b16 v[46:47], v209 offset:18688
 v_mfma_f32_16x16x32_bf16 v[204:207], v[244:247], v[84:87], v[204:207]
 ds_read_b64_tr_b16 v[240:241], v210 offset:16640
 s_waitcnt lgkmcnt(5)
 v_mfma_f32_16x16x32_bf16 a[0:3], v[24:27], v[88:91], a[0:3]
 ds_read_b64_tr_b16 v[242:243], v210 offset:18688
 buffer_load_dwordx4 v98, s[24:27], s46 offen offset:2048 lds
 v_mfma_f32_16x16x32_bf16 a[4:7], v[24:27], v[92:95], a[4:7]
 ds_read_b64_tr_b16 v[244:245], v211 offset:16640
 v_mfma_f32_16x16x32_bf16 a[8:11], v[28:31], v[88:91], a[8:11]
 ds_read_b64_tr_b16 v[246:247], v211 offset:18688
 v_mfma_f32_16x16x32_bf16 a[12:15], v[28:31], v[92:95], a[12:15]
 v_add_u32 v6, 65536, v6
 ds_read_b64_tr_b16 v[24:25], v6 offset:0
 v_mfma_f32_16x16x32_bf16 a[16:19], v[32:35], v[88:91], a[16:19]
 ds_read_b64_tr_b16 v[26:27], v6 offset:2048
 buffer_load_dwordx4 v99, s[24:27], s46 offen offset:3072 lds
 v_mfma_f32_16x16x32_bf16 a[20:23], v[32:35], v[92:95], a[20:23]
 v_add_u32 v7, 65536, v7
 ds_read_b64_tr_b16 v[28:29], v7 offset:0
 v_mfma_f32_16x16x32_bf16 a[24:27], v[36:39], v[88:91], a[24:27]
 ds_read_b64_tr_b16 v[30:31], v7 offset:2048
 v_mfma_f32_16x16x32_bf16 a[28:31], v[36:39], v[92:95], a[28:31]
 v_add_u32 v10, 65536, v10
 ds_read_b64_tr_b16 v[32:33], v10 offset:0
 s_add_u32 m0, s50, 81920
 s_add_u32 s46, s90, 2359808
 s_waitcnt lgkmcnt(5)
 v_mfma_f32_16x16x32_bf16 a[32:35], v[40:43], v[88:91], a[32:35]
 ds_read_b64_tr_b16 v[34:35], v10 offset:2048
 buffer_load_dwordx4 v96, s[24:27], s46 offen offset:0 lds
 v_mfma_f32_16x16x32_bf16 a[36:39], v[40:43], v[92:95], a[36:39]
 v_add_u32 v11, 65536, v11
 ds_read_b64_tr_b16 v[36:37], v11 offset:0
 v_mfma_f32_16x16x32_bf16 a[40:43], v[44:47], v[88:91], a[40:43]
 ds_read_b64_tr_b16 v[38:39], v11 offset:2048
 v_mfma_f32_16x16x32_bf16 a[44:47], v[44:47], v[92:95], a[44:47]
 v_add_u32 v208, 65536, v208
 ds_read_b64_tr_b16 v[40:41], v208 offset:0
 v_mfma_f32_16x16x32_bf16 a[48:51], v[240:243], v[88:91], a[48:51]
 ds_read_b64_tr_b16 v[42:43], v208 offset:2048
 buffer_load_dwordx4 v97, s[24:27], s46 offen offset:1024 lds
 v_mfma_f32_16x16x32_bf16 a[52:55], v[240:243], v[92:95], a[52:55]
 v_add_u32 v209, 65536, v209
 ds_read_b64_tr_b16 v[44:45], v209 offset:0
 v_mfma_f32_16x16x32_bf16 a[56:59], v[244:247], v[88:91], a[56:59]
 ds_read_b64_tr_b16 v[46:47], v209 offset:2048
 v_mfma_f32_16x16x32_bf16 a[60:63], v[244:247], v[92:95], a[60:63]
 v_add_u32 v210, 65536, v210
 ds_read_b64_tr_b16 v[240:241], v210 offset:0
 s_waitcnt lgkmcnt(5)
 v_mfma_f32_16x16x32_bf16 a[64:67], v[24:27], v[88:91], a[64:67]
 ds_read_b64_tr_b16 v[242:243], v210 offset:2048
 buffer_load_dwordx4 v98, s[24:27], s46 offen offset:2048 lds
 v_mfma_f32_16x16x32_bf16 a[68:71], v[24:27], v[92:95], a[68:71]
 v_add_u32 v211, 65536, v211
 ds_read_b64_tr_b16 v[244:245], v211 offset:0
 v_mfma_f32_16x16x32_bf16 a[72:75], v[28:31], v[88:91], a[72:75]
 ds_read_b64_tr_b16 v[246:247], v211 offset:2048
 v_mfma_f32_16x16x32_bf16 a[76:79], v[28:31], v[92:95], a[76:79]
 v_add_u32 v6, 4294918144, v6
 ds_read_b64_tr_b16 v[24:25], v6 offset:0
 v_mfma_f32_16x16x32_bf16 a[80:83], v[32:35], v[88:91], a[80:83]
 ds_read_b64_tr_b16 v[26:27], v6 offset:2048
 buffer_load_dwordx4 v99, s[24:27], s46 offen offset:3072 lds
 v_mfma_f32_16x16x32_bf16 a[84:87], v[32:35], v[92:95], a[84:87]
 v_add_u32 v7, 4294918144, v7
 ds_read_b64_tr_b16 v[28:29], v7 offset:0
 v_mfma_f32_16x16x32_bf16 a[88:91], v[36:39], v[88:91], a[88:91]
 ds_read_b64_tr_b16 v[30:31], v7 offset:2048
 v_mfma_f32_16x16x32_bf16 a[92:95], v[36:39], v[92:95], a[92:95]
 v_add_u32 v10, 4294918144, v10
 ds_read_b64_tr_b16 v[32:33], v10 offset:0
 s_waitcnt lgkmcnt(5)
 v_mfma_f32_16x16x32_bf16 a[96:99], v[40:43], v[88:91], a[96:99]
 ds_read_b64_tr_b16 v[34:35], v10 offset:2048
 v_mfma_f32_16x16x32_bf16 a[100:103], v[40:43], v[92:95], a[100:103]
 v_add_u32 v11, 4294918144, v11
 ds_read_b64_tr_b16 v[36:37], v11 offset:0
 v_mfma_f32_16x16x32_bf16 a[104:107], v[44:47], v[88:91], a[104:107]
 ds_read_b64_tr_b16 v[38:39], v11 offset:2048
 v_mfma_f32_16x16x32_bf16 a[108:111], v[44:47], v[92:95], a[108:111]
 v_add_u32 v208, 4294918144, v208
 ds_read_b64_tr_b16 v[40:41], v208 offset:0
 v_mfma_f32_16x16x32_bf16 a[112:115], v[240:243], v[88:91], a[112:115]
 ds_read_b64_tr_b16 v[42:43], v208 offset:2048
 v_mfma_f32_16x16x32_bf16 a[116:119], v[240:243], v[92:95], a[116:119]
 v_add_u32 v209, 4294918144, v209
 ds_read_b64_tr_b16 v[44:45], v209 offset:0
 v_mfma_f32_16x16x32_bf16 a[120:123], v[244:247], v[88:91], a[120:123]
 ds_read_b64_tr_b16 v[46:47], v209 offset:2048
 v_mfma_f32_16x16x32_bf16 a[124:127], v[244:247], v[92:95], a[124:127]
 v_add_u32 v210, 4294918144, v210
 ds_read_b64_tr_b16 v[240:241], v210 offset:0
 s_waitcnt lgkmcnt(5)
 v_mfma_f32_16x16x32_bf16 v[144:147], v[24:27], v[88:91], v[144:147]
 ds_read_b64_tr_b16 v[242:243], v210 offset:2048
 v_mfma_f32_16x16x32_bf16 v[148:151], v[24:27], v[92:95], v[148:151]
 v_add_u32 v211, 4294918144, v211
 ds_read_b64_tr_b16 v[244:245], v211 offset:0
 v_mfma_f32_16x16x32_bf16 v[152:155], v[28:31], v[88:91], v[152:155]
 ds_read_b64_tr_b16 v[246:247], v211 offset:2048
 v_mfma_f32_16x16x32_bf16 v[156:159], v[28:31], v[92:95], v[156:159]
 v_mfma_f32_16x16x32_bf16 v[160:163], v[32:35], v[88:91], v[160:163]
 v_mfma_f32_16x16x32_bf16 v[164:167], v[32:35], v[92:95], v[164:167]
 v_mfma_f32_16x16x32_bf16 v[168:171], v[36:39], v[88:91], v[168:171]
 v_mfma_f32_16x16x32_bf16 v[172:175], v[36:39], v[92:95], v[172:175]
 s_waitcnt vmcnt(8) lgkmcnt(0)
 s_barrier
 v_add_u32 v4, 114688, v4
 ds_read_b128 v[64:67], v4 offset:0
 ds_read_b128 v[68:71], v4 offset:2048
 ds_read_b64_tr_b16 v[24:25], v6 offset:33024
 ds_read_b64_tr_b16 v[28:29], v7 offset:33024
 ds_read_b64_tr_b16 v[26:27], v6 offset:35072
 ds_read_b64_tr_b16 v[32:33], v10 offset:33024
 ds_read_b64_tr_b16 v[30:31], v7 offset:35072
 v_mfma_f32_16x16x32_bf16 v[176:179], v[40:43], v[88:91], v[176:179]
 ds_read_b64_tr_b16 v[34:35], v10 offset:35072
 s_add_u32 m0, s50, 65536
 s_add_u32 s46, s90, 2621440
 buffer_load_dwordx4 v96, s[24:27], s46 offen offset:0 lds
 v_mfma_f32_16x16x32_bf16 v[180:183], v[40:43], v[92:95], v[180:183]
 ds_read_b64_tr_b16 v[36:37], v11 offset:33024
 v_mfma_f32_16x16x32_bf16 v[184:187], v[44:47], v[88:91], v[184:187]
 ds_read_b64_tr_b16 v[38:39], v11 offset:35072
 buffer_load_dwordx4 v97, s[24:27], s46 offen offset:1024 lds
 v_mfma_f32_16x16x32_bf16 v[188:191], v[44:47], v[92:95], v[188:191]
 ds_read_b64_tr_b16 v[40:41], v208 offset:33024
 v_mfma_f32_16x16x32_bf16 v[192:195], v[240:243], v[88:91], v[192:195]
 ds_read_b64_tr_b16 v[42:43], v208 offset:35072
 v_mfma_f32_16x16x32_bf16 v[196:199], v[240:243], v[92:95], v[196:199]
 ds_read_b64_tr_b16 v[44:45], v209 offset:33024
 v_mfma_f32_16x16x32_bf16 v[200:203], v[244:247], v[88:91], v[200:203]
 ds_read_b64_tr_b16 v[46:47], v209 offset:35072
 buffer_load_dwordx4 v98, s[24:27], s46 offen offset:2048 lds
 v_mfma_f32_16x16x32_bf16 v[204:207], v[244:247], v[92:95], v[204:207]
 ds_read_b64_tr_b16 v[240:241], v210 offset:33024
 s_waitcnt lgkmcnt(5)
 v_mfma_f32_16x16x32_bf16 a[0:3], v[24:27], v[64:67], a[0:3]
 ds_read_b64_tr_b16 v[242:243], v210 offset:35072
 v_mfma_f32_16x16x32_bf16 a[4:7], v[24:27], v[68:71], a[4:7]
 ds_read_b64_tr_b16 v[244:245], v211 offset:33024
 v_mfma_f32_16x16x32_bf16 a[8:11], v[28:31], v[64:67], a[8:11]
 ds_read_b64_tr_b16 v[246:247], v211 offset:35072
 buffer_load_dwordx4 v99, s[24:27], s46 offen offset:3072 lds
 v_mfma_f32_16x16x32_bf16 a[12:15], v[28:31], v[68:71], a[12:15]
 v_add_u32 v6, 65536, v6
 ds_read_b64_tr_b16 v[24:25], v6 offset:0
 v_mfma_f32_16x16x32_bf16 a[16:19], v[32:35], v[64:67], a[16:19]
 ds_read_b64_tr_b16 v[26:27], v6 offset:2048
 v_mfma_f32_16x16x32_bf16 a[20:23], v[32:35], v[68:71], a[20:23]
 v_add_u32 v7, 65536, v7
 ds_read_b64_tr_b16 v[28:29], v7 offset:0
 s_add_u32 m0, s50, 114688
 s_add_u32 s46, s90, 2621952
 v_mfma_f32_16x16x32_bf16 a[24:27], v[36:39], v[64:67], a[24:27]
 ds_read_b64_tr_b16 v[30:31], v7 offset:2048
 buffer_load_dwordx4 v96, s[24:27], s46 offen offset:0 lds
 v_mfma_f32_16x16x32_bf16 a[28:31], v[36:39], v[68:71], a[28:31]
 v_add_u32 v10, 65536, v10
 ds_read_b64_tr_b16 v[32:33], v10 offset:0
 s_waitcnt lgkmcnt(5)
 v_mfma_f32_16x16x32_bf16 a[32:35], v[40:43], v[64:67], a[32:35]
 ds_read_b64_tr_b16 v[34:35], v10 offset:2048
 buffer_load_dwordx4 v97, s[24:27], s46 offen offset:1024 lds
 v_mfma_f32_16x16x32_bf16 a[36:39], v[40:43], v[68:71], a[36:39]
 v_add_u32 v11, 65536, v11
 ds_read_b64_tr_b16 v[36:37], v11 offset:0
 v_mfma_f32_16x16x32_bf16 a[40:43], v[44:47], v[64:67], a[40:43]
 ds_read_b64_tr_b16 v[38:39], v11 offset:2048
 v_mfma_f32_16x16x32_bf16 a[44:47], v[44:47], v[68:71], a[44:47]
 v_add_u32 v208, 65536, v208
 ds_read_b64_tr_b16 v[40:41], v208 offset:0
 v_mfma_f32_16x16x32_bf16 a[48:51], v[240:243], v[64:67], a[48:51]
 ds_read_b64_tr_b16 v[42:43], v208 offset:2048
 buffer_load_dwordx4 v98, s[24:27], s46 offen offset:2048 lds
 v_mfma_f32_16x16x32_bf16 a[52:55], v[240:243], v[68:71], a[52:55]
 v_add_u32 v209, 65536, v209
 ds_read_b64_tr_b16 v[44:45], v209 offset:0
 v_mfma_f32_16x16x32_bf16 a[56:59], v[244:247], v[64:67], a[56:59]
 ds_read_b64_tr_b16 v[46:47], v209 offset:2048
 v_mfma_f32_16x16x32_bf16 a[60:63], v[244:247], v[68:71], a[60:63]
 v_add_u32 v210, 65536, v210
 ds_read_b64_tr_b16 v[240:241], v210 offset:0
 s_waitcnt lgkmcnt(5)
 v_mfma_f32_16x16x32_bf16 a[64:67], v[24:27], v[64:67], a[64:67]
 ds_read_b64_tr_b16 v[242:243], v210 offset:2048
 buffer_load_dwordx4 v99, s[24:27], s46 offen offset:3072 lds
 v_mfma_f32_16x16x32_bf16 a[68:71], v[24:27], v[68:71], a[68:71]
 v_add_u32 v211, 65536, v211
 ds_read_b64_tr_b16 v[244:245], v211 offset:0
 v_mfma_f32_16x16x32_bf16 a[72:75], v[28:31], v[64:67], a[72:75]
 ds_read_b64_tr_b16 v[246:247], v211 offset:2048
 v_mfma_f32_16x16x32_bf16 a[76:79], v[28:31], v[68:71], a[76:79]
 v_add_u32 v6, 4294934528, v6
 ds_read_b64_tr_b16 v[24:25], v6 offset:0
 s_add_u32 m0, s50, 32768
 s_add_u32 s46, s91, 640
 v_mfma_f32_16x16x32_bf16 a[80:83], v[32:35], v[64:67], a[80:83]
 ds_read_b64_tr_b16 v[26:27], v6 offset:2048
 buffer_load_dwordx4 v100, s[32:35], s46 offen offset:0 lds
 v_mfma_f32_16x16x32_bf16 a[84:87], v[32:35], v[68:71], a[84:87]
 v_add_u32 v7, 4294934528, v7
 ds_read_b64_tr_b16 v[28:29], v7 offset:0
 v_mfma_f32_16x16x32_bf16 a[88:91], v[36:39], v[64:67], a[88:91]
 ds_read_b64_tr_b16 v[30:31], v7 offset:2048
 buffer_load_dwordx4 v101, s[32:35], s46 offen offset:1024 lds
 v_mfma_f32_16x16x32_bf16 a[92:95], v[36:39], v[68:71], a[92:95]
 v_add_u32 v10, 4294934528, v10
 ds_read_b64_tr_b16 v[32:33], v10 offset:0
 s_waitcnt lgkmcnt(5)
 v_mfma_f32_16x16x32_bf16 a[96:99], v[40:43], v[64:67], a[96:99]
 ds_read_b64_tr_b16 v[34:35], v10 offset:2048
 v_mfma_f32_16x16x32_bf16 a[100:103], v[40:43], v[68:71], a[100:103]
 v_add_u32 v11, 4294934528, v11
 ds_read_b64_tr_b16 v[36:37], v11 offset:0
 v_mfma_f32_16x16x32_bf16 a[104:107], v[44:47], v[64:67], a[104:107]
 ds_read_b64_tr_b16 v[38:39], v11 offset:2048
 buffer_load_dwordx4 v102, s[32:35], s46 offen offset:2048 lds
 v_mfma_f32_16x16x32_bf16 a[108:111], v[44:47], v[68:71], a[108:111]
 v_add_u32 v208, 4294934528, v208
 ds_read_b64_tr_b16 v[40:41], v208 offset:0
 v_mfma_f32_16x16x32_bf16 a[112:115], v[240:243], v[64:67], a[112:115]
 ds_read_b64_tr_b16 v[42:43], v208 offset:2048
 v_mfma_f32_16x16x32_bf16 a[116:119], v[240:243], v[68:71], a[116:119]
 v_add_u32 v209, 4294934528, v209
 ds_read_b64_tr_b16 v[44:45], v209 offset:0
 v_mfma_f32_16x16x32_bf16 a[120:123], v[244:247], v[64:67], a[120:123]
 ds_read_b64_tr_b16 v[46:47], v209 offset:2048
 buffer_load_dwordx4 v103, s[32:35], s46 offen offset:3072 lds
 v_mfma_f32_16x16x32_bf16 a[124:127], v[244:247], v[68:71], a[124:127]
 v_add_u32 v210, 4294934528, v210
 ds_read_b64_tr_b16 v[240:241], v210 offset:0
 s_waitcnt lgkmcnt(5)
 v_mfma_f32_16x16x32_bf16 v[144:147], v[24:27], v[64:67], v[144:147]
 ds_read_b64_tr_b16 v[242:243], v210 offset:2048
 v_mfma_f32_16x16x32_bf16 v[148:151], v[24:27], v[68:71], v[148:151]
 v_add_u32 v211, 4294934528, v211
 ds_read_b64_tr_b16 v[244:245], v211 offset:0
 s_add_u32 s99, s98, 3145728
 v_mfma_f32_16x16x32_bf16 v[152:155], v[28:31], v[64:67], v[152:155]
 ds_read_b64_tr_b16 v[246:247], v211 offset:2048
 buffer_load_dword v48, v106, s[24:27], s99 offen
 v_mfma_f32_16x16x32_bf16 v[156:159], v[28:31], v[68:71], v[156:159]
 v_mfma_f32_16x16x32_bf16 v[160:163], v[32:35], v[64:67], v[160:163]
 v_mfma_f32_16x16x32_bf16 v[164:167], v[32:35], v[68:71], v[164:167]
 v_mfma_f32_16x16x32_bf16 v[168:171], v[36:39], v[64:67], v[168:171]
 v_mfma_f32_16x16x32_bf16 v[172:175], v[36:39], v[68:71], v[172:175]
 s_waitcnt vmcnt(13) lgkmcnt(0)
 s_barrier
 v_add_u32 v5, 114688, v5
 ds_read_b128 v[72:75], v5 offset:0
 ds_read_b128 v[76:79], v5 offset:2048
 v_add_u32 v6, 4294918144, v6
 ds_read_b64_tr_b16 v[24:25], v6 offset:256
 v_add_u32 v7, 4294918144, v7
 ds_read_b64_tr_b16 v[28:29], v7 offset:256
 ds_read_b64_tr_b16 v[26:27], v6 offset:2304
 v_add_u32 v10, 4294918144, v10
 ds_read_b64_tr_b16 v[32:33], v10 offset:256
 ds_read_b64_tr_b16 v[30:31], v7 offset:2304
 v_mfma_f32_16x16x32_bf16 v[176:179], v[40:43], v[64:67], v[176:179]
 ds_read_b64_tr_b16 v[34:35], v10 offset:2304
 s_add_u32 m0, s50, 98304
 s_add_u32 s46, s90, 2883584
 buffer_load_dwordx4 v96, s[24:27], s46 offen offset:0 lds
 v_mfma_f32_16x16x32_bf16 v[180:183], v[40:43], v[68:71], v[180:183]
 v_add_u32 v11, 4294918144, v11
 ds_read_b64_tr_b16 v[36:37], v11 offset:256
 v_mfma_f32_16x16x32_bf16 v[184:187], v[44:47], v[64:67], v[184:187]
 ds_read_b64_tr_b16 v[38:39], v11 offset:2304
 v_mfma_f32_16x16x32_bf16 v[188:191], v[44:47], v[68:71], v[188:191]
 v_add_u32 v208, 4294918144, v208
 ds_read_b64_tr_b16 v[40:41], v208 offset:256
 v_mfma_f32_16x16x32_bf16 v[192:195], v[240:243], v[64:67], v[192:195]
 ds_read_b64_tr_b16 v[42:43], v208 offset:2304
 buffer_load_dwordx4 v97, s[24:27], s46 offen offset:1024 lds
 v_mfma_f32_16x16x32_bf16 v[196:199], v[240:243], v[68:71], v[196:199]
 v_add_u32 v209, 4294918144, v209
 ds_read_b64_tr_b16 v[44:45], v209 offset:256
 v_mfma_f32_16x16x32_bf16 v[200:203], v[244:247], v[64:67], v[200:203]
 ds_read_b64_tr_b16 v[46:47], v209 offset:2304
 v_mfma_f32_16x16x32_bf16 v[204:207], v[244:247], v[68:71], v[204:207]
 v_add_u32 v210, 4294918144, v210
 ds_read_b64_tr_b16 v[240:241], v210 offset:256
 s_waitcnt lgkmcnt(5)
 v_mfma_f32_16x16x32_bf16 a[0:3], v[24:27], v[72:75], a[0:3]
 ds_read_b64_tr_b16 v[242:243], v210 offset:2304
 buffer_load_dwordx4 v98, s[24:27], s46 offen offset:2048 lds
 v_mfma_f32_16x16x32_bf16 a[4:7], v[24:27], v[76:79], a[4:7]
 v_add_u32 v211, 4294918144, v211
 ds_read_b64_tr_b16 v[244:245], v211 offset:256
 v_mfma_f32_16x16x32_bf16 a[8:11], v[28:31], v[72:75], a[8:11]
 ds_read_b64_tr_b16 v[246:247], v211 offset:2304
 v_mfma_f32_16x16x32_bf16 a[12:15], v[28:31], v[76:79], a[12:15]
 ds_read_b64_tr_b16 v[24:25], v6 offset:32768
 v_mfma_f32_16x16x32_bf16 a[16:19], v[32:35], v[72:75], a[16:19]
 ds_read_b64_tr_b16 v[26:27], v6 offset:34816
 buffer_load_dwordx4 v99, s[24:27], s46 offen offset:3072 lds
 v_mfma_f32_16x16x32_bf16 a[20:23], v[32:35], v[76:79], a[20:23]
 ds_read_b64_tr_b16 v[28:29], v7 offset:32768
 v_mfma_f32_16x16x32_bf16 a[24:27], v[36:39], v[72:75], a[24:27]
 ds_read_b64_tr_b16 v[30:31], v7 offset:34816
 v_mfma_f32_16x16x32_bf16 a[28:31], v[36:39], v[76:79], a[28:31]
 ds_read_b64_tr_b16 v[32:33], v10 offset:32768
 s_add_u32 m0, s50, 131072
 s_add_u32 s46, s90, 2884096
 s_waitcnt lgkmcnt(5)
 v_mfma_f32_16x16x32_bf16 a[32:35], v[40:43], v[72:75], a[32:35]
 ds_read_b64_tr_b16 v[34:35], v10 offset:34816
 buffer_load_dwordx4 v96, s[24:27], s46 offen offset:0 lds
 v_mfma_f32_16x16x32_bf16 a[36:39], v[40:43], v[76:79], a[36:39]
 ds_read_b64_tr_b16 v[36:37], v11 offset:32768
 v_mfma_f32_16x16x32_bf16 a[40:43], v[44:47], v[72:75], a[40:43]
 ds_read_b64_tr_b16 v[38:39], v11 offset:34816
 v_mfma_f32_16x16x32_bf16 a[44:47], v[44:47], v[76:79], a[44:47]
 ds_read_b64_tr_b16 v[40:41], v208 offset:32768
 v_mfma_f32_16x16x32_bf16 a[48:51], v[240:243], v[72:75], a[48:51]
 ds_read_b64_tr_b16 v[42:43], v208 offset:34816
 buffer_load_dwordx4 v97, s[24:27], s46 offen offset:1024 lds
 v_mfma_f32_16x16x32_bf16 a[52:55], v[240:243], v[76:79], a[52:55]
 ds_read_b64_tr_b16 v[44:45], v209 offset:32768
 v_mfma_f32_16x16x32_bf16 a[56:59], v[244:247], v[72:75], a[56:59]
 ds_read_b64_tr_b16 v[46:47], v209 offset:34816
 v_mfma_f32_16x16x32_bf16 a[60:63], v[244:247], v[76:79], a[60:63]
 ds_read_b64_tr_b16 v[240:241], v210 offset:32768
 s_waitcnt lgkmcnt(5)
 v_mfma_f32_16x16x32_bf16 a[64:67], v[24:27], v[72:75], a[64:67]
 ds_read_b64_tr_b16 v[242:243], v210 offset:34816
 buffer_load_dwordx4 v98, s[24:27], s46 offen offset:2048 lds
 v_mfma_f32_16x16x32_bf16 a[68:71], v[24:27], v[76:79], a[68:71]
 ds_read_b64_tr_b16 v[244:245], v211 offset:32768
 v_mfma_f32_16x16x32_bf16 a[72:75], v[28:31], v[72:75], a[72:75]
 ds_read_b64_tr_b16 v[246:247], v211 offset:34816
 v_mfma_f32_16x16x32_bf16 a[76:79], v[28:31], v[76:79], a[76:79]
 ds_read_b64_tr_b16 v[24:25], v6 offset:0
 v_mfma_f32_16x16x32_bf16 a[80:83], v[32:35], v[72:75], a[80:83]
 ds_read_b64_tr_b16 v[26:27], v6 offset:2048
 buffer_load_dwordx4 v99, s[24:27], s46 offen offset:3072 lds
 v_mfma_f32_16x16x32_bf16 a[84:87], v[32:35], v[76:79], a[84:87]
 ds_read_b64_tr_b16 v[28:29], v7 offset:0
 v_mfma_f32_16x16x32_bf16 a[88:91], v[36:39], v[72:75], a[88:91]
 ds_read_b64_tr_b16 v[30:31], v7 offset:2048
 v_mfma_f32_16x16x32_bf16 a[92:95], v[36:39], v[76:79], a[92:95]
 ds_read_b64_tr_b16 v[32:33], v10 offset:0
 s_waitcnt lgkmcnt(5)
 v_mfma_f32_16x16x32_bf16 a[96:99], v[40:43], v[72:75], a[96:99]
 ds_read_b64_tr_b16 v[34:35], v10 offset:2048
 v_mfma_f32_16x16x32_bf16 a[100:103], v[40:43], v[76:79], a[100:103]
 ds_read_b64_tr_b16 v[36:37], v11 offset:0
 v_mfma_f32_16x16x32_bf16 a[104:107], v[44:47], v[72:75], a[104:107]
 ds_read_b64_tr_b16 v[38:39], v11 offset:2048
 v_mfma_f32_16x16x32_bf16 a[108:111], v[44:47], v[76:79], a[108:111]
 ds_read_b64_tr_b16 v[40:41], v208 offset:0
 v_mfma_f32_16x16x32_bf16 a[112:115], v[240:243], v[72:75], a[112:115]
 ds_read_b64_tr_b16 v[42:43], v208 offset:2048
 v_mfma_f32_16x16x32_bf16 a[116:119], v[240:243], v[76:79], a[116:119]
 ds_read_b64_tr_b16 v[44:45], v209 offset:0
 v_mfma_f32_16x16x32_bf16 a[120:123], v[244:247], v[72:75], a[120:123]
 ds_read_b64_tr_b16 v[46:47], v209 offset:2048
 v_mfma_f32_16x16x32_bf16 a[124:127], v[244:247], v[76:79], a[124:127]
 ds_read_b64_tr_b16 v[240:241], v210 offset:0
 s_waitcnt lgkmcnt(5)
 v_mfma_f32_16x16x32_bf16 v[144:147], v[24:27], v[72:75], v[144:147]
 ds_read_b64_tr_b16 v[242:243], v210 offset:2048
 v_mfma_f32_16x16x32_bf16 v[148:151], v[24:27], v[76:79], v[148:151]
 ds_read_b64_tr_b16 v[244:245], v211 offset:0
 v_mfma_f32_16x16x32_bf16 v[152:155], v[28:31], v[72:75], v[152:155]
 ds_read_b64_tr_b16 v[246:247], v211 offset:2048
 v_mfma_f32_16x16x32_bf16 v[156:159], v[28:31], v[76:79], v[156:159]
 v_mfma_f32_16x16x32_bf16 v[160:163], v[32:35], v[72:75], v[160:163]
 v_mfma_f32_16x16x32_bf16 v[164:167], v[32:35], v[76:79], v[164:167]
 v_mfma_f32_16x16x32_bf16 v[168:171], v[36:39], v[72:75], v[168:171]
 v_mfma_f32_16x16x32_bf16 v[172:175], v[36:39], v[76:79], v[172:175]
 s_waitcnt vmcnt(9) lgkmcnt(0)
 s_barrier
 v_add_u32 v4, 4294852608, v4
 ds_read_b128 v[80:83], v4 offset:0
 ds_read_b128 v[84:87], v4 offset:2048
 ds_read_b64_tr_b16 v[24:25], v6 offset:16640
 ds_read_b64_tr_b16 v[28:29], v7 offset:16640
 ds_read_b64_tr_b16 v[26:27], v6 offset:18688
 ds_read_b64_tr_b16 v[32:33], v10 offset:16640
 ds_read_b64_tr_b16 v[30:31], v7 offset:18688
 v_mfma_f32_16x16x32_bf16 v[176:179], v[40:43], v[72:75], v[176:179]
 ds_read_b64_tr_b16 v[34:35], v10 offset:18688
 s_add_u32 m0, s50, 49152
 s_add_u32 s46, s90, 3145728
 buffer_load_dwordx4 v96, s[24:27], s46 offen offset:0 lds
 v_mfma_f32_16x16x32_bf16 v[180:183], v[40:43], v[76:79], v[180:183]
 ds_read_b64_tr_b16 v[36:37], v11 offset:16640
 v_mfma_f32_16x16x32_bf16 v[184:187], v[44:47], v[72:75], v[184:187]
 ds_read_b64_tr_b16 v[38:39], v11 offset:18688
 buffer_load_dwordx4 v97, s[24:27], s46 offen offset:1024 lds
 v_mfma_f32_16x16x32_bf16 v[188:191], v[44:47], v[76:79], v[188:191]
 ds_read_b64_tr_b16 v[40:41], v208 offset:16640
 v_mfma_f32_16x16x32_bf16 v[192:195], v[240:243], v[72:75], v[192:195]
 ds_read_b64_tr_b16 v[42:43], v208 offset:18688
 v_mfma_f32_16x16x32_bf16 v[196:199], v[240:243], v[76:79], v[196:199]
 ds_read_b64_tr_b16 v[44:45], v209 offset:16640
 v_mfma_f32_16x16x32_bf16 v[200:203], v[244:247], v[72:75], v[200:203]
 ds_read_b64_tr_b16 v[46:47], v209 offset:18688
 buffer_load_dwordx4 v98, s[24:27], s46 offen offset:2048 lds
 v_mfma_f32_16x16x32_bf16 v[204:207], v[244:247], v[76:79], v[204:207]
 ds_read_b64_tr_b16 v[240:241], v210 offset:16640
 s_waitcnt lgkmcnt(5)
 v_mfma_f32_16x16x32_bf16 a[0:3], v[24:27], v[80:83], a[0:3]
 ds_read_b64_tr_b16 v[242:243], v210 offset:18688
 v_mfma_f32_16x16x32_bf16 a[4:7], v[24:27], v[84:87], a[4:7]
 ds_read_b64_tr_b16 v[244:245], v211 offset:16640
 v_mfma_f32_16x16x32_bf16 a[8:11], v[28:31], v[80:83], a[8:11]
 ds_read_b64_tr_b16 v[246:247], v211 offset:18688
 buffer_load_dwordx4 v99, s[24:27], s46 offen offset:3072 lds
 v_mfma_f32_16x16x32_bf16 a[12:15], v[28:31], v[84:87], a[12:15]
 v_add_u32 v6, 65536, v6
 ds_read_b64_tr_b16 v[24:25], v6 offset:0
 v_mfma_f32_16x16x32_bf16 a[16:19], v[32:35], v[80:83], a[16:19]
 ds_read_b64_tr_b16 v[26:27], v6 offset:2048
 v_mfma_f32_16x16x32_bf16 a[20:23], v[32:35], v[84:87], a[20:23]
 v_add_u32 v7, 65536, v7
 ds_read_b64_tr_b16 v[28:29], v7 offset:0
 s_add_u32 m0, s50, 81920
 s_add_u32 s46, s90, 3146240
 v_mfma_f32_16x16x32_bf16 a[24:27], v[36:39], v[80:83], a[24:27]
 ds_read_b64_tr_b16 v[30:31], v7 offset:2048
 buffer_load_dwordx4 v96, s[24:27], s46 offen offset:0 lds
 v_mfma_f32_16x16x32_bf16 a[28:31], v[36:39], v[84:87], a[28:31]
 v_add_u32 v10, 65536, v10
 ds_read_b64_tr_b16 v[32:33], v10 offset:0
 s_waitcnt lgkmcnt(5)
 v_mfma_f32_16x16x32_bf16 a[32:35], v[40:43], v[80:83], a[32:35]
 ds_read_b64_tr_b16 v[34:35], v10 offset:2048
 v_mfma_f32_16x16x32_bf16 a[36:39], v[40:43], v[84:87], a[36:39]
 v_add_u32 v11, 65536, v11
 ds_read_b64_tr_b16 v[36:37], v11 offset:0
 v_mfma_f32_16x16x32_bf16 a[40:43], v[44:47], v[80:83], a[40:43]
 ds_read_b64_tr_b16 v[38:39], v11 offset:2048
 buffer_load_dwordx4 v97, s[24:27], s46 offen offset:1024 lds
 v_mfma_f32_16x16x32_bf16 a[44:47], v[44:47], v[84:87], a[44:47]
 v_add_u32 v208, 65536, v208
 ds_read_b64_tr_b16 v[40:41], v208 offset:0
 v_mfma_f32_16x16x32_bf16 a[48:51], v[240:243], v[80:83], a[48:51]
 ds_read_b64_tr_b16 v[42:43], v208 offset:2048
 v_mfma_f32_16x16x32_bf16 a[52:55], v[240:243], v[84:87], a[52:55]
 v_add_u32 v209, 65536, v209
 ds_read_b64_tr_b16 v[44:45], v209 offset:0
 v_mfma_f32_16x16x32_bf16 a[56:59], v[244:247], v[80:83], a[56:59]
 ds_read_b64_tr_b16 v[46:47], v209 offset:2048
 buffer_load_dwordx4 v98, s[24:27], s46 offen offset:2048 lds
 v_mfma_f32_16x16x32_bf16 a[60:63], v[244:247], v[84:87], a[60:63]
 v_add_u32 v210, 65536, v210
 ds_read_b64_tr_b16 v[240:241], v210 offset:0
 s_waitcnt lgkmcnt(5)
 v_mfma_f32_16x16x32_bf16 a[64:67], v[24:27], v[80:83], a[64:67]
 ds_read_b64_tr_b16 v[242:243], v210 offset:2048
 v_mfma_f32_16x16x32_bf16 a[68:71], v[24:27], v[84:87], a[68:71]
 v_add_u32 v211, 65536, v211
 ds_read_b64_tr_b16 v[244:245], v211 offset:0
 v_mfma_f32_16x16x32_bf16 a[72:75], v[28:31], v[80:83], a[72:75]
 ds_read_b64_tr_b16 v[246:247], v211 offset:2048
 buffer_load_dwordx4 v99, s[24:27], s46 offen offset:3072 lds
 v_mfma_f32_16x16x32_bf16 a[76:79], v[28:31], v[84:87], a[76:79]
 v_add_u32 v6, 4294918144, v6
 ds_read_b64_tr_b16 v[24:25], v6 offset:0
 v_mfma_f32_16x16x32_bf16 a[80:83], v[32:35], v[80:83], a[80:83]
 ds_read_b64_tr_b16 v[26:27], v6 offset:2048
 v_mfma_f32_16x16x32_bf16 a[84:87], v[32:35], v[84:87], a[84:87]
 v_add_u32 v7, 4294918144, v7
 ds_read_b64_tr_b16 v[28:29], v7 offset:0
 s_add_u32 m0, s50, 147456
 s_add_u32 s46, s91, 768
 v_mfma_f32_16x16x32_bf16 a[88:91], v[36:39], v[80:83], a[88:91]
 ds_read_b64_tr_b16 v[30:31], v7 offset:2048
 buffer_load_dwordx4 v100, s[32:35], s46 offen offset:0 lds
 v_mfma_f32_16x16x32_bf16 a[92:95], v[36:39], v[84:87], a[92:95]
 v_add_u32 v10, 4294918144, v10
 ds_read_b64_tr_b16 v[32:33], v10 offset:0
 s_waitcnt lgkmcnt(5)
 v_mfma_f32_16x16x32_bf16 a[96:99], v[40:43], v[80:83], a[96:99]
 ds_read_b64_tr_b16 v[34:35], v10 offset:2048
 v_mfma_f32_16x16x32_bf16 a[100:103], v[40:43], v[84:87], a[100:103]
 v_add_u32 v11, 4294918144, v11
 ds_read_b64_tr_b16 v[36:37], v11 offset:0
 v_mfma_f32_16x16x32_bf16 a[104:107], v[44:47], v[80:83], a[104:107]
 ds_read_b64_tr_b16 v[38:39], v11 offset:2048
 buffer_load_dwordx4 v101, s[32:35], s46 offen offset:1024 lds
 v_mfma_f32_16x16x32_bf16 a[108:111], v[44:47], v[84:87], a[108:111]
 v_add_u32 v208, 4294918144, v208
 ds_read_b64_tr_b16 v[40:41], v208 offset:0
 v_mfma_f32_16x16x32_bf16 a[112:115], v[240:243], v[80:83], a[112:115]
 ds_read_b64_tr_b16 v[42:43], v208 offset:2048
 v_mfma_f32_16x16x32_bf16 a[116:119], v[240:243], v[84:87], a[116:119]
 v_add_u32 v209, 4294918144, v209
 ds_read_b64_tr_b16 v[44:45], v209 offset:0
 v_mfma_f32_16x16x32_bf16 a[120:123], v[244:247], v[80:83], a[120:123]
 ds_read_b64_tr_b16 v[46:47], v209 offset:2048
 buffer_load_dwordx4 v102, s[32:35], s46 offen offset:2048 lds
 v_mfma_f32_16x16x32_bf16 a[124:127], v[244:247], v[84:87], a[124:127]
 v_add_u32 v210, 4294918144, v210
 ds_read_b64_tr_b16 v[240:241], v210 offset:0
 s_waitcnt lgkmcnt(5)
 v_mfma_f32_16x16x32_bf16 v[144:147], v[24:27], v[80:83], v[144:147]
 ds_read_b64_tr_b16 v[242:243], v210 offset:2048
 v_mfma_f32_16x16x32_bf16 v[148:151], v[24:27], v[84:87], v[148:151]
 v_add_u32 v211, 4294918144, v211
 ds_read_b64_tr_b16 v[244:245], v211 offset:0
 v_mfma_f32_16x16x32_bf16 v[152:155], v[28:31], v[80:83], v[152:155]
 ds_read_b64_tr_b16 v[246:247], v211 offset:2048
 buffer_load_dwordx4 v103, s[32:35], s46 offen offset:3072 lds
 v_mfma_f32_16x16x32_bf16 v[156:159], v[28:31], v[84:87], v[156:159]
 v_mfma_f32_16x16x32_bf16 v[160:163], v[32:35], v[80:83], v[160:163]
 v_mfma_f32_16x16x32_bf16 v[164:167], v[32:35], v[84:87], v[164:167]
 v_mfma_f32_16x16x32_bf16 v[168:171], v[36:39], v[80:83], v[168:171]
 v_mfma_f32_16x16x32_bf16 v[172:175], v[36:39], v[84:87], v[172:175]
 s_waitcnt vmcnt(12) lgkmcnt(0)
 s_barrier
 v_add_u32 v5, 4294852608, v5
 ds_read_b128 v[88:91], v5 offset:0
 ds_read_b128 v[92:95], v5 offset:2048
 ds_read_b64_tr_b16 v[24:25], v6 offset:33024
 ds_read_b64_tr_b16 v[28:29], v7 offset:33024
 ds_read_b64_tr_b16 v[26:27], v6 offset:35072
 ds_read_b64_tr_b16 v[32:33], v10 offset:33024
 ds_read_b64_tr_b16 v[30:31], v7 offset:35072
 v_mfma_f32_16x16x32_bf16 v[176:179], v[40:43], v[80:83], v[176:179]
 ds_read_b64_tr_b16 v[34:35], v10 offset:35072
 s_add_u32 m0, s50, 65536
 s_add_u32 s46, s90, 3407872
 buffer_load_dwordx4 v96, s[24:27], s46 offen offset:0 lds
 v_mfma_f32_16x16x32_bf16 v[180:183], v[40:43], v[84:87], v[180:183]
 ds_read_b64_tr_b16 v[36:37], v11 offset:33024
 v_mfma_f32_16x16x32_bf16 v[184:187], v[44:47], v[80:83], v[184:187]
 ds_read_b64_tr_b16 v[38:39], v11 offset:35072
 v_mfma_f32_16x16x32_bf16 v[188:191], v[44:47], v[84:87], v[188:191]
 ds_read_b64_tr_b16 v[40:41], v208 offset:33024
 v_mfma_f32_16x16x32_bf16 v[192:195], v[240:243], v[80:83], v[192:195]
 ds_read_b64_tr_b16 v[42:43], v208 offset:35072
 buffer_load_dwordx4 v97, s[24:27], s46 offen offset:1024 lds
 v_mfma_f32_16x16x32_bf16 v[196:199], v[240:243], v[84:87], v[196:199]
 ds_read_b64_tr_b16 v[44:45], v209 offset:33024
 v_mfma_f32_16x16x32_bf16 v[200:203], v[244:247], v[80:83], v[200:203]
 ds_read_b64_tr_b16 v[46:47], v209 offset:35072
 v_mfma_f32_16x16x32_bf16 v[204:207], v[244:247], v[84:87], v[204:207]
 ds_read_b64_tr_b16 v[240:241], v210 offset:33024
 s_waitcnt lgkmcnt(5)
 v_mfma_f32_16x16x32_bf16 a[0:3], v[24:27], v[88:91], a[0:3]
 ds_read_b64_tr_b16 v[242:243], v210 offset:35072
 buffer_load_dwordx4 v98, s[24:27], s46 offen offset:2048 lds
 v_mfma_f32_16x16x32_bf16 a[4:7], v[24:27], v[92:95], a[4:7]
 ds_read_b64_tr_b16 v[244:245], v211 offset:33024
 v_mfma_f32_16x16x32_bf16 a[8:11], v[28:31], v[88:91], a[8:11]
 ds_read_b64_tr_b16 v[246:247], v211 offset:35072
 v_mfma_f32_16x16x32_bf16 a[12:15], v[28:31], v[92:95], a[12:15]
 v_add_u32 v6, 65536, v6
 ds_read_b64_tr_b16 v[24:25], v6 offset:0
 v_mfma_f32_16x16x32_bf16 a[16:19], v[32:35], v[88:91], a[16:19]
 ds_read_b64_tr_b16 v[26:27], v6 offset:2048
 buffer_load_dwordx4 v99, s[24:27], s46 offen offset:3072 lds
 v_mfma_f32_16x16x32_bf16 a[20:23], v[32:35], v[92:95], a[20:23]
 v_add_u32 v7, 65536, v7
 ds_read_b64_tr_b16 v[28:29], v7 offset:0
 v_mfma_f32_16x16x32_bf16 a[24:27], v[36:39], v[88:91], a[24:27]
 ds_read_b64_tr_b16 v[30:31], v7 offset:2048
 v_mfma_f32_16x16x32_bf16 a[28:31], v[36:39], v[92:95], a[28:31]
 v_add_u32 v10, 65536, v10
 ds_read_b64_tr_b16 v[32:33], v10 offset:0
 s_add_u32 m0, s50, 114688
 s_add_u32 s46, s90, 3408384
 s_waitcnt lgkmcnt(5)
 v_mfma_f32_16x16x32_bf16 a[32:35], v[40:43], v[88:91], a[32:35]
 ds_read_b64_tr_b16 v[34:35], v10 offset:2048
 buffer_load_dwordx4 v96, s[24:27], s46 offen offset:0 lds
 v_mfma_f32_16x16x32_bf16 a[36:39], v[40:43], v[92:95], a[36:39]
 v_add_u32 v11, 65536, v11
 ds_read_b64_tr_b16 v[36:37], v11 offset:0
 v_mfma_f32_16x16x32_bf16 a[40:43], v[44:47], v[88:91], a[40:43]
 ds_read_b64_tr_b16 v[38:39], v11 offset:2048
 v_mfma_f32_16x16x32_bf16 a[44:47], v[44:47], v[92:95], a[44:47]
 v_add_u32 v208, 65536, v208
 ds_read_b64_tr_b16 v[40:41], v208 offset:0
 v_mfma_f32_16x16x32_bf16 a[48:51], v[240:243], v[88:91], a[48:51]
 ds_read_b64_tr_b16 v[42:43], v208 offset:2048
 buffer_load_dwordx4 v97, s[24:27], s46 offen offset:1024 lds
 v_mfma_f32_16x16x32_bf16 a[52:55], v[240:243], v[92:95], a[52:55]
 v_add_u32 v209, 65536, v209
 ds_read_b64_tr_b16 v[44:45], v209 offset:0
 v_mfma_f32_16x16x32_bf16 a[56:59], v[244:247], v[88:91], a[56:59]
 ds_read_b64_tr_b16 v[46:47], v209 offset:2048
 v_mfma_f32_16x16x32_bf16 a[60:63], v[244:247], v[92:95], a[60:63]
 v_add_u32 v210, 65536, v210
 ds_read_b64_tr_b16 v[240:241], v210 offset:0
 s_waitcnt lgkmcnt(5)
 v_mfma_f32_16x16x32_bf16 a[64:67], v[24:27], v[88:91], a[64:67]
 ds_read_b64_tr_b16 v[242:243], v210 offset:2048
 buffer_load_dwordx4 v98, s[24:27], s46 offen offset:2048 lds
 v_mfma_f32_16x16x32_bf16 a[68:71], v[24:27], v[92:95], a[68:71]
 v_add_u32 v211, 65536, v211
 ds_read_b64_tr_b16 v[244:245], v211 offset:0
 v_mfma_f32_16x16x32_bf16 a[72:75], v[28:31], v[88:91], a[72:75]
 ds_read_b64_tr_b16 v[246:247], v211 offset:2048
 v_mfma_f32_16x16x32_bf16 a[76:79], v[28:31], v[92:95], a[76:79]
 v_add_u32 v6, 4294934528, v6
 ds_read_b64_tr_b16 v[24:25], v6 offset:0
 v_mfma_f32_16x16x32_bf16 a[80:83], v[32:35], v[88:91], a[80:83]
 ds_read_b64_tr_b16 v[26:27], v6 offset:2048
 buffer_load_dwordx4 v99, s[24:27], s46 offen offset:3072 lds
 v_mfma_f32_16x16x32_bf16 a[84:87], v[32:35], v[92:95], a[84:87]
 v_add_u32 v7, 4294934528, v7
 ds_read_b64_tr_b16 v[28:29], v7 offset:0
 v_mfma_f32_16x16x32_bf16 a[88:91], v[36:39], v[88:91], a[88:91]
 ds_read_b64_tr_b16 v[30:31], v7 offset:2048
 v_mfma_f32_16x16x32_bf16 a[92:95], v[36:39], v[92:95], a[92:95]
 v_add_u32 v10, 4294934528, v10
 ds_read_b64_tr_b16 v[32:33], v10 offset:0
 s_waitcnt lgkmcnt(5)
 v_mfma_f32_16x16x32_bf16 a[96:99], v[40:43], v[88:91], a[96:99]
 ds_read_b64_tr_b16 v[34:35], v10 offset:2048
 v_mfma_f32_16x16x32_bf16 a[100:103], v[40:43], v[92:95], a[100:103]
 v_add_u32 v11, 4294934528, v11
 ds_read_b64_tr_b16 v[36:37], v11 offset:0
 v_mfma_f32_16x16x32_bf16 a[104:107], v[44:47], v[88:91], a[104:107]
 ds_read_b64_tr_b16 v[38:39], v11 offset:2048
 v_mfma_f32_16x16x32_bf16 a[108:111], v[44:47], v[92:95], a[108:111]
 v_add_u32 v208, 4294934528, v208
 ds_read_b64_tr_b16 v[40:41], v208 offset:0
 v_mfma_f32_16x16x32_bf16 a[112:115], v[240:243], v[88:91], a[112:115]
 ds_read_b64_tr_b16 v[42:43], v208 offset:2048
 v_mfma_f32_16x16x32_bf16 a[116:119], v[240:243], v[92:95], a[116:119]
 v_add_u32 v209, 4294934528, v209
 ds_read_b64_tr_b16 v[44:45], v209 offset:0
 v_mfma_f32_16x16x32_bf16 a[120:123], v[244:247], v[88:91], a[120:123]
 ds_read_b64_tr_b16 v[46:47], v209 offset:2048
 v_mfma_f32_16x16x32_bf16 a[124:127], v[244:247], v[92:95], a[124:127]
 v_add_u32 v210, 4294934528, v210
 ds_read_b64_tr_b16 v[240:241], v210 offset:0
 s_waitcnt lgkmcnt(5)
 v_mfma_f32_16x16x32_bf16 v[144:147], v[24:27], v[88:91], v[144:147]
 ds_read_b64_tr_b16 v[242:243], v210 offset:2048
 v_mfma_f32_16x16x32_bf16 v[148:151], v[24:27], v[92:95], v[148:151]
 v_add_u32 v211, 4294934528, v211
 ds_read_b64_tr_b16 v[244:245], v211 offset:0
 v_mfma_f32_16x16x32_bf16 v[152:155], v[28:31], v[88:91], v[152:155]
 ds_read_b64_tr_b16 v[246:247], v211 offset:2048
 v_mfma_f32_16x16x32_bf16 v[156:159], v[28:31], v[92:95], v[156:159]
 v_mfma_f32_16x16x32_bf16 v[160:163], v[32:35], v[88:91], v[160:163]
 v_mfma_f32_16x16x32_bf16 v[164:167], v[32:35], v[92:95], v[164:167]
 v_mfma_f32_16x16x32_bf16 v[168:171], v[36:39], v[88:91], v[168:171]
 v_mfma_f32_16x16x32_bf16 v[172:175], v[36:39], v[92:95], v[172:175]
 s_waitcnt vmcnt(8) lgkmcnt(0)
 s_barrier
 v_add_u32 v4, 114688, v4
 ds_read_b128 v[64:67], v4 offset:0
 ds_read_b128 v[68:71], v4 offset:2048
 v_add_u32 v6, 4294918144, v6
 ds_read_b64_tr_b16 v[24:25], v6 offset:256
 v_add_u32 v7, 4294918144, v7
 ds_read_b64_tr_b16 v[28:29], v7 offset:256
 ds_read_b64_tr_b16 v[26:27], v6 offset:2304
 v_add_u32 v10, 4294918144, v10
 ds_read_b64_tr_b16 v[32:33], v10 offset:256
 ds_read_b64_tr_b16 v[30:31], v7 offset:2304
 v_mfma_f32_16x16x32_bf16 v[176:179], v[40:43], v[88:91], v[176:179]
 ds_read_b64_tr_b16 v[34:35], v10 offset:2304
 s_add_u32 m0, s50, 98304
 s_add_u32 s46, s90, 3670016
 buffer_load_dwordx4 v96, s[24:27], s46 offen offset:0 lds
 v_mfma_f32_16x16x32_bf16 v[180:183], v[40:43], v[92:95], v[180:183]
 v_add_u32 v11, 4294918144, v11
 ds_read_b64_tr_b16 v[36:37], v11 offset:256
 v_mfma_f32_16x16x32_bf16 v[184:187], v[44:47], v[88:91], v[184:187]
 ds_read_b64_tr_b16 v[38:39], v11 offset:2304
 buffer_load_dwordx4 v97, s[24:27], s46 offen offset:1024 lds
 v_mfma_f32_16x16x32_bf16 v[188:191], v[44:47], v[92:95], v[188:191]
 v_add_u32 v208, 4294918144, v208
 ds_read_b64_tr_b16 v[40:41], v208 offset:256
 v_mfma_f32_16x16x32_bf16 v[192:195], v[240:243], v[88:91], v[192:195]
 ds_read_b64_tr_b16 v[42:43], v208 offset:2304
 v_mfma_f32_16x16x32_bf16 v[196:199], v[240:243], v[92:95], v[196:199]
 v_add_u32 v209, 4294918144, v209
 ds_read_b64_tr_b16 v[44:45], v209 offset:256
 v_mfma_f32_16x16x32_bf16 v[200:203], v[244:247], v[88:91], v[200:203]
 ds_read_b64_tr_b16 v[46:47], v209 offset:2304
 buffer_load_dwordx4 v98, s[24:27], s46 offen offset:2048 lds
 v_mfma_f32_16x16x32_bf16 v[204:207], v[244:247], v[92:95], v[204:207]
 v_add_u32 v210, 4294918144, v210
 ds_read_b64_tr_b16 v[240:241], v210 offset:256
 s_waitcnt lgkmcnt(5)
 v_mfma_f32_16x16x32_bf16 a[0:3], v[24:27], v[64:67], a[0:3]
 ds_read_b64_tr_b16 v[242:243], v210 offset:2304
 v_mfma_f32_16x16x32_bf16 a[4:7], v[24:27], v[68:71], a[4:7]
 v_add_u32 v211, 4294918144, v211
 ds_read_b64_tr_b16 v[244:245], v211 offset:256
 v_mfma_f32_16x16x32_bf16 a[8:11], v[28:31], v[64:67], a[8:11]
 ds_read_b64_tr_b16 v[246:247], v211 offset:2304
 buffer_load_dwordx4 v99, s[24:27], s46 offen offset:3072 lds
 v_mfma_f32_16x16x32_bf16 a[12:15], v[28:31], v[68:71], a[12:15]
 ds_read_b64_tr_b16 v[24:25], v6 offset:32768
 v_mfma_f32_16x16x32_bf16 a[16:19], v[32:35], v[64:67], a[16:19]
 ds_read_b64_tr_b16 v[26:27], v6 offset:34816
 v_mfma_f32_16x16x32_bf16 a[20:23], v[32:35], v[68:71], a[20:23]
 ds_read_b64_tr_b16 v[28:29], v7 offset:32768
 s_add_u32 m0, s50, 131072
 s_add_u32 s46, s90, 3670528
 v_mfma_f32_16x16x32_bf16 a[24:27], v[36:39], v[64:67], a[24:27]
 ds_read_b64_tr_b16 v[30:31], v7 offset:34816
 buffer_load_dwordx4 v96, s[24:27], s46 offen offset:0 lds
 v_mfma_f32_16x16x32_bf16 a[28:31], v[36:39], v[68:71], a[28:31]
 ds_read_b64_tr_b16 v[32:33], v10 offset:32768
 s_waitcnt lgkmcnt(5)
 v_mfma_f32_16x16x32_bf16 a[32:35], v[40:43], v[64:67], a[32:35]
 ds_read_b64_tr_b16 v[34:35], v10 offset:34816
 v_mfma_f32_16x16x32_bf16 a[36:39], v[40:43], v[68:71], a[36:39]
 ds_read_b64_tr_b16 v[36:37], v11 offset:32768
 v_mfma_f32_16x16x32_bf16 a[40:43], v[44:47], v[64:67], a[40:43]
 ds_read_b64_tr_b16 v[38:39], v11 offset:34816
 buffer_load_dwordx4 v97, s[24:27], s46 offen offset:1024 lds
 v_mfma_f32_16x16x32_bf16 a[44:47], v[44:47], v[68:71], a[44:47]
 ds_read_b64_tr_b16 v[40:41], v208 offset:32768
 v_mfma_f32_16x16x32_bf16 a[48:51], v[240:243], v[64:67], a[48:51]
 ds_read_b64_tr_b16 v[42:43], v208 offset:34816
 v_mfma_f32_16x16x32_bf16 a[52:55], v[240:243], v[68:71], a[52:55]
 ds_read_b64_tr_b16 v[44:45], v209 offset:32768
 v_mfma_f32_16x16x32_bf16 a[56:59], v[244:247], v[64:67], a[56:59]
 ds_read_b64_tr_b16 v[46:47], v209 offset:34816
 buffer_load_dwordx4 v98, s[24:27], s46 offen offset:2048 lds
 v_mfma_f32_16x16x32_bf16 a[60:63], v[244:247], v[68:71], a[60:63]
 ds_read_b64_tr_b16 v[240:241], v210 offset:32768
 s_waitcnt lgkmcnt(5)
 v_mfma_f32_16x16x32_bf16 a[64:67], v[24:27], v[64:67], a[64:67]
 ds_read_b64_tr_b16 v[242:243], v210 offset:34816
 v_mfma_f32_16x16x32_bf16 a[68:71], v[24:27], v[68:71], a[68:71]
 ds_read_b64_tr_b16 v[244:245], v211 offset:32768
 v_mfma_f32_16x16x32_bf16 a[72:75], v[28:31], v[64:67], a[72:75]
 ds_read_b64_tr_b16 v[246:247], v211 offset:34816
 buffer_load_dwordx4 v99, s[24:27], s46 offen offset:3072 lds
 v_mfma_f32_16x16x32_bf16 a[76:79], v[28:31], v[68:71], a[76:79]
 ds_read_b64_tr_b16 v[24:25], v6 offset:0
 v_mfma_f32_16x16x32_bf16 a[80:83], v[32:35], v[64:67], a[80:83]
 ds_read_b64_tr_b16 v[26:27], v6 offset:2048
 v_mfma_f32_16x16x32_bf16 a[84:87], v[32:35], v[68:71], a[84:87]
 ds_read_b64_tr_b16 v[28:29], v7 offset:0
 s_add_u32 m0, s50, 32768
 s_add_u32 s46, s91, 896
 v_mfma_f32_16x16x32_bf16 a[88:91], v[36:39], v[64:67], a[88:91]
 ds_read_b64_tr_b16 v[30:31], v7 offset:2048
 buffer_load_dwordx4 v100, s[32:35], s46 offen offset:0 lds
 v_mfma_f32_16x16x32_bf16 a[92:95], v[36:39], v[68:71], a[92:95]
 ds_read_b64_tr_b16 v[32:33], v10 offset:0
 s_waitcnt lgkmcnt(5)
 v_mfma_f32_16x16x32_bf16 a[96:99], v[40:43], v[64:67], a[96:99]
 ds_read_b64_tr_b16 v[34:35], v10 offset:2048
 v_mfma_f32_16x16x32_bf16 a[100:103], v[40:43], v[68:71], a[100:103]
 ds_read_b64_tr_b16 v[36:37], v11 offset:0
 v_mfma_f32_16x16x32_bf16 a[104:107], v[44:47], v[64:67], a[104:107]
 ds_read_b64_tr_b16 v[38:39], v11 offset:2048
 buffer_load_dwordx4 v101, s[32:35], s46 offen offset:1024 lds
 v_mfma_f32_16x16x32_bf16 a[108:111], v[44:47], v[68:71], a[108:111]
 ds_read_b64_tr_b16 v[40:41], v208 offset:0
 v_mfma_f32_16x16x32_bf16 a[112:115], v[240:243], v[64:67], a[112:115]
 ds_read_b64_tr_b16 v[42:43], v208 offset:2048
 v_mfma_f32_16x16x32_bf16 a[116:119], v[240:243], v[68:71], a[116:119]
 ds_read_b64_tr_b16 v[44:45], v209 offset:0
 v_mfma_f32_16x16x32_bf16 a[120:123], v[244:247], v[64:67], a[120:123]
 ds_read_b64_tr_b16 v[46:47], v209 offset:2048
 buffer_load_dwordx4 v102, s[32:35], s46 offen offset:2048 lds
 v_mfma_f32_16x16x32_bf16 a[124:127], v[244:247], v[68:71], a[124:127]
 ds_read_b64_tr_b16 v[240:241], v210 offset:0
 s_waitcnt lgkmcnt(5)
 v_mfma_f32_16x16x32_bf16 v[144:147], v[24:27], v[64:67], v[144:147]
 ds_read_b64_tr_b16 v[242:243], v210 offset:2048
 v_mfma_f32_16x16x32_bf16 v[148:151], v[24:27], v[68:71], v[148:151]
 ds_read_b64_tr_b16 v[244:245], v211 offset:0
 v_mfma_f32_16x16x32_bf16 v[152:155], v[28:31], v[64:67], v[152:155]
 ds_read_b64_tr_b16 v[246:247], v211 offset:2048
 buffer_load_dwordx4 v103, s[32:35], s46 offen offset:3072 lds
 v_mfma_f32_16x16x32_bf16 v[156:159], v[28:31], v[68:71], v[156:159]
 v_mfma_f32_16x16x32_bf16 v[160:163], v[32:35], v[64:67], v[160:163]
 v_mfma_f32_16x16x32_bf16 v[164:167], v[32:35], v[68:71], v[164:167]
 v_mfma_f32_16x16x32_bf16 v[168:171], v[36:39], v[64:67], v[168:171]
 v_mfma_f32_16x16x32_bf16 v[172:175], v[36:39], v[68:71], v[172:175]
 s_waitcnt vmcnt(12) lgkmcnt(0)
 s_barrier
 v_add_u32 v5, 114688, v5
 ds_read_b128 v[72:75], v5 offset:0
 ds_read_b128 v[76:79], v5 offset:2048
 ds_read_b64_tr_b16 v[24:25], v6 offset:16640
 ds_read_b64_tr_b16 v[28:29], v7 offset:16640
 ds_read_b64_tr_b16 v[26:27], v6 offset:18688
 ds_read_b64_tr_b16 v[32:33], v10 offset:16640
 ds_read_b64_tr_b16 v[30:31], v7 offset:18688
 v_mfma_f32_16x16x32_bf16 v[176:179], v[40:43], v[64:67], v[176:179]
 ds_read_b64_tr_b16 v[34:35], v10 offset:18688
 s_add_u32 m0, s50, 49152
 s_add_u32 s46, s90, 3932160
 buffer_load_dwordx4 v96, s[24:27], s46 offen offset:0 lds
 v_mfma_f32_16x16x32_bf16 v[180:183], v[40:43], v[68:71], v[180:183]
 ds_read_b64_tr_b16 v[36:37], v11 offset:16640
 v_mfma_f32_16x16x32_bf16 v[184:187], v[44:47], v[64:67], v[184:187]
 ds_read_b64_tr_b16 v[38:39], v11 offset:18688
 v_mfma_f32_16x16x32_bf16 v[188:191], v[44:47], v[68:71], v[188:191]
 ds_read_b64_tr_b16 v[40:41], v208 offset:16640
 v_mfma_f32_16x16x32_bf16 v[192:195], v[240:243], v[64:67], v[192:195]
 ds_read_b64_tr_b16 v[42:43], v208 offset:18688
 buffer_load_dwordx4 v97, s[24:27], s46 offen offset:1024 lds
 v_mfma_f32_16x16x32_bf16 v[196:199], v[240:243], v[68:71], v[196:199]
 ds_read_b64_tr_b16 v[44:45], v209 offset:16640
 v_mfma_f32_16x16x32_bf16 v[200:203], v[244:247], v[64:67], v[200:203]
 ds_read_b64_tr_b16 v[46:47], v209 offset:18688
 v_mfma_f32_16x16x32_bf16 v[204:207], v[244:247], v[68:71], v[204:207]
 ds_read_b64_tr_b16 v[240:241], v210 offset:16640
 s_waitcnt lgkmcnt(5)
 v_mfma_f32_16x16x32_bf16 a[0:3], v[24:27], v[72:75], a[0:3]
 ds_read_b64_tr_b16 v[242:243], v210 offset:18688
 buffer_load_dwordx4 v98, s[24:27], s46 offen offset:2048 lds
 v_mfma_f32_16x16x32_bf16 a[4:7], v[24:27], v[76:79], a[4:7]
 ds_read_b64_tr_b16 v[244:245], v211 offset:16640
 v_mfma_f32_16x16x32_bf16 a[8:11], v[28:31], v[72:75], a[8:11]
 ds_read_b64_tr_b16 v[246:247], v211 offset:18688
 v_mfma_f32_16x16x32_bf16 a[12:15], v[28:31], v[76:79], a[12:15]
 v_add_u32 v6, 65536, v6
 ds_read_b64_tr_b16 v[24:25], v6 offset:0
 v_mfma_f32_16x16x32_bf16 a[16:19], v[32:35], v[72:75], a[16:19]
 ds_read_b64_tr_b16 v[26:27], v6 offset:2048
 buffer_load_dwordx4 v99, s[24:27], s46 offen offset:3072 lds
 v_mfma_f32_16x16x32_bf16 a[20:23], v[32:35], v[76:79], a[20:23]
 v_add_u32 v7, 65536, v7
 ds_read_b64_tr_b16 v[28:29], v7 offset:0
 v_mfma_f32_16x16x32_bf16 a[24:27], v[36:39], v[72:75], a[24:27]
 ds_read_b64_tr_b16 v[30:31], v7 offset:2048
 v_mfma_f32_16x16x32_bf16 a[28:31], v[36:39], v[76:79], a[28:31]
 v_add_u32 v10, 65536, v10
 ds_read_b64_tr_b16 v[32:33], v10 offset:0
 s_add_u32 m0, s50, 81920
 s_add_u32 s46, s90, 3932672
 s_waitcnt lgkmcnt(5)
 v_mfma_f32_16x16x32_bf16 a[32:35], v[40:43], v[72:75], a[32:35]
 ds_read_b64_tr_b16 v[34:35], v10 offset:2048
 buffer_load_dwordx4 v96, s[24:27], s46 offen offset:0 lds
 v_mfma_f32_16x16x32_bf16 a[36:39], v[40:43], v[76:79], a[36:39]
 v_add_u32 v11, 65536, v11
 ds_read_b64_tr_b16 v[36:37], v11 offset:0
 v_mfma_f32_16x16x32_bf16 a[40:43], v[44:47], v[72:75], a[40:43]
 ds_read_b64_tr_b16 v[38:39], v11 offset:2048
 v_mfma_f32_16x16x32_bf16 a[44:47], v[44:47], v[76:79], a[44:47]
 v_add_u32 v208, 65536, v208
 ds_read_b64_tr_b16 v[40:41], v208 offset:0
 v_mfma_f32_16x16x32_bf16 a[48:51], v[240:243], v[72:75], a[48:51]
 ds_read_b64_tr_b16 v[42:43], v208 offset:2048
 buffer_load_dwordx4 v97, s[24:27], s46 offen offset:1024 lds
 v_mfma_f32_16x16x32_bf16 a[52:55], v[240:243], v[76:79], a[52:55]
 v_add_u32 v209, 65536, v209
 ds_read_b64_tr_b16 v[44:45], v209 offset:0
 v_mfma_f32_16x16x32_bf16 a[56:59], v[244:247], v[72:75], a[56:59]
 ds_read_b64_tr_b16 v[46:47], v209 offset:2048
 v_mfma_f32_16x16x32_bf16 a[60:63], v[244:247], v[76:79], a[60:63]
 v_add_u32 v210, 65536, v210
 ds_read_b64_tr_b16 v[240:241], v210 offset:0
 s_waitcnt lgkmcnt(5)
 v_mfma_f32_16x16x32_bf16 a[64:67], v[24:27], v[72:75], a[64:67]
 ds_read_b64_tr_b16 v[242:243], v210 offset:2048
 buffer_load_dwordx4 v98, s[24:27], s46 offen offset:2048 lds
 v_mfma_f32_16x16x32_bf16 a[68:71], v[24:27], v[76:79], a[68:71]
 v_add_u32 v211, 65536, v211
 ds_read_b64_tr_b16 v[244:245], v211 offset:0
 v_mfma_f32_16x16x32_bf16 a[72:75], v[28:31], v[72:75], a[72:75]
 ds_read_b64_tr_b16 v[246:247], v211 offset:2048
 v_mfma_f32_16x16x32_bf16 a[76:79], v[28:31], v[76:79], a[76:79]
 v_add_u32 v6, 4294918144, v6
 ds_read_b64_tr_b16 v[24:25], v6 offset:0
 v_mfma_f32_16x16x32_bf16 a[80:83], v[32:35], v[72:75], a[80:83]
 ds_read_b64_tr_b16 v[26:27], v6 offset:2048
 buffer_load_dwordx4 v99, s[24:27], s46 offen offset:3072 lds
 v_mfma_f32_16x16x32_bf16 a[84:87], v[32:35], v[76:79], a[84:87]
 v_add_u32 v7, 4294918144, v7
 ds_read_b64_tr_b16 v[28:29], v7 offset:0
 v_mfma_f32_16x16x32_bf16 a[88:91], v[36:39], v[72:75], a[88:91]
 ds_read_b64_tr_b16 v[30:31], v7 offset:2048
 v_mfma_f32_16x16x32_bf16 a[92:95], v[36:39], v[76:79], a[92:95]
 v_add_u32 v10, 4294918144, v10
 ds_read_b64_tr_b16 v[32:33], v10 offset:0
 s_waitcnt lgkmcnt(5)
 v_mfma_f32_16x16x32_bf16 a[96:99], v[40:43], v[72:75], a[96:99]
 ds_read_b64_tr_b16 v[34:35], v10 offset:2048
 v_mfma_f32_16x16x32_bf16 a[100:103], v[40:43], v[76:79], a[100:103]
 v_add_u32 v11, 4294918144, v11
 ds_read_b64_tr_b16 v[36:37], v11 offset:0
 v_mfma_f32_16x16x32_bf16 a[104:107], v[44:47], v[72:75], a[104:107]
 ds_read_b64_tr_b16 v[38:39], v11 offset:2048
 v_mfma_f32_16x16x32_bf16 a[108:111], v[44:47], v[76:79], a[108:111]
 v_add_u32 v208, 4294918144, v208
 ds_read_b64_tr_b16 v[40:41], v208 offset:0
 v_mfma_f32_16x16x32_bf16 a[112:115], v[240:243], v[72:75], a[112:115]
 ds_read_b64_tr_b16 v[42:43], v208 offset:2048
 v_mfma_f32_16x16x32_bf16 a[116:119], v[240:243], v[76:79], a[116:119]
 v_add_u32 v209, 4294918144, v209
 ds_read_b64_tr_b16 v[44:45], v209 offset:0
 v_mfma_f32_16x16x32_bf16 a[120:123], v[244:247], v[72:75], a[120:123]
 ds_read_b64_tr_b16 v[46:47], v209 offset:2048
 v_mfma_f32_16x16x32_bf16 a[124:127], v[244:247], v[76:79], a[124:127]
 v_add_u32 v210, 4294918144, v210
 ds_read_b64_tr_b16 v[240:241], v210 offset:0
 s_waitcnt lgkmcnt(5)
 v_mfma_f32_16x16x32_bf16 v[144:147], v[24:27], v[72:75], v[144:147]
 ds_read_b64_tr_b16 v[242:243], v210 offset:2048
 v_mfma_f32_16x16x32_bf16 v[148:151], v[24:27], v[76:79], v[148:151]
 v_add_u32 v211, 4294918144, v211
 ds_read_b64_tr_b16 v[244:245], v211 offset:0
 v_mfma_f32_16x16x32_bf16 v[152:155], v[28:31], v[72:75], v[152:155]
 ds_read_b64_tr_b16 v[246:247], v211 offset:2048
 v_mfma_f32_16x16x32_bf16 v[156:159], v[28:31], v[76:79], v[156:159]
 v_mfma_f32_16x16x32_bf16 v[160:163], v[32:35], v[72:75], v[160:163]
 v_mfma_f32_16x16x32_bf16 v[164:167], v[32:35], v[76:79], v[164:167]
 v_mfma_f32_16x16x32_bf16 v[168:171], v[36:39], v[72:75], v[168:171]
 v_mfma_f32_16x16x32_bf16 v[172:175], v[36:39], v[76:79], v[172:175]
 s_waitcnt vmcnt(8) lgkmcnt(0)
 s_barrier
 v_add_u32 v4, 4294852608, v4
 ds_read_b128 v[80:83], v4 offset:0
 ds_read_b128 v[84:87], v4 offset:2048
 ds_read_b64_tr_b16 v[24:25], v6 offset:33024
 ds_read_b64_tr_b16 v[28:29], v7 offset:33024
 ds_read_b64_tr_b16 v[26:27], v6 offset:35072
 ds_read_b64_tr_b16 v[32:33], v10 offset:33024
 ds_read_b64_tr_b16 v[30:31], v7 offset:35072
 v_mfma_f32_16x16x32_bf16 v[176:179], v[40:43], v[72:75], v[176:179]
 ds_read_b64_tr_b16 v[34:35], v10 offset:35072
 s_add_u32 m0, s50, 65536
 s_add_u32 s46, s90, 4194304
 buffer_load_dwordx4 v96, s[24:27], s46 offen offset:0 lds
 v_mfma_f32_16x16x32_bf16 v[180:183], v[40:43], v[76:79], v[180:183]
 ds_read_b64_tr_b16 v[36:37], v11 offset:33024
 v_mfma_f32_16x16x32_bf16 v[184:187], v[44:47], v[72:75], v[184:187]
 ds_read_b64_tr_b16 v[38:39], v11 offset:35072
 buffer_load_dwordx4 v97, s[24:27], s46 offen offset:1024 lds
 v_mfma_f32_16x16x32_bf16 v[188:191], v[44:47], v[76:79], v[188:191]
 ds_read_b64_tr_b16 v[40:41], v208 offset:33024
 v_mfma_f32_16x16x32_bf16 v[192:195], v[240:243], v[72:75], v[192:195]
 ds_read_b64_tr_b16 v[42:43], v208 offset:35072
 v_mfma_f32_16x16x32_bf16 v[196:199], v[240:243], v[76:79], v[196:199]
 ds_read_b64_tr_b16 v[44:45], v209 offset:33024
 v_mfma_f32_16x16x32_bf16 v[200:203], v[244:247], v[72:75], v[200:203]
 ds_read_b64_tr_b16 v[46:47], v209 offset:35072
 buffer_load_dwordx4 v98, s[24:27], s46 offen offset:2048 lds
 v_mfma_f32_16x16x32_bf16 v[204:207], v[244:247], v[76:79], v[204:207]
 ds_read_b64_tr_b16 v[240:241], v210 offset:33024
 s_waitcnt lgkmcnt(5)
 v_mfma_f32_16x16x32_bf16 a[0:3], v[24:27], v[80:83], a[0:3]
 ds_read_b64_tr_b16 v[242:243], v210 offset:35072
 v_mfma_f32_16x16x32_bf16 a[4:7], v[24:27], v[84:87], a[4:7]
 ds_read_b64_tr_b16 v[244:245], v211 offset:33024
 v_mfma_f32_16x16x32_bf16 a[8:11], v[28:31], v[80:83], a[8:11]
 ds_read_b64_tr_b16 v[246:247], v211 offset:35072
 buffer_load_dwordx4 v99, s[24:27], s46 offen offset:3072 lds
 v_mfma_f32_16x16x32_bf16 a[12:15], v[28:31], v[84:87], a[12:15]
 v_add_u32 v6, 65536, v6
 ds_read_b64_tr_b16 v[24:25], v6 offset:0
 v_mfma_f32_16x16x32_bf16 a[16:19], v[32:35], v[80:83], a[16:19]
 ds_read_b64_tr_b16 v[26:27], v6 offset:2048
 v_mfma_f32_16x16x32_bf16 a[20:23], v[32:35], v[84:87], a[20:23]
 v_add_u32 v7, 65536, v7
 ds_read_b64_tr_b16 v[28:29], v7 offset:0
 s_add_u32 m0, s50, 114688
 s_add_u32 s46, s90, 4194816
 v_mfma_f32_16x16x32_bf16 a[24:27], v[36:39], v[80:83], a[24:27]
 ds_read_b64_tr_b16 v[30:31], v7 offset:2048
 buffer_load_dwordx4 v96, s[24:27], s46 offen offset:0 lds
 v_mfma_f32_16x16x32_bf16 a[28:31], v[36:39], v[84:87], a[28:31]
 v_add_u32 v10, 65536, v10
 ds_read_b64_tr_b16 v[32:33], v10 offset:0
 s_waitcnt lgkmcnt(5)
 v_mfma_f32_16x16x32_bf16 a[32:35], v[40:43], v[80:83], a[32:35]
 ds_read_b64_tr_b16 v[34:35], v10 offset:2048
 v_mfma_f32_16x16x32_bf16 a[36:39], v[40:43], v[84:87], a[36:39]
 v_add_u32 v11, 65536, v11
 ds_read_b64_tr_b16 v[36:37], v11 offset:0
 v_mfma_f32_16x16x32_bf16 a[40:43], v[44:47], v[80:83], a[40:43]
 ds_read_b64_tr_b16 v[38:39], v11 offset:2048
 buffer_load_dwordx4 v97, s[24:27], s46 offen offset:1024 lds
 v_mfma_f32_16x16x32_bf16 a[44:47], v[44:47], v[84:87], a[44:47]
 v_add_u32 v208, 65536, v208
 ds_read_b64_tr_b16 v[40:41], v208 offset:0
 v_mfma_f32_16x16x32_bf16 a[48:51], v[240:243], v[80:83], a[48:51]
 ds_read_b64_tr_b16 v[42:43], v208 offset:2048
 v_mfma_f32_16x16x32_bf16 a[52:55], v[240:243], v[84:87], a[52:55]
 v_add_u32 v209, 65536, v209
 ds_read_b64_tr_b16 v[44:45], v209 offset:0
 v_mfma_f32_16x16x32_bf16 a[56:59], v[244:247], v[80:83], a[56:59]
 ds_read_b64_tr_b16 v[46:47], v209 offset:2048
 buffer_load_dwordx4 v98, s[24:27], s46 offen offset:2048 lds
 v_mfma_f32_16x16x32_bf16 a[60:63], v[244:247], v[84:87], a[60:63]
 v_add_u32 v210, 65536, v210
 ds_read_b64_tr_b16 v[240:241], v210 offset:0
 s_waitcnt lgkmcnt(5)
 v_mfma_f32_16x16x32_bf16 a[64:67], v[24:27], v[80:83], a[64:67]
 ds_read_b64_tr_b16 v[242:243], v210 offset:2048
 v_mfma_f32_16x16x32_bf16 a[68:71], v[24:27], v[84:87], a[68:71]
 v_add_u32 v211, 65536, v211
 ds_read_b64_tr_b16 v[244:245], v211 offset:0
 v_mfma_f32_16x16x32_bf16 a[72:75], v[28:31], v[80:83], a[72:75]
 ds_read_b64_tr_b16 v[246:247], v211 offset:2048
 buffer_load_dwordx4 v99, s[24:27], s46 offen offset:3072 lds
 v_mfma_f32_16x16x32_bf16 a[76:79], v[28:31], v[84:87], a[76:79]
 v_add_u32 v6, 4294934528, v6
 ds_read_b64_tr_b16 v[24:25], v6 offset:0
 v_mfma_f32_16x16x32_bf16 a[80:83], v[32:35], v[80:83], a[80:83]
 ds_read_b64_tr_b16 v[26:27], v6 offset:2048
 v_mfma_f32_16x16x32_bf16 a[84:87], v[32:35], v[84:87], a[84:87]
 v_add_u32 v7, 4294934528, v7
 ds_read_b64_tr_b16 v[28:29], v7 offset:0
 s_add_u32 m0, s50, 147456
 s_add_u32 s46, s91, 1024
 v_mfma_f32_16x16x32_bf16 a[88:91], v[36:39], v[80:83], a[88:91]
 ds_read_b64_tr_b16 v[30:31], v7 offset:2048
 buffer_load_dwordx4 v100, s[32:35], s46 offen offset:0 lds
 v_mfma_f32_16x16x32_bf16 a[92:95], v[36:39], v[84:87], a[92:95]
 v_add_u32 v10, 4294934528, v10
 ds_read_b64_tr_b16 v[32:33], v10 offset:0
 s_waitcnt lgkmcnt(5)
 v_mfma_f32_16x16x32_bf16 a[96:99], v[40:43], v[80:83], a[96:99]
 ds_read_b64_tr_b16 v[34:35], v10 offset:2048
 v_mfma_f32_16x16x32_bf16 a[100:103], v[40:43], v[84:87], a[100:103]
 v_add_u32 v11, 4294934528, v11
 ds_read_b64_tr_b16 v[36:37], v11 offset:0
 v_mfma_f32_16x16x32_bf16 a[104:107], v[44:47], v[80:83], a[104:107]
 ds_read_b64_tr_b16 v[38:39], v11 offset:2048
 buffer_load_dwordx4 v101, s[32:35], s46 offen offset:1024 lds
 v_mfma_f32_16x16x32_bf16 a[108:111], v[44:47], v[84:87], a[108:111]
 v_add_u32 v208, 4294934528, v208
 ds_read_b64_tr_b16 v[40:41], v208 offset:0
 v_mfma_f32_16x16x32_bf16 a[112:115], v[240:243], v[80:83], a[112:115]
 ds_read_b64_tr_b16 v[42:43], v208 offset:2048
 v_mfma_f32_16x16x32_bf16 a[116:119], v[240:243], v[84:87], a[116:119]
 v_add_u32 v209, 4294934528, v209
 ds_read_b64_tr_b16 v[44:45], v209 offset:0
 v_mfma_f32_16x16x32_bf16 a[120:123], v[244:247], v[80:83], a[120:123]
 ds_read_b64_tr_b16 v[46:47], v209 offset:2048
 buffer_load_dwordx4 v102, s[32:35], s46 offen offset:2048 lds
 v_mfma_f32_16x16x32_bf16 a[124:127], v[244:247], v[84:87], a[124:127]
 v_add_u32 v210, 4294934528, v210
 ds_read_b64_tr_b16 v[240:241], v210 offset:0
 s_waitcnt lgkmcnt(5)
 v_mfma_f32_16x16x32_bf16 v[144:147], v[24:27], v[80:83], v[144:147]
 ds_read_b64_tr_b16 v[242:243], v210 offset:2048
 v_mfma_f32_16x16x32_bf16 v[148:151], v[24:27], v[84:87], v[148:151]
 v_add_u32 v211, 4294934528, v211
 ds_read_b64_tr_b16 v[244:245], v211 offset:0
 v_mfma_f32_16x16x32_bf16 v[152:155], v[28:31], v[80:83], v[152:155]
 ds_read_b64_tr_b16 v[246:247], v211 offset:2048
 buffer_load_dwordx4 v103, s[32:35], s46 offen offset:3072 lds
 v_mfma_f32_16x16x32_bf16 v[156:159], v[28:31], v[84:87], v[156:159]
 v_mfma_f32_16x16x32_bf16 v[160:163], v[32:35], v[80:83], v[160:163]
 v_mfma_f32_16x16x32_bf16 v[164:167], v[32:35], v[84:87], v[164:167]
 v_mfma_f32_16x16x32_bf16 v[168:171], v[36:39], v[80:83], v[168:171]
 v_mfma_f32_16x16x32_bf16 v[172:175], v[36:39], v[84:87], v[172:175]
 s_waitcnt vmcnt(12) lgkmcnt(0)
 s_barrier
 v_add_u32 v5, 4294852608, v5
 ds_read_b128 v[88:91], v5 offset:0
 ds_read_b128 v[92:95], v5 offset:2048
 v_add_u32 v6, 4294918144, v6
 ds_read_b64_tr_b16 v[24:25], v6 offset:256
 v_add_u32 v7, 4294918144, v7
 ds_read_b64_tr_b16 v[28:29], v7 offset:256
 ds_read_b64_tr_b16 v[26:27], v6 offset:2304
 v_add_u32 v10, 4294918144, v10
 ds_read_b64_tr_b16 v[32:33], v10 offset:256
 ds_read_b64_tr_b16 v[30:31], v7 offset:2304
 v_mfma_f32_16x16x32_bf16 v[176:179], v[40:43], v[80:83], v[176:179]
 ds_read_b64_tr_b16 v[34:35], v10 offset:2304
 s_add_u32 m0, s50, 98304
 s_add_u32 s46, s90, 4456448
 buffer_load_dwordx4 v96, s[24:27], s46 offen offset:0 lds
 v_mfma_f32_16x16x32_bf16 v[180:183], v[40:43], v[84:87], v[180:183]
 v_add_u32 v11, 4294918144, v11
 ds_read_b64_tr_b16 v[36:37], v11 offset:256
 v_mfma_f32_16x16x32_bf16 v[184:187], v[44:47], v[80:83], v[184:187]
 ds_read_b64_tr_b16 v[38:39], v11 offset:2304
 v_mfma_f32_16x16x32_bf16 v[188:191], v[44:47], v[84:87], v[188:191]
 v_add_u32 v208, 4294918144, v208
 ds_read_b64_tr_b16 v[40:41], v208 offset:256
 v_mfma_f32_16x16x32_bf16 v[192:195], v[240:243], v[80:83], v[192:195]
 ds_read_b64_tr_b16 v[42:43], v208 offset:2304
 buffer_load_dwordx4 v97, s[24:27], s46 offen offset:1024 lds
 v_mfma_f32_16x16x32_bf16 v[196:199], v[240:243], v[84:87], v[196:199]
 v_add_u32 v209, 4294918144, v209
 ds_read_b64_tr_b16 v[44:45], v209 offset:256
 v_mfma_f32_16x16x32_bf16 v[200:203], v[244:247], v[80:83], v[200:203]
 ds_read_b64_tr_b16 v[46:47], v209 offset:2304
 v_mfma_f32_16x16x32_bf16 v[204:207], v[244:247], v[84:87], v[204:207]
 v_add_u32 v210, 4294918144, v210
 ds_read_b64_tr_b16 v[240:241], v210 offset:256
 s_waitcnt lgkmcnt(5)
 v_mfma_f32_16x16x32_bf16 a[0:3], v[24:27], v[88:91], a[0:3]
 ds_read_b64_tr_b16 v[242:243], v210 offset:2304
 buffer_load_dwordx4 v98, s[24:27], s46 offen offset:2048 lds
 v_mfma_f32_16x16x32_bf16 a[4:7], v[24:27], v[92:95], a[4:7]
 v_add_u32 v211, 4294918144, v211
 ds_read_b64_tr_b16 v[244:245], v211 offset:256
 v_mfma_f32_16x16x32_bf16 a[8:11], v[28:31], v[88:91], a[8:11]
 ds_read_b64_tr_b16 v[246:247], v211 offset:2304
 v_mfma_f32_16x16x32_bf16 a[12:15], v[28:31], v[92:95], a[12:15]
 ds_read_b64_tr_b16 v[24:25], v6 offset:32768
 v_mfma_f32_16x16x32_bf16 a[16:19], v[32:35], v[88:91], a[16:19]
 ds_read_b64_tr_b16 v[26:27], v6 offset:34816
 buffer_load_dwordx4 v99, s[24:27], s46 offen offset:3072 lds
 v_mfma_f32_16x16x32_bf16 a[20:23], v[32:35], v[92:95], a[20:23]
 ds_read_b64_tr_b16 v[28:29], v7 offset:32768
 v_mfma_f32_16x16x32_bf16 a[24:27], v[36:39], v[88:91], a[24:27]
 ds_read_b64_tr_b16 v[30:31], v7 offset:34816
 v_mfma_f32_16x16x32_bf16 a[28:31], v[36:39], v[92:95], a[28:31]
 ds_read_b64_tr_b16 v[32:33], v10 offset:32768
 s_add_u32 m0, s50, 131072
 s_add_u32 s46, s90, 4456960
 s_waitcnt lgkmcnt(5)
 v_mfma_f32_16x16x32_bf16 a[32:35], v[40:43], v[88:91], a[32:35]
 ds_read_b64_tr_b16 v[34:35], v10 offset:34816
 buffer_load_dwordx4 v96, s[24:27], s46 offen offset:0 lds
 v_mfma_f32_16x16x32_bf16 a[36:39], v[40:43], v[92:95], a[36:39]
 ds_read_b64_tr_b16 v[36:37], v11 offset:32768
 v_mfma_f32_16x16x32_bf16 a[40:43], v[44:47], v[88:91], a[40:43]
 ds_read_b64_tr_b16 v[38:39], v11 offset:34816
 v_mfma_f32_16x16x32_bf16 a[44:47], v[44:47], v[92:95], a[44:47]
 ds_read_b64_tr_b16 v[40:41], v208 offset:32768
 v_mfma_f32_16x16x32_bf16 a[48:51], v[240:243], v[88:91], a[48:51]
 ds_read_b64_tr_b16 v[42:43], v208 offset:34816
 buffer_load_dwordx4 v97, s[24:27], s46 offen offset:1024 lds
 v_mfma_f32_16x16x32_bf16 a[52:55], v[240:243], v[92:95], a[52:55]
 ds_read_b64_tr_b16 v[44:45], v209 offset:32768
 v_mfma_f32_16x16x32_bf16 a[56:59], v[244:247], v[88:91], a[56:59]
 ds_read_b64_tr_b16 v[46:47], v209 offset:34816
 v_mfma_f32_16x16x32_bf16 a[60:63], v[244:247], v[92:95], a[60:63]
 ds_read_b64_tr_b16 v[240:241], v210 offset:32768
 s_waitcnt lgkmcnt(5)
 v_mfma_f32_16x16x32_bf16 a[64:67], v[24:27], v[88:91], a[64:67]
 ds_read_b64_tr_b16 v[242:243], v210 offset:34816
 buffer_load_dwordx4 v98, s[24:27], s46 offen offset:2048 lds
 v_mfma_f32_16x16x32_bf16 a[68:71], v[24:27], v[92:95], a[68:71]
 ds_read_b64_tr_b16 v[244:245], v211 offset:32768
 v_mfma_f32_16x16x32_bf16 a[72:75], v[28:31], v[88:91], a[72:75]
 ds_read_b64_tr_b16 v[246:247], v211 offset:34816
 v_mfma_f32_16x16x32_bf16 a[76:79], v[28:31], v[92:95], a[76:79]
 ds_read_b64_tr_b16 v[24:25], v6 offset:0
 v_mfma_f32_16x16x32_bf16 a[80:83], v[32:35], v[88:91], a[80:83]
 ds_read_b64_tr_b16 v[26:27], v6 offset:2048
 buffer_load_dwordx4 v99, s[24:27], s46 offen offset:3072 lds
 v_mfma_f32_16x16x32_bf16 a[84:87], v[32:35], v[92:95], a[84:87]
 ds_read_b64_tr_b16 v[28:29], v7 offset:0
 v_mfma_f32_16x16x32_bf16 a[88:91], v[36:39], v[88:91], a[88:91]
 ds_read_b64_tr_b16 v[30:31], v7 offset:2048
 v_mfma_f32_16x16x32_bf16 a[92:95], v[36:39], v[92:95], a[92:95]
 ds_read_b64_tr_b16 v[32:33], v10 offset:0
 s_waitcnt lgkmcnt(5)
 v_mfma_f32_16x16x32_bf16 a[96:99], v[40:43], v[88:91], a[96:99]
 ds_read_b64_tr_b16 v[34:35], v10 offset:2048
 v_mfma_f32_16x16x32_bf16 a[100:103], v[40:43], v[92:95], a[100:103]
 ds_read_b64_tr_b16 v[36:37], v11 offset:0
 v_mfma_f32_16x16x32_bf16 a[104:107], v[44:47], v[88:91], a[104:107]
 ds_read_b64_tr_b16 v[38:39], v11 offset:2048
 v_mfma_f32_16x16x32_bf16 a[108:111], v[44:47], v[92:95], a[108:111]
 ds_read_b64_tr_b16 v[40:41], v208 offset:0
 v_mfma_f32_16x16x32_bf16 a[112:115], v[240:243], v[88:91], a[112:115]
 ds_read_b64_tr_b16 v[42:43], v208 offset:2048
 v_mfma_f32_16x16x32_bf16 a[116:119], v[240:243], v[92:95], a[116:119]
 ds_read_b64_tr_b16 v[44:45], v209 offset:0
 v_mfma_f32_16x16x32_bf16 a[120:123], v[244:247], v[88:91], a[120:123]
 ds_read_b64_tr_b16 v[46:47], v209 offset:2048
 v_mfma_f32_16x16x32_bf16 a[124:127], v[244:247], v[92:95], a[124:127]
 ds_read_b64_tr_b16 v[240:241], v210 offset:0
 s_waitcnt lgkmcnt(5)
 v_mfma_f32_16x16x32_bf16 v[144:147], v[24:27], v[88:91], v[144:147]
 ds_read_b64_tr_b16 v[242:243], v210 offset:2048
 v_mfma_f32_16x16x32_bf16 v[148:151], v[24:27], v[92:95], v[148:151]
 ds_read_b64_tr_b16 v[244:245], v211 offset:0
 v_mfma_f32_16x16x32_bf16 v[152:155], v[28:31], v[88:91], v[152:155]
 ds_read_b64_tr_b16 v[246:247], v211 offset:2048
 v_mfma_f32_16x16x32_bf16 v[156:159], v[28:31], v[92:95], v[156:159]
 v_mfma_f32_16x16x32_bf16 v[160:163], v[32:35], v[88:91], v[160:163]
 v_mfma_f32_16x16x32_bf16 v[164:167], v[32:35], v[92:95], v[164:167]
 v_mfma_f32_16x16x32_bf16 v[168:171], v[36:39], v[88:91], v[168:171]
 v_mfma_f32_16x16x32_bf16 v[172:175], v[36:39], v[92:95], v[172:175]
 s_waitcnt vmcnt(8) lgkmcnt(0)
 s_barrier
 v_add_u32 v4, 114688, v4
 ds_read_b128 v[64:67], v4 offset:0
 ds_read_b128 v[68:71], v4 offset:2048
 ds_read_b64_tr_b16 v[24:25], v6 offset:16640
 ds_read_b64_tr_b16 v[28:29], v7 offset:16640
 ds_read_b64_tr_b16 v[26:27], v6 offset:18688
 ds_read_b64_tr_b16 v[32:33], v10 offset:16640
 ds_read_b64_tr_b16 v[30:31], v7 offset:18688
 v_mfma_f32_16x16x32_bf16 v[176:179], v[40:43], v[88:91], v[176:179]
 ds_read_b64_tr_b16 v[34:35], v10 offset:18688
 v_mfma_f32_16x16x32_bf16 v[180:183], v[40:43], v[92:95], v[180:183]
 ds_read_b64_tr_b16 v[36:37], v11 offset:16640
 v_mfma_f32_16x16x32_bf16 v[184:187], v[44:47], v[88:91], v[184:187]
 ds_read_b64_tr_b16 v[38:39], v11 offset:18688
 v_mfma_f32_16x16x32_bf16 v[188:191], v[44:47], v[92:95], v[188:191]
 ds_read_b64_tr_b16 v[40:41], v208 offset:16640
 v_mfma_f32_16x16x32_bf16 v[192:195], v[240:243], v[88:91], v[192:195]
 ds_read_b64_tr_b16 v[42:43], v208 offset:18688
 v_mfma_f32_16x16x32_bf16 v[196:199], v[240:243], v[92:95], v[196:199]
 ds_read_b64_tr_b16 v[44:45], v209 offset:16640
 v_mfma_f32_16x16x32_bf16 v[200:203], v[244:247], v[88:91], v[200:203]
 ds_read_b64_tr_b16 v[46:47], v209 offset:18688
 v_mfma_f32_16x16x32_bf16 v[204:207], v[244:247], v[92:95], v[204:207]
 ds_read_b64_tr_b16 v[240:241], v210 offset:16640
 s_waitcnt lgkmcnt(5)
 v_mfma_f32_16x16x32_bf16 a[0:3], v[24:27], v[64:67], a[0:3]
 ds_read_b64_tr_b16 v[242:243], v210 offset:18688
 v_mfma_f32_16x16x32_bf16 a[4:7], v[24:27], v[68:71], a[4:7]
 ds_read_b64_tr_b16 v[244:245], v211 offset:16640
 v_mfma_f32_16x16x32_bf16 a[8:11], v[28:31], v[64:67], a[8:11]
 ds_read_b64_tr_b16 v[246:247], v211 offset:18688
 v_mfma_f32_16x16x32_bf16 a[12:15], v[28:31], v[68:71], a[12:15]
 v_add_u32 v6, 65536, v6
 ds_read_b64_tr_b16 v[24:25], v6 offset:0
 v_mfma_f32_16x16x32_bf16 a[16:19], v[32:35], v[64:67], a[16:19]
 ds_read_b64_tr_b16 v[26:27], v6 offset:2048
 v_mfma_f32_16x16x32_bf16 a[20:23], v[32:35], v[68:71], a[20:23]
 v_add_u32 v7, 65536, v7
 ds_read_b64_tr_b16 v[28:29], v7 offset:0
 v_mfma_f32_16x16x32_bf16 a[24:27], v[36:39], v[64:67], a[24:27]
 ds_read_b64_tr_b16 v[30:31], v7 offset:2048
 v_mfma_f32_16x16x32_bf16 a[28:31], v[36:39], v[68:71], a[28:31]
 v_add_u32 v10, 65536, v10
 ds_read_b64_tr_b16 v[32:33], v10 offset:0
 s_waitcnt lgkmcnt(5)
 v_mfma_f32_16x16x32_bf16 a[32:35], v[40:43], v[64:67], a[32:35]
 ds_read_b64_tr_b16 v[34:35], v10 offset:2048
 v_mfma_f32_16x16x32_bf16 a[36:39], v[40:43], v[68:71], a[36:39]
 v_add_u32 v11, 65536, v11
 ds_read_b64_tr_b16 v[36:37], v11 offset:0
 v_mfma_f32_16x16x32_bf16 a[40:43], v[44:47], v[64:67], a[40:43]
 ds_read_b64_tr_b16 v[38:39], v11 offset:2048
 v_mfma_f32_16x16x32_bf16 a[44:47], v[44:47], v[68:71], a[44:47]
 v_add_u32 v208, 65536, v208
 ds_read_b64_tr_b16 v[40:41], v208 offset:0
 v_mfma_f32_16x16x32_bf16 a[48:51], v[240:243], v[64:67], a[48:51]
 ds_read_b64_tr_b16 v[42:43], v208 offset:2048
 v_mfma_f32_16x16x32_bf16 a[52:55], v[240:243], v[68:71], a[52:55]
 v_add_u32 v209, 65536, v209
 ds_read_b64_tr_b16 v[44:45], v209 offset:0
 v_mfma_f32_16x16x32_bf16 a[56:59], v[244:247], v[64:67], a[56:59]
 ds_read_b64_tr_b16 v[46:47], v209 offset:2048
 v_mfma_f32_16x16x32_bf16 a[60:63], v[244:247], v[68:71], a[60:63]
 v_add_u32 v210, 65536, v210
 ds_read_b64_tr_b16 v[240:241], v210 offset:0
 s_waitcnt lgkmcnt(5)
 v_mfma_f32_16x16x32_bf16 a[64:67], v[24:27], v[64:67], a[64:67]
 ds_read_b64_tr_b16 v[242:243], v210 offset:2048
 v_mfma_f32_16x16x32_bf16 a[68:71], v[24:27], v[68:71], a[68:71]
 v_add_u32 v211, 65536, v211
 ds_read_b64_tr_b16 v[244:245], v211 offset:0
 v_mfma_f32_16x16x32_bf16 a[72:75], v[28:31], v[64:67], a[72:75]
 ds_read_b64_tr_b16 v[246:247], v211 offset:2048
 v_mfma_f32_16x16x32_bf16 a[76:79], v[28:31], v[68:71], a[76:79]
 v_add_u32 v6, 4294918144, v6
 ds_read_b64_tr_b16 v[24:25], v6 offset:0
 v_mfma_f32_16x16x32_bf16 a[80:83], v[32:35], v[64:67], a[80:83]
 ds_read_b64_tr_b16 v[26:27], v6 offset:2048
 v_mfma_f32_16x16x32_bf16 a[84:87], v[32:35], v[68:71], a[84:87]
 v_add_u32 v7, 4294918144, v7
 ds_read_b64_tr_b16 v[28:29], v7 offset:0
 v_mfma_f32_16x16x32_bf16 a[88:91], v[36:39], v[64:67], a[88:91]
 ds_read_b64_tr_b16 v[30:31], v7 offset:2048
 v_mfma_f32_16x16x32_bf16 a[92:95], v[36:39], v[68:71], a[92:95]
 v_add_u32 v10, 4294918144, v10
 ds_read_b64_tr_b16 v[32:33], v10 offset:0
 s_waitcnt lgkmcnt(5)
 v_mfma_f32_16x16x32_bf16 a[96:99], v[40:43], v[64:67], a[96:99]
 ds_read_b64_tr_b16 v[34:35], v10 offset:2048
 v_mfma_f32_16x16x32_bf16 a[100:103], v[40:43], v[68:71], a[100:103]
 v_add_u32 v11, 4294918144, v11
 ds_read_b64_tr_b16 v[36:37], v11 offset:0
 v_mfma_f32_16x16x32_bf16 a[104:107], v[44:47], v[64:67], a[104:107]
 ds_read_b64_tr_b16 v[38:39], v11 offset:2048
 v_mfma_f32_16x16x32_bf16 a[108:111], v[44:47], v[68:71], a[108:111]
 v_add_u32 v208, 4294918144, v208
 ds_read_b64_tr_b16 v[40:41], v208 offset:0
 v_mfma_f32_16x16x32_bf16 a[112:115], v[240:243], v[64:67], a[112:115]
 ds_read_b64_tr_b16 v[42:43], v208 offset:2048
 v_mfma_f32_16x16x32_bf16 a[116:119], v[240:243], v[68:71], a[116:119]
 v_add_u32 v209, 4294918144, v209
 ds_read_b64_tr_b16 v[44:45], v209 offset:0
 v_mfma_f32_16x16x32_bf16 a[120:123], v[244:247], v[64:67], a[120:123]
 ds_read_b64_tr_b16 v[46:47], v209 offset:2048
 v_mfma_f32_16x16x32_bf16 a[124:127], v[244:247], v[68:71], a[124:127]
 v_add_u32 v210, 4294918144, v210
 ds_read_b64_tr_b16 v[240:241], v210 offset:0
 s_waitcnt lgkmcnt(5)
 v_mfma_f32_16x16x32_bf16 v[144:147], v[24:27], v[64:67], v[144:147]
 ds_read_b64_tr_b16 v[242:243], v210 offset:2048
 v_mfma_f32_16x16x32_bf16 v[148:151], v[24:27], v[68:71], v[148:151]
 v_add_u32 v211, 4294918144, v211
 ds_read_b64_tr_b16 v[244:245], v211 offset:0
 v_mfma_f32_16x16x32_bf16 v[152:155], v[28:31], v[64:67], v[152:155]
 ds_read_b64_tr_b16 v[246:247], v211 offset:2048
 v_mfma_f32_16x16x32_bf16 v[156:159], v[28:31], v[68:71], v[156:159]
 v_mfma_f32_16x16x32_bf16 v[160:163], v[32:35], v[64:67], v[160:163]
 v_mfma_f32_16x16x32_bf16 v[164:167], v[32:35], v[68:71], v[164:167]
 v_mfma_f32_16x16x32_bf16 v[168:171], v[36:39], v[64:67], v[168:171]
 v_mfma_f32_16x16x32_bf16 v[172:175], v[36:39], v[68:71], v[172:175]
 s_waitcnt vmcnt(0) lgkmcnt(0)
 s_barrier
 v_add_u32 v5, 114688, v5
 ds_read_b128 v[72:75], v5 offset:0
 ds_read_b128 v[76:79], v5 offset:2048
 ds_read_b64_tr_b16 v[24:25], v6 offset:32768
 ds_read_b64_tr_b16 v[28:29], v7 offset:32768
 ds_read_b64_tr_b16 v[26:27], v6 offset:34816
 ds_read_b64_tr_b16 v[32:33], v10 offset:32768
 ds_read_b64_tr_b16 v[30:31], v7 offset:34816
 v_mfma_f32_16x16x32_bf16 v[176:179], v[40:43], v[64:67], v[176:179]
 ds_read_b64_tr_b16 v[34:35], v10 offset:34816
 v_mfma_f32_16x16x32_bf16 v[180:183], v[40:43], v[68:71], v[180:183]
 ds_read_b64_tr_b16 v[36:37], v11 offset:32768
 v_mfma_f32_16x16x32_bf16 v[184:187], v[44:47], v[64:67], v[184:187]
 ds_read_b64_tr_b16 v[38:39], v11 offset:34816
 v_mfma_f32_16x16x32_bf16 v[188:191], v[44:47], v[68:71], v[188:191]
 ds_read_b64_tr_b16 v[40:41], v208 offset:32768
 v_mfma_f32_16x16x32_bf16 v[192:195], v[240:243], v[64:67], v[192:195]
 ds_read_b64_tr_b16 v[42:43], v208 offset:34816
 v_mfma_f32_16x16x32_bf16 v[196:199], v[240:243], v[68:71], v[196:199]
 ds_read_b64_tr_b16 v[44:45], v209 offset:32768
 v_mfma_f32_16x16x32_bf16 v[200:203], v[244:247], v[64:67], v[200:203]
 ds_read_b64_tr_b16 v[46:47], v209 offset:34816
 v_mfma_f32_16x16x32_bf16 v[204:207], v[244:247], v[68:71], v[204:207]
 ds_read_b64_tr_b16 v[240:241], v210 offset:32768
 s_waitcnt lgkmcnt(5)
 v_mfma_f32_16x16x32_bf16 v[144:147], v[24:27], v[72:75], v[144:147]
 ds_read_b64_tr_b16 v[242:243], v210 offset:34816
 v_mfma_f32_16x16x32_bf16 v[148:151], v[24:27], v[76:79], v[148:151]
 ds_read_b64_tr_b16 v[244:245], v211 offset:32768
 v_mfma_f32_16x16x32_bf16 v[152:155], v[28:31], v[72:75], v[152:155]
 ds_read_b64_tr_b16 v[246:247], v211 offset:34816
 v_mfma_f32_16x16x32_bf16 v[156:159], v[28:31], v[76:79], v[156:159]
 ds_read_b64_tr_b16 v[24:25], v6 offset:33024
 v_mfma_f32_16x16x32_bf16 v[160:163], v[32:35], v[72:75], v[160:163]
 ds_read_b64_tr_b16 v[26:27], v6 offset:35072
 v_mfma_f32_16x16x32_bf16 v[164:167], v[32:35], v[76:79], v[164:167]
 ds_read_b64_tr_b16 v[28:29], v7 offset:33024
 v_mfma_f32_16x16x32_bf16 v[168:171], v[36:39], v[72:75], v[168:171]
 ds_read_b64_tr_b16 v[30:31], v7 offset:35072
 v_mfma_f32_16x16x32_bf16 v[172:175], v[36:39], v[76:79], v[172:175]
 ds_read_b64_tr_b16 v[32:33], v10 offset:33024
 s_waitcnt lgkmcnt(5)
 v_mfma_f32_16x16x32_bf16 v[176:179], v[40:43], v[72:75], v[176:179]
 ds_read_b64_tr_b16 v[34:35], v10 offset:35072
 v_mfma_f32_16x16x32_bf16 v[180:183], v[40:43], v[76:79], v[180:183]
 ds_read_b64_tr_b16 v[36:37], v11 offset:33024
 v_mfma_f32_16x16x32_bf16 v[184:187], v[44:47], v[72:75], v[184:187]
 ds_read_b64_tr_b16 v[38:39], v11 offset:35072
 v_mfma_f32_16x16x32_bf16 v[188:191], v[44:47], v[76:79], v[188:191]
 ds_read_b64_tr_b16 v[40:41], v208 offset:33024
 v_mfma_f32_16x16x32_bf16 v[192:195], v[240:243], v[72:75], v[192:195]
 ds_read_b64_tr_b16 v[42:43], v208 offset:35072
 v_mfma_f32_16x16x32_bf16 v[196:199], v[240:243], v[76:79], v[196:199]
 ds_read_b64_tr_b16 v[44:45], v209 offset:33024
 v_mfma_f32_16x16x32_bf16 v[200:203], v[244:247], v[72:75], v[200:203]
 ds_read_b64_tr_b16 v[46:47], v209 offset:35072
 v_mfma_f32_16x16x32_bf16 v[204:207], v[244:247], v[76:79], v[204:207]
 ds_read_b64_tr_b16 v[240:241], v210 offset:33024
 v_mul_f32 v144, s48, v144
 v_mul_f32 v145, s48, v145
 v_mul_f32 v146, s48, v146
 s_waitcnt lgkmcnt(5)
 v_mfma_f32_16x16x32_bf16 a[0:3], v[24:27], v[72:75], a[0:3]
 ds_read_b64_tr_b16 v[242:243], v210 offset:35072
 v_mul_f32 v147, s48, v147
 v_cvt_pk_bf16_f32 v112, v144, v145
 v_cvt_pk_bf16_f32 v113, v146, v147
 v_mul_f32 v152, s48, v152
 v_mfma_f32_16x16x32_bf16 a[4:7], v[24:27], v[76:79], a[4:7]
 ds_read_b64_tr_b16 v[244:245], v211 offset:33024
 v_mul_f32 v153, s48, v153
 v_mul_f32 v154, s48, v154
 v_mul_f32 v155, s48, v155
 v_mfma_f32_16x16x32_bf16 a[8:11], v[28:31], v[72:75], a[8:11]
 ds_read_b64_tr_b16 v[246:247], v211 offset:35072
 v_cvt_pk_bf16_f32 v114, v152, v153
 v_cvt_pk_bf16_f32 v115, v154, v155
 v_mul_f32 v148, s48, v148
 v_mul_f32 v149, s48, v149
 v_mfma_f32_16x16x32_bf16 a[12:15], v[28:31], v[76:79], a[12:15]
 v_add_u32 v6, 65536, v6
 ds_read_b64_tr_b16 v[24:25], v6 offset:0
 v_mul_f32 v150, s48, v150
 v_mul_f32 v151, s48, v151
 v_cvt_pk_bf16_f32 v116, v148, v149
 v_mfma_f32_16x16x32_bf16 a[16:19], v[32:35], v[72:75], a[16:19]
 ds_read_b64_tr_b16 v[26:27], v6 offset:2048
 v_cvt_pk_bf16_f32 v117, v150, v151
 v_mul_f32 v156, s48, v156
 v_mul_f32 v157, s48, v157
 v_mul_f32 v158, s48, v158
 v_mfma_f32_16x16x32_bf16 a[20:23], v[32:35], v[76:79], a[20:23]
 v_add_u32 v7, 65536, v7
 ds_read_b64_tr_b16 v[28:29], v7 offset:0
 v_mul_f32 v159, s48, v159
 v_cvt_pk_bf16_f32 v118, v156, v157
 v_cvt_pk_bf16_f32 v119, v158, v159
 v_mfma_f32_16x16x32_bf16 a[24:27], v[36:39], v[72:75], a[24:27]
 ds_read_b64_tr_b16 v[30:31], v7 offset:2048
 v_permlane16_swap_b32 v112, v114
 v_permlane16_swap_b32 v113, v115
 v_permlane16_swap_b32 v116, v118
 v_permlane16_swap_b32 v117, v119
 v_mfma_f32_16x16x32_bf16 a[28:31], v[36:39], v[76:79], a[28:31]
 v_add_u32 v10, 65536, v10
 ds_read_b64_tr_b16 v[32:33], v10 offset:0
 v_mul_f32 v160, s48, v160
 v_mul_f32 v161, s48, v161
 v_mul_f32 v162, s48, v162
 s_waitcnt lgkmcnt(5)
 v_mfma_f32_16x16x32_bf16 a[32:35], v[40:43], v[72:75], a[32:35]
 ds_read_b64_tr_b16 v[34:35], v10 offset:2048
 v_mul_f32 v163, s48, v163
 v_cvt_pk_bf16_f32 v120, v160, v161
 v_cvt_pk_bf16_f32 v121, v162, v163
 v_mul_f32 v168, s48, v168
 v_mfma_f32_16x16x32_bf16 a[36:39], v[40:43], v[76:79], a[36:39]
 v_add_u32 v11, 65536, v11
 ds_read_b64_tr_b16 v[36:37], v11 offset:0
 v_mul_f32 v169, s48, v169
 v_mul_f32 v170, s48, v170
 v_mul_f32 v171, s48, v171
 v_mfma_f32_16x16x32_bf16 a[40:43], v[44:47], v[72:75], a[40:43]
 ds_read_b64_tr_b16 v[38:39], v11 offset:2048
 v_cvt_pk_bf16_f32 v122, v168, v169
 v_cvt_pk_bf16_f32 v123, v170, v171
 v_mul_f32 v164, s48, v164
 v_mul_f32 v165, s48, v165
 v_mfma_f32_16x16x32_bf16 a[44:47], v[44:47], v[76:79], a[44:47]
 v_add_u32 v208, 65536, v208
 ds_read_b64_tr_b16 v[40:41], v208 offset:0
 v_mul_f32 v166, s48, v166
 v_mul_f32 v167, s48, v167
 v_cvt_pk_bf16_f32 v124, v164, v165
 v_mfma_f32_16x16x32_bf16 a[48:51], v[240:243], v[72:75], a[48:51]
 ds_read_b64_tr_b16 v[42:43], v208 offset:2048
 v_cvt_pk_bf16_f32 v125, v166, v167
 v_mul_f32 v172, s48, v172
 v_mul_f32 v173, s48, v173
 v_mul_f32 v174, s48, v174
 v_mfma_f32_16x16x32_bf16 a[52:55], v[240:243], v[76:79], a[52:55]
 v_add_u32 v209, 65536, v209
 ds_read_b64_tr_b16 v[44:45], v209 offset:0
 v_mul_f32 v175, s48, v175
 v_cvt_pk_bf16_f32 v126, v172, v173
 v_cvt_pk_bf16_f32 v127, v174, v175
 v_mfma_f32_16x16x32_bf16 a[56:59], v[244:247], v[72:75], a[56:59]
 ds_read_b64_tr_b16 v[46:47], v209 offset:2048
 v_permlane16_swap_b32 v120, v122
 v_permlane16_swap_b32 v121, v123
 v_permlane16_swap_b32 v124, v126
 v_permlane16_swap_b32 v125, v127
 v_mfma_f32_16x16x32_bf16 a[60:63], v[244:247], v[76:79], a[60:63]
 v_add_u32 v210, 65536, v210
 ds_read_b64_tr_b16 v[240:241], v210 offset:0
 v_mul_f32 v176, s48, v176
 v_mul_f32 v177, s48, v177
 v_mul_f32 v178, s48, v178
 s_waitcnt lgkmcnt(5)
 v_mfma_f32_16x16x32_bf16 a[64:67], v[24:27], v[72:75], a[64:67]
 ds_read_b64_tr_b16 v[242:243], v210 offset:2048
 v_mul_f32 v179, s48, v179
 v_cvt_pk_bf16_f32 v128, v176, v177
 v_cvt_pk_bf16_f32 v129, v178, v179
 v_mul_f32 v184, s48, v184
 v_mfma_f32_16x16x32_bf16 a[68:71], v[24:27], v[76:79], a[68:71]
 v_add_u32 v211, 65536, v211
 ds_read_b64_tr_b16 v[244:245], v211 offset:0
 v_mul_f32 v185, s48, v185
 v_mul_f32 v186, s48, v186
 v_mul_f32 v187, s48, v187
 v_mfma_f32_16x16x32_bf16 a[72:75], v[28:31], v[72:75], a[72:75]
 ds_read_b64_tr_b16 v[246:247], v211 offset:2048
 v_cvt_pk_bf16_f32 v130, v184, v185
 v_cvt_pk_bf16_f32 v131, v186, v187
 v_mul_f32 v180, s48, v180
 v_mul_f32 v181, s48, v181
 v_mfma_f32_16x16x32_bf16 a[76:79], v[28:31], v[76:79], a[76:79]
 v_mul_f32 v182, s48, v182
 v_mul_f32 v183, s48, v183
 v_cvt_pk_bf16_f32 v132, v180, v181
 v_mfma_f32_16x16x32_bf16 a[80:83], v[32:35], v[72:75], a[80:83]
 v_cvt_pk_bf16_f32 v133, v182, v183
 v_mul_f32 v188, s48, v188
 v_mul_f32 v189, s48, v189
 v_mul_f32 v190, s48, v190
 v_mfma_f32_16x16x32_bf16 a[84:87], v[32:35], v[76:79], a[84:87]
 v_mul_f32 v191, s48, v191
 v_cvt_pk_bf16_f32 v134, v188, v189
 v_cvt_pk_bf16_f32 v135, v190, v191
 v_mfma_f32_16x16x32_bf16 a[88:91], v[36:39], v[72:75], a[88:91]
 v_permlane16_swap_b32 v128, v130
 v_permlane16_swap_b32 v129, v131
 v_permlane16_swap_b32 v132, v134
 v_permlane16_swap_b32 v133, v135
 v_mfma_f32_16x16x32_bf16 a[92:95], v[36:39], v[76:79], a[92:95]
 v_mul_f32 v192, s48, v192
 v_mul_f32 v193, s48, v193
 v_mul_f32 v194, s48, v194
 s_waitcnt lgkmcnt(0)
 v_mfma_f32_16x16x32_bf16 a[96:99], v[40:43], v[72:75], a[96:99]
 v_mul_f32 v195, s48, v195
 v_cvt_pk_bf16_f32 v136, v192, v193
 v_cvt_pk_bf16_f32 v137, v194, v195
 v_mul_f32 v200, s48, v200
 v_mfma_f32_16x16x32_bf16 a[100:103], v[40:43], v[76:79], a[100:103]
 v_mul_f32 v201, s48, v201
 v_mul_f32 v202, s48, v202
 v_mul_f32 v203, s48, v203
 v_mfma_f32_16x16x32_bf16 a[104:107], v[44:47], v[72:75], a[104:107]
 v_cvt_pk_bf16_f32 v138, v200, v201
 v_cvt_pk_bf16_f32 v139, v202, v203
 v_mul_f32 v196, s48, v196
 v_mul_f32 v197, s48, v197
 v_mfma_f32_16x16x32_bf16 a[108:111], v[44:47], v[76:79], a[108:111]
 v_mul_f32 v198, s48, v198
 v_mul_f32 v199, s48, v199
 v_cvt_pk_bf16_f32 v140, v196, v197
 v_mfma_f32_16x16x32_bf16 a[112:115], v[240:243], v[72:75], a[112:115]
 v_cvt_pk_bf16_f32 v141, v198, v199
 v_mul_f32 v204, s48, v204
 v_mul_f32 v205, s48, v205
 v_mul_f32 v206, s48, v206
 v_mfma_f32_16x16x32_bf16 a[116:119], v[240:243], v[76:79], a[116:119]
 v_mul_f32 v207, s48, v207
 v_cvt_pk_bf16_f32 v142, v204, v205
 v_cvt_pk_bf16_f32 v143, v206, v207
 v_mfma_f32_16x16x32_bf16 a[120:123], v[244:247], v[72:75], a[120:123]
 v_permlane16_swap_b32 v136, v138
 v_permlane16_swap_b32 v137, v139
 v_permlane16_swap_b32 v140, v142
 v_permlane16_swap_b32 v141, v143
 v_mfma_f32_16x16x32_bf16 a[124:127], v[244:247], v[76:79], a[124:127]
 s_waitcnt lgkmcnt(0)
 s_barrier
 v_mov_b32 v208, 0
 v_mov_b32 v209, 0
 v_mov_b32 v210, 0
 v_mov_b32 v211, 0
 v_bfe_u32 v16, v0, 2, 2
 v_and_b32 v2, 3, v0
 v_lshlrev_b32 v2, 7, v2
 v_lshl_add_u32 v2, v16, 10, v2
 v_bfe_u32 v16, v0, 2, 1
 v_and_b32 v17, 2, v0
 v_or_b32 v16, v16, v17
 v_bfe_u32 v17, v0, 3, 1
 v_lshl_or_b32 v16, v17, 2, v16
 v_bfe_u32 v17, v0, 5, 1
 v_xor_b32 v16, v16, v17
 v_bfe_u32 v17, v0, 4, 1
 v_lshlrev_b32 v17, 1, v17
 v_xor_b32 v16, v16, v17
 v_lshl_add_u32 v4, v16, 4, v2
 v_xor_b32 v5, 64, v4
 v_lshrrev_b32 v16, 4, v0
 v_lshlrev_b32 v16, 9, v16
 v_sub_u32 v10, 0, v16
 v_add_u32 v3, 147456, v3
 s_waitcnt lgkmcnt(0)
 s_barrier
 ds_read_b128 v[24:27], v4 offset:0
 ds_read_b128 v[28:31], v5 offset:0
 ds_read_b128 v[32:35], v4 offset:512
 ds_read_b128 v[36:39], v5 offset:512
 ds_read_b128 v[40:43], v4 offset:4096
 ds_read_b128 v[44:47], v5 offset:4096
M_item:
 ds_read_b128 v[240:243], v4 offset:4608
 s_waitcnt lgkmcnt(3)
 v_mfma_f32_16x16x32_bf16 v[144:147], v[24:27], v[112:115], 0
 v_mfma_f32_16x16x32_bf16 v[152:155], v[24:27], v[116:119], 0
 ds_read_b128 v[244:247], v5 offset:4608
 v_mfma_f32_16x16x32_bf16 v[144:147], v[28:31], v[120:123], v[144:147]
 v_mfma_f32_16x16x32_bf16 v[152:155], v[28:31], v[124:127], v[152:155]
 ds_read_b128 v[24:27], v4 offset:8192
 v_mfma_f32_16x16x32_bf16 v[144:147], v[32:35], v[128:131], v[144:147]
 v_mfma_f32_16x16x32_bf16 v[152:155], v[32:35], v[132:135], v[152:155]
 ds_read_b128 v[28:31], v5 offset:8192
 v_mfma_f32_16x16x32_bf16 v[144:147], v[36:39], v[136:139], v[144:147]
 v_mfma_f32_16x16x32_bf16 v[152:155], v[36:39], v[140:143], v[152:155]
 ds_read_b128 v[32:35], v4 offset:8704
 s_waitcnt lgkmcnt(3)
 v_mfma_f32_16x16x32_bf16 v[148:151], v[40:43], v[112:115], 0
 v_mfma_f32_16x16x32_bf16 v[156:159], v[40:43], v[116:119], 0
 ds_read_b128 v[36:39], v5 offset:8704
 v_mfma_f32_16x16x32_bf16 v[148:151], v[44:47], v[120:123], v[148:151]
 v_mfma_f32_16x16x32_bf16 v[156:159], v[44:47], v[124:127], v[156:159]
 ds_read_b128 v[40:43], v4 offset:12288
 v_mfma_f32_16x16x32_bf16 v[148:151], v[240:243], v[128:131], v[148:151]
 v_mfma_f32_16x16x32_bf16 v[156:159], v[240:243], v[132:135], v[156:159]
 ds_read_b128 v[44:47], v5 offset:12288
 v_mfma_f32_16x16x32_bf16 v[148:151], v[244:247], v[136:139], v[148:151]
 v_mfma_f32_16x16x32_bf16 v[156:159], v[244:247], v[140:143], v[156:159]
 ds_read_b128 v[240:243], v4 offset:12800
 s_waitcnt lgkmcnt(3)
 v_mfma_f32_16x16x32_bf16 v[80:83], v[24:27], v[112:115], 0
 v_mfma_f32_16x16x32_bf16 v[88:91], v[24:27], v[116:119], 0
 ds_read_b128 v[244:247], v5 offset:12800
 v_mfma_f32_16x16x32_bf16 v[80:83], v[28:31], v[120:123], v[80:83]
 v_mfma_f32_16x16x32_bf16 v[88:91], v[28:31], v[124:127], v[88:91]
 v_max3_f32 v20, v144, v145, v146
 v_max3_f32 v11, v152, v153, v154
 v_mfma_f32_16x16x32_bf16 v[80:83], v[32:35], v[128:131], v[80:83]
 v_max3_f32 v20, v20, v147, v148
 v_max3_f32 v11, v11, v155, v156
 v_mfma_f32_16x16x32_bf16 v[88:91], v[32:35], v[132:135], v[88:91]
 v_max3_f32 v20, v20, v149, v150
 v_max3_f32 v11, v11, v157, v158
 v_mfma_f32_16x16x32_bf16 v[80:83], v[36:39], v[136:139], v[80:83]
 v_max_f32 v20, v20, v151
 v_max_f32 v11, v11, v159
 v_mfma_f32_16x16x32_bf16 v[88:91], v[36:39], v[140:143], v[88:91]
 s_waitcnt lgkmcnt(0)
 s_barrier
 ds_read_b128 v[24:27], v4 offset:16384
 ds_read_b128 v[28:31], v5 offset:16384
 ds_read_b128 v[32:35], v4 offset:16896
 v_mfma_f32_16x16x32_bf16 v[84:87], v[40:43], v[112:115], 0
 v_permlane16_swap_b32 v20, v11
 v_max_f32 v20, v20, v11
 v_mov_b32 v21, v20
 v_mfma_f32_16x16x32_bf16 v[92:95], v[40:43], v[116:119], 0
 ds_read_b128 v[36:39], v5 offset:16896
 v_permlane32_swap_b32 v20, v21
 v_mfma_f32_16x16x32_bf16 v[84:87], v[44:47], v[120:123], v[84:87]
 v_max_f32 v20, v20, v21
 v_mov_b32 v11, v20
 s_nop 1
 v_permlane16_swap_b32 v20, v11
 v_mfma_f32_16x16x32_bf16 v[92:95], v[44:47], v[124:127], v[92:95]
 ds_read_b128 v[40:43], v4 offset:20480
 v_sub_f32 v48, 0, v20
 v_mfma_f32_16x16x32_bf16 v[84:87], v[240:243], v[128:131], v[84:87]
 v_sub_f32 v49, 0, v20
 v_sub_f32 v50, 0, v20
 v_sub_f32 v51, 0, v20
 v_mfma_f32_16x16x32_bf16 v[92:95], v[240:243], v[132:135], v[92:95]
 ds_read_b128 v[44:47], v5 offset:20480
 v_sub_f32 v52, 0, v11
 v_mfma_f32_16x16x32_bf16 v[84:87], v[244:247], v[136:139], v[84:87]
 v_sub_f32 v53, 0, v11
 v_sub_f32 v54, 0, v11
 v_sub_f32 v55, 0, v11
 v_mfma_f32_16x16x32_bf16 v[92:95], v[244:247], v[140:143], v[92:95]
 ds_read_b128 v[240:243], v4 offset:20992
 v_sub_f32 v144, v144, v20
 v_sub_f32 v145, v145, v20
 v_sub_f32 v146, v146, v20
 s_waitcnt lgkmcnt(3)
 v_mfma_f32_16x16x32_bf16 v[64:67], v[24:27], v[112:115], v[48:51]
 v_sub_f32 v147, v147, v20
 v_exp_f32 v16, v144
 v_sub_f32 v148, v148, v20
 v_exp_f32 v17, v145
 v_mfma_f32_16x16x32_bf16 v[72:75], v[24:27], v[116:119], v[52:55]
 ds_read_b128 v[244:247], v5 offset:20992
 v_sub_f32 v149, v149, v20
 v_exp_f32 v18, v146
 v_sub_f32 v150, v150, v20
 v_mfma_f32_16x16x32_bf16 v[64:67], v[28:31], v[120:123], v[64:67]
 v_add_f32 v15, v16, v17
 v_exp_f32 v19, v147
 v_sub_f32 v151, v151, v20
 v_cvt_pk_bf16_f32 v96, v16, v17
 v_mfma_f32_16x16x32_bf16 v[72:75], v[28:31], v[124:127], v[72:75]
 ds_read_b64_tr_b16 v[24:25], v8 offset:24576
 v_exp_f32 v16, v148
 v_sub_f32 v152, v152, v11
 v_add_f32 v15, v15, v18
 v_mfma_f32_16x16x32_bf16 v[64:67], v[32:35], v[128:131], v[64:67]
 ds_read_b64_tr_b16 v[26:27], v8 offset:28672
 v_exp_f32 v17, v149
 v_sub_f32 v153, v153, v11
 v_cvt_pk_bf16_f32 v97, v18, v19
 v_add_f32 v15, v15, v19
 v_mfma_f32_16x16x32_bf16 v[72:75], v[32:35], v[132:135], v[72:75]
 ds_read_b64_tr_b16 v[28:29], v9 offset:24576
 v_exp_f32 v18, v150
 v_sub_f32 v154, v154, v11
 v_add_f32 v15, v15, v16
 v_mfma_f32_16x16x32_bf16 v[64:67], v[36:39], v[136:139], v[64:67]
 ds_read_b64_tr_b16 v[30:31], v9 offset:28672
 v_exp_f32 v19, v151
 v_sub_f32 v155, v155, v11
 v_cvt_pk_bf16_f32 v98, v16, v17
 v_add_f32 v15, v15, v17
 v_mfma_f32_16x16x32_bf16 v[72:75], v[36:39], v[140:143], v[72:75]
 ds_read_b64_tr_b16 v[32:33], v12 offset:24576
 v_exp_f32 v16, v152
 v_sub_f32 v156, v156, v11
 v_add_f32 v15, v15, v18
 s_waitcnt lgkmcnt(5)
 v_mfma_f32_16x16x32_bf16 v[68:71], v[40:43], v[112:115], v[48:51]
 ds_read_b64_tr_b16 v[34:35], v12 offset:28672
 v_exp_f32 v17, v153
 v_sub_f32 v157, v157, v11
 v_cvt_pk_bf16_f32 v99, v18, v19
 v_add_f32 v15, v15, v19
 v_mfma_f32_16x16x32_bf16 v[76:79], v[40:43], v[116:119], v[52:55]
 ds_read_b64_tr_b16 v[36:37], v13 offset:24576
 v_exp_f32 v18, v154
 v_sub_f32 v158, v158, v11
 v_add_f32 v57, v16, v17
 v_mfma_f32_16x16x32_bf16 v[68:71], v[44:47], v[120:123], v[68:71]
 ds_read_b64_tr_b16 v[38:39], v13 offset:28672
 v_exp_f32 v19, v155
 v_sub_f32 v159, v159, v11
 v_cvt_pk_bf16_f32 v100, v16, v17
 v_mfma_f32_16x16x32_bf16 v[76:79], v[44:47], v[124:127], v[76:79]
 ds_read_b64_tr_b16 v[40:41], v8 offset:25088
 v_exp_f32 v16, v156
 v_add_f32 v57, v57, v18
 v_exp_f32 v17, v157
 v_mfma_f32_16x16x32_bf16 v[68:71], v[240:243], v[128:131], v[68:71]
 ds_read_b64_tr_b16 v[42:43], v8 offset:29184
 v_cvt_pk_bf16_f32 v101, v18, v19
 v_add_f32 v57, v57, v19
 v_exp_f32 v18, v158
 v_add_f32 v57, v57, v16
 v_mfma_f32_16x16x32_bf16 v[76:79], v[240:243], v[132:135], v[76:79]
 ds_read_b64_tr_b16 v[44:45], v9 offset:25088
 v_exp_f32 v19, v159
 v_cvt_pk_bf16_f32 v102, v16, v17
 v_add_f32 v57, v57, v17
 v_mfma_f32_16x16x32_bf16 v[68:71], v[244:247], v[136:139], v[68:71]
 ds_read_b64_tr_b16 v[46:47], v9 offset:29184
 v_add_f32 v57, v57, v18
 v_cvt_pk_bf16_f32 v103, v18, v19
 v_add_f32 v57, v57, v19
 v_mov_b32 v14, v15
 v_mov_b32 v56, v57
 v_mfma_f32_16x16x32_bf16 v[76:79], v[244:247], v[140:143], v[76:79]
 ds_read_b64_tr_b16 v[240:241], v12 offset:25088
 v_sub_f32 v80, v80, v20
 v_sub_f32 v81, v81, v20
 v_sub_f32 v82, v82, v20
 v_sub_f32 v83, v83, v20
 s_waitcnt lgkmcnt(5)
 v_mfma_f32_16x16x32_bf16 v[144:147], v[24:27], v[96:99], 0
 ds_read_b64_tr_b16 v[242:243], v12 offset:29184
 v_exp_f32 v16, v80
 v_sub_f32 v84, v84, v20
 v_exp_f32 v17, v81
 v_mfma_f32_16x16x32_bf16 v[148:151], v[24:27], v[100:103], 0
 ds_read_b64_tr_b16 v[244:245], v13 offset:25088
 v_sub_f32 v85, v85, v20
 v_exp_f32 v18, v82
 v_sub_f32 v86, v86, v20
 v_mfma_f32_16x16x32_bf16 v[152:155], v[28:31], v[96:99], 0
 ds_read_b64_tr_b16 v[246:247], v13 offset:29184
 v_add_f32 v15, v16, v17
 v_exp_f32 v19, v83
 v_sub_f32 v87, v87, v20
 v_cvt_pk_bf16_f32 v104, v16, v17
 v_mfma_f32_16x16x32_bf16 v[156:159], v[28:31], v[100:103], 0
 v_exp_f32 v16, v84
 v_sub_f32 v88, v88, v11
 v_add_f32 v15, v15, v18
 v_mfma_f32_16x16x32_bf16 v[160:163], v[32:35], v[96:99], 0
 v_exp_f32 v17, v85
 v_sub_f32 v89, v89, v11
 v_cvt_pk_bf16_f32 v105, v18, v19
 v_add_f32 v15, v15, v19
 v_mfma_f32_16x16x32_bf16 v[164:167], v[32:35], v[100:103], 0
 v_exp_f32 v18, v86
 v_sub_f32 v90, v90, v11
 v_add_f32 v15, v15, v16
 v_mfma_f32_16x16x32_bf16 v[168:171], v[36:39], v[96:99], 0
 v_exp_f32 v19, v87
 v_sub_f32 v91, v91, v11
 v_cvt_pk_bf16_f32 v106, v16, v17
 v_add_f32 v15, v15, v17
 v_mfma_f32_16x16x32_bf16 v[172:175], v[36:39], v[100:103], 0
 s_waitcnt lgkmcnt(0)
 s_barrier
 ds_read_b128 v[24:27], v4 offset:32768
 ds_read_b128 v[28:31], v5 offset:32768
 ds_read_b128 v[32:35], v4 offset:33280
 v_exp_f32 v16, v88
 v_mfma_f32_16x16x32_bf16 v[176:179], v[40:43], v[96:99], 0
 v_sub_f32 v92, v92, v11
 v_add_f32 v15, v15, v18
 v_exp_f32 v17, v89
 v_sub_f32 v93, v93, v11
 v_cvt_pk_bf16_f32 v107, v18, v19
 v_add_f32 v15, v15, v19
 v_mfma_f32_16x16x32_bf16 v[180:183], v[40:43], v[100:103], 0
 ds_read_b128 v[36:39], v5 offset:33280
 v_exp_f32 v18, v90
 v_sub_f32 v94, v94, v11
 v_mfma_f32_16x16x32_bf16 v[184:187], v[44:47], v[96:99], 0
 v_add_f32 v57, v16, v17
 v_exp_f32 v19, v91
 v_sub_f32 v95, v95, v11
 v_cvt_pk_bf16_f32 v108, v16, v17
 v_mfma_f32_16x16x32_bf16 v[188:191], v[44:47], v[100:103], 0
 ds_read_b128 v[40:43], v4 offset:36864
 v_exp_f32 v16, v92
 v_add_f32 v57, v57, v18
 v_exp_f32 v17, v93
 v_mfma_f32_16x16x32_bf16 v[192:195], v[240:243], v[96:99], 0
 v_cvt_pk_bf16_f32 v109, v18, v19
 v_add_f32 v57, v57, v19
 v_exp_f32 v18, v94
 v_add_f32 v57, v57, v16
 v_mfma_f32_16x16x32_bf16 v[196:199], v[240:243], v[100:103], 0
 ds_read_b128 v[44:47], v5 offset:36864
 v_exp_f32 v19, v95
 v_cvt_pk_bf16_f32 v110, v16, v17
 v_add_f32 v57, v57, v17
 v_mfma_f32_16x16x32_bf16 v[200:203], v[244:247], v[96:99], 0
 v_add_f32 v57, v57, v18
 v_cvt_pk_bf16_f32 v111, v18, v19
 v_add_f32 v57, v57, v19
 v_max_f32 v58, v15, v57
 v_cmp_lt_f32 vcc, s49, v58
 v_mfma_f32_16x16x32_bf16 v[204:207], v[244:247], v[100:103], 0
 s_cbranch_vccnz M_stub_1_0
M_back_1_0:
 v_add_f32 v14, v14, v15
 v_add_f32 v56, v56, v57
 ds_read_b128 v[240:243], v4 offset:37376
 s_waitcnt lgkmcnt(3)
 v_mfma_f32_16x16x32_bf16 v[80:83], v[24:27], v[112:115], v[48:51]
 v_exp_f32 v16, v64
 v_exp_f32 v17, v65
 v_mfma_f32_16x16x32_bf16 v[88:91], v[24:27], v[116:119], v[52:55]
 ds_read_b128 v[244:247], v5 offset:37376
 v_mfma_f32_16x16x32_bf16 v[80:83], v[28:31], v[120:123], v[80:83]
 v_exp_f32 v18, v66
 v_add_f32 v15, v16, v17
 v_mfma_f32_16x16x32_bf16 v[88:91], v[28:31], v[124:127], v[88:91]
 ds_read_b64_tr_b16 v[24:25], v8 offset:40960
 v_exp_f32 v19, v67
 v_mfma_f32_16x16x32_bf16 v[80:83], v[32:35], v[128:131], v[80:83]
 ds_read_b64_tr_b16 v[26:27], v8 offset:45056
 v_cvt_pk_bf16_f32 v96, v16, v17
 v_mfma_f32_16x16x32_bf16 v[88:91], v[32:35], v[132:135], v[88:91]
 ds_read_b64_tr_b16 v[28:29], v9 offset:40960
 v_exp_f32 v16, v68
 v_mfma_f32_16x16x32_bf16 v[80:83], v[36:39], v[136:139], v[80:83]
 ds_read_b64_tr_b16 v[30:31], v9 offset:45056
 v_add_f32 v15, v15, v18
 v_exp_f32 v17, v69
 v_mfma_f32_16x16x32_bf16 v[88:91], v[36:39], v[140:143], v[88:91]
 ds_read_b64_tr_b16 v[32:33], v12 offset:40960
 v_cvt_pk_bf16_f32 v97, v18, v19
 s_waitcnt lgkmcnt(5)
 v_mfma_f32_16x16x32_bf16 v[84:87], v[40:43], v[112:115], v[48:51]
 ds_read_b64_tr_b16 v[34:35], v12 offset:45056
 s_cmp_lg_u32 s47, 0
 s_cbranch_scc1 M_lump36
 v_accvgpr_read_b32 v248, a0
 v_accvgpr_read_b32 v249, a1
 v_accvgpr_read_b32 v250, a2
 v_accvgpr_read_b32 v251, a3
 v_pk_mul_f32 v[248:249], v[248:249], s[96:97]
 v_pk_mul_f32 v[250:251], v[250:251], s[96:97]
 v_cvt_pk_bf16_f32 v252, v248, v249
 v_cvt_pk_bf16_f32 v253, v250, v251
 v_accvgpr_read_b32 v248, a8
 v_accvgpr_read_b32 v249, a9
 v_accvgpr_read_b32 v250, a10
 v_accvgpr_read_b32 v251, a11
 v_pk_mul_f32 v[248:249], v[248:249], s[96:97]
 v_pk_mul_f32 v[250:251], v[250:251], s[96:97]
 v_cvt_pk_bf16_f32 v254, v248, v249
 v_cvt_pk_bf16_f32 v255, v250, v251
 s_nop 0
 v_permlane16_swap_b32 v252, v254
 v_permlane16_swap_b32 v253, v255
 v_accvgpr_write_b32 a224, v252
 v_accvgpr_write_b32 a225, v253
 v_accvgpr_write_b32 a226, v254
 v_accvgpr_write_b32 a227, v255
 v_accvgpr_read_b32 v248, a4
 v_accvgpr_read_b32 v249, a5
 v_accvgpr_read_b32 v250, a6
 v_accvgpr_read_b32 v251, a7
 v_pk_mul_f32 v[248:249], v[248:249], s[96:97]
 v_pk_mul_f32 v[250:251], v[250:251], s[96:97]
 v_cvt_pk_bf16_f32 v252, v248, v249
 v_cvt_pk_bf16_f32 v253, v250, v251
 v_accvgpr_read_b32 v248, a12
 v_accvgpr_read_b32 v249, a13
 v_accvgpr_read_b32 v250, a14
 v_accvgpr_read_b32 v251, a15
 v_pk_mul_f32 v[248:249], v[248:249], s[96:97]
 v_pk_mul_f32 v[250:251], v[250:251], s[96:97]
 v_cvt_pk_bf16_f32 v254, v248, v249
 v_cvt_pk_bf16_f32 v255, v250, v251
 s_nop 0
 v_permlane16_swap_b32 v252, v254
 v_permlane16_swap_b32 v253, v255
 v_accvgpr_write_b32 a228, v252
 v_accvgpr_write_b32 a229, v253
 v_accvgpr_write_b32 a230, v254
 v_accvgpr_write_b32 a231, v255
 v_mfma_f32_32x32x16_bf16 a[0:15], v[60:63], v[60:63], 0
M_lump36:
 v_mfma_f32_16x16x32_bf16 v[92:95], v[40:43], v[116:119], v[52:55]
 ds_read_b64_tr_b16 v[36:37], v13 offset:40960
 v_add_f32 v15, v15, v19
 v_mfma_f32_16x16x32_bf16 v[84:87], v[44:47], v[120:123], v[84:87]
 ds_read_b64_tr_b16 v[38:39], v13 offset:45056
 v_exp_f32 v18, v70
 v_add_f32 v15, v15, v16
 v_mfma_f32_16x16x32_bf16 v[92:95], v[44:47], v[124:127], v[92:95]
 ds_read_b64_tr_b16 v[40:41], v8 offset:41472
 v_exp_f32 v19, v71
 v_mfma_f32_16x16x32_bf16 v[84:87], v[240:243], v[128:131], v[84:87]
 ds_read_b64_tr_b16 v[42:43], v8 offset:45568
 v_cvt_pk_bf16_f32 v98, v16, v17
 v_mfma_f32_16x16x32_bf16 v[92:95], v[240:243], v[132:135], v[92:95]
 ds_read_b64_tr_b16 v[44:45], v9 offset:41472
 v_add_f32 v15, v15, v17
 v_mfma_f32_16x16x32_bf16 v[84:87], v[244:247], v[136:139], v[84:87]
 ds_read_b64_tr_b16 v[46:47], v9 offset:45568
 v_exp_f32 v16, v72
 v_mfma_f32_16x16x32_bf16 v[92:95], v[244:247], v[140:143], v[92:95]
 ds_read_b64_tr_b16 v[240:241], v12 offset:41472
 v_add_f32 v15, v15, v18
 s_waitcnt lgkmcnt(5)
 v_mfma_f32_16x16x32_bf16 v[144:147], v[24:27], v[104:107], v[144:147]
 ds_read_b64_tr_b16 v[242:243], v12 offset:45568
 v_exp_f32 v17, v73
 v_mfma_f32_16x16x32_bf16 v[148:151], v[24:27], v[108:111], v[148:151]
 ds_read_b64_tr_b16 v[244:245], v13 offset:41472
 v_cvt_pk_bf16_f32 v99, v18, v19
 v_mfma_f32_16x16x32_bf16 v[152:155], v[28:31], v[104:107], v[152:155]
 ds_read_b64_tr_b16 v[246:247], v13 offset:45568
 v_add_f32 v15, v15, v19
 v_mfma_f32_16x16x32_bf16 v[156:159], v[28:31], v[108:111], v[156:159]
 v_exp_f32 v18, v74
 v_mfma_f32_16x16x32_bf16 v[160:163], v[32:35], v[104:107], v[160:163]
 v_add_f32 v57, v16, v17
 v_exp_f32 v19, v75
 v_mfma_f32_16x16x32_bf16 v[164:167], v[32:35], v[108:111], v[164:167]
 v_cvt_pk_bf16_f32 v100, v16, v17
 v_mfma_f32_16x16x32_bf16 v[168:171], v[36:39], v[104:107], v[168:171]
 v_exp_f32 v16, v76
 v_add_f32 v57, v57, v18
 v_mfma_f32_16x16x32_bf16 v[172:175], v[36:39], v[108:111], v[172:175]
 s_waitcnt lgkmcnt(0)
 s_barrier
 ds_read_b128 v[24:27], v4 offset:49152
 ds_read_b128 v[28:31], v5 offset:49152
 ds_read_b128 v[32:35], v4 offset:49664
 v_mfma_f32_16x16x32_bf16 v[176:179], v[40:43], v[104:107], v[176:179]
 v_exp_f32 v17, v77
 v_cvt_pk_bf16_f32 v101, v18, v19
 v_mfma_f32_16x16x32_bf16 v[180:183], v[40:43], v[108:111], v[180:183]
 ds_read_b128 v[36:39], v5 offset:49664
 v_add_f32 v57, v57, v19
 v_mfma_f32_16x16x32_bf16 v[184:187], v[44:47], v[104:107], v[184:187]
 v_exp_f32 v18, v78
 v_add_f32 v57, v57, v16
 v_mfma_f32_16x16x32_bf16 v[188:191], v[44:47], v[108:111], v[188:191]
 ds_read_b128 v[40:43], v4 offset:53248
 v_exp_f32 v19, v79
 v_mfma_f32_16x16x32_bf16 v[192:195], v[240:243], v[104:107], v[192:195]
 v_cvt_pk_bf16_f32 v102, v16, v17
 v_add_f32 v57, v57, v17
 v_add_f32 v57, v57, v18
 v_mfma_f32_16x16x32_bf16 v[196:199], v[240:243], v[108:111], v[196:199]
 ds_read_b128 v[44:47], v5 offset:53248
 v_cvt_pk_bf16_f32 v103, v18, v19
 v_mfma_f32_16x16x32_bf16 v[200:203], v[244:247], v[104:107], v[200:203]
 v_add_f32 v57, v57, v19
 v_max_f32 v58, v15, v57
 v_cmp_lt_f32 vcc, s49, v58
 v_mfma_f32_16x16x32_bf16 v[204:207], v[244:247], v[108:111], v[204:207]
 s_cbranch_vccnz M_stub_2_1
M_back_2_1:
 v_add_f32 v14, v14, v15
 v_add_f32 v56, v56, v57
 ds_read_b128 v[240:243], v4 offset:53760
 s_waitcnt lgkmcnt(3)
 v_mfma_f32_16x16x32_bf16 v[64:67], v[24:27], v[112:115], v[48:51]
 v_exp_f32 v16, v80
 v_exp_f32 v17, v81
 v_mfma_f32_16x16x32_bf16 v[72:75], v[24:27], v[116:119], v[52:55]
 ds_read_b128 v[244:247], v5 offset:53760
 v_mfma_f32_16x16x32_bf16 v[64:67], v[28:31], v[120:123], v[64:67]
 v_exp_f32 v18, v82
 v_add_f32 v15, v16, v17
 v_mfma_f32_16x16x32_bf16 v[72:75], v[28:31], v[124:127], v[72:75]
 ds_read_b64_tr_b16 v[24:25], v8 offset:57344
 v_exp_f32 v19, v83
 v_mfma_f32_16x16x32_bf16 v[64:67], v[32:35], v[128:131], v[64:67]
 ds_read_b64_tr_b16 v[26:27], v8 offset:61440
 v_cvt_pk_bf16_f32 v104, v16, v17
 v_mfma_f32_16x16x32_bf16 v[72:75], v[32:35], v[132:135], v[72:75]
 ds_read_b64_tr_b16 v[28:29], v9 offset:57344
 v_exp_f32 v16, v84
 v_mfma_f32_16x16x32_bf16 v[64:67], v[36:39], v[136:139], v[64:67]
 ds_read_b64_tr_b16 v[30:31], v9 offset:61440
 v_add_f32 v15, v15, v18
 v_exp_f32 v17, v85
 v_mfma_f32_16x16x32_bf16 v[72:75], v[36:39], v[140:143], v[72:75]
 ds_read_b64_tr_b16 v[32:33], v12 offset:57344
 v_cvt_pk_bf16_f32 v105, v18, v19
 s_waitcnt lgkmcnt(5)
 v_mfma_f32_16x16x32_bf16 v[68:71], v[40:43], v[112:115], v[48:51]
 ds_read_b64_tr_b16 v[34:35], v12 offset:61440
 s_cmp_lg_u32 s47, 0
 s_cbranch_scc1 M_lump52
 v_accvgpr_read_b32 v248, a16
 v_accvgpr_read_b32 v249, a17
 v_accvgpr_read_b32 v250, a18
 v_accvgpr_read_b32 v251, a19
 v_pk_mul_f32 v[248:249], v[248:249], s[96:97]
 v_pk_mul_f32 v[250:251], v[250:251], s[96:97]
 v_cvt_pk_bf16_f32 v252, v248, v249
 v_cvt_pk_bf16_f32 v253, v250, v251
 v_accvgpr_read_b32 v248, a24
 v_accvgpr_read_b32 v249, a25
 v_accvgpr_read_b32 v250, a26
 v_accvgpr_read_b32 v251, a27
 v_pk_mul_f32 v[248:249], v[248:249], s[96:97]
 v_pk_mul_f32 v[250:251], v[250:251], s[96:97]
 v_cvt_pk_bf16_f32 v254, v248, v249
 v_cvt_pk_bf16_f32 v255, v250, v251
 s_nop 0
 v_permlane16_swap_b32 v252, v254
 v_permlane16_swap_b32 v253, v255
 v_accvgpr_write_b32 a232, v252
 v_accvgpr_write_b32 a233, v253
 v_accvgpr_write_b32 a234, v254
 v_accvgpr_write_b32 a235, v255
 v_accvgpr_read_b32 v248, a20
 v_accvgpr_read_b32 v249, a21
 v_accvgpr_read_b32 v250, a22
 v_accvgpr_read_b32 v251, a23
 v_pk_mul_f32 v[248:249], v[248:249], s[96:97]
 v_pk_mul_f32 v[250:251], v[250:251], s[96:97]
 v_cvt_pk_bf16_f32 v252, v248, v249
 v_cvt_pk_bf16_f32 v253, v250, v251
 v_accvgpr_read_b32 v248, a28
 v_accvgpr_read_b32 v249, a29
 v_accvgpr_read_b32 v250, a30
 v_accvgpr_read_b32 v251, a31
 v_pk_mul_f32 v[248:249], v[248:249], s[96:97]
 v_pk_mul_f32 v[250:251], v[250:251], s[96:97]
 v_cvt_pk_bf16_f32 v254, v248, v249
 v_cvt_pk_bf16_f32 v255, v250, v251
 s_nop 0
 v_permlane16_swap_b32 v252, v254
 v_permlane16_swap_b32 v253, v255
 v_accvgpr_write_b32 a236, v252
 v_accvgpr_write_b32 a237, v253
 v_accvgpr_write_b32 a238, v254
 v_accvgpr_write_b32 a239, v255
 v_mfma_f32_32x32x16_bf16 a[16:31], v[60:63], v[60:63], 0
M_lump52:
 v_mfma_f32_16x16x32_bf16 v[76:79], v[40:43], v[116:119], v[52:55]
 ds_read_b64_tr_b16 v[36:37], v13 offset:57344
 v_add_f32 v15, v15, v19
 v_mfma_f32_16x16x32_bf16 v[68:71], v[44:47], v[120:123], v[68:71]
 ds_read_b64_tr_b16 v[38:39], v13 offset:61440
 v_exp_f32 v18, v86
 v_add_f32 v15, v15, v16
 v_mfma_f32_16x16x32_bf16 v[76:79], v[44:47], v[124:127], v[76:79]
 ds_read_b64_tr_b16 v[40:41], v8 offset:57856
 v_exp_f32 v19, v87
 v_mfma_f32_16x16x32_bf16 v[68:71], v[240:243], v[128:131], v[68:71]
 ds_read_b64_tr_b16 v[42:43], v8 offset:61952
 v_cvt_pk_bf16_f32 v106, v16, v17
 v_mfma_f32_16x16x32_bf16 v[76:79], v[240:243], v[132:135], v[76:79]
 ds_read_b64_tr_b16 v[44:45], v9 offset:57856
 v_add_f32 v15, v15, v17
 v_mfma_f32_16x16x32_bf16 v[68:71], v[244:247], v[136:139], v[68:71]
 ds_read_b64_tr_b16 v[46:47], v9 offset:61952
 v_exp_f32 v16, v88
 v_mfma_f32_16x16x32_bf16 v[76:79], v[244:247], v[140:143], v[76:79]
 ds_read_b64_tr_b16 v[240:241], v12 offset:57856
 v_add_f32 v15, v15, v18
 s_waitcnt lgkmcnt(5)
 v_mfma_f32_16x16x32_bf16 v[144:147], v[24:27], v[96:99], v[144:147]
 ds_read_b64_tr_b16 v[242:243], v12 offset:61952
 v_exp_f32 v17, v89
 v_mfma_f32_16x16x32_bf16 v[148:151], v[24:27], v[100:103], v[148:151]
 ds_read_b64_tr_b16 v[244:245], v13 offset:57856
 v_cvt_pk_bf16_f32 v107, v18, v19
 v_mfma_f32_16x16x32_bf16 v[152:155], v[28:31], v[96:99], v[152:155]
 ds_read_b64_tr_b16 v[246:247], v13 offset:61952
 v_add_f32 v15, v15, v19
 v_mfma_f32_16x16x32_bf16 v[156:159], v[28:31], v[100:103], v[156:159]
 v_exp_f32 v18, v90
 v_mfma_f32_16x16x32_bf16 v[160:163], v[32:35], v[96:99], v[160:163]
 v_add_f32 v57, v16, v17
 v_exp_f32 v19, v91
 v_mfma_f32_16x16x32_bf16 v[164:167], v[32:35], v[100:103], v[164:167]
 v_cvt_pk_bf16_f32 v108, v16, v17
 v_mfma_f32_16x16x32_bf16 v[168:171], v[36:39], v[96:99], v[168:171]
 v_exp_f32 v16, v92
 v_add_f32 v57, v57, v18
 v_mfma_f32_16x16x32_bf16 v[172:175], v[36:39], v[100:103], v[172:175]
 s_waitcnt lgkmcnt(0)
 s_barrier
 v_add_u32 v4, 81920, v4
 ds_read_b128 v[24:27], v4 offset:0
 v_add_u32 v5, 81920, v5
 ds_read_b128 v[28:31], v5 offset:0
 ds_read_b128 v[32:35], v4 offset:512
 v_mfma_f32_16x16x32_bf16 v[176:179], v[40:43], v[96:99], v[176:179]
 v_exp_f32 v17, v93
 v_cvt_pk_bf16_f32 v109, v18, v19
 v_mfma_f32_16x16x32_bf16 v[180:183], v[40:43], v[100:103], v[180:183]
 ds_read_b128 v[36:39], v5 offset:512
 v_add_f32 v57, v57, v19
 v_mfma_f32_16x16x32_bf16 v[184:187], v[44:47], v[96:99], v[184:187]
 v_exp_f32 v18, v94
 v_add_f32 v57, v57, v16
 v_mfma_f32_16x16x32_bf16 v[188:191], v[44:47], v[100:103], v[188:191]
 ds_read_b128 v[40:43], v4 offset:4096
 v_exp_f32 v19, v95
 v_mfma_f32_16x16x32_bf16 v[192:195], v[240:243], v[96:99], v[192:195]
 v_cvt_pk_bf16_f32 v110, v16, v17
 v_add_f32 v57, v57, v17
 v_add_f32 v57, v57, v18
 v_mfma_f32_16x16x32_bf16 v[196:199], v[240:243], v[100:103], v[196:199]
 ds_read_b128 v[44:47], v5 offset:4096
 v_cvt_pk_bf16_f32 v111, v18, v19
 v_mfma_f32_16x16x32_bf16 v[200:203], v[244:247], v[96:99], v[200:203]
 v_add_f32 v57, v57, v19
 v_max_f32 v58, v15, v57
 v_cmp_lt_f32 vcc, s49, v58
 v_mfma_f32_16x16x32_bf16 v[204:207], v[244:247], v[100:103], v[204:207]
 s_cbranch_vccnz M_stub_3_2
M_back_3_2:
 v_add_f32 v14, v14, v15
 v_add_f32 v56, v56, v57
 ds_read_b128 v[240:243], v4 offset:4608
 s_waitcnt lgkmcnt(3)
 v_mfma_f32_16x16x32_bf16 v[80:83], v[24:27], v[112:115], v[48:51]
 v_exp_f32 v16, v64
 v_exp_f32 v17, v65
 v_mfma_f32_16x16x32_bf16 v[88:91], v[24:27], v[116:119], v[52:55]
 ds_read_b128 v[244:247], v5 offset:4608
 v_mfma_f32_16x16x32_bf16 v[80:83], v[28:31], v[120:123], v[80:83]
 v_exp_f32 v18, v66
 v_add_f32 v15, v16, v17
 v_mfma_f32_16x16x32_bf16 v[88:91], v[28:31], v[124:127], v[88:91]
 v_add_u32 v8, 90112, v8
 ds_read_b64_tr_b16 v[24:25], v8 offset:0
 v_exp_f32 v19, v67
 v_mfma_f32_16x16x32_bf16 v[80:83], v[32:35], v[128:131], v[80:83]
 ds_read_b64_tr_b16 v[26:27], v8 offset:4096
 v_cvt_pk_bf16_f32 v96, v16, v17
 v_mfma_f32_16x16x32_bf16 v[88:91], v[32:35], v[132:135], v[88:91]
 v_add_u32 v9, 90112, v9
 ds_read_b64_tr_b16 v[28:29], v9 offset:0
 v_exp_f32 v16, v68
 v_mfma_f32_16x16x32_bf16 v[80:83], v[36:39], v[136:139], v[80:83]
 ds_read_b64_tr_b16 v[30:31], v9 offset:4096
 v_add_f32 v15, v15, v18
 v_exp_f32 v17, v69
 v_mfma_f32_16x16x32_bf16 v[88:91], v[36:39], v[140:143], v[88:91]
 v_add_u32 v12, 90112, v12
 ds_read_b64_tr_b16 v[32:33], v12 offset:0
 v_cvt_pk_bf16_f32 v97, v18, v19
 s_waitcnt lgkmcnt(5)
 v_mfma_f32_16x16x32_bf16 v[84:87], v[40:43], v[112:115], v[48:51]
 ds_read_b64_tr_b16 v[34:35], v12 offset:4096
 s_cmp_lg_u32 s47, 0
 s_cbranch_scc1 M_lump68
 v_accvgpr_read_b32 v248, a32
 v_accvgpr_read_b32 v249, a33
 v_accvgpr_read_b32 v250, a34
 v_accvgpr_read_b32 v251, a35
 v_pk_mul_f32 v[248:249], v[248:249], s[96:97]
 v_pk_mul_f32 v[250:251], v[250:251], s[96:97]
 v_cvt_pk_bf16_f32 v252, v248, v249
 v_cvt_pk_bf16_f32 v253, v250, v251
 v_accvgpr_read_b32 v248, a40
 v_accvgpr_read_b32 v249, a41
 v_accvgpr_read_b32 v250, a42
 v_accvgpr_read_b32 v251, a43
 v_pk_mul_f32 v[248:249], v[248:249], s[96:97]
 v_pk_mul_f32 v[250:251], v[250:251], s[96:97]
 v_cvt_pk_bf16_f32 v254, v248, v249
 v_cvt_pk_bf16_f32 v255, v250, v251
 s_nop 0
 v_permlane16_swap_b32 v252, v254
 v_permlane16_swap_b32 v253, v255
 v_accvgpr_write_b32 a240, v252
 v_accvgpr_write_b32 a241, v253
 v_accvgpr_write_b32 a242, v254
 v_accvgpr_write_b32 a243, v255
 v_accvgpr_read_b32 v248, a36
 v_accvgpr_read_b32 v249, a37
 v_accvgpr_read_b32 v250, a38
 v_accvgpr_read_b32 v251, a39
 v_pk_mul_f32 v[248:249], v[248:249], s[96:97]
 v_pk_mul_f32 v[250:251], v[250:251], s[96:97]
 v_cvt_pk_bf16_f32 v252, v248, v249
 v_cvt_pk_bf16_f32 v253, v250, v251
 v_accvgpr_read_b32 v248, a44
 v_accvgpr_read_b32 v249, a45
 v_accvgpr_read_b32 v250, a46
 v_accvgpr_read_b32 v251, a47
 v_pk_mul_f32 v[248:249], v[248:249], s[96:97]
 v_pk_mul_f32 v[250:251], v[250:251], s[96:97]
 v_cvt_pk_bf16_f32 v254, v248, v249
 v_cvt_pk_bf16_f32 v255, v250, v251
 s_nop 0
 v_permlane16_swap_b32 v252, v254
 v_permlane16_swap_b32 v253, v255
 v_accvgpr_write_b32 a244, v252
 v_accvgpr_write_b32 a245, v253
 v_accvgpr_write_b32 a246, v254
 v_accvgpr_write_b32 a247, v255
 v_mfma_f32_32x32x16_bf16 a[32:47], v[60:63], v[60:63], 0
M_lump68:
 v_mfma_f32_16x16x32_bf16 v[92:95], v[40:43], v[116:119], v[52:55]
 v_add_u32 v13, 90112, v13
 ds_read_b64_tr_b16 v[36:37], v13 offset:0
 v_add_f32 v15, v15, v19
 v_mfma_f32_16x16x32_bf16 v[84:87], v[44:47], v[120:123], v[84:87]
 ds_read_b64_tr_b16 v[38:39], v13 offset:4096
 v_exp_f32 v18, v70
 v_add_f32 v15, v15, v16
 v_mfma_f32_16x16x32_bf16 v[92:95], v[44:47], v[124:127], v[92:95]
 ds_read_b64_tr_b16 v[40:41], v8 offset:512
 v_exp_f32 v19, v71
 v_mfma_f32_16x16x32_bf16 v[84:87], v[240:243], v[128:131], v[84:87]
 ds_read_b64_tr_b16 v[42:43], v8 offset:4608
 v_cvt_pk_bf16_f32 v98, v16, v17
 v_mfma_f32_16x16x32_bf16 v[92:95], v[240:243], v[132:135], v[92:95]
 ds_read_b64_tr_b16 v[44:45], v9 offset:512
 v_add_f32 v15, v15, v17
 v_mfma_f32_16x16x32_bf16 v[84:87], v[244:247], v[136:139], v[84:87]
 ds_read_b64_tr_b16 v[46:47], v9 offset:4608
 v_exp_f32 v16, v72
 v_mfma_f32_16x16x32_bf16 v[92:95], v[244:247], v[140:143], v[92:95]
 ds_read_b64_tr_b16 v[240:241], v12 offset:512
 v_add_f32 v15, v15, v18
 s_waitcnt lgkmcnt(5)
 v_mfma_f32_16x16x32_bf16 v[144:147], v[24:27], v[104:107], v[144:147]
 ds_read_b64_tr_b16 v[242:243], v12 offset:4608
 v_exp_f32 v17, v73
 v_mfma_f32_16x16x32_bf16 v[148:151], v[24:27], v[108:111], v[148:151]
 ds_read_b64_tr_b16 v[244:245], v13 offset:512
 v_cvt_pk_bf16_f32 v99, v18, v19
 v_mfma_f32_16x16x32_bf16 v[152:155], v[28:31], v[104:107], v[152:155]
 ds_read_b64_tr_b16 v[246:247], v13 offset:4608
 v_add_f32 v15, v15, v19
 v_mfma_f32_16x16x32_bf16 v[156:159], v[28:31], v[108:111], v[156:159]
 v_exp_f32 v18, v74
 v_mfma_f32_16x16x32_bf16 v[160:163], v[32:35], v[104:107], v[160:163]
 v_add_f32 v57, v16, v17
 v_exp_f32 v19, v75
 v_mfma_f32_16x16x32_bf16 v[164:167], v[32:35], v[108:111], v[164:167]
 v_cvt_pk_bf16_f32 v100, v16, v17
 v_mfma_f32_16x16x32_bf16 v[168:171], v[36:39], v[104:107], v[168:171]
 v_exp_f32 v16, v76
 v_add_f32 v57, v57, v18
 v_mfma_f32_16x16x32_bf16 v[172:175], v[36:39], v[108:111], v[172:175]
 s_waitcnt lgkmcnt(0)
 s_barrier
 v_add_u32 v4, 4294950912, v4
 ds_read_b128 v[24:27], v4 offset:0
 v_add_u32 v5, 4294950912, v5
 ds_read_b128 v[28:31], v5 offset:0
 ds_read_b128 v[32:35], v4 offset:512
 v_mfma_f32_16x16x32_bf16 v[176:179], v[40:43], v[104:107], v[176:179]
 v_exp_f32 v17, v77
 v_cvt_pk_bf16_f32 v101, v18, v19
 v_mfma_f32_16x16x32_bf16 v[180:183], v[40:43], v[108:111], v[180:183]
 ds_read_b128 v[36:39], v5 offset:512
 v_add_f32 v57, v57, v19
 v_mfma_f32_16x16x32_bf16 v[184:187], v[44:47], v[104:107], v[184:187]
 v_exp_f32 v18, v78
 v_add_f32 v57, v57, v16
 v_mfma_f32_16x16x32_bf16 v[188:191], v[44:47], v[108:111], v[188:191]
 ds_read_b128 v[40:43], v4 offset:4096
 v_exp_f32 v19, v79
 v_mfma_f32_16x16x32_bf16 v[192:195], v[240:243], v[104:107], v[192:195]
 v_cvt_pk_bf16_f32 v102, v16, v17
 v_add_f32 v57, v57, v17
 v_add_f32 v57, v57, v18
 v_mfma_f32_16x16x32_bf16 v[196:199], v[240:243], v[108:111], v[196:199]
 ds_read_b128 v[44:47], v5 offset:4096
 v_cvt_pk_bf16_f32 v103, v18, v19
 v_mfma_f32_16x16x32_bf16 v[200:203], v[244:247], v[104:107], v[200:203]
 v_add_f32 v57, v57, v19
 v_max_f32 v58, v15, v57
 v_cmp_lt_f32 vcc, s49, v58
 v_mfma_f32_16x16x32_bf16 v[204:207], v[244:247], v[108:111], v[204:207]
 s_cbranch_vccnz M_stub_4_3
M_back_4_3:
 v_add_f32 v14, v14, v15
 v_add_f32 v56, v56, v57
 ds_read_b128 v[240:243], v4 offset:4608
 s_waitcnt lgkmcnt(3)
 v_mfma_f32_16x16x32_bf16 v[64:67], v[24:27], v[112:115], v[48:51]
 v_exp_f32 v16, v80
 v_exp_f32 v17, v81
 v_mfma_f32_16x16x32_bf16 v[72:75], v[24:27], v[116:119], v[52:55]
 ds_read_b128 v[244:247], v5 offset:4608
 v_mfma_f32_16x16x32_bf16 v[64:67], v[28:31], v[120:123], v[64:67]
 v_exp_f32 v18, v82
 v_add_f32 v15, v16, v17
 v_mfma_f32_16x16x32_bf16 v[72:75], v[28:31], v[124:127], v[72:75]
 v_add_u32 v8, 4294950912, v8
 ds_read_b64_tr_b16 v[24:25], v8 offset:0
 v_exp_f32 v19, v83
 v_mfma_f32_16x16x32_bf16 v[64:67], v[32:35], v[128:131], v[64:67]
 ds_read_b64_tr_b16 v[26:27], v8 offset:4096
 v_cvt_pk_bf16_f32 v104, v16, v17
 v_mfma_f32_16x16x32_bf16 v[72:75], v[32:35], v[132:135], v[72:75]
 v_add_u32 v9, 4294950912, v9
 ds_read_b64_tr_b16 v[28:29], v9 offset:0
 v_exp_f32 v16, v84
 v_mfma_f32_16x16x32_bf16 v[64:67], v[36:39], v[136:139], v[64:67]
 ds_read_b64_tr_b16 v[30:31], v9 offset:4096
 v_add_f32 v15, v15, v18
 v_exp_f32 v17, v85
 v_mfma_f32_16x16x32_bf16 v[72:75], v[36:39], v[140:143], v[72:75]
 v_add_u32 v12, 4294950912, v12
 ds_read_b64_tr_b16 v[32:33], v12 offset:0
 v_cvt_pk_bf16_f32 v105, v18, v19
 s_waitcnt lgkmcnt(5)
 v_mfma_f32_16x16x32_bf16 v[68:71], v[40:43], v[112:115], v[48:51]
 ds_read_b64_tr_b16 v[34:35], v12 offset:4096
 s_cmp_lg_u32 s47, 0
 s_cbranch_scc1 M_lump84
 v_accvgpr_read_b32 v248, a48
 v_accvgpr_read_b32 v249, a49
 v_accvgpr_read_b32 v250, a50
 v_accvgpr_read_b32 v251, a51
 v_pk_mul_f32 v[248:249], v[248:249], s[96:97]
 v_pk_mul_f32 v[250:251], v[250:251], s[96:97]
 v_cvt_pk_bf16_f32 v252, v248, v249
 v_cvt_pk_bf16_f32 v253, v250, v251
 v_accvgpr_read_b32 v248, a56
 v_accvgpr_read_b32 v249, a57
 v_accvgpr_read_b32 v250, a58
 v_accvgpr_read_b32 v251, a59
 v_pk_mul_f32 v[248:249], v[248:249], s[96:97]
 v_pk_mul_f32 v[250:251], v[250:251], s[96:97]
 v_cvt_pk_bf16_f32 v254, v248, v249
 v_cvt_pk_bf16_f32 v255, v250, v251
 s_nop 0
 v_permlane16_swap_b32 v252, v254
 v_permlane16_swap_b32 v253, v255
 v_accvgpr_write_b32 a248, v252
 v_accvgpr_write_b32 a249, v253
 v_accvgpr_write_b32 a250, v254
 v_accvgpr_write_b32 a251, v255
 v_accvgpr_read_b32 v248, a52
 v_accvgpr_read_b32 v249, a53
 v_accvgpr_read_b32 v250, a54
 v_accvgpr_read_b32 v251, a55
 v_pk_mul_f32 v[248:249], v[248:249], s[96:97]
 v_pk_mul_f32 v[250:251], v[250:251], s[96:97]
 v_cvt_pk_bf16_f32 v252, v248, v249
 v_cvt_pk_bf16_f32 v253, v250, v251
 v_accvgpr_read_b32 v248, a60
 v_accvgpr_read_b32 v249, a61
 v_accvgpr_read_b32 v250, a62
 v_accvgpr_read_b32 v251, a63
 v_pk_mul_f32 v[248:249], v[248:249], s[96:97]
 v_pk_mul_f32 v[250:251], v[250:251], s[96:97]
 v_cvt_pk_bf16_f32 v254, v248, v249
 v_cvt_pk_bf16_f32 v255, v250, v251
 s_nop 0
 v_permlane16_swap_b32 v252, v254
 v_permlane16_swap_b32 v253, v255
 v_accvgpr_write_b32 a252, v252
 v_accvgpr_write_b32 a253, v253
 v_accvgpr_write_b32 a254, v254
 v_accvgpr_write_b32 a255, v255
 v_mfma_f32_32x32x16_bf16 a[48:63], v[60:63], v[60:63], 0
M_lump84:
 v_mfma_f32_16x16x32_bf16 v[76:79], v[40:43], v[116:119], v[52:55]
 v_add_u32 v13, 4294950912, v13
 ds_read_b64_tr_b16 v[36:37], v13 offset:0
 v_add_f32 v15, v15, v19
 v_mfma_f32_16x16x32_bf16 v[68:71], v[44:47], v[120:123], v[68:71]
 ds_read_b64_tr_b16 v[38:39], v13 offset:4096
 v_exp_f32 v18, v86
 v_add_f32 v15, v15, v16
 v_mfma_f32_16x16x32_bf16 v[76:79], v[44:47], v[124:127], v[76:79]
 ds_read_b64_tr_b16 v[40:41], v8 offset:512
 v_exp_f32 v19, v87
 v_mfma_f32_16x16x32_bf16 v[68:71], v[240:243], v[128:131], v[68:71]
 ds_read_b64_tr_b16 v[42:43], v8 offset:4608
 v_cvt_pk_bf16_f32 v106, v16, v17
 v_mfma_f32_16x16x32_bf16 v[76:79], v[240:243], v[132:135], v[76:79]
 ds_read_b64_tr_b16 v[44:45], v9 offset:512
 v_add_f32 v15, v15, v17
 v_mfma_f32_16x16x32_bf16 v[68:71], v[244:247], v[136:139], v[68:71]
 ds_read_b64_tr_b16 v[46:47], v9 offset:4608
 v_exp_f32 v16, v88
 v_mfma_f32_16x16x32_bf16 v[76:79], v[244:247], v[140:143], v[76:79]
 ds_read_b64_tr_b16 v[240:241], v12 offset:512
 v_add_f32 v15, v15, v18
 s_waitcnt lgkmcnt(5)
 v_mfma_f32_16x16x32_bf16 v[144:147], v[24:27], v[96:99], v[144:147]
 ds_read_b64_tr_b16 v[242:243], v12 offset:4608
 v_exp_f32 v17, v89
 v_mfma_f32_16x16x32_bf16 v[148:151], v[24:27], v[100:103], v[148:151]
 ds_read_b64_tr_b16 v[244:245], v13 offset:512
 v_cvt_pk_bf16_f32 v107, v18, v19
 v_mfma_f32_16x16x32_bf16 v[152:155], v[28:31], v[96:99], v[152:155]
 ds_read_b64_tr_b16 v[246:247], v13 offset:4608
 v_add_f32 v15, v15, v19
 v_mfma_f32_16x16x32_bf16 v[156:159], v[28:31], v[100:103], v[156:159]
 v_exp_f32 v18, v90
 v_mfma_f32_16x16x32_bf16 v[160:163], v[32:35], v[96:99], v[160:163]
 v_add_f32 v57, v16, v17
 v_exp_f32 v19, v91
 v_mfma_f32_16x16x32_bf16 v[164:167], v[32:35], v[100:103], v[164:167]
 v_cvt_pk_bf16_f32 v108, v16, v17
 v_mfma_f32_16x16x32_bf16 v[168:171], v[36:39], v[96:99], v[168:171]
 v_exp_f32 v16, v92
 v_add_f32 v57, v57, v18
 v_mfma_f32_16x16x32_bf16 v[172:175], v[36:39], v[100:103], v[172:175]
 s_waitcnt lgkmcnt(0)
 s_barrier
 ds_read_b128 v[24:27], v4 offset:49152
 ds_read_b128 v[28:31], v5 offset:49152
 ds_read_b128 v[32:35], v4 offset:49664
 v_mfma_f32_16x16x32_bf16 v[176:179], v[40:43], v[96:99], v[176:179]
 v_exp_f32 v17, v93
 v_cvt_pk_bf16_f32 v109, v18, v19
 v_mfma_f32_16x16x32_bf16 v[180:183], v[40:43], v[100:103], v[180:183]
 ds_read_b128 v[36:39], v5 offset:49664
 v_add_f32 v57, v57, v19
 v_mfma_f32_16x16x32_bf16 v[184:187], v[44:47], v[96:99], v[184:187]
 v_exp_f32 v18, v94
 v_add_f32 v57, v57, v16
 v_mfma_f32_16x16x32_bf16 v[188:191], v[44:47], v[100:103], v[188:191]
 ds_read_b128 v[40:43], v4 offset:53248
 v_exp_f32 v19, v95
 v_mfma_f32_16x16x32_bf16 v[192:195], v[240:243], v[96:99], v[192:195]
 v_cvt_pk_bf16_f32 v110, v16, v17
 v_add_f32 v57, v57, v17
 v_add_f32 v57, v57, v18
 v_mfma_f32_16x16x32_bf16 v[196:199], v[240:243], v[100:103], v[196:199]
 ds_read_b128 v[44:47], v5 offset:53248
 v_cvt_pk_bf16_f32 v111, v18, v19
 v_mfma_f32_16x16x32_bf16 v[200:203], v[244:247], v[96:99], v[200:203]
 v_add_f32 v57, v57, v19
 v_max_f32 v58, v15, v57
 v_cmp_lt_f32 vcc, s49, v58
 v_mfma_f32_16x16x32_bf16 v[204:207], v[244:247], v[100:103], v[204:207]
 s_cbranch_vccnz M_stub_5_4
M_back_5_4:
 v_add_f32 v14, v14, v15
 v_add_f32 v56, v56, v57
 ds_read_b128 v[240:243], v4 offset:53760
 s_waitcnt lgkmcnt(3)
 v_mfma_f32_16x16x32_bf16 v[80:83], v[24:27], v[112:115], v[48:51]
 v_exp_f32 v16, v64
 v_exp_f32 v17, v65
 v_mfma_f32_16x16x32_bf16 v[88:91], v[24:27], v[116:119], v[52:55]
 ds_read_b128 v[244:247], v5 offset:53760
 v_mfma_f32_16x16x32_bf16 v[80:83], v[28:31], v[120:123], v[80:83]
 v_exp_f32 v18, v66
 v_add_f32 v15, v16, v17
 v_mfma_f32_16x16x32_bf16 v[88:91], v[28:31], v[124:127], v[88:91]
 ds_read_b64_tr_b16 v[24:25], v8 offset:49152
 v_exp_f32 v19, v67
 v_mfma_f32_16x16x32_bf16 v[80:83], v[32:35], v[128:131], v[80:83]
 ds_read_b64_tr_b16 v[26:27], v8 offset:53248
 v_cvt_pk_bf16_f32 v96, v16, v17
 v_mfma_f32_16x16x32_bf16 v[88:91], v[32:35], v[132:135], v[88:91]
 ds_read_b64_tr_b16 v[28:29], v9 offset:49152
 v_exp_f32 v16, v68
 v_mfma_f32_16x16x32_bf16 v[80:83], v[36:39], v[136:139], v[80:83]
 ds_read_b64_tr_b16 v[30:31], v9 offset:53248
 v_add_f32 v15, v15, v18
 v_exp_f32 v17, v69
 v_mfma_f32_16x16x32_bf16 v[88:91], v[36:39], v[140:143], v[88:91]
 ds_read_b64_tr_b16 v[32:33], v12 offset:49152
 v_cvt_pk_bf16_f32 v97, v18, v19
 s_waitcnt lgkmcnt(5)
 v_mfma_f32_16x16x32_bf16 v[84:87], v[40:43], v[112:115], v[48:51]
 ds_read_b64_tr_b16 v[34:35], v12 offset:53248
 s_cmp_lg_u32 s47, 0
 s_cbranch_scc1 M_lump100
 v_accvgpr_read_b32 v248, a64
 v_accvgpr_read_b32 v249, a65
 v_accvgpr_read_b32 v250, a66
 v_accvgpr_read_b32 v251, a67
 v_pk_mul_f32 v[248:249], v[248:249], s[96:97]
 v_pk_mul_f32 v[250:251], v[250:251], s[96:97]
 v_cvt_pk_bf16_f32 v252, v248, v249
 v_cvt_pk_bf16_f32 v253, v250, v251
 v_accvgpr_read_b32 v248, a72
 v_accvgpr_read_b32 v249, a73
 v_accvgpr_read_b32 v250, a74
 v_accvgpr_read_b32 v251, a75
 v_pk_mul_f32 v[248:249], v[248:249], s[96:97]
 v_pk_mul_f32 v[250:251], v[250:251], s[96:97]
 v_cvt_pk_bf16_f32 v254, v248, v249
 v_cvt_pk_bf16_f32 v255, v250, v251
 s_nop 0
 v_permlane16_swap_b32 v252, v254
 v_permlane16_swap_b32 v253, v255
 ds_write_b128 v3, v[252:255] offset:0
 v_accvgpr_read_b32 v248, a68
 v_accvgpr_read_b32 v249, a69
 v_accvgpr_read_b32 v250, a70
 v_accvgpr_read_b32 v251, a71
 v_pk_mul_f32 v[248:249], v[248:249], s[96:97]
 v_pk_mul_f32 v[250:251], v[250:251], s[96:97]
 v_cvt_pk_bf16_f32 v252, v248, v249
 v_cvt_pk_bf16_f32 v253, v250, v251
 v_accvgpr_read_b32 v248, a76
 v_accvgpr_read_b32 v249, a77
 v_accvgpr_read_b32 v250, a78
 v_accvgpr_read_b32 v251, a79
 v_pk_mul_f32 v[248:249], v[248:249], s[96:97]
 v_pk_mul_f32 v[250:251], v[250:251], s[96:97]
 v_cvt_pk_bf16_f32 v254, v248, v249
 v_cvt_pk_bf16_f32 v255, v250, v251
 s_nop 0
 v_permlane16_swap_b32 v252, v254
 v_permlane16_swap_b32 v253, v255
 ds_write_b128 v3, v[252:255] offset:1024
 v_mfma_f32_32x32x16_bf16 a[64:79], v[60:63], v[60:63], 0
M_lump100:
 v_mfma_f32_16x16x32_bf16 v[92:95], v[40:43], v[116:119], v[52:55]
 ds_read_b64_tr_b16 v[36:37], v13 offset:49152
 v_add_f32 v15, v15, v19
 v_mfma_f32_16x16x32_bf16 v[84:87], v[44:47], v[120:123], v[84:87]
 ds_read_b64_tr_b16 v[38:39], v13 offset:53248
 v_exp_f32 v18, v70
 v_add_f32 v15, v15, v16
 v_mfma_f32_16x16x32_bf16 v[92:95], v[44:47], v[124:127], v[92:95]
 ds_read_b64_tr_b16 v[40:41], v8 offset:49664
 v_exp_f32 v19, v71
 v_mfma_f32_16x16x32_bf16 v[84:87], v[240:243], v[128:131], v[84:87]
 ds_read_b64_tr_b16 v[42:43], v8 offset:53760
 v_cvt_pk_bf16_f32 v98, v16, v17
 v_mfma_f32_16x16x32_bf16 v[92:95], v[240:243], v[132:135], v[92:95]
 ds_read_b64_tr_b16 v[44:45], v9 offset:49664
 v_add_f32 v15, v15, v17
 v_mfma_f32_16x16x32_bf16 v[84:87], v[244:247], v[136:139], v[84:87]
 ds_read_b64_tr_b16 v[46:47], v9 offset:53760
 v_exp_f32 v16, v72
 v_mfma_f32_16x16x32_bf16 v[92:95], v[244:247], v[140:143], v[92:95]
 ds_read_b64_tr_b16 v[240:241], v12 offset:49664
 v_add_f32 v15, v15, v18
 s_waitcnt lgkmcnt(5)
 v_mfma_f32_16x16x32_bf16 v[144:147], v[24:27], v[104:107], v[144:147]
 ds_read_b64_tr_b16 v[242:243], v12 offset:53760
 v_exp_f32 v17, v73
 v_mfma_f32_16x16x32_bf16 v[148:151], v[24:27], v[108:111], v[148:151]
 ds_read_b64_tr_b16 v[244:245], v13 offset:49664
 v_cvt_pk_bf16_f32 v99, v18, v19
 v_mfma_f32_16x16x32_bf16 v[152:155], v[28:31], v[104:107], v[152:155]
 ds_read_b64_tr_b16 v[246:247], v13 offset:53760
 v_add_f32 v15, v15, v19
 v_mfma_f32_16x16x32_bf16 v[156:159], v[28:31], v[108:111], v[156:159]
 v_exp_f32 v18, v74
 v_mfma_f32_16x16x32_bf16 v[160:163], v[32:35], v[104:107], v[160:163]
 v_add_f32 v57, v16, v17
 v_exp_f32 v19, v75
 v_mfma_f32_16x16x32_bf16 v[164:167], v[32:35], v[108:111], v[164:167]
 v_cvt_pk_bf16_f32 v100, v16, v17
 v_mfma_f32_16x16x32_bf16 v[168:171], v[36:39], v[104:107], v[168:171]
 v_exp_f32 v16, v76
 v_add_f32 v57, v57, v18
 v_mfma_f32_16x16x32_bf16 v[172:175], v[36:39], v[108:111], v[172:175]
 s_waitcnt lgkmcnt(0)
 s_barrier
 ds_read_b128 v[24:27], v4 offset:32768
 ds_read_b128 v[28:31], v5 offset:32768
 ds_read_b128 v[32:35], v4 offset:33280
 v_mfma_f32_16x16x32_bf16 v[176:179], v[40:43], v[104:107], v[176:179]
 v_exp_f32 v17, v77
 v_cvt_pk_bf16_f32 v101, v18, v19
 v_mfma_f32_16x16x32_bf16 v[180:183], v[40:43], v[108:111], v[180:183]
 ds_read_b128 v[36:39], v5 offset:33280
 v_add_f32 v57, v57, v19
 v_mfma_f32_16x16x32_bf16 v[184:187], v[44:47], v[104:107], v[184:187]
 v_exp_f32 v18, v78
 v_add_f32 v57, v57, v16
 v_mfma_f32_16x16x32_bf16 v[188:191], v[44:47], v[108:111], v[188:191]
 ds_read_b128 v[40:43], v4 offset:36864
 v_exp_f32 v19, v79
 v_mfma_f32_16x16x32_bf16 v[192:195], v[240:243], v[104:107], v[192:195]
 v_cvt_pk_bf16_f32 v102, v16, v17
 v_add_f32 v57, v57, v17
 v_add_f32 v57, v57, v18
 v_mfma_f32_16x16x32_bf16 v[196:199], v[240:243], v[108:111], v[196:199]
 ds_read_b128 v[44:47], v5 offset:36864
 v_cvt_pk_bf16_f32 v103, v18, v19
 v_mfma_f32_16x16x32_bf16 v[200:203], v[244:247], v[104:107], v[200:203]
 v_add_f32 v57, v57, v19
 v_max_f32 v58, v15, v57
 v_cmp_lt_f32 vcc, s49, v58
 v_mfma_f32_16x16x32_bf16 v[204:207], v[244:247], v[108:111], v[204:207]
 s_cbranch_vccnz M_stub_6_5
M_back_6_5:
 v_add_f32 v14, v14, v15
 v_add_f32 v56, v56, v57
 ds_read_b128 v[240:243], v4 offset:37376
 s_waitcnt lgkmcnt(3)
 v_mfma_f32_16x16x32_bf16 v[64:67], v[24:27], v[112:115], v[48:51]
 v_exp_f32 v16, v80
 v_exp_f32 v17, v81
 v_mfma_f32_16x16x32_bf16 v[72:75], v[24:27], v[116:119], v[52:55]
 ds_read_b128 v[244:247], v5 offset:37376
 v_mfma_f32_16x16x32_bf16 v[64:67], v[28:31], v[120:123], v[64:67]
 v_exp_f32 v18, v82
 v_add_f32 v15, v16, v17
 v_mfma_f32_16x16x32_bf16 v[72:75], v[28:31], v[124:127], v[72:75]
 ds_read_b64_tr_b16 v[24:25], v8 offset:32768
 v_exp_f32 v19, v83
 v_mfma_f32_16x16x32_bf16 v[64:67], v[32:35], v[128:131], v[64:67]
 ds_read_b64_tr_b16 v[26:27], v8 offset:36864
 v_cvt_pk_bf16_f32 v104, v16, v17
 v_mfma_f32_16x16x32_bf16 v[72:75], v[32:35], v[132:135], v[72:75]
 ds_read_b64_tr_b16 v[28:29], v9 offset:32768
 v_exp_f32 v16, v84
 v_mfma_f32_16x16x32_bf16 v[64:67], v[36:39], v[136:139], v[64:67]
 ds_read_b64_tr_b16 v[30:31], v9 offset:36864
 v_add_f32 v15, v15, v18
 v_exp_f32 v17, v85
 v_mfma_f32_16x16x32_bf16 v[72:75], v[36:39], v[140:143], v[72:75]
 ds_read_b64_tr_b16 v[32:33], v12 offset:32768
 v_cvt_pk_bf16_f32 v105, v18, v19
 s_waitcnt lgkmcnt(5)
 v_mfma_f32_16x16x32_bf16 v[68:71], v[40:43], v[112:115], v[48:51]
 ds_read_b64_tr_b16 v[34:35], v12 offset:36864
 s_cmp_lg_u32 s47, 0
 s_cbranch_scc1 M_lump116
 v_accvgpr_read_b32 v248, a80
 v_accvgpr_read_b32 v249, a81
 v_accvgpr_read_b32 v250, a82
 v_accvgpr_read_b32 v251, a83
 v_pk_mul_f32 v[248:249], v[248:249], s[96:97]
 v_pk_mul_f32 v[250:251], v[250:251], s[96:97]
 v_cvt_pk_bf16_f32 v252, v248, v249
 v_cvt_pk_bf16_f32 v253, v250, v251
 v_accvgpr_read_b32 v248, a88
 v_accvgpr_read_b32 v249, a89
 v_accvgpr_read_b32 v250, a90
 v_accvgpr_read_b32 v251, a91
 v_pk_mul_f32 v[248:249], v[248:249], s[96:97]
 v_pk_mul_f32 v[250:251], v[250:251], s[96:97]
 v_cvt_pk_bf16_f32 v254, v248, v249
 v_cvt_pk_bf16_f32 v255, v250, v251
 s_nop 0
 v_permlane16_swap_b32 v252, v254
 v_permlane16_swap_b32 v253, v255
 ds_write_b128 v3, v[252:255] offset:2048
 v_accvgpr_read_b32 v248, a84
 v_accvgpr_read_b32 v249, a85
 v_accvgpr_read_b32 v250, a86
 v_accvgpr_read_b32 v251, a87
 v_pk_mul_f32 v[248:249], v[248:249], s[96:97]
 v_pk_mul_f32 v[250:251], v[250:251], s[96:97]
 v_cvt_pk_bf16_f32 v252, v248, v249
 v_cvt_pk_bf16_f32 v253, v250, v251
 v_accvgpr_read_b32 v248, a92
 v_accvgpr_read_b32 v249, a93
 v_accvgpr_read_b32 v250, a94
 v_accvgpr_read_b32 v251, a95
 v_pk_mul_f32 v[248:249], v[248:249], s[96:97]
 v_pk_mul_f32 v[250:251], v[250:251], s[96:97]
 v_cvt_pk_bf16_f32 v254, v248, v249
 v_cvt_pk_bf16_f32 v255, v250, v251
 s_nop 0
 v_permlane16_swap_b32 v252, v254
 v_permlane16_swap_b32 v253, v255
 ds_write_b128 v3, v[252:255] offset:3072
 v_mfma_f32_32x32x16_bf16 a[80:95], v[60:63], v[60:63], 0
M_lump116:
 v_mfma_f32_16x16x32_bf16 v[76:79], v[40:43], v[116:119], v[52:55]
 ds_read_b64_tr_b16 v[36:37], v13 offset:32768
 v_add_f32 v15, v15, v19
 v_mfma_f32_16x16x32_bf16 v[68:71], v[44:47], v[120:123], v[68:71]
 ds_read_b64_tr_b16 v[38:39], v13 offset:36864
 v_exp_f32 v18, v86
 v_add_f32 v15, v15, v16
 v_mfma_f32_16x16x32_bf16 v[76:79], v[44:47], v[124:127], v[76:79]
 ds_read_b64_tr_b16 v[40:41], v8 offset:33280
 v_exp_f32 v19, v87
 v_mfma_f32_16x16x32_bf16 v[68:71], v[240:243], v[128:131], v[68:71]
 ds_read_b64_tr_b16 v[42:43], v8 offset:37376
 v_cvt_pk_bf16_f32 v106, v16, v17
 v_mfma_f32_16x16x32_bf16 v[76:79], v[240:243], v[132:135], v[76:79]
 ds_read_b64_tr_b16 v[44:45], v9 offset:33280
 v_add_f32 v15, v15, v17
 v_mfma_f32_16x16x32_bf16 v[68:71], v[244:247], v[136:139], v[68:71]
 ds_read_b64_tr_b16 v[46:47], v9 offset:37376
 v_exp_f32 v16, v88
 v_mfma_f32_16x16x32_bf16 v[76:79], v[244:247], v[140:143], v[76:79]
 ds_read_b64_tr_b16 v[240:241], v12 offset:33280
 v_add_f32 v15, v15, v18
 s_waitcnt lgkmcnt(5)
 v_mfma_f32_16x16x32_bf16 v[144:147], v[24:27], v[96:99], v[144:147]
 ds_read_b64_tr_b16 v[242:243], v12 offset:37376
 v_exp_f32 v17, v89
 v_mfma_f32_16x16x32_bf16 v[148:151], v[24:27], v[100:103], v[148:151]
 ds_read_b64_tr_b16 v[244:245], v13 offset:33280
 v_cvt_pk_bf16_f32 v107, v18, v19
 v_mfma_f32_16x16x32_bf16 v[152:155], v[28:31], v[96:99], v[152:155]
 ds_read_b64_tr_b16 v[246:247], v13 offset:37376
 v_add_f32 v15, v15, v19
 v_mfma_f32_16x16x32_bf16 v[156:159], v[28:31], v[100:103], v[156:159]
 v_exp_f32 v18, v90
 v_mfma_f32_16x16x32_bf16 v[160:163], v[32:35], v[96:99], v[160:163]
 v_add_f32 v57, v16, v17
 v_exp_f32 v19, v91
 v_mfma_f32_16x16x32_bf16 v[164:167], v[32:35], v[100:103], v[164:167]
 v_cvt_pk_bf16_f32 v108, v16, v17
 v_mfma_f32_16x16x32_bf16 v[168:171], v[36:39], v[96:99], v[168:171]
 v_exp_f32 v16, v92
 v_add_f32 v57, v57, v18
 v_mfma_f32_16x16x32_bf16 v[172:175], v[36:39], v[100:103], v[172:175]
 s_waitcnt lgkmcnt(0)
 s_barrier
 v_add_u32 v4, 65536, v4
 ds_read_b128 v[24:27], v4 offset:0
 v_add_u32 v5, 65536, v5
 ds_read_b128 v[28:31], v5 offset:0
 ds_read_b128 v[32:35], v4 offset:512
 v_mfma_f32_16x16x32_bf16 v[176:179], v[40:43], v[96:99], v[176:179]
 v_exp_f32 v17, v93
 v_cvt_pk_bf16_f32 v109, v18, v19
 v_mfma_f32_16x16x32_bf16 v[180:183], v[40:43], v[100:103], v[180:183]
 ds_read_b128 v[36:39], v5 offset:512
 v_add_f32 v57, v57, v19
 v_mfma_f32_16x16x32_bf16 v[184:187], v[44:47], v[96:99], v[184:187]
 v_exp_f32 v18, v94
 v_add_f32 v57, v57, v16
 v_mfma_f32_16x16x32_bf16 v[188:191], v[44:47], v[100:103], v[188:191]
 ds_read_b128 v[40:43], v4 offset:4096
 v_exp_f32 v19, v95
 v_mfma_f32_16x16x32_bf16 v[192:195], v[240:243], v[96:99], v[192:195]
 v_cvt_pk_bf16_f32 v110, v16, v17
 v_add_f32 v57, v57, v17
 v_add_f32 v57, v57, v18
 v_mfma_f32_16x16x32_bf16 v[196:199], v[240:243], v[100:103], v[196:199]
 ds_read_b128 v[44:47], v5 offset:4096
 v_cvt_pk_bf16_f32 v111, v18, v19
 v_mfma_f32_16x16x32_bf16 v[200:203], v[244:247], v[96:99], v[200:203]
 v_add_f32 v57, v57, v19
 v_max_f32 v58, v15, v57
 v_cmp_lt_f32 vcc, s49, v58
 v_mfma_f32_16x16x32_bf16 v[204:207], v[244:247], v[100:103], v[204:207]
 s_cbranch_vccnz M_stub_7_6
M_back_7_6:
 v_add_f32 v14, v14, v15
 v_add_f32 v56, v56, v57
 ds_read_b128 v[240:243], v4 offset:4608
 s_waitcnt lgkmcnt(3)
 v_mfma_f32_16x16x32_bf16 v[80:83], v[24:27], v[112:115], v[48:51]
 v_exp_f32 v16, v64
 v_exp_f32 v17, v65
 v_mfma_f32_16x16x32_bf16 v[88:91], v[24:27], v[116:119], v[52:55]
 ds_read_b128 v[244:247], v5 offset:4608
 v_mfma_f32_16x16x32_bf16 v[80:83], v[28:31], v[120:123], v[80:83]
 v_exp_f32 v18, v66
 v_add_f32 v15, v16, v17
 v_mfma_f32_16x16x32_bf16 v[88:91], v[28:31], v[124:127], v[88:91]
 v_add_u32 v8, 65536, v8
 ds_read_b64_tr_b16 v[24:25], v8 offset:0
 v_exp_f32 v19, v67
 v_mfma_f32_16x16x32_bf16 v[80:83], v[32:35], v[128:131], v[80:83]
 ds_read_b64_tr_b16 v[26:27], v8 offset:4096
 v_cvt_pk_bf16_f32 v96, v16, v17
 v_mfma_f32_16x16x32_bf16 v[88:91], v[32:35], v[132:135], v[88:91]
 v_add_u32 v9, 65536, v9
 ds_read_b64_tr_b16 v[28:29], v9 offset:0
 v_exp_f32 v16, v68
 v_mfma_f32_16x16x32_bf16 v[80:83], v[36:39], v[136:139], v[80:83]
 ds_read_b64_tr_b16 v[30:31], v9 offset:4096
 v_add_f32 v15, v15, v18
 v_exp_f32 v17, v69
 v_mfma_f32_16x16x32_bf16 v[88:91], v[36:39], v[140:143], v[88:91]
 v_add_u32 v12, 65536, v12
 ds_read_b64_tr_b16 v[32:33], v12 offset:0
 s_waitcnt lgkmcnt(5)
 v_mfma_f32_16x16x32_bf16 v[84:87], v[40:43], v[112:115], v[48:51]
 ds_read_b64_tr_b16 v[34:35], v12 offset:4096
 v_cvt_pk_bf16_f32 v97, v18, v19
 v_mfma_f32_16x16x32_bf16 v[92:95], v[40:43], v[116:119], v[52:55]
 v_add_u32 v13, 65536, v13
 ds_read_b64_tr_b16 v[36:37], v13 offset:0
 v_add_f32 v15, v15, v19
 v_mfma_f32_16x16x32_bf16 v[84:87], v[44:47], v[120:123], v[84:87]
 ds_read_b64_tr_b16 v[38:39], v13 offset:4096
 v_exp_f32 v18, v70
 v_add_f32 v15, v15, v16
 v_mfma_f32_16x16x32_bf16 v[92:95], v[44:47], v[124:127], v[92:95]
 ds_read_b64_tr_b16 v[40:41], v8 offset:512
 v_exp_f32 v19, v71
 v_mfma_f32_16x16x32_bf16 v[84:87], v[240:243], v[128:131], v[84:87]
 ds_read_b64_tr_b16 v[42:43], v8 offset:4608
 v_cvt_pk_bf16_f32 v98, v16, v17
 v_mfma_f32_16x16x32_bf16 v[92:95], v[240:243], v[132:135], v[92:95]
 ds_read_b64_tr_b16 v[44:45], v9 offset:512
 v_add_f32 v15, v15, v17
 v_mfma_f32_16x16x32_bf16 v[84:87], v[244:247], v[136:139], v[84:87]
 ds_read_b64_tr_b16 v[46:47], v9 offset:4608
 v_exp_f32 v16, v72
 v_mfma_f32_16x16x32_bf16 v[92:95], v[244:247], v[140:143], v[92:95]
 ds_read_b64_tr_b16 v[240:241], v12 offset:512
 v_add_f32 v15, v15, v18
 s_waitcnt lgkmcnt(5)
 v_mfma_f32_16x16x32_bf16 v[144:147], v[24:27], v[104:107], v[144:147]
 ds_read_b64_tr_b16 v[242:243], v12 offset:4608
 v_exp_f32 v17, v73
 v_mfma_f32_16x16x32_bf16 v[148:151], v[24:27], v[108:111], v[148:151]
 ds_read_b64_tr_b16 v[244:245], v13 offset:512
 v_cvt_pk_bf16_f32 v99, v18, v19
 v_mfma_f32_16x16x32_bf16 v[152:155], v[28:31], v[104:107], v[152:155]
 ds_read_b64_tr_b16 v[246:247], v13 offset:4608
 v_add_f32 v15, v15, v19
 v_mfma_f32_16x16x32_bf16 v[156:159], v[28:31], v[108:111], v[156:159]
 v_exp_f32 v18, v74
 v_mfma_f32_16x16x32_bf16 v[160:163], v[32:35], v[104:107], v[160:163]
 v_add_f32 v57, v16, v17
 v_exp_f32 v19, v75
 v_mfma_f32_16x16x32_bf16 v[164:167], v[32:35], v[108:111], v[164:167]
 v_cvt_pk_bf16_f32 v100, v16, v17
 v_mfma_f32_16x16x32_bf16 v[168:171], v[36:39], v[104:107], v[168:171]
 v_exp_f32 v16, v76
 v_add_f32 v57, v57, v18
 v_mfma_f32_16x16x32_bf16 v[172:175], v[36:39], v[108:111], v[172:175]
 s_waitcnt lgkmcnt(0)
 s_barrier
 v_add_u32 v4, 4294836224, v4
 ds_read_b128 v[24:27], v4 offset:0
 v_add_u32 v5, 4294836224, v5
 ds_read_b128 v[28:31], v5 offset:0
 ds_read_b128 v[32:35], v4 offset:512
 v_mfma_f32_16x16x32_bf16 v[176:179], v[40:43], v[104:107], v[176:179]
 v_exp_f32 v17, v77
 v_cvt_pk_bf16_f32 v101, v18, v19
 v_mfma_f32_16x16x32_bf16 v[180:183], v[40:43], v[108:111], v[180:183]
 ds_read_b128 v[36:39], v5 offset:512
 v_add_f32 v57, v57, v19
 v_mfma_f32_16x16x32_bf16 v[184:187], v[44:47], v[104:107], v[184:187]
 v_exp_f32 v18, v78
 v_add_f32 v57, v57, v16
 v_mfma_f32_16x16x32_bf16 v[188:191], v[44:47], v[108:111], v[188:191]
 ds_read_b128 v[40:43], v4 offset:4096
 v_exp_f32 v19, v79
 v_mfma_f32_16x16x32_bf16 v[192:195], v[240:243], v[104:107], v[192:195]
 v_cvt_pk_bf16_f32 v102, v16, v17
 v_add_f32 v57, v57, v17
 v_add_f32 v57, v57, v18
 v_mfma_f32_16x16x32_bf16 v[196:199], v[240:243], v[108:111], v[196:199]
 ds_read_b128 v[44:47], v5 offset:4096
 v_cvt_pk_bf16_f32 v103, v18, v19
 v_mfma_f32_16x16x32_bf16 v[200:203], v[244:247], v[104:107], v[200:203]
 v_add_f32 v57, v57, v19
 v_max_f32 v58, v15, v57
 v_cmp_lt_f32 vcc, s49, v58
 v_mfma_f32_16x16x32_bf16 v[204:207], v[244:247], v[108:111], v[204:207]
 s_cbranch_vccnz M_stub_8_7
M_back_8_7:
 v_add_f32 v14, v14, v15
 v_add_f32 v56, v56, v57
 ds_read_b128 v[240:243], v4 offset:4608
 s_waitcnt lgkmcnt(3)
 v_mfma_f32_16x16x32_bf16 v[64:67], v[24:27], v[112:115], v[48:51]
 v_exp_f32 v16, v80
 v_exp_f32 v17, v81
 v_mfma_f32_16x16x32_bf16 v[72:75], v[24:27], v[116:119], v[52:55]
 ds_read_b128 v[244:247], v5 offset:4608
 v_mfma_f32_16x16x32_bf16 v[64:67], v[28:31], v[120:123], v[64:67]
 v_exp_f32 v18, v82
 v_add_f32 v15, v16, v17
 v_mfma_f32_16x16x32_bf16 v[72:75], v[28:31], v[124:127], v[72:75]
 v_add_u32 v8, 4294836224, v8
 ds_read_b64_tr_b16 v[24:25], v8 offset:0
 v_exp_f32 v19, v83
 v_mfma_f32_16x16x32_bf16 v[64:67], v[32:35], v[128:131], v[64:67]
 ds_read_b64_tr_b16 v[26:27], v8 offset:4096
 v_cvt_pk_bf16_f32 v104, v16, v17
 v_mfma_f32_16x16x32_bf16 v[72:75], v[32:35], v[132:135], v[72:75]
 v_add_u32 v9, 4294836224, v9
 ds_read_b64_tr_b16 v[28:29], v9 offset:0
 v_exp_f32 v16, v84
 v_mfma_f32_16x16x32_bf16 v[64:67], v[36:39], v[136:139], v[64:67]
 ds_read_b64_tr_b16 v[30:31], v9 offset:4096
 v_add_f32 v15, v15, v18
 v_exp_f32 v17, v85
 v_mfma_f32_16x16x32_bf16 v[72:75], v[36:39], v[140:143], v[72:75]
 v_add_u32 v12, 4294836224, v12
 ds_read_b64_tr_b16 v[32:33], v12 offset:0
 v_cvt_pk_bf16_f32 v105, v18, v19
 s_waitcnt lgkmcnt(5)
 v_mfma_f32_16x16x32_bf16 v[68:71], v[40:43], v[112:115], v[48:51]
 ds_read_b64_tr_b16 v[34:35], v12 offset:4096
 s_cmp_lg_u32 s47, 0
 s_cbranch_scc1 M_lump148
 v_accvgpr_read_b32 v248, a96
 v_accvgpr_read_b32 v249, a97
 v_accvgpr_read_b32 v250, a98
 v_accvgpr_read_b32 v251, a99
 v_pk_mul_f32 v[248:249], v[248:249], s[96:97]
 v_pk_mul_f32 v[250:251], v[250:251], s[96:97]
 v_cvt_pk_bf16_f32 v252, v248, v249
 v_cvt_pk_bf16_f32 v253, v250, v251
 v_accvgpr_read_b32 v248, a104
 v_accvgpr_read_b32 v249, a105
 v_accvgpr_read_b32 v250, a106
 v_accvgpr_read_b32 v251, a107
 v_pk_mul_f32 v[248:249], v[248:249], s[96:97]
 v_pk_mul_f32 v[250:251], v[250:251], s[96:97]
 v_cvt_pk_bf16_f32 v254, v248, v249
 v_cvt_pk_bf16_f32 v255, v250, v251
 s_nop 0
 v_permlane16_swap_b32 v252, v254
 v_permlane16_swap_b32 v253, v255
 ds_write_b128 v3, v[252:255] offset:0
 v_accvgpr_read_b32 v248, a100
 v_accvgpr_read_b32 v249, a101
 v_accvgpr_read_b32 v250, a102
 v_accvgpr_read_b32 v251, a103
 v_pk_mul_f32 v[248:249], v[248:249], s[96:97]
 v_pk_mul_f32 v[250:251], v[250:251], s[96:97]
 v_cvt_pk_bf16_f32 v252, v248, v249
 v_cvt_pk_bf16_f32 v253, v250, v251
 v_accvgpr_read_b32 v248, a108
 v_accvgpr_read_b32 v249, a109
 v_accvgpr_read_b32 v250, a110
 v_accvgpr_read_b32 v251, a111
 v_pk_mul_f32 v[248:249], v[248:249], s[96:97]
 v_pk_mul_f32 v[250:251], v[250:251], s[96:97]
 v_cvt_pk_bf16_f32 v254, v248, v249
 v_cvt_pk_bf16_f32 v255, v250, v251
 s_nop 0
 v_permlane16_swap_b32 v252, v254
 v_permlane16_swap_b32 v253, v255
 ds_write_b128 v3, v[252:255] offset:1024
 v_mfma_f32_32x32x16_bf16 a[96:111], v[60:63], v[60:63], 0
M_lump148:
 v_mfma_f32_16x16x32_bf16 v[76:79], v[40:43], v[116:119], v[52:55]
 v_add_u32 v13, 4294836224, v13
 ds_read_b64_tr_b16 v[36:37], v13 offset:0
 v_add_f32 v15, v15, v19
 v_mfma_f32_16x16x32_bf16 v[68:71], v[44:47], v[120:123], v[68:71]
 ds_read_b64_tr_b16 v[38:39], v13 offset:4096
 v_exp_f32 v18, v86
 v_add_f32 v15, v15, v16
 v_mfma_f32_16x16x32_bf16 v[76:79], v[44:47], v[124:127], v[76:79]
 ds_read_b64_tr_b16 v[40:41], v8 offset:512
 v_exp_f32 v19, v87
 v_mfma_f32_16x16x32_bf16 v[68:71], v[240:243], v[128:131], v[68:71]
 ds_read_b64_tr_b16 v[42:43], v8 offset:4608
 v_cvt_pk_bf16_f32 v106, v16, v17
 v_mfma_f32_16x16x32_bf16 v[76:79], v[240:243], v[132:135], v[76:79]
 ds_read_b64_tr_b16 v[44:45], v9 offset:512
 v_add_f32 v15, v15, v17
 v_mfma_f32_16x16x32_bf16 v[68:71], v[244:247], v[136:139], v[68:71]
 ds_read_b64_tr_b16 v[46:47], v9 offset:4608
 v_exp_f32 v16, v88
 v_mfma_f32_16x16x32_bf16 v[76:79], v[244:247], v[140:143], v[76:79]
 ds_read_b64_tr_b16 v[240:241], v12 offset:512
 v_add_f32 v15, v15, v18
 s_waitcnt lgkmcnt(5)
 v_mfma_f32_16x16x32_bf16 v[144:147], v[24:27], v[96:99], v[144:147]
 ds_read_b64_tr_b16 v[242:243], v12 offset:4608
 v_exp_f32 v17, v89
 v_mfma_f32_16x16x32_bf16 v[148:151], v[24:27], v[100:103], v[148:151]
 ds_read_b64_tr_b16 v[244:245], v13 offset:512
 v_cvt_pk_bf16_f32 v107, v18, v19
 v_mfma_f32_16x16x32_bf16 v[152:155], v[28:31], v[96:99], v[152:155]
 ds_read_b64_tr_b16 v[246:247], v13 offset:4608
 v_add_f32 v15, v15, v19
 v_mfma_f32_16x16x32_bf16 v[156:159], v[28:31], v[100:103], v[156:159]
 v_exp_f32 v18, v90
 v_mfma_f32_16x16x32_bf16 v[160:163], v[32:35], v[96:99], v[160:163]
 v_add_f32 v57, v16, v17
 v_exp_f32 v19, v91
 v_mfma_f32_16x16x32_bf16 v[164:167], v[32:35], v[100:103], v[164:167]
 v_cvt_pk_bf16_f32 v108, v16, v17
 v_mfma_f32_16x16x32_bf16 v[168:171], v[36:39], v[96:99], v[168:171]
 v_exp_f32 v16, v92
 v_add_f32 v57, v57, v18
 v_mfma_f32_16x16x32_bf16 v[172:175], v[36:39], v[100:103], v[172:175]
 s_waitcnt lgkmcnt(0)
 s_barrier
 ds_read_b128 v[24:27], v4 offset:32768
 ds_read_b128 v[28:31], v5 offset:32768
 ds_read_b128 v[32:35], v4 offset:33280
 v_mfma_f32_16x16x32_bf16 v[176:179], v[40:43], v[96:99], v[176:179]
 v_exp_f32 v17, v93
 v_cvt_pk_bf16_f32 v109, v18, v19
 v_mfma_f32_16x16x32_bf16 v[180:183], v[40:43], v[100:103], v[180:183]
 ds_read_b128 v[36:39], v5 offset:33280
 v_add_f32 v57, v57, v19
 v_mfma_f32_16x16x32_bf16 v[184:187], v[44:47], v[96:99], v[184:187]
 v_exp_f32 v18, v94
 v_add_f32 v57, v57, v16
 v_mfma_f32_16x16x32_bf16 v[188:191], v[44:47], v[100:103], v[188:191]
 ds_read_b128 v[40:43], v4 offset:36864
 v_exp_f32 v19, v95
 v_mfma_f32_16x16x32_bf16 v[192:195], v[240:243], v[96:99], v[192:195]
 v_cvt_pk_bf16_f32 v110, v16, v17
 v_add_f32 v57, v57, v17
 v_add_f32 v57, v57, v18
 v_mfma_f32_16x16x32_bf16 v[196:199], v[240:243], v[100:103], v[196:199]
 ds_read_b128 v[44:47], v5 offset:36864
 v_cvt_pk_bf16_f32 v111, v18, v19
 v_mfma_f32_16x16x32_bf16 v[200:203], v[244:247], v[96:99], v[200:203]
 v_add_f32 v57, v57, v19
 v_max_f32 v58, v15, v57
 v_cmp_lt_f32 vcc, s49, v58
 v_mfma_f32_16x16x32_bf16 v[204:207], v[244:247], v[100:103], v[204:207]
 s_cbranch_vccnz M_stub_9_8
M_back_9_8:
 v_add_f32 v14, v14, v15
 v_add_f32 v56, v56, v57
 ds_read_b128 v[240:243], v4 offset:37376
 s_waitcnt lgkmcnt(3)
 v_mfma_f32_16x16x32_bf16 v[80:83], v[24:27], v[112:115], v[48:51]
 v_exp_f32 v16, v64
 v_exp_f32 v17, v65
 v_mfma_f32_16x16x32_bf16 v[88:91], v[24:27], v[116:119], v[52:55]
 ds_read_b128 v[244:247], v5 offset:37376
 v_mfma_f32_16x16x32_bf16 v[80:83], v[28:31], v[120:123], v[80:83]
 v_exp_f32 v18, v66
 v_add_f32 v15, v16, v17
 v_mfma_f32_16x16x32_bf16 v[88:91], v[28:31], v[124:127], v[88:91]
 ds_read_b64_tr_b16 v[24:25], v8 offset:32768
 v_exp_f32 v19, v67
 v_mfma_f32_16x16x32_bf16 v[80:83], v[32:35], v[128:131], v[80:83]
 ds_read_b64_tr_b16 v[26:27], v8 offset:36864
 v_cvt_pk_bf16_f32 v96, v16, v17
 v_mfma_f32_16x16x32_bf16 v[88:91], v[32:35], v[132:135], v[88:91]
 ds_read_b64_tr_b16 v[28:29], v9 offset:32768
 v_exp_f32 v16, v68
 v_mfma_f32_16x16x32_bf16 v[80:83], v[36:39], v[136:139], v[80:83]
 ds_read_b64_tr_b16 v[30:31], v9 offset:36864
 v_add_f32 v15, v15, v18
 v_exp_f32 v17, v69
 v_mfma_f32_16x16x32_bf16 v[88:91], v[36:39], v[140:143], v[88:91]
 ds_read_b64_tr_b16 v[32:33], v12 offset:32768
 v_cvt_pk_bf16_f32 v97, v18, v19
 s_waitcnt lgkmcnt(5)
 v_mfma_f32_16x16x32_bf16 v[84:87], v[40:43], v[112:115], v[48:51]
 ds_read_b64_tr_b16 v[34:35], v12 offset:36864
 s_cmp_lg_u32 s47, 0
 s_cbranch_scc1 M_lump164
 v_accvgpr_read_b32 v248, a112
 v_accvgpr_read_b32 v249, a113
 v_accvgpr_read_b32 v250, a114
 v_accvgpr_read_b32 v251, a115
 v_pk_mul_f32 v[248:249], v[248:249], s[96:97]
 v_pk_mul_f32 v[250:251], v[250:251], s[96:97]
 v_cvt_pk_bf16_f32 v252, v248, v249
 v_cvt_pk_bf16_f32 v253, v250, v251
 v_accvgpr_read_b32 v248, a120
 v_accvgpr_read_b32 v249, a121
 v_accvgpr_read_b32 v250, a122
 v_accvgpr_read_b32 v251, a123
 v_pk_mul_f32 v[248:249], v[248:249], s[96:97]
 v_pk_mul_f32 v[250:251], v[250:251], s[96:97]
 v_cvt_pk_bf16_f32 v254, v248, v249
 v_cvt_pk_bf16_f32 v255, v250, v251
 s_nop 0
 v_permlane16_swap_b32 v252, v254
 v_permlane16_swap_b32 v253, v255
 ds_write_b128 v3, v[252:255] offset:2048
 v_accvgpr_read_b32 v248, a116
 v_accvgpr_read_b32 v249, a117
 v_accvgpr_read_b32 v250, a118
 v_accvgpr_read_b32 v251, a119
 v_pk_mul_f32 v[248:249], v[248:249], s[96:97]
 v_pk_mul_f32 v[250:251], v[250:251], s[96:97]
 v_cvt_pk_bf16_f32 v252, v248, v249
 v_cvt_pk_bf16_f32 v253, v250, v251
 v_accvgpr_read_b32 v248, a124
 v_accvgpr_read_b32 v249, a125
 v_accvgpr_read_b32 v250, a126
 v_accvgpr_read_b32 v251, a127
 v_pk_mul_f32 v[248:249], v[248:249], s[96:97]
 v_pk_mul_f32 v[250:251], v[250:251], s[96:97]
 v_cvt_pk_bf16_f32 v254, v248, v249
 v_cvt_pk_bf16_f32 v255, v250, v251
 s_nop 0
 v_permlane16_swap_b32 v252, v254
 v_permlane16_swap_b32 v253, v255
 ds_write_b128 v3, v[252:255] offset:3072
 v_mfma_f32_32x32x16_bf16 a[112:127], v[60:63], v[60:63], 0
M_lump164:
 v_mfma_f32_16x16x32_bf16 v[92:95], v[40:43], v[116:119], v[52:55]
 ds_read_b64_tr_b16 v[36:37], v13 offset:32768
 v_add_f32 v15, v15, v19
 v_mfma_f32_16x16x32_bf16 v[84:87], v[44:47], v[120:123], v[84:87]
 ds_read_b64_tr_b16 v[38:39], v13 offset:36864
 v_exp_f32 v18, v70
 v_add_f32 v15, v15, v16
 v_mfma_f32_16x16x32_bf16 v[92:95], v[44:47], v[124:127], v[92:95]
 ds_read_b64_tr_b16 v[40:41], v8 offset:33280
 v_exp_f32 v19, v71
 v_mfma_f32_16x16x32_bf16 v[84:87], v[240:243], v[128:131], v[84:87]
 ds_read_b64_tr_b16 v[42:43], v8 offset:37376
 v_cvt_pk_bf16_f32 v98, v16, v17
 v_mfma_f32_16x16x32_bf16 v[92:95], v[240:243], v[132:135], v[92:95]
 ds_read_b64_tr_b16 v[44:45], v9 offset:33280
 v_add_f32 v15, v15, v17
 v_mfma_f32_16x16x32_bf16 v[84:87], v[244:247], v[136:139], v[84:87]
 ds_read_b64_tr_b16 v[46:47], v9 offset:37376
 v_exp_f32 v16, v72
 v_mfma_f32_16x16x32_bf16 v[92:95], v[244:247], v[140:143], v[92:95]
 ds_read_b64_tr_b16 v[240:241], v12 offset:33280
 v_add_f32 v15, v15, v18
 s_waitcnt lgkmcnt(5)
 v_mfma_f32_16x16x32_bf16 v[144:147], v[24:27], v[104:107], v[144:147]
 ds_read_b64_tr_b16 v[242:243], v12 offset:37376
 v_exp_f32 v17, v73
 v_mfma_f32_16x16x32_bf16 v[148:151], v[24:27], v[108:111], v[148:151]
 ds_read_b64_tr_b16 v[244:245], v13 offset:33280
 v_cvt_pk_bf16_f32 v99, v18, v19
 v_mfma_f32_16x16x32_bf16 v[152:155], v[28:31], v[104:107], v[152:155]
 ds_read_b64_tr_b16 v[246:247], v13 offset:37376
 v_add_f32 v15, v15, v19
 v_mfma_f32_16x16x32_bf16 v[156:159], v[28:31], v[108:111], v[156:159]
 v_exp_f32 v18, v74
 v_mfma_f32_16x16x32_bf16 v[160:163], v[32:35], v[104:107], v[160:163]
 v_add_f32 v57, v16, v17
 v_exp_f32 v19, v75
 v_mfma_f32_16x16x32_bf16 v[164:167], v[32:35], v[108:111], v[164:167]
 v_cvt_pk_bf16_f32 v100, v16, v17
 v_mfma_f32_16x16x32_bf16 v[168:171], v[36:39], v[104:107], v[168:171]
 v_exp_f32 v16, v76
 v_add_f32 v57, v57, v18
 v_mfma_f32_16x16x32_bf16 v[172:175], v[36:39], v[108:111], v[172:175]
 s_waitcnt lgkmcnt(0)
 s_barrier
 ds_read_b128 v[24:27], v4 offset:16384
 ds_read_b128 v[28:31], v5 offset:16384
 ds_read_b128 v[32:35], v4 offset:16896
 v_mfma_f32_16x16x32_bf16 v[176:179], v[40:43], v[104:107], v[176:179]
 v_exp_f32 v17, v77
 v_cvt_pk_bf16_f32 v101, v18, v19
 v_mfma_f32_16x16x32_bf16 v[180:183], v[40:43], v[108:111], v[180:183]
 ds_read_b128 v[36:39], v5 offset:16896
 v_add_f32 v57, v57, v19
 v_mfma_f32_16x16x32_bf16 v[184:187], v[44:47], v[104:107], v[184:187]
 v_exp_f32 v18, v78
 v_add_f32 v57, v57, v16
 v_mfma_f32_16x16x32_bf16 v[188:191], v[44:47], v[108:111], v[188:191]
 ds_read_b128 v[40:43], v4 offset:20480
 v_exp_f32 v19, v79
 v_mfma_f32_16x16x32_bf16 v[192:195], v[240:243], v[104:107], v[192:195]
 v_cvt_pk_bf16_f32 v102, v16, v17
 v_add_f32 v57, v57, v17
 v_add_f32 v57, v57, v18
 v_mfma_f32_16x16x32_bf16 v[196:199], v[240:243], v[108:111], v[196:199]
 ds_read_b128 v[44:47], v5 offset:20480
 v_cvt_pk_bf16_f32 v103, v18, v19
 v_mfma_f32_16x16x32_bf16 v[200:203], v[244:247], v[104:107], v[200:203]
 v_add_f32 v57, v57, v19
 v_max_f32 v58, v15, v57
 v_cmp_lt_f32 vcc, s49, v58
 v_mfma_f32_16x16x32_bf16 v[204:207], v[244:247], v[108:111], v[204:207]
 s_cbranch_vccnz M_stub_10_9
M_back_10_9:
 v_add_f32 v14, v14, v15
 v_add_f32 v56, v56, v57
 ds_read_b128 v[240:243], v4 offset:20992
 s_waitcnt lgkmcnt(3)
 v_mfma_f32_16x16x32_bf16 v[64:67], v[24:27], v[112:115], v[48:51]
 v_exp_f32 v16, v80
 v_exp_f32 v17, v81
 v_mfma_f32_16x16x32_bf16 v[72:75], v[24:27], v[116:119], v[52:55]
 ds_read_b128 v[244:247], v5 offset:20992
 v_mfma_f32_16x16x32_bf16 v[64:67], v[28:31], v[120:123], v[64:67]
 v_exp_f32 v18, v82
 v_add_f32 v15, v16, v17
 v_mfma_f32_16x16x32_bf16 v[72:75], v[28:31], v[124:127], v[72:75]
 ds_read_b64_tr_b16 v[24:25], v8 offset:16384
 v_exp_f32 v19, v83
 v_mfma_f32_16x16x32_bf16 v[64:67], v[32:35], v[128:131], v[64:67]
 ds_read_b64_tr_b16 v[26:27], v8 offset:20480
 v_cvt_pk_bf16_f32 v104, v16, v17
 v_mfma_f32_16x16x32_bf16 v[72:75], v[32:35], v[132:135], v[72:75]
 ds_read_b64_tr_b16 v[28:29], v9 offset:16384
 v_exp_f32 v16, v84
 v_mfma_f32_16x16x32_bf16 v[64:67], v[36:39], v[136:139], v[64:67]
 ds_read_b64_tr_b16 v[30:31], v9 offset:20480
 v_add_f32 v15, v15, v18
 v_exp_f32 v17, v85
 v_mfma_f32_16x16x32_bf16 v[72:75], v[36:39], v[140:143], v[72:75]
 ds_read_b64_tr_b16 v[32:33], v12 offset:16384
 s_waitcnt lgkmcnt(5)
 v_mfma_f32_16x16x32_bf16 v[68:71], v[40:43], v[112:115], v[48:51]
 ds_read_b64_tr_b16 v[34:35], v12 offset:20480
 v_cvt_pk_bf16_f32 v105, v18, v19
 v_mfma_f32_16x16x32_bf16 v[76:79], v[40:43], v[116:119], v[52:55]
 ds_read_b64_tr_b16 v[36:37], v13 offset:16384
 v_add_f32 v15, v15, v19
 v_mfma_f32_16x16x32_bf16 v[68:71], v[44:47], v[120:123], v[68:71]
 ds_read_b64_tr_b16 v[38:39], v13 offset:20480
 v_exp_f32 v18, v86
 v_add_f32 v15, v15, v16
 v_mfma_f32_16x16x32_bf16 v[76:79], v[44:47], v[124:127], v[76:79]
 ds_read_b64_tr_b16 v[40:41], v8 offset:16896
 v_exp_f32 v19, v87
 v_mfma_f32_16x16x32_bf16 v[68:71], v[240:243], v[128:131], v[68:71]
 ds_read_b64_tr_b16 v[42:43], v8 offset:20992
 v_cvt_pk_bf16_f32 v106, v16, v17
 v_mfma_f32_16x16x32_bf16 v[76:79], v[240:243], v[132:135], v[76:79]
 ds_read_b64_tr_b16 v[44:45], v9 offset:16896
 v_add_f32 v15, v15, v17
 v_mfma_f32_16x16x32_bf16 v[68:71], v[244:247], v[136:139], v[68:71]
 ds_read_b64_tr_b16 v[46:47], v9 offset:20992
 v_exp_f32 v16, v88
 v_mfma_f32_16x16x32_bf16 v[76:79], v[244:247], v[140:143], v[76:79]
 ds_read_b64_tr_b16 v[240:241], v12 offset:16896
 v_add_f32 v15, v15, v18
 s_waitcnt lgkmcnt(5)
 v_mfma_f32_16x16x32_bf16 v[144:147], v[24:27], v[96:99], v[144:147]
 ds_read_b64_tr_b16 v[242:243], v12 offset:20992
 v_exp_f32 v17, v89
 v_mfma_f32_16x16x32_bf16 v[148:151], v[24:27], v[100:103], v[148:151]
 ds_read_b64_tr_b16 v[244:245], v13 offset:16896
 v_cvt_pk_bf16_f32 v107, v18, v19
 v_mfma_f32_16x16x32_bf16 v[152:155], v[28:31], v[96:99], v[152:155]
 ds_read_b64_tr_b16 v[246:247], v13 offset:20992
 v_add_f32 v15, v15, v19
 v_mfma_f32_16x16x32_bf16 v[156:159], v[28:31], v[100:103], v[156:159]
 v_exp_f32 v18, v90
 v_mfma_f32_16x16x32_bf16 v[160:163], v[32:35], v[96:99], v[160:163]
 v_add_f32 v57, v16, v17
 v_exp_f32 v19, v91
 v_mfma_f32_16x16x32_bf16 v[164:167], v[32:35], v[100:103], v[164:167]
 v_cvt_pk_bf16_f32 v108, v16, v17
 v_mfma_f32_16x16x32_bf16 v[168:171], v[36:39], v[96:99], v[168:171]
 v_exp_f32 v16, v92
 v_add_f32 v57, v57, v18
 v_mfma_f32_16x16x32_bf16 v[172:175], v[36:39], v[100:103], v[172:175]
 s_waitcnt lgkmcnt(0)
 s_barrier
 v_add_u32 v4, 81920, v4
 ds_read_b128 v[24:27], v4 offset:0
 v_add_u32 v5, 81920, v5
 ds_read_b128 v[28:31], v5 offset:0
 ds_read_b128 v[32:35], v4 offset:512
 v_mfma_f32_16x16x32_bf16 v[176:179], v[40:43], v[96:99], v[176:179]
 v_exp_f32 v17, v93
 v_cvt_pk_bf16_f32 v109, v18, v19
 v_mfma_f32_16x16x32_bf16 v[180:183], v[40:43], v[100:103], v[180:183]
 ds_read_b128 v[36:39], v5 offset:512
 v_add_f32 v57, v57, v19
 v_mfma_f32_16x16x32_bf16 v[184:187], v[44:47], v[96:99], v[184:187]
 v_exp_f32 v18, v94
 v_add_f32 v57, v57, v16
 v_mfma_f32_16x16x32_bf16 v[188:191], v[44:47], v[100:103], v[188:191]
 ds_read_b128 v[40:43], v4 offset:4096
 v_exp_f32 v19, v95
 v_mfma_f32_16x16x32_bf16 v[192:195], v[240:243], v[96:99], v[192:195]
 v_cvt_pk_bf16_f32 v110, v16, v17
 v_add_f32 v57, v57, v17
 v_add_f32 v57, v57, v18
 v_mfma_f32_16x16x32_bf16 v[196:199], v[240:243], v[100:103], v[196:199]
 ds_read_b128 v[44:47], v5 offset:4096
 v_cvt_pk_bf16_f32 v111, v18, v19
 v_mfma_f32_16x16x32_bf16 v[200:203], v[244:247], v[96:99], v[200:203]
 v_add_f32 v57, v57, v19
 v_max_f32 v58, v15, v57
 v_cmp_lt_f32 vcc, s49, v58
 v_mfma_f32_16x16x32_bf16 v[204:207], v[244:247], v[100:103], v[204:207]
 s_cbranch_vccnz M_stub_11_10
M_back_11_10:
 v_add_f32 v14, v14, v15
 v_add_f32 v56, v56, v57
 ds_read_b128 v[240:243], v4 offset:4608
 s_waitcnt lgkmcnt(3)
 v_mfma_f32_16x16x32_bf16 v[80:83], v[24:27], v[112:115], v[48:51]
 v_exp_f32 v16, v64
 v_exp_f32 v17, v65
 v_mfma_f32_16x16x32_bf16 v[88:91], v[24:27], v[116:119], v[52:55]
 ds_read_b128 v[244:247], v5 offset:4608
 v_mfma_f32_16x16x32_bf16 v[80:83], v[28:31], v[120:123], v[80:83]
 v_exp_f32 v18, v66
 v_add_f32 v15, v16, v17
 v_mfma_f32_16x16x32_bf16 v[88:91], v[28:31], v[124:127], v[88:91]
 v_add_u32 v8, 81920, v8
 ds_read_b64_tr_b16 v[24:25], v8 offset:0
 v_exp_f32 v19, v67
 v_mfma_f32_16x16x32_bf16 v[80:83], v[32:35], v[128:131], v[80:83]
 ds_read_b64_tr_b16 v[26:27], v8 offset:4096
 v_cvt_pk_bf16_f32 v96, v16, v17
 v_mfma_f32_16x16x32_bf16 v[88:91], v[32:35], v[132:135], v[88:91]
 v_add_u32 v9, 81920, v9
 ds_read_b64_tr_b16 v[28:29], v9 offset:0
 v_exp_f32 v16, v68
 v_mfma_f32_16x16x32_bf16 v[80:83], v[36:39], v[136:139], v[80:83]
 ds_read_b64_tr_b16 v[30:31], v9 offset:4096
 v_add_f32 v15, v15, v18
 v_exp_f32 v17, v69
 v_mfma_f32_16x16x32_bf16 v[88:91], v[36:39], v[140:143], v[88:91]
 v_add_u32 v12, 81920, v12
 ds_read_b64_tr_b16 v[32:33], v12 offset:0
 s_waitcnt lgkmcnt(5)
 v_mfma_f32_16x16x32_bf16 v[84:87], v[40:43], v[112:115], v[48:51]
 ds_read_b64_tr_b16 v[34:35], v12 offset:4096
 v_cvt_pk_bf16_f32 v97, v18, v19
 v_mfma_f32_16x16x32_bf16 v[92:95], v[40:43], v[116:119], v[52:55]
 v_add_u32 v13, 81920, v13
 ds_read_b64_tr_b16 v[36:37], v13 offset:0
 v_add_f32 v15, v15, v19
 v_mfma_f32_16x16x32_bf16 v[84:87], v[44:47], v[120:123], v[84:87]
 ds_read_b64_tr_b16 v[38:39], v13 offset:4096
 v_exp_f32 v18, v70
 v_add_f32 v15, v15, v16
 v_mfma_f32_16x16x32_bf16 v[92:95], v[44:47], v[124:127], v[92:95]
 ds_read_b64_tr_b16 v[40:41], v8 offset:512
 v_exp_f32 v19, v71
 v_mfma_f32_16x16x32_bf16 v[84:87], v[240:243], v[128:131], v[84:87]
 ds_read_b64_tr_b16 v[42:43], v8 offset:4608
 v_cvt_pk_bf16_f32 v98, v16, v17
 v_mfma_f32_16x16x32_bf16 v[92:95], v[240:243], v[132:135], v[92:95]
 ds_read_b64_tr_b16 v[44:45], v9 offset:512
 v_add_f32 v15, v15, v17
 v_mfma_f32_16x16x32_bf16 v[84:87], v[244:247], v[136:139], v[84:87]
 ds_read_b64_tr_b16 v[46:47], v9 offset:4608
 v_exp_f32 v16, v72
 v_mfma_f32_16x16x32_bf16 v[92:95], v[244:247], v[140:143], v[92:95]
 ds_read_b64_tr_b16 v[240:241], v12 offset:512
 v_add_f32 v15, v15, v18
 s_waitcnt lgkmcnt(5)
 v_mfma_f32_16x16x32_bf16 v[144:147], v[24:27], v[104:107], v[144:147]
 ds_read_b64_tr_b16 v[242:243], v12 offset:4608
 v_exp_f32 v17, v73
 v_mfma_f32_16x16x32_bf16 v[148:151], v[24:27], v[108:111], v[148:151]
 ds_read_b64_tr_b16 v[244:245], v13 offset:512
 v_cvt_pk_bf16_f32 v99, v18, v19
 v_mfma_f32_16x16x32_bf16 v[152:155], v[28:31], v[104:107], v[152:155]
 ds_read_b64_tr_b16 v[246:247], v13 offset:4608
 v_add_f32 v15, v15, v19
 v_mfma_f32_16x16x32_bf16 v[156:159], v[28:31], v[108:111], v[156:159]
 v_exp_f32 v18, v74
 v_mfma_f32_16x16x32_bf16 v[160:163], v[32:35], v[104:107], v[160:163]
 v_add_f32 v57, v16, v17
 v_exp_f32 v19, v75
 v_mfma_f32_16x16x32_bf16 v[164:167], v[32:35], v[108:111], v[164:167]
 v_cvt_pk_bf16_f32 v100, v16, v17
 v_mfma_f32_16x16x32_bf16 v[168:171], v[36:39], v[104:107], v[168:171]
 v_exp_f32 v16, v76
 v_add_f32 v57, v57, v18
 v_mfma_f32_16x16x32_bf16 v[172:175], v[36:39], v[108:111], v[172:175]
 s_waitcnt lgkmcnt(0)
 s_barrier
 ds_read_b128 v[24:27], v4 offset:32768
 ds_read_b128 v[28:31], v5 offset:32768
 ds_read_b128 v[32:35], v4 offset:33280
 v_mfma_f32_16x16x32_bf16 v[176:179], v[40:43], v[104:107], v[176:179]
 v_exp_f32 v17, v77
 v_cvt_pk_bf16_f32 v101, v18, v19
 v_mfma_f32_16x16x32_bf16 v[180:183], v[40:43], v[108:111], v[180:183]
 ds_read_b128 v[36:39], v5 offset:33280
 v_add_f32 v57, v57, v19
 v_mfma_f32_16x16x32_bf16 v[184:187], v[44:47], v[104:107], v[184:187]
 v_exp_f32 v18, v78
 v_add_f32 v57, v57, v16
 v_mfma_f32_16x16x32_bf16 v[188:191], v[44:47], v[108:111], v[188:191]
 ds_read_b128 v[40:43], v4 offset:36864
 v_exp_f32 v19, v79
 v_mfma_f32_16x16x32_bf16 v[192:195], v[240:243], v[104:107], v[192:195]
 v_cvt_pk_bf16_f32 v102, v16, v17
 v_add_f32 v57, v57, v17
 v_add_f32 v57, v57, v18
 v_mfma_f32_16x16x32_bf16 v[196:199], v[240:243], v[108:111], v[196:199]
 ds_read_b128 v[44:47], v5 offset:36864
 v_cvt_pk_bf16_f32 v103, v18, v19
 v_mfma_f32_16x16x32_bf16 v[200:203], v[244:247], v[104:107], v[200:203]
 v_add_f32 v57, v57, v19
 v_max_f32 v58, v15, v57
 v_cmp_lt_f32 vcc, s49, v58
 v_mfma_f32_16x16x32_bf16 v[204:207], v[244:247], v[108:111], v[204:207]
 s_cbranch_vccnz M_stub_12_11
M_back_12_11:
 v_add_f32 v14, v14, v15
 v_add_f32 v56, v56, v57
 ds_read_b128 v[240:243], v4 offset:37376
 s_waitcnt lgkmcnt(3)
 v_mfma_f32_16x16x32_bf16 v[64:67], v[24:27], v[112:115], v[48:51]
 v_exp_f32 v16, v80
 v_exp_f32 v17, v81
 v_mfma_f32_16x16x32_bf16 v[72:75], v[24:27], v[116:119], v[52:55]
 ds_read_b128 v[244:247], v5 offset:37376
 v_mfma_f32_16x16x32_bf16 v[64:67], v[28:31], v[120:123], v[64:67]
 v_exp_f32 v18, v82
 v_add_f32 v15, v16, v17
 v_mfma_f32_16x16x32_bf16 v[72:75], v[28:31], v[124:127], v[72:75]
 ds_read_b64_tr_b16 v[24:25], v8 offset:32768
 v_exp_f32 v19, v83
 v_mfma_f32_16x16x32_bf16 v[64:67], v[32:35], v[128:131], v[64:67]
 ds_read_b64_tr_b16 v[26:27], v8 offset:36864
 v_cvt_pk_bf16_f32 v104, v16, v17
 v_mfma_f32_16x16x32_bf16 v[72:75], v[32:35], v[132:135], v[72:75]
 ds_read_b64_tr_b16 v[28:29], v9 offset:32768
 v_exp_f32 v16, v84
 v_mfma_f32_16x16x32_bf16 v[64:67], v[36:39], v[136:139], v[64:67]
 ds_read_b64_tr_b16 v[30:31], v9 offset:36864
 v_add_f32 v15, v15, v18
 v_exp_f32 v17, v85
 v_mfma_f32_16x16x32_bf16 v[72:75], v[36:39], v[140:143], v[72:75]
 ds_read_b64_tr_b16 v[32:33], v12 offset:32768
 s_waitcnt lgkmcnt(5)
 v_mfma_f32_16x16x32_bf16 v[68:71], v[40:43], v[112:115], v[48:51]
 ds_read_b64_tr_b16 v[34:35], v12 offset:36864
 v_cvt_pk_bf16_f32 v105, v18, v19
 v_mfma_f32_16x16x32_bf16 v[76:79], v[40:43], v[116:119], v[52:55]
 ds_read_b64_tr_b16 v[36:37], v13 offset:32768
 v_add_f32 v15, v15, v19
 v_mfma_f32_16x16x32_bf16 v[68:71], v[44:47], v[120:123], v[68:71]
 ds_read_b64_tr_b16 v[38:39], v13 offset:36864
 v_exp_f32 v18, v86
 v_add_f32 v15, v15, v16
 v_mfma_f32_16x16x32_bf16 v[76:79], v[44:47], v[124:127], v[76:79]
 ds_read_b64_tr_b16 v[40:41], v8 offset:33280
 v_exp_f32 v19, v87
 v_mfma_f32_16x16x32_bf16 v[68:71], v[240:243], v[128:131], v[68:71]
 ds_read_b64_tr_b16 v[42:43], v8 offset:37376
 v_cvt_pk_bf16_f32 v106, v16, v17
 v_mfma_f32_16x16x32_bf16 v[76:79], v[240:243], v[132:135], v[76:79]
 ds_read_b64_tr_b16 v[44:45], v9 offset:33280
 v_add_f32 v15, v15, v17
 v_mfma_f32_16x16x32_bf16 v[68:71], v[244:247], v[136:139], v[68:71]
 ds_read_b64_tr_b16 v[46:47], v9 offset:37376
 v_exp_f32 v16, v88
 v_mfma_f32_16x16x32_bf16 v[76:79], v[244:247], v[140:143], v[76:79]
 ds_read_b64_tr_b16 v[240:241], v12 offset:33280
 v_add_f32 v15, v15, v18
 s_waitcnt lgkmcnt(5)
 v_mfma_f32_16x16x32_bf16 v[144:147], v[24:27], v[96:99], v[144:147]
 ds_read_b64_tr_b16 v[242:243], v12 offset:37376
 v_exp_f32 v17, v89
 v_mfma_f32_16x16x32_bf16 v[148:151], v[24:27], v[100:103], v[148:151]
 ds_read_b64_tr_b16 v[244:245], v13 offset:33280
 v_cvt_pk_bf16_f32 v107, v18, v19
 v_mfma_f32_16x16x32_bf16 v[152:155], v[28:31], v[96:99], v[152:155]
 ds_read_b64_tr_b16 v[246:247], v13 offset:37376
 v_add_f32 v15, v15, v19
 v_mfma_f32_16x16x32_bf16 v[156:159], v[28:31], v[100:103], v[156:159]
 v_exp_f32 v18, v90
 v_mfma_f32_16x16x32_bf16 v[160:163], v[32:35], v[96:99], v[160:163]
 v_add_f32 v57, v16, v17
 v_exp_f32 v19, v91
 v_mfma_f32_16x16x32_bf16 v[164:167], v[32:35], v[100:103], v[164:167]
 v_cvt_pk_bf16_f32 v108, v16, v17
 v_mfma_f32_16x16x32_bf16 v[168:171], v[36:39], v[96:99], v[168:171]
 v_exp_f32 v16, v92
 v_add_f32 v57, v57, v18
 v_mfma_f32_16x16x32_bf16 v[172:175], v[36:39], v[100:103], v[172:175]
 s_waitcnt lgkmcnt(0)
 s_barrier
 ds_read_b128 v[24:27], v4 offset:49152
 ds_read_b128 v[28:31], v5 offset:49152
 ds_read_b128 v[32:35], v4 offset:49664
 v_mfma_f32_16x16x32_bf16 v[176:179], v[40:43], v[96:99], v[176:179]
 v_exp_f32 v17, v93
 v_cvt_pk_bf16_f32 v109, v18, v19
 v_mfma_f32_16x16x32_bf16 v[180:183], v[40:43], v[100:103], v[180:183]
 ds_read_b128 v[36:39], v5 offset:49664
 v_add_f32 v57, v57, v19
 v_mfma_f32_16x16x32_bf16 v[184:187], v[44:47], v[96:99], v[184:187]
 v_exp_f32 v18, v94
 v_add_f32 v57, v57, v16
 v_mfma_f32_16x16x32_bf16 v[188:191], v[44:47], v[100:103], v[188:191]
 ds_read_b128 v[40:43], v4 offset:53248
 v_exp_f32 v19, v95
 v_mfma_f32_16x16x32_bf16 v[192:195], v[240:243], v[96:99], v[192:195]
 v_cvt_pk_bf16_f32 v110, v16, v17
 v_add_f32 v57, v57, v17
 v_add_f32 v57, v57, v18
 v_mfma_f32_16x16x32_bf16 v[196:199], v[240:243], v[100:103], v[196:199]
 ds_read_b128 v[44:47], v5 offset:53248
 v_cvt_pk_bf16_f32 v111, v18, v19
 v_mfma_f32_16x16x32_bf16 v[200:203], v[244:247], v[96:99], v[200:203]
 v_add_f32 v57, v57, v19
 v_max_f32 v58, v15, v57
 v_cmp_lt_f32 vcc, s49, v58
 v_mfma_f32_16x16x32_bf16 v[204:207], v[244:247], v[100:103], v[204:207]
 s_cbranch_vccnz M_stub_13_12
M_back_13_12:
 v_add_f32 v14, v14, v15
 v_add_f32 v56, v56, v57
 ds_read_b128 v[240:243], v4 offset:53760
 s_waitcnt lgkmcnt(3)
 v_mfma_f32_16x16x32_bf16 v[80:83], v[24:27], v[112:115], v[48:51]
 v_exp_f32 v16, v64
 v_exp_f32 v17, v65
 v_mfma_f32_16x16x32_bf16 v[88:91], v[24:27], v[116:119], v[52:55]
 ds_read_b128 v[244:247], v5 offset:53760
 v_exp_f32 v18, v66
 v_mfma_f32_16x16x32_bf16 v[80:83], v[28:31], v[120:123], v[80:83]
 v_add_f32 v15, v16, v17
 v_exp_f32 v19, v67
 v_mfma_f32_16x16x32_bf16 v[88:91], v[28:31], v[124:127], v[88:91]
 ds_read_b64_tr_b16 v[24:25], v8 offset:49152
 v_cvt_pk_bf16_f32 v96, v16, v17
 v_mfma_f32_16x16x32_bf16 v[80:83], v[32:35], v[128:131], v[80:83]
 ds_read_b64_tr_b16 v[26:27], v8 offset:53248
 v_exp_f32 v16, v68
 v_mfma_f32_16x16x32_bf16 v[88:91], v[32:35], v[132:135], v[88:91]
 ds_read_b64_tr_b16 v[28:29], v9 offset:49152
 v_add_f32 v15, v15, v18
 v_mfma_f32_16x16x32_bf16 v[80:83], v[36:39], v[136:139], v[80:83]
 ds_read_b64_tr_b16 v[30:31], v9 offset:53248
 v_exp_f32 v17, v69
 v_cvt_pk_bf16_f32 v97, v18, v19
 v_mfma_f32_16x16x32_bf16 v[88:91], v[36:39], v[140:143], v[88:91]
 ds_read_b64_tr_b16 v[32:33], v12 offset:49152
 v_add_f32 v15, v15, v19
 s_waitcnt lgkmcnt(5)
 v_mfma_f32_16x16x32_bf16 v[84:87], v[40:43], v[112:115], v[48:51]
 ds_read_b64_tr_b16 v[34:35], v12 offset:53248
 v_exp_f32 v18, v70
 v_mfma_f32_16x16x32_bf16 v[92:95], v[40:43], v[116:119], v[52:55]
 ds_read_b64_tr_b16 v[36:37], v13 offset:49152
 v_add_f32 v15, v15, v16
 v_mfma_f32_16x16x32_bf16 v[84:87], v[44:47], v[120:123], v[84:87]
 ds_read_b64_tr_b16 v[38:39], v13 offset:53248
 v_exp_f32 v19, v71
 v_mfma_f32_16x16x32_bf16 v[92:95], v[44:47], v[124:127], v[92:95]
 ds_read_b64_tr_b16 v[40:41], v8 offset:49664
 v_cvt_pk_bf16_f32 v98, v16, v17
 v_add_f32 v15, v15, v17
 v_mfma_f32_16x16x32_bf16 v[84:87], v[240:243], v[128:131], v[84:87]
 ds_read_b64_tr_b16 v[42:43], v8 offset:53760
 v_exp_f32 v16, v72
 v_mfma_f32_16x16x32_bf16 v[92:95], v[240:243], v[132:135], v[92:95]
 ds_read_b64_tr_b16 v[44:45], v9 offset:49664
 v_add_f32 v15, v15, v18
 v_mfma_f32_16x16x32_bf16 v[84:87], v[244:247], v[136:139], v[84:87]
 ds_read_b64_tr_b16 v[46:47], v9 offset:53760
 v_exp_f32 v17, v73
 v_mfma_f32_16x16x32_bf16 v[92:95], v[244:247], v[140:143], v[92:95]
 ds_read_b64_tr_b16 v[240:241], v12 offset:49664
 s_waitcnt lgkmcnt(5)
 v_mfma_f32_16x16x32_bf16 v[144:147], v[24:27], v[104:107], v[144:147]
 ds_read_b64_tr_b16 v[242:243], v12 offset:53760
 v_cvt_pk_bf16_f32 v99, v18, v19
 v_add_f32 v15, v15, v19
 v_mfma_f32_16x16x32_bf16 v[148:151], v[24:27], v[108:111], v[148:151]
 ds_read_b64_tr_b16 v[244:245], v13 offset:49664
 v_exp_f32 v18, v74
 v_mfma_f32_16x16x32_bf16 v[152:155], v[28:31], v[104:107], v[152:155]
 ds_read_b64_tr_b16 v[246:247], v13 offset:53760
 v_add_f32 v57, v16, v17
 v_exp_f32 v19, v75
 v_mfma_f32_16x16x32_bf16 v[156:159], v[28:31], v[108:111], v[156:159]
 v_cvt_pk_bf16_f32 v100, v16, v17
 v_mfma_f32_16x16x32_bf16 v[160:163], v[32:35], v[104:107], v[160:163]
 v_exp_f32 v16, v76
 v_mfma_f32_16x16x32_bf16 v[164:167], v[32:35], v[108:111], v[164:167]
 v_add_f32 v57, v57, v18
 v_mfma_f32_16x16x32_bf16 v[168:171], v[36:39], v[104:107], v[168:171]
 v_exp_f32 v17, v77
 v_cvt_pk_bf16_f32 v101, v18, v19
 v_mfma_f32_16x16x32_bf16 v[172:175], v[36:39], v[108:111], v[172:175]
 s_waitcnt lgkmcnt(0)
 s_barrier
 v_add_u32 v8, 4294909952, v8
 ds_read_b64_tr_b16 v[24:25], v8 offset:0
 v_add_u32 v9, 4294909952, v9
 ds_read_b64_tr_b16 v[28:29], v9 offset:0
 ds_read_b64_tr_b16 v[26:27], v8 offset:4096
 v_add_u32 v12, 4294909952, v12
 ds_read_b64_tr_b16 v[32:33], v12 offset:0
 ds_read_b64_tr_b16 v[30:31], v9 offset:4096
 v_mfma_f32_16x16x32_bf16 v[176:179], v[40:43], v[104:107], v[176:179]
 ds_read_b64_tr_b16 v[34:35], v12 offset:4096
 v_add_f32 v57, v57, v19
 v_exp_f32 v18, v78
 v_mfma_f32_16x16x32_bf16 v[180:183], v[40:43], v[108:111], v[180:183]
 v_add_u32 v13, 4294909952, v13
 ds_read_b64_tr_b16 v[36:37], v13 offset:0
 v_add_f32 v57, v57, v16
 v_mfma_f32_16x16x32_bf16 v[184:187], v[44:47], v[104:107], v[184:187]
 ds_read_b64_tr_b16 v[38:39], v13 offset:4096
 v_exp_f32 v19, v79
 v_mfma_f32_16x16x32_bf16 v[188:191], v[44:47], v[108:111], v[188:191]
 ds_read_b64_tr_b16 v[40:41], v8 offset:512
 v_cvt_pk_bf16_f32 v102, v16, v17
 v_mfma_f32_16x16x32_bf16 v[192:195], v[240:243], v[104:107], v[192:195]
 ds_read_b64_tr_b16 v[42:43], v8 offset:4608
 v_add_f32 v57, v57, v17
 v_add_f32 v57, v57, v18
 v_mfma_f32_16x16x32_bf16 v[196:199], v[240:243], v[108:111], v[196:199]
 ds_read_b64_tr_b16 v[44:45], v9 offset:512
 v_cvt_pk_bf16_f32 v103, v18, v19
 v_add_f32 v57, v57, v19
 v_mfma_f32_16x16x32_bf16 v[200:203], v[244:247], v[104:107], v[200:203]
 ds_read_b64_tr_b16 v[46:47], v9 offset:4608
 v_max_f32 v58, v15, v57
 v_cmp_lt_f32 vcc, s49, v58
 v_mfma_f32_16x16x32_bf16 v[204:207], v[244:247], v[108:111], v[204:207]
 s_cbranch_vccnz M_stub_14_13
M_back_14_13:
 v_add_f32 v14, v14, v15
 v_add_f32 v56, v56, v57
 ds_read_b64_tr_b16 v[240:241], v12 offset:512
 v_exp_f32 v16, v80
 s_waitcnt lgkmcnt(5)
 v_mfma_f32_16x16x32_bf16 v[144:147], v[24:27], v[96:99], v[144:147]
 ds_read_b64_tr_b16 v[242:243], v12 offset:4608
 v_exp_f32 v17, v81
 v_exp_f32 v18, v82
 v_add_f32 v15, v16, v17
 v_mfma_f32_16x16x32_bf16 v[148:151], v[24:27], v[100:103], v[148:151]
 ds_read_b64_tr_b16 v[244:245], v13 offset:512
 v_exp_f32 v19, v83
 v_cvt_pk_bf16_f32 v104, v16, v17
 v_mfma_f32_16x16x32_bf16 v[152:155], v[28:31], v[96:99], v[152:155]
 ds_read_b64_tr_b16 v[246:247], v13 offset:4608
 v_exp_f32 v16, v84
 v_add_f32 v15, v15, v18
 v_mfma_f32_16x16x32_bf16 v[156:159], v[28:31], v[100:103], v[156:159]
 ds_read_b64_tr_b16 v[24:25], v8 offset:8192
 v_exp_f32 v17, v85
 v_cvt_pk_bf16_f32 v105, v18, v19
 v_mfma_f32_16x16x32_bf16 v[160:163], v[32:35], v[96:99], v[160:163]
 ds_read_b64_tr_b16 v[26:27], v8 offset:12288
 v_add_f32 v15, v15, v19
 v_exp_f32 v18, v86
 v_add_f32 v15, v15, v16
 v_mfma_f32_16x16x32_bf16 v[164:167], v[32:35], v[100:103], v[164:167]
 ds_read_b64_tr_b16 v[28:29], v9 offset:8192
 v_exp_f32 v19, v87
 v_cvt_pk_bf16_f32 v106, v16, v17
 v_mfma_f32_16x16x32_bf16 v[168:171], v[36:39], v[96:99], v[168:171]
 ds_read_b64_tr_b16 v[30:31], v9 offset:12288
 v_add_f32 v15, v15, v17
 v_exp_f32 v16, v88
 v_add_f32 v15, v15, v18
 v_mfma_f32_16x16x32_bf16 v[172:175], v[36:39], v[100:103], v[172:175]
 ds_read_b64_tr_b16 v[32:33], v12 offset:8192
 v_exp_f32 v17, v89
 v_cvt_pk_bf16_f32 v107, v18, v19
 s_waitcnt lgkmcnt(5)
 v_mfma_f32_16x16x32_bf16 v[176:179], v[40:43], v[96:99], v[176:179]
 ds_read_b64_tr_b16 v[34:35], v12 offset:12288
 v_add_f32 v15, v15, v19
 v_exp_f32 v18, v90
 v_add_f32 v57, v16, v17
 v_mfma_f32_16x16x32_bf16 v[180:183], v[40:43], v[100:103], v[180:183]
 ds_read_b64_tr_b16 v[36:37], v13 offset:8192
 v_exp_f32 v19, v91
 v_cvt_pk_bf16_f32 v108, v16, v17
 v_mfma_f32_16x16x32_bf16 v[184:187], v[44:47], v[96:99], v[184:187]
 ds_read_b64_tr_b16 v[38:39], v13 offset:12288
 v_exp_f32 v16, v92
 v_add_f32 v57, v57, v18
 v_exp_f32 v17, v93
 v_mfma_f32_16x16x32_bf16 v[188:191], v[44:47], v[100:103], v[188:191]
 ds_read_b64_tr_b16 v[40:41], v8 offset:8704
 v_cvt_pk_bf16_f32 v109, v18, v19
 v_add_f32 v57, v57, v19
 v_exp_f32 v18, v94
 v_mfma_f32_16x16x32_bf16 v[192:195], v[240:243], v[96:99], v[192:195]
 ds_read_b64_tr_b16 v[42:43], v8 offset:12800
 v_add_f32 v57, v57, v16
 v_exp_f32 v19, v95
 v_mfma_f32_16x16x32_bf16 v[196:199], v[240:243], v[100:103], v[196:199]
 ds_read_b64_tr_b16 v[44:45], v9 offset:8704
 v_cvt_pk_bf16_f32 v110, v16, v17
 v_add_f32 v57, v57, v17
 v_add_f32 v57, v57, v18
 v_mfma_f32_16x16x32_bf16 v[200:203], v[244:247], v[96:99], v[200:203]
 ds_read_b64_tr_b16 v[46:47], v9 offset:12800
 v_cvt_pk_bf16_f32 v111, v18, v19
 v_add_f32 v57, v57, v19
 v_max_f32 v58, v15, v57
 v_cmp_lt_f32 vcc, s49, v58
 v_mfma_f32_16x16x32_bf16 v[204:207], v[244:247], v[100:103], v[204:207]
 s_cbranch_vccnz M_stub_15_14
M_back_15_14:
 v_add_f32 v14, v14, v15
 v_add_f32 v56, v56, v57
 ds_read_b64_tr_b16 v[240:241], v12 offset:8704
 s_waitcnt lgkmcnt(5)
 v_mfma_f32_16x16x32_bf16 v[144:147], v[24:27], v[104:107], v[144:147]
 ds_read_b64_tr_b16 v[242:243], v12 offset:12800
 v_mov_b32 v20, v14
 v_mov_b32 v11, v56
 v_mfma_f32_16x16x32_bf16 v[148:151], v[24:27], v[108:111], v[148:151]
 ds_read_b64_tr_b16 v[244:245], v13 offset:8704
 ds_read_b64_tr_b16 v[246:247], v13 offset:12800
 v_mfma_f32_16x16x32_bf16 v[152:155], v[28:31], v[104:107], v[152:155]
 v_permlane16_swap_b32 v20, v11
 v_add_f32 v20, v20, v11
 v_mfma_f32_16x16x32_bf16 v[156:159], v[28:31], v[108:111], v[156:159]
 v_mov_b32 v21, v20
 v_mfma_f32_16x16x32_bf16 v[160:163], v[32:35], v[104:107], v[160:163]
 s_nop 0
 v_permlane32_swap_b32 v20, v21
 v_mfma_f32_16x16x32_bf16 v[164:167], v[32:35], v[108:111], v[164:167]
 v_add_f32 v20, v20, v21
 v_mfma_f32_16x16x32_bf16 v[168:171], v[36:39], v[104:107], v[168:171]
 v_rcp_f32 v20, v20
 v_mfma_f32_16x16x32_bf16 v[172:175], v[36:39], v[108:111], v[172:175]
 s_waitcnt lgkmcnt(0)
 s_barrier
 v_add_u32 v8, v8, v10
 v_add_u32 v9, v9, v10
 v_add_u32 v12, v12, v10
 v_add_u32 v13, v13, v10
 ds_read_b64_tr_b16 v[24:25], v8 offset:16384
 ds_read_b64_tr_b16 v[28:29], v9 offset:16384
 ds_read_b64_tr_b16 v[26:27], v8 offset:18432
 ds_read_b64_tr_b16 v[32:33], v12 offset:16384
 ds_read_b64_tr_b16 v[30:31], v9 offset:18432
 v_mfma_f32_16x16x32_bf16 v[176:179], v[40:43], v[104:107], v[176:179]
 ds_read_b64_tr_b16 v[34:35], v12 offset:18432
 v_mov_b32 v11, v20
 s_nop 1
 v_permlane16_swap_b32 v20, v11
 v_mfma_f32_16x16x32_bf16 v[180:183], v[40:43], v[108:111], v[180:183]
 ds_read_b64_tr_b16 v[36:37], v13 offset:16384
 v_mul_f32 v144, v20, v144
 v_mul_f32 v145, v20, v145
 v_mul_f32 v146, v20, v146
 v_mul_f32 v147, v20, v147
 v_mfma_f32_16x16x32_bf16 v[184:187], v[44:47], v[104:107], v[184:187]
 ds_read_b64_tr_b16 v[38:39], v13 offset:18432
 v_cvt_pk_bf16_f32 v64, v144, v145
 v_cvt_pk_bf16_f32 v65, v146, v147
 v_mul_f32 v152, v20, v152
 v_mul_f32 v153, v20, v153
 v_mfma_f32_16x16x32_bf16 v[188:191], v[44:47], v[108:111], v[188:191]
 ds_read_b64_tr_b16 v[40:41], v8 offset:32768
 v_mul_f32 v154, v20, v154
 v_mul_f32 v155, v20, v155
 v_cvt_pk_bf16_f32 v66, v152, v153
 v_cvt_pk_bf16_f32 v67, v154, v155
 v_mfma_f32_16x16x32_bf16 v[192:195], v[240:243], v[104:107], v[192:195]
 ds_read_b64_tr_b16 v[42:43], v8 offset:34816
 v_mul_f32 v148, v11, v148
 v_mul_f32 v149, v11, v149
 v_mul_f32 v150, v11, v150
 v_mul_f32 v151, v11, v151
 v_mfma_f32_16x16x32_bf16 v[196:199], v[240:243], v[108:111], v[196:199]
 ds_read_b64_tr_b16 v[44:45], v9 offset:32768
 v_cvt_pk_bf16_f32 v68, v148, v149
 v_cvt_pk_bf16_f32 v69, v150, v151
 v_mul_f32 v156, v11, v156
 v_mul_f32 v157, v11, v157
 v_mfma_f32_16x16x32_bf16 v[200:203], v[244:247], v[104:107], v[200:203]
 ds_read_b64_tr_b16 v[46:47], v9 offset:34816
 v_mul_f32 v158, v11, v158
 v_mul_f32 v159, v11, v159
 v_cvt_pk_bf16_f32 v70, v156, v157
 v_cvt_pk_bf16_f32 v71, v158, v159
 v_mfma_f32_16x16x32_bf16 v[204:207], v[244:247], v[108:111], v[204:207]
 ds_read_b64_tr_b16 v[240:241], v12 offset:32768
 v_mul_f32 v160, v20, v160
 s_waitcnt lgkmcnt(5)
 v_mfma_f32_16x16x32_bf16 a[0:3], v[24:27], v[64:67], a[0:3]
 ds_read_b64_tr_b16 v[242:243], v12 offset:34816
 v_mul_f32 v161, v20, v161
 v_mul_f32 v162, v20, v162
 v_mfma_f32_16x16x32_bf16 a[4:7], v[24:27], v[68:71], a[4:7]
 ds_read_b64_tr_b16 v[244:245], v13 offset:32768
 v_mul_f32 v163, v20, v163
 v_mfma_f32_16x16x32_bf16 a[8:11], v[28:31], v[64:67], a[8:11]
 ds_read_b64_tr_b16 v[246:247], v13 offset:34816
 v_cvt_pk_bf16_f32 v72, v160, v161
 v_cvt_pk_bf16_f32 v73, v162, v163
 v_mfma_f32_16x16x32_bf16 a[12:15], v[28:31], v[68:71], a[12:15]
 ds_read_b64_tr_b16 v[24:25], v8 offset:20480
 v_mul_f32 v168, v20, v168
 v_mfma_f32_16x16x32_bf16 a[16:19], v[32:35], v[64:67], a[16:19]
 ds_read_b64_tr_b16 v[26:27], v8 offset:22528
 v_mul_f32 v169, v20, v169
 v_mul_f32 v170, v20, v170
 v_mfma_f32_16x16x32_bf16 a[20:23], v[32:35], v[68:71], a[20:23]
 ds_read_b64_tr_b16 v[28:29], v9 offset:20480
 v_mul_f32 v171, v20, v171
 v_mfma_f32_16x16x32_bf16 a[24:27], v[36:39], v[64:67], a[24:27]
 ds_read_b64_tr_b16 v[30:31], v9 offset:22528
 v_cvt_pk_bf16_f32 v74, v168, v169
 v_cvt_pk_bf16_f32 v75, v170, v171
 v_mfma_f32_16x16x32_bf16 a[28:31], v[36:39], v[68:71], a[28:31]
 ds_read_b64_tr_b16 v[32:33], v12 offset:20480
 v_mul_f32 v164, v11, v164
 s_waitcnt lgkmcnt(5)
 v_mfma_f32_16x16x32_bf16 a[32:35], v[40:43], v[64:67], a[32:35]
 ds_read_b64_tr_b16 v[34:35], v12 offset:22528
 v_mul_f32 v165, v11, v165
 v_mul_f32 v166, v11, v166
 v_mfma_f32_16x16x32_bf16 a[36:39], v[40:43], v[68:71], a[36:39]
 ds_read_b64_tr_b16 v[36:37], v13 offset:20480
 v_mul_f32 v167, v11, v167
 v_mfma_f32_16x16x32_bf16 a[40:43], v[44:47], v[64:67], a[40:43]
 ds_read_b64_tr_b16 v[38:39], v13 offset:22528
 v_cvt_pk_bf16_f32 v76, v164, v165
 v_cvt_pk_bf16_f32 v77, v166, v167
 v_mfma_f32_16x16x32_bf16 a[44:47], v[44:47], v[68:71], a[44:47]
 ds_read_b64_tr_b16 v[40:41], v8 offset:36864
 v_mul_f32 v172, v11, v172
 v_mfma_f32_16x16x32_bf16 a[48:51], v[240:243], v[64:67], a[48:51]
 ds_read_b64_tr_b16 v[42:43], v8 offset:38912
 v_mul_f32 v173, v11, v173
 v_mul_f32 v174, v11, v174
 v_mfma_f32_16x16x32_bf16 a[52:55], v[240:243], v[68:71], a[52:55]
 ds_read_b64_tr_b16 v[44:45], v9 offset:36864
 v_mul_f32 v175, v11, v175
 v_mfma_f32_16x16x32_bf16 a[56:59], v[244:247], v[64:67], a[56:59]
 ds_read_b64_tr_b16 v[46:47], v9 offset:38912
 v_cvt_pk_bf16_f32 v78, v172, v173
 v_cvt_pk_bf16_f32 v79, v174, v175
 v_mfma_f32_16x16x32_bf16 a[60:63], v[244:247], v[68:71], a[60:63]
 ds_read_b64_tr_b16 v[240:241], v12 offset:36864
 v_mul_f32 v176, v20, v176
 s_waitcnt lgkmcnt(5)
 v_mfma_f32_16x16x32_bf16 a[0:3], v[24:27], v[72:75], a[0:3]
 ds_read_b64_tr_b16 v[242:243], v12 offset:38912
 v_mul_f32 v177, v20, v177
 v_mul_f32 v178, v20, v178
 v_mfma_f32_16x16x32_bf16 a[4:7], v[24:27], v[76:79], a[4:7]
 ds_read_b64_tr_b16 v[244:245], v13 offset:36864
 v_mul_f32 v179, v20, v179
 v_mfma_f32_16x16x32_bf16 a[8:11], v[28:31], v[72:75], a[8:11]
 ds_read_b64_tr_b16 v[246:247], v13 offset:38912
 v_cvt_pk_bf16_f32 v80, v176, v177
 v_cvt_pk_bf16_f32 v81, v178, v179
 v_mfma_f32_16x16x32_bf16 a[12:15], v[28:31], v[76:79], a[12:15]
 v_mul_f32 v184, v20, v184
 v_mfma_f32_16x16x32_bf16 a[16:19], v[32:35], v[72:75], a[16:19]
 v_mul_f32 v185, v20, v185
 v_mul_f32 v186, v20, v186
 v_mfma_f32_16x16x32_bf16 a[20:23], v[32:35], v[76:79], a[20:23]
 v_mul_f32 v187, v20, v187
 v_mfma_f32_16x16x32_bf16 a[24:27], v[36:39], v[72:75], a[24:27]
 v_cvt_pk_bf16_f32 v82, v184, v185
 v_cvt_pk_bf16_f32 v83, v186, v187
 v_mfma_f32_16x16x32_bf16 a[28:31], v[36:39], v[76:79], a[28:31]
 s_waitcnt lgkmcnt(0)
 s_barrier
 ds_read_b64_tr_b16 v[24:25], v8 offset:24576
 ds_read_b64_tr_b16 v[28:29], v9 offset:24576
 ds_read_b64_tr_b16 v[26:27], v8 offset:26624
 ds_read_b64_tr_b16 v[32:33], v12 offset:24576
 ds_read_b64_tr_b16 v[30:31], v9 offset:26624
 v_mfma_f32_16x16x32_bf16 a[32:35], v[40:43], v[72:75], a[32:35]
 ds_read_b64_tr_b16 v[34:35], v12 offset:26624
 v_mul_f32 v180, v11, v180
 v_mul_f32 v181, v11, v181
 v_mul_f32 v182, v11, v182
 v_mfma_f32_16x16x32_bf16 a[36:39], v[40:43], v[76:79], a[36:39]
 ds_read_b64_tr_b16 v[36:37], v13 offset:24576
 v_mul_f32 v183, v11, v183
 v_mfma_f32_16x16x32_bf16 a[40:43], v[44:47], v[72:75], a[40:43]
 ds_read_b64_tr_b16 v[38:39], v13 offset:26624
 v_cvt_pk_bf16_f32 v84, v180, v181
 v_cvt_pk_bf16_f32 v85, v182, v183
 v_mfma_f32_16x16x32_bf16 a[44:47], v[44:47], v[76:79], a[44:47]
 ds_read_b64_tr_b16 v[40:41], v8 offset:40960
 v_mul_f32 v188, v11, v188
 v_mfma_f32_16x16x32_bf16 a[48:51], v[240:243], v[72:75], a[48:51]
 ds_read_b64_tr_b16 v[42:43], v8 offset:43008
 v_mul_f32 v189, v11, v189
 v_mul_f32 v190, v11, v190
 v_mfma_f32_16x16x32_bf16 a[52:55], v[240:243], v[76:79], a[52:55]
 ds_read_b64_tr_b16 v[44:45], v9 offset:40960
 v_mul_f32 v191, v11, v191
 v_mfma_f32_16x16x32_bf16 a[56:59], v[244:247], v[72:75], a[56:59]
 ds_read_b64_tr_b16 v[46:47], v9 offset:43008
 v_cvt_pk_bf16_f32 v86, v188, v189
 v_cvt_pk_bf16_f32 v87, v190, v191
 v_mfma_f32_16x16x32_bf16 a[60:63], v[244:247], v[76:79], a[60:63]
 s_cmp_lg_u32 s47, 3
 s_cbranch_scc1 M_more
 ds_read_b64_tr_b16 v[240:241], v12 offset:40960
 v_mul_f32 v192, v20, v192
 s_waitcnt lgkmcnt(5)
 v_mfma_f32_16x16x32_bf16 a[0:3], v[24:27], v[80:83], a[0:3]
 ds_read_b64_tr_b16 v[242:243], v12 offset:43008
 v_mul_f32 v193, v20, v193
 v_mul_f32 v194, v20, v194
 v_mfma_f32_16x16x32_bf16 a[4:7], v[24:27], v[84:87], a[4:7]
 ds_read_b64_tr_b16 v[244:245], v13 offset:40960
 v_mul_f32 v195, v20, v195
 v_mfma_f32_16x16x32_bf16 a[8:11], v[28:31], v[80:83], a[8:11]
 ds_read_b64_tr_b16 v[246:247], v13 offset:43008
 v_cvt_pk_bf16_f32 v88, v192, v193
 v_cvt_pk_bf16_f32 v89, v194, v195
 v_mfma_f32_16x16x32_bf16 a[12:15], v[28:31], v[84:87], a[12:15]
 ds_read_b64_tr_b16 v[24:25], v8 offset:28672
 v_mul_f32 v200, v20, v200
 v_mfma_f32_16x16x32_bf16 a[16:19], v[32:35], v[80:83], a[16:19]
 ds_read_b64_tr_b16 v[26:27], v8 offset:30720
 v_mul_f32 v201, v20, v201
 v_mul_f32 v202, v20, v202
 v_mfma_f32_16x16x32_bf16 a[20:23], v[32:35], v[84:87], a[20:23]
 ds_read_b64_tr_b16 v[28:29], v9 offset:28672
 v_mul_f32 v203, v20, v203
 v_mfma_f32_16x16x32_bf16 a[24:27], v[36:39], v[80:83], a[24:27]
 ds_read_b64_tr_b16 v[30:31], v9 offset:30720
 v_cvt_pk_bf16_f32 v90, v200, v201
 v_cvt_pk_bf16_f32 v91, v202, v203
 v_mfma_f32_16x16x32_bf16 a[28:31], v[36:39], v[84:87], a[28:31]
 ds_read_b64_tr_b16 v[32:33], v12 offset:28672
 v_mul_f32 v196, v11, v196
 s_waitcnt lgkmcnt(5)
 v_mfma_f32_16x16x32_bf16 a[32:35], v[40:43], v[80:83], a[32:35]
 ds_read_b64_tr_b16 v[34:35], v12 offset:30720
 v_mul_f32 v197, v11, v197
 v_mul_f32 v198, v11, v198
 v_mfma_f32_16x16x32_bf16 a[36:39], v[40:43], v[84:87], a[36:39]
 ds_read_b64_tr_b16 v[36:37], v13 offset:28672
 v_mul_f32 v199, v11, v199
 v_mfma_f32_16x16x32_bf16 a[40:43], v[44:47], v[80:83], a[40:43]
 ds_read_b64_tr_b16 v[38:39], v13 offset:30720
 v_cvt_pk_bf16_f32 v92, v196, v197
 v_cvt_pk_bf16_f32 v93, v198, v199
 v_mfma_f32_16x16x32_bf16 a[44:47], v[44:47], v[84:87], a[44:47]
 ds_read_b64_tr_b16 v[40:41], v8 offset:45056
 v_mul_f32 v204, v11, v204
 v_mfma_f32_16x16x32_bf16 a[48:51], v[240:243], v[80:83], a[48:51]
 ds_read_b64_tr_b16 v[42:43], v8 offset:47104
 v_mul_f32 v205, v11, v205
 v_mul_f32 v206, v11, v206
 v_mfma_f32_16x16x32_bf16 a[52:55], v[240:243], v[84:87], a[52:55]
 ds_read_b64_tr_b16 v[44:45], v9 offset:45056
 v_mul_f32 v207, v11, v207
 v_mfma_f32_16x16x32_bf16 a[56:59], v[244:247], v[80:83], a[56:59]
 ds_read_b64_tr_b16 v[46:47], v9 offset:47104
 v_cvt_pk_bf16_f32 v94, v204, v205
 v_cvt_pk_bf16_f32 v95, v206, v207
 v_mfma_f32_16x16x32_bf16 a[60:63], v[244:247], v[84:87], a[60:63]
 ds_read_b64_tr_b16 v[240:241], v12 offset:45056
 s_waitcnt lgkmcnt(5)
 v_mfma_f32_16x16x32_bf16 a[0:3], v[24:27], v[88:91], a[0:3]
 ds_read_b64_tr_b16 v[242:243], v12 offset:47104
 v_mfma_f32_16x16x32_bf16 a[4:7], v[24:27], v[92:95], a[4:7]
 ds_read_b64_tr_b16 v[244:245], v13 offset:45056
 v_mfma_f32_16x16x32_bf16 a[8:11], v[28:31], v[88:91], a[8:11]
 ds_read_b64_tr_b16 v[246:247], v13 offset:47104
 v_mfma_f32_16x16x32_bf16 a[12:15], v[28:31], v[92:95], a[12:15]
 v_mfma_f32_16x16x32_bf16 a[16:19], v[32:35], v[88:91], a[16:19]
 v_mfma_f32_16x16x32_bf16 a[20:23], v[32:35], v[92:95], a[20:23]
 v_mfma_f32_16x16x32_bf16 a[24:27], v[36:39], v[88:91], a[24:27]
 v_mfma_f32_16x16x32_bf16 a[28:31], v[36:39], v[92:95], a[28:31]
 s_waitcnt lgkmcnt(0)
 s_barrier
 v_add_u32 v8, 65536, v8
 ds_read_b64_tr_b16 v[24:25], v8 offset:0
 v_add_u32 v9, 65536, v9
 ds_read_b64_tr_b16 v[28:29], v9 offset:0
 ds_read_b64_tr_b16 v[26:27], v8 offset:2048
 v_add_u32 v12, 65536, v12
 ds_read_b64_tr_b16 v[32:33], v12 offset:0
 ds_read_b64_tr_b16 v[30:31], v9 offset:2048
 v_mfma_f32_16x16x32_bf16 a[32:35], v[40:43], v[88:91], a[32:35]
 ds_read_b64_tr_b16 v[34:35], v12 offset:2048
 v_mfma_f32_16x16x32_bf16 a[36:39], v[40:43], v[92:95], a[36:39]
 v_add_u32 v13, 65536, v13
 ds_read_b64_tr_b16 v[36:37], v13 offset:0
 v_mfma_f32_16x16x32_bf16 a[40:43], v[44:47], v[88:91], a[40:43]
 ds_read_b64_tr_b16 v[38:39], v13 offset:2048
 v_mfma_f32_16x16x32_bf16 a[44:47], v[44:47], v[92:95], a[44:47]
 ds_read_b64_tr_b16 v[40:41], v8 offset:4096
 v_mfma_f32_16x16x32_bf16 a[48:51], v[240:243], v[88:91], a[48:51]
 ds_read_b64_tr_b16 v[42:43], v8 offset:6144
 v_mfma_f32_16x16x32_bf16 a[52:55], v[240:243], v[92:95], a[52:55]
 ds_read_b64_tr_b16 v[44:45], v9 offset:4096
 v_mfma_f32_16x16x32_bf16 a[56:59], v[244:247], v[88:91], a[56:59]
 ds_read_b64_tr_b16 v[46:47], v9 offset:6144
 v_mfma_f32_16x16x32_bf16 a[60:63], v[244:247], v[92:95], a[60:63]
 ds_read_b64_tr_b16 v[240:241], v12 offset:4096
 s_waitcnt lgkmcnt(5)
 v_mfma_f32_16x16x32_bf16 a[64:67], v[24:27], v[64:67], a[64:67]
 ds_read_b64_tr_b16 v[242:243], v12 offset:6144
 v_mfma_f32_16x16x32_bf16 a[68:71], v[24:27], v[68:71], a[68:71]
 ds_read_b64_tr_b16 v[244:245], v13 offset:4096
 v_mfma_f32_16x16x32_bf16 a[72:75], v[28:31], v[64:67], a[72:75]
 ds_read_b64_tr_b16 v[246:247], v13 offset:6144
 v_mfma_f32_16x16x32_bf16 a[76:79], v[28:31], v[68:71], a[76:79]
 ds_read_b64_tr_b16 v[24:25], v8 offset:8192
 s_mul_i32 s56, s80, 768
 s_add_u32 s56, s56, s51
 v_mfma_f32_16x16x32_bf16 a[80:83], v[32:35], v[64:67], a[80:83]
 ds_read_b64_tr_b16 v[26:27], v8 offset:10240
 v_accvgpr_read_b32 v112, a0
 v_accvgpr_read_b32 v113, a1
 v_mfma_f32_16x16x32_bf16 a[84:87], v[32:35], v[68:71], a[84:87]
 ds_read_b64_tr_b16 v[28:29], v9 offset:8192
 v_accvgpr_read_b32 v114, a2
 v_accvgpr_read_b32 v115, a3
 v_mfma_f32_16x16x32_bf16 a[88:91], v[36:39], v[64:67], a[88:91]
 ds_read_b64_tr_b16 v[30:31], v9 offset:10240
 v_accvgpr_read_b32 v116, a8
 v_accvgpr_read_b32 v117, a9
 v_mfma_f32_16x16x32_bf16 a[92:95], v[36:39], v[68:71], a[92:95]
 ds_read_b64_tr_b16 v[32:33], v12 offset:8192
 v_accvgpr_read_b32 v118, a10
 s_waitcnt lgkmcnt(5)
 v_mfma_f32_16x16x32_bf16 a[64:67], v[40:43], v[72:75], a[64:67]
 ds_read_b64_tr_b16 v[34:35], v12 offset:10240
 v_accvgpr_read_b32 v119, a11
 v_cvt_pk_bf16_f32 v96, v112, v113
 v_cvt_pk_bf16_f32 v97, v114, v115
 v_mfma_f32_16x16x32_bf16 a[68:71], v[40:43], v[76:79], a[68:71]
 ds_read_b64_tr_b16 v[36:37], v13 offset:8192
 v_cvt_pk_bf16_f32 v98, v116, v117
 v_cvt_pk_bf16_f32 v99, v118, v119
 v_mfma_f32_16x16x32_bf16 a[72:75], v[44:47], v[72:75], a[72:75]
 ds_read_b64_tr_b16 v[38:39], v13 offset:10240
 buffer_store_dwordx4 v[96:99], v22, s[36:39], s56 offen offset:0 sc1
 v_accvgpr_read_b32 v120, a4
 v_accvgpr_read_b32 v121, a5
 v_mfma_f32_16x16x32_bf16 a[76:79], v[44:47], v[76:79], a[76:79]
 ds_read_b64_tr_b16 v[40:41], v8 offset:12288
 v_accvgpr_read_b32 v122, a6
 v_accvgpr_read_b32 v123, a7
 v_mfma_f32_16x16x32_bf16 a[80:83], v[240:243], v[72:75], a[80:83]
 ds_read_b64_tr_b16 v[42:43], v8 offset:14336
 v_accvgpr_read_b32 v124, a12
 v_accvgpr_read_b32 v125, a13
 v_mfma_f32_16x16x32_bf16 a[84:87], v[240:243], v[76:79], a[84:87]
 ds_read_b64_tr_b16 v[44:45], v9 offset:12288
 v_accvgpr_read_b32 v126, a14
 v_accvgpr_read_b32 v127, a15
 v_mfma_f32_16x16x32_bf16 a[88:91], v[244:247], v[72:75], a[88:91]
 ds_read_b64_tr_b16 v[46:47], v9 offset:14336
 v_cvt_pk_bf16_f32 v100, v120, v121
 v_cvt_pk_bf16_f32 v101, v122, v123
 v_mfma_f32_16x16x32_bf16 a[92:95], v[244:247], v[76:79], a[92:95]
 ds_read_b64_tr_b16 v[240:241], v12 offset:12288
 v_cvt_pk_bf16_f32 v102, v124, v125
 v_cvt_pk_bf16_f32 v103, v126, v127
 s_waitcnt lgkmcnt(5)
 v_mfma_f32_16x16x32_bf16 a[64:67], v[24:27], v[80:83], a[64:67]
 ds_read_b64_tr_b16 v[242:243], v12 offset:14336
 buffer_store_dwordx4 v[100:103], v22, s[36:39], s56 offen offset:1024 sc1
 v_accvgpr_read_b32 v128, a16
 v_mfma_f32_16x16x32_bf16 a[68:71], v[24:27], v[84:87], a[68:71]
 ds_read_b64_tr_b16 v[244:245], v13 offset:12288
 v_accvgpr_read_b32 v129, a17
 v_accvgpr_read_b32 v130, a18
 v_mfma_f32_16x16x32_bf16 a[72:75], v[28:31], v[80:83], a[72:75]
 ds_read_b64_tr_b16 v[246:247], v13 offset:14336
 v_accvgpr_read_b32 v131, a19
 v_accvgpr_read_b32 v132, a24
 v_mfma_f32_16x16x32_bf16 a[76:79], v[28:31], v[84:87], a[76:79]
 v_accvgpr_read_b32 v133, a25
 v_accvgpr_read_b32 v134, a26
 v_mfma_f32_16x16x32_bf16 a[80:83], v[32:35], v[80:83], a[80:83]
 v_accvgpr_read_b32 v135, a27
 v_cvt_pk_bf16_f32 v104, v128, v129
 v_mfma_f32_16x16x32_bf16 a[84:87], v[32:35], v[84:87], a[84:87]
 v_cvt_pk_bf16_f32 v105, v130, v131
 v_cvt_pk_bf16_f32 v106, v132, v133
 v_cvt_pk_bf16_f32 v107, v134, v135
 v_mfma_f32_16x16x32_bf16 a[88:91], v[36:39], v[80:83], a[88:91]
 buffer_store_dwordx4 v[104:107], v22, s[36:39], s56 offen offset:2048 sc1
 v_accvgpr_read_b32 v136, a20
 v_mfma_f32_16x16x32_bf16 a[92:95], v[36:39], v[84:87], a[92:95]
 s_waitcnt lgkmcnt(0)
 s_barrier
 v_add_u32 v8, 4294950912, v8
 ds_read_b64_tr_b16 v[24:25], v8 offset:0
 v_add_u32 v9, 4294950912, v9
 ds_read_b64_tr_b16 v[28:29], v9 offset:0
 ds_read_b64_tr_b16 v[26:27], v8 offset:2048
 v_add_u32 v12, 4294950912, v12
 ds_read_b64_tr_b16 v[32:33], v12 offset:0
 ds_read_b64_tr_b16 v[30:31], v9 offset:2048
 v_mfma_f32_16x16x32_bf16 a[64:67], v[40:43], v[88:91], a[64:67]
 ds_read_b64_tr_b16 v[34:35], v12 offset:2048
 v_accvgpr_read_b32 v137, a21
 v_accvgpr_read_b32 v138, a22
 v_accvgpr_read_b32 v139, a23
 v_accvgpr_read_b32 v140, a28
 v_mfma_f32_16x16x32_bf16 a[68:71], v[40:43], v[92:95], a[68:71]
 v_add_u32 v13, 4294950912, v13
 ds_read_b64_tr_b16 v[36:37], v13 offset:0
 v_accvgpr_read_b32 v141, a29
 v_accvgpr_read_b32 v142, a30
 v_mfma_f32_16x16x32_bf16 a[72:75], v[44:47], v[88:91], a[72:75]
 ds_read_b64_tr_b16 v[38:39], v13 offset:2048
 v_accvgpr_read_b32 v143, a31
 v_cvt_pk_bf16_f32 v108, v136, v137
 v_mfma_f32_16x16x32_bf16 a[76:79], v[44:47], v[92:95], a[76:79]
 ds_read_b64_tr_b16 v[40:41], v8 offset:4096
 v_cvt_pk_bf16_f32 v109, v138, v139
 v_cvt_pk_bf16_f32 v110, v140, v141
 v_cvt_pk_bf16_f32 v111, v142, v143
 v_mfma_f32_16x16x32_bf16 a[80:83], v[240:243], v[88:91], a[80:83]
 ds_read_b64_tr_b16 v[42:43], v8 offset:6144
 buffer_store_dwordx4 v[108:111], v22, s[36:39], s56 offen offset:3072 sc1
 v_mfma_f32_16x16x32_bf16 a[84:87], v[240:243], v[92:95], a[84:87]
 ds_read_b64_tr_b16 v[44:45], v9 offset:4096
 s_mul_i32 s56, s81, 768
 s_add_u32 s56, s56, s51
 v_mfma_f32_16x16x32_bf16 a[88:91], v[244:247], v[88:91], a[88:91]
 ds_read_b64_tr_b16 v[46:47], v9 offset:6144
 v_accvgpr_read_b32 v112, a32
 v_accvgpr_read_b32 v113, a33
 v_mfma_f32_16x16x32_bf16 a[92:95], v[244:247], v[92:95], a[92:95]
 ds_read_b64_tr_b16 v[240:241], v12 offset:4096
 v_accvgpr_read_b32 v114, a34
 s_waitcnt lgkmcnt(5)
 v_mfma_f32_16x16x32_bf16 a[96:99], v[24:27], v[64:67], a[96:99]
 ds_read_b64_tr_b16 v[242:243], v12 offset:6144
 v_accvgpr_read_b32 v115, a35
 v_accvgpr_read_b32 v116, a40
 v_accvgpr_read_b32 v117, a41
 v_mfma_f32_16x16x32_bf16 a[100:103], v[24:27], v[68:71], a[100:103]
 ds_read_b64_tr_b16 v[244:245], v13 offset:4096
 v_accvgpr_read_b32 v118, a42
 v_accvgpr_read_b32 v119, a43
 v_mfma_f32_16x16x32_bf16 a[104:107], v[28:31], v[64:67], a[104:107]
 ds_read_b64_tr_b16 v[246:247], v13 offset:6144
 v_cvt_pk_bf16_f32 v96, v112, v113
 v_cvt_pk_bf16_f32 v97, v114, v115
 v_mfma_f32_16x16x32_bf16 a[108:111], v[28:31], v[68:71], a[108:111]
 ds_read_b64_tr_b16 v[24:25], v8 offset:8192
 v_cvt_pk_bf16_f32 v98, v116, v117
 v_cvt_pk_bf16_f32 v99, v118, v119
 v_mfma_f32_16x16x32_bf16 a[112:115], v[32:35], v[64:67], a[112:115]
 ds_read_b64_tr_b16 v[26:27], v8 offset:10240
 buffer_store_dwordx4 v[96:99], v22, s[36:39], s56 offen offset:0 sc1
 v_mfma_f32_16x16x32_bf16 a[116:119], v[32:35], v[68:71], a[116:119]
 ds_read_b64_tr_b16 v[28:29], v9 offset:8192
 v_accvgpr_read_b32 v120, a36
 v_accvgpr_read_b32 v121, a37
 v_mfma_f32_16x16x32_bf16 a[120:123], v[36:39], v[64:67], a[120:123]
 ds_read_b64_tr_b16 v[30:31], v9 offset:10240
 v_accvgpr_read_b32 v122, a38
 v_accvgpr_read_b32 v123, a39
 v_mfma_f32_16x16x32_bf16 a[124:127], v[36:39], v[68:71], a[124:127]
 ds_read_b64_tr_b16 v[32:33], v12 offset:8192
 v_accvgpr_read_b32 v124, a44
 s_waitcnt lgkmcnt(5)
 v_mfma_f32_16x16x32_bf16 a[96:99], v[40:43], v[72:75], a[96:99]
 ds_read_b64_tr_b16 v[34:35], v12 offset:10240
 v_accvgpr_read_b32 v125, a45
 v_accvgpr_read_b32 v126, a46
 v_accvgpr_read_b32 v127, a47
 v_mfma_f32_16x16x32_bf16 a[100:103], v[40:43], v[76:79], a[100:103]
 ds_read_b64_tr_b16 v[36:37], v13 offset:8192
 v_cvt_pk_bf16_f32 v100, v120, v121
 v_cvt_pk_bf16_f32 v101, v122, v123
 v_mfma_f32_16x16x32_bf16 a[104:107], v[44:47], v[72:75], a[104:107]
 ds_read_b64_tr_b16 v[38:39], v13 offset:10240
 v_cvt_pk_bf16_f32 v102, v124, v125
 v_cvt_pk_bf16_f32 v103, v126, v127
 v_mfma_f32_16x16x32_bf16 a[108:111], v[44:47], v[76:79], a[108:111]
 ds_read_b64_tr_b16 v[40:41], v8 offset:12288
 buffer_store_dwordx4 v[100:103], v22, s[36:39], s56 offen offset:1024 sc1
 v_mfma_f32_16x16x32_bf16 a[112:115], v[240:243], v[72:75], a[112:115]
 ds_read_b64_tr_b16 v[42:43], v8 offset:14336
 v_accvgpr_read_b32 v128, a48
 v_accvgpr_read_b32 v129, a49
 v_accvgpr_read_b32 v130, a50
 v_mfma_f32_16x16x32_bf16 a[116:119], v[240:243], v[76:79], a[116:119]
 ds_read_b64_tr_b16 v[44:45], v9 offset:12288
 v_accvgpr_read_b32 v131, a51
 v_accvgpr_read_b32 v132, a56
 v_mfma_f32_16x16x32_bf16 a[120:123], v[244:247], v[72:75], a[120:123]
 ds_read_b64_tr_b16 v[46:47], v9 offset:14336
 v_accvgpr_read_b32 v133, a57
 v_accvgpr_read_b32 v134, a58
 v_mfma_f32_16x16x32_bf16 a[124:127], v[244:247], v[76:79], a[124:127]
 ds_read_b64_tr_b16 v[240:241], v12 offset:12288
 v_accvgpr_read_b32 v135, a59
 s_waitcnt lgkmcnt(5)
 v_mfma_f32_16x16x32_bf16 a[96:99], v[24:27], v[80:83], a[96:99]
 ds_read_b64_tr_b16 v[242:243], v12 offset:14336
 v_cvt_pk_bf16_f32 v104, v128, v129
 v_cvt_pk_bf16_f32 v105, v130, v131
 v_cvt_pk_bf16_f32 v106, v132, v133
 v_mfma_f32_16x16x32_bf16 a[100:103], v[24:27], v[84:87], a[100:103]
 ds_read_b64_tr_b16 v[244:245], v13 offset:12288
 v_cvt_pk_bf16_f32 v107, v134, v135
 v_mfma_f32_16x16x32_bf16 a[104:107], v[28:31], v[80:83], a[104:107]
 ds_read_b64_tr_b16 v[246:247], v13 offset:14336
 buffer_store_dwordx4 v[104:107], v22, s[36:39], s56 offen offset:2048 sc1
 v_accvgpr_read_b32 v136, a52
 v_mfma_f32_16x16x32_bf16 a[108:111], v[28:31], v[84:87], a[108:111]
 v_accvgpr_read_b32 v137, a53
 v_accvgpr_read_b32 v138, a54
 v_mfma_f32_16x16x32_bf16 a[112:115], v[32:35], v[80:83], a[112:115]
 v_accvgpr_read_b32 v139, a55
 v_accvgpr_read_b32 v140, a60
 v_mfma_f32_16x16x32_bf16 a[116:119], v[32:35], v[84:87], a[116:119]
 v_accvgpr_read_b32 v141, a61
 v_accvgpr_read_b32 v142, a62
 v_mfma_f32_16x16x32_bf16 a[120:123], v[36:39], v[80:83], a[120:123]
 v_accvgpr_read_b32 v143, a63
 v_cvt_pk_bf16_f32 v108, v136, v137
 v_mfma_f32_16x16x32_bf16 a[124:127], v[36:39], v[84:87], a[124:127]
 s_waitcnt lgkmcnt(0)
 s_barrier
 ds_read_b64_tr_b16 v[24:25], v8 offset:32768
 ds_read_b64_tr_b16 v[28:29], v9 offset:32768
 ds_read_b64_tr_b16 v[26:27], v8 offset:34816
 ds_read_b64_tr_b16 v[32:33], v12 offset:32768
 ds_read_b64_tr_b16 v[30:31], v9 offset:34816
 v_cvt_pk_bf16_f32 v109, v138, v139
 v_mfma_f32_16x16x32_bf16 a[96:99], v[40:43], v[88:91], a[96:99]
 ds_read_b64_tr_b16 v[34:35], v12 offset:34816
 v_cvt_pk_bf16_f32 v110, v140, v141
 v_cvt_pk_bf16_f32 v111, v142, v143
 buffer_store_dwordx4 v[108:111], v22, s[36:39], s56 offen offset:3072 sc1
 v_mfma_f32_16x16x32_bf16 a[100:103], v[40:43], v[92:95], a[100:103]
 ds_read_b64_tr_b16 v[36:37], v13 offset:32768
 s_mul_i32 s56, s82, 768
 s_add_u32 s56, s56, s51
 v_mfma_f32_16x16x32_bf16 a[104:107], v[44:47], v[88:91], a[104:107]
 ds_read_b64_tr_b16 v[38:39], v13 offset:34816
 v_accvgpr_read_b32 v112, a64
 v_accvgpr_read_b32 v113, a65
 v_mfma_f32_16x16x32_bf16 a[108:111], v[44:47], v[92:95], a[108:111]
 ds_read_b64_tr_b16 v[40:41], v8 offset:36864
 v_accvgpr_read_b32 v114, a66
 v_accvgpr_read_b32 v115, a67
 v_mfma_f32_16x16x32_bf16 a[112:115], v[240:243], v[88:91], a[112:115]
 ds_read_b64_tr_b16 v[42:43], v8 offset:38912
 v_accvgpr_read_b32 v116, a72
 v_accvgpr_read_b32 v117, a73
 v_mfma_f32_16x16x32_bf16 a[116:119], v[240:243], v[92:95], a[116:119]
 ds_read_b64_tr_b16 v[44:45], v9 offset:36864
 v_accvgpr_read_b32 v118, a74
 v_accvgpr_read_b32 v119, a75
 v_mfma_f32_16x16x32_bf16 a[120:123], v[244:247], v[88:91], a[120:123]
 ds_read_b64_tr_b16 v[46:47], v9 offset:38912
 v_cvt_pk_bf16_f32 v96, v112, v113
 v_cvt_pk_bf16_f32 v97, v114, v115
 v_mfma_f32_16x16x32_bf16 a[124:127], v[244:247], v[92:95], a[124:127]
 ds_read_b64_tr_b16 v[240:241], v12 offset:36864
 v_cvt_pk_bf16_f32 v98, v116, v117
 v_cvt_pk_bf16_f32 v99, v118, v119
 s_waitcnt lgkmcnt(5)
 v_mfma_f32_16x16x32_bf16 a[128:131], v[24:27], v[64:67], a[128:131]
 ds_read_b64_tr_b16 v[242:243], v12 offset:38912
 buffer_store_dwordx4 v[96:99], v22, s[36:39], s56 offen offset:0 sc1
 v_mfma_f32_16x16x32_bf16 a[132:135], v[24:27], v[68:71], a[132:135]
 ds_read_b64_tr_b16 v[244:245], v13 offset:36864
 v_accvgpr_read_b32 v120, a68
 v_accvgpr_read_b32 v121, a69
 v_mfma_f32_16x16x32_bf16 a[136:139], v[28:31], v[64:67], a[136:139]
 ds_read_b64_tr_b16 v[246:247], v13 offset:38912
 v_accvgpr_read_b32 v122, a70
 v_accvgpr_read_b32 v123, a71
 v_mfma_f32_16x16x32_bf16 a[140:143], v[28:31], v[68:71], a[140:143]
 ds_read_b64_tr_b16 v[24:25], v8 offset:40960
 v_accvgpr_read_b32 v124, a76
 v_accvgpr_read_b32 v125, a77
 v_mfma_f32_16x16x32_bf16 a[144:147], v[32:35], v[64:67], a[144:147]
 ds_read_b64_tr_b16 v[26:27], v8 offset:43008
 v_accvgpr_read_b32 v126, a78
 v_accvgpr_read_b32 v127, a79
 v_mfma_f32_16x16x32_bf16 a[148:151], v[32:35], v[68:71], a[148:151]
 ds_read_b64_tr_b16 v[28:29], v9 offset:40960
 v_cvt_pk_bf16_f32 v100, v120, v121
 v_cvt_pk_bf16_f32 v101, v122, v123
 v_mfma_f32_16x16x32_bf16 a[152:155], v[36:39], v[64:67], a[152:155]
 ds_read_b64_tr_b16 v[30:31], v9 offset:43008
 v_cvt_pk_bf16_f32 v102, v124, v125
 v_cvt_pk_bf16_f32 v103, v126, v127
 v_mfma_f32_16x16x32_bf16 a[156:159], v[36:39], v[68:71], a[156:159]
 ds_read_b64_tr_b16 v[32:33], v12 offset:40960
 buffer_store_dwordx4 v[100:103], v22, s[36:39], s56 offen offset:1024 sc1
 s_waitcnt lgkmcnt(5)
 v_mfma_f32_16x16x32_bf16 a[128:131], v[40:43], v[72:75], a[128:131]
 ds_read_b64_tr_b16 v[34:35], v12 offset:43008
 v_accvgpr_read_b32 v128, a80
 v_accvgpr_read_b32 v129, a81
 v_accvgpr_read_b32 v130, a82
 v_mfma_f32_16x16x32_bf16 a[132:135], v[40:43], v[76:79], a[132:135]
 ds_read_b64_tr_b16 v[36:37], v13 offset:40960
 v_accvgpr_read_b32 v131, a83
 v_accvgpr_read_b32 v132, a88
 v_mfma_f32_16x16x32_bf16 a[136:139], v[44:47], v[72:75], a[136:139]
 ds_read_b64_tr_b16 v[38:39], v13 offset:43008
 v_accvgpr_read_b32 v133, a89
 v_accvgpr_read_b32 v134, a90
 v_mfma_f32_16x16x32_bf16 a[140:143], v[44:47], v[76:79], a[140:143]
 ds_read_b64_tr_b16 v[40:41], v8 offset:45056
 v_accvgpr_read_b32 v135, a91
 v_cvt_pk_bf16_f32 v104, v128, v129
 v_mfma_f32_16x16x32_bf16 a[144:147], v[240:243], v[72:75], a[144:147]
 ds_read_b64_tr_b16 v[42:43], v8 offset:47104
 v_cvt_pk_bf16_f32 v105, v130, v131
 v_cvt_pk_bf16_f32 v106, v132, v133
 v_mfma_f32_16x16x32_bf16 a[148:151], v[240:243], v[76:79], a[148:151]
 ds_read_b64_tr_b16 v[44:45], v9 offset:45056
 v_cvt_pk_bf16_f32 v107, v134, v135
 v_mfma_f32_16x16x32_bf16 a[152:155], v[244:247], v[72:75], a[152:155]
 ds_read_b64_tr_b16 v[46:47], v9 offset:47104
 buffer_store_dwordx4 v[104:107], v22, s[36:39], s56 offen offset:2048 sc1
 v_accvgpr_read_b32 v136, a84
 v_mfma_f32_16x16x32_bf16 a[156:159], v[244:247], v[76:79], a[156:159]
 ds_read_b64_tr_b16 v[240:241], v12 offset:45056
 v_accvgpr_read_b32 v137, a85
 s_waitcnt lgkmcnt(5)
 v_mfma_f32_16x16x32_bf16 a[128:131], v[24:27], v[80:83], a[128:131]
 ds_read_b64_tr_b16 v[242:243], v12 offset:47104
 v_accvgpr_read_b32 v138, a86
 v_accvgpr_read_b32 v139, a87
 v_accvgpr_read_b32 v140, a92
 v_mfma_f32_16x16x32_bf16 a[132:135], v[24:27], v[84:87], a[132:135]
 ds_read_b64_tr_b16 v[244:245], v13 offset:45056
 v_accvgpr_read_b32 v141, a93
 v_accvgpr_read_b32 v142, a94
 v_mfma_f32_16x16x32_bf16 a[136:139], v[28:31], v[80:83], a[136:139]
 ds_read_b64_tr_b16 v[246:247], v13 offset:47104
 v_accvgpr_read_b32 v143, a95
 v_cvt_pk_bf16_f32 v108, v136, v137
 v_mfma_f32_16x16x32_bf16 a[140:143], v[28:31], v[84:87], a[140:143]
 v_cvt_pk_bf16_f32 v109, v138, v139
 v_cvt_pk_bf16_f32 v110, v140, v141
 v_cvt_pk_bf16_f32 v111, v142, v143
 v_mfma_f32_16x16x32_bf16 a[144:147], v[32:35], v[80:83], a[144:147]
 buffer_store_dwordx4 v[108:111], v22, s[36:39], s56 offen offset:3072 sc1
 v_mfma_f32_16x16x32_bf16 a[148:151], v[32:35], v[84:87], a[148:151]
 s_mul_i32 s56, s83, 768
 s_add_u32 s56, s56, s51
 v_mfma_f32_16x16x32_bf16 a[152:155], v[36:39], v[80:83], a[152:155]
 v_accvgpr_read_b32 v112, a96
 v_accvgpr_read_b32 v113, a97
 v_mfma_f32_16x16x32_bf16 a[156:159], v[36:39], v[84:87], a[156:159]
 s_waitcnt lgkmcnt(0)
 s_barrier
 ds_read_b64_tr_b16 v[24:25], v8 offset:49152
 ds_read_b64_tr_b16 v[28:29], v9 offset:49152
 ds_read_b64_tr_b16 v[26:27], v8 offset:51200
 ds_read_b64_tr_b16 v[32:33], v12 offset:49152
 ds_read_b64_tr_b16 v[30:31], v9 offset:51200
 v_mfma_f32_16x16x32_bf16 a[128:131], v[40:43], v[88:91], a[128:131]
 ds_read_b64_tr_b16 v[34:35], v12 offset:51200
 v_accvgpr_read_b32 v114, a98
 v_accvgpr_read_b32 v115, a99
 v_accvgpr_read_b32 v116, a104
 v_accvgpr_read_b32 v117, a105
 v_mfma_f32_16x16x32_bf16 a[132:135], v[40:43], v[92:95], a[132:135]
 ds_read_b64_tr_b16 v[36:37], v13 offset:49152
 v_accvgpr_read_b32 v118, a106
 v_accvgpr_read_b32 v119, a107
 v_mfma_f32_16x16x32_bf16 a[136:139], v[44:47], v[88:91], a[136:139]
 ds_read_b64_tr_b16 v[38:39], v13 offset:51200
 v_cvt_pk_bf16_f32 v96, v112, v113
 v_cvt_pk_bf16_f32 v97, v114, v115
 v_mfma_f32_16x16x32_bf16 a[140:143], v[44:47], v[92:95], a[140:143]
 ds_read_b64_tr_b16 v[40:41], v8 offset:53248
 v_cvt_pk_bf16_f32 v98, v116, v117
 v_cvt_pk_bf16_f32 v99, v118, v119
 v_mfma_f32_16x16x32_bf16 a[144:147], v[240:243], v[88:91], a[144:147]
 ds_read_b64_tr_b16 v[42:43], v8 offset:55296
 buffer_store_dwordx4 v[96:99], v22, s[36:39], s56 offen offset:0 sc1
 v_mfma_f32_16x16x32_bf16 a[148:151], v[240:243], v[92:95], a[148:151]
 ds_read_b64_tr_b16 v[44:45], v9 offset:53248
 v_accvgpr_read_b32 v120, a100
 v_accvgpr_read_b32 v121, a101
 v_mfma_f32_16x16x32_bf16 a[152:155], v[244:247], v[88:91], a[152:155]
 ds_read_b64_tr_b16 v[46:47], v9 offset:55296
 v_accvgpr_read_b32 v122, a102
 v_accvgpr_read_b32 v123, a103
 v_mfma_f32_16x16x32_bf16 a[156:159], v[244:247], v[92:95], a[156:159]
 ds_read_b64_tr_b16 v[240:241], v12 offset:53248
 v_accvgpr_read_b32 v124, a108
 s_waitcnt lgkmcnt(5)
 v_mfma_f32_16x16x32_bf16 a[160:163], v[24:27], v[64:67], a[160:163]
 ds_read_b64_tr_b16 v[242:243], v12 offset:55296
 v_accvgpr_read_b32 v125, a109
 v_accvgpr_read_b32 v126, a110
 v_accvgpr_read_b32 v127, a111
 v_mfma_f32_16x16x32_bf16 a[164:167], v[24:27], v[68:71], a[164:167]
 ds_read_b64_tr_b16 v[244:245], v13 offset:53248
 v_cvt_pk_bf16_f32 v100, v120, v121
 v_cvt_pk_bf16_f32 v101, v122, v123
 v_mfma_f32_16x16x32_bf16 a[168:171], v[28:31], v[64:67], a[168:171]
 ds_read_b64_tr_b16 v[246:247], v13 offset:55296
 v_cvt_pk_bf16_f32 v102, v124, v125
 v_cvt_pk_bf16_f32 v103, v126, v127
 v_mfma_f32_16x16x32_bf16 a[172:175], v[28:31], v[68:71], a[172:175]
 ds_read_b64_tr_b16 v[24:25], v8 offset:57344
 buffer_store_dwordx4 v[100:103], v22, s[36:39], s56 offen offset:1024 sc1
 v_mfma_f32_16x16x32_bf16 a[176:179], v[32:35], v[64:67], a[176:179]
 ds_read_b64_tr_b16 v[26:27], v8 offset:59392
 v_accvgpr_read_b32 v128, a112
 v_accvgpr_read_b32 v129, a113
 v_accvgpr_read_b32 v130, a114
 v_mfma_f32_16x16x32_bf16 a[180:183], v[32:35], v[68:71], a[180:183]
 ds_read_b64_tr_b16 v[28:29], v9 offset:57344
 v_accvgpr_read_b32 v131, a115
 v_accvgpr_read_b32 v132, a120
 v_mfma_f32_16x16x32_bf16 a[184:187], v[36:39], v[64:67], a[184:187]
 ds_read_b64_tr_b16 v[30:31], v9 offset:59392
 v_accvgpr_read_b32 v133, a121
 v_accvgpr_read_b32 v134, a122
 v_mfma_f32_16x16x32_bf16 a[188:191], v[36:39], v[68:71], a[188:191]
 ds_read_b64_tr_b16 v[32:33], v12 offset:57344
 v_accvgpr_read_b32 v135, a123
 s_waitcnt lgkmcnt(5)
 v_mfma_f32_16x16x32_bf16 a[160:163], v[40:43], v[72:75], a[160:163]
 ds_read_b64_tr_b16 v[34:35], v12 offset:59392
 v_cvt_pk_bf16_f32 v104, v128, v129
 v_cvt_pk_bf16_f32 v105, v130, v131
 v_cvt_pk_bf16_f32 v106, v132, v133
 v_mfma_f32_16x16x32_bf16 a[164:167], v[40:43], v[76:79], a[164:167]
 ds_read_b64_tr_b16 v[36:37], v13 offset:57344
 v_cvt_pk_bf16_f32 v107, v134, v135
 v_mfma_f32_16x16x32_bf16 a[168:171], v[44:47], v[72:75], a[168:171]
 ds_read_b64_tr_b16 v[38:39], v13 offset:59392
 buffer_store_dwordx4 v[104:107], v22, s[36:39], s56 offen offset:2048 sc1
 v_accvgpr_read_b32 v136, a116
 v_mfma_f32_16x16x32_bf16 a[172:175], v[44:47], v[76:79], a[172:175]
 ds_read_b64_tr_b16 v[40:41], v8 offset:61440
 v_accvgpr_read_b32 v137, a117
 v_accvgpr_read_b32 v138, a118
 v_mfma_f32_16x16x32_bf16 a[176:179], v[240:243], v[72:75], a[176:179]
 ds_read_b64_tr_b16 v[42:43], v8 offset:63488
 v_accvgpr_read_b32 v139, a119
 v_accvgpr_read_b32 v140, a124
 v_mfma_f32_16x16x32_bf16 a[180:183], v[240:243], v[76:79], a[180:183]
 ds_read_b64_tr_b16 v[44:45], v9 offset:61440
 v_accvgpr_read_b32 v141, a125
 v_accvgpr_read_b32 v142, a126
 v_mfma_f32_16x16x32_bf16 a[184:187], v[244:247], v[72:75], a[184:187]
 ds_read_b64_tr_b16 v[46:47], v9 offset:63488
 v_accvgpr_read_b32 v143, a127
 v_cvt_pk_bf16_f32 v108, v136, v137
 v_mfma_f32_16x16x32_bf16 a[188:191], v[244:247], v[76:79], a[188:191]
 ds_read_b64_tr_b16 v[240:241], v12 offset:61440
 v_cvt_pk_bf16_f32 v109, v138, v139
 v_cvt_pk_bf16_f32 v110, v140, v141
 v_cvt_pk_bf16_f32 v111, v142, v143
 s_waitcnt lgkmcnt(5)
 v_mfma_f32_16x16x32_bf16 a[160:163], v[24:27], v[80:83], a[160:163]
 ds_read_b64_tr_b16 v[242:243], v12 offset:63488
 buffer_store_dwordx4 v[108:111], v22, s[36:39], s56 offen offset:3072 sc1
 v_mfma_f32_16x16x32_bf16 a[164:167], v[24:27], v[84:87], a[164:167]
 ds_read_b64_tr_b16 v[244:245], v13 offset:61440
 s_mul_i32 s56, s84, 768
 s_add_u32 s56, s56, s51
 v_mfma_f32_16x16x32_bf16 a[168:171], v[28:31], v[80:83], a[168:171]
 ds_read_b64_tr_b16 v[246:247], v13 offset:63488
 v_accvgpr_read_b32 v112, a128
 v_accvgpr_read_b32 v113, a129
 v_mfma_f32_16x16x32_bf16 a[172:175], v[28:31], v[84:87], a[172:175]
 v_accvgpr_read_b32 v114, a130
 v_accvgpr_read_b32 v115, a131
 v_mfma_f32_16x16x32_bf16 a[176:179], v[32:35], v[80:83], a[176:179]
 v_accvgpr_read_b32 v116, a136
 v_accvgpr_read_b32 v117, a137
 v_mfma_f32_16x16x32_bf16 a[180:183], v[32:35], v[84:87], a[180:183]
 v_accvgpr_read_b32 v118, a138
 v_accvgpr_read_b32 v119, a139
 v_mfma_f32_16x16x32_bf16 a[184:187], v[36:39], v[80:83], a[184:187]
 v_cvt_pk_bf16_f32 v96, v112, v113
 v_cvt_pk_bf16_f32 v97, v114, v115
 v_mfma_f32_16x16x32_bf16 a[188:191], v[36:39], v[84:87], a[188:191]
 s_waitcnt lgkmcnt(0)
 s_barrier
 v_add_u32 v8, 4294950912, v8
 ds_read_b64_tr_b16 v[24:25], v8 offset:0
 v_add_u32 v9, 4294950912, v9
 ds_read_b64_tr_b16 v[28:29], v9 offset:0
 ds_read_b64_tr_b16 v[26:27], v8 offset:2048
 v_add_u32 v12, 4294950912, v12
 ds_read_b64_tr_b16 v[32:33], v12 offset:0
 ds_read_b64_tr_b16 v[30:31], v9 offset:2048
 v_cvt_pk_bf16_f32 v98, v116, v117
 v_mfma_f32_16x16x32_bf16 a[160:163], v[40:43], v[88:91], a[160:163]
 ds_read_b64_tr_b16 v[34:35], v12 offset:2048
 v_cvt_pk_bf16_f32 v99, v118, v119
 buffer_store_dwordx4 v[96:99], v22, s[36:39], s56 offen offset:0 sc1
 v_accvgpr_read_b32 v120, a132
 v_accvgpr_read_b32 v121, a133
 v_mfma_f32_16x16x32_bf16 a[164:167], v[40:43], v[92:95], a[164:167]
 v_add_u32 v13, 4294950912, v13
 ds_read_b64_tr_b16 v[36:37], v13 offset:0
 v_accvgpr_read_b32 v122, a134
 v_accvgpr_read_b32 v123, a135
 v_mfma_f32_16x16x32_bf16 a[168:171], v[44:47], v[88:91], a[168:171]
 ds_read_b64_tr_b16 v[38:39], v13 offset:2048
 v_accvgpr_read_b32 v124, a140
 v_accvgpr_read_b32 v125, a141
 v_mfma_f32_16x16x32_bf16 a[172:175], v[44:47], v[92:95], a[172:175]
 ds_read_b64_tr_b16 v[40:41], v8 offset:4096
 v_accvgpr_read_b32 v126, a142
 v_accvgpr_read_b32 v127, a143
 v_mfma_f32_16x16x32_bf16 a[176:179], v[240:243], v[88:91], a[176:179]
 ds_read_b64_tr_b16 v[42:43], v8 offset:6144
 v_cvt_pk_bf16_f32 v100, v120, v121
 v_cvt_pk_bf16_f32 v101, v122, v123
 v_mfma_f32_16x16x32_bf16 a[180:183], v[240:243], v[92:95], a[180:183]
 ds_read_b64_tr_b16 v[44:45], v9 offset:4096
 v_cvt_pk_bf16_f32 v102, v124, v125
 v_cvt_pk_bf16_f32 v103, v126, v127
 v_mfma_f32_16x16x32_bf16 a[184:187], v[244:247], v[88:91], a[184:187]
 ds_read_b64_tr_b16 v[46:47], v9 offset:6144
 buffer_store_dwordx4 v[100:103], v22, s[36:39], s56 offen offset:1024 sc1
 v_accvgpr_read_b32 v128, a144
 v_mfma_f32_16x16x32_bf16 a[188:191], v[244:247], v[92:95], a[188:191]
 ds_read_b64_tr_b16 v[240:241], v12 offset:4096
 v_accvgpr_read_b32 v129, a145
 s_waitcnt lgkmcnt(5)
 v_mfma_f32_16x16x32_bf16 a[192:195], v[24:27], v[64:67], a[192:195]
 ds_read_b64_tr_b16 v[242:243], v12 offset:6144
 v_accvgpr_read_b32 v130, a146
 v_accvgpr_read_b32 v131, a147
 v_accvgpr_read_b32 v132, a152
 v_mfma_f32_16x16x32_bf16 a[196:199], v[24:27], v[68:71], a[196:199]
 ds_read_b64_tr_b16 v[244:245], v13 offset:4096
 v_accvgpr_read_b32 v133, a153
 v_accvgpr_read_b32 v134, a154
 v_mfma_f32_16x16x32_bf16 a[200:203], v[28:31], v[64:67], a[200:203]
 ds_read_b64_tr_b16 v[246:247], v13 offset:6144
 v_accvgpr_read_b32 v135, a155
 v_cvt_pk_bf16_f32 v104, v128, v129
 v_mfma_f32_16x16x32_bf16 a[204:207], v[28:31], v[68:71], a[204:207]
 ds_read_b64_tr_b16 v[24:25], v8 offset:8192
 v_cvt_pk_bf16_f32 v105, v130, v131
 v_cvt_pk_bf16_f32 v106, v132, v133
 v_cvt_pk_bf16_f32 v107, v134, v135
 v_mfma_f32_16x16x32_bf16 a[208:211], v[32:35], v[64:67], a[208:211]
 ds_read_b64_tr_b16 v[26:27], v8 offset:10240
 buffer_store_dwordx4 v[104:107], v22, s[36:39], s56 offen offset:2048 sc1
 v_accvgpr_read_b32 v136, a148
 v_mfma_f32_16x16x32_bf16 a[212:215], v[32:35], v[68:71], a[212:215]
 ds_read_b64_tr_b16 v[28:29], v9 offset:8192
 v_accvgpr_read_b32 v137, a149
 v_accvgpr_read_b32 v138, a150
 v_mfma_f32_16x16x32_bf16 a[216:219], v[36:39], v[64:67], a[216:219]
 ds_read_b64_tr_b16 v[30:31], v9 offset:10240
 v_accvgpr_read_b32 v139, a151
 v_accvgpr_read_b32 v140, a156
 v_mfma_f32_16x16x32_bf16 a[220:223], v[36:39], v[68:71], a[220:223]
 ds_read_b64_tr_b16 v[32:33], v12 offset:8192
 v_accvgpr_read_b32 v141, a157
 s_waitcnt lgkmcnt(5)
 v_mfma_f32_16x16x32_bf16 a[192:195], v[40:43], v[72:75], a[192:195]
 ds_read_b64_tr_b16 v[34:35], v12 offset:10240
 v_accvgpr_read_b32 v142, a158
 v_accvgpr_read_b32 v143, a159
 v_cvt_pk_bf16_f32 v108, v136, v137
 v_mfma_f32_16x16x32_bf16 a[196:199], v[40:43], v[76:79], a[196:199]
 ds_read_b64_tr_b16 v[36:37], v13 offset:8192
 v_cvt_pk_bf16_f32 v109, v138, v139
 v_cvt_pk_bf16_f32 v110, v140, v141
 v_cvt_pk_bf16_f32 v111, v142, v143
 v_mfma_f32_16x16x32_bf16 a[200:203], v[44:47], v[72:75], a[200:203]
 ds_read_b64_tr_b16 v[38:39], v13 offset:10240
 buffer_store_dwordx4 v[108:111], v22, s[36:39], s56 offen offset:3072 sc1
 v_mfma_f32_16x16x32_bf16 a[204:207], v[44:47], v[76:79], a[204:207]
 ds_read_b64_tr_b16 v[40:41], v8 offset:12288
 s_mul_i32 s56, s85, 768
 s_add_u32 s56, s56, s51
 v_mfma_f32_16x16x32_bf16 a[208:211], v[240:243], v[72:75], a[208:211]
 ds_read_b64_tr_b16 v[42:43], v8 offset:14336
 v_accvgpr_read_b32 v112, a160
 v_accvgpr_read_b32 v113, a161
 v_mfma_f32_16x16x32_bf16 a[212:215], v[240:243], v[76:79], a[212:215]
 ds_read_b64_tr_b16 v[44:45], v9 offset:12288
 v_accvgpr_read_b32 v114, a162
 v_accvgpr_read_b32 v115, a163
 v_mfma_f32_16x16x32_bf16 a[216:219], v[244:247], v[72:75], a[216:219]
 ds_read_b64_tr_b16 v[46:47], v9 offset:14336
 v_accvgpr_read_b32 v116, a168
 v_accvgpr_read_b32 v117, a169
 v_mfma_f32_16x16x32_bf16 a[220:223], v[244:247], v[76:79], a[220:223]
 ds_read_b64_tr_b16 v[240:241], v12 offset:12288
 v_accvgpr_read_b32 v118, a170
 s_waitcnt lgkmcnt(5)
 v_mfma_f32_16x16x32_bf16 a[192:195], v[24:27], v[80:83], a[192:195]
 ds_read_b64_tr_b16 v[242:243], v12 offset:14336
 v_accvgpr_read_b32 v119, a171
 v_cvt_pk_bf16_f32 v96, v112, v113
 v_cvt_pk_bf16_f32 v97, v114, v115
 v_mfma_f32_16x16x32_bf16 a[196:199], v[24:27], v[84:87], a[196:199]
 ds_read_b64_tr_b16 v[244:245], v13 offset:12288
 v_cvt_pk_bf16_f32 v98, v116, v117
 v_cvt_pk_bf16_f32 v99, v118, v119
 v_mfma_f32_16x16x32_bf16 a[200:203], v[28:31], v[80:83], a[200:203]
 ds_read_b64_tr_b16 v[246:247], v13 offset:14336
 buffer_store_dwordx4 v[96:99], v22, s[36:39], s56 offen offset:0 sc1
 v_mfma_f32_16x16x32_bf16 a[204:207], v[28:31], v[84:87], a[204:207]
 v_accvgpr_read_b32 v120, a164
 v_accvgpr_read_b32 v121, a165
 v_mfma_f32_16x16x32_bf16 a[208:211], v[32:35], v[80:83], a[208:211]
 v_accvgpr_read_b32 v122, a166
 v_accvgpr_read_b32 v123, a167
 v_mfma_f32_16x16x32_bf16 a[212:215], v[32:35], v[84:87], a[212:215]
 v_accvgpr_read_b32 v124, a172
 v_accvgpr_read_b32 v125, a173
 v_mfma_f32_16x16x32_bf16 a[216:219], v[36:39], v[80:83], a[216:219]
 v_accvgpr_read_b32 v126, a174
 v_accvgpr_read_b32 v127, a175
 v_mfma_f32_16x16x32_bf16 a[220:223], v[36:39], v[84:87], a[220:223]
 s_waitcnt lgkmcnt(0)
 s_barrier
 ds_read_b64_tr_b16 v[24:25], v8 offset:32768
 ds_read_b64_tr_b16 v[28:29], v9 offset:32768
 ds_read_b64_tr_b16 v[26:27], v8 offset:34816
 ds_read_b64_tr_b16 v[32:33], v12 offset:32768
 ds_read_b64_tr_b16 v[30:31], v9 offset:34816
 v_mfma_f32_16x16x32_bf16 a[192:195], v[40:43], v[88:91], a[192:195]
 ds_read_b64_tr_b16 v[34:35], v12 offset:34816
 v_cvt_pk_bf16_f32 v100, v120, v121
 v_cvt_pk_bf16_f32 v101, v122, v123
 v_cvt_pk_bf16_f32 v102, v124, v125
 v_cvt_pk_bf16_f32 v103, v126, v127
 v_mfma_f32_16x16x32_bf16 a[196:199], v[40:43], v[92:95], a[196:199]
 ds_read_b64_tr_b16 v[36:37], v13 offset:32768
 buffer_store_dwordx4 v[100:103], v22, s[36:39], s56 offen offset:1024 sc1
 v_mfma_f32_16x16x32_bf16 a[200:203], v[44:47], v[88:91], a[200:203]
 ds_read_b64_tr_b16 v[38:39], v13 offset:34816
 v_accvgpr_read_b32 v128, a176
 v_accvgpr_read_b32 v129, a177
 v_accvgpr_read_b32 v130, a178
 v_mfma_f32_16x16x32_bf16 a[204:207], v[44:47], v[92:95], a[204:207]
 ds_read_b64_tr_b16 v[40:41], v8 offset:36864
 v_accvgpr_read_b32 v131, a179
 v_accvgpr_read_b32 v132, a184
 v_mfma_f32_16x16x32_bf16 a[208:211], v[240:243], v[88:91], a[208:211]
 ds_read_b64_tr_b16 v[42:43], v8 offset:38912
 v_accvgpr_read_b32 v133, a185
 v_accvgpr_read_b32 v134, a186
 v_mfma_f32_16x16x32_bf16 a[212:215], v[240:243], v[92:95], a[212:215]
 ds_read_b64_tr_b16 v[44:45], v9 offset:36864
 v_accvgpr_read_b32 v135, a187
 v_cvt_pk_bf16_f32 v104, v128, v129
 v_mfma_f32_16x16x32_bf16 a[216:219], v[244:247], v[88:91], a[216:219]
 ds_read_b64_tr_b16 v[46:47], v9 offset:38912
 v_cvt_pk_bf16_f32 v105, v130, v131
 v_cvt_pk_bf16_f32 v106, v132, v133
 v_mfma_f32_16x16x32_bf16 a[220:223], v[244:247], v[92:95], a[220:223]
 ds_read_b64_tr_b16 v[240:241], v12 offset:36864
 v_cvt_pk_bf16_f32 v107, v134, v135
 s_waitcnt lgkmcnt(5)
 v_mfma_f32_16x16x32_bf16 a[224:227], v[24:27], v[64:67], a[224:227]
 ds_read_b64_tr_b16 v[242:243], v12 offset:38912
 buffer_store_dwordx4 v[104:107], v22, s[36:39], s56 offen offset:2048 sc1
 v_accvgpr_read_b32 v136, a180
 v_mfma_f32_16x16x32_bf16 a[228:231], v[24:27], v[68:71], a[228:231]
 ds_read_b64_tr_b16 v[244:245], v13 offset:36864
 v_accvgpr_read_b32 v137, a181
 v_accvgpr_read_b32 v138, a182
 v_mfma_f32_16x16x32_bf16 a[232:235], v[28:31], v[64:67], a[232:235]
 ds_read_b64_tr_b16 v[246:247], v13 offset:38912
 v_accvgpr_read_b32 v139, a183
 v_accvgpr_read_b32 v140, a188
 v_mfma_f32_16x16x32_bf16 a[236:239], v[28:31], v[68:71], a[236:239]
 ds_read_b64_tr_b16 v[24:25], v8 offset:40960
 v_accvgpr_read_b32 v141, a189
 v_accvgpr_read_b32 v142, a190
 v_mfma_f32_16x16x32_bf16 a[240:243], v[32:35], v[64:67], a[240:243]
 ds_read_b64_tr_b16 v[26:27], v8 offset:43008
 v_accvgpr_read_b32 v143, a191
 v_cvt_pk_bf16_f32 v108, v136, v137
 v_mfma_f32_16x16x32_bf16 a[244:247], v[32:35], v[68:71], a[244:247]
 ds_read_b64_tr_b16 v[28:29], v9 offset:40960
 v_cvt_pk_bf16_f32 v109, v138, v139
 v_cvt_pk_bf16_f32 v110, v140, v141
 v_cvt_pk_bf16_f32 v111, v142, v143
 v_mfma_f32_16x16x32_bf16 a[248:251], v[36:39], v[64:67], a[248:251]
 ds_read_b64_tr_b16 v[30:31], v9 offset:43008
 buffer_store_dwordx4 v[108:111], v22, s[36:39], s56 offen offset:3072 sc1
 v_mfma_f32_16x16x32_bf16 a[252:255], v[36:39], v[68:71], a[252:255]
 ds_read_b64_tr_b16 v[32:33], v12 offset:40960
 s_mul_i32 s56, s86, 768
 s_waitcnt lgkmcnt(5)
 v_mfma_f32_16x16x32_bf16 a[224:227], v[40:43], v[72:75], a[224:227]
 ds_read_b64_tr_b16 v[34:35], v12 offset:43008
 s_add_u32 s56, s56, s51
 v_accvgpr_read_b32 v112, a192
 v_accvgpr_read_b32 v113, a193
 v_mfma_f32_16x16x32_bf16 a[228:231], v[40:43], v[76:79], a[228:231]
 ds_read_b64_tr_b16 v[36:37], v13 offset:40960
 v_accvgpr_read_b32 v114, a194
 v_accvgpr_read_b32 v115, a195
 v_mfma_f32_16x16x32_bf16 a[232:235], v[44:47], v[72:75], a[232:235]
 ds_read_b64_tr_b16 v[38:39], v13 offset:43008
 v_accvgpr_read_b32 v116, a200
 v_accvgpr_read_b32 v117, a201
 v_mfma_f32_16x16x32_bf16 a[236:239], v[44:47], v[76:79], a[236:239]
 ds_read_b64_tr_b16 v[40:41], v8 offset:45056
 v_accvgpr_read_b32 v118, a202
 v_accvgpr_read_b32 v119, a203
 v_mfma_f32_16x16x32_bf16 a[240:243], v[240:243], v[72:75], a[240:243]
 ds_read_b64_tr_b16 v[42:43], v8 offset:47104
 v_cvt_pk_bf16_f32 v96, v112, v113
 v_cvt_pk_bf16_f32 v97, v114, v115
 v_mfma_f32_16x16x32_bf16 a[244:247], v[240:243], v[76:79], a[244:247]
 ds_read_b64_tr_b16 v[44:45], v9 offset:45056
 v_cvt_pk_bf16_f32 v98, v116, v117
 v_cvt_pk_bf16_f32 v99, v118, v119
 v_mfma_f32_16x16x32_bf16 a[248:251], v[244:247], v[72:75], a[248:251]
 ds_read_b64_tr_b16 v[46:47], v9 offset:47104
 buffer_store_dwordx4 v[96:99], v22, s[36:39], s56 offen offset:0 sc1
 v_mfma_f32_16x16x32_bf16 a[252:255], v[244:247], v[76:79], a[252:255]
 ds_read_b64_tr_b16 v[240:241], v12 offset:45056
 v_accvgpr_read_b32 v120, a196
 s_waitcnt lgkmcnt(5)
 v_mfma_f32_16x16x32_bf16 a[224:227], v[24:27], v[80:83], a[224:227]
 ds_read_b64_tr_b16 v[242:243], v12 offset:47104
 v_accvgpr_read_b32 v121, a197
 v_accvgpr_read_b32 v122, a198
 v_accvgpr_read_b32 v123, a199
 v_mfma_f32_16x16x32_bf16 a[228:231], v[24:27], v[84:87], a[228:231]
 ds_read_b64_tr_b16 v[244:245], v13 offset:45056
 v_accvgpr_read_b32 v124, a204
 v_accvgpr_read_b32 v125, a205
 v_mfma_f32_16x16x32_bf16 a[232:235], v[28:31], v[80:83], a[232:235]
 ds_read_b64_tr_b16 v[246:247], v13 offset:47104
 v_accvgpr_read_b32 v126, a206
 v_accvgpr_read_b32 v127, a207
 v_mfma_f32_16x16x32_bf16 a[236:239], v[28:31], v[84:87], a[236:239]
 v_cvt_pk_bf16_f32 v100, v120, v121
 v_cvt_pk_bf16_f32 v101, v122, v123
 v_mfma_f32_16x16x32_bf16 a[240:243], v[32:35], v[80:83], a[240:243]
 v_cvt_pk_bf16_f32 v102, v124, v125
 v_cvt_pk_bf16_f32 v103, v126, v127
 v_mfma_f32_16x16x32_bf16 a[244:247], v[32:35], v[84:87], a[244:247]
 buffer_store_dwordx4 v[100:103], v22, s[36:39], s56 offen offset:1024 sc1
 v_mfma_f32_16x16x32_bf16 a[248:251], v[36:39], v[80:83], a[248:251]
 v_accvgpr_read_b32 v128, a208
 v_accvgpr_read_b32 v129, a209
 v_accvgpr_read_b32 v130, a210
 v_mfma_f32_16x16x32_bf16 a[252:255], v[36:39], v[84:87], a[252:255]
 s_waitcnt lgkmcnt(0)
 s_barrier
 v_add_u32 v8, 65536, v8
 ds_read_b64_tr_b16 v[24:25], v8 offset:0
 v_add_u32 v9, 65536, v9
 ds_read_b64_tr_b16 v[28:29], v9 offset:0
 ds_read_b64_tr_b16 v[26:27], v8 offset:2048
 v_add_u32 v12, 65536, v12
 ds_read_b64_tr_b16 v[32:33], v12 offset:0
 ds_read_b64_tr_b16 v[30:31], v9 offset:2048
 v_mfma_f32_16x16x32_bf16 a[224:227], v[40:43], v[88:91], a[224:227]
 ds_read_b64_tr_b16 v[34:35], v12 offset:2048
 v_accvgpr_read_b32 v131, a211
 v_accvgpr_read_b32 v132, a216
 v_accvgpr_read_b32 v133, a217
 v_accvgpr_read_b32 v134, a218
 v_mfma_f32_16x16x32_bf16 a[228:231], v[40:43], v[92:95], a[228:231]
 v_add_u32 v13, 65536, v13
 ds_read_b64_tr_b16 v[36:37], v13 offset:0
 v_accvgpr_read_b32 v135, a219
 v_cvt_pk_bf16_f32 v104, v128, v129
 v_mfma_f32_16x16x32_bf16 a[232:235], v[44:47], v[88:91], a[232:235]
 ds_read_b64_tr_b16 v[38:39], v13 offset:2048
 v_cvt_pk_bf16_f32 v105, v130, v131
 v_cvt_pk_bf16_f32 v106, v132, v133
 v_mfma_f32_16x16x32_bf16 a[236:239], v[44:47], v[92:95], a[236:239]
 ds_read_b64_tr_b16 v[40:41], v8 offset:4096
 v_cvt_pk_bf16_f32 v107, v134, v135
 v_mfma_f32_16x16x32_bf16 a[240:243], v[240:243], v[88:91], a[240:243]
 ds_read_b64_tr_b16 v[42:43], v8 offset:6144
 buffer_store_dwordx4 v[104:107], v22, s[36:39], s56 offen offset:2048 sc1
 v_accvgpr_read_b32 v136, a212
 v_mfma_f32_16x16x32_bf16 a[244:247], v[240:243], v[92:95], a[244:247]
 ds_read_b64_tr_b16 v[44:45], v9 offset:4096
 v_accvgpr_read_b32 v137, a213
 v_accvgpr_read_b32 v138, a214
 v_mfma_f32_16x16x32_bf16 a[248:251], v[244:247], v[88:91], a[248:251]
 ds_read_b64_tr_b16 v[46:47], v9 offset:6144
 v_accvgpr_read_b32 v139, a215
 v_accvgpr_read_b32 v140, a220
 v_mfma_f32_16x16x32_bf16 a[252:255], v[244:247], v[92:95], a[252:255]
 ds_read_b64_tr_b16 v[240:241], v12 offset:4096
 v_accvgpr_read_b32 v141, a221
 s_waitcnt lgkmcnt(5)
 v_mfma_f32_16x16x32_bf16 v[208:211], v[24:27], v[64:67], v[208:211]
 ds_read_b64_tr_b16 v[242:243], v12 offset:6144
 v_accvgpr_read_b32 v142, a222
 v_accvgpr_read_b32 v143, a223
 v_cvt_pk_bf16_f32 v108, v136, v137
 v_mfma_f32_16x16x32_bf16 v[212:215], v[24:27], v[68:71], v[212:215]
 ds_read_b64_tr_b16 v[244:245], v13 offset:4096
 v_cvt_pk_bf16_f32 v109, v138, v139
 v_cvt_pk_bf16_f32 v110, v140, v141
 v_cvt_pk_bf16_f32 v111, v142, v143
 v_mfma_f32_16x16x32_bf16 v[216:219], v[28:31], v[64:67], v[216:219]
 ds_read_b64_tr_b16 v[246:247], v13 offset:6144
 buffer_store_dwordx4 v[108:111], v22, s[36:39], s56 offen offset:3072 sc1
 v_mfma_f32_16x16x32_bf16 v[220:223], v[28:31], v[68:71], v[220:223]
 ds_read_b64_tr_b16 v[24:25], v8 offset:8192
 s_mul_i32 s56, s87, 768
 s_add_u32 s56, s56, s51
 v_mfma_f32_16x16x32_bf16 v[224:227], v[32:35], v[64:67], v[224:227]
 ds_read_b64_tr_b16 v[26:27], v8 offset:10240
 v_accvgpr_read_b32 v112, a224
 v_accvgpr_read_b32 v113, a225
 v_mfma_f32_16x16x32_bf16 v[228:231], v[32:35], v[68:71], v[228:231]
 ds_read_b64_tr_b16 v[28:29], v9 offset:8192
 v_accvgpr_read_b32 v114, a226
 v_accvgpr_read_b32 v115, a227
 v_mfma_f32_16x16x32_bf16 v[232:235], v[36:39], v[64:67], v[232:235]
 ds_read_b64_tr_b16 v[30:31], v9 offset:10240
 v_accvgpr_read_b32 v116, a232
 v_accvgpr_read_b32 v117, a233
 v_mfma_f32_16x16x32_bf16 v[236:239], v[36:39], v[68:71], v[236:239]
 ds_read_b64_tr_b16 v[32:33], v12 offset:8192
 v_accvgpr_read_b32 v118, a234
 s_waitcnt lgkmcnt(5)
 v_mfma_f32_16x16x32_bf16 v[208:211], v[40:43], v[72:75], v[208:211]
 ds_read_b64_tr_b16 v[34:35], v12 offset:10240
 v_accvgpr_read_b32 v119, a235
 v_cvt_pk_bf16_f32 v96, v112, v113
 v_cvt_pk_bf16_f32 v97, v114, v115
 v_mfma_f32_16x16x32_bf16 v[212:215], v[40:43], v[76:79], v[212:215]
 ds_read_b64_tr_b16 v[36:37], v13 offset:8192
 v_cvt_pk_bf16_f32 v98, v116, v117
 v_cvt_pk_bf16_f32 v99, v118, v119
 v_mfma_f32_16x16x32_bf16 v[216:219], v[44:47], v[72:75], v[216:219]
 ds_read_b64_tr_b16 v[38:39], v13 offset:10240
 buffer_store_dwordx4 v[96:99], v22, s[36:39], s56 offen offset:0 sc1
 v_mfma_f32_16x16x32_bf16 v[220:223], v[44:47], v[76:79], v[220:223]
 ds_read_b64_tr_b16 v[40:41], v8 offset:12288
 v_accvgpr_read_b32 v120, a228
 v_accvgpr_read_b32 v121, a229
 v_mfma_f32_16x16x32_bf16 v[224:227], v[240:243], v[72:75], v[224:227]
 ds_read_b64_tr_b16 v[42:43], v8 offset:14336
 v_accvgpr_read_b32 v122, a230
 v_accvgpr_read_b32 v123, a231
 v_mfma_f32_16x16x32_bf16 v[228:231], v[240:243], v[76:79], v[228:231]
 ds_read_b64_tr_b16 v[44:45], v9 offset:12288
 v_accvgpr_read_b32 v124, a236
 v_accvgpr_read_b32 v125, a237
 v_mfma_f32_16x16x32_bf16 v[232:235], v[244:247], v[72:75], v[232:235]
 ds_read_b64_tr_b16 v[46:47], v9 offset:14336
 v_accvgpr_read_b32 v126, a238
 v_accvgpr_read_b32 v127, a239
 v_mfma_f32_16x16x32_bf16 v[236:239], v[244:247], v[76:79], v[236:239]
 ds_read_b64_tr_b16 v[240:241], v12 offset:12288
 v_cvt_pk_bf16_f32 v100, v120, v121
 s_waitcnt lgkmcnt(5)
 v_mfma_f32_16x16x32_bf16 v[208:211], v[24:27], v[80:83], v[208:211]
 ds_read_b64_tr_b16 v[242:243], v12 offset:14336
 v_cvt_pk_bf16_f32 v101, v122, v123
 v_cvt_pk_bf16_f32 v102, v124, v125
 v_cvt_pk_bf16_f32 v103, v126, v127
 v_mfma_f32_16x16x32_bf16 v[212:215], v[24:27], v[84:87], v[212:215]
 ds_read_b64_tr_b16 v[244:245], v13 offset:12288
 buffer_store_dwordx4 v[100:103], v22, s[36:39], s56 offen offset:1024 sc1
 v_mfma_f32_16x16x32_bf16 v[216:219], v[28:31], v[80:83], v[216:219]
 ds_read_b64_tr_b16 v[246:247], v13 offset:14336
 v_accvgpr_read_b32 v128, a240
 v_accvgpr_read_b32 v129, a241
 v_accvgpr_read_b32 v130, a242
 v_mfma_f32_16x16x32_bf16 v[220:223], v[28:31], v[84:87], v[220:223]
 v_accvgpr_read_b32 v131, a243
 v_accvgpr_read_b32 v132, a248
 v_mfma_f32_16x16x32_bf16 v[224:227], v[32:35], v[80:83], v[224:227]
 v_accvgpr_read_b32 v133, a249
 v_accvgpr_read_b32 v134, a250
 v_mfma_f32_16x16x32_bf16 v[228:231], v[32:35], v[84:87], v[228:231]
 v_accvgpr_read_b32 v135, a251
 v_cvt_pk_bf16_f32 v104, v128, v129
 v_mfma_f32_16x16x32_bf16 v[232:235], v[36:39], v[80:83], v[232:235]
 v_cvt_pk_bf16_f32 v105, v130, v131
 v_cvt_pk_bf16_f32 v106, v132, v133
 v_mfma_f32_16x16x32_bf16 v[236:239], v[36:39], v[84:87], v[236:239]
 v_cvt_pk_bf16_f32 v107, v134, v135
 s_waitcnt lgkmcnt(0)
 v_mfma_f32_16x16x32_bf16 v[208:211], v[40:43], v[88:91], v[208:211]
 buffer_store_dwordx4 v[104:107], v22, s[36:39], s56 offen offset:2048 sc1
 v_accvgpr_read_b32 v136, a244
 v_mfma_f32_16x16x32_bf16 v[212:215], v[40:43], v[92:95], v[212:215]
 v_accvgpr_read_b32 v137, a245
 v_accvgpr_read_b32 v138, a246
 v_mfma_f32_16x16x32_bf16 v[216:219], v[44:47], v[88:91], v[216:219]
 v_accvgpr_read_b32 v139, a247
 v_accvgpr_read_b32 v140, a252
 v_mfma_f32_16x16x32_bf16 v[220:223], v[44:47], v[92:95], v[220:223]
 v_accvgpr_read_b32 v141, a253
 v_accvgpr_read_b32 v142, a254
 v_mfma_f32_16x16x32_bf16 v[224:227], v[240:243], v[88:91], v[224:227]
 v_accvgpr_read_b32 v143, a255
 v_cvt_pk_bf16_f32 v108, v136, v137
 v_mfma_f32_16x16x32_bf16 v[228:231], v[240:243], v[92:95], v[228:231]
 v_cvt_pk_bf16_f32 v109, v138, v139
 v_cvt_pk_bf16_f32 v110, v140, v141
 v_cvt_pk_bf16_f32 v111, v142, v143
 v_mfma_f32_16x16x32_bf16 v[232:235], v[244:247], v[88:91], v[232:235]
 buffer_store_dwordx4 v[108:111], v22, s[36:39], s56 offen offset:3072 sc1
 v_mfma_f32_16x16x32_bf16 v[236:239], v[244:247], v[92:95], v[236:239]
 v_and_b32 v10, 7, v0
 v_lshlrev_b32 v1, 2, v10
 v_lshlrev_b32 v6, 4, v0
 buffer_load_dword v2, v1, s[36:39], s89 offen sc1
 s_mul_i32 s56, s53, 884736
 s_mul_i32 s57, s59, 3
 s_add_u32 s57, s57, s3
 s_lshl_b32 s57, s57, 15
 s_add_u32 s56, s56, s57
 s_mul_i32 s60, s4, 96
 s_lshl_b32 s58, s3, 5
 s_add_u32 s60, s60, s58
 s_mul_i32 s60, s60, 2304
 s_lshl_b32 s58, s59, 7
 s_add_u32 s60, s60, s58
 s_and_b32 s58, s2, 4
 s_mul_i32 s58, s58, 288
 s_add_u32 s60, s60, s58
 v_and_b32 v7, 15, v0
 v_mul_u32_u24 v7, 2304, v7
 v_lshrrev_b32 v3, 5, v0
 v_lshl_add_u32 v7, v3, 4, v7
 v_bfe_u32 v3, v0, 4, 1
 v_lshl_add_u32 v7, v3, 5, v7
 v_sub_u32 v10, s59, v10
 v_add_u32 v3, 9, v10
 v_cmp_gt_i32 vcc, 1, v10
 s_nop 1
 v_cndmask_b32 v10, v10, v3, vcc
 s_mov_b32 s62, 254
 s_mov_b32 s58, 0
 s_mov_b32 s64, 7
 v_and_b32 v4, 15, v0
 v_lshrrev_b32 v5, 4, v0
 v_lshlrev_b32 v5, 2, v5
 v_sub_u32 v4, v4, v5
 v_mov_b32 v8, 0x3f80
 v_mov_b32 v9, 0x3f800000
 v_cmp_eq_u32 vcc, 0, v4
 v_cmp_eq_u32 s[66:67], 1, v4
 v_mov_b32 v5, 0
 v_cndmask_b32 v5, v5, v8, vcc
 v_cndmask_b32 v24, v5, v9, s[66:67]
 v_cmp_eq_u32 vcc, 2, v4
 v_cmp_eq_u32 s[66:67], 3, v4
 v_mov_b32 v5, 0
 v_cndmask_b32 v5, v5, v8, vcc
 v_cndmask_b32 v25, v5, v9, s[66:67]
 v_mov_b32 v26, 0
 v_mov_b32 v27, 0
 v_mov_b32 v28, v24
 v_mov_b32 v29, v25
 v_add_u32 v3, 8, v23
 s_lshl_b32 s66, 1, s59
 s_mov_b32 s67, 0
 s_waitcnt vmcnt(0)
 s_mov_b64 exec, s[66:67]
 buffer_store_dword v3, v1, s[36:39], s89 offen sc1
 s_mov_b64 exec, -1
 s_branch M_chkc
M_pollc:
 s_waitcnt vmcnt(0)
M_chkc:
 v_sub_u32 v3, v2, v23
 v_cmp_ge_u32 vcc, v3, v10
 s_nop 3
 s_and_b32 s63, vcc_lo, 0xffff
 s_lshr_b32 s63, s63, s59
 s_and_b32 s63, s63, s62
 s_cbranch_scc1 M_somec
 s_add_u32 s58, s58, 1
 s_cmp_gt_u32 s58, 0x100000
 s_cbranch_scc1 M_outc
 s_sleep 8
 buffer_load_dword v2, v1, s[36:39], s89 offen sc1
 s_branch M_pollc
M_somec:
 s_bitcmp1_b32 s63, 7
 s_cbranch_scc0 M_nlc7
 s_add_u32 s57, s59, 7
 s_and_b32 s57, s57, 7
 s_lshl_b32 s57, s57, 12
 s_add_u32 s57, s57, s56
 buffer_load_dwordx4 v[128:131], v6, s[36:39], s57 offen offset:0 sc1
 buffer_load_dwordx4 v[132:135], v6, s[36:39], s57 offen offset:1024 sc1
 buffer_load_dwordx4 v[136:139], v6, s[36:39], s57 offen offset:2048 sc1
 buffer_load_dwordx4 v[140:143], v6, s[36:39], s57 offen offset:3072 sc1
M_nlc7:
 s_bitcmp1_b32 s63, 6
 s_cbranch_scc0 M_nlc6
 s_add_u32 s57, s59, 6
 s_and_b32 s57, s57, 7
 s_lshl_b32 s57, s57, 12
 s_add_u32 s57, s57, s56
 buffer_load_dwordx4 v[112:115], v6, s[36:39], s57 offen offset:0 sc1
 buffer_load_dwordx4 v[116:119], v6, s[36:39], s57 offen offset:1024 sc1
 buffer_load_dwordx4 v[120:123], v6, s[36:39], s57 offen offset:2048 sc1
 buffer_load_dwordx4 v[124:127], v6, s[36:39], s57 offen offset:3072 sc1
M_nlc6:
 s_bitcmp1_b32 s63, 5
 s_cbranch_scc0 M_nlc5
 s_add_u32 s57, s59, 5
 s_and_b32 s57, s57, 7
 s_lshl_b32 s57, s57, 12
 s_add_u32 s57, s57, s56
 buffer_load_dwordx4 v[96:99], v6, s[36:39], s57 offen offset:0 sc1
 buffer_load_dwordx4 v[100:103], v6, s[36:39], s57 offen offset:1024 sc1
 buffer_load_dwordx4 v[104:107], v6, s[36:39], s57 offen offset:2048 sc1
 buffer_load_dwordx4 v[108:111], v6, s[36:39], s57 offen offset:3072 sc1
M_nlc5:
 s_bitcmp1_b32 s63, 4
 s_cbranch_scc0 M_nlc4
 s_add_u32 s57, s59, 4
 s_and_b32 s57, s57, 7
 s_lshl_b32 s57, s57, 12
 s_add_u32 s57, s57, s56
 buffer_load_dwordx4 v[80:83], v6, s[36:39], s57 offen offset:0 sc1
 buffer_load_dwordx4 v[84:87], v6, s[36:39], s57 offen offset:1024 sc1
 buffer_load_dwordx4 v[88:91], v6, s[36:39], s57 offen offset:2048 sc1
 buffer_load_dwordx4 v[92:95], v6, s[36:39], s57 offen offset:3072 sc1
M_nlc4:
 s_bitcmp1_b32 s63, 3
 s_cbranch_scc0 M_nlc3
 s_add_u32 s57, s59, 3
 s_and_b32 s57, s57, 7
 s_lshl_b32 s57, s57, 12
 s_add_u32 s57, s57, s56
 buffer_load_dwordx4 v[64:67], v6, s[36:39], s57 offen offset:0 sc1
 buffer_load_dwordx4 v[68:71], v6, s[36:39], s57 offen offset:1024 sc1
 buffer_load_dwordx4 v[72:75], v6, s[36:39], s57 offen offset:2048 sc1
 buffer_load_dwordx4 v[76:79], v6, s[36:39], s57 offen offset:3072 sc1
M_nlc3:
 s_bitcmp1_b32 s63, 2
 s_cbranch_scc0 M_nlc2
 s_add_u32 s57, s59, 2
 s_and_b32 s57, s57, 7
 s_lshl_b32 s57, s57, 12
 s_add_u32 s57, s57, s56
 buffer_load_dwordx4 v[48:51], v6, s[36:39], s57 offen offset:0 sc1
 buffer_load_dwordx4 v[52:55], v6, s[36:39], s57 offen offset:1024 sc1
 buffer_load_dwordx4 v[56:59], v6, s[36:39], s57 offen offset:2048 sc1
 buffer_load_dwordx4 v[60:63], v6, s[36:39], s57 offen offset:3072 sc1
M_nlc2:
 s_bitcmp1_b32 s63, 1
 s_cbranch_scc0 M_nlc1
 s_add_u32 s57, s59, 1
 s_and_b32 s57, s57, 7
 s_lshl_b32 s57, s57, 12
 s_add_u32 s57, s57, s56
 buffer_load_dwordx4 v[32:35], v6, s[36:39], s57 offen offset:0 sc1
 buffer_load_dwordx4 v[36:39], v6, s[36:39], s57 offen offset:1024 sc1
 buffer_load_dwordx4 v[40:43], v6, s[36:39], s57 offen offset:2048 sc1
 buffer_load_dwordx4 v[44:47], v6, s[36:39], s57 offen offset:3072 sc1
M_nlc1:
 buffer_load_dword v2, v1, s[36:39], s89 offen sc1
 s_andn2_b32 s62, s62, s63
 s_waitcnt vmcnt(1)
 s_cmp_lg_u32 s64, 7
 s_cbranch_scc1 M_nac7
 s_bitcmp1_b32 s62, 7
 s_cbranch_scc1 M_pollc
 v_mfma_f32_16x16x32_bf16 v[208:211], v[24:27], v[128:131], v[208:211]
 v_mfma_f32_16x16x32_bf16 v[212:215], v[24:27], v[132:135], v[212:215]
 v_mfma_f32_16x16x32_bf16 v[224:227], v[24:27], v[136:139], v[224:227]
 v_mfma_f32_16x16x32_bf16 v[228:231], v[24:27], v[140:143], v[228:231]
 v_mfma_f32_16x16x32_bf16 v[216:219], v[26:29], v[128:131], v[216:219]
 v_mfma_f32_16x16x32_bf16 v[220:223], v[26:29], v[132:135], v[220:223]
 v_mfma_f32_16x16x32_bf16 v[232:235], v[26:29], v[136:139], v[232:235]
 v_mfma_f32_16x16x32_bf16 v[236:239], v[26:29], v[140:143], v[236:239]
 s_mov_b32 s64, 6
M_nac7:
 s_cmp_lg_u32 s64, 6
 s_cbranch_scc1 M_nac6
 s_bitcmp1_b32 s62, 6
 s_cbranch_scc1 M_pollc
 v_mfma_f32_16x16x32_bf16 v[208:211], v[24:27], v[112:115], v[208:211]
 v_mfma_f32_16x16x32_bf16 v[212:215], v[24:27], v[116:119], v[212:215]
 v_mfma_f32_16x16x32_bf16 v[224:227], v[24:27], v[120:123], v[224:227]
 v_mfma_f32_16x16x32_bf16 v[228:231], v[24:27], v[124:127], v[228:231]
 v_mfma_f32_16x16x32_bf16 v[216:219], v[26:29], v[112:115], v[216:219]
 v_mfma_f32_16x16x32_bf16 v[220:223], v[26:29], v[116:119], v[220:223]
 v_mfma_f32_16x16x32_bf16 v[232:235], v[26:29], v[120:123], v[232:235]
 v_mfma_f32_16x16x32_bf16 v[236:239], v[26:29], v[124:127], v[236:239]
 s_mov_b32 s64, 5
M_nac6:
 s_cmp_lg_u32 s64, 5
 s_cbranch_scc1 M_nac5
 s_bitcmp1_b32 s62, 5
 s_cbranch_scc1 M_pollc
 v_mfma_f32_16x16x32_bf16 v[208:211], v[24:27], v[96:99], v[208:211]
 v_mfma_f32_16x16x32_bf16 v[212:215], v[24:27], v[100:103], v[212:215]
 v_mfma_f32_16x16x32_bf16 v[224:227], v[24:27], v[104:107], v[224:227]
 v_mfma_f32_16x16x32_bf16 v[228:231], v[24:27], v[108:111], v[228:231]
 v_mfma_f32_16x16x32_bf16 v[216:219], v[26:29], v[96:99], v[216:219]
 v_mfma_f32_16x16x32_bf16 v[220:223], v[26:29], v[100:103], v[220:223]
 v_mfma_f32_16x16x32_bf16 v[232:235], v[26:29], v[104:107], v[232:235]
 v_mfma_f32_16x16x32_bf16 v[236:239], v[26:29], v[108:111], v[236:239]
 s_mov_b32 s64, 4
M_nac5:
 s_cmp_lg_u32 s64, 4
 s_cbranch_scc1 M_nac4
 s_bitcmp1_b32 s62, 4
 s_cbranch_scc1 M_pollc
 v_mfma_f32_16x16x32_bf16 v[208:211], v[24:27], v[80:83], v[208:211]
 v_mfma_f32_16x16x32_bf16 v[212:215], v[24:27], v[84:87], v[212:215]
 v_mfma_f32_16x16x32_bf16 v[224:227], v[24:27], v[88:91], v[224:227]
 v_mfma_f32_16x16x32_bf16 v[228:231], v[24:27], v[92:95], v[228:231]
 v_mfma_f32_16x16x32_bf16 v[216:219], v[26:29], v[80:83], v[216:219]
 v_mfma_f32_16x16x32_bf16 v[220:223], v[26:29], v[84:87], v[220:223]
 v_mfma_f32_16x16x32_bf16 v[232:235], v[26:29], v[88:91], v[232:235]
 v_mfma_f32_16x16x32_bf16 v[236:239], v[26:29], v[92:95], v[236:239]
 s_mov_b32 s64, 3
M_nac4:
 s_cmp_lg_u32 s64, 3
 s_cbranch_scc1 M_nac3
 s_bitcmp1_b32 s62, 3
 s_cbranch_scc1 M_pollc
 v_mfma_f32_16x16x32_bf16 v[208:211], v[24:27], v[64:67], v[208:211]
 v_mfma_f32_16x16x32_bf16 v[212:215], v[24:27], v[68:71], v[212:215]
 v_mfma_f32_16x16x32_bf16 v[224:227], v[24:27], v[72:75], v[224:227]
 v_mfma_f32_16x16x32_bf16 v[228:231], v[24:27], v[76:79], v[228:231]
 v_mfma_f32_16x16x32_bf16 v[216:219], v[26:29], v[64:67], v[216:219]
 v_mfma_f32_16x16x32_bf16 v[220:223], v[26:29], v[68:71], v[220:223]
 v_mfma_f32_16x16x32_bf16 v[232:235], v[26:29], v[72:75], v[232:235]
 v_mfma_f32_16x16x32_bf16 v[236:239], v[26:29], v[76:79], v[236:239]
 s_mov_b32 s64, 2
M_nac3:
 s_cmp_lg_u32 s64, 2
 s_cbranch_scc1 M_nac2
 s_bitcmp1_b32 s62, 2
 s_cbranch_scc1 M_pollc
 v_mfma_f32_16x16x32_bf16 v[208:211], v[24:27], v[48:51], v[208:211]
 v_mfma_f32_16x16x32_bf16 v[212:215], v[24:27], v[52:55], v[212:215]
 v_mfma_f32_16x16x32_bf16 v[224:227], v[24:27], v[56:59], v[224:227]
 v_mfma_f32_16x16x32_bf16 v[228:231], v[24:27], v[60:63], v[228:231]
 v_mfma_f32_16x16x32_bf16 v[216:219], v[26:29], v[48:51], v[216:219]
 v_mfma_f32_16x16x32_bf16 v[220:223], v[26:29], v[52:55], v[220:223]
 v_mfma_f32_16x16x32_bf16 v[232:235], v[26:29], v[56:59], v[232:235]
 v_mfma_f32_16x16x32_bf16 v[236:239], v[26:29], v[60:63], v[236:239]
 s_mov_b32 s64, 1
M_nac2:
 s_cmp_lg_u32 s64, 1
 s_cbranch_scc1 M_nac1
 s_bitcmp1_b32 s62, 1
 s_cbranch_scc1 M_pollc
 v_mfma_f32_16x16x32_bf16 v[208:211], v[24:27], v[32:35], v[208:211]
 v_mfma_f32_16x16x32_bf16 v[212:215], v[24:27], v[36:39], v[212:215]
 v_mfma_f32_16x16x32_bf16 v[224:227], v[24:27], v[40:43], v[224:227]
 v_mfma_f32_16x16x32_bf16 v[228:231], v[24:27], v[44:47], v[228:231]
 v_mfma_f32_16x16x32_bf16 v[216:219], v[26:29], v[32:35], v[216:219]
 v_mfma_f32_16x16x32_bf16 v[220:223], v[26:29], v[36:39], v[220:223]
 v_mfma_f32_16x16x32_bf16 v[232:235], v[26:29], v[40:43], v[232:235]
 v_mfma_f32_16x16x32_bf16 v[236:239], v[26:29], v[44:47], v[236:239]
 s_mov_b32 s64, 0
M_nac1:
M_outc:
 s_nop 15
 v_cvt_pk_bf16_f32 v8, v208, v209
 v_cvt_pk_bf16_f32 v9, v210, v211
 v_cvt_pk_bf16_f32 v10, v216, v217
 v_cvt_pk_bf16_f32 v11, v218, v219
 v_cvt_pk_bf16_f32 v12, v212, v213
 v_cvt_pk_bf16_f32 v13, v214, v215
 v_cvt_pk_bf16_f32 v14, v220, v221
 v_cvt_pk_bf16_f32 v15, v222, v223
 v_cvt_pk_bf16_f32 v16, v224, v225
 v_cvt_pk_bf16_f32 v17, v226, v227
 v_cvt_pk_bf16_f32 v18, v232, v233
 v_cvt_pk_bf16_f32 v19, v234, v235
 v_cvt_pk_bf16_f32 v20, v228, v229
 v_cvt_pk_bf16_f32 v21, v230, v231
 v_cvt_pk_bf16_f32 v22, v236, v237
 v_cvt_pk_bf16_f32 v23, v238, v239
 s_add_u32 s57, s60, 36864
 v_permlane16_swap_b32 v8, v10
 v_permlane16_swap_b32 v9, v11
 buffer_store_dwordx4 v[8:11], v7, s[72:75], s60 offen offset:0
 v_permlane16_swap_b32 v12, v14
 v_permlane16_swap_b32 v13, v15
 buffer_store_dwordx4 v[12:15], v7, s[72:75], s57 offen offset:0
 v_permlane16_swap_b32 v16, v18
 v_permlane16_swap_b32 v17, v19
 buffer_store_dwordx4 v[16:19], v7, s[72:75], s60 offen offset:64
 v_permlane16_swap_b32 v20, v22
 v_permlane16_swap_b32 v21, v23
 buffer_store_dwordx4 v[20:23], v7, s[72:75], s57 offen offset:64
 s_endpgm
M_warm_more:
 s_setpc_b64 s[40:41]
M_more:
 ds_read_b64_tr_b16 v[240:241], v12 offset:40960
 v_mul_f32 v192, v20, v192
 s_waitcnt lgkmcnt(5)
 v_mfma_f32_16x16x32_bf16 a[0:3], v[24:27], v[80:83], a[0:3]
 ds_read_b64_tr_b16 v[242:243], v12 offset:43008
 v_mul_f32 v193, v20, v193
 v_mul_f32 v194, v20, v194
 v_mfma_f32_16x16x32_bf16 a[4:7], v[24:27], v[84:87], a[4:7]
 ds_read_b64_tr_b16 v[244:245], v13 offset:40960
 v_mul_f32 v195, v20, v195
 v_mfma_f32_16x16x32_bf16 a[8:11], v[28:31], v[80:83], a[8:11]
 ds_read_b64_tr_b16 v[246:247], v13 offset:43008
 v_cvt_pk_bf16_f32 v88, v192, v193
 v_cvt_pk_bf16_f32 v89, v194, v195
 v_mfma_f32_16x16x32_bf16 a[12:15], v[28:31], v[84:87], a[12:15]
 ds_read_b64_tr_b16 v[24:25], v8 offset:28672
 v_mul_f32 v200, v20, v200
 v_mfma_f32_16x16x32_bf16 a[16:19], v[32:35], v[80:83], a[16:19]
 ds_read_b64_tr_b16 v[26:27], v8 offset:30720
 v_mul_f32 v201, v20, v201
 v_mul_f32 v202, v20, v202
 v_mfma_f32_16x16x32_bf16 a[20:23], v[32:35], v[84:87], a[20:23]
 ds_read_b64_tr_b16 v[28:29], v9 offset:28672
 v_mul_f32 v203, v20, v203
 v_mfma_f32_16x16x32_bf16 a[24:27], v[36:39], v[80:83], a[24:27]
 ds_read_b64_tr_b16 v[30:31], v9 offset:30720
 v_cvt_pk_bf16_f32 v90, v200, v201
 v_cvt_pk_bf16_f32 v91, v202, v203
 v_mfma_f32_16x16x32_bf16 a[28:31], v[36:39], v[84:87], a[28:31]
 ds_read_b64_tr_b16 v[32:33], v12 offset:28672
 v_mul_f32 v196, v11, v196
 s_waitcnt lgkmcnt(5)
 v_mfma_f32_16x16x32_bf16 a[32:35], v[40:43], v[80:83], a[32:35]
 ds_read_b64_tr_b16 v[34:35], v12 offset:30720
 v_mul_f32 v197, v11, v197
 v_mul_f32 v198, v11, v198
 v_mfma_f32_16x16x32_bf16 a[36:39], v[40:43], v[84:87], a[36:39]
 ds_read_b64_tr_b16 v[36:37], v13 offset:28672
 v_mul_f32 v199, v11, v199
 v_mfma_f32_16x16x32_bf16 a[40:43], v[44:47], v[80:83], a[40:43]
 ds_read_b64_tr_b16 v[38:39], v13 offset:30720
 v_cvt_pk_bf16_f32 v92, v196, v197
 v_cvt_pk_bf16_f32 v93, v198, v199
 v_mfma_f32_16x16x32_bf16 a[44:47], v[44:47], v[84:87], a[44:47]
 ds_read_b64_tr_b16 v[40:41], v8 offset:45056
 v_mul_f32 v204, v11, v204
 v_mfma_f32_16x16x32_bf16 a[48:51], v[240:243], v[80:83], a[48:51]
 ds_read_b64_tr_b16 v[42:43], v8 offset:47104
 v_mul_f32 v205, v11, v205
 v_mul_f32 v206, v11, v206
 v_mfma_f32_16x16x32_bf16 a[52:55], v[240:243], v[84:87], a[52:55]
 ds_read_b64_tr_b16 v[44:45], v9 offset:45056
 v_mul_f32 v207, v11, v207
 v_mfma_f32_16x16x32_bf16 a[56:59], v[244:247], v[80:83], a[56:59]
 ds_read_b64_tr_b16 v[46:47], v9 offset:47104
 v_cvt_pk_bf16_f32 v94, v204, v205
 v_cvt_pk_bf16_f32 v95, v206, v207
 v_mfma_f32_16x16x32_bf16 a[60:63], v[244:247], v[84:87], a[60:63]
 ds_read_b64_tr_b16 v[240:241], v12 offset:45056
 s_waitcnt lgkmcnt(5)
 v_mfma_f32_16x16x32_bf16 a[0:3], v[24:27], v[88:91], a[0:3]
 ds_read_b64_tr_b16 v[242:243], v12 offset:47104
 v_mfma_f32_16x16x32_bf16 a[4:7], v[24:27], v[92:95], a[4:7]
 ds_read_b64_tr_b16 v[244:245], v13 offset:45056
 v_mfma_f32_16x16x32_bf16 a[8:11], v[28:31], v[88:91], a[8:11]
 ds_read_b64_tr_b16 v[246:247], v13 offset:47104
 v_mfma_f32_16x16x32_bf16 a[12:15], v[28:31], v[92:95], a[12:15]
 v_mfma_f32_16x16x32_bf16 a[16:19], v[32:35], v[88:91], a[16:19]
 v_mfma_f32_16x16x32_bf16 a[20:23], v[32:35], v[92:95], a[20:23]
 v_mfma_f32_16x16x32_bf16 a[24:27], v[36:39], v[88:91], a[24:27]
 v_mfma_f32_16x16x32_bf16 a[28:31], v[36:39], v[92:95], a[28:31]
 s_waitcnt lgkmcnt(0)
 s_barrier
 v_add_u32 v8, 65536, v8
 ds_read_b64_tr_b16 v[24:25], v8 offset:0
 v_add_u32 v9, 65536, v9
 ds_read_b64_tr_b16 v[28:29], v9 offset:0
 ds_read_b64_tr_b16 v[26:27], v8 offset:2048
 v_add_u32 v12, 65536, v12
 ds_read_b64_tr_b16 v[32:33], v12 offset:0
 ds_read_b64_tr_b16 v[30:31], v9 offset:2048
 v_mfma_f32_16x16x32_bf16 a[32:35], v[40:43], v[88:91], a[32:35]
 ds_read_b64_tr_b16 v[34:35], v12 offset:2048
 v_mfma_f32_16x16x32_bf16 a[36:39], v[40:43], v[92:95], a[36:39]
 v_add_u32 v13, 65536, v13
 ds_read_b64_tr_b16 v[36:37], v13 offset:0
 v_mfma_f32_16x16x32_bf16 a[40:43], v[44:47], v[88:91], a[40:43]
 ds_read_b64_tr_b16 v[38:39], v13 offset:2048
 v_mfma_f32_16x16x32_bf16 a[44:47], v[44:47], v[92:95], a[44:47]
 ds_read_b64_tr_b16 v[40:41], v8 offset:4096
 v_mfma_f32_16x16x32_bf16 a[48:51], v[240:243], v[88:91], a[48:51]
 ds_read_b64_tr_b16 v[42:43], v8 offset:6144
 v_mfma_f32_16x16x32_bf16 a[52:55], v[240:243], v[92:95], a[52:55]
 ds_read_b64_tr_b16 v[44:45], v9 offset:4096
 v_mfma_f32_16x16x32_bf16 a[56:59], v[244:247], v[88:91], a[56:59]
 ds_read_b64_tr_b16 v[46:47], v9 offset:6144
 v_mfma_f32_16x16x32_bf16 a[60:63], v[244:247], v[92:95], a[60:63]
 ds_read_b64_tr_b16 v[240:241], v12 offset:4096
 s_waitcnt lgkmcnt(5)
 v_mfma_f32_16x16x32_bf16 a[64:67], v[24:27], v[64:67], a[64:67]
 ds_read_b64_tr_b16 v[242:243], v12 offset:6144
 ds_read_b128 v[112:115], v3 offset:0
 v_mfma_f32_16x16x32_bf16 a[68:71], v[24:27], v[68:71], a[68:71]
 ds_read_b64_tr_b16 v[244:245], v13 offset:4096
 v_mfma_f32_16x16x32_bf16 a[72:75], v[28:31], v[64:67], a[72:75]
 ds_read_b64_tr_b16 v[246:247], v13 offset:6144
 ds_read_b128 v[116:119], v3 offset:1024
 v_mfma_f32_16x16x32_bf16 a[76:79], v[28:31], v[68:71], a[76:79]
 ds_read_b64_tr_b16 v[24:25], v8 offset:8192
 v_mfma_f32_16x16x32_bf16 a[80:83], v[32:35], v[64:67], a[80:83]
 ds_read_b64_tr_b16 v[26:27], v8 offset:10240
 ds_read_b128 v[120:123], v3 offset:2048
 v_mfma_f32_16x16x32_bf16 a[84:87], v[32:35], v[68:71], a[84:87]
 ds_read_b64_tr_b16 v[28:29], v9 offset:8192
 v_mfma_f32_16x16x32_bf16 a[88:91], v[36:39], v[64:67], a[88:91]
 ds_read_b64_tr_b16 v[30:31], v9 offset:10240
 ds_read_b128 v[124:127], v3 offset:3072
 s_waitcnt lgkmcnt(15)
 v_mfma_f32_16x16x32_bf16 a[92:95], v[36:39], v[68:71], a[92:95]
 ds_read_b64_tr_b16 v[32:33], v12 offset:8192
 s_waitcnt lgkmcnt(15)
 s_waitcnt lgkmcnt(8)
 v_mfma_f32_16x16x32_bf16 a[64:67], v[40:43], v[72:75], a[64:67]
 ds_read_b64_tr_b16 v[34:35], v12 offset:10240
 v_mfma_f32_16x16x32_bf16 a[68:71], v[40:43], v[76:79], a[68:71]
 ds_read_b64_tr_b16 v[36:37], v13 offset:8192
 v_mfma_f32_16x16x32_bf16 a[72:75], v[44:47], v[72:75], a[72:75]
 ds_read_b64_tr_b16 v[38:39], v13 offset:10240
 v_mfma_f32_16x16x32_bf16 a[76:79], v[44:47], v[76:79], a[76:79]
 ds_read_b64_tr_b16 v[40:41], v8 offset:12288
 v_mfma_f32_16x16x32_bf16 a[80:83], v[240:243], v[72:75], a[80:83]
 ds_read_b64_tr_b16 v[42:43], v8 offset:14336
 v_mfma_f32_16x16x32_bf16 a[84:87], v[240:243], v[76:79], a[84:87]
 ds_read_b64_tr_b16 v[44:45], v9 offset:12288
 v_mfma_f32_16x16x32_bf16 a[88:91], v[244:247], v[72:75], a[88:91]
 ds_read_b64_tr_b16 v[46:47], v9 offset:14336
 v_mfma_f32_16x16x32_bf16 a[92:95], v[244:247], v[76:79], a[92:95]
 ds_read_b64_tr_b16 v[240:241], v12 offset:12288
 s_waitcnt lgkmcnt(15)
 s_waitcnt lgkmcnt(5)
 v_mfma_f32_16x16x32_bf16 a[64:67], v[24:27], v[80:83], a[64:67]
 ds_read_b64_tr_b16 v[242:243], v12 offset:14336
 v_mfma_f32_16x16x32_bf16 a[68:71], v[24:27], v[84:87], a[68:71]
 ds_read_b64_tr_b16 v[244:245], v13 offset:12288
 v_mfma_f32_16x16x32_bf16 a[72:75], v[28:31], v[80:83], a[72:75]
 ds_read_b64_tr_b16 v[246:247], v13 offset:14336
 v_mfma_f32_16x16x32_bf16 a[76:79], v[28:31], v[84:87], a[76:79]
 v_mfma_f32_16x16x32_bf16 a[80:83], v[32:35], v[80:83], a[80:83]
 v_mfma_f32_16x16x32_bf16 a[84:87], v[32:35], v[84:87], a[84:87]
 v_mfma_f32_16x16x32_bf16 a[88:91], v[36:39], v[80:83], a[88:91]
 v_mfma_f32_16x16x32_bf16 a[92:95], v[36:39], v[84:87], a[92:95]
 s_waitcnt lgkmcnt(0)
 s_barrier
 v_add_u32 v8, 4294950912, v8
 ds_read_b64_tr_b16 v[24:25], v8 offset:0
 v_add_u32 v9, 4294950912, v9
 ds_read_b64_tr_b16 v[28:29], v9 offset:0
 ds_read_b64_tr_b16 v[26:27], v8 offset:2048
 v_add_u32 v12, 4294950912, v12
 ds_read_b64_tr_b16 v[32:33], v12 offset:0
 ds_read_b64_tr_b16 v[30:31], v9 offset:2048
 v_mfma_f32_16x16x32_bf16 a[64:67], v[40:43], v[88:91], a[64:67]
 ds_read_b64_tr_b16 v[34:35], v12 offset:2048
 v_mfma_f32_16x16x32_bf16 a[68:71], v[40:43], v[92:95], a[68:71]
 v_add_u32 v13, 4294950912, v13
 ds_read_b64_tr_b16 v[36:37], v13 offset:0
 v_mfma_f32_16x16x32_bf16 a[72:75], v[44:47], v[88:91], a[72:75]
 ds_read_b64_tr_b16 v[38:39], v13 offset:2048
 v_mfma_f32_16x16x32_bf16 a[76:79], v[44:47], v[92:95], a[76:79]
 ds_read_b64_tr_b16 v[40:41], v8 offset:4096
 v_mfma_f32_16x16x32_bf16 a[80:83], v[240:243], v[88:91], a[80:83]
 ds_read_b64_tr_b16 v[42:43], v8 offset:6144
 s_cmp_lg_u32 s47, 0
 s_cbranch_scc1 M_lumpm0
 v_accvgpr_read_b32 v112, a224
 v_accvgpr_read_b32 v113, a225
 v_accvgpr_read_b32 v114, a226
 v_accvgpr_read_b32 v115, a227
 v_accvgpr_read_b32 v116, a228
 v_accvgpr_read_b32 v117, a229
 v_accvgpr_read_b32 v118, a230
 v_accvgpr_read_b32 v119, a231
 v_accvgpr_read_b32 v120, a232
 v_accvgpr_read_b32 v121, a233
 v_accvgpr_read_b32 v122, a234
 v_accvgpr_read_b32 v123, a235
 v_accvgpr_read_b32 v124, a236
 v_accvgpr_read_b32 v125, a237
 v_accvgpr_read_b32 v126, a238
 v_accvgpr_read_b32 v127, a239
 v_mfma_f32_32x32x16_bf16 a[224:239], v[60:63], v[60:63], 0
 s_nop 9
M_lumpm0:
 v_mfma_f32_16x16x32_bf16 a[84:87], v[240:243], v[92:95], a[84:87]
 ds_read_b64_tr_b16 v[44:45], v9 offset:4096
 v_mfma_f32_16x16x32_bf16 a[88:91], v[244:247], v[88:91], a[88:91]
 ds_read_b64_tr_b16 v[46:47], v9 offset:6144
 v_mfma_f32_16x16x32_bf16 a[92:95], v[244:247], v[92:95], a[92:95]
 ds_read_b64_tr_b16 v[240:241], v12 offset:4096
 s_waitcnt lgkmcnt(5)
 v_mfma_f32_16x16x32_bf16 a[96:99], v[24:27], v[64:67], a[96:99]
 ds_read_b64_tr_b16 v[242:243], v12 offset:6144
 v_mfma_f32_16x16x32_bf16 a[100:103], v[24:27], v[68:71], a[100:103]
 ds_read_b64_tr_b16 v[244:245], v13 offset:4096
 v_mfma_f32_16x16x32_bf16 a[104:107], v[28:31], v[64:67], a[104:107]
 ds_read_b64_tr_b16 v[246:247], v13 offset:6144
 v_mfma_f32_16x16x32_bf16 a[108:111], v[28:31], v[68:71], a[108:111]
 ds_read_b64_tr_b16 v[24:25], v8 offset:8192
 v_mfma_f32_16x16x32_bf16 a[112:115], v[32:35], v[64:67], a[112:115]
 ds_read_b64_tr_b16 v[26:27], v8 offset:10240
 v_mfma_f32_16x16x32_bf16 a[116:119], v[32:35], v[68:71], a[116:119]
 ds_read_b64_tr_b16 v[28:29], v9 offset:8192
 v_mfma_f32_16x16x32_bf16 a[120:123], v[36:39], v[64:67], a[120:123]
 ds_read_b64_tr_b16 v[30:31], v9 offset:10240
 v_mfma_f32_16x16x32_bf16 a[124:127], v[36:39], v[68:71], a[124:127]
 ds_read_b64_tr_b16 v[32:33], v12 offset:8192
 s_waitcnt lgkmcnt(5)
 v_mfma_f32_16x16x32_bf16 a[96:99], v[40:43], v[72:75], a[96:99]
 ds_read_b64_tr_b16 v[34:35], v12 offset:10240
 v_mfma_f32_16x16x32_bf16 a[100:103], v[40:43], v[76:79], a[100:103]
 ds_read_b64_tr_b16 v[36:37], v13 offset:8192
 v_mfma_f32_16x16x32_bf16 a[104:107], v[44:47], v[72:75], a[104:107]
 ds_read_b64_tr_b16 v[38:39], v13 offset:10240
 v_mfma_f32_16x16x32_bf16 a[108:111], v[44:47], v[76:79], a[108:111]
 ds_read_b64_tr_b16 v[40:41], v8 offset:12288
 v_mfma_f32_16x16x32_bf16 a[112:115], v[240:243], v[72:75], a[112:115]
 ds_read_b64_tr_b16 v[42:43], v8 offset:14336
 v_mfma_f32_16x16x32_bf16 a[116:119], v[240:243], v[76:79], a[116:119]
 ds_read_b64_tr_b16 v[44:45], v9 offset:12288
 v_mfma_f32_16x16x32_bf16 a[120:123], v[244:247], v[72:75], a[120:123]
 ds_read_b64_tr_b16 v[46:47], v9 offset:14336
 v_mfma_f32_16x16x32_bf16 a[124:127], v[244:247], v[76:79], a[124:127]
 ds_read_b64_tr_b16 v[240:241], v12 offset:12288
 s_waitcnt lgkmcnt(5)
 v_mfma_f32_16x16x32_bf16 a[96:99], v[24:27], v[80:83], a[96:99]
 ds_read_b64_tr_b16 v[242:243], v12 offset:14336
 v_mfma_f32_16x16x32_bf16 a[100:103], v[24:27], v[84:87], a[100:103]
 ds_read_b64_tr_b16 v[244:245], v13 offset:12288
 v_mfma_f32_16x16x32_bf16 a[104:107], v[28:31], v[80:83], a[104:107]
 ds_read_b64_tr_b16 v[246:247], v13 offset:14336
 v_mfma_f32_16x16x32_bf16 a[108:111], v[28:31], v[84:87], a[108:111]
 v_mfma_f32_16x16x32_bf16 a[112:115], v[32:35], v[80:83], a[112:115]
 v_mfma_f32_16x16x32_bf16 a[116:119], v[32:35], v[84:87], a[116:119]
 v_mfma_f32_16x16x32_bf16 a[120:123], v[36:39], v[80:83], a[120:123]
 v_mfma_f32_16x16x32_bf16 a[124:127], v[36:39], v[84:87], a[124:127]
 s_waitcnt lgkmcnt(0)
 s_barrier
 ds_read_b64_tr_b16 v[24:25], v8 offset:32768
 ds_read_b64_tr_b16 v[28:29], v9 offset:32768
 ds_read_b64_tr_b16 v[26:27], v8 offset:34816
 ds_read_b64_tr_b16 v[32:33], v12 offset:32768
 ds_read_b64_tr_b16 v[30:31], v9 offset:34816
 v_mfma_f32_16x16x32_bf16 a[96:99], v[40:43], v[88:91], a[96:99]
 ds_read_b64_tr_b16 v[34:35], v12 offset:34816
 v_mfma_f32_16x16x32_bf16 a[100:103], v[40:43], v[92:95], a[100:103]
 ds_read_b64_tr_b16 v[36:37], v13 offset:32768
 v_mfma_f32_16x16x32_bf16 a[104:107], v[44:47], v[88:91], a[104:107]
 ds_read_b64_tr_b16 v[38:39], v13 offset:34816
 v_mfma_f32_16x16x32_bf16 a[108:111], v[44:47], v[92:95], a[108:111]
 ds_read_b64_tr_b16 v[40:41], v8 offset:36864
 v_mfma_f32_16x16x32_bf16 a[112:115], v[240:243], v[88:91], a[112:115]
 ds_read_b64_tr_b16 v[42:43], v8 offset:38912
 v_mfma_f32_16x16x32_bf16 a[116:119], v[240:243], v[92:95], a[116:119]
 ds_read_b64_tr_b16 v[44:45], v9 offset:36864
 v_mfma_f32_16x16x32_bf16 a[120:123], v[244:247], v[88:91], a[120:123]
 ds_read_b64_tr_b16 v[46:47], v9 offset:38912
 v_mfma_f32_16x16x32_bf16 a[124:127], v[244:247], v[92:95], a[124:127]
 ds_read_b64_tr_b16 v[240:241], v12 offset:36864
 s_waitcnt lgkmcnt(5)
 v_mfma_f32_16x16x32_bf16 a[128:131], v[24:27], v[64:67], a[128:131]
 ds_read_b64_tr_b16 v[242:243], v12 offset:38912
 v_mfma_f32_16x16x32_bf16 a[132:135], v[24:27], v[68:71], a[132:135]
 ds_read_b64_tr_b16 v[244:245], v13 offset:36864
 v_mfma_f32_16x16x32_bf16 a[136:139], v[28:31], v[64:67], a[136:139]
 ds_read_b64_tr_b16 v[246:247], v13 offset:38912
 v_mfma_f32_16x16x32_bf16 a[140:143], v[28:31], v[68:71], a[140:143]
 ds_read_b64_tr_b16 v[24:25], v8 offset:40960
 v_mfma_f32_16x16x32_bf16 a[144:147], v[32:35], v[64:67], a[144:147]
 ds_read_b64_tr_b16 v[26:27], v8 offset:43008
 v_mfma_f32_16x16x32_bf16 a[148:151], v[32:35], v[68:71], a[148:151]
 ds_read_b64_tr_b16 v[28:29], v9 offset:40960
 v_mfma_f32_16x16x32_bf16 a[152:155], v[36:39], v[64:67], a[152:155]
 ds_read_b64_tr_b16 v[30:31], v9 offset:43008
 v_mfma_f32_16x16x32_bf16 a[156:159], v[36:39], v[68:71], a[156:159]
 ds_read_b64_tr_b16 v[32:33], v12 offset:40960
 s_waitcnt lgkmcnt(5)
 v_mfma_f32_16x16x32_bf16 a[128:131], v[40:43], v[72:75], a[128:131]
 ds_read_b64_tr_b16 v[34:35], v12 offset:43008
 v_mfma_f32_16x16x32_bf16 a[132:135], v[40:43], v[76:79], a[132:135]
 ds_read_b64_tr_b16 v[36:37], v13 offset:40960
 v_mfma_f32_16x16x32_bf16 a[136:139], v[44:47], v[72:75], a[136:139]
 ds_read_b64_tr_b16 v[38:39], v13 offset:43008
 v_mfma_f32_16x16x32_bf16 a[140:143], v[44:47], v[76:79], a[140:143]
 ds_read_b64_tr_b16 v[40:41], v8 offset:45056
 v_mfma_f32_16x16x32_bf16 a[144:147], v[240:243], v[72:75], a[144:147]
 ds_read_b64_tr_b16 v[42:43], v8 offset:47104
 v_mfma_f32_16x16x32_bf16 a[148:151], v[240:243], v[76:79], a[148:151]
 ds_read_b64_tr_b16 v[44:45], v9 offset:45056
 v_mfma_f32_16x16x32_bf16 a[152:155], v[244:247], v[72:75], a[152:155]
 ds_read_b64_tr_b16 v[46:47], v9 offset:47104
 v_mfma_f32_16x16x32_bf16 a[156:159], v[244:247], v[76:79], a[156:159]
 ds_read_b64_tr_b16 v[240:241], v12 offset:45056
 s_waitcnt lgkmcnt(5)
 v_mfma_f32_16x16x32_bf16 a[128:131], v[24:27], v[80:83], a[128:131]
 ds_read_b64_tr_b16 v[242:243], v12 offset:47104
 v_mfma_f32_16x16x32_bf16 a[132:135], v[24:27], v[84:87], a[132:135]
 ds_read_b64_tr_b16 v[244:245], v13 offset:45056
 v_mfma_f32_16x16x32_bf16 a[136:139], v[28:31], v[80:83], a[136:139]
 ds_read_b64_tr_b16 v[246:247], v13 offset:47104
 v_mfma_f32_16x16x32_bf16 a[140:143], v[28:31], v[84:87], a[140:143]
 v_mfma_f32_16x16x32_bf16 a[144:147], v[32:35], v[80:83], a[144:147]
 v_mfma_f32_16x16x32_bf16 a[148:151], v[32:35], v[84:87], a[148:151]
 v_mfma_f32_16x16x32_bf16 a[152:155], v[36:39], v[80:83], a[152:155]
 v_mfma_f32_16x16x32_bf16 a[156:159], v[36:39], v[84:87], a[156:159]
 s_waitcnt lgkmcnt(0)
 s_barrier
 ds_read_b64_tr_b16 v[24:25], v8 offset:49152
 ds_read_b64_tr_b16 v[28:29], v9 offset:49152
 ds_read_b64_tr_b16 v[26:27], v8 offset:51200
 ds_read_b64_tr_b16 v[32:33], v12 offset:49152
 ds_read_b64_tr_b16 v[30:31], v9 offset:51200
 v_mfma_f32_16x16x32_bf16 a[128:131], v[40:43], v[88:91], a[128:131]
 ds_read_b64_tr_b16 v[34:35], v12 offset:51200
 v_mfma_f32_16x16x32_bf16 a[132:135], v[40:43], v[92:95], a[132:135]
 ds_read_b64_tr_b16 v[36:37], v13 offset:49152
 v_mfma_f32_16x16x32_bf16 a[136:139], v[44:47], v[88:91], a[136:139]
 ds_read_b64_tr_b16 v[38:39], v13 offset:51200
 v_mfma_f32_16x16x32_bf16 a[140:143], v[44:47], v[92:95], a[140:143]
 ds_read_b64_tr_b16 v[40:41], v8 offset:53248
 v_mfma_f32_16x16x32_bf16 a[144:147], v[240:243], v[88:91], a[144:147]
 ds_read_b64_tr_b16 v[42:43], v8 offset:55296
 v_mfma_f32_16x16x32_bf16 a[148:151], v[240:243], v[92:95], a[148:151]
 ds_read_b64_tr_b16 v[44:45], v9 offset:53248
 v_mfma_f32_16x16x32_bf16 a[152:155], v[244:247], v[88:91], a[152:155]
 ds_read_b64_tr_b16 v[46:47], v9 offset:55296
 v_mfma_f32_16x16x32_bf16 a[156:159], v[244:247], v[92:95], a[156:159]
 ds_read_b64_tr_b16 v[240:241], v12 offset:53248
 s_waitcnt lgkmcnt(5)
 v_mfma_f32_16x16x32_bf16 a[160:163], v[24:27], v[64:67], a[160:163]
 ds_read_b64_tr_b16 v[242:243], v12 offset:55296
 v_mfma_f32_16x16x32_bf16 a[164:167], v[24:27], v[68:71], a[164:167]
 ds_read_b64_tr_b16 v[244:245], v13 offset:53248
 v_mfma_f32_16x16x32_bf16 a[168:171], v[28:31], v[64:67], a[168:171]
 ds_read_b64_tr_b16 v[246:247], v13 offset:55296
 v_mfma_f32_16x16x32_bf16 a[172:175], v[28:31], v[68:71], a[172:175]
 ds_read_b64_tr_b16 v[24:25], v8 offset:57344
 v_mfma_f32_16x16x32_bf16 a[176:179], v[32:35], v[64:67], a[176:179]
 ds_read_b64_tr_b16 v[26:27], v8 offset:59392
 v_mfma_f32_16x16x32_bf16 a[180:183], v[32:35], v[68:71], a[180:183]
 ds_read_b64_tr_b16 v[28:29], v9 offset:57344
 v_mfma_f32_16x16x32_bf16 a[184:187], v[36:39], v[64:67], a[184:187]
 ds_read_b64_tr_b16 v[30:31], v9 offset:59392
 v_mfma_f32_16x16x32_bf16 a[188:191], v[36:39], v[68:71], a[188:191]
 ds_read_b64_tr_b16 v[32:33], v12 offset:57344
 s_waitcnt lgkmcnt(5)
 v_mfma_f32_16x16x32_bf16 a[160:163], v[40:43], v[72:75], a[160:163]
 ds_read_b64_tr_b16 v[34:35], v12 offset:59392
 v_mfma_f32_16x16x32_bf16 a[164:167], v[40:43], v[76:79], a[164:167]
 ds_read_b64_tr_b16 v[36:37], v13 offset:57344
 v_mfma_f32_16x16x32_bf16 a[168:171], v[44:47], v[72:75], a[168:171]
 ds_read_b64_tr_b16 v[38:39], v13 offset:59392
 v_mfma_f32_16x16x32_bf16 a[172:175], v[44:47], v[76:79], a[172:175]
 ds_read_b64_tr_b16 v[40:41], v8 offset:61440
 v_mfma_f32_16x16x32_bf16 a[176:179], v[240:243], v[72:75], a[176:179]
 ds_read_b64_tr_b16 v[42:43], v8 offset:63488
 v_mfma_f32_16x16x32_bf16 a[180:183], v[240:243], v[76:79], a[180:183]
 ds_read_b64_tr_b16 v[44:45], v9 offset:61440
 v_mfma_f32_16x16x32_bf16 a[184:187], v[244:247], v[72:75], a[184:187]
 ds_read_b64_tr_b16 v[46:47], v9 offset:63488
 v_mfma_f32_16x16x32_bf16 a[188:191], v[244:247], v[76:79], a[188:191]
 ds_read_b64_tr_b16 v[240:241], v12 offset:61440
 s_waitcnt lgkmcnt(5)
 v_mfma_f32_16x16x32_bf16 a[160:163], v[24:27], v[80:83], a[160:163]
 ds_read_b64_tr_b16 v[242:243], v12 offset:63488
 v_mfma_f32_16x16x32_bf16 a[164:167], v[24:27], v[84:87], a[164:167]
 ds_read_b64_tr_b16 v[244:245], v13 offset:61440
 v_mfma_f32_16x16x32_bf16 a[168:171], v[28:31], v[80:83], a[168:171]
 ds_read_b64_tr_b16 v[246:247], v13 offset:63488
 v_mfma_f32_16x16x32_bf16 a[172:175], v[28:31], v[84:87], a[172:175]
 v_mfma_f32_16x16x32_bf16 a[176:179], v[32:35], v[80:83], a[176:179]
 v_mfma_f32_16x16x32_bf16 a[180:183], v[32:35], v[84:87], a[180:183]
 v_mfma_f32_16x16x32_bf16 a[184:187], v[36:39], v[80:83], a[184:187]
 v_mfma_f32_16x16x32_bf16 a[188:191], v[36:39], v[84:87], a[188:191]
 s_waitcnt lgkmcnt(0)
 s_barrier
 v_add_u32 v8, 4294950912, v8
 ds_read_b64_tr_b16 v[24:25], v8 offset:0
 v_add_u32 v9, 4294950912, v9
 ds_read_b64_tr_b16 v[28:29], v9 offset:0
 ds_read_b64_tr_b16 v[26:27], v8 offset:2048
 v_add_u32 v12, 4294950912, v12
 ds_read_b64_tr_b16 v[32:33], v12 offset:0
 ds_read_b64_tr_b16 v[30:31], v9 offset:2048
 v_mfma_f32_16x16x32_bf16 a[160:163], v[40:43], v[88:91], a[160:163]
 ds_read_b64_tr_b16 v[34:35], v12 offset:2048
 v_mfma_f32_16x16x32_bf16 a[164:167], v[40:43], v[92:95], a[164:167]
 v_add_u32 v13, 4294950912, v13
 ds_read_b64_tr_b16 v[36:37], v13 offset:0
 v_mfma_f32_16x16x32_bf16 a[168:171], v[44:47], v[88:91], a[168:171]
 ds_read_b64_tr_b16 v[38:39], v13 offset:2048
 v_mfma_f32_16x16x32_bf16 a[172:175], v[44:47], v[92:95], a[172:175]
 ds_read_b64_tr_b16 v[40:41], v8 offset:4096
 v_mfma_f32_16x16x32_bf16 a[176:179], v[240:243], v[88:91], a[176:179]
 ds_read_b64_tr_b16 v[42:43], v8 offset:6144
 v_mfma_f32_16x16x32_bf16 a[180:183], v[240:243], v[92:95], a[180:183]
 ds_read_b64_tr_b16 v[44:45], v9 offset:4096
 v_mfma_f32_16x16x32_bf16 a[184:187], v[244:247], v[88:91], a[184:187]
 ds_read_b64_tr_b16 v[46:47], v9 offset:6144
 v_mfma_f32_16x16x32_bf16 a[188:191], v[244:247], v[92:95], a[188:191]
 ds_read_b64_tr_b16 v[240:241], v12 offset:4096
 s_waitcnt lgkmcnt(5)
 v_mfma_f32_16x16x32_bf16 a[192:195], v[24:27], v[64:67], a[192:195]
 ds_read_b64_tr_b16 v[242:243], v12 offset:6144
 ds_read_b128 v[128:131], v3 offset:0
 v_mfma_f32_16x16x32_bf16 a[196:199], v[24:27], v[68:71], a[196:199]
 ds_read_b64_tr_b16 v[244:245], v13 offset:4096
 v_mfma_f32_16x16x32_bf16 a[200:203], v[28:31], v[64:67], a[200:203]
 ds_read_b64_tr_b16 v[246:247], v13 offset:6144
 ds_read_b128 v[132:135], v3 offset:1024
 v_mfma_f32_16x16x32_bf16 a[204:207], v[28:31], v[68:71], a[204:207]
 ds_read_b64_tr_b16 v[24:25], v8 offset:8192
 v_mfma_f32_16x16x32_bf16 a[208:211], v[32:35], v[64:67], a[208:211]
 ds_read_b64_tr_b16 v[26:27], v8 offset:10240
 ds_read_b128 v[136:139], v3 offset:2048
 v_mfma_f32_16x16x32_bf16 a[212:215], v[32:35], v[68:71], a[212:215]
 ds_read_b64_tr_b16 v[28:29], v9 offset:8192
 v_mfma_f32_16x16x32_bf16 a[216:219], v[36:39], v[64:67], a[216:219]
 ds_read_b64_tr_b16 v[30:31], v9 offset:10240
 ds_read_b128 v[140:143], v3 offset:3072
 s_waitcnt lgkmcnt(15)
 v_mfma_f32_16x16x32_bf16 a[220:223], v[36:39], v[68:71], a[220:223]
 ds_read_b64_tr_b16 v[32:33], v12 offset:8192
 s_waitcnt lgkmcnt(15)
 s_waitcnt lgkmcnt(8)
 v_mfma_f32_16x16x32_bf16 a[192:195], v[40:43], v[72:75], a[192:195]
 ds_read_b64_tr_b16 v[34:35], v12 offset:10240
 v_mfma_f32_16x16x32_bf16 a[196:199], v[40:43], v[76:79], a[196:199]
 ds_read_b64_tr_b16 v[36:37], v13 offset:8192
 v_mfma_f32_16x16x32_bf16 a[200:203], v[44:47], v[72:75], a[200:203]
 ds_read_b64_tr_b16 v[38:39], v13 offset:10240
 v_mfma_f32_16x16x32_bf16 a[204:207], v[44:47], v[76:79], a[204:207]
 ds_read_b64_tr_b16 v[40:41], v8 offset:12288
 v_mfma_f32_16x16x32_bf16 a[208:211], v[240:243], v[72:75], a[208:211]
 ds_read_b64_tr_b16 v[42:43], v8 offset:14336
 v_mfma_f32_16x16x32_bf16 a[212:215], v[240:243], v[76:79], a[212:215]
 ds_read_b64_tr_b16 v[44:45], v9 offset:12288
 v_mfma_f32_16x16x32_bf16 a[216:219], v[244:247], v[72:75], a[216:219]
 ds_read_b64_tr_b16 v[46:47], v9 offset:14336
 v_mfma_f32_16x16x32_bf16 a[220:223], v[244:247], v[76:79], a[220:223]
 ds_read_b64_tr_b16 v[240:241], v12 offset:12288
 s_waitcnt lgkmcnt(15)
 s_waitcnt lgkmcnt(5)
 v_mfma_f32_16x16x32_bf16 a[192:195], v[24:27], v[80:83], a[192:195]
 ds_read_b64_tr_b16 v[242:243], v12 offset:14336
 v_mfma_f32_16x16x32_bf16 a[196:199], v[24:27], v[84:87], a[196:199]
 ds_read_b64_tr_b16 v[244:245], v13 offset:12288
 v_mfma_f32_16x16x32_bf16 a[200:203], v[28:31], v[80:83], a[200:203]
 ds_read_b64_tr_b16 v[246:247], v13 offset:14336
 v_mfma_f32_16x16x32_bf16 a[204:207], v[28:31], v[84:87], a[204:207]
 v_mfma_f32_16x16x32_bf16 a[208:211], v[32:35], v[80:83], a[208:211]
 v_mfma_f32_16x16x32_bf16 a[212:215], v[32:35], v[84:87], a[212:215]
 v_mfma_f32_16x16x32_bf16 a[216:219], v[36:39], v[80:83], a[216:219]
 v_mfma_f32_16x16x32_bf16 a[220:223], v[36:39], v[84:87], a[220:223]
 s_waitcnt lgkmcnt(0)
 s_barrier
 ds_read_b64_tr_b16 v[24:25], v8 offset:32768
 ds_read_b64_tr_b16 v[28:29], v9 offset:32768
 ds_read_b64_tr_b16 v[26:27], v8 offset:34816
 ds_read_b64_tr_b16 v[32:33], v12 offset:32768
 ds_read_b64_tr_b16 v[30:31], v9 offset:34816
 v_mfma_f32_16x16x32_bf16 a[192:195], v[40:43], v[88:91], a[192:195]
 ds_read_b64_tr_b16 v[34:35], v12 offset:34816
 v_mfma_f32_16x16x32_bf16 a[196:199], v[40:43], v[92:95], a[196:199]
 ds_read_b64_tr_b16 v[36:37], v13 offset:32768
 v_mfma_f32_16x16x32_bf16 a[200:203], v[44:47], v[88:91], a[200:203]
 ds_read_b64_tr_b16 v[38:39], v13 offset:34816
 s_cmp_lg_u32 s47, 0
 s_cbranch_scc1 M_lumpm1
 v_accvgpr_read_b32 v128, a240
 v_accvgpr_read_b32 v129, a241
 v_accvgpr_read_b32 v130, a242
 v_accvgpr_read_b32 v131, a243
 v_accvgpr_read_b32 v132, a244
 v_accvgpr_read_b32 v133, a245
 v_accvgpr_read_b32 v134, a246
 v_accvgpr_read_b32 v135, a247
 v_accvgpr_read_b32 v136, a248
 v_accvgpr_read_b32 v137, a249
 v_accvgpr_read_b32 v138, a250
 v_accvgpr_read_b32 v139, a251
 v_accvgpr_read_b32 v140, a252
 v_accvgpr_read_b32 v141, a253
 v_accvgpr_read_b32 v142, a254
 v_accvgpr_read_b32 v143, a255
 v_mfma_f32_32x32x16_bf16 a[240:255], v[60:63], v[60:63], 0
 s_nop 9
M_lumpm1:
 v_mfma_f32_16x16x32_bf16 a[204:207], v[44:47], v[92:95], a[204:207]
 ds_read_b64_tr_b16 v[40:41], v8 offset:36864
 v_mfma_f32_16x16x32_bf16 a[208:211], v[240:243], v[88:91], a[208:211]
 ds_read_b64_tr_b16 v[42:43], v8 offset:38912
 v_mfma_f32_16x16x32_bf16 a[212:215], v[240:243], v[92:95], a[212:215]
 ds_read_b64_tr_b16 v[44:45], v9 offset:36864
 v_mfma_f32_16x16x32_bf16 a[216:219], v[244:247], v[88:91], a[216:219]
 ds_read_b64_tr_b16 v[46:47], v9 offset:38912
 v_mfma_f32_16x16x32_bf16 a[220:223], v[244:247], v[92:95], a[220:223]
 ds_read_b64_tr_b16 v[240:241], v12 offset:36864
 s_waitcnt lgkmcnt(5)
 v_mfma_f32_16x16x32_bf16 a[224:227], v[24:27], v[64:67], a[224:227]
 ds_read_b64_tr_b16 v[242:243], v12 offset:38912
 v_mfma_f32_16x16x32_bf16 a[228:231], v[24:27], v[68:71], a[228:231]
 ds_read_b64_tr_b16 v[244:245], v13 offset:36864
 v_mfma_f32_16x16x32_bf16 a[232:235], v[28:31], v[64:67], a[232:235]
 ds_read_b64_tr_b16 v[246:247], v13 offset:38912
 v_mfma_f32_16x16x32_bf16 a[236:239], v[28:31], v[68:71], a[236:239]
 ds_read_b64_tr_b16 v[24:25], v8 offset:40960
 v_mfma_f32_16x16x32_bf16 a[240:243], v[32:35], v[64:67], a[240:243]
 ds_read_b64_tr_b16 v[26:27], v8 offset:43008
 v_mfma_f32_16x16x32_bf16 a[244:247], v[32:35], v[68:71], a[244:247]
 ds_read_b64_tr_b16 v[28:29], v9 offset:40960
 v_mfma_f32_16x16x32_bf16 a[248:251], v[36:39], v[64:67], a[248:251]
 ds_read_b64_tr_b16 v[30:31], v9 offset:43008
 v_mfma_f32_16x16x32_bf16 a[252:255], v[36:39], v[68:71], a[252:255]
 ds_read_b64_tr_b16 v[32:33], v12 offset:40960
 s_waitcnt lgkmcnt(5)
 v_mfma_f32_16x16x32_bf16 a[224:227], v[40:43], v[72:75], a[224:227]
 ds_read_b64_tr_b16 v[34:35], v12 offset:43008
 v_mfma_f32_16x16x32_bf16 a[228:231], v[40:43], v[76:79], a[228:231]
 ds_read_b64_tr_b16 v[36:37], v13 offset:40960
 v_mfma_f32_16x16x32_bf16 a[232:235], v[44:47], v[72:75], a[232:235]
 ds_read_b64_tr_b16 v[38:39], v13 offset:43008
 v_mfma_f32_16x16x32_bf16 a[236:239], v[44:47], v[76:79], a[236:239]
 ds_read_b64_tr_b16 v[40:41], v8 offset:45056
 v_mfma_f32_16x16x32_bf16 a[240:243], v[240:243], v[72:75], a[240:243]
 ds_read_b64_tr_b16 v[42:43], v8 offset:47104
 v_mfma_f32_16x16x32_bf16 a[244:247], v[240:243], v[76:79], a[244:247]
 ds_read_b64_tr_b16 v[44:45], v9 offset:45056
 v_mfma_f32_16x16x32_bf16 a[248:251], v[244:247], v[72:75], a[248:251]
 ds_read_b64_tr_b16 v[46:47], v9 offset:47104
 v_mfma_f32_16x16x32_bf16 a[252:255], v[244:247], v[76:79], a[252:255]
 ds_read_b64_tr_b16 v[240:241], v12 offset:45056
 s_waitcnt lgkmcnt(5)
 v_mfma_f32_16x16x32_bf16 a[224:227], v[24:27], v[80:83], a[224:227]
 ds_read_b64_tr_b16 v[242:243], v12 offset:47104
 v_mfma_f32_16x16x32_bf16 a[228:231], v[24:27], v[84:87], a[228:231]
 ds_read_b64_tr_b16 v[244:245], v13 offset:45056
 v_mfma_f32_16x16x32_bf16 a[232:235], v[28:31], v[80:83], a[232:235]
 ds_read_b64_tr_b16 v[246:247], v13 offset:47104
 v_mfma_f32_16x16x32_bf16 a[236:239], v[28:31], v[84:87], a[236:239]
 v_mfma_f32_16x16x32_bf16 a[240:243], v[32:35], v[80:83], a[240:243]
 v_mfma_f32_16x16x32_bf16 a[244:247], v[32:35], v[84:87], a[244:247]
 v_mfma_f32_16x16x32_bf16 a[248:251], v[36:39], v[80:83], a[248:251]
 v_mfma_f32_16x16x32_bf16 a[252:255], v[36:39], v[84:87], a[252:255]
 s_waitcnt lgkmcnt(0)
 s_barrier
 v_add_u32 v8, 65536, v8
 ds_read_b64_tr_b16 v[24:25], v8 offset:0
 v_add_u32 v9, 65536, v9
 ds_read_b64_tr_b16 v[28:29], v9 offset:0
 ds_read_b64_tr_b16 v[26:27], v8 offset:2048
 v_add_u32 v12, 65536, v12
 ds_read_b64_tr_b16 v[32:33], v12 offset:0
 ds_read_b64_tr_b16 v[30:31], v9 offset:2048
 v_mfma_f32_16x16x32_bf16 a[224:227], v[40:43], v[88:91], a[224:227]
 ds_read_b64_tr_b16 v[34:35], v12 offset:2048
 v_mfma_f32_16x16x32_bf16 a[228:231], v[40:43], v[92:95], a[228:231]
 v_add_u32 v13, 65536, v13
 ds_read_b64_tr_b16 v[36:37], v13 offset:0
 v_mfma_f32_16x16x32_bf16 a[232:235], v[44:47], v[88:91], a[232:235]
 ds_read_b64_tr_b16 v[38:39], v13 offset:2048
 v_mfma_f32_16x16x32_bf16 a[236:239], v[44:47], v[92:95], a[236:239]
 ds_read_b64_tr_b16 v[40:41], v8 offset:4096
 v_mfma_f32_16x16x32_bf16 a[240:243], v[240:243], v[88:91], a[240:243]
 ds_read_b64_tr_b16 v[42:43], v8 offset:6144
 v_mfma_f32_16x16x32_bf16 a[244:247], v[240:243], v[92:95], a[244:247]
 ds_read_b64_tr_b16 v[44:45], v9 offset:4096
 v_mfma_f32_16x16x32_bf16 a[248:251], v[244:247], v[88:91], a[248:251]
 ds_read_b64_tr_b16 v[46:47], v9 offset:6144
 v_mfma_f32_16x16x32_bf16 a[252:255], v[244:247], v[92:95], a[252:255]
 ds_read_b64_tr_b16 v[240:241], v12 offset:4096
 s_waitcnt lgkmcnt(5)
 v_mfma_f32_16x16x32_bf16 v[208:211], v[24:27], v[64:67], v[208:211]
 ds_read_b64_tr_b16 v[242:243], v12 offset:6144
 v_mfma_f32_16x16x32_bf16 v[212:215], v[24:27], v[68:71], v[212:215]
 ds_read_b64_tr_b16 v[244:245], v13 offset:4096
 v_mfma_f32_16x16x32_bf16 v[216:219], v[28:31], v[64:67], v[216:219]
 ds_read_b64_tr_b16 v[246:247], v13 offset:6144
 v_mfma_f32_16x16x32_bf16 v[220:223], v[28:31], v[68:71], v[220:223]
 ds_read_b64_tr_b16 v[24:25], v8 offset:8192
 v_mfma_f32_16x16x32_bf16 v[224:227], v[32:35], v[64:67], v[224:227]
 ds_read_b64_tr_b16 v[26:27], v8 offset:10240
 v_mfma_f32_16x16x32_bf16 v[228:231], v[32:35], v[68:71], v[228:231]
 ds_read_b64_tr_b16 v[28:29], v9 offset:8192
 v_mfma_f32_16x16x32_bf16 v[232:235], v[36:39], v[64:67], v[232:235]
 ds_read_b64_tr_b16 v[30:31], v9 offset:10240
 v_mfma_f32_16x16x32_bf16 v[236:239], v[36:39], v[68:71], v[236:239]
 ds_read_b64_tr_b16 v[32:33], v12 offset:8192
 s_waitcnt lgkmcnt(5)
 v_mfma_f32_16x16x32_bf16 v[208:211], v[40:43], v[72:75], v[208:211]
 ds_read_b64_tr_b16 v[34:35], v12 offset:10240
 v_mfma_f32_16x16x32_bf16 v[212:215], v[40:43], v[76:79], v[212:215]
 ds_read_b64_tr_b16 v[36:37], v13 offset:8192
 v_mfma_f32_16x16x32_bf16 v[216:219], v[44:47], v[72:75], v[216:219]
 ds_read_b64_tr_b16 v[38:39], v13 offset:10240
 v_mfma_f32_16x16x32_bf16 v[220:223], v[44:47], v[76:79], v[220:223]
 ds_read_b64_tr_b16 v[40:41], v8 offset:12288
 v_mfma_f32_16x16x32_bf16 v[224:227], v[240:243], v[72:75], v[224:227]
 ds_read_b64_tr_b16 v[42:43], v8 offset:14336
 s_add_u32 s47, s47, 1
 v_mfma_f32_16x16x32_bf16 v[228:231], v[240:243], v[76:79], v[228:231]
 ds_read_b64_tr_b16 v[44:45], v9 offset:12288
 v_mfma_f32_16x16x32_bf16 v[232:235], v[244:247], v[72:75], v[232:235]
 ds_read_b64_tr_b16 v[46:47], v9 offset:14336
 v_mfma_f32_16x16x32_bf16 v[236:239], v[244:247], v[76:79], v[236:239]
 ds_read_b64_tr_b16 v[240:241], v12 offset:12288
 s_waitcnt lgkmcnt(5)
 v_mfma_f32_16x16x32_bf16 v[208:211], v[24:27], v[80:83], v[208:211]
 ds_read_b64_tr_b16 v[242:243], v12 offset:14336
 v_mfma_f32_16x16x32_bf16 v[212:215], v[24:27], v[84:87], v[212:215]
 ds_read_b64_tr_b16 v[244:245], v13 offset:12288
 v_mfma_f32_16x16x32_bf16 v[216:219], v[28:31], v[80:83], v[216:219]
 ds_read_b64_tr_b16 v[246:247], v13 offset:14336
 v_mfma_f32_16x16x32_bf16 v[220:223], v[28:31], v[84:87], v[220:223]
 v_mfma_f32_16x16x32_bf16 v[224:227], v[32:35], v[80:83], v[224:227]
 v_mfma_f32_16x16x32_bf16 v[228:231], v[32:35], v[84:87], v[228:231]
 v_mfma_f32_16x16x32_bf16 v[232:235], v[36:39], v[80:83], v[232:235]
 v_mfma_f32_16x16x32_bf16 v[236:239], v[36:39], v[84:87], v[236:239]
 v_add_u32 v4, 4294885376, v4
 v_add_u32 v5, 4294885376, v5
 v_add_u32 v8, 4294836224, v8
 v_add_u32 v9, 4294836224, v9
 v_add_u32 v12, 4294836224, v12
 v_add_u32 v13, 4294836224, v13
 v_sub_u32 v8, v8, v10
 v_sub_u32 v9, v9, v10
 v_sub_u32 v12, v12, v10
 v_sub_u32 v13, v13, v10
 s_waitcnt lgkmcnt(0)
 s_barrier
 ds_read_b128 v[24:27], v4 offset:0
 ds_read_b128 v[28:31], v5 offset:0
 ds_read_b128 v[32:35], v4 offset:512
 v_mfma_f32_16x16x32_bf16 v[208:211], v[40:43], v[88:91], v[208:211]
 v_mfma_f32_16x16x32_bf16 v[212:215], v[40:43], v[92:95], v[212:215]
 ds_read_b128 v[36:39], v5 offset:512
 v_mfma_f32_16x16x32_bf16 v[216:219], v[44:47], v[88:91], v[216:219]
 v_mfma_f32_16x16x32_bf16 v[220:223], v[44:47], v[92:95], v[220:223]
 ds_read_b128 v[40:43], v4 offset:4096
 v_mfma_f32_16x16x32_bf16 v[224:227], v[240:243], v[88:91], v[224:227]
 v_mfma_f32_16x16x32_bf16 v[228:231], v[240:243], v[92:95], v[228:231]
 ds_read_b128 v[44:47], v5 offset:4096
 v_mfma_f32_16x16x32_bf16 v[232:235], v[244:247], v[88:91], v[232:235]
 v_mfma_f32_16x16x32_bf16 v[236:239], v[244:247], v[92:95], v[236:239]
 s_branch M_item
M_stub_1_0:
 s_call_b64 s[40:41], M_rare1
 s_branch M_back_1_0
M_stub_2_1:
 s_call_b64 s[40:41], M_rare0
 s_branch M_back_2_1
M_stub_3_2:
 s_call_b64 s[40:41], M_rare1
 s_branch M_back_3_2
M_stub_4_3:
 s_call_b64 s[40:41], M_rare0
 s_branch M_back_4_3
M_stub_5_4:
 s_call_b64 s[40:41], M_rare1
 s_branch M_back_5_4
M_stub_6_5:
 s_call_b64 s[40:41], M_rare0
 s_branch M_back_6_5
M_stub_7_6:
 s_call_b64 s[40:41], M_rare1
 s_branch M_back_7_6
M_stub_8_7:
 s_call_b64 s[40:41], M_rare0
 s_branch M_back_8_7
M_stub_9_8:
 s_call_b64 s[40:41], M_rare1
 s_branch M_back_9_8
M_stub_10_9:
 s_call_b64 s[40:41], M_rare0
 s_branch M_back_10_9
M_stub_11_10:
 s_call_b64 s[40:41], M_rare1
 s_branch M_back_11_10
M_stub_12_11:
 s_call_b64 s[40:41], M_rare0
 s_branch M_back_12_11
M_stub_13_12:
 s_call_b64 s[40:41], M_rare1
 s_branch M_back_13_12
M_stub_14_13:
 s_call_b64 s[40:41], M_rare0
 s_branch M_back_14_13
M_stub_15_14:
 s_call_b64 s[40:41], M_rare1
 s_branch M_back_15_14
M_rare0:
 s_nop 15
 s_nop 15
 v_max3_f32 v20, v64, v65, v66
 v_max3_f32 v11, v72, v73, v74
 v_max3_f32 v20, v20, v67, v68
 v_max3_f32 v11, v11, v75, v76
 v_max3_f32 v20, v20, v69, v70
 v_max3_f32 v11, v11, v77, v78
 v_max_f32 v20, v20, v71
 v_max_f32 v11, v11, v79
 s_nop 1
 v_permlane16_swap_b32 v20, v11
 v_max_f32 v20, v20, v11
 v_mov_b32 v21, v20
 s_nop 1
 v_permlane32_swap_b32 v20, v21
 v_max_f32 v20, v20, v21
 v_mov_b32 v11, v20
 s_nop 1
 v_permlane16_swap_b32 v20, v11
 v_max_f32 v20, 0, v20
 v_max_f32 v11, 0, v11
 v_sub_f32 v48, v48, v20
 v_sub_f32 v49, v49, v20
 v_sub_f32 v50, v50, v20
 v_sub_f32 v51, v51, v20
 v_sub_f32 v52, v52, v11
 v_sub_f32 v53, v53, v11
 v_sub_f32 v54, v54, v11
 v_sub_f32 v55, v55, v11
 v_sub_f32 v64, v64, v20
 v_sub_f32 v80, v80, v20
 v_sub_f32 v65, v65, v20
 v_sub_f32 v81, v81, v20
 v_sub_f32 v66, v66, v20
 v_sub_f32 v82, v82, v20
 v_sub_f32 v67, v67, v20
 v_sub_f32 v83, v83, v20
 v_sub_f32 v68, v68, v20
 v_sub_f32 v84, v84, v20
 v_sub_f32 v69, v69, v20
 v_sub_f32 v85, v85, v20
 v_sub_f32 v70, v70, v20
 v_sub_f32 v86, v86, v20
 v_sub_f32 v71, v71, v20
 v_sub_f32 v87, v87, v20
 v_sub_f32 v72, v72, v11
 v_sub_f32 v88, v88, v11
 v_sub_f32 v73, v73, v11
 v_sub_f32 v89, v89, v11
 v_sub_f32 v74, v74, v11
 v_sub_f32 v90, v90, v11
 v_sub_f32 v75, v75, v11
 v_sub_f32 v91, v91, v11
 v_sub_f32 v76, v76, v11
 v_sub_f32 v92, v92, v11
 v_sub_f32 v77, v77, v11
 v_sub_f32 v93, v93, v11
 v_sub_f32 v78, v78, v11
 v_sub_f32 v94, v94, v11
 v_sub_f32 v79, v79, v11
 v_sub_f32 v95, v95, v11
 v_exp_f32 v20, -v20
 v_exp_f32 v11, -v11
 s_nop 0
 v_mul_f32 v14, v14, v20
 v_mul_f32 v56, v56, v11
 v_mul_f32 v144, v144, v20
 v_mul_f32 v145, v145, v20
 v_mul_f32 v146, v146, v20
 v_mul_f32 v147, v147, v20
 v_mul_f32 v148, v148, v11
 v_mul_f32 v149, v149, v11
 v_mul_f32 v150, v150, v11
 v_mul_f32 v151, v151, v11
 v_mul_f32 v152, v152, v20
 v_mul_f32 v153, v153, v20
 v_mul_f32 v154, v154, v20
 v_mul_f32 v155, v155, v20
 v_mul_f32 v156, v156, v11
 v_mul_f32 v157, v157, v11
 v_mul_f32 v158, v158, v11
 v_mul_f32 v159, v159, v11
 v_mul_f32 v160, v160, v20
 v_mul_f32 v161, v161, v20
 v_mul_f32 v162, v162, v20
 v_mul_f32 v163, v163, v20
 v_mul_f32 v164, v164, v11
 v_mul_f32 v165, v165, v11
 v_mul_f32 v166, v166, v11
 v_mul_f32 v167, v167, v11
 v_mul_f32 v168, v168, v20
 v_mul_f32 v169, v169, v20
 v_mul_f32 v170, v170, v20
 v_mul_f32 v171, v171, v20
 v_mul_f32 v172, v172, v11
 v_mul_f32 v173, v173, v11
 v_mul_f32 v174, v174, v11
 v_mul_f32 v175, v175, v11
 v_mul_f32 v176, v176, v20
 v_mul_f32 v177, v177, v20
 v_mul_f32 v178, v178, v20
 v_mul_f32 v179, v179, v20
 v_mul_f32 v180, v180, v11
 v_mul_f32 v181, v181, v11
 v_mul_f32 v182, v182, v11
 v_mul_f32 v183, v183, v11
 v_mul_f32 v184, v184, v20
 v_mul_f32 v185, v185, v20
 v_mul_f32 v186, v186, v20
 v_mul_f32 v187, v187, v20
 v_mul_f32 v188, v188, v11
 v_mul_f32 v189, v189, v11
 v_mul_f32 v190, v190, v11
 v_mul_f32 v191, v191, v11
 v_mul_f32 v192, v192, v20
 v_mul_f32 v193, v193, v20
 v_mul_f32 v194, v194, v20
 v_mul_f32 v195, v195, v20
 v_mul_f32 v196, v196, v11
 v_mul_f32 v197, v197, v11
 v_mul_f32 v198, v198, v11
 v_mul_f32 v199, v199, v11
 v_mul_f32 v200, v200, v20
 v_mul_f32 v201, v201, v20
 v_mul_f32 v202, v202, v20
 v_mul_f32 v203, v203, v20
 v_mul_f32 v204, v204, v11
 v_mul_f32 v205, v205, v11
 v_mul_f32 v206, v206, v11
 v_mul_f32 v207, v207, v11
 v_exp_f32 v16, v64
 v_exp_f32 v17, v65
 v_exp_f32 v18, v66
 v_add_f32 v15, v16, v17
 v_exp_f32 v19, v67
 v_cvt_pk_bf16_f32 v96, v16, v17
 v_exp_f32 v16, v68
 v_add_f32 v15, v15, v18
 v_exp_f32 v17, v69
 v_cvt_pk_bf16_f32 v97, v18, v19
 v_add_f32 v15, v15, v19
 v_exp_f32 v18, v70
 v_add_f32 v15, v15, v16
 v_exp_f32 v19, v71
 v_cvt_pk_bf16_f32 v98, v16, v17
 v_add_f32 v15, v15, v17
 v_exp_f32 v16, v72
 v_add_f32 v15, v15, v18
 v_exp_f32 v17, v73
 v_cvt_pk_bf16_f32 v99, v18, v19
 v_add_f32 v15, v15, v19
 v_exp_f32 v18, v74
 v_add_f32 v57, v16, v17
 v_exp_f32 v19, v75
 v_cvt_pk_bf16_f32 v100, v16, v17
 v_exp_f32 v16, v76
 v_add_f32 v57, v57, v18
 v_exp_f32 v17, v77
 v_cvt_pk_bf16_f32 v101, v18, v19
 v_add_f32 v57, v57, v19
 v_exp_f32 v18, v78
 v_add_f32 v57, v57, v16
 v_exp_f32 v19, v79
 v_cvt_pk_bf16_f32 v102, v16, v17
 v_add_f32 v57, v57, v17
 v_add_f32 v57, v57, v18
 v_cvt_pk_bf16_f32 v103, v18, v19
 v_add_f32 v57, v57, v19
 s_nop 3
 s_setpc_b64 s[40:41]
M_rare1:
 s_nop 15
 s_nop 15
 v_max3_f32 v20, v80, v81, v82
 v_max3_f32 v11, v88, v89, v90
 v_max3_f32 v20, v20, v83, v84
 v_max3_f32 v11, v11, v91, v92
 v_max3_f32 v20, v20, v85, v86
 v_max3_f32 v11, v11, v93, v94
 v_max_f32 v20, v20, v87
 v_max_f32 v11, v11, v95
 s_nop 1
 v_permlane16_swap_b32 v20, v11
 v_max_f32 v20, v20, v11
 v_mov_b32 v21, v20
 s_nop 1
 v_permlane32_swap_b32 v20, v21
 v_max_f32 v20, v20, v21
 v_mov_b32 v11, v20
 s_nop 1
 v_permlane16_swap_b32 v20, v11
 v_max_f32 v20, 0, v20
 v_max_f32 v11, 0, v11
 v_sub_f32 v48, v48, v20
 v_sub_f32 v49, v49, v20
 v_sub_f32 v50, v50, v20
 v_sub_f32 v51, v51, v20
 v_sub_f32 v52, v52, v11
 v_sub_f32 v53, v53, v11
 v_sub_f32 v54, v54, v11
 v_sub_f32 v55, v55, v11
 v_sub_f32 v80, v80, v20
 v_sub_f32 v64, v64, v20
 v_sub_f32 v81, v81, v20
 v_sub_f32 v65, v65, v20
 v_sub_f32 v82, v82, v20
 v_sub_f32 v66, v66, v20
 v_sub_f32 v83, v83, v20
 v_sub_f32 v67, v67, v20
 v_sub_f32 v84, v84, v20
 v_sub_f32 v68, v68, v20
 v_sub_f32 v85, v85, v20
 v_sub_f32 v69, v69, v20
 v_sub_f32 v86, v86, v20
 v_sub_f32 v70, v70, v20
 v_sub_f32 v87, v87, v20
 v_sub_f32 v71, v71, v20
 v_sub_f32 v88, v88, v11
 v_sub_f32 v72, v72, v11
 v_sub_f32 v89, v89, v11
 v_sub_f32 v73, v73, v11
 v_sub_f32 v90, v90, v11
 v_sub_f32 v74, v74, v11
 v_sub_f32 v91, v91, v11
 v_sub_f32 v75, v75, v11
 v_sub_f32 v92, v92, v11
 v_sub_f32 v76, v76, v11
 v_sub_f32 v93, v93, v11
 v_sub_f32 v77, v77, v11
 v_sub_f32 v94, v94, v11
 v_sub_f32 v78, v78, v11
 v_sub_f32 v95, v95, v11
 v_sub_f32 v79, v79, v11
 v_exp_f32 v20, -v20
 v_exp_f32 v11, -v11
 s_nop 0
 v_mul_f32 v14, v14, v20
 v_mul_f32 v56, v56, v11
 v_mul_f32 v144, v144, v20
 v_mul_f32 v145, v145, v20
 v_mul_f32 v146, v146, v20
 v_mul_f32 v147, v147, v20
 v_mul_f32 v148, v148, v11
 v_mul_f32 v149, v149, v11
 v_mul_f32 v150, v150, v11
 v_mul_f32 v151, v151, v11
 v_mul_f32 v152, v152, v20
 v_mul_f32 v153, v153, v20
 v_mul_f32 v154, v154, v20
 v_mul_f32 v155, v155, v20
 v_mul_f32 v156, v156, v11
 v_mul_f32 v157, v157, v11
 v_mul_f32 v158, v158, v11
 v_mul_f32 v159, v159, v11
 v_mul_f32 v160, v160, v20
 v_mul_f32 v161, v161, v20
 v_mul_f32 v162, v162, v20
 v_mul_f32 v163, v163, v20
 v_mul_f32 v164, v164, v11
 v_mul_f32 v165, v165, v11
 v_mul_f32 v166, v166, v11
 v_mul_f32 v167, v167, v11
 v_mul_f32 v168, v168, v20
 v_mul_f32 v169, v169, v20
 v_mul_f32 v170, v170, v20
 v_mul_f32 v171, v171, v20
 v_mul_f32 v172, v172, v11
 v_mul_f32 v173, v173, v11
 v_mul_f32 v174, v174, v11
 v_mul_f32 v175, v175, v11
 v_mul_f32 v176, v176, v20
 v_mul_f32 v177, v177, v20
 v_mul_f32 v178, v178, v20
 v_mul_f32 v179, v179, v20
 v_mul_f32 v180, v180, v11
 v_mul_f32 v181, v181, v11
 v_mul_f32 v182, v182, v11
 v_mul_f32 v183, v183, v11
 v_mul_f32 v184, v184, v20
 v_mul_f32 v185, v185, v20
 v_mul_f32 v186, v186, v20
 v_mul_f32 v187, v187, v20
 v_mul_f32 v188, v188, v11
 v_mul_f32 v189, v189, v11
 v_mul_f32 v190, v190, v11
 v_mul_f32 v191, v191, v11
 v_mul_f32 v192, v192, v20
 v_mul_f32 v193, v193, v20
 v_mul_f32 v194, v194, v20
 v_mul_f32 v195, v195, v20
 v_mul_f32 v196, v196, v11
 v_mul_f32 v197, v197, v11
 v_mul_f32 v198, v198, v11
 v_mul_f32 v199, v199, v11
 v_mul_f32 v200, v200, v20
 v_mul_f32 v201, v201, v20
 v_mul_f32 v202, v202, v20
 v_mul_f32 v203, v203, v20
 v_mul_f32 v204, v204, v11
 v_mul_f32 v205, v205, v11
 v_mul_f32 v206, v206, v11
 v_mul_f32 v207, v207, v11
 v_exp_f32 v16, v80
 v_exp_f32 v17, v81
 v_exp_f32 v18, v82
 v_add_f32 v15, v16, v17
 v_exp_f32 v19, v83
 v_cvt_pk_bf16_f32 v104, v16, v17
 v_exp_f32 v16, v84
 v_add_f32 v15, v15, v18
 v_exp_f32 v17, v85
 v_cvt_pk_bf16_f32 v105, v18, v19
 v_add_f32 v15, v15, v19
 v_exp_f32 v18, v86
 v_add_f32 v15, v15, v16
 v_exp_f32 v19, v87
 v_cvt_pk_bf16_f32 v106, v16, v17
 v_add_f32 v15, v15, v17
 v_exp_f32 v16, v88
 v_add_f32 v15, v15, v18
 v_exp_f32 v17, v89
 v_cvt_pk_bf16_f32 v107, v18, v19
 v_add_f32 v15, v15, v19
 v_exp_f32 v18, v90
 v_add_f32 v57, v16, v17
 v_exp_f32 v19, v91
 v_cvt_pk_bf16_f32 v108, v16, v17
 v_exp_f32 v16, v92
 v_add_f32 v57, v57, v18
 v_exp_f32 v17, v93
 v_cvt_pk_bf16_f32 v109, v18, v19
 v_add_f32 v57, v57, v19
 v_exp_f32 v18, v94
 v_add_f32 v57, v57, v16
 v_exp_f32 v19, v95
 v_cvt_pk_bf16_f32 v110, v16, v17
 v_add_f32 v57, v57, v17
 v_add_f32 v57, v57, v18
 v_cvt_pk_bf16_f32 v111, v18, v19
 v_add_f32 v57, v57, v19
 s_nop 3
 s_setpc_b64 s[40:41]
M_loader:
 s_lshl_b32 s50, s3, 12
 s_add_u32 s90, s44, 196608
 v_lshrrev_b32 v1, 5, v0
 v_and_b32 v2, 31, v0
 v_lshlrev_b32 v16, 2, v1
 v_xor_b32 v2, v2, v16
 s_and_b32 s56, s3, 1
 s_lshl_b32 s56, s56, 1
 v_xor_b32 v2, s56, v2
 v_lshlrev_b32 v2, 4, v2
 v_lshl_add_u32 v2, v1, 13, v2
 v_xor_b32 v17, 0, v2
 v_add_u32 v32, 0, v17
 v_xor_b32 v17, 128, v2
 v_add_u32 v33, 15360, v17
 v_xor_b32 v17, 0, v2
 v_add_u32 v34, 30720, v17
 v_xor_b32 v17, 128, v2
 v_add_u32 v35, 46080, v17
 s_waitcnt lgkmcnt(0)
 s_mov_b32 s24, s12
 s_mov_b32 s25, s13
 s_mov_b32 s26, 4718592
 s_mov_b32 s27, 0x20000
 s_mov_b32 s32, s40
 s_mov_b32 s33, s41
 s_mov_b32 s34, 1769472
 s_mov_b32 s35, 0x20000
 s_mov_b32 s36, s54
 s_mov_b32 s37, s55
 s_mov_b32 s38, 290848768
 s_mov_b32 s39, 0x20000
 s_mov_b32 s16, s8
 s_mov_b32 s17, s9
 s_mov_b32 s18, 67108864
 s_mov_b32 s19, 0x20000
 s_mov_b32 s20, s10
 s_mov_b32 s21, s11
 s_mov_b32 s22, 67108864
 s_mov_b32 s23, 0x20000
 s_mov_b32 s28, s14
 s_mov_b32 s29, s15
 s_mov_b32 s30, 4718592
 s_mov_b32 s31, 0x20000
 s_mov_b32 s92, s12
 s_mov_b32 s93, s13
 s_mov_b32 s94, 4718592
 s_mov_b32 s95, 0x20000
 s_mov_b32 s72, s76
 s_mov_b32 s73, s77
 s_mov_b32 s74, 3538944
 s_mov_b32 s75, 0x20000
 s_mov_b32 s68, s78
 s_mov_b32 s69, s79
 s_mov_b32 s70, 256
 s_mov_b32 s71, 0x20000
 s_lshl_b32 s15, s59, 1
 s_add_u32 s15, s15, s4
 s_lshl_b32 s15, s15, 13
 s_add_u32 m0, s50, 49152
 s_add_u32 s46, s90, 0
 buffer_load_dwordx4 v32, s[24:27], s46 offen offset:0 lds
 buffer_load_dwordx4 v33, s[24:27], s46 offen offset:1024 lds
 buffer_load_dwordx4 v34, s[24:27], s46 offen offset:2048 lds
 buffer_load_dwordx4 v35, s[24:27], s46 offen offset:3072 lds
 s_add_u32 m0, s50, 81920
 s_add_u32 s46, s90, 512
 buffer_load_dwordx4 v32, s[24:27], s46 offen offset:0 lds
 buffer_load_dwordx4 v33, s[24:27], s46 offen offset:1024 lds
 buffer_load_dwordx4 v34, s[24:27], s46 offen offset:2048 lds
 buffer_load_dwordx4 v35, s[24:27], s46 offen offset:3072 lds
 v_and_b32 v1, 7, v0
 v_lshlrev_b32 v1, 2, v1
 buffer_load_dword v63, v1, s[36:39], s89 offen sc1
 v_lshrrev_b32 v1, 4, v0
 v_and_b32 v2, 15, v0
 v_lshrrev_b32 v16, 1, v2
 v_xor_b32 v16, v16, v1
 v_lshlrev_b32 v2, 7, v2
 v_lshl_add_u32 v4, v16, 4, v2
 v_xor_b32 v5, 64, v4
 v_lshrrev_b32 v1, 4, v0
 v_bfe_u32 v2, v0, 2, 2
 v_lshl_add_u32 v16, v1, 3, v2
 v_lshlrev_b32 v16, 9, v16
 v_lshl_add_u32 v16, v2, 6, v16
 v_and_b32 v2, 1, v1
 v_lshl_add_u32 v16, v2, 5, v16
 v_and_b32 v2, 3, v0
 v_lshl_add_u32 v6, v2, 3, v16
 v_xor_b32 v7, 32, v6
 v_xor_b32 v8, 64, v6
 v_xor_b32 v9, 96, v6
 v_xor_b32 v10, 128, v6
 v_xor_b32 v11, 160, v6
 v_xor_b32 v60, 192, v6
 v_xor_b32 v61, 224, v6
 v_lshrrev_b32 v1, 3, v0
 v_and_b32 v1, 3, v1
 v_and_b32 v2, 7, v0
 v_lshrrev_b32 v16, 5, v0
 v_lshlrev_b32 v16, 7, v16
 v_lshl_add_u32 v16, v1, 8, v16
 v_and_b32 v1, 2, v1
 v_xor_b32 v17, v1, v2
 v_lshl_add_u32 v24, v17, 4, v16
 v_lshlrev_b32 v1, 1, v1
 v_xor_b32 v17, v1, v2
 v_lshl_add_u32 v28, v17, 4, v16
 v_xor_b32 v3, 32, v28
 v_xor_b32 v25, 16, v24
 v_xor_b32 v26, 64, v24
 v_xor_b32 v27, 80, v24
 s_and_b32 s56, s4, 15
 v_mov_b32 v17, 0x7fffff00
 v_cmp_gt_u32 vcc, 36, v0
 v_lshlrev_b32 v29, 7, v0
 s_mul_i32 s57, s56, 9216
 v_add_u32 v29, s57, v29
 v_cndmask_b32 v29, v17, v29, vcc
 s_waitcnt vmcnt(1) lgkmcnt(0)
 s_barrier
 v_add_u32 v4, 147456, v4
 ds_read_b128 v[48:51], v4 offset:0
 ds_read_b128 v[52:55], v4 offset:2048
 ds_read_b128 v[56:59], v4 offset:4096
 ds_read_b128 v[12:15], v4 offset:6144
 ds_read_b128 v[16:19], v4 offset:8192
 ds_read_b128 v[20:23], v4 offset:10240
 v_add_u32 v6, 81920, v6
 ds_read_b64_tr_b16 v[36:37], v6 offset:256
 ds_read_b64_tr_b16 v[38:39], v6 offset:2304
 v_add_u32 v7, 81920, v7
 ds_read_b64_tr_b16 v[40:41], v7 offset:256
 ds_read_b64_tr_b16 v[42:43], v7 offset:2304
 s_waitcnt lgkmcnt(2)
 v_mfma_f32_16x16x32_bf16 v[64:67], v[36:39], v[48:51], 0
 s_add_u32 m0, s50, 65536
 s_add_u32 s46, s90, 262144
 buffer_load_dwordx4 v32, s[24:27], s46 offen offset:0 lds
 v_mfma_f32_16x16x32_bf16 v[68:71], v[36:39], v[52:55], 0
 v_add_u32 v8, 81920, v8
 ds_read_b64_tr_b16 v[44:45], v8 offset:256
 ds_read_b64_tr_b16 v[46:47], v8 offset:2304
 v_mfma_f32_16x16x32_bf16 v[72:75], v[36:39], v[56:59], 0
 buffer_load_dwordx4 v33, s[24:27], s46 offen offset:1024 lds
 v_mfma_f32_16x16x32_bf16 v[76:79], v[36:39], v[12:15], 0
 v_mfma_f32_16x16x32_bf16 v[80:83], v[36:39], v[16:19], 0
 buffer_load_dwordx4 v34, s[24:27], s46 offen offset:2048 lds
 v_mfma_f32_16x16x32_bf16 v[84:87], v[36:39], v[20:23], 0
 s_waitcnt lgkmcnt(2)
 v_mfma_f32_16x16x32_bf16 v[88:91], v[40:43], v[48:51], 0
 buffer_load_dwordx4 v35, s[24:27], s46 offen offset:3072 lds
 v_mfma_f32_16x16x32_bf16 v[92:95], v[40:43], v[52:55], 0
 v_add_u32 v9, 81920, v9
 ds_read_b64_tr_b16 v[36:37], v9 offset:256
 ds_read_b64_tr_b16 v[38:39], v9 offset:2304
 v_mfma_f32_16x16x32_bf16 v[96:99], v[40:43], v[56:59], 0
 s_add_u32 m0, s50, 114688
 s_add_u32 s46, s90, 262656
 buffer_load_dwordx4 v32, s[24:27], s46 offen offset:0 lds
 v_mfma_f32_16x16x32_bf16 v[100:103], v[40:43], v[12:15], 0
 v_mfma_f32_16x16x32_bf16 v[104:107], v[40:43], v[16:19], 0
 buffer_load_dwordx4 v33, s[24:27], s46 offen offset:1024 lds
 v_mfma_f32_16x16x32_bf16 v[108:111], v[40:43], v[20:23], 0
 s_waitcnt lgkmcnt(2)
 v_mfma_f32_16x16x32_bf16 v[112:115], v[44:47], v[48:51], 0
 buffer_load_dwordx4 v34, s[24:27], s46 offen offset:2048 lds
 v_mfma_f32_16x16x32_bf16 v[116:119], v[44:47], v[52:55], 0
 v_add_u32 v10, 81920, v10
 ds_read_b64_tr_b16 v[40:41], v10 offset:256
 ds_read_b64_tr_b16 v[42:43], v10 offset:2304
 v_mfma_f32_16x16x32_bf16 v[120:123], v[44:47], v[56:59], 0
 buffer_load_dwordx4 v35, s[24:27], s46 offen offset:3072 lds
 v_mfma_f32_16x16x32_bf16 v[124:127], v[44:47], v[12:15], 0
 v_mfma_f32_16x16x32_bf16 v[128:131], v[44:47], v[16:19], 0
 s_add_u32 m0, s50, 98304
 s_add_u32 s46, s90, 524288
 buffer_load_dwordx4 v32, s[24:27], s46 offen offset:0 lds
 v_mfma_f32_16x16x32_bf16 v[132:135], v[44:47], v[20:23], 0
 s_waitcnt lgkmcnt(2)
 v_mfma_f32_16x16x32_bf16 v[136:139], v[36:39], v[48:51], 0
 buffer_load_dwordx4 v33, s[24:27], s46 offen offset:1024 lds
 v_mfma_f32_16x16x32_bf16 v[140:143], v[36:39], v[52:55], 0
 v_add_u32 v11, 81920, v11
 ds_read_b64_tr_b16 v[44:45], v11 offset:256
 ds_read_b64_tr_b16 v[46:47], v11 offset:2304
 v_mfma_f32_16x16x32_bf16 v[144:147], v[36:39], v[56:59], 0
 buffer_load_dwordx4 v34, s[24:27], s46 offen offset:2048 lds
 v_mfma_f32_16x16x32_bf16 v[148:151], v[36:39], v[12:15], 0
 v_mfma_f32_16x16x32_bf16 v[152:155], v[36:39], v[16:19], 0
 buffer_load_dwordx4 v35, s[24:27], s46 offen offset:3072 lds
 v_mfma_f32_16x16x32_bf16 v[156:159], v[36:39], v[20:23], 0
 s_waitcnt lgkmcnt(2)
 v_mfma_f32_16x16x32_bf16 v[160:163], v[40:43], v[48:51], 0
 s_add_u32 m0, s50, 131072
 s_add_u32 s46, s90, 524800
 buffer_load_dwordx4 v32, s[24:27], s46 offen offset:0 lds
 v_mfma_f32_16x16x32_bf16 v[164:167], v[40:43], v[52:55], 0
 v_add_u32 v60, 81920, v60
 ds_read_b64_tr_b16 v[36:37], v60 offset:256
 ds_read_b64_tr_b16 v[38:39], v60 offset:2304
 v_mfma_f32_16x16x32_bf16 v[168:171], v[40:43], v[56:59], 0
 v_mfma_f32_16x16x32_bf16 v[172:175], v[40:43], v[12:15], 0
 v_mfma_f32_16x16x32_bf16 v[176:179], v[40:43], v[16:19], 0
 buffer_load_dwordx4 v33, s[24:27], s46 offen offset:1024 lds
 v_mfma_f32_16x16x32_bf16 v[180:183], v[40:43], v[20:23], 0
 s_waitcnt lgkmcnt(2)
 v_mfma_f32_16x16x32_bf16 v[184:187], v[44:47], v[48:51], 0
 v_mfma_f32_16x16x32_bf16 v[188:191], v[44:47], v[52:55], 0
 v_add_u32 v61, 81920, v61
 ds_read_b64_tr_b16 v[40:41], v61 offset:256
 ds_read_b64_tr_b16 v[42:43], v61 offset:2304
 v_mfma_f32_16x16x32_bf16 v[192:195], v[44:47], v[56:59], 0
 buffer_load_dwordx4 v34, s[24:27], s46 offen offset:2048 lds
 v_mfma_f32_16x16x32_bf16 v[196:199], v[44:47], v[12:15], 0
 v_mfma_f32_16x16x32_bf16 v[200:203], v[44:47], v[16:19], 0
 v_mfma_f32_16x16x32_bf16 v[204:207], v[44:47], v[20:23], 0
 s_waitcnt lgkmcnt(2)
 v_mfma_f32_16x16x32_bf16 v[208:211], v[36:39], v[48:51], 0
 buffer_load_dwordx4 v35, s[24:27], s46 offen offset:3072 lds
 v_mfma_f32_16x16x32_bf16 v[212:215], v[36:39], v[52:55], 0
 v_mfma_f32_16x16x32_bf16 v[216:219], v[36:39], v[56:59], 0
 v_mfma_f32_16x16x32_bf16 v[220:223], v[36:39], v[12:15], 0
 s_waitcnt vmcnt(8) lgkmcnt(0)
 s_barrier
 ds_read_b64_tr_b16 v[44:45], v6 offset:33024
 ds_read_b64_tr_b16 v[46:47], v6 offset:35072
 v_mfma_f32_16x16x32_bf16 v[224:227], v[36:39], v[16:19], 0
 s_add_u32 m0, s50, 49152
 s_add_u32 s46, s90, 786432
 buffer_load_dwordx4 v32, s[24:27], s46 offen offset:0 lds
 v_mfma_f32_16x16x32_bf16 v[228:231], v[36:39], v[20:23], 0
 v_mfma_f32_16x16x32_bf16 v[232:235], v[40:43], v[48:51], 0
 v_mfma_f32_16x16x32_bf16 v[236:239], v[40:43], v[52:55], 0
 v_add_u32 v5, 147456, v5
 ds_read_b128 v[48:51], v5 offset:0
 ds_read_b128 v[52:55], v5 offset:2048
 ds_read_b64_tr_b16 v[36:37], v7 offset:33024
 ds_read_b64_tr_b16 v[38:39], v7 offset:35072
 v_mfma_f32_16x16x32_bf16 v[240:243], v[40:43], v[56:59], 0
 buffer_load_dwordx4 v33, s[24:27], s46 offen offset:1024 lds
 v_mfma_f32_16x16x32_bf16 v[244:247], v[40:43], v[12:15], 0
 ds_read_b128 v[56:59], v5 offset:4096
 ds_read_b128 v[12:15], v5 offset:6144
 v_mfma_f32_16x16x32_bf16 v[248:251], v[40:43], v[16:19], 0
 v_mfma_f32_16x16x32_bf16 v[252:255], v[40:43], v[20:23], 0
 ds_read_b128 v[16:19], v5 offset:8192
 ds_read_b128 v[20:23], v5 offset:10240
 s_waitcnt lgkmcnt(7)
 v_mfma_f32_16x16x32_bf16 v[64:67], v[44:47], v[48:51], v[64:67]
 buffer_load_dwordx4 v34, s[24:27], s46 offen offset:2048 lds
 s_waitcnt lgkmcnt(6)
 v_mfma_f32_16x16x32_bf16 v[68:71], v[44:47], v[52:55], v[68:71]
 ds_read_b64_tr_b16 v[40:41], v8 offset:33024
 ds_read_b64_tr_b16 v[42:43], v8 offset:35072
 s_waitcnt lgkmcnt(5)
 v_mfma_f32_16x16x32_bf16 v[72:75], v[44:47], v[56:59], v[72:75]
 s_waitcnt lgkmcnt(4)
 v_mfma_f32_16x16x32_bf16 v[76:79], v[44:47], v[12:15], v[76:79]
 s_waitcnt lgkmcnt(3)
 v_mfma_f32_16x16x32_bf16 v[80:83], v[44:47], v[16:19], v[80:83]
 buffer_load_dwordx4 v35, s[24:27], s46 offen offset:3072 lds
 s_waitcnt lgkmcnt(2)
 v_mfma_f32_16x16x32_bf16 v[84:87], v[44:47], v[20:23], v[84:87]
 v_mfma_f32_16x16x32_bf16 v[88:91], v[36:39], v[48:51], v[88:91]
 v_mfma_f32_16x16x32_bf16 v[92:95], v[36:39], v[52:55], v[92:95]
 ds_read_b64_tr_b16 v[44:45], v9 offset:33024
 ds_read_b64_tr_b16 v[46:47], v9 offset:35072
 v_mfma_f32_16x16x32_bf16 v[96:99], v[36:39], v[56:59], v[96:99]
 s_add_u32 m0, s50, 81920
 s_add_u32 s46, s90, 786944
 buffer_load_dwordx4 v32, s[24:27], s46 offen offset:0 lds
 v_mfma_f32_16x16x32_bf16 v[100:103], v[36:39], v[12:15], v[100:103]
 v_mfma_f32_16x16x32_bf16 v[104:107], v[36:39], v[16:19], v[104:107]
 v_mfma_f32_16x16x32_bf16 v[108:111], v[36:39], v[20:23], v[108:111]
 s_waitcnt lgkmcnt(2)
 v_mfma_f32_16x16x32_bf16 v[112:115], v[40:43], v[48:51], v[112:115]
 buffer_load_dwordx4 v33, s[24:27], s46 offen offset:1024 lds
 v_mfma_f32_16x16x32_bf16 v[116:119], v[40:43], v[52:55], v[116:119]
 ds_read_b64_tr_b16 v[36:37], v10 offset:33024
 ds_read_b64_tr_b16 v[38:39], v10 offset:35072
 v_mfma_f32_16x16x32_bf16 v[120:123], v[40:43], v[56:59], v[120:123]
 v_mfma_f32_16x16x32_bf16 v[124:127], v[40:43], v[12:15], v[124:127]
 v_mfma_f32_16x16x32_bf16 v[128:131], v[40:43], v[16:19], v[128:131]
 buffer_load_dwordx4 v34, s[24:27], s46 offen offset:2048 lds
 v_mfma_f32_16x16x32_bf16 v[132:135], v[40:43], v[20:23], v[132:135]
 s_waitcnt lgkmcnt(2)
 v_mfma_f32_16x16x32_bf16 v[136:139], v[44:47], v[48:51], v[136:139]
 v_mfma_f32_16x16x32_bf16 v[140:143], v[44:47], v[52:55], v[140:143]
 ds_read_b64_tr_b16 v[40:41], v11 offset:33024
 ds_read_b64_tr_b16 v[42:43], v11 offset:35072
 v_mfma_f32_16x16x32_bf16 v[144:147], v[44:47], v[56:59], v[144:147]
 buffer_load_dwordx4 v35, s[24:27], s46 offen offset:3072 lds
 v_mfma_f32_16x16x32_bf16 v[148:151], v[44:47], v[12:15], v[148:151]
 v_mfma_f32_16x16x32_bf16 v[152:155], v[44:47], v[16:19], v[152:155]
 v_mfma_f32_16x16x32_bf16 v[156:159], v[44:47], v[20:23], v[156:159]
 s_waitcnt lgkmcnt(2)
 v_mfma_f32_16x16x32_bf16 v[160:163], v[36:39], v[48:51], v[160:163]
 v_mfma_f32_16x16x32_bf16 v[164:167], v[36:39], v[52:55], v[164:167]
 ds_read_b64_tr_b16 v[44:45], v60 offset:33024
 ds_read_b64_tr_b16 v[46:47], v60 offset:35072
 v_mfma_f32_16x16x32_bf16 v[168:171], v[36:39], v[56:59], v[168:171]
 v_mfma_f32_16x16x32_bf16 v[172:175], v[36:39], v[12:15], v[172:175]
 v_mfma_f32_16x16x32_bf16 v[176:179], v[36:39], v[16:19], v[176:179]
 v_mfma_f32_16x16x32_bf16 v[180:183], v[36:39], v[20:23], v[180:183]
 s_waitcnt lgkmcnt(2)
 v_mfma_f32_16x16x32_bf16 v[184:187], v[40:43], v[48:51], v[184:187]
 v_mfma_f32_16x16x32_bf16 v[188:191], v[40:43], v[52:55], v[188:191]
 ds_read_b64_tr_b16 v[36:37], v61 offset:33024
 ds_read_b64_tr_b16 v[38:39], v61 offset:35072
 v_mfma_f32_16x16x32_bf16 v[192:195], v[40:43], v[56:59], v[192:195]
 v_mfma_f32_16x16x32_bf16 v[196:199], v[40:43], v[12:15], v[196:199]
 v_mfma_f32_16x16x32_bf16 v[200:203], v[40:43], v[16:19], v[200:203]
 v_mfma_f32_16x16x32_bf16 v[204:207], v[40:43], v[20:23], v[204:207]
 s_waitcnt lgkmcnt(2)
 v_mfma_f32_16x16x32_bf16 v[208:211], v[44:47], v[48:51], v[208:211]
 v_mfma_f32_16x16x32_bf16 v[212:215], v[44:47], v[52:55], v[212:215]
 v_mfma_f32_16x16x32_bf16 v[216:219], v[44:47], v[56:59], v[216:219]
 v_mfma_f32_16x16x32_bf16 v[220:223], v[44:47], v[12:15], v[220:223]
 s_waitcnt vmcnt(8) lgkmcnt(0)
 s_barrier
 s_lshl_b32 s56, s53, 2
 v_mov_b32 v1, s56
 v_mov_b32 v2, 1
 s_mov_b64 exec, 1
 buffer_atomic_add v2, v1, s[68:71], 0 offen offset:0 sc1
 s_mov_b64 exec, -1
 ds_read_b64_tr_b16 v[40:41], v6 offset:49408
 ds_read_b64_tr_b16 v[42:43], v6 offset:51456
 v_mfma_f32_16x16x32_bf16 v[224:227], v[44:47], v[16:19], v[224:227]
 s_add_u32 m0, s50, 65536
 s_add_u32 s46, s90, 1048576
 buffer_load_dwordx4 v32, s[24:27], s46 offen offset:0 lds
 v_mfma_f32_16x16x32_bf16 v[228:231], v[44:47], v[20:23], v[228:231]
 v_mfma_f32_16x16x32_bf16 v[232:235], v[36:39], v[48:51], v[232:235]
 v_mfma_f32_16x16x32_bf16 v[236:239], v[36:39], v[52:55], v[236:239]
 v_add_u32 v4, 4294852608, v4
 ds_read_b128 v[48:51], v4 offset:0
 ds_read_b128 v[52:55], v4 offset:2048
 ds_read_b64_tr_b16 v[44:45], v7 offset:49408
 ds_read_b64_tr_b16 v[46:47], v7 offset:51456
 v_mfma_f32_16x16x32_bf16 v[240:243], v[36:39], v[56:59], v[240:243]
 buffer_load_dwordx4 v33, s[24:27], s46 offen offset:1024 lds
 v_mfma_f32_16x16x32_bf16 v[244:247], v[36:39], v[12:15], v[244:247]
 ds_read_b128 v[56:59], v4 offset:4096
 ds_read_b128 v[12:15], v4 offset:6144
 v_mfma_f32_16x16x32_bf16 v[248:251], v[36:39], v[16:19], v[248:251]
 v_mfma_f32_16x16x32_bf16 v[252:255], v[36:39], v[20:23], v[252:255]
 ds_read_b128 v[16:19], v4 offset:8192
 ds_read_b128 v[20:23], v4 offset:10240
 s_waitcnt lgkmcnt(7)
 v_mfma_f32_16x16x32_bf16 v[64:67], v[40:43], v[48:51], v[64:67]
 buffer_load_dwordx4 v34, s[24:27], s46 offen offset:2048 lds
 s_waitcnt lgkmcnt(6)
 v_mfma_f32_16x16x32_bf16 v[68:71], v[40:43], v[52:55], v[68:71]
 ds_read_b64_tr_b16 v[36:37], v8 offset:49408
 ds_read_b64_tr_b16 v[38:39], v8 offset:51456
 s_waitcnt lgkmcnt(5)
 v_mfma_f32_16x16x32_bf16 v[72:75], v[40:43], v[56:59], v[72:75]
 s_waitcnt lgkmcnt(4)
 v_mfma_f32_16x16x32_bf16 v[76:79], v[40:43], v[12:15], v[76:79]
 s_waitcnt lgkmcnt(3)
 v_mfma_f32_16x16x32_bf16 v[80:83], v[40:43], v[16:19], v[80:83]
 buffer_load_dwordx4 v35, s[24:27], s46 offen offset:3072 lds
 s_waitcnt lgkmcnt(2)
 v_mfma_f32_16x16x32_bf16 v[84:87], v[40:43], v[20:23], v[84:87]
 v_mfma_f32_16x16x32_bf16 v[88:91], v[44:47], v[48:51], v[88:91]
 v_mfma_f32_16x16x32_bf16 v[92:95], v[44:47], v[52:55], v[92:95]
 ds_read_b64_tr_b16 v[40:41], v9 offset:49408
 ds_read_b64_tr_b16 v[42:43], v9 offset:51456
 v_mfma_f32_16x16x32_bf16 v[96:99], v[44:47], v[56:59], v[96:99]
 s_add_u32 m0, s50, 114688
 s_add_u32 s46, s90, 1049088
 buffer_load_dwordx4 v32, s[24:27], s46 offen offset:0 lds
 v_mfma_f32_16x16x32_bf16 v[100:103], v[44:47], v[12:15], v[100:103]
 v_mfma_f32_16x16x32_bf16 v[104:107], v[44:47], v[16:19], v[104:107]
 v_mfma_f32_16x16x32_bf16 v[108:111], v[44:47], v[20:23], v[108:111]
 s_waitcnt lgkmcnt(2)
 v_mfma_f32_16x16x32_bf16 v[112:115], v[36:39], v[48:51], v[112:115]
 buffer_load_dwordx4 v33, s[24:27], s46 offen offset:1024 lds
 v_mfma_f32_16x16x32_bf16 v[116:119], v[36:39], v[52:55], v[116:119]
 ds_read_b64_tr_b16 v[44:45], v10 offset:49408
 ds_read_b64_tr_b16 v[46:47], v10 offset:51456
 v_mfma_f32_16x16x32_bf16 v[120:123], v[36:39], v[56:59], v[120:123]
 v_mfma_f32_16x16x32_bf16 v[124:127], v[36:39], v[12:15], v[124:127]
 v_mfma_f32_16x16x32_bf16 v[128:131], v[36:39], v[16:19], v[128:131]
 buffer_load_dwordx4 v34, s[24:27], s46 offen offset:2048 lds
 v_mfma_f32_16x16x32_bf16 v[132:135], v[36:39], v[20:23], v[132:135]
 s_waitcnt lgkmcnt(2)
 v_mfma_f32_16x16x32_bf16 v[136:139], v[40:43], v[48:51], v[136:139]
 v_mfma_f32_16x16x32_bf16 v[140:143], v[40:43], v[52:55], v[140:143]
 ds_read_b64_tr_b16 v[36:37], v11 offset:49408
 ds_read_b64_tr_b16 v[38:39], v11 offset:51456
 v_mfma_f32_16x16x32_bf16 v[144:147], v[40:43], v[56:59], v[144:147]
 buffer_load_dwordx4 v35, s[24:27], s46 offen offset:3072 lds
 v_mfma_f32_16x16x32_bf16 v[148:151], v[40:43], v[12:15], v[148:151]
 v_mfma_f32_16x16x32_bf16 v[152:155], v[40:43], v[16:19], v[152:155]
 v_mfma_f32_16x16x32_bf16 v[156:159], v[40:43], v[20:23], v[156:159]
 s_waitcnt lgkmcnt(2)
 v_mfma_f32_16x16x32_bf16 v[160:163], v[44:47], v[48:51], v[160:163]
 v_mfma_f32_16x16x32_bf16 v[164:167], v[44:47], v[52:55], v[164:167]
 ds_read_b64_tr_b16 v[40:41], v60 offset:49408
 ds_read_b64_tr_b16 v[42:43], v60 offset:51456
 v_mfma_f32_16x16x32_bf16 v[168:171], v[44:47], v[56:59], v[168:171]
 v_mfma_f32_16x16x32_bf16 v[172:175], v[44:47], v[12:15], v[172:175]
 v_mfma_f32_16x16x32_bf16 v[176:179], v[44:47], v[16:19], v[176:179]
 v_mfma_f32_16x16x32_bf16 v[180:183], v[44:47], v[20:23], v[180:183]
 s_waitcnt lgkmcnt(2)
 v_mfma_f32_16x16x32_bf16 v[184:187], v[36:39], v[48:51], v[184:187]
 v_mfma_f32_16x16x32_bf16 v[188:191], v[36:39], v[52:55], v[188:191]
 ds_read_b64_tr_b16 v[44:45], v61 offset:49408
 ds_read_b64_tr_b16 v[46:47], v61 offset:51456
 v_mfma_f32_16x16x32_bf16 v[192:195], v[36:39], v[56:59], v[192:195]
 v_mfma_f32_16x16x32_bf16 v[196:199], v[36:39], v[12:15], v[196:199]
 v_mfma_f32_16x16x32_bf16 v[200:203], v[36:39], v[16:19], v[200:203]
 v_mfma_f32_16x16x32_bf16 v[204:207], v[36:39], v[20:23], v[204:207]
 s_waitcnt lgkmcnt(2)
 v_mfma_f32_16x16x32_bf16 v[208:211], v[40:43], v[48:51], v[208:211]
 v_mfma_f32_16x16x32_bf16 v[212:215], v[40:43], v[52:55], v[212:215]
 v_mfma_f32_16x16x32_bf16 v[216:219], v[40:43], v[56:59], v[216:219]
 v_mfma_f32_16x16x32_bf16 v[220:223], v[40:43], v[12:15], v[220:223]
 s_waitcnt vmcnt(9) lgkmcnt(0)
 s_barrier
 ds_read_b64_tr_b16 v[36:37], v6 offset:256
 ds_read_b64_tr_b16 v[38:39], v6 offset:2304
 v_mfma_f32_16x16x32_bf16 v[224:227], v[40:43], v[16:19], v[224:227]
 s_add_u32 m0, s50, 98304
 s_add_u32 s46, s90, 1310720
 buffer_load_dwordx4 v32, s[24:27], s46 offen offset:0 lds
 v_mfma_f32_16x16x32_bf16 v[228:231], v[40:43], v[20:23], v[228:231]
 v_mfma_f32_16x16x32_bf16 v[232:235], v[44:47], v[48:51], v[232:235]
 v_mfma_f32_16x16x32_bf16 v[236:239], v[44:47], v[52:55], v[236:239]
 v_add_u32 v5, 4294852608, v5
 ds_read_b128 v[48:51], v5 offset:0
 ds_read_b128 v[52:55], v5 offset:2048
 ds_read_b64_tr_b16 v[40:41], v7 offset:256
 ds_read_b64_tr_b16 v[42:43], v7 offset:2304
 v_mfma_f32_16x16x32_bf16 v[240:243], v[44:47], v[56:59], v[240:243]
 buffer_load_dwordx4 v33, s[24:27], s46 offen offset:1024 lds
 v_mfma_f32_16x16x32_bf16 v[244:247], v[44:47], v[12:15], v[244:247]
 ds_read_b128 v[56:59], v5 offset:4096
 ds_read_b128 v[12:15], v5 offset:6144
 v_mfma_f32_16x16x32_bf16 v[248:251], v[44:47], v[16:19], v[248:251]
 v_mfma_f32_16x16x32_bf16 v[252:255], v[44:47], v[20:23], v[252:255]
 ds_read_b128 v[16:19], v5 offset:8192
 ds_read_b128 v[20:23], v5 offset:10240
 s_waitcnt lgkmcnt(7)
 v_mfma_f32_16x16x32_bf16 v[64:67], v[36:39], v[48:51], v[64:67]
 buffer_load_dwordx4 v34, s[24:27], s46 offen offset:2048 lds
 s_waitcnt lgkmcnt(6)
 v_mfma_f32_16x16x32_bf16 v[68:71], v[36:39], v[52:55], v[68:71]
 ds_read_b64_tr_b16 v[44:45], v8 offset:256
 ds_read_b64_tr_b16 v[46:47], v8 offset:2304
 s_waitcnt lgkmcnt(5)
 v_mfma_f32_16x16x32_bf16 v[72:75], v[36:39], v[56:59], v[72:75]
 s_waitcnt lgkmcnt(4)
 v_mfma_f32_16x16x32_bf16 v[76:79], v[36:39], v[12:15], v[76:79]
 s_waitcnt lgkmcnt(3)
 v_mfma_f32_16x16x32_bf16 v[80:83], v[36:39], v[16:19], v[80:83]
 buffer_load_dwordx4 v35, s[24:27], s46 offen offset:3072 lds
 s_waitcnt lgkmcnt(2)
 v_mfma_f32_16x16x32_bf16 v[84:87], v[36:39], v[20:23], v[84:87]
 v_mfma_f32_16x16x32_bf16 v[88:91], v[40:43], v[48:51], v[88:91]
 v_mfma_f32_16x16x32_bf16 v[92:95], v[40:43], v[52:55], v[92:95]
 ds_read_b64_tr_b16 v[36:37], v9 offset:256
 ds_read_b64_tr_b16 v[38:39], v9 offset:2304
 v_mfma_f32_16x16x32_bf16 v[96:99], v[40:43], v[56:59], v[96:99]
 s_add_u32 m0, s50, 131072
 s_add_u32 s46, s90, 1311232
 buffer_load_dwordx4 v32, s[24:27], s46 offen offset:0 lds
 v_mfma_f32_16x16x32_bf16 v[100:103], v[40:43], v[12:15], v[100:103]
 v_mfma_f32_16x16x32_bf16 v[104:107], v[40:43], v[16:19], v[104:107]
 v_mfma_f32_16x16x32_bf16 v[108:111], v[40:43], v[20:23], v[108:111]
 s_waitcnt lgkmcnt(2)
 v_mfma_f32_16x16x32_bf16 v[112:115], v[44:47], v[48:51], v[112:115]
 buffer_load_dwordx4 v33, s[24:27], s46 offen offset:1024 lds
 v_mfma_f32_16x16x32_bf16 v[116:119], v[44:47], v[52:55], v[116:119]
 ds_read_b64_tr_b16 v[40:41], v10 offset:256
 ds_read_b64_tr_b16 v[42:43], v10 offset:2304
 v_mfma_f32_16x16x32_bf16 v[120:123], v[44:47], v[56:59], v[120:123]
 v_mfma_f32_16x16x32_bf16 v[124:127], v[44:47], v[12:15], v[124:127]
 v_mfma_f32_16x16x32_bf16 v[128:131], v[44:47], v[16:19], v[128:131]
 buffer_load_dwordx4 v34, s[24:27], s46 offen offset:2048 lds
 v_mfma_f32_16x16x32_bf16 v[132:135], v[44:47], v[20:23], v[132:135]
 s_waitcnt lgkmcnt(2)
 v_mfma_f32_16x16x32_bf16 v[136:139], v[36:39], v[48:51], v[136:139]
 v_mfma_f32_16x16x32_bf16 v[140:143], v[36:39], v[52:55], v[140:143]
 ds_read_b64_tr_b16 v[44:45], v11 offset:256
 ds_read_b64_tr_b16 v[46:47], v11 offset:2304
 v_mfma_f32_16x16x32_bf16 v[144:147], v[36:39], v[56:59], v[144:147]
 buffer_load_dwordx4 v35, s[24:27], s46 offen offset:3072 lds
 v_mfma_f32_16x16x32_bf16 v[148:151], v[36:39], v[12:15], v[148:151]
 v_mfma_f32_16x16x32_bf16 v[152:155], v[36:39], v[16:19], v[152:155]
 v_mfma_f32_16x16x32_bf16 v[156:159], v[36:39], v[20:23], v[156:159]
 s_waitcnt lgkmcnt(2)
 v_mfma_f32_16x16x32_bf16 v[160:163], v[40:43], v[48:51], v[160:163]
 v_mfma_f32_16x16x32_bf16 v[164:167], v[40:43], v[52:55], v[164:167]
 ds_read_b64_tr_b16 v[36:37], v60 offset:256
 ds_read_b64_tr_b16 v[38:39], v60 offset:2304
 v_mfma_f32_16x16x32_bf16 v[168:171], v[40:43], v[56:59], v[168:171]
 v_mfma_f32_16x16x32_bf16 v[172:175], v[40:43], v[12:15], v[172:175]
 v_mfma_f32_16x16x32_bf16 v[176:179], v[40:43], v[16:19], v[176:179]
 v_mfma_f32_16x16x32_bf16 v[180:183], v[40:43], v[20:23], v[180:183]
 s_waitcnt lgkmcnt(2)
 v_mfma_f32_16x16x32_bf16 v[184:187], v[44:47], v[48:51], v[184:187]
 v_mfma_f32_16x16x32_bf16 v[188:191], v[44:47], v[52:55], v[188:191]
 ds_read_b64_tr_b16 v[40:41], v61 offset:256
 ds_read_b64_tr_b16 v[42:43], v61 offset:2304
 v_mfma_f32_16x16x32_bf16 v[192:195], v[44:47], v[56:59], v[192:195]
 v_mfma_f32_16x16x32_bf16 v[196:199], v[44:47], v[12:15], v[196:199]
 v_mfma_f32_16x16x32_bf16 v[200:203], v[44:47], v[16:19], v[200:203]
 v_mfma_f32_16x16x32_bf16 v[204:207], v[44:47], v[20:23], v[204:207]
 s_waitcnt lgkmcnt(2)
 v_mfma_f32_16x16x32_bf16 v[208:211], v[36:39], v[48:51], v[208:211]
 v_mfma_f32_16x16x32_bf16 v[212:215], v[36:39], v[52:55], v[212:215]
 v_mfma_f32_16x16x32_bf16 v[216:219], v[36:39], v[56:59], v[216:219]
 v_mfma_f32_16x16x32_bf16 v[220:223], v[36:39], v[12:15], v[220:223]
 s_waitcnt vmcnt(8) lgkmcnt(0)
 s_barrier
 ds_read_b64_tr_b16 v[44:45], v6 offset:33024
 ds_read_b64_tr_b16 v[46:47], v6 offset:35072
 v_mfma_f32_16x16x32_bf16 v[224:227], v[36:39], v[16:19], v[224:227]
 s_add_u32 m0, s50, 49152
 s_add_u32 s46, s90, 1572864
 buffer_load_dwordx4 v32, s[24:27], s46 offen offset:0 lds
 v_mfma_f32_16x16x32_bf16 v[228:231], v[36:39], v[20:23], v[228:231]
 v_mfma_f32_16x16x32_bf16 v[232:235], v[40:43], v[48:51], v[232:235]
 v_mfma_f32_16x16x32_bf16 v[236:239], v[40:43], v[52:55], v[236:239]
 v_add_u32 v4, 114688, v4
 ds_read_b128 v[48:51], v4 offset:0
 ds_read_b128 v[52:55], v4 offset:2048
 ds_read_b64_tr_b16 v[36:37], v7 offset:33024
 ds_read_b64_tr_b16 v[38:39], v7 offset:35072
 v_mfma_f32_16x16x32_bf16 v[240:243], v[40:43], v[56:59], v[240:243]
 buffer_load_dwordx4 v33, s[24:27], s46 offen offset:1024 lds
 v_mfma_f32_16x16x32_bf16 v[244:247], v[40:43], v[12:15], v[244:247]
 ds_read_b128 v[56:59], v4 offset:4096
 ds_read_b128 v[12:15], v4 offset:6144
 v_mfma_f32_16x16x32_bf16 v[248:251], v[40:43], v[16:19], v[248:251]
 v_mfma_f32_16x16x32_bf16 v[252:255], v[40:43], v[20:23], v[252:255]
 ds_read_b128 v[16:19], v4 offset:8192
 ds_read_b128 v[20:23], v4 offset:10240
 s_waitcnt lgkmcnt(7)
 v_mfma_f32_16x16x32_bf16 v[64:67], v[44:47], v[48:51], v[64:67]
 buffer_load_dwordx4 v34, s[24:27], s46 offen offset:2048 lds
 s_waitcnt lgkmcnt(6)
 v_mfma_f32_16x16x32_bf16 v[68:71], v[44:47], v[52:55], v[68:71]
 ds_read_b64_tr_b16 v[40:41], v8 offset:33024
 ds_read_b64_tr_b16 v[42:43], v8 offset:35072
 s_waitcnt lgkmcnt(5)
 v_mfma_f32_16x16x32_bf16 v[72:75], v[44:47], v[56:59], v[72:75]
 s_waitcnt lgkmcnt(4)
 v_mfma_f32_16x16x32_bf16 v[76:79], v[44:47], v[12:15], v[76:79]
 s_waitcnt lgkmcnt(3)
 v_mfma_f32_16x16x32_bf16 v[80:83], v[44:47], v[16:19], v[80:83]
 buffer_load_dwordx4 v35, s[24:27], s46 offen offset:3072 lds
 s_waitcnt lgkmcnt(2)
 v_mfma_f32_16x16x32_bf16 v[84:87], v[44:47], v[20:23], v[84:87]
 v_mfma_f32_16x16x32_bf16 v[88:91], v[36:39], v[48:51], v[88:91]
 v_mfma_f32_16x16x32_bf16 v[92:95], v[36:39], v[52:55], v[92:95]
 ds_read_b64_tr_b16 v[44:45], v9 offset:33024
 ds_read_b64_tr_b16 v[46:47], v9 offset:35072
 v_mfma_f32_16x16x32_bf16 v[96:99], v[36:39], v[56:59], v[96:99]
 s_add_u32 m0, s50, 81920
 s_add_u32 s46, s90, 1573376
 buffer_load_dwordx4 v32, s[24:27], s46 offen offset:0 lds
 v_mfma_f32_16x16x32_bf16 v[100:103], v[36:39], v[12:15], v[100:103]
 v_mfma_f32_16x16x32_bf16 v[104:107], v[36:39], v[16:19], v[104:107]
 v_mfma_f32_16x16x32_bf16 v[108:111], v[36:39], v[20:23], v[108:111]
 s_waitcnt lgkmcnt(2)
 v_mfma_f32_16x16x32_bf16 v[112:115], v[40:43], v[48:51], v[112:115]
 buffer_load_dwordx4 v33, s[24:27], s46 offen offset:1024 lds
 v_mfma_f32_16x16x32_bf16 v[116:119], v[40:43], v[52:55], v[116:119]
 ds_read_b64_tr_b16 v[36:37], v10 offset:33024
 ds_read_b64_tr_b16 v[38:39], v10 offset:35072
 v_mfma_f32_16x16x32_bf16 v[120:123], v[40:43], v[56:59], v[120:123]
 v_mfma_f32_16x16x32_bf16 v[124:127], v[40:43], v[12:15], v[124:127]
 v_mfma_f32_16x16x32_bf16 v[128:131], v[40:43], v[16:19], v[128:131]
 buffer_load_dwordx4 v34, s[24:27], s46 offen offset:2048 lds
 v_mfma_f32_16x16x32_bf16 v[132:135], v[40:43], v[20:23], v[132:135]
 s_waitcnt lgkmcnt(2)
 v_mfma_f32_16x16x32_bf16 v[136:139], v[44:47], v[48:51], v[136:139]
 v_mfma_f32_16x16x32_bf16 v[140:143], v[44:47], v[52:55], v[140:143]
 ds_read_b64_tr_b16 v[40:41], v11 offset:33024
 ds_read_b64_tr_b16 v[42:43], v11 offset:35072
 v_mfma_f32_16x16x32_bf16 v[144:147], v[44:47], v[56:59], v[144:147]
 buffer_load_dwordx4 v35, s[24:27], s46 offen offset:3072 lds
 v_mfma_f32_16x16x32_bf16 v[148:151], v[44:47], v[12:15], v[148:151]
 v_mfma_f32_16x16x32_bf16 v[152:155], v[44:47], v[16:19], v[152:155]
 v_mfma_f32_16x16x32_bf16 v[156:159], v[44:47], v[20:23], v[156:159]
 s_waitcnt lgkmcnt(2)
 v_mfma_f32_16x16x32_bf16 v[160:163], v[36:39], v[48:51], v[160:163]
 v_mfma_f32_16x16x32_bf16 v[164:167], v[36:39], v[52:55], v[164:167]
 ds_read_b64_tr_b16 v[44:45], v60 offset:33024
 ds_read_b64_tr_b16 v[46:47], v60 offset:35072
 v_mfma_f32_16x16x32_bf16 v[168:171], v[36:39], v[56:59], v[168:171]
 v_mfma_f32_16x16x32_bf16 v[172:175], v[36:39], v[12:15], v[172:175]
 v_mfma_f32_16x16x32_bf16 v[176:179], v[36:39], v[16:19], v[176:179]
 v_mfma_f32_16x16x32_bf16 v[180:183], v[36:39], v[20:23], v[180:183]
 s_waitcnt lgkmcnt(2)
 v_mfma_f32_16x16x32_bf16 v[184:187], v[40:43], v[48:51], v[184:187]
 v_mfma_f32_16x16x32_bf16 v[188:191], v[40:43], v[52:55], v[188:191]
 ds_read_b64_tr_b16 v[36:37], v61 offset:33024
 ds_read_b64_tr_b16 v[38:39], v61 offset:35072
 v_mfma_f32_16x16x32_bf16 v[192:195], v[40:43], v[56:59], v[192:195]
 v_mfma_f32_16x16x32_bf16 v[196:199], v[40:43], v[12:15], v[196:199]
 v_mfma_f32_16x16x32_bf16 v[200:203], v[40:43], v[16:19], v[200:203]
 v_mfma_f32_16x16x32_bf16 v[204:207], v[40:43], v[20:23], v[204:207]
 s_waitcnt lgkmcnt(2)
 v_mfma_f32_16x16x32_bf16 v[208:211], v[44:47], v[48:51], v[208:211]
 v_mfma_f32_16x16x32_bf16 v[212:215], v[44:47], v[52:55], v[212:215]
 v_mfma_f32_16x16x32_bf16 v[216:219], v[44:47], v[56:59], v[216:219]
 v_mfma_f32_16x16x32_bf16 v[220:223], v[44:47], v[12:15], v[220:223]
 s_waitcnt vmcnt(8) lgkmcnt(0)
 s_barrier
 ds_read_b64_tr_b16 v[40:41], v6 offset:49408
 ds_read_b64_tr_b16 v[42:43], v6 offset:51456
 v_mfma_f32_16x16x32_bf16 v[224:227], v[44:47], v[16:19], v[224:227]
 s_add_u32 m0, s50, 65536
 s_add_u32 s46, s90, 1835008
 buffer_load_dwordx4 v32, s[24:27], s46 offen offset:0 lds
 v_mfma_f32_16x16x32_bf16 v[228:231], v[44:47], v[20:23], v[228:231]
 v_mfma_f32_16x16x32_bf16 v[232:235], v[36:39], v[48:51], v[232:235]
 v_mfma_f32_16x16x32_bf16 v[236:239], v[36:39], v[52:55], v[236:239]
 v_add_u32 v5, 114688, v5
 ds_read_b128 v[48:51], v5 offset:0
 ds_read_b128 v[52:55], v5 offset:2048
 ds_read_b64_tr_b16 v[44:45], v7 offset:49408
 ds_read_b64_tr_b16 v[46:47], v7 offset:51456
 v_mfma_f32_16x16x32_bf16 v[240:243], v[36:39], v[56:59], v[240:243]
 buffer_load_dwordx4 v33, s[24:27], s46 offen offset:1024 lds
 v_mfma_f32_16x16x32_bf16 v[244:247], v[36:39], v[12:15], v[244:247]
 ds_read_b128 v[56:59], v5 offset:4096
 ds_read_b128 v[12:15], v5 offset:6144
 v_mfma_f32_16x16x32_bf16 v[248:251], v[36:39], v[16:19], v[248:251]
 v_mfma_f32_16x16x32_bf16 v[252:255], v[36:39], v[20:23], v[252:255]
 ds_read_b128 v[16:19], v5 offset:8192
 ds_read_b128 v[20:23], v5 offset:10240
 s_waitcnt lgkmcnt(7)
 v_mfma_f32_16x16x32_bf16 v[64:67], v[40:43], v[48:51], v[64:67]
 buffer_load_dwordx4 v34, s[24:27], s46 offen offset:2048 lds
 s_waitcnt lgkmcnt(6)
 v_mfma_f32_16x16x32_bf16 v[68:71], v[40:43], v[52:55], v[68:71]
 ds_read_b64_tr_b16 v[36:37], v8 offset:49408
 ds_read_b64_tr_b16 v[38:39], v8 offset:51456
 s_waitcnt lgkmcnt(5)
 v_mfma_f32_16x16x32_bf16 v[72:75], v[40:43], v[56:59], v[72:75]
 s_waitcnt lgkmcnt(4)
 v_mfma_f32_16x16x32_bf16 v[76:79], v[40:43], v[12:15], v[76:79]
 s_waitcnt lgkmcnt(3)
 v_mfma_f32_16x16x32_bf16 v[80:83], v[40:43], v[16:19], v[80:83]
 buffer_load_dwordx4 v35, s[24:27], s46 offen offset:3072 lds
 s_waitcnt lgkmcnt(2)
 v_mfma_f32_16x16x32_bf16 v[84:87], v[40:43], v[20:23], v[84:87]
 v_mfma_f32_16x16x32_bf16 v[88:91], v[44:47], v[48:51], v[88:91]
 v_mfma_f32_16x16x32_bf16 v[92:95], v[44:47], v[52:55], v[92:95]
 ds_read_b64_tr_b16 v[40:41], v9 offset:49408
 ds_read_b64_tr_b16 v[42:43], v9 offset:51456
 v_mfma_f32_16x16x32_bf16 v[96:99], v[44:47], v[56:59], v[96:99]
 s_add_u32 m0, s50, 114688
 s_add_u32 s46, s90, 1835520
 buffer_load_dwordx4 v32, s[24:27], s46 offen offset:0 lds
 v_mfma_f32_16x16x32_bf16 v[100:103], v[44:47], v[12:15], v[100:103]
 v_mfma_f32_16x16x32_bf16 v[104:107], v[44:47], v[16:19], v[104:107]
 v_mfma_f32_16x16x32_bf16 v[108:111], v[44:47], v[20:23], v[108:111]
 s_waitcnt lgkmcnt(2)
 v_mfma_f32_16x16x32_bf16 v[112:115], v[36:39], v[48:51], v[112:115]
 buffer_load_dwordx4 v33, s[24:27], s46 offen offset:1024 lds
 v_mfma_f32_16x16x32_bf16 v[116:119], v[36:39], v[52:55], v[116:119]
 ds_read_b64_tr_b16 v[44:45], v10 offset:49408
 ds_read_b64_tr_b16 v[46:47], v10 offset:51456
 v_mfma_f32_16x16x32_bf16 v[120:123], v[36:39], v[56:59], v[120:123]
 v_mfma_f32_16x16x32_bf16 v[124:127], v[36:39], v[12:15], v[124:127]
 v_mfma_f32_16x16x32_bf16 v[128:131], v[36:39], v[16:19], v[128:131]
 buffer_load_dwordx4 v34, s[24:27], s46 offen offset:2048 lds
 v_mfma_f32_16x16x32_bf16 v[132:135], v[36:39], v[20:23], v[132:135]
 s_waitcnt lgkmcnt(2)
 v_mfma_f32_16x16x32_bf16 v[136:139], v[40:43], v[48:51], v[136:139]
 v_mfma_f32_16x16x32_bf16 v[140:143], v[40:43], v[52:55], v[140:143]
 ds_read_b64_tr_b16 v[36:37], v11 offset:49408
 ds_read_b64_tr_b16 v[38:39], v11 offset:51456
 v_mfma_f32_16x16x32_bf16 v[144:147], v[40:43], v[56:59], v[144:147]
 buffer_load_dwordx4 v35, s[24:27], s46 offen offset:3072 lds
 v_mfma_f32_16x16x32_bf16 v[148:151], v[40:43], v[12:15], v[148:151]
 v_mfma_f32_16x16x32_bf16 v[152:155], v[40:43], v[16:19], v[152:155]
 v_mfma_f32_16x16x32_bf16 v[156:159], v[40:43], v[20:23], v[156:159]
 s_waitcnt lgkmcnt(2)
 v_mfma_f32_16x16x32_bf16 v[160:163], v[44:47], v[48:51], v[160:163]
 v_mfma_f32_16x16x32_bf16 v[164:167], v[44:47], v[52:55], v[164:167]
 ds_read_b64_tr_b16 v[40:41], v60 offset:49408
 ds_read_b64_tr_b16 v[42:43], v60 offset:51456
 v_mfma_f32_16x16x32_bf16 v[168:171], v[44:47], v[56:59], v[168:171]
 v_mfma_f32_16x16x32_bf16 v[172:175], v[44:47], v[12:15], v[172:175]
 v_mfma_f32_16x16x32_bf16 v[176:179], v[44:47], v[16:19], v[176:179]
 v_mfma_f32_16x16x32_bf16 v[180:183], v[44:47], v[20:23], v[180:183]
 s_waitcnt lgkmcnt(2)
 v_mfma_f32_16x16x32_bf16 v[184:187], v[36:39], v[48:51], v[184:187]
 v_mfma_f32_16x16x32_bf16 v[188:191], v[36:39], v[52:55], v[188:191]
 ds_read_b64_tr_b16 v[44:45], v61 offset:49408
 ds_read_b64_tr_b16 v[46:47], v61 offset:51456
 v_mfma_f32_16x16x32_bf16 v[192:195], v[36:39], v[56:59], v[192:195]
 v_mfma_f32_16x16x32_bf16 v[196:199], v[36:39], v[12:15], v[196:199]
 v_mfma_f32_16x16x32_bf16 v[200:203], v[36:39], v[16:19], v[200:203]
 v_mfma_f32_16x16x32_bf16 v[204:207], v[36:39], v[20:23], v[204:207]
 s_waitcnt lgkmcnt(2)
 v_mfma_f32_16x16x32_bf16 v[208:211], v[40:43], v[48:51], v[208:211]
 v_mfma_f32_16x16x32_bf16 v[212:215], v[40:43], v[52:55], v[212:215]
 v_mfma_f32_16x16x32_bf16 v[216:219], v[40:43], v[56:59], v[216:219]
 v_mfma_f32_16x16x32_bf16 v[220:223], v[40:43], v[12:15], v[220:223]
 s_waitcnt vmcnt(8) lgkmcnt(0)
 s_barrier
 ds_read_b64_tr_b16 v[36:37], v6 offset:256
 ds_read_b64_tr_b16 v[38:39], v6 offset:2304
 v_mfma_f32_16x16x32_bf16 v[224:227], v[40:43], v[16:19], v[224:227]
 s_add_u32 m0, s50, 98304
 s_add_u32 s46, s90, 2097152
 buffer_load_dwordx4 v32, s[24:27], s46 offen offset:0 lds
 v_mfma_f32_16x16x32_bf16 v[228:231], v[40:43], v[20:23], v[228:231]
 v_mfma_f32_16x16x32_bf16 v[232:235], v[44:47], v[48:51], v[232:235]
 v_mfma_f32_16x16x32_bf16 v[236:239], v[44:47], v[52:55], v[236:239]
 v_add_u32 v4, 4294852608, v4
 ds_read_b128 v[48:51], v4 offset:0
 ds_read_b128 v[52:55], v4 offset:2048
 ds_read_b64_tr_b16 v[40:41], v7 offset:256
 ds_read_b64_tr_b16 v[42:43], v7 offset:2304
 v_mfma_f32_16x16x32_bf16 v[240:243], v[44:47], v[56:59], v[240:243]
 buffer_load_dwordx4 v33, s[24:27], s46 offen offset:1024 lds
 v_mfma_f32_16x16x32_bf16 v[244:247], v[44:47], v[12:15], v[244:247]
 ds_read_b128 v[56:59], v4 offset:4096
 ds_read_b128 v[12:15], v4 offset:6144
 v_mfma_f32_16x16x32_bf16 v[248:251], v[44:47], v[16:19], v[248:251]
 v_mfma_f32_16x16x32_bf16 v[252:255], v[44:47], v[20:23], v[252:255]
 ds_read_b128 v[16:19], v4 offset:8192
 ds_read_b128 v[20:23], v4 offset:10240
 s_waitcnt lgkmcnt(7)
 v_mfma_f32_16x16x32_bf16 v[64:67], v[36:39], v[48:51], v[64:67]
 buffer_load_dwordx4 v34, s[24:27], s46 offen offset:2048 lds
 s_waitcnt lgkmcnt(6)
 v_mfma_f32_16x16x32_bf16 v[68:71], v[36:39], v[52:55], v[68:71]
 ds_read_b64_tr_b16 v[44:45], v8 offset:256
 ds_read_b64_tr_b16 v[46:47], v8 offset:2304
 s_waitcnt lgkmcnt(5)
 v_mfma_f32_16x16x32_bf16 v[72:75], v[36:39], v[56:59], v[72:75]
 s_waitcnt lgkmcnt(4)
 v_mfma_f32_16x16x32_bf16 v[76:79], v[36:39], v[12:15], v[76:79]
 s_waitcnt lgkmcnt(3)
 v_mfma_f32_16x16x32_bf16 v[80:83], v[36:39], v[16:19], v[80:83]
 buffer_load_dwordx4 v35, s[24:27], s46 offen offset:3072 lds
 s_waitcnt lgkmcnt(2)
 v_mfma_f32_16x16x32_bf16 v[84:87], v[36:39], v[20:23], v[84:87]
 v_mfma_f32_16x16x32_bf16 v[88:91], v[40:43], v[48:51], v[88:91]
 v_mfma_f32_16x16x32_bf16 v[92:95], v[40:43], v[52:55], v[92:95]
 ds_read_b64_tr_b16 v[36:37], v9 offset:256
 ds_read_b64_tr_b16 v[38:39], v9 offset:2304
 v_mfma_f32_16x16x32_bf16 v[96:99], v[40:43], v[56:59], v[96:99]
 s_add_u32 m0, s50, 131072
 s_add_u32 s46, s90, 2097664
 buffer_load_dwordx4 v32, s[24:27], s46 offen offset:0 lds
 v_mfma_f32_16x16x32_bf16 v[100:103], v[40:43], v[12:15], v[100:103]
 v_mfma_f32_16x16x32_bf16 v[104:107], v[40:43], v[16:19], v[104:107]
 v_mfma_f32_16x16x32_bf16 v[108:111], v[40:43], v[20:23], v[108:111]
 s_waitcnt lgkmcnt(2)
 v_mfma_f32_16x16x32_bf16 v[112:115], v[44:47], v[48:51], v[112:115]
 buffer_load_dwordx4 v33, s[24:27], s46 offen offset:1024 lds
 v_mfma_f32_16x16x32_bf16 v[116:119], v[44:47], v[52:55], v[116:119]
 ds_read_b64_tr_b16 v[40:41], v10 offset:256
 ds_read_b64_tr_b16 v[42:43], v10 offset:2304
 v_mfma_f32_16x16x32_bf16 v[120:123], v[44:47], v[56:59], v[120:123]
 v_mfma_f32_16x16x32_bf16 v[124:127], v[44:47], v[12:15], v[124:127]
 v_mfma_f32_16x16x32_bf16 v[128:131], v[44:47], v[16:19], v[128:131]
 buffer_load_dwordx4 v34, s[24:27], s46 offen offset:2048 lds
 v_mfma_f32_16x16x32_bf16 v[132:135], v[44:47], v[20:23], v[132:135]
 s_waitcnt lgkmcnt(2)
 v_mfma_f32_16x16x32_bf16 v[136:139], v[36:39], v[48:51], v[136:139]
 v_mfma_f32_16x16x32_bf16 v[140:143], v[36:39], v[52:55], v[140:143]
 ds_read_b64_tr_b16 v[44:45], v11 offset:256
 ds_read_b64_tr_b16 v[46:47], v11 offset:2304
 v_mfma_f32_16x16x32_bf16 v[144:147], v[36:39], v[56:59], v[144:147]
 buffer_load_dwordx4 v35, s[24:27], s46 offen offset:3072 lds
 v_mfma_f32_16x16x32_bf16 v[148:151], v[36:39], v[12:15], v[148:151]
 v_mfma_f32_16x16x32_bf16 v[152:155], v[36:39], v[16:19], v[152:155]
 v_mfma_f32_16x16x32_bf16 v[156:159], v[36:39], v[20:23], v[156:159]
 s_waitcnt lgkmcnt(2)
 v_mfma_f32_16x16x32_bf16 v[160:163], v[40:43], v[48:51], v[160:163]
 v_mfma_f32_16x16x32_bf16 v[164:167], v[40:43], v[52:55], v[164:167]
 ds_read_b64_tr_b16 v[36:37], v60 offset:256
 ds_read_b64_tr_b16 v[38:39], v60 offset:2304
 v_mfma_f32_16x16x32_bf16 v[168:171], v[40:43], v[56:59], v[168:171]
 v_mfma_f32_16x16x32_bf16 v[172:175], v[40:43], v[12:15], v[172:175]
 v_mfma_f32_16x16x32_bf16 v[176:179], v[40:43], v[16:19], v[176:179]
 v_mfma_f32_16x16x32_bf16 v[180:183], v[40:43], v[20:23], v[180:183]
 s_waitcnt lgkmcnt(2)
 v_mfma_f32_16x16x32_bf16 v[184:187], v[44:47], v[48:51], v[184:187]
 v_mfma_f32_16x16x32_bf16 v[188:191], v[44:47], v[52:55], v[188:191]
 ds_read_b64_tr_b16 v[40:41], v61 offset:256
 ds_read_b64_tr_b16 v[42:43], v61 offset:2304
 v_mfma_f32_16x16x32_bf16 v[192:195], v[44:47], v[56:59], v[192:195]
 v_mfma_f32_16x16x32_bf16 v[196:199], v[44:47], v[12:15], v[196:199]
 v_mfma_f32_16x16x32_bf16 v[200:203], v[44:47], v[16:19], v[200:203]
 v_mfma_f32_16x16x32_bf16 v[204:207], v[44:47], v[20:23], v[204:207]
 s_waitcnt lgkmcnt(2)
 v_mfma_f32_16x16x32_bf16 v[208:211], v[36:39], v[48:51], v[208:211]
 v_mfma_f32_16x16x32_bf16 v[212:215], v[36:39], v[52:55], v[212:215]
 v_mfma_f32_16x16x32_bf16 v[216:219], v[36:39], v[56:59], v[216:219]
 v_mfma_f32_16x16x32_bf16 v[220:223], v[36:39], v[12:15], v[220:223]
 s_waitcnt vmcnt(8) lgkmcnt(0)
 s_barrier
 ds_read_b64_tr_b16 v[44:45], v6 offset:33024
 ds_read_b64_tr_b16 v[46:47], v6 offset:35072
 v_mfma_f32_16x16x32_bf16 v[224:227], v[36:39], v[16:19], v[224:227]
 s_add_u32 m0, s50, 49152
 s_add_u32 s46, s90, 2359296
 buffer_load_dwordx4 v32, s[24:27], s46 offen offset:0 lds
 v_mfma_f32_16x16x32_bf16 v[228:231], v[36:39], v[20:23], v[228:231]
 v_mfma_f32_16x16x32_bf16 v[232:235], v[40:43], v[48:51], v[232:235]
 v_mfma_f32_16x16x32_bf16 v[236:239], v[40:43], v[52:55], v[236:239]
 v_add_u32 v5, 4294852608, v5
 ds_read_b128 v[48:51], v5 offset:0
 ds_read_b128 v[52:55], v5 offset:2048
 ds_read_b64_tr_b16 v[36:37], v7 offset:33024
 ds_read_b64_tr_b16 v[38:39], v7 offset:35072
 v_mfma_f32_16x16x32_bf16 v[240:243], v[40:43], v[56:59], v[240:243]
 buffer_load_dwordx4 v33, s[24:27], s46 offen offset:1024 lds
 v_mfma_f32_16x16x32_bf16 v[244:247], v[40:43], v[12:15], v[244:247]
 ds_read_b128 v[56:59], v5 offset:4096
 ds_read_b128 v[12:15], v5 offset:6144
 v_mfma_f32_16x16x32_bf16 v[248:251], v[40:43], v[16:19], v[248:251]
 v_mfma_f32_16x16x32_bf16 v[252:255], v[40:43], v[20:23], v[252:255]
 ds_read_b128 v[16:19], v5 offset:8192
 ds_read_b128 v[20:23], v5 offset:10240
 s_waitcnt lgkmcnt(7)
 v_mfma_f32_16x16x32_bf16 v[64:67], v[44:47], v[48:51], v[64:67]
 buffer_load_dwordx4 v34, s[24:27], s46 offen offset:2048 lds
 s_waitcnt lgkmcnt(6)
 v_mfma_f32_16x16x32_bf16 v[68:71], v[44:47], v[52:55], v[68:71]
 ds_read_b64_tr_b16 v[40:41], v8 offset:33024
 ds_read_b64_tr_b16 v[42:43], v8 offset:35072
 s_waitcnt lgkmcnt(5)
 v_mfma_f32_16x16x32_bf16 v[72:75], v[44:47], v[56:59], v[72:75]
 s_waitcnt lgkmcnt(4)
 v_mfma_f32_16x16x32_bf16 v[76:79], v[44:47], v[12:15], v[76:79]
 s_waitcnt lgkmcnt(3)
 v_mfma_f32_16x16x32_bf16 v[80:83], v[44:47], v[16:19], v[80:83]
 buffer_load_dwordx4 v35, s[24:27], s46 offen offset:3072 lds
 s_waitcnt lgkmcnt(2)
 v_mfma_f32_16x16x32_bf16 v[84:87], v[44:47], v[20:23], v[84:87]
 v_mfma_f32_16x16x32_bf16 v[88:91], v[36:39], v[48:51], v[88:91]
 v_mfma_f32_16x16x32_bf16 v[92:95], v[36:39], v[52:55], v[92:95]
 ds_read_b64_tr_b16 v[44:45], v9 offset:33024
 ds_read_b64_tr_b16 v[46:47], v9 offset:35072
 v_mfma_f32_16x16x32_bf16 v[96:99], v[36:39], v[56:59], v[96:99]
 s_add_u32 m0, s50, 81920
 s_add_u32 s46, s90, 2359808
 buffer_load_dwordx4 v32, s[24:27], s46 offen offset:0 lds
 v_mfma_f32_16x16x32_bf16 v[100:103], v[36:39], v[12:15], v[100:103]
 v_mfma_f32_16x16x32_bf16 v[104:107], v[36:39], v[16:19], v[104:107]
 v_mfma_f32_16x16x32_bf16 v[108:111], v[36:39], v[20:23], v[108:111]
 s_waitcnt lgkmcnt(2)
 v_mfma_f32_16x16x32_bf16 v[112:115], v[40:43], v[48:51], v[112:115]
 buffer_load_dwordx4 v33, s[24:27], s46 offen offset:1024 lds
 v_mfma_f32_16x16x32_bf16 v[116:119], v[40:43], v[52:55], v[116:119]
 ds_read_b64_tr_b16 v[36:37], v10 offset:33024
 ds_read_b64_tr_b16 v[38:39], v10 offset:35072
 v_mfma_f32_16x16x32_bf16 v[120:123], v[40:43], v[56:59], v[120:123]
 v_mfma_f32_16x16x32_bf16 v[124:127], v[40:43], v[12:15], v[124:127]
 v_mfma_f32_16x16x32_bf16 v[128:131], v[40:43], v[16:19], v[128:131]
 buffer_load_dwordx4 v34, s[24:27], s46 offen offset:2048 lds
 v_mfma_f32_16x16x32_bf16 v[132:135], v[40:43], v[20:23], v[132:135]
 s_waitcnt lgkmcnt(2)
 v_mfma_f32_16x16x32_bf16 v[136:139], v[44:47], v[48:51], v[136:139]
 v_mfma_f32_16x16x32_bf16 v[140:143], v[44:47], v[52:55], v[140:143]
 ds_read_b64_tr_b16 v[40:41], v11 offset:33024
 ds_read_b64_tr_b16 v[42:43], v11 offset:35072
 v_mfma_f32_16x16x32_bf16 v[144:147], v[44:47], v[56:59], v[144:147]
 buffer_load_dwordx4 v35, s[24:27], s46 offen offset:3072 lds
 v_mfma_f32_16x16x32_bf16 v[148:151], v[44:47], v[12:15], v[148:151]
 v_mfma_f32_16x16x32_bf16 v[152:155], v[44:47], v[16:19], v[152:155]
 v_mfma_f32_16x16x32_bf16 v[156:159], v[44:47], v[20:23], v[156:159]
 s_waitcnt lgkmcnt(2)
 v_mfma_f32_16x16x32_bf16 v[160:163], v[36:39], v[48:51], v[160:163]
 v_mfma_f32_16x16x32_bf16 v[164:167], v[36:39], v[52:55], v[164:167]
 ds_read_b64_tr_b16 v[44:45], v60 offset:33024
 ds_read_b64_tr_b16 v[46:47], v60 offset:35072
 v_mfma_f32_16x16x32_bf16 v[168:171], v[36:39], v[56:59], v[168:171]
 v_mfma_f32_16x16x32_bf16 v[172:175], v[36:39], v[12:15], v[172:175]
 v_mfma_f32_16x16x32_bf16 v[176:179], v[36:39], v[16:19], v[176:179]
 v_mfma_f32_16x16x32_bf16 v[180:183], v[36:39], v[20:23], v[180:183]
 s_waitcnt lgkmcnt(2)
 v_mfma_f32_16x16x32_bf16 v[184:187], v[40:43], v[48:51], v[184:187]
 v_mfma_f32_16x16x32_bf16 v[188:191], v[40:43], v[52:55], v[188:191]
 ds_read_b64_tr_b16 v[36:37], v61 offset:33024
 ds_read_b64_tr_b16 v[38:39], v61 offset:35072
 v_mfma_f32_16x16x32_bf16 v[192:195], v[40:43], v[56:59], v[192:195]
 v_mfma_f32_16x16x32_bf16 v[196:199], v[40:43], v[12:15], v[196:199]
 v_mfma_f32_16x16x32_bf16 v[200:203], v[40:43], v[16:19], v[200:203]
 v_mfma_f32_16x16x32_bf16 v[204:207], v[40:43], v[20:23], v[204:207]
 s_waitcnt lgkmcnt(2)
 v_mfma_f32_16x16x32_bf16 v[208:211], v[44:47], v[48:51], v[208:211]
 v_mfma_f32_16x16x32_bf16 v[212:215], v[44:47], v[52:55], v[212:215]
 v_mfma_f32_16x16x32_bf16 v[216:219], v[44:47], v[56:59], v[216:219]
 v_mfma_f32_16x16x32_bf16 v[220:223], v[44:47], v[12:15], v[220:223]
 s_waitcnt vmcnt(8) lgkmcnt(0)
 s_barrier
 ds_read_b64_tr_b16 v[40:41], v6 offset:49408
 ds_read_b64_tr_b16 v[42:43], v6 offset:51456
 v_mfma_f32_16x16x32_bf16 v[224:227], v[44:47], v[16:19], v[224:227]
 s_add_u32 m0, s50, 65536
 s_add_u32 s46, s90, 2621440
 buffer_load_dwordx4 v32, s[24:27], s46 offen offset:0 lds
 v_mfma_f32_16x16x32_bf16 v[228:231], v[44:47], v[20:23], v[228:231]
 v_mfma_f32_16x16x32_bf16 v[232:235], v[36:39], v[48:51], v[232:235]
 v_mfma_f32_16x16x32_bf16 v[236:239], v[36:39], v[52:55], v[236:239]
 v_add_u32 v4, 114688, v4
 ds_read_b128 v[48:51], v4 offset:0
 ds_read_b128 v[52:55], v4 offset:2048
 ds_read_b64_tr_b16 v[44:45], v7 offset:49408
 ds_read_b64_tr_b16 v[46:47], v7 offset:51456
 v_mfma_f32_16x16x32_bf16 v[240:243], v[36:39], v[56:59], v[240:243]
 buffer_load_dwordx4 v33, s[24:27], s46 offen offset:1024 lds
 v_mfma_f32_16x16x32_bf16 v[244:247], v[36:39], v[12:15], v[244:247]
 ds_read_b128 v[56:59], v4 offset:4096
 ds_read_b128 v[12:15], v4 offset:6144
 v_mfma_f32_16x16x32_bf16 v[248:251], v[36:39], v[16:19], v[248:251]
 v_mfma_f32_16x16x32_bf16 v[252:255], v[36:39], v[20:23], v[252:255]
 ds_read_b128 v[16:19], v4 offset:8192
 ds_read_b128 v[20:23], v4 offset:10240
 s_waitcnt lgkmcnt(7)
 v_mfma_f32_16x16x32_bf16 v[64:67], v[40:43], v[48:51], v[64:67]
 buffer_load_dwordx4 v34, s[24:27], s46 offen offset:2048 lds
 s_waitcnt lgkmcnt(6)
 v_mfma_f32_16x16x32_bf16 v[68:71], v[40:43], v[52:55], v[68:71]
 ds_read_b64_tr_b16 v[36:37], v8 offset:49408
 ds_read_b64_tr_b16 v[38:39], v8 offset:51456
 s_waitcnt lgkmcnt(5)
 v_mfma_f32_16x16x32_bf16 v[72:75], v[40:43], v[56:59], v[72:75]
 s_waitcnt lgkmcnt(4)
 v_mfma_f32_16x16x32_bf16 v[76:79], v[40:43], v[12:15], v[76:79]
 s_waitcnt lgkmcnt(3)
 v_mfma_f32_16x16x32_bf16 v[80:83], v[40:43], v[16:19], v[80:83]
 buffer_load_dwordx4 v35, s[24:27], s46 offen offset:3072 lds
 s_waitcnt lgkmcnt(2)
 v_mfma_f32_16x16x32_bf16 v[84:87], v[40:43], v[20:23], v[84:87]
 v_mfma_f32_16x16x32_bf16 v[88:91], v[44:47], v[48:51], v[88:91]
 v_mfma_f32_16x16x32_bf16 v[92:95], v[44:47], v[52:55], v[92:95]
 ds_read_b64_tr_b16 v[40:41], v9 offset:49408
 ds_read_b64_tr_b16 v[42:43], v9 offset:51456
 v_mfma_f32_16x16x32_bf16 v[96:99], v[44:47], v[56:59], v[96:99]
 s_add_u32 m0, s50, 114688
 s_add_u32 s46, s90, 2621952
 buffer_load_dwordx4 v32, s[24:27], s46 offen offset:0 lds
 v_mfma_f32_16x16x32_bf16 v[100:103], v[44:47], v[12:15], v[100:103]
 v_mfma_f32_16x16x32_bf16 v[104:107], v[44:47], v[16:19], v[104:107]
 v_mfma_f32_16x16x32_bf16 v[108:111], v[44:47], v[20:23], v[108:111]
 s_waitcnt lgkmcnt(2)
 v_mfma_f32_16x16x32_bf16 v[112:115], v[36:39], v[48:51], v[112:115]
 buffer_load_dwordx4 v33, s[24:27], s46 offen offset:1024 lds
 v_mfma_f32_16x16x32_bf16 v[116:119], v[36:39], v[52:55], v[116:119]
 ds_read_b64_tr_b16 v[44:45], v10 offset:49408
 ds_read_b64_tr_b16 v[46:47], v10 offset:51456
 v_mfma_f32_16x16x32_bf16 v[120:123], v[36:39], v[56:59], v[120:123]
 v_mfma_f32_16x16x32_bf16 v[124:127], v[36:39], v[12:15], v[124:127]
 v_mfma_f32_16x16x32_bf16 v[128:131], v[36:39], v[16:19], v[128:131]
 buffer_load_dwordx4 v34, s[24:27], s46 offen offset:2048 lds
 v_mfma_f32_16x16x32_bf16 v[132:135], v[36:39], v[20:23], v[132:135]
 s_waitcnt lgkmcnt(2)
 v_mfma_f32_16x16x32_bf16 v[136:139], v[40:43], v[48:51], v[136:139]
 v_mfma_f32_16x16x32_bf16 v[140:143], v[40:43], v[52:55], v[140:143]
 ds_read_b64_tr_b16 v[36:37], v11 offset:49408
 ds_read_b64_tr_b16 v[38:39], v11 offset:51456
 v_mfma_f32_16x16x32_bf16 v[144:147], v[40:43], v[56:59], v[144:147]
 buffer_load_dwordx4 v35, s[24:27], s46 offen offset:3072 lds
 v_mfma_f32_16x16x32_bf16 v[148:151], v[40:43], v[12:15], v[148:151]
 v_mfma_f32_16x16x32_bf16 v[152:155], v[40:43], v[16:19], v[152:155]
 v_mfma_f32_16x16x32_bf16 v[156:159], v[40:43], v[20:23], v[156:159]
 s_waitcnt lgkmcnt(2)
 v_mfma_f32_16x16x32_bf16 v[160:163], v[44:47], v[48:51], v[160:163]
 s_add_u32 s46, s45, 0
 buffer_load_dword v30, v29, s[28:31], s46 offen
 v_mfma_f32_16x16x32_bf16 v[164:167], v[44:47], v[52:55], v[164:167]
 ds_read_b64_tr_b16 v[40:41], v60 offset:49408
 ds_read_b64_tr_b16 v[42:43], v60 offset:51456
 v_mfma_f32_16x16x32_bf16 v[168:171], v[44:47], v[56:59], v[168:171]
 v_mfma_f32_16x16x32_bf16 v[172:175], v[44:47], v[12:15], v[172:175]
 v_mfma_f32_16x16x32_bf16 v[176:179], v[44:47], v[16:19], v[176:179]
 s_add_u32 s46, s45, 4608
 buffer_load_dword v30, v29, s[28:31], s46 offen
 v_mfma_f32_16x16x32_bf16 v[180:183], v[44:47], v[20:23], v[180:183]
 s_waitcnt lgkmcnt(2)
 v_mfma_f32_16x16x32_bf16 v[184:187], v[36:39], v[48:51], v[184:187]
 v_mfma_f32_16x16x32_bf16 v[188:191], v[36:39], v[52:55], v[188:191]
 ds_read_b64_tr_b16 v[44:45], v61 offset:49408
 ds_read_b64_tr_b16 v[46:47], v61 offset:51456
 v_mfma_f32_16x16x32_bf16 v[192:195], v[36:39], v[56:59], v[192:195]
 v_mfma_f32_16x16x32_bf16 v[196:199], v[36:39], v[12:15], v[196:199]
 v_mfma_f32_16x16x32_bf16 v[200:203], v[36:39], v[16:19], v[200:203]
 v_mfma_f32_16x16x32_bf16 v[204:207], v[36:39], v[20:23], v[204:207]
 s_waitcnt lgkmcnt(2)
 v_mfma_f32_16x16x32_bf16 v[208:211], v[40:43], v[48:51], v[208:211]
 v_mfma_f32_16x16x32_bf16 v[212:215], v[40:43], v[52:55], v[212:215]
 v_mfma_f32_16x16x32_bf16 v[216:219], v[40:43], v[56:59], v[216:219]
 v_mfma_f32_16x16x32_bf16 v[220:223], v[40:43], v[12:15], v[220:223]
 s_waitcnt vmcnt(10) lgkmcnt(0)
 s_barrier
 ds_read_b64_tr_b16 v[36:37], v6 offset:256
 ds_read_b64_tr_b16 v[38:39], v6 offset:2304
 v_mfma_f32_16x16x32_bf16 v[224:227], v[40:43], v[16:19], v[224:227]
 s_add_u32 m0, s50, 98304
 s_add_u32 s46, s90, 2883584
 buffer_load_dwordx4 v32, s[24:27], s46 offen offset:0 lds
 v_mfma_f32_16x16x32_bf16 v[228:231], v[40:43], v[20:23], v[228:231]
 v_mfma_f32_16x16x32_bf16 v[232:235], v[44:47], v[48:51], v[232:235]
 v_mfma_f32_16x16x32_bf16 v[236:239], v[44:47], v[52:55], v[236:239]
 v_add_u32 v5, 114688, v5
 ds_read_b128 v[48:51], v5 offset:0
 ds_read_b128 v[52:55], v5 offset:2048
 ds_read_b64_tr_b16 v[40:41], v7 offset:256
 ds_read_b64_tr_b16 v[42:43], v7 offset:2304
 v_mfma_f32_16x16x32_bf16 v[240:243], v[44:47], v[56:59], v[240:243]
 buffer_load_dwordx4 v33, s[24:27], s46 offen offset:1024 lds
 v_mfma_f32_16x16x32_bf16 v[244:247], v[44:47], v[12:15], v[244:247]
 ds_read_b128 v[56:59], v5 offset:4096
 ds_read_b128 v[12:15], v5 offset:6144
 v_mfma_f32_16x16x32_bf16 v[248:251], v[44:47], v[16:19], v[248:251]
 v_mfma_f32_16x16x32_bf16 v[252:255], v[44:47], v[20:23], v[252:255]
 ds_read_b128 v[16:19], v5 offset:8192
 ds_read_b128 v[20:23], v5 offset:10240
 s_waitcnt lgkmcnt(7)
 v_mfma_f32_16x16x32_bf16 v[64:67], v[36:39], v[48:51], v[64:67]
 buffer_load_dwordx4 v34, s[24:27], s46 offen offset:2048 lds
 s_waitcnt lgkmcnt(6)
 v_mfma_f32_16x16x32_bf16 v[68:71], v[36:39], v[52:55], v[68:71]
 ds_read_b64_tr_b16 v[44:45], v8 offset:256
 ds_read_b64_tr_b16 v[46:47], v8 offset:2304
 s_waitcnt lgkmcnt(5)
 v_mfma_f32_16x16x32_bf16 v[72:75], v[36:39], v[56:59], v[72:75]
 s_waitcnt lgkmcnt(4)
 v_mfma_f32_16x16x32_bf16 v[76:79], v[36:39], v[12:15], v[76:79]
 s_waitcnt lgkmcnt(3)
 v_mfma_f32_16x16x32_bf16 v[80:83], v[36:39], v[16:19], v[80:83]
 buffer_load_dwordx4 v35, s[24:27], s46 offen offset:3072 lds
 s_waitcnt lgkmcnt(2)
 v_mfma_f32_16x16x32_bf16 v[84:87], v[36:39], v[20:23], v[84:87]
 v_mfma_f32_16x16x32_bf16 v[88:91], v[40:43], v[48:51], v[88:91]
 v_mfma_f32_16x16x32_bf16 v[92:95], v[40:43], v[52:55], v[92:95]
 ds_read_b64_tr_b16 v[36:37], v9 offset:256
 ds_read_b64_tr_b16 v[38:39], v9 offset:2304
 v_mfma_f32_16x16x32_bf16 v[96:99], v[40:43], v[56:59], v[96:99]
 s_add_u32 m0, s50, 131072
 s_add_u32 s46, s90, 2884096
 buffer_load_dwordx4 v32, s[24:27], s46 offen offset:0 lds
 v_mfma_f32_16x16x32_bf16 v[100:103], v[40:43], v[12:15], v[100:103]
 v_mfma_f32_16x16x32_bf16 v[104:107], v[40:43], v[16:19], v[104:107]
 v_mfma_f32_16x16x32_bf16 v[108:111], v[40:43], v[20:23], v[108:111]
 s_waitcnt lgkmcnt(2)
 v_mfma_f32_16x16x32_bf16 v[112:115], v[44:47], v[48:51], v[112:115]
 buffer_load_dwordx4 v33, s[24:27], s46 offen offset:1024 lds
 v_mfma_f32_16x16x32_bf16 v[116:119], v[44:47], v[52:55], v[116:119]
 ds_read_b64_tr_b16 v[40:41], v10 offset:256
 ds_read_b64_tr_b16 v[42:43], v10 offset:2304
 v_mfma_f32_16x16x32_bf16 v[120:123], v[44:47], v[56:59], v[120:123]
 v_mfma_f32_16x16x32_bf16 v[124:127], v[44:47], v[12:15], v[124:127]
 v_mfma_f32_16x16x32_bf16 v[128:131], v[44:47], v[16:19], v[128:131]
 buffer_load_dwordx4 v34, s[24:27], s46 offen offset:2048 lds
 v_mfma_f32_16x16x32_bf16 v[132:135], v[44:47], v[20:23], v[132:135]
 s_waitcnt lgkmcnt(2)
 v_mfma_f32_16x16x32_bf16 v[136:139], v[36:39], v[48:51], v[136:139]
 v_mfma_f32_16x16x32_bf16 v[140:143], v[36:39], v[52:55], v[140:143]
 ds_read_b64_tr_b16 v[44:45], v11 offset:256
 ds_read_b64_tr_b16 v[46:47], v11 offset:2304
 v_mfma_f32_16x16x32_bf16 v[144:147], v[36:39], v[56:59], v[144:147]
 buffer_load_dwordx4 v35, s[24:27], s46 offen offset:3072 lds
 v_mfma_f32_16x16x32_bf16 v[148:151], v[36:39], v[12:15], v[148:151]
 v_mfma_f32_16x16x32_bf16 v[152:155], v[36:39], v[16:19], v[152:155]
 v_mfma_f32_16x16x32_bf16 v[156:159], v[36:39], v[20:23], v[156:159]
 s_waitcnt lgkmcnt(2)
 v_mfma_f32_16x16x32_bf16 v[160:163], v[40:43], v[48:51], v[160:163]
 v_mfma_f32_16x16x32_bf16 v[164:167], v[40:43], v[52:55], v[164:167]
 ds_read_b64_tr_b16 v[36:37], v60 offset:256
 ds_read_b64_tr_b16 v[38:39], v60 offset:2304
 v_mfma_f32_16x16x32_bf16 v[168:171], v[40:43], v[56:59], v[168:171]
 v_mfma_f32_16x16x32_bf16 v[172:175], v[40:43], v[12:15], v[172:175]
 v_mfma_f32_16x16x32_bf16 v[176:179], v[40:43], v[16:19], v[176:179]
 v_mfma_f32_16x16x32_bf16 v[180:183], v[40:43], v[20:23], v[180:183]
 s_waitcnt lgkmcnt(2)
 v_mfma_f32_16x16x32_bf16 v[184:187], v[44:47], v[48:51], v[184:187]
 v_mfma_f32_16x16x32_bf16 v[188:191], v[44:47], v[52:55], v[188:191]
 ds_read_b64_tr_b16 v[40:41], v61 offset:256
 ds_read_b64_tr_b16 v[42:43], v61 offset:2304
 v_mfma_f32_16x16x32_bf16 v[192:195], v[44:47], v[56:59], v[192:195]
 v_mfma_f32_16x16x32_bf16 v[196:199], v[44:47], v[12:15], v[196:199]
 v_mfma_f32_16x16x32_bf16 v[200:203], v[44:47], v[16:19], v[200:203]
 v_mfma_f32_16x16x32_bf16 v[204:207], v[44:47], v[20:23], v[204:207]
 s_waitcnt lgkmcnt(2)
 v_mfma_f32_16x16x32_bf16 v[208:211], v[36:39], v[48:51], v[208:211]
 v_mfma_f32_16x16x32_bf16 v[212:215], v[36:39], v[52:55], v[212:215]
 v_mfma_f32_16x16x32_bf16 v[216:219], v[36:39], v[56:59], v[216:219]
 v_mfma_f32_16x16x32_bf16 v[220:223], v[36:39], v[12:15], v[220:223]
 s_waitcnt vmcnt(10) lgkmcnt(0)
 s_barrier
 ds_read_b64_tr_b16 v[44:45], v6 offset:33024
 ds_read_b64_tr_b16 v[46:47], v6 offset:35072
 v_mfma_f32_16x16x32_bf16 v[224:227], v[36:39], v[16:19], v[224:227]
 s_add_u32 m0, s50, 49152
 s_add_u32 s46, s90, 3145728
 buffer_load_dwordx4 v32, s[24:27], s46 offen offset:0 lds
 v_mfma_f32_16x16x32_bf16 v[228:231], v[36:39], v[20:23], v[228:231]
 v_mfma_f32_16x16x32_bf16 v[232:235], v[40:43], v[48:51], v[232:235]
 buffer_load_dwordx4 v33, s[24:27], s46 offen offset:1024 lds
 v_mfma_f32_16x16x32_bf16 v[236:239], v[40:43], v[52:55], v[236:239]
 v_add_u32 v4, 4294852608, v4
 ds_read_b128 v[48:51], v4 offset:0
 ds_read_b128 v[52:55], v4 offset:2048
 ds_read_b64_tr_b16 v[36:37], v7 offset:33024
 ds_read_b64_tr_b16 v[38:39], v7 offset:35072
 v_mfma_f32_16x16x32_bf16 v[240:243], v[40:43], v[56:59], v[240:243]
 buffer_load_dwordx4 v34, s[24:27], s46 offen offset:2048 lds
 v_mfma_f32_16x16x32_bf16 v[244:247], v[40:43], v[12:15], v[244:247]
 ds_read_b128 v[56:59], v4 offset:4096
 ds_read_b128 v[12:15], v4 offset:6144
 v_mfma_f32_16x16x32_bf16 v[248:251], v[40:43], v[16:19], v[248:251]
 buffer_load_dwordx4 v35, s[24:27], s46 offen offset:3072 lds
 v_mfma_f32_16x16x32_bf16 v[252:255], v[40:43], v[20:23], v[252:255]
 ds_read_b128 v[16:19], v4 offset:8192
 ds_read_b128 v[20:23], v4 offset:10240
 s_waitcnt lgkmcnt(7)
 v_mfma_f32_16x16x32_bf16 v[64:67], v[44:47], v[48:51], v[64:67]
 s_add_u32 m0, s50, 81920
 s_add_u32 s46, s90, 3146240
 buffer_load_dwordx4 v32, s[24:27], s46 offen offset:0 lds
 s_waitcnt lgkmcnt(6)
 v_mfma_f32_16x16x32_bf16 v[68:71], v[44:47], v[52:55], v[68:71]
 ds_read_b64_tr_b16 v[40:41], v8 offset:33024
 ds_read_b64_tr_b16 v[42:43], v8 offset:35072
 s_waitcnt lgkmcnt(5)
 v_mfma_f32_16x16x32_bf16 v[72:75], v[44:47], v[56:59], v[72:75]
 buffer_load_dwordx4 v33, s[24:27], s46 offen offset:1024 lds
 s_waitcnt lgkmcnt(4)
 v_mfma_f32_16x16x32_bf16 v[76:79], v[44:47], v[12:15], v[76:79]
 s_waitcnt lgkmcnt(3)
 v_mfma_f32_16x16x32_bf16 v[80:83], v[44:47], v[16:19], v[80:83]
 buffer_load_dwordx4 v34, s[24:27], s46 offen offset:2048 lds
 s_waitcnt lgkmcnt(2)
 v_mfma_f32_16x16x32_bf16 v[84:87], v[44:47], v[20:23], v[84:87]
 v_mfma_f32_16x16x32_bf16 v[88:91], v[36:39], v[48:51], v[88:91]
 buffer_load_dwordx4 v35, s[24:27], s46 offen offset:3072 lds
 v_mfma_f32_16x16x32_bf16 v[92:95], v[36:39], v[52:55], v[92:95]
 ds_read_b64_tr_b16 v[44:45], v9 offset:33024
 ds_read_b64_tr_b16 v[46:47], v9 offset:35072
 v_mfma_f32_16x16x32_bf16 v[96:99], v[36:39], v[56:59], v[96:99]
 s_add_u32 s46, s15, 0
 s_and_b32 s46, s46, 0x1ffff
 s_add_u32 s46, s46, s42
 s_mov_b32 m0, 0
 s_add_u32 s46, s46, 0
 buffer_load_dwordx4 v24, s[16:19], s46 offen offset:0 nt lds
 v_mfma_f32_16x16x32_bf16 v[100:103], v[36:39], v[12:15], v[100:103]
 v_mfma_f32_16x16x32_bf16 v[104:107], v[36:39], v[16:19], v[104:107]
 buffer_load_dwordx4 v25, s[16:19], s46 offen offset:1024 nt lds
 v_mfma_f32_16x16x32_bf16 v[108:111], v[36:39], v[20:23], v[108:111]
 s_waitcnt lgkmcnt(2)
 v_mfma_f32_16x16x32_bf16 v[112:115], v[40:43], v[48:51], v[112:115]
 buffer_load_dwordx4 v26, s[16:19], s46 offen offset:2048 nt lds
 v_mfma_f32_16x16x32_bf16 v[116:119], v[40:43], v[52:55], v[116:119]
 ds_read_b64_tr_b16 v[36:37], v10 offset:33024
 ds_read_b64_tr_b16 v[38:39], v10 offset:35072
 v_mfma_f32_16x16x32_bf16 v[120:123], v[40:43], v[56:59], v[120:123]
 buffer_load_dwordx4 v27, s[16:19], s46 offen offset:3072 nt lds
 v_mfma_f32_16x16x32_bf16 v[124:127], v[40:43], v[12:15], v[124:127]
 v_mfma_f32_16x16x32_bf16 v[128:131], v[40:43], v[16:19], v[128:131]
 s_add_u32 s46, s15, 0
 s_and_b32 s46, s46, 0x1ffff
 s_add_u32 s46, s46, s42
 s_mov_b32 m0, 4096
 s_add_u32 s46, s46, 4096
 buffer_load_dwordx4 v24, s[16:19], s46 offen offset:0 nt lds
 v_mfma_f32_16x16x32_bf16 v[132:135], v[40:43], v[20:23], v[132:135]
 s_waitcnt lgkmcnt(2)
 v_mfma_f32_16x16x32_bf16 v[136:139], v[44:47], v[48:51], v[136:139]
 buffer_load_dwordx4 v25, s[16:19], s46 offen offset:1024 nt lds
 v_mfma_f32_16x16x32_bf16 v[140:143], v[44:47], v[52:55], v[140:143]
 ds_read_b64_tr_b16 v[40:41], v11 offset:33024
 ds_read_b64_tr_b16 v[42:43], v11 offset:35072
 v_mfma_f32_16x16x32_bf16 v[144:147], v[44:47], v[56:59], v[144:147]
 buffer_load_dwordx4 v26, s[16:19], s46 offen offset:2048 nt lds
 v_mfma_f32_16x16x32_bf16 v[148:151], v[44:47], v[12:15], v[148:151]
 v_mfma_f32_16x16x32_bf16 v[152:155], v[44:47], v[16:19], v[152:155]
 buffer_load_dwordx4 v27, s[16:19], s46 offen offset:3072 nt lds
 v_mfma_f32_16x16x32_bf16 v[156:159], v[44:47], v[20:23], v[156:159]
 s_waitcnt lgkmcnt(2)
 v_mfma_f32_16x16x32_bf16 v[160:163], v[36:39], v[48:51], v[160:163]
 s_add_u32 s46, s15, 8192
 s_and_b32 s46, s46, 0x1ffff
 s_add_u32 s46, s46, s42
 s_mov_b32 m0, 8192
 s_add_u32 s46, s46, 0
 buffer_load_dwordx4 v24, s[16:19], s46 offen offset:0 nt lds
 v_mfma_f32_16x16x32_bf16 v[164:167], v[36:39], v[52:55], v[164:167]
 ds_read_b64_tr_b16 v[44:45], v60 offset:33024
 ds_read_b64_tr_b16 v[46:47], v60 offset:35072
 v_mfma_f32_16x16x32_bf16 v[168:171], v[36:39], v[56:59], v[168:171]
 buffer_load_dwordx4 v25, s[16:19], s46 offen offset:1024 nt lds
 v_mfma_f32_16x16x32_bf16 v[172:175], v[36:39], v[12:15], v[172:175]
 v_mfma_f32_16x16x32_bf16 v[176:179], v[36:39], v[16:19], v[176:179]
 buffer_load_dwordx4 v26, s[16:19], s46 offen offset:2048 nt lds
 v_mfma_f32_16x16x32_bf16 v[180:183], v[36:39], v[20:23], v[180:183]
 s_waitcnt lgkmcnt(2)
 v_mfma_f32_16x16x32_bf16 v[184:187], v[40:43], v[48:51], v[184:187]
 buffer_load_dwordx4 v27, s[16:19], s46 offen offset:3072 nt lds
 v_mfma_f32_16x16x32_bf16 v[188:191], v[40:43], v[52:55], v[188:191]
 ds_read_b64_tr_b16 v[36:37], v61 offset:33024
 ds_read_b64_tr_b16 v[38:39], v61 offset:35072
 v_mfma_f32_16x16x32_bf16 v[192:195], v[40:43], v[56:59], v[192:195]
 s_add_u32 s46, s15, 8192
 s_and_b32 s46, s46, 0x1ffff
 s_add_u32 s46, s46, s42
 s_mov_b32 m0, 12288
 s_add_u32 s46, s46, 4096
 buffer_load_dwordx4 v24, s[16:19], s46 offen offset:0 nt lds
 v_mfma_f32_16x16x32_bf16 v[196:199], v[40:43], v[12:15], v[196:199]
 v_mfma_f32_16x16x32_bf16 v[200:203], v[40:43], v[16:19], v[200:203]
 buffer_load_dwordx4 v25, s[16:19], s46 offen offset:1024 nt lds
 v_mfma_f32_16x16x32_bf16 v[204:207], v[40:43], v[20:23], v[204:207]
 s_waitcnt lgkmcnt(2)
 v_mfma_f32_16x16x32_bf16 v[208:211], v[44:47], v[48:51], v[208:211]
 buffer_load_dwordx4 v26, s[16:19], s46 offen offset:2048 nt lds
 v_mfma_f32_16x16x32_bf16 v[212:215], v[44:47], v[52:55], v[212:215]
 v_mfma_f32_16x16x32_bf16 v[216:219], v[44:47], v[56:59], v[216:219]
 buffer_load_dwordx4 v27, s[16:19], s46 offen offset:3072 nt lds
 v_mfma_f32_16x16x32_bf16 v[220:223], v[44:47], v[12:15], v[220:223]
 s_waitcnt vmcnt(24) lgkmcnt(0)
 s_barrier
 ds_read_b64_tr_b16 v[40:41], v6 offset:49408
 ds_read_b64_tr_b16 v[42:43], v6 offset:51456
 v_mfma_f32_16x16x32_bf16 v[224:227], v[44:47], v[16:19], v[224:227]
 s_add_u32 m0, s50, 65536
 s_add_u32 s46, s90, 3407872
 buffer_load_dwordx4 v32, s[24:27], s46 offen offset:0 lds
 v_mfma_f32_16x16x32_bf16 v[228:231], v[44:47], v[20:23], v[228:231]
 v_mfma_f32_16x16x32_bf16 v[232:235], v[36:39], v[48:51], v[232:235]
 v_mfma_f32_16x16x32_bf16 v[236:239], v[36:39], v[52:55], v[236:239]
 v_add_u32 v5, 4294852608, v5
 ds_read_b128 v[48:51], v5 offset:0
 ds_read_b128 v[52:55], v5 offset:2048
 ds_read_b64_tr_b16 v[44:45], v7 offset:49408
 ds_read_b64_tr_b16 v[46:47], v7 offset:51456
 v_mfma_f32_16x16x32_bf16 v[240:243], v[36:39], v[56:59], v[240:243]
 buffer_load_dwordx4 v33, s[24:27], s46 offen offset:1024 lds
 v_mfma_f32_16x16x32_bf16 v[244:247], v[36:39], v[12:15], v[244:247]
 ds_read_b128 v[56:59], v5 offset:4096
 ds_read_b128 v[12:15], v5 offset:6144
 v_mfma_f32_16x16x32_bf16 v[248:251], v[36:39], v[16:19], v[248:251]
 v_mfma_f32_16x16x32_bf16 v[252:255], v[36:39], v[20:23], v[252:255]
 ds_read_b128 v[16:19], v5 offset:8192
 ds_read_b128 v[20:23], v5 offset:10240
 s_waitcnt lgkmcnt(7)
 v_mfma_f32_16x16x32_bf16 v[64:67], v[40:43], v[48:51], v[64:67]
 buffer_load_dwordx4 v34, s[24:27], s46 offen offset:2048 lds
 s_waitcnt lgkmcnt(6)
 v_mfma_f32_16x16x32_bf16 v[68:71], v[40:43], v[52:55], v[68:71]
 ds_read_b64_tr_b16 v[36:37], v8 offset:49408
 ds_read_b64_tr_b16 v[38:39], v8 offset:51456
 s_waitcnt lgkmcnt(5)
 v_mfma_f32_16x16x32_bf16 v[72:75], v[40:43], v[56:59], v[72:75]
 s_waitcnt lgkmcnt(4)
 v_mfma_f32_16x16x32_bf16 v[76:79], v[40:43], v[12:15], v[76:79]
 s_waitcnt lgkmcnt(3)
 v_mfma_f32_16x16x32_bf16 v[80:83], v[40:43], v[16:19], v[80:83]
 buffer_load_dwordx4 v35, s[24:27], s46 offen offset:3072 lds
 s_waitcnt lgkmcnt(2)
 v_mfma_f32_16x16x32_bf16 v[84:87], v[40:43], v[20:23], v[84:87]
 v_mfma_f32_16x16x32_bf16 v[88:91], v[44:47], v[48:51], v[88:91]
 v_mfma_f32_16x16x32_bf16 v[92:95], v[44:47], v[52:55], v[92:95]
 ds_read_b64_tr_b16 v[40:41], v9 offset:49408
 ds_read_b64_tr_b16 v[42:43], v9 offset:51456
 v_mfma_f32_16x16x32_bf16 v[96:99], v[44:47], v[56:59], v[96:99]
 s_add_u32 m0, s50, 114688
 s_add_u32 s46, s90, 3408384
 buffer_load_dwordx4 v32, s[24:27], s46 offen offset:0 lds
 v_mfma_f32_16x16x32_bf16 v[100:103], v[44:47], v[12:15], v[100:103]
 v_mfma_f32_16x16x32_bf16 v[104:107], v[44:47], v[16:19], v[104:107]
 v_mfma_f32_16x16x32_bf16 v[108:111], v[44:47], v[20:23], v[108:111]
 s_waitcnt lgkmcnt(2)
 v_mfma_f32_16x16x32_bf16 v[112:115], v[36:39], v[48:51], v[112:115]
 buffer_load_dwordx4 v33, s[24:27], s46 offen offset:1024 lds
 v_mfma_f32_16x16x32_bf16 v[116:119], v[36:39], v[52:55], v[116:119]
 ds_read_b64_tr_b16 v[44:45], v10 offset:49408
 ds_read_b64_tr_b16 v[46:47], v10 offset:51456
 v_mfma_f32_16x16x32_bf16 v[120:123], v[36:39], v[56:59], v[120:123]
 v_mfma_f32_16x16x32_bf16 v[124:127], v[36:39], v[12:15], v[124:127]
 v_mfma_f32_16x16x32_bf16 v[128:131], v[36:39], v[16:19], v[128:131]
 buffer_load_dwordx4 v34, s[24:27], s46 offen offset:2048 lds
 v_mfma_f32_16x16x32_bf16 v[132:135], v[36:39], v[20:23], v[132:135]
 s_waitcnt lgkmcnt(2)
 v_mfma_f32_16x16x32_bf16 v[136:139], v[40:43], v[48:51], v[136:139]
 v_mfma_f32_16x16x32_bf16 v[140:143], v[40:43], v[52:55], v[140:143]
 ds_read_b64_tr_b16 v[36:37], v11 offset:49408
 ds_read_b64_tr_b16 v[38:39], v11 offset:51456
 v_mfma_f32_16x16x32_bf16 v[144:147], v[40:43], v[56:59], v[144:147]
 buffer_load_dwordx4 v35, s[24:27], s46 offen offset:3072 lds
 v_mfma_f32_16x16x32_bf16 v[148:151], v[40:43], v[12:15], v[148:151]
 v_mfma_f32_16x16x32_bf16 v[152:155], v[40:43], v[16:19], v[152:155]
 v_mfma_f32_16x16x32_bf16 v[156:159], v[40:43], v[20:23], v[156:159]
 s_waitcnt lgkmcnt(2)
 v_mfma_f32_16x16x32_bf16 v[160:163], v[44:47], v[48:51], v[160:163]
 v_mfma_f32_16x16x32_bf16 v[164:167], v[44:47], v[52:55], v[164:167]
 ds_read_b64_tr_b16 v[40:41], v60 offset:49408
 ds_read_b64_tr_b16 v[42:43], v60 offset:51456
 v_mfma_f32_16x16x32_bf16 v[168:171], v[44:47], v[56:59], v[168:171]
 v_mfma_f32_16x16x32_bf16 v[172:175], v[44:47], v[12:15], v[172:175]
 v_mfma_f32_16x16x32_bf16 v[176:179], v[44:47], v[16:19], v[176:179]
 v_mfma_f32_16x16x32_bf16 v[180:183], v[44:47], v[20:23], v[180:183]
 s_waitcnt lgkmcnt(2)
 v_mfma_f32_16x16x32_bf16 v[184:187], v[36:39], v[48:51], v[184:187]
 v_mfma_f32_16x16x32_bf16 v[188:191], v[36:39], v[52:55], v[188:191]
 ds_read_b64_tr_b16 v[44:45], v61 offset:49408
 ds_read_b64_tr_b16 v[46:47], v61 offset:51456
 v_mfma_f32_16x16x32_bf16 v[192:195], v[36:39], v[56:59], v[192:195]
 v_mfma_f32_16x16x32_bf16 v[196:199], v[36:39], v[12:15], v[196:199]
 v_mfma_f32_16x16x32_bf16 v[200:203], v[36:39], v[16:19], v[200:203]
 v_mfma_f32_16x16x32_bf16 v[204:207], v[36:39], v[20:23], v[204:207]
 s_waitcnt lgkmcnt(2)
 v_mfma_f32_16x16x32_bf16 v[208:211], v[40:43], v[48:51], v[208:211]
 v_mfma_f32_16x16x32_bf16 v[212:215], v[40:43], v[52:55], v[212:215]
 v_mfma_f32_16x16x32_bf16 v[216:219], v[40:43], v[56:59], v[216:219]
 v_mfma_f32_16x16x32_bf16 v[220:223], v[40:43], v[12:15], v[220:223]
 s_waitcnt vmcnt(24) lgkmcnt(0)
 s_barrier
 ds_read_b64_tr_b16 v[36:37], v6 offset:256
 ds_read_b64_tr_b16 v[38:39], v6 offset:2304
 v_mfma_f32_16x16x32_bf16 v[224:227], v[40:43], v[16:19], v[224:227]
 s_add_u32 m0, s50, 98304
 s_add_u32 s46, s90, 3670016
 buffer_load_dwordx4 v32, s[24:27], s46 offen offset:0 lds
 v_mfma_f32_16x16x32_bf16 v[228:231], v[40:43], v[20:23], v[228:231]
 v_mfma_f32_16x16x32_bf16 v[232:235], v[44:47], v[48:51], v[232:235]
 v_mfma_f32_16x16x32_bf16 v[236:239], v[44:47], v[52:55], v[236:239]
 v_add_u32 v4, 114688, v4
 ds_read_b128 v[48:51], v4 offset:0
 ds_read_b128 v[52:55], v4 offset:2048
 ds_read_b64_tr_b16 v[40:41], v7 offset:256
 ds_read_b64_tr_b16 v[42:43], v7 offset:2304
 v_mfma_f32_16x16x32_bf16 v[240:243], v[44:47], v[56:59], v[240:243]
 buffer_load_dwordx4 v33, s[24:27], s46 offen offset:1024 lds
 v_mfma_f32_16x16x32_bf16 v[244:247], v[44:47], v[12:15], v[244:247]
 ds_read_b128 v[56:59], v4 offset:4096
 ds_read_b128 v[12:15], v4 offset:6144
 v_mfma_f32_16x16x32_bf16 v[248:251], v[44:47], v[16:19], v[248:251]
 v_mfma_f32_16x16x32_bf16 v[252:255], v[44:47], v[20:23], v[252:255]
 ds_read_b128 v[16:19], v4 offset:8192
 ds_read_b128 v[20:23], v4 offset:10240
 s_waitcnt lgkmcnt(7)
 v_mfma_f32_16x16x32_bf16 v[64:67], v[36:39], v[48:51], v[64:67]
 buffer_load_dwordx4 v34, s[24:27], s46 offen offset:2048 lds
 s_waitcnt lgkmcnt(6)
 v_mfma_f32_16x16x32_bf16 v[68:71], v[36:39], v[52:55], v[68:71]
 ds_read_b64_tr_b16 v[44:45], v8 offset:256
 ds_read_b64_tr_b16 v[46:47], v8 offset:2304
 s_waitcnt lgkmcnt(5)
 v_mfma_f32_16x16x32_bf16 v[72:75], v[36:39], v[56:59], v[72:75]
 s_waitcnt lgkmcnt(4)
 v_mfma_f32_16x16x32_bf16 v[76:79], v[36:39], v[12:15], v[76:79]
 s_waitcnt lgkmcnt(3)
 v_mfma_f32_16x16x32_bf16 v[80:83], v[36:39], v[16:19], v[80:83]
 buffer_load_dwordx4 v35, s[24:27], s46 offen offset:3072 lds
 s_waitcnt lgkmcnt(2)
 v_mfma_f32_16x16x32_bf16 v[84:87], v[36:39], v[20:23], v[84:87]
 v_mfma_f32_16x16x32_bf16 v[88:91], v[40:43], v[48:51], v[88:91]
 v_mfma_f32_16x16x32_bf16 v[92:95], v[40:43], v[52:55], v[92:95]
 ds_read_b64_tr_b16 v[36:37], v9 offset:256
 ds_read_b64_tr_b16 v[38:39], v9 offset:2304
 v_mfma_f32_16x16x32_bf16 v[96:99], v[40:43], v[56:59], v[96:99]
 s_add_u32 m0, s50, 131072
 s_add_u32 s46, s90, 3670528
 buffer_load_dwordx4 v32, s[24:27], s46 offen offset:0 lds
 v_mfma_f32_16x16x32_bf16 v[100:103], v[40:43], v[12:15], v[100:103]
 v_mfma_f32_16x16x32_bf16 v[104:107], v[40:43], v[16:19], v[104:107]
 v_mfma_f32_16x16x32_bf16 v[108:111], v[40:43], v[20:23], v[108:111]
 s_waitcnt lgkmcnt(2)
 v_mfma_f32_16x16x32_bf16 v[112:115], v[44:47], v[48:51], v[112:115]
 buffer_load_dwordx4 v33, s[24:27], s46 offen offset:1024 lds
 v_mfma_f32_16x16x32_bf16 v[116:119], v[44:47], v[52:55], v[116:119]
 ds_read_b64_tr_b16 v[40:41], v10 offset:256
 ds_read_b64_tr_b16 v[42:43], v10 offset:2304
 v_mfma_f32_16x16x32_bf16 v[120:123], v[44:47], v[56:59], v[120:123]
 v_mfma_f32_16x16x32_bf16 v[124:127], v[44:47], v[12:15], v[124:127]
 v_mfma_f32_16x16x32_bf16 v[128:131], v[44:47], v[16:19], v[128:131]
 buffer_load_dwordx4 v34, s[24:27], s46 offen offset:2048 lds
 v_mfma_f32_16x16x32_bf16 v[132:135], v[44:47], v[20:23], v[132:135]
 s_waitcnt lgkmcnt(2)
 v_mfma_f32_16x16x32_bf16 v[136:139], v[36:39], v[48:51], v[136:139]
 v_mfma_f32_16x16x32_bf16 v[140:143], v[36:39], v[52:55], v[140:143]
 ds_read_b64_tr_b16 v[44:45], v11 offset:256
 ds_read_b64_tr_b16 v[46:47], v11 offset:2304
 v_mfma_f32_16x16x32_bf16 v[144:147], v[36:39], v[56:59], v[144:147]
 buffer_load_dwordx4 v35, s[24:27], s46 offen offset:3072 lds
 v_mfma_f32_16x16x32_bf16 v[148:151], v[36:39], v[12:15], v[148:151]
 v_mfma_f32_16x16x32_bf16 v[152:155], v[36:39], v[16:19], v[152:155]
 v_mfma_f32_16x16x32_bf16 v[156:159], v[36:39], v[20:23], v[156:159]
 s_waitcnt lgkmcnt(2)
 v_mfma_f32_16x16x32_bf16 v[160:163], v[40:43], v[48:51], v[160:163]
 v_mfma_f32_16x16x32_bf16 v[164:167], v[40:43], v[52:55], v[164:167]
 ds_read_b64_tr_b16 v[36:37], v60 offset:256
 ds_read_b64_tr_b16 v[38:39], v60 offset:2304
 v_mfma_f32_16x16x32_bf16 v[168:171], v[40:43], v[56:59], v[168:171]
 v_mfma_f32_16x16x32_bf16 v[172:175], v[40:43], v[12:15], v[172:175]
 v_mfma_f32_16x16x32_bf16 v[176:179], v[40:43], v[16:19], v[176:179]
 v_mfma_f32_16x16x32_bf16 v[180:183], v[40:43], v[20:23], v[180:183]
 s_waitcnt lgkmcnt(2)
 v_mfma_f32_16x16x32_bf16 v[184:187], v[44:47], v[48:51], v[184:187]
 v_mfma_f32_16x16x32_bf16 v[188:191], v[44:47], v[52:55], v[188:191]
 ds_read_b64_tr_b16 v[40:41], v61 offset:256
 ds_read_b64_tr_b16 v[42:43], v61 offset:2304
 v_mfma_f32_16x16x32_bf16 v[192:195], v[44:47], v[56:59], v[192:195]
 v_mfma_f32_16x16x32_bf16 v[196:199], v[44:47], v[12:15], v[196:199]
 v_mfma_f32_16x16x32_bf16 v[200:203], v[44:47], v[16:19], v[200:203]
 v_mfma_f32_16x16x32_bf16 v[204:207], v[44:47], v[20:23], v[204:207]
 s_waitcnt lgkmcnt(2)
 v_mfma_f32_16x16x32_bf16 v[208:211], v[36:39], v[48:51], v[208:211]
 v_mfma_f32_16x16x32_bf16 v[212:215], v[36:39], v[52:55], v[212:215]
 v_mfma_f32_16x16x32_bf16 v[216:219], v[36:39], v[56:59], v[216:219]
 v_mfma_f32_16x16x32_bf16 v[220:223], v[36:39], v[12:15], v[220:223]
 s_waitcnt vmcnt(8) lgkmcnt(0)
 s_barrier
 ds_read_b64_tr_b16 v[44:45], v6 offset:33024
 ds_read_b64_tr_b16 v[46:47], v6 offset:35072
 v_mfma_f32_16x16x32_bf16 v[224:227], v[36:39], v[16:19], v[224:227]
 s_add_u32 m0, s50, 49152
 s_add_u32 s46, s90, 3932160
 buffer_load_dwordx4 v32, s[24:27], s46 offen offset:0 lds
 v_mfma_f32_16x16x32_bf16 v[228:231], v[36:39], v[20:23], v[228:231]
 v_mfma_f32_16x16x32_bf16 v[232:235], v[40:43], v[48:51], v[232:235]
 buffer_load_dwordx4 v33, s[24:27], s46 offen offset:1024 lds
 v_mfma_f32_16x16x32_bf16 v[236:239], v[40:43], v[52:55], v[236:239]
 v_add_u32 v5, 114688, v5
 ds_read_b128 v[48:51], v5 offset:0
 ds_read_b128 v[52:55], v5 offset:2048
 ds_read_b64_tr_b16 v[36:37], v7 offset:33024
 ds_read_b64_tr_b16 v[38:39], v7 offset:35072
 v_mfma_f32_16x16x32_bf16 v[240:243], v[40:43], v[56:59], v[240:243]
 buffer_load_dwordx4 v34, s[24:27], s46 offen offset:2048 lds
 v_mfma_f32_16x16x32_bf16 v[244:247], v[40:43], v[12:15], v[244:247]
 ds_read_b128 v[56:59], v5 offset:4096
 ds_read_b128 v[12:15], v5 offset:6144
 v_mfma_f32_16x16x32_bf16 v[248:251], v[40:43], v[16:19], v[248:251]
 buffer_load_dwordx4 v35, s[24:27], s46 offen offset:3072 lds
 v_mfma_f32_16x16x32_bf16 v[252:255], v[40:43], v[20:23], v[252:255]
 ds_read_b128 v[16:19], v5 offset:8192
 ds_read_b128 v[20:23], v5 offset:10240
 s_waitcnt lgkmcnt(7)
 v_mfma_f32_16x16x32_bf16 v[64:67], v[44:47], v[48:51], v[64:67]
 s_add_u32 m0, s50, 81920
 s_add_u32 s46, s90, 3932672
 buffer_load_dwordx4 v32, s[24:27], s46 offen offset:0 lds
 s_waitcnt lgkmcnt(6)
 v_mfma_f32_16x16x32_bf16 v[68:71], v[44:47], v[52:55], v[68:71]
 ds_read_b64_tr_b16 v[40:41], v8 offset:33024
 ds_read_b64_tr_b16 v[42:43], v8 offset:35072
 s_waitcnt lgkmcnt(5)
 v_mfma_f32_16x16x32_bf16 v[72:75], v[44:47], v[56:59], v[72:75]
 buffer_load_dwordx4 v33, s[24:27], s46 offen offset:1024 lds
 s_waitcnt lgkmcnt(4)
 v_mfma_f32_16x16x32_bf16 v[76:79], v[44:47], v[12:15], v[76:79]
 s_waitcnt lgkmcnt(3)
 v_mfma_f32_16x16x32_bf16 v[80:83], v[44:47], v[16:19], v[80:83]
 buffer_load_dwordx4 v34, s[24:27], s46 offen offset:2048 lds
 s_waitcnt lgkmcnt(2)
 v_mfma_f32_16x16x32_bf16 v[84:87], v[44:47], v[20:23], v[84:87]
 v_mfma_f32_16x16x32_bf16 v[88:91], v[36:39], v[48:51], v[88:91]
 buffer_load_dwordx4 v35, s[24:27], s46 offen offset:3072 lds
 v_mfma_f32_16x16x32_bf16 v[92:95], v[36:39], v[52:55], v[92:95]
 ds_read_b64_tr_b16 v[44:45], v9 offset:33024
 ds_read_b64_tr_b16 v[46:47], v9 offset:35072
 v_mfma_f32_16x16x32_bf16 v[96:99], v[36:39], v[56:59], v[96:99]
 s_add_u32 s46, s15, 16384
 s_and_b32 s46, s46, 0x1ffff
 s_add_u32 s46, s46, s42
 s_mov_b32 m0, 16384
 s_add_u32 s46, s46, 0
 buffer_load_dwordx4 v24, s[16:19], s46 offen offset:0 nt lds
 v_mfma_f32_16x16x32_bf16 v[100:103], v[36:39], v[12:15], v[100:103]
 v_mfma_f32_16x16x32_bf16 v[104:107], v[36:39], v[16:19], v[104:107]
 buffer_load_dwordx4 v25, s[16:19], s46 offen offset:1024 nt lds
 v_mfma_f32_16x16x32_bf16 v[108:111], v[36:39], v[20:23], v[108:111]
 s_waitcnt lgkmcnt(2)
 v_mfma_f32_16x16x32_bf16 v[112:115], v[40:43], v[48:51], v[112:115]
 buffer_load_dwordx4 v26, s[16:19], s46 offen offset:2048 nt lds
 v_mfma_f32_16x16x32_bf16 v[116:119], v[40:43], v[52:55], v[116:119]
 ds_read_b64_tr_b16 v[36:37], v10 offset:33024
 ds_read_b64_tr_b16 v[38:39], v10 offset:35072
 v_mfma_f32_16x16x32_bf16 v[120:123], v[40:43], v[56:59], v[120:123]
 buffer_load_dwordx4 v27, s[16:19], s46 offen offset:3072 nt lds
 v_mfma_f32_16x16x32_bf16 v[124:127], v[40:43], v[12:15], v[124:127]
 v_mfma_f32_16x16x32_bf16 v[128:131], v[40:43], v[16:19], v[128:131]
 s_add_u32 s46, s15, 16384
 s_and_b32 s46, s46, 0x1ffff
 s_add_u32 s46, s46, s42
 s_mov_b32 m0, 20480
 s_add_u32 s46, s46, 4096
 buffer_load_dwordx4 v24, s[16:19], s46 offen offset:0 nt lds
 v_mfma_f32_16x16x32_bf16 v[132:135], v[40:43], v[20:23], v[132:135]
 s_waitcnt lgkmcnt(2)
 v_mfma_f32_16x16x32_bf16 v[136:139], v[44:47], v[48:51], v[136:139]
 buffer_load_dwordx4 v25, s[16:19], s46 offen offset:1024 nt lds
 v_mfma_f32_16x16x32_bf16 v[140:143], v[44:47], v[52:55], v[140:143]
 ds_read_b64_tr_b16 v[40:41], v11 offset:33024
 ds_read_b64_tr_b16 v[42:43], v11 offset:35072
 v_mfma_f32_16x16x32_bf16 v[144:147], v[44:47], v[56:59], v[144:147]
 buffer_load_dwordx4 v26, s[16:19], s46 offen offset:2048 nt lds
 v_mfma_f32_16x16x32_bf16 v[148:151], v[44:47], v[12:15], v[148:151]
 v_mfma_f32_16x16x32_bf16 v[152:155], v[44:47], v[16:19], v[152:155]
 buffer_load_dwordx4 v27, s[16:19], s46 offen offset:3072 nt lds
 v_mfma_f32_16x16x32_bf16 v[156:159], v[44:47], v[20:23], v[156:159]
 s_waitcnt lgkmcnt(2)
 v_mfma_f32_16x16x32_bf16 v[160:163], v[36:39], v[48:51], v[160:163]
 s_add_u32 s46, s15, 0
 s_and_b32 s46, s46, 0x1ffff
 s_add_u32 s46, s46, s42
 s_mov_b32 m0, 24576
 s_add_u32 s46, s46, 0
 buffer_load_dwordx4 v28, s[20:23], s46 offen offset:0 nt lds
 v_mfma_f32_16x16x32_bf16 v[164:167], v[36:39], v[52:55], v[164:167]
 ds_read_b64_tr_b16 v[44:45], v60 offset:33024
 ds_read_b64_tr_b16 v[46:47], v60 offset:35072
 v_mfma_f32_16x16x32_bf16 v[168:171], v[36:39], v[56:59], v[168:171]
 buffer_load_dwordx4 v3, s[20:23], s46 offen offset:1024 nt lds
 v_mfma_f32_16x16x32_bf16 v[172:175], v[36:39], v[12:15], v[172:175]
 v_mfma_f32_16x16x32_bf16 v[176:179], v[36:39], v[16:19], v[176:179]
 buffer_load_dwordx4 v28, s[20:23], s46 offen offset:2048 nt lds
 v_mfma_f32_16x16x32_bf16 v[180:183], v[36:39], v[20:23], v[180:183]
 s_waitcnt lgkmcnt(2)
 v_mfma_f32_16x16x32_bf16 v[184:187], v[40:43], v[48:51], v[184:187]
 buffer_load_dwordx4 v3, s[20:23], s46 offen offset:3072 nt lds
 v_mfma_f32_16x16x32_bf16 v[188:191], v[40:43], v[52:55], v[188:191]
 ds_read_b64_tr_b16 v[36:37], v61 offset:33024
 ds_read_b64_tr_b16 v[38:39], v61 offset:35072
 v_mfma_f32_16x16x32_bf16 v[192:195], v[40:43], v[56:59], v[192:195]
 s_add_u32 s46, s15, 0
 s_and_b32 s46, s46, 0x1ffff
 s_add_u32 s46, s46, s42
 s_mov_b32 m0, 28672
 s_add_u32 s46, s46, 4096
 buffer_load_dwordx4 v28, s[20:23], s46 offen offset:0 nt lds
 v_mfma_f32_16x16x32_bf16 v[196:199], v[40:43], v[12:15], v[196:199]
 v_mfma_f32_16x16x32_bf16 v[200:203], v[40:43], v[16:19], v[200:203]
 buffer_load_dwordx4 v3, s[20:23], s46 offen offset:1024 nt lds
 v_mfma_f32_16x16x32_bf16 v[204:207], v[40:43], v[20:23], v[204:207]
 s_waitcnt lgkmcnt(2)
 v_mfma_f32_16x16x32_bf16 v[208:211], v[44:47], v[48:51], v[208:211]
 buffer_load_dwordx4 v28, s[20:23], s46 offen offset:2048 nt lds
 v_mfma_f32_16x16x32_bf16 v[212:215], v[44:47], v[52:55], v[212:215]
 v_mfma_f32_16x16x32_bf16 v[216:219], v[44:47], v[56:59], v[216:219]
 buffer_load_dwordx4 v3, s[20:23], s46 offen offset:3072 nt lds
 v_mfma_f32_16x16x32_bf16 v[220:223], v[44:47], v[12:15], v[220:223]
 s_waitcnt vmcnt(24) lgkmcnt(0)
 s_barrier
 ds_read_b64_tr_b16 v[40:41], v6 offset:49408
 ds_read_b64_tr_b16 v[42:43], v6 offset:51456
 v_mfma_f32_16x16x32_bf16 v[224:227], v[44:47], v[16:19], v[224:227]
 s_add_u32 m0, s50, 65536
 s_add_u32 s46, s90, 4194304
 buffer_load_dwordx4 v32, s[24:27], s46 offen offset:0 lds
 v_mfma_f32_16x16x32_bf16 v[228:231], v[44:47], v[20:23], v[228:231]
 v_mfma_f32_16x16x32_bf16 v[232:235], v[36:39], v[48:51], v[232:235]
 v_mfma_f32_16x16x32_bf16 v[236:239], v[36:39], v[52:55], v[236:239]
 v_add_u32 v4, 4294852608, v4
 ds_read_b128 v[48:51], v4 offset:0
 ds_read_b128 v[52:55], v4 offset:2048
 ds_read_b64_tr_b16 v[44:45], v7 offset:49408
 ds_read_b64_tr_b16 v[46:47], v7 offset:51456
 v_mfma_f32_16x16x32_bf16 v[240:243], v[36:39], v[56:59], v[240:243]
 buffer_load_dwordx4 v33, s[24:27], s46 offen offset:1024 lds
 v_mfma_f32_16x16x32_bf16 v[244:247], v[36:39], v[12:15], v[244:247]
 ds_read_b128 v[56:59], v4 offset:4096
 ds_read_b128 v[12:15], v4 offset:6144
 v_mfma_f32_16x16x32_bf16 v[248:251], v[36:39], v[16:19], v[248:251]
 v_mfma_f32_16x16x32_bf16 v[252:255], v[36:39], v[20:23], v[252:255]
 ds_read_b128 v[16:19], v4 offset:8192
 ds_read_b128 v[20:23], v4 offset:10240
 s_waitcnt lgkmcnt(7)
 v_mfma_f32_16x16x32_bf16 v[64:67], v[40:43], v[48:51], v[64:67]
 buffer_load_dwordx4 v34, s[24:27], s46 offen offset:2048 lds
 s_waitcnt lgkmcnt(6)
 v_mfma_f32_16x16x32_bf16 v[68:71], v[40:43], v[52:55], v[68:71]
 ds_read_b64_tr_b16 v[36:37], v8 offset:49408
 ds_read_b64_tr_b16 v[38:39], v8 offset:51456
 s_waitcnt lgkmcnt(5)
 v_mfma_f32_16x16x32_bf16 v[72:75], v[40:43], v[56:59], v[72:75]
 s_waitcnt lgkmcnt(4)
 v_mfma_f32_16x16x32_bf16 v[76:79], v[40:43], v[12:15], v[76:79]
 s_waitcnt lgkmcnt(3)
 v_mfma_f32_16x16x32_bf16 v[80:83], v[40:43], v[16:19], v[80:83]
 buffer_load_dwordx4 v35, s[24:27], s46 offen offset:3072 lds
 s_waitcnt lgkmcnt(2)
 v_mfma_f32_16x16x32_bf16 v[84:87], v[40:43], v[20:23], v[84:87]
 v_mfma_f32_16x16x32_bf16 v[88:91], v[44:47], v[48:51], v[88:91]
 v_mfma_f32_16x16x32_bf16 v[92:95], v[44:47], v[52:55], v[92:95]
 ds_read_b64_tr_b16 v[40:41], v9 offset:49408
 ds_read_b64_tr_b16 v[42:43], v9 offset:51456
 v_mfma_f32_16x16x32_bf16 v[96:99], v[44:47], v[56:59], v[96:99]
 s_add_u32 m0, s50, 114688
 s_add_u32 s46, s90, 4194816
 buffer_load_dwordx4 v32, s[24:27], s46 offen offset:0 lds
 v_mfma_f32_16x16x32_bf16 v[100:103], v[44:47], v[12:15], v[100:103]
 v_mfma_f32_16x16x32_bf16 v[104:107], v[44:47], v[16:19], v[104:107]
 v_mfma_f32_16x16x32_bf16 v[108:111], v[44:47], v[20:23], v[108:111]
 s_waitcnt lgkmcnt(2)
 v_mfma_f32_16x16x32_bf16 v[112:115], v[36:39], v[48:51], v[112:115]
 buffer_load_dwordx4 v33, s[24:27], s46 offen offset:1024 lds
 v_mfma_f32_16x16x32_bf16 v[116:119], v[36:39], v[52:55], v[116:119]
 ds_read_b64_tr_b16 v[44:45], v10 offset:49408
 ds_read_b64_tr_b16 v[46:47], v10 offset:51456
 v_mfma_f32_16x16x32_bf16 v[120:123], v[36:39], v[56:59], v[120:123]
 v_mfma_f32_16x16x32_bf16 v[124:127], v[36:39], v[12:15], v[124:127]
 v_mfma_f32_16x16x32_bf16 v[128:131], v[36:39], v[16:19], v[128:131]
 buffer_load_dwordx4 v34, s[24:27], s46 offen offset:2048 lds
 v_mfma_f32_16x16x32_bf16 v[132:135], v[36:39], v[20:23], v[132:135]
 s_waitcnt lgkmcnt(2)
 v_mfma_f32_16x16x32_bf16 v[136:139], v[40:43], v[48:51], v[136:139]
 v_mfma_f32_16x16x32_bf16 v[140:143], v[40:43], v[52:55], v[140:143]
 ds_read_b64_tr_b16 v[36:37], v11 offset:49408
 ds_read_b64_tr_b16 v[38:39], v11 offset:51456
 v_mfma_f32_16x16x32_bf16 v[144:147], v[40:43], v[56:59], v[144:147]
 buffer_load_dwordx4 v35, s[24:27], s46 offen offset:3072 lds
 v_mfma_f32_16x16x32_bf16 v[148:151], v[40:43], v[12:15], v[148:151]
 v_mfma_f32_16x16x32_bf16 v[152:155], v[40:43], v[16:19], v[152:155]
 v_mfma_f32_16x16x32_bf16 v[156:159], v[40:43], v[20:23], v[156:159]
 s_waitcnt lgkmcnt(2)
 v_mfma_f32_16x16x32_bf16 v[160:163], v[44:47], v[48:51], v[160:163]
 v_mfma_f32_16x16x32_bf16 v[164:167], v[44:47], v[52:55], v[164:167]
 ds_read_b64_tr_b16 v[40:41], v60 offset:49408
 ds_read_b64_tr_b16 v[42:43], v60 offset:51456
 v_mfma_f32_16x16x32_bf16 v[168:171], v[44:47], v[56:59], v[168:171]
 v_mfma_f32_16x16x32_bf16 v[172:175], v[44:47], v[12:15], v[172:175]
 v_mfma_f32_16x16x32_bf16 v[176:179], v[44:47], v[16:19], v[176:179]
 v_mfma_f32_16x16x32_bf16 v[180:183], v[44:47], v[20:23], v[180:183]
 s_waitcnt lgkmcnt(2)
 v_mfma_f32_16x16x32_bf16 v[184:187], v[36:39], v[48:51], v[184:187]
 v_mfma_f32_16x16x32_bf16 v[188:191], v[36:39], v[52:55], v[188:191]
 ds_read_b64_tr_b16 v[44:45], v61 offset:49408
 ds_read_b64_tr_b16 v[46:47], v61 offset:51456
 v_mfma_f32_16x16x32_bf16 v[192:195], v[36:39], v[56:59], v[192:195]
 v_mfma_f32_16x16x32_bf16 v[196:199], v[36:39], v[12:15], v[196:199]
 v_mfma_f32_16x16x32_bf16 v[200:203], v[36:39], v[16:19], v[200:203]
 v_mfma_f32_16x16x32_bf16 v[204:207], v[36:39], v[20:23], v[204:207]
 s_waitcnt lgkmcnt(2)
 v_mfma_f32_16x16x32_bf16 v[208:211], v[40:43], v[48:51], v[208:211]
 v_mfma_f32_16x16x32_bf16 v[212:215], v[40:43], v[52:55], v[212:215]
 v_mfma_f32_16x16x32_bf16 v[216:219], v[40:43], v[56:59], v[216:219]
 v_mfma_f32_16x16x32_bf16 v[220:223], v[40:43], v[12:15], v[220:223]
 s_waitcnt vmcnt(24) lgkmcnt(0)
 s_barrier
 ds_read_b64_tr_b16 v[36:37], v6 offset:256
 ds_read_b64_tr_b16 v[38:39], v6 offset:2304
 v_mfma_f32_16x16x32_bf16 v[224:227], v[40:43], v[16:19], v[224:227]
 s_add_u32 m0, s50, 98304
 s_add_u32 s46, s90, 4456448
 buffer_load_dwordx4 v32, s[24:27], s46 offen offset:0 lds
 v_mfma_f32_16x16x32_bf16 v[228:231], v[40:43], v[20:23], v[228:231]
 v_mfma_f32_16x16x32_bf16 v[232:235], v[44:47], v[48:51], v[232:235]
 v_mfma_f32_16x16x32_bf16 v[236:239], v[44:47], v[52:55], v[236:239]
 v_add_u32 v5, 4294852608, v5
 ds_read_b128 v[48:51], v5 offset:0
 ds_read_b128 v[52:55], v5 offset:2048
 ds_read_b64_tr_b16 v[40:41], v7 offset:256
 ds_read_b64_tr_b16 v[42:43], v7 offset:2304
 v_mfma_f32_16x16x32_bf16 v[240:243], v[44:47], v[56:59], v[240:243]
 buffer_load_dwordx4 v33, s[24:27], s46 offen offset:1024 lds
 v_mfma_f32_16x16x32_bf16 v[244:247], v[44:47], v[12:15], v[244:247]
 ds_read_b128 v[56:59], v5 offset:4096
 ds_read_b128 v[12:15], v5 offset:6144
 v_mfma_f32_16x16x32_bf16 v[248:251], v[44:47], v[16:19], v[248:251]
 v_mfma_f32_16x16x32_bf16 v[252:255], v[44:47], v[20:23], v[252:255]
 ds_read_b128 v[16:19], v5 offset:8192
 ds_read_b128 v[20:23], v5 offset:10240
 s_waitcnt lgkmcnt(7)
 v_mfma_f32_16x16x32_bf16 v[64:67], v[36:39], v[48:51], v[64:67]
 buffer_load_dwordx4 v34, s[24:27], s46 offen offset:2048 lds
 s_waitcnt lgkmcnt(6)
 v_mfma_f32_16x16x32_bf16 v[68:71], v[36:39], v[52:55], v[68:71]
 ds_read_b64_tr_b16 v[44:45], v8 offset:256
 ds_read_b64_tr_b16 v[46:47], v8 offset:2304
 s_waitcnt lgkmcnt(5)
 v_mfma_f32_16x16x32_bf16 v[72:75], v[36:39], v[56:59], v[72:75]
 s_waitcnt lgkmcnt(4)
 v_mfma_f32_16x16x32_bf16 v[76:79], v[36:39], v[12:15], v[76:79]
 s_waitcnt lgkmcnt(3)
 v_mfma_f32_16x16x32_bf16 v[80:83], v[36:39], v[16:19], v[80:83]
 buffer_load_dwordx4 v35, s[24:27], s46 offen offset:3072 lds
 s_waitcnt lgkmcnt(2)
 v_mfma_f32_16x16x32_bf16 v[84:87], v[36:39], v[20:23], v[84:87]
 v_mfma_f32_16x16x32_bf16 v[88:91], v[40:43], v[48:51], v[88:91]
 v_mfma_f32_16x16x32_bf16 v[92:95], v[40:43], v[52:55], v[92:95]
 ds_read_b64_tr_b16 v[36:37], v9 offset:256
 ds_read_b64_tr_b16 v[38:39], v9 offset:2304
 v_mfma_f32_16x16x32_bf16 v[96:99], v[40:43], v[56:59], v[96:99]
 s_add_u32 m0, s50, 131072
 s_add_u32 s46, s90, 4456960
 buffer_load_dwordx4 v32, s[24:27], s46 offen offset:0 lds
 v_mfma_f32_16x16x32_bf16 v[100:103], v[40:43], v[12:15], v[100:103]
 v_mfma_f32_16x16x32_bf16 v[104:107], v[40:43], v[16:19], v[104:107]
 v_mfma_f32_16x16x32_bf16 v[108:111], v[40:43], v[20:23], v[108:111]
 s_waitcnt lgkmcnt(2)
 v_mfma_f32_16x16x32_bf16 v[112:115], v[44:47], v[48:51], v[112:115]
 buffer_load_dwordx4 v33, s[24:27], s46 offen offset:1024 lds
 v_mfma_f32_16x16x32_bf16 v[116:119], v[44:47], v[52:55], v[116:119]
 ds_read_b64_tr_b16 v[40:41], v10 offset:256
 ds_read_b64_tr_b16 v[42:43], v10 offset:2304
 v_mfma_f32_16x16x32_bf16 v[120:123], v[44:47], v[56:59], v[120:123]
 v_mfma_f32_16x16x32_bf16 v[124:127], v[44:47], v[12:15], v[124:127]
 v_mfma_f32_16x16x32_bf16 v[128:131], v[44:47], v[16:19], v[128:131]
 buffer_load_dwordx4 v34, s[24:27], s46 offen offset:2048 lds
 v_mfma_f32_16x16x32_bf16 v[132:135], v[44:47], v[20:23], v[132:135]
 s_waitcnt lgkmcnt(2)
 v_mfma_f32_16x16x32_bf16 v[136:139], v[36:39], v[48:51], v[136:139]
 v_mfma_f32_16x16x32_bf16 v[140:143], v[36:39], v[52:55], v[140:143]
 ds_read_b64_tr_b16 v[44:45], v11 offset:256
 ds_read_b64_tr_b16 v[46:47], v11 offset:2304
 v_mfma_f32_16x16x32_bf16 v[144:147], v[36:39], v[56:59], v[144:147]
 buffer_load_dwordx4 v35, s[24:27], s46 offen offset:3072 lds
 v_mfma_f32_16x16x32_bf16 v[148:151], v[36:39], v[12:15], v[148:151]
 v_mfma_f32_16x16x32_bf16 v[152:155], v[36:39], v[16:19], v[152:155]
 v_mfma_f32_16x16x32_bf16 v[156:159], v[36:39], v[20:23], v[156:159]
 s_waitcnt lgkmcnt(2)
 v_mfma_f32_16x16x32_bf16 v[160:163], v[40:43], v[48:51], v[160:163]
 v_mfma_f32_16x16x32_bf16 v[164:167], v[40:43], v[52:55], v[164:167]
 ds_read_b64_tr_b16 v[36:37], v60 offset:256
 ds_read_b64_tr_b16 v[38:39], v60 offset:2304
 v_mfma_f32_16x16x32_bf16 v[168:171], v[40:43], v[56:59], v[168:171]
 v_mfma_f32_16x16x32_bf16 v[172:175], v[40:43], v[12:15], v[172:175]
 v_mfma_f32_16x16x32_bf16 v[176:179], v[40:43], v[16:19], v[176:179]
 v_mfma_f32_16x16x32_bf16 v[180:183], v[40:43], v[20:23], v[180:183]
 s_waitcnt lgkmcnt(2)
 v_mfma_f32_16x16x32_bf16 v[184:187], v[44:47], v[48:51], v[184:187]
 v_mfma_f32_16x16x32_bf16 v[188:191], v[44:47], v[52:55], v[188:191]
 ds_read_b64_tr_b16 v[40:41], v61 offset:256
 ds_read_b64_tr_b16 v[42:43], v61 offset:2304
 v_mfma_f32_16x16x32_bf16 v[192:195], v[44:47], v[56:59], v[192:195]
 v_mfma_f32_16x16x32_bf16 v[196:199], v[44:47], v[12:15], v[196:199]
 v_mfma_f32_16x16x32_bf16 v[200:203], v[44:47], v[16:19], v[200:203]
 v_mfma_f32_16x16x32_bf16 v[204:207], v[44:47], v[20:23], v[204:207]
 s_waitcnt lgkmcnt(2)
 v_mfma_f32_16x16x32_bf16 v[208:211], v[36:39], v[48:51], v[208:211]
 v_mfma_f32_16x16x32_bf16 v[212:215], v[36:39], v[52:55], v[212:215]
 v_mfma_f32_16x16x32_bf16 v[216:219], v[36:39], v[56:59], v[216:219]
 v_mfma_f32_16x16x32_bf16 v[220:223], v[36:39], v[12:15], v[220:223]
 s_waitcnt vmcnt(8) lgkmcnt(0)
 s_barrier
 ds_read_b64_tr_b16 v[44:45], v6 offset:33024
 ds_read_b64_tr_b16 v[46:47], v6 offset:35072
 v_mfma_f32_16x16x32_bf16 v[224:227], v[36:39], v[16:19], v[224:227]
 s_add_u32 s46, s15, 24576
 s_and_b32 s46, s46, 0x1ffff
 s_add_u32 s46, s46, s42
 s_mov_b32 m0, 32768
 s_add_u32 s46, s46, 0
 buffer_load_dwordx4 v24, s[16:19], s46 offen offset:0 nt lds
 buffer_load_dwordx4 v25, s[16:19], s46 offen offset:1024 nt lds
 v_mfma_f32_16x16x32_bf16 v[228:231], v[36:39], v[20:23], v[228:231]
 v_mfma_f32_16x16x32_bf16 v[232:235], v[40:43], v[48:51], v[232:235]
 buffer_load_dwordx4 v26, s[16:19], s46 offen offset:2048 nt lds
 buffer_load_dwordx4 v27, s[16:19], s46 offen offset:3072 nt lds
 v_mfma_f32_16x16x32_bf16 v[236:239], v[40:43], v[52:55], v[236:239]
 v_add_u32 v4, 114688, v4
 ds_read_b128 v[48:51], v4 offset:0
 ds_read_b128 v[52:55], v4 offset:2048
 ds_read_b64_tr_b16 v[36:37], v7 offset:33024
 ds_read_b64_tr_b16 v[38:39], v7 offset:35072
 v_mfma_f32_16x16x32_bf16 v[240:243], v[40:43], v[56:59], v[240:243]
 s_add_u32 s46, s15, 24576
 s_and_b32 s46, s46, 0x1ffff
 s_add_u32 s46, s46, s42
 s_mov_b32 m0, 36864
 s_add_u32 s46, s46, 4096
 buffer_load_dwordx4 v24, s[16:19], s46 offen offset:0 nt lds
 buffer_load_dwordx4 v25, s[16:19], s46 offen offset:1024 nt lds
 v_mfma_f32_16x16x32_bf16 v[244:247], v[40:43], v[12:15], v[244:247]
 ds_read_b128 v[56:59], v4 offset:4096
 ds_read_b128 v[12:15], v4 offset:6144
 v_mfma_f32_16x16x32_bf16 v[248:251], v[40:43], v[16:19], v[248:251]
 buffer_load_dwordx4 v26, s[16:19], s46 offen offset:2048 nt lds
 buffer_load_dwordx4 v27, s[16:19], s46 offen offset:3072 nt lds
 v_mfma_f32_16x16x32_bf16 v[252:255], v[40:43], v[20:23], v[252:255]
 ds_read_b128 v[16:19], v4 offset:8192
 ds_read_b128 v[20:23], v4 offset:10240
 s_waitcnt lgkmcnt(7)
 v_mfma_f32_16x16x32_bf16 v[64:67], v[44:47], v[48:51], v[64:67]
 s_add_u32 s46, s15, 8192
 s_and_b32 s46, s46, 0x1ffff
 s_add_u32 s46, s46, s42
 s_mov_b32 m0, 40960
 s_add_u32 s46, s46, 0
 buffer_load_dwordx4 v28, s[20:23], s46 offen offset:0 nt lds
 buffer_load_dwordx4 v3, s[20:23], s46 offen offset:1024 nt lds
 s_waitcnt lgkmcnt(6)
 v_mfma_f32_16x16x32_bf16 v[68:71], v[44:47], v[52:55], v[68:71]
 ds_read_b64_tr_b16 v[40:41], v8 offset:33024
 ds_read_b64_tr_b16 v[42:43], v8 offset:35072
 s_waitcnt lgkmcnt(5)
 v_mfma_f32_16x16x32_bf16 v[72:75], v[44:47], v[56:59], v[72:75]
 buffer_load_dwordx4 v28, s[20:23], s46 offen offset:2048 nt lds
 buffer_load_dwordx4 v3, s[20:23], s46 offen offset:3072 nt lds
 s_waitcnt lgkmcnt(4)
 v_mfma_f32_16x16x32_bf16 v[76:79], v[44:47], v[12:15], v[76:79]
 s_waitcnt lgkmcnt(3)
 v_mfma_f32_16x16x32_bf16 v[80:83], v[44:47], v[16:19], v[80:83]
 s_add_u32 s46, s15, 8192
 s_and_b32 s46, s46, 0x1ffff
 s_add_u32 s46, s46, s42
 s_mov_b32 m0, 45056
 s_add_u32 s46, s46, 4096
 buffer_load_dwordx4 v28, s[20:23], s46 offen offset:0 nt lds
 buffer_load_dwordx4 v3, s[20:23], s46 offen offset:1024 nt lds
 s_waitcnt lgkmcnt(2)
 v_mfma_f32_16x16x32_bf16 v[84:87], v[44:47], v[20:23], v[84:87]
 v_mfma_f32_16x16x32_bf16 v[88:91], v[36:39], v[48:51], v[88:91]
 buffer_load_dwordx4 v28, s[20:23], s46 offen offset:2048 nt lds
 buffer_load_dwordx4 v3, s[20:23], s46 offen offset:3072 nt lds
 v_mfma_f32_16x16x32_bf16 v[92:95], v[36:39], v[52:55], v[92:95]
 ds_read_b64_tr_b16 v[44:45], v9 offset:33024
 ds_read_b64_tr_b16 v[46:47], v9 offset:35072
 v_mfma_f32_16x16x32_bf16 v[96:99], v[36:39], v[56:59], v[96:99]
 s_add_u32 s46, s15, 32768
 s_and_b32 s46, s46, 0x1ffff
 s_add_u32 s46, s46, s42
 s_mov_b32 m0, 49152
 s_add_u32 s46, s46, 0
 buffer_load_dwordx4 v24, s[16:19], s46 offen offset:0 nt lds
 buffer_load_dwordx4 v25, s[16:19], s46 offen offset:1024 nt lds
 v_mfma_f32_16x16x32_bf16 v[100:103], v[36:39], v[12:15], v[100:103]
 v_mfma_f32_16x16x32_bf16 v[104:107], v[36:39], v[16:19], v[104:107]
 buffer_load_dwordx4 v26, s[16:19], s46 offen offset:2048 nt lds
 buffer_load_dwordx4 v27, s[16:19], s46 offen offset:3072 nt lds
 v_mfma_f32_16x16x32_bf16 v[108:111], v[36:39], v[20:23], v[108:111]
 s_waitcnt lgkmcnt(2)
 v_mfma_f32_16x16x32_bf16 v[112:115], v[40:43], v[48:51], v[112:115]
 s_add_u32 s46, s15, 32768
 s_and_b32 s46, s46, 0x1ffff
 s_add_u32 s46, s46, s42
 s_mov_b32 m0, 53248
 s_add_u32 s46, s46, 4096
 buffer_load_dwordx4 v24, s[16:19], s46 offen offset:0 nt lds
 buffer_load_dwordx4 v25, s[16:19], s46 offen offset:1024 nt lds
 v_mfma_f32_16x16x32_bf16 v[116:119], v[40:43], v[52:55], v[116:119]
 ds_read_b64_tr_b16 v[36:37], v10 offset:33024
 ds_read_b64_tr_b16 v[38:39], v10 offset:35072
 v_mfma_f32_16x16x32_bf16 v[120:123], v[40:43], v[56:59], v[120:123]
 buffer_load_dwordx4 v26, s[16:19], s46 offen offset:2048 nt lds
 buffer_load_dwordx4 v27, s[16:19], s46 offen offset:3072 nt lds
 v_mfma_f32_16x16x32_bf16 v[124:127], v[40:43], v[12:15], v[124:127]
 v_mfma_f32_16x16x32_bf16 v[128:131], v[40:43], v[16:19], v[128:131]
 s_add_u32 s46, s15, 16384
 s_and_b32 s46, s46, 0x1ffff
 s_add_u32 s46, s46, s42
 s_mov_b32 m0, 57344
 s_add_u32 s46, s46, 0
 buffer_load_dwordx4 v28, s[20:23], s46 offen offset:0 nt lds
 buffer_load_dwordx4 v3, s[20:23], s46 offen offset:1024 nt lds
 v_mfma_f32_16x16x32_bf16 v[132:135], v[40:43], v[20:23], v[132:135]
 s_waitcnt lgkmcnt(2)
 v_mfma_f32_16x16x32_bf16 v[136:139], v[44:47], v[48:51], v[136:139]
 buffer_load_dwordx4 v28, s[20:23], s46 offen offset:2048 nt lds
 buffer_load_dwordx4 v3, s[20:23], s46 offen offset:3072 nt lds
 v_mfma_f32_16x16x32_bf16 v[140:143], v[44:47], v[52:55], v[140:143]
 ds_read_b64_tr_b16 v[40:41], v11 offset:33024
 ds_read_b64_tr_b16 v[42:43], v11 offset:35072
 v_mfma_f32_16x16x32_bf16 v[144:147], v[44:47], v[56:59], v[144:147]
 s_add_u32 s46, s15, 16384
 s_and_b32 s46, s46, 0x1ffff
 s_add_u32 s46, s46, s42
 s_mov_b32 m0, 61440
 s_add_u32 s46, s46, 4096
 buffer_load_dwordx4 v28, s[20:23], s46 offen offset:0 nt lds
 buffer_load_dwordx4 v3, s[20:23], s46 offen offset:1024 nt lds
 v_mfma_f32_16x16x32_bf16 v[148:151], v[44:47], v[12:15], v[148:151]
 v_mfma_f32_16x16x32_bf16 v[152:155], v[44:47], v[16:19], v[152:155]
 buffer_load_dwordx4 v28, s[20:23], s46 offen offset:2048 nt lds
 buffer_load_dwordx4 v3, s[20:23], s46 offen offset:3072 nt lds
 v_mfma_f32_16x16x32_bf16 v[156:159], v[44:47], v[20:23], v[156:159]
 s_waitcnt lgkmcnt(2)
 v_mfma_f32_16x16x32_bf16 v[160:163], v[36:39], v[48:51], v[160:163]
 s_add_u32 s46, s15, 40960
 s_and_b32 s46, s46, 0x1ffff
 s_add_u32 s46, s46, s42
 s_mov_b32 m0, 81920
 s_add_u32 s46, s46, 0
 buffer_load_dwordx4 v24, s[16:19], s46 offen offset:0 nt lds
 buffer_load_dwordx4 v25, s[16:19], s46 offen offset:1024 nt lds
 v_mfma_f32_16x16x32_bf16 v[164:167], v[36:39], v[52:55], v[164:167]
 ds_read_b64_tr_b16 v[44:45], v60 offset:33024
 ds_read_b64_tr_b16 v[46:47], v60 offset:35072
 v_mfma_f32_16x16x32_bf16 v[168:171], v[36:39], v[56:59], v[168:171]
 buffer_load_dwordx4 v26, s[16:19], s46 offen offset:2048 nt lds
 buffer_load_dwordx4 v27, s[16:19], s46 offen offset:3072 nt lds
 v_mfma_f32_16x16x32_bf16 v[172:175], v[36:39], v[12:15], v[172:175]
 v_mfma_f32_16x16x32_bf16 v[176:179], v[36:39], v[16:19], v[176:179]
 s_add_u32 s46, s15, 40960
 s_and_b32 s46, s46, 0x1ffff
 s_add_u32 s46, s46, s42
 s_mov_b32 m0, 86016
 s_add_u32 s46, s46, 4096
 buffer_load_dwordx4 v24, s[16:19], s46 offen offset:0 nt lds
 buffer_load_dwordx4 v25, s[16:19], s46 offen offset:1024 nt lds
 v_mfma_f32_16x16x32_bf16 v[180:183], v[36:39], v[20:23], v[180:183]
 s_waitcnt lgkmcnt(2)
 v_mfma_f32_16x16x32_bf16 v[184:187], v[40:43], v[48:51], v[184:187]
 buffer_load_dwordx4 v26, s[16:19], s46 offen offset:2048 nt lds
 buffer_load_dwordx4 v27, s[16:19], s46 offen offset:3072 nt lds
 v_mfma_f32_16x16x32_bf16 v[188:191], v[40:43], v[52:55], v[188:191]
 ds_read_b64_tr_b16 v[36:37], v61 offset:33024
 ds_read_b64_tr_b16 v[38:39], v61 offset:35072
 v_mfma_f32_16x16x32_bf16 v[192:195], v[40:43], v[56:59], v[192:195]
 s_add_u32 s46, s15, 24576
 s_and_b32 s46, s46, 0x1ffff
 s_add_u32 s46, s46, s42
 s_mov_b32 m0, 90112
 s_add_u32 s46, s46, 0
 buffer_load_dwordx4 v28, s[20:23], s46 offen offset:0 nt lds
 buffer_load_dwordx4 v3, s[20:23], s46 offen offset:1024 nt lds
 v_mfma_f32_16x16x32_bf16 v[196:199], v[40:43], v[12:15], v[196:199]
 v_mfma_f32_16x16x32_bf16 v[200:203], v[40:43], v[16:19], v[200:203]
 buffer_load_dwordx4 v28, s[20:23], s46 offen offset:2048 nt lds
 buffer_load_dwordx4 v3, s[20:23], s46 offen offset:3072 nt lds
 v_mfma_f32_16x16x32_bf16 v[204:207], v[40:43], v[20:23], v[204:207]
 s_waitcnt lgkmcnt(2)
 v_mfma_f32_16x16x32_bf16 v[208:211], v[44:47], v[48:51], v[208:211]
 s_add_u32 s46, s15, 24576
 s_and_b32 s46, s46, 0x1ffff
 s_add_u32 s46, s46, s42
 s_mov_b32 m0, 94208
 s_add_u32 s46, s46, 4096
 buffer_load_dwordx4 v28, s[20:23], s46 offen offset:0 nt lds
 buffer_load_dwordx4 v3, s[20:23], s46 offen offset:1024 nt lds
 v_mfma_f32_16x16x32_bf16 v[212:215], v[44:47], v[52:55], v[212:215]
 v_mfma_f32_16x16x32_bf16 v[216:219], v[44:47], v[56:59], v[216:219]
 buffer_load_dwordx4 v28, s[20:23], s46 offen offset:2048 nt lds
 buffer_load_dwordx4 v3, s[20:23], s46 offen offset:3072 nt lds
 v_mfma_f32_16x16x32_bf16 v[220:223], v[44:47], v[12:15], v[220:223]
 s_waitcnt vmcnt(48) lgkmcnt(0)
 s_barrier
 ds_read_b64_tr_b16 v[40:41], v6 offset:49408
 ds_read_b64_tr_b16 v[42:43], v6 offset:51456
 v_mfma_f32_16x16x32_bf16 v[224:227], v[44:47], v[16:19], v[224:227]
 s_add_u32 s46, s15, 49152
 s_and_b32 s46, s46, 0x1ffff
 s_add_u32 s46, s46, s42
 s_mov_b32 m0, 65536
 s_add_u32 s46, s46, 0
 buffer_load_dwordx4 v24, s[16:19], s46 offen offset:0 nt lds
 buffer_load_dwordx4 v25, s[16:19], s46 offen offset:1024 nt lds
 v_mfma_f32_16x16x32_bf16 v[228:231], v[44:47], v[20:23], v[228:231]
 v_mfma_f32_16x16x32_bf16 v[232:235], v[36:39], v[48:51], v[232:235]
 buffer_load_dwordx4 v26, s[16:19], s46 offen offset:2048 nt lds
 buffer_load_dwordx4 v27, s[16:19], s46 offen offset:3072 nt lds
 v_mfma_f32_16x16x32_bf16 v[236:239], v[36:39], v[52:55], v[236:239]
 v_add_u32 v5, 114688, v5
 ds_read_b128 v[48:51], v5 offset:0
 ds_read_b128 v[52:55], v5 offset:2048
 ds_read_b64_tr_b16 v[44:45], v7 offset:49408
 ds_read_b64_tr_b16 v[46:47], v7 offset:51456
 v_mfma_f32_16x16x32_bf16 v[240:243], v[36:39], v[56:59], v[240:243]
 s_add_u32 s46, s15, 49152
 s_and_b32 s46, s46, 0x1ffff
 s_add_u32 s46, s46, s42
 s_mov_b32 m0, 69632
 s_add_u32 s46, s46, 4096
 buffer_load_dwordx4 v24, s[16:19], s46 offen offset:0 nt lds
 buffer_load_dwordx4 v25, s[16:19], s46 offen offset:1024 nt lds
 v_mfma_f32_16x16x32_bf16 v[244:247], v[36:39], v[12:15], v[244:247]
 ds_read_b128 v[56:59], v5 offset:4096
 ds_read_b128 v[12:15], v5 offset:6144
 v_mfma_f32_16x16x32_bf16 v[248:251], v[36:39], v[16:19], v[248:251]
 buffer_load_dwordx4 v26, s[16:19], s46 offen offset:2048 nt lds
 buffer_load_dwordx4 v27, s[16:19], s46 offen offset:3072 nt lds
 v_mfma_f32_16x16x32_bf16 v[252:255], v[36:39], v[20:23], v[252:255]
 ds_read_b128 v[16:19], v5 offset:8192
 ds_read_b128 v[20:23], v5 offset:10240
 s_waitcnt lgkmcnt(7)
 v_mfma_f32_16x16x32_bf16 v[64:67], v[40:43], v[48:51], v[64:67]
 s_add_u32 s46, s15, 32768
 s_and_b32 s46, s46, 0x1ffff
 s_add_u32 s46, s46, s42
 s_mov_b32 m0, 73728
 s_add_u32 s46, s46, 0
 buffer_load_dwordx4 v28, s[20:23], s46 offen offset:0 nt lds
 buffer_load_dwordx4 v3, s[20:23], s46 offen offset:1024 nt lds
 s_waitcnt lgkmcnt(6)
 v_mfma_f32_16x16x32_bf16 v[68:71], v[40:43], v[52:55], v[68:71]
 ds_read_b64_tr_b16 v[36:37], v8 offset:49408
 ds_read_b64_tr_b16 v[38:39], v8 offset:51456
 s_waitcnt lgkmcnt(5)
 v_mfma_f32_16x16x32_bf16 v[72:75], v[40:43], v[56:59], v[72:75]
 buffer_load_dwordx4 v28, s[20:23], s46 offen offset:2048 nt lds
 buffer_load_dwordx4 v3, s[20:23], s46 offen offset:3072 nt lds
 s_waitcnt lgkmcnt(4)
 v_mfma_f32_16x16x32_bf16 v[76:79], v[40:43], v[12:15], v[76:79]
 s_waitcnt lgkmcnt(3)
 v_mfma_f32_16x16x32_bf16 v[80:83], v[40:43], v[16:19], v[80:83]
 s_add_u32 s46, s15, 32768
 s_and_b32 s46, s46, 0x1ffff
 s_add_u32 s46, s46, s42
 s_mov_b32 m0, 77824
 s_add_u32 s46, s46, 4096
 buffer_load_dwordx4 v28, s[20:23], s46 offen offset:0 nt lds
 buffer_load_dwordx4 v3, s[20:23], s46 offen offset:1024 nt lds
 s_waitcnt lgkmcnt(2)
 v_mfma_f32_16x16x32_bf16 v[84:87], v[40:43], v[20:23], v[84:87]
 v_mfma_f32_16x16x32_bf16 v[88:91], v[44:47], v[48:51], v[88:91]
 buffer_load_dwordx4 v28, s[20:23], s46 offen offset:2048 nt lds
 buffer_load_dwordx4 v3, s[20:23], s46 offen offset:3072 nt lds
 v_mfma_f32_16x16x32_bf16 v[92:95], v[44:47], v[52:55], v[92:95]
 ds_read_b64_tr_b16 v[40:41], v9 offset:49408
 ds_read_b64_tr_b16 v[42:43], v9 offset:51456
 v_mfma_f32_16x16x32_bf16 v[96:99], v[44:47], v[56:59], v[96:99]
 s_add_u32 s46, s15, 57344
 s_and_b32 s46, s46, 0x1ffff
 s_add_u32 s46, s46, s42
 s_mov_b32 m0, 114688
 s_add_u32 s46, s46, 0
 buffer_load_dwordx4 v24, s[16:19], s46 offen offset:0 nt lds
 v_mfma_f32_16x16x32_bf16 v[100:103], v[44:47], v[12:15], v[100:103]
 v_mfma_f32_16x16x32_bf16 v[104:107], v[44:47], v[16:19], v[104:107]
 buffer_load_dwordx4 v25, s[16:19], s46 offen offset:1024 nt lds
 v_mfma_f32_16x16x32_bf16 v[108:111], v[44:47], v[20:23], v[108:111]
 s_waitcnt lgkmcnt(2)
 v_mfma_f32_16x16x32_bf16 v[112:115], v[36:39], v[48:51], v[112:115]
 buffer_load_dwordx4 v26, s[16:19], s46 offen offset:2048 nt lds
 v_mfma_f32_16x16x32_bf16 v[116:119], v[36:39], v[52:55], v[116:119]
 ds_read_b64_tr_b16 v[44:45], v10 offset:49408
 ds_read_b64_tr_b16 v[46:47], v10 offset:51456
 v_mfma_f32_16x16x32_bf16 v[120:123], v[36:39], v[56:59], v[120:123]
 buffer_load_dwordx4 v27, s[16:19], s46 offen offset:3072 nt lds
 v_mfma_f32_16x16x32_bf16 v[124:127], v[36:39], v[12:15], v[124:127]
 v_mfma_f32_16x16x32_bf16 v[128:131], v[36:39], v[16:19], v[128:131]
 s_add_u32 s46, s15, 57344
 s_and_b32 s46, s46, 0x1ffff
 s_add_u32 s46, s46, s42
 s_mov_b32 m0, 118784
 s_add_u32 s46, s46, 4096
 buffer_load_dwordx4 v24, s[16:19], s46 offen offset:0 nt lds
 v_mfma_f32_16x16x32_bf16 v[132:135], v[36:39], v[20:23], v[132:135]
 s_waitcnt lgkmcnt(2)
 v_mfma_f32_16x16x32_bf16 v[136:139], v[40:43], v[48:51], v[136:139]
 buffer_load_dwordx4 v25, s[16:19], s46 offen offset:1024 nt lds
 v_mfma_f32_16x16x32_bf16 v[140:143], v[40:43], v[52:55], v[140:143]
 ds_read_b64_tr_b16 v[36:37], v11 offset:49408
 ds_read_b64_tr_b16 v[38:39], v11 offset:51456
 v_mfma_f32_16x16x32_bf16 v[144:147], v[40:43], v[56:59], v[144:147]
 buffer_load_dwordx4 v26, s[16:19], s46 offen offset:2048 nt lds
 v_mfma_f32_16x16x32_bf16 v[148:151], v[40:43], v[12:15], v[148:151]
 v_mfma_f32_16x16x32_bf16 v[152:155], v[40:43], v[16:19], v[152:155]
 buffer_load_dwordx4 v27, s[16:19], s46 offen offset:3072 nt lds
 v_mfma_f32_16x16x32_bf16 v[156:159], v[40:43], v[20:23], v[156:159]
 s_waitcnt lgkmcnt(2)
 v_mfma_f32_16x16x32_bf16 v[160:163], v[44:47], v[48:51], v[160:163]
 s_add_u32 s46, s15, 40960
 s_and_b32 s46, s46, 0x1ffff
 s_add_u32 s46, s46, s42
 s_mov_b32 m0, 122880
 s_add_u32 s46, s46, 0
 buffer_load_dwordx4 v28, s[20:23], s46 offen offset:0 nt lds
 v_mfma_f32_16x16x32_bf16 v[164:167], v[44:47], v[52:55], v[164:167]
 ds_read_b64_tr_b16 v[40:41], v60 offset:49408
 ds_read_b64_tr_b16 v[42:43], v60 offset:51456
 v_mfma_f32_16x16x32_bf16 v[168:171], v[44:47], v[56:59], v[168:171]
 buffer_load_dwordx4 v3, s[20:23], s46 offen offset:1024 nt lds
 v_mfma_f32_16x16x32_bf16 v[172:175], v[44:47], v[12:15], v[172:175]
 v_mfma_f32_16x16x32_bf16 v[176:179], v[44:47], v[16:19], v[176:179]
 buffer_load_dwordx4 v28, s[20:23], s46 offen offset:2048 nt lds
 v_mfma_f32_16x16x32_bf16 v[180:183], v[44:47], v[20:23], v[180:183]
 s_waitcnt lgkmcnt(2)
 v_mfma_f32_16x16x32_bf16 v[184:187], v[36:39], v[48:51], v[184:187]
 buffer_load_dwordx4 v3, s[20:23], s46 offen offset:3072 nt lds
 v_mfma_f32_16x16x32_bf16 v[188:191], v[36:39], v[52:55], v[188:191]
 ds_read_b64_tr_b16 v[44:45], v61 offset:49408
 ds_read_b64_tr_b16 v[46:47], v61 offset:51456
 v_mfma_f32_16x16x32_bf16 v[192:195], v[36:39], v[56:59], v[192:195]
 s_add_u32 s46, s15, 40960
 s_and_b32 s46, s46, 0x1ffff
 s_add_u32 s46, s46, s42
 s_mov_b32 m0, 126976
 s_add_u32 s46, s46, 4096
 buffer_load_dwordx4 v28, s[20:23], s46 offen offset:0 nt lds
 v_mfma_f32_16x16x32_bf16 v[196:199], v[36:39], v[12:15], v[196:199]
 v_mfma_f32_16x16x32_bf16 v[200:203], v[36:39], v[16:19], v[200:203]
 buffer_load_dwordx4 v3, s[20:23], s46 offen offset:1024 nt lds
 v_mfma_f32_16x16x32_bf16 v[204:207], v[36:39], v[20:23], v[204:207]
 s_waitcnt lgkmcnt(2)
 v_mfma_f32_16x16x32_bf16 v[208:211], v[40:43], v[48:51], v[208:211]
 buffer_load_dwordx4 v28, s[20:23], s46 offen offset:2048 nt lds
 v_mfma_f32_16x16x32_bf16 v[212:215], v[40:43], v[52:55], v[212:215]
 v_mfma_f32_16x16x32_bf16 v[216:219], v[40:43], v[56:59], v[216:219]
 buffer_load_dwordx4 v3, s[20:23], s46 offen offset:3072 nt lds
 v_mfma_f32_16x16x32_bf16 v[220:223], v[40:43], v[12:15], v[220:223]
 v_mfma_f32_16x16x32_bf16 v[224:227], v[40:43], v[16:19], v[224:227]
 v_mfma_f32_16x16x32_bf16 v[228:231], v[40:43], v[20:23], v[228:231]
 s_waitcnt lgkmcnt(0)
 v_mfma_f32_16x16x32_bf16 v[232:235], v[44:47], v[48:51], v[232:235]
 v_mfma_f32_16x16x32_bf16 v[236:239], v[44:47], v[52:55], v[236:239]
 v_mfma_f32_16x16x32_bf16 v[240:243], v[44:47], v[56:59], v[240:243]
 v_mfma_f32_16x16x32_bf16 v[244:247], v[44:47], v[12:15], v[244:247]
 v_mfma_f32_16x16x32_bf16 v[248:251], v[44:47], v[16:19], v[248:251]
 v_mfma_f32_16x16x32_bf16 v[252:255], v[44:47], v[20:23], v[252:255]
 s_waitcnt lgkmcnt(0)
 s_barrier
 v_lshrrev_b32 v1, 3, v0
 v_and_b32 v2, 7, v0
 v_lshrrev_b32 v16, 4, v0
 v_and_b32 v16, 1, v16
 v_lshlrev_b32 v16, 2, v16
 v_mov_b32 v23, v63
 v_lshrrev_b32 v17, 5, v0
 v_lshlrev_b32 v17, 1, v17
 v_xor_b32 v16, v16, v17
 v_xor_b32 v16, v16, v2
 v_lshlrev_b32 v16, 4, v16
 v_mul_u32_u24 v17, 1152, v1
 v_add_u32 v16, v16, v17
 v_add_u32 v60, 0, v16
 v_add_u32 v61, 8192, v16
 v_add_u32 v62, 16384, v16
 v_add_u32 v63, 24576, v16
 v_lshlrev_b32 v31, 4, v0
 v_add_u32 v31, 147456, v31
M_w3loop:
 s_waitcnt vmcnt(63) lgkmcnt(0)
 s_barrier
 s_add_u32 s46, s15, 65536
 s_and_b32 s46, s46, 0x1ffff
 s_add_u32 s46, s46, s42
 s_mov_b32 m0, 98304
 s_add_u32 s46, s46, 0
 buffer_load_dwordx4 v24, s[16:19], s46 offen offset:0 nt lds
 buffer_load_dwordx4 v25, s[16:19], s46 offen offset:1024 nt lds
 buffer_load_dwordx4 v26, s[16:19], s46 offen offset:2048 nt lds
 buffer_load_dwordx4 v27, s[16:19], s46 offen offset:3072 nt lds
 s_add_u32 s46, s15, 65536
 s_and_b32 s46, s46, 0x1ffff
 s_add_u32 s46, s46, s42
 s_mov_b32 m0, 102400
 s_add_u32 s46, s46, 4096
 buffer_load_dwordx4 v24, s[16:19], s46 offen offset:0 nt lds
 buffer_load_dwordx4 v25, s[16:19], s46 offen offset:1024 nt lds
 buffer_load_dwordx4 v26, s[16:19], s46 offen offset:2048 nt lds
 buffer_load_dwordx4 v27, s[16:19], s46 offen offset:3072 nt lds
 s_add_u32 s46, s15, 49152
 s_and_b32 s46, s46, 0x1ffff
 s_add_u32 s46, s46, s42
 s_mov_b32 m0, 106496
 s_add_u32 s46, s46, 0
 buffer_load_dwordx4 v28, s[20:23], s46 offen offset:0 nt lds
 buffer_load_dwordx4 v3, s[20:23], s46 offen offset:1024 nt lds
 buffer_load_dwordx4 v28, s[20:23], s46 offen offset:2048 nt lds
 buffer_load_dwordx4 v3, s[20:23], s46 offen offset:3072 nt lds
 s_add_u32 s46, s15, 49152
 s_and_b32 s46, s46, 0x1ffff
 s_add_u32 s46, s46, s42
 s_mov_b32 m0, 110592
 s_add_u32 s46, s46, 4096
 buffer_load_dwordx4 v28, s[20:23], s46 offen offset:0 nt lds
 buffer_load_dwordx4 v3, s[20:23], s46 offen offset:1024 nt lds
 buffer_load_dwordx4 v28, s[20:23], s46 offen offset:2048 nt lds
 buffer_load_dwordx4 v3, s[20:23], s46 offen offset:3072 nt lds
 s_cmp_lg_u32 s47, 0
 s_cbranch_scc1 M_w3x0
 v_mul_f32 v64, s48, v64
 v_mul_f32 v65, s48, v65
 v_mul_f32 v66, s48, v66
 v_mul_f32 v67, s48, v67
 v_mul_f32 v88, s48, v88
 v_mul_f32 v89, s48, v89
 v_mul_f32 v90, s48, v90
 v_mul_f32 v91, s48, v91
 v_cvt_pk_bf16_f32 v64, v64, v65
 v_cvt_pk_bf16_f32 v65, v66, v67
 v_cvt_pk_bf16_f32 v88, v88, v89
 v_cvt_pk_bf16_f32 v89, v90, v91
 s_nop 0
 v_permlane16_swap_b32 v64, v88
 v_permlane16_swap_b32 v65, v89
 v_accvgpr_write_b32 a96, v64
 v_accvgpr_write_b32 a97, v65
 v_accvgpr_write_b32 a98, v88
 v_accvgpr_write_b32 a99, v89
 v_mul_f32 v68, s48, v68
 v_mul_f32 v69, s48, v69
 v_mul_f32 v70, s48, v70
 v_mul_f32 v71, s48, v71
 v_mul_f32 v92, s48, v92
 v_mul_f32 v93, s48, v93
 v_mul_f32 v94, s48, v94
 v_mul_f32 v95, s48, v95
 v_cvt_pk_bf16_f32 v68, v68, v69
 v_cvt_pk_bf16_f32 v69, v70, v71
 v_cvt_pk_bf16_f32 v92, v92, v93
 v_cvt_pk_bf16_f32 v93, v94, v95
 s_nop 0
 v_permlane16_swap_b32 v68, v92
 v_permlane16_swap_b32 v69, v93
 v_accvgpr_write_b32 a100, v68
 v_accvgpr_write_b32 a101, v69
 v_accvgpr_write_b32 a102, v92
 v_accvgpr_write_b32 a103, v93
 v_mul_f32 v72, s48, v72
 v_mul_f32 v73, s48, v73
 v_mul_f32 v74, s48, v74
 v_mul_f32 v75, s48, v75
 v_mul_f32 v96, s48, v96
 v_mul_f32 v97, s48, v97
 v_mul_f32 v98, s48, v98
 v_mul_f32 v99, s48, v99
 v_cvt_pk_bf16_f32 v72, v72, v73
 v_cvt_pk_bf16_f32 v73, v74, v75
 v_cvt_pk_bf16_f32 v96, v96, v97
 v_cvt_pk_bf16_f32 v97, v98, v99
 s_nop 0
 v_permlane16_swap_b32 v72, v96
 v_permlane16_swap_b32 v73, v97
 v_accvgpr_write_b32 a128, v72
 v_accvgpr_write_b32 a129, v73
 v_accvgpr_write_b32 a130, v96
 v_accvgpr_write_b32 a131, v97
 v_mul_f32 v76, s48, v76
 v_mul_f32 v77, s48, v77
 v_mul_f32 v78, s48, v78
 v_mul_f32 v79, s48, v79
 v_mul_f32 v100, s48, v100
 v_mul_f32 v101, s48, v101
 v_mul_f32 v102, s48, v102
 v_mul_f32 v103, s48, v103
 v_cvt_pk_bf16_f32 v76, v76, v77
 v_cvt_pk_bf16_f32 v77, v78, v79
 v_cvt_pk_bf16_f32 v100, v100, v101
 v_cvt_pk_bf16_f32 v101, v102, v103
 s_nop 0
 v_permlane16_swap_b32 v76, v100
 v_permlane16_swap_b32 v77, v101
 v_accvgpr_write_b32 a132, v76
 v_accvgpr_write_b32 a133, v77
 v_accvgpr_write_b32 a134, v100
 v_accvgpr_write_b32 a135, v101
 s_waitcnt lgkmcnt(0)
M_w3x0:
 s_waitcnt vmcnt(63) lgkmcnt(0)
 s_barrier
 s_add_u32 s46, s15, 73728
 s_and_b32 s46, s46, 0x1ffff
 s_add_u32 s46, s46, s42
 s_mov_b32 m0, 131072
 s_add_u32 s46, s46, 0
 buffer_load_dwordx4 v24, s[16:19], s46 offen offset:0 nt lds
 buffer_load_dwordx4 v25, s[16:19], s46 offen offset:1024 nt lds
 buffer_load_dwordx4 v26, s[16:19], s46 offen offset:2048 nt lds
 buffer_load_dwordx4 v27, s[16:19], s46 offen offset:3072 nt lds
 s_add_u32 s46, s15, 73728
 s_and_b32 s46, s46, 0x1ffff
 s_add_u32 s46, s46, s42
 s_mov_b32 m0, 135168
 s_add_u32 s46, s46, 4096
 buffer_load_dwordx4 v24, s[16:19], s46 offen offset:0 nt lds
 buffer_load_dwordx4 v25, s[16:19], s46 offen offset:1024 nt lds
 buffer_load_dwordx4 v26, s[16:19], s46 offen offset:2048 nt lds
 buffer_load_dwordx4 v27, s[16:19], s46 offen offset:3072 nt lds
 s_add_u32 s46, s15, 57344
 s_and_b32 s46, s46, 0x1ffff
 s_add_u32 s46, s46, s42
 s_mov_b32 m0, 139264
 s_add_u32 s46, s46, 0
 buffer_load_dwordx4 v28, s[20:23], s46 offen offset:0 nt lds
 buffer_load_dwordx4 v3, s[20:23], s46 offen offset:1024 nt lds
 buffer_load_dwordx4 v28, s[20:23], s46 offen offset:2048 nt lds
 buffer_load_dwordx4 v3, s[20:23], s46 offen offset:3072 nt lds
 s_add_u32 s46, s15, 57344
 s_and_b32 s46, s46, 0x1ffff
 s_add_u32 s46, s46, s42
 s_mov_b32 m0, 143360
 s_add_u32 s46, s46, 4096
 buffer_load_dwordx4 v28, s[20:23], s46 offen offset:0 nt lds
 buffer_load_dwordx4 v3, s[20:23], s46 offen offset:1024 nt lds
 buffer_load_dwordx4 v28, s[20:23], s46 offen offset:2048 nt lds
 buffer_load_dwordx4 v3, s[20:23], s46 offen offset:3072 nt lds
 s_cmp_lg_u32 s47, 0
 s_cbranch_scc1 M_w3x1
 v_mul_f32 v80, s48, v80
 v_mul_f32 v81, s48, v81
 v_mul_f32 v82, s48, v82
 v_mul_f32 v83, s48, v83
 v_mul_f32 v104, s48, v104
 v_mul_f32 v105, s48, v105
 v_mul_f32 v106, s48, v106
 v_mul_f32 v107, s48, v107
 v_cvt_pk_bf16_f32 v80, v80, v81
 v_cvt_pk_bf16_f32 v81, v82, v83
 v_cvt_pk_bf16_f32 v104, v104, v105
 v_cvt_pk_bf16_f32 v105, v106, v107
 s_nop 0
 v_permlane16_swap_b32 v80, v104
 v_permlane16_swap_b32 v81, v105
 v_accvgpr_write_b32 a160, v80
 v_accvgpr_write_b32 a161, v81
 v_accvgpr_write_b32 a162, v104
 v_accvgpr_write_b32 a163, v105
 v_mul_f32 v84, s48, v84
 v_mul_f32 v85, s48, v85
 v_mul_f32 v86, s48, v86
 v_mul_f32 v87, s48, v87
 v_mul_f32 v108, s48, v108
 v_mul_f32 v109, s48, v109
 v_mul_f32 v110, s48, v110
 v_mul_f32 v111, s48, v111
 v_cvt_pk_bf16_f32 v84, v84, v85
 v_cvt_pk_bf16_f32 v85, v86, v87
 v_cvt_pk_bf16_f32 v108, v108, v109
 v_cvt_pk_bf16_f32 v109, v110, v111
 s_nop 0
 v_permlane16_swap_b32 v84, v108
 v_permlane16_swap_b32 v85, v109
 v_accvgpr_write_b32 a164, v84
 v_accvgpr_write_b32 a165, v85
 v_accvgpr_write_b32 a166, v108
 v_accvgpr_write_b32 a167, v109
 v_mul_f32 v112, s48, v112
 v_mul_f32 v113, s48, v113
 v_mul_f32 v114, s48, v114
 v_mul_f32 v115, s48, v115
 v_mul_f32 v136, s48, v136
 v_mul_f32 v137, s48, v137
 v_mul_f32 v138, s48, v138
 v_mul_f32 v139, s48, v139
 v_cvt_pk_bf16_f32 v112, v112, v113
 v_cvt_pk_bf16_f32 v113, v114, v115
 v_cvt_pk_bf16_f32 v136, v136, v137
 v_cvt_pk_bf16_f32 v137, v138, v139
 s_nop 0
 v_permlane16_swap_b32 v112, v136
 v_permlane16_swap_b32 v113, v137
 v_accvgpr_write_b32 a104, v112
 v_accvgpr_write_b32 a105, v113
 v_accvgpr_write_b32 a106, v136
 v_accvgpr_write_b32 a107, v137
 v_mul_f32 v116, s48, v116
 v_mul_f32 v117, s48, v117
 v_mul_f32 v118, s48, v118
 v_mul_f32 v119, s48, v119
 v_mul_f32 v140, s48, v140
 v_mul_f32 v141, s48, v141
 v_mul_f32 v142, s48, v142
 v_mul_f32 v143, s48, v143
 v_cvt_pk_bf16_f32 v116, v116, v117
 v_cvt_pk_bf16_f32 v117, v118, v119
 v_cvt_pk_bf16_f32 v140, v140, v141
 v_cvt_pk_bf16_f32 v141, v142, v143
 s_nop 0
 v_permlane16_swap_b32 v116, v140
 v_permlane16_swap_b32 v117, v141
 v_accvgpr_write_b32 a108, v116
 v_accvgpr_write_b32 a109, v117
 v_accvgpr_write_b32 a110, v140
 v_accvgpr_write_b32 a111, v141
 s_waitcnt lgkmcnt(0)
M_w3x1:
 s_waitcnt vmcnt(63) lgkmcnt(0)
 s_barrier
 s_add_u32 s46, s15, 81920
 s_and_b32 s46, s46, 0x1ffff
 s_add_u32 s46, s46, s42
 s_mov_b32 m0, 0
 s_add_u32 s46, s46, 0
 buffer_load_dwordx4 v24, s[16:19], s46 offen offset:0 nt lds
 buffer_load_dwordx4 v25, s[16:19], s46 offen offset:1024 nt lds
 buffer_load_dwordx4 v26, s[16:19], s46 offen offset:2048 nt lds
 buffer_load_dwordx4 v27, s[16:19], s46 offen offset:3072 nt lds
 s_add_u32 s46, s15, 81920
 s_and_b32 s46, s46, 0x1ffff
 s_add_u32 s46, s46, s42
 s_mov_b32 m0, 4096
 s_add_u32 s46, s46, 4096
 buffer_load_dwordx4 v24, s[16:19], s46 offen offset:0 nt lds
 buffer_load_dwordx4 v25, s[16:19], s46 offen offset:1024 nt lds
 buffer_load_dwordx4 v26, s[16:19], s46 offen offset:2048 nt lds
 buffer_load_dwordx4 v27, s[16:19], s46 offen offset:3072 nt lds
 s_add_u32 s46, s15, 65536
 s_and_b32 s46, s46, 0x1ffff
 s_add_u32 s46, s46, s42
 s_mov_b32 m0, 8192
 s_add_u32 s46, s46, 0
 buffer_load_dwordx4 v28, s[20:23], s46 offen offset:0 nt lds
 buffer_load_dwordx4 v3, s[20:23], s46 offen offset:1024 nt lds
 buffer_load_dwordx4 v28, s[20:23], s46 offen offset:2048 nt lds
 buffer_load_dwordx4 v3, s[20:23], s46 offen offset:3072 nt lds
 s_add_u32 s46, s15, 65536
 s_and_b32 s46, s46, 0x1ffff
 s_add_u32 s46, s46, s42
 s_mov_b32 m0, 12288
 s_add_u32 s46, s46, 4096
 buffer_load_dwordx4 v28, s[20:23], s46 offen offset:0 nt lds
 buffer_load_dwordx4 v3, s[20:23], s46 offen offset:1024 nt lds
 buffer_load_dwordx4 v28, s[20:23], s46 offen offset:2048 nt lds
 buffer_load_dwordx4 v3, s[20:23], s46 offen offset:3072 nt lds
 s_cmp_lg_u32 s47, 0
 s_cbranch_scc1 M_w3x2
 v_mul_f32 v120, s48, v120
 v_mul_f32 v121, s48, v121
 v_mul_f32 v122, s48, v122
 v_mul_f32 v123, s48, v123
 v_mul_f32 v144, s48, v144
 v_mul_f32 v145, s48, v145
 v_mul_f32 v146, s48, v146
 v_mul_f32 v147, s48, v147
 v_cvt_pk_bf16_f32 v120, v120, v121
 v_cvt_pk_bf16_f32 v121, v122, v123
 v_cvt_pk_bf16_f32 v144, v144, v145
 v_cvt_pk_bf16_f32 v145, v146, v147
 s_nop 0
 v_permlane16_swap_b32 v120, v144
 v_permlane16_swap_b32 v121, v145
 v_accvgpr_write_b32 a136, v120
 v_accvgpr_write_b32 a137, v121
 v_accvgpr_write_b32 a138, v144
 v_accvgpr_write_b32 a139, v145
 v_mul_f32 v124, s48, v124
 v_mul_f32 v125, s48, v125
 v_mul_f32 v126, s48, v126
 v_mul_f32 v127, s48, v127
 v_mul_f32 v148, s48, v148
 v_mul_f32 v149, s48, v149
 v_mul_f32 v150, s48, v150
 v_mul_f32 v151, s48, v151
 v_cvt_pk_bf16_f32 v124, v124, v125
 v_cvt_pk_bf16_f32 v125, v126, v127
 v_cvt_pk_bf16_f32 v148, v148, v149
 v_cvt_pk_bf16_f32 v149, v150, v151
 s_nop 0
 v_permlane16_swap_b32 v124, v148
 v_permlane16_swap_b32 v125, v149
 v_accvgpr_write_b32 a140, v124
 v_accvgpr_write_b32 a141, v125
 v_accvgpr_write_b32 a142, v148
 v_accvgpr_write_b32 a143, v149
 v_mul_f32 v128, s48, v128
 v_mul_f32 v129, s48, v129
 v_mul_f32 v130, s48, v130
 v_mul_f32 v131, s48, v131
 v_mul_f32 v152, s48, v152
 v_mul_f32 v153, s48, v153
 v_mul_f32 v154, s48, v154
 v_mul_f32 v155, s48, v155
 v_cvt_pk_bf16_f32 v128, v128, v129
 v_cvt_pk_bf16_f32 v129, v130, v131
 v_cvt_pk_bf16_f32 v152, v152, v153
 v_cvt_pk_bf16_f32 v153, v154, v155
 s_nop 0
 v_permlane16_swap_b32 v128, v152
 v_permlane16_swap_b32 v129, v153
 v_accvgpr_write_b32 a168, v128
 v_accvgpr_write_b32 a169, v129
 v_accvgpr_write_b32 a170, v152
 v_accvgpr_write_b32 a171, v153
 v_mul_f32 v132, s48, v132
 v_mul_f32 v133, s48, v133
 v_mul_f32 v134, s48, v134
 v_mul_f32 v135, s48, v135
 v_mul_f32 v156, s48, v156
 v_mul_f32 v157, s48, v157
 v_mul_f32 v158, s48, v158
 v_mul_f32 v159, s48, v159
 v_cvt_pk_bf16_f32 v132, v132, v133
 v_cvt_pk_bf16_f32 v133, v134, v135
 v_cvt_pk_bf16_f32 v156, v156, v157
 v_cvt_pk_bf16_f32 v157, v158, v159
 s_nop 0
 v_permlane16_swap_b32 v132, v156
 v_permlane16_swap_b32 v133, v157
 v_accvgpr_write_b32 a172, v132
 v_accvgpr_write_b32 a173, v133
 v_accvgpr_write_b32 a174, v156
 v_accvgpr_write_b32 a175, v157
 s_waitcnt lgkmcnt(0)
M_w3x2:
 s_waitcnt vmcnt(63) lgkmcnt(0)
 s_barrier
 s_add_u32 s46, s15, 90112
 s_and_b32 s46, s46, 0x1ffff
 s_add_u32 s46, s46, s42
 s_mov_b32 m0, 32768
 s_add_u32 s46, s46, 0
 buffer_load_dwordx4 v24, s[16:19], s46 offen offset:0 nt lds
 buffer_load_dwordx4 v25, s[16:19], s46 offen offset:1024 nt lds
 buffer_load_dwordx4 v26, s[16:19], s46 offen offset:2048 nt lds
 buffer_load_dwordx4 v27, s[16:19], s46 offen offset:3072 nt lds
 s_add_u32 s46, s15, 90112
 s_and_b32 s46, s46, 0x1ffff
 s_add_u32 s46, s46, s42
 s_mov_b32 m0, 36864
 s_add_u32 s46, s46, 4096
 buffer_load_dwordx4 v24, s[16:19], s46 offen offset:0 nt lds
 buffer_load_dwordx4 v25, s[16:19], s46 offen offset:1024 nt lds
 buffer_load_dwordx4 v26, s[16:19], s46 offen offset:2048 nt lds
 buffer_load_dwordx4 v27, s[16:19], s46 offen offset:3072 nt lds
 s_add_u32 s46, s15, 73728
 s_and_b32 s46, s46, 0x1ffff
 s_add_u32 s46, s46, s42
 s_mov_b32 m0, 40960
 s_add_u32 s46, s46, 0
 buffer_load_dwordx4 v28, s[20:23], s46 offen offset:0 nt lds
 buffer_load_dwordx4 v3, s[20:23], s46 offen offset:1024 nt lds
 buffer_load_dwordx4 v28, s[20:23], s46 offen offset:2048 nt lds
 buffer_load_dwordx4 v3, s[20:23], s46 offen offset:3072 nt lds
 s_add_u32 s46, s15, 73728
 s_and_b32 s46, s46, 0x1ffff
 s_add_u32 s46, s46, s42
 s_mov_b32 m0, 45056
 s_add_u32 s46, s46, 4096
 buffer_load_dwordx4 v28, s[20:23], s46 offen offset:0 nt lds
 buffer_load_dwordx4 v3, s[20:23], s46 offen offset:1024 nt lds
 buffer_load_dwordx4 v28, s[20:23], s46 offen offset:2048 nt lds
 buffer_load_dwordx4 v3, s[20:23], s46 offen offset:3072 nt lds
 s_cmp_lg_u32 s47, 0
 s_cbranch_scc1 M_w3x3
 v_mul_f32 v160, s48, v160
 v_mul_f32 v161, s48, v161
 v_mul_f32 v162, s48, v162
 v_mul_f32 v163, s48, v163
 v_mul_f32 v184, s48, v184
 v_mul_f32 v185, s48, v185
 v_mul_f32 v186, s48, v186
 v_mul_f32 v187, s48, v187
 v_cvt_pk_bf16_f32 v160, v160, v161
 v_cvt_pk_bf16_f32 v161, v162, v163
 v_cvt_pk_bf16_f32 v184, v184, v185
 v_cvt_pk_bf16_f32 v185, v186, v187
 s_nop 0
 v_permlane16_swap_b32 v160, v184
 v_permlane16_swap_b32 v161, v185
 v_accvgpr_write_b32 a112, v160
 v_accvgpr_write_b32 a113, v161
 v_accvgpr_write_b32 a114, v184
 v_accvgpr_write_b32 a115, v185
 v_mul_f32 v164, s48, v164
 v_mul_f32 v165, s48, v165
 v_mul_f32 v166, s48, v166
 v_mul_f32 v167, s48, v167
 v_mul_f32 v188, s48, v188
 v_mul_f32 v189, s48, v189
 v_mul_f32 v190, s48, v190
 v_mul_f32 v191, s48, v191
 v_cvt_pk_bf16_f32 v164, v164, v165
 v_cvt_pk_bf16_f32 v165, v166, v167
 v_cvt_pk_bf16_f32 v188, v188, v189
 v_cvt_pk_bf16_f32 v189, v190, v191
 s_nop 0
 v_permlane16_swap_b32 v164, v188
 v_permlane16_swap_b32 v165, v189
 v_accvgpr_write_b32 a116, v164
 v_accvgpr_write_b32 a117, v165
 v_accvgpr_write_b32 a118, v188
 v_accvgpr_write_b32 a119, v189
 v_mul_f32 v168, s48, v168
 v_mul_f32 v169, s48, v169
 v_mul_f32 v170, s48, v170
 v_mul_f32 v171, s48, v171
 v_mul_f32 v192, s48, v192
 v_mul_f32 v193, s48, v193
 v_mul_f32 v194, s48, v194
 v_mul_f32 v195, s48, v195
 v_cvt_pk_bf16_f32 v168, v168, v169
 v_cvt_pk_bf16_f32 v169, v170, v171
 v_cvt_pk_bf16_f32 v192, v192, v193
 v_cvt_pk_bf16_f32 v193, v194, v195
 s_nop 0
 v_permlane16_swap_b32 v168, v192
 v_permlane16_swap_b32 v169, v193
 v_accvgpr_write_b32 a144, v168
 v_accvgpr_write_b32 a145, v169
 v_accvgpr_write_b32 a146, v192
 v_accvgpr_write_b32 a147, v193
 v_mul_f32 v172, s48, v172
 v_mul_f32 v173, s48, v173
 v_mul_f32 v174, s48, v174
 v_mul_f32 v175, s48, v175
 v_mul_f32 v196, s48, v196
 v_mul_f32 v197, s48, v197
 v_mul_f32 v198, s48, v198
 v_mul_f32 v199, s48, v199
 v_cvt_pk_bf16_f32 v172, v172, v173
 v_cvt_pk_bf16_f32 v173, v174, v175
 v_cvt_pk_bf16_f32 v196, v196, v197
 v_cvt_pk_bf16_f32 v197, v198, v199
 s_nop 0
 v_permlane16_swap_b32 v172, v196
 v_permlane16_swap_b32 v173, v197
 v_accvgpr_write_b32 a148, v172
 v_accvgpr_write_b32 a149, v173
 v_accvgpr_write_b32 a150, v196
 v_accvgpr_write_b32 a151, v197
 s_waitcnt lgkmcnt(0)
M_w3x3:
 s_waitcnt vmcnt(63) lgkmcnt(0)
 s_barrier
 s_add_u32 s46, s15, 98304
 s_and_b32 s46, s46, 0x1ffff
 s_add_u32 s46, s46, s42
 s_mov_b32 m0, 16384
 s_add_u32 s46, s46, 0
 buffer_load_dwordx4 v24, s[16:19], s46 offen offset:0 nt lds
 buffer_load_dwordx4 v25, s[16:19], s46 offen offset:1024 nt lds
 buffer_load_dwordx4 v26, s[16:19], s46 offen offset:2048 nt lds
 buffer_load_dwordx4 v27, s[16:19], s46 offen offset:3072 nt lds
 s_add_u32 s46, s15, 98304
 s_and_b32 s46, s46, 0x1ffff
 s_add_u32 s46, s46, s42
 s_mov_b32 m0, 20480
 s_add_u32 s46, s46, 4096
 buffer_load_dwordx4 v24, s[16:19], s46 offen offset:0 nt lds
 buffer_load_dwordx4 v25, s[16:19], s46 offen offset:1024 nt lds
 buffer_load_dwordx4 v26, s[16:19], s46 offen offset:2048 nt lds
 buffer_load_dwordx4 v27, s[16:19], s46 offen offset:3072 nt lds
 s_add_u32 s46, s15, 81920
 s_and_b32 s46, s46, 0x1ffff
 s_add_u32 s46, s46, s42
 s_mov_b32 m0, 24576
 s_add_u32 s46, s46, 0
 buffer_load_dwordx4 v28, s[20:23], s46 offen offset:0 nt lds
 buffer_load_dwordx4 v3, s[20:23], s46 offen offset:1024 nt lds
 buffer_load_dwordx4 v28, s[20:23], s46 offen offset:2048 nt lds
 buffer_load_dwordx4 v3, s[20:23], s46 offen offset:3072 nt lds
 s_add_u32 s46, s15, 81920
 s_and_b32 s46, s46, 0x1ffff
 s_add_u32 s46, s46, s42
 s_mov_b32 m0, 28672
 s_add_u32 s46, s46, 4096
 buffer_load_dwordx4 v28, s[20:23], s46 offen offset:0 nt lds
 buffer_load_dwordx4 v3, s[20:23], s46 offen offset:1024 nt lds
 buffer_load_dwordx4 v28, s[20:23], s46 offen offset:2048 nt lds
 buffer_load_dwordx4 v3, s[20:23], s46 offen offset:3072 nt lds
 s_cmp_lg_u32 s47, 0
 s_cbranch_scc1 M_w3x4
 v_mul_f32 v176, s48, v176
 v_mul_f32 v177, s48, v177
 v_mul_f32 v178, s48, v178
 v_mul_f32 v179, s48, v179
 v_mul_f32 v200, s48, v200
 v_mul_f32 v201, s48, v201
 v_mul_f32 v202, s48, v202
 v_mul_f32 v203, s48, v203
 v_cvt_pk_bf16_f32 v176, v176, v177
 v_cvt_pk_bf16_f32 v177, v178, v179
 v_cvt_pk_bf16_f32 v200, v200, v201
 v_cvt_pk_bf16_f32 v201, v202, v203
 s_nop 0
 v_permlane16_swap_b32 v176, v200
 v_permlane16_swap_b32 v177, v201
 v_accvgpr_write_b32 a176, v176
 v_accvgpr_write_b32 a177, v177
 v_accvgpr_write_b32 a178, v200
 v_accvgpr_write_b32 a179, v201
 v_mul_f32 v180, s48, v180
 v_mul_f32 v181, s48, v181
 v_mul_f32 v182, s48, v182
 v_mul_f32 v183, s48, v183
 v_mul_f32 v204, s48, v204
 v_mul_f32 v205, s48, v205
 v_mul_f32 v206, s48, v206
 v_mul_f32 v207, s48, v207
 v_cvt_pk_bf16_f32 v180, v180, v181
 v_cvt_pk_bf16_f32 v181, v182, v183
 v_cvt_pk_bf16_f32 v204, v204, v205
 v_cvt_pk_bf16_f32 v205, v206, v207
 s_nop 0
 v_permlane16_swap_b32 v180, v204
 v_permlane16_swap_b32 v181, v205
 v_accvgpr_write_b32 a180, v180
 v_accvgpr_write_b32 a181, v181
 v_accvgpr_write_b32 a182, v204
 v_accvgpr_write_b32 a183, v205
 v_mul_f32 v208, s48, v208
 v_mul_f32 v209, s48, v209
 v_mul_f32 v210, s48, v210
 v_mul_f32 v211, s48, v211
 v_mul_f32 v232, s48, v232
 v_mul_f32 v233, s48, v233
 v_mul_f32 v234, s48, v234
 v_mul_f32 v235, s48, v235
 v_cvt_pk_bf16_f32 v208, v208, v209
 v_cvt_pk_bf16_f32 v209, v210, v211
 v_cvt_pk_bf16_f32 v232, v232, v233
 v_cvt_pk_bf16_f32 v233, v234, v235
 s_nop 0
 v_permlane16_swap_b32 v208, v232
 v_permlane16_swap_b32 v209, v233
 v_accvgpr_write_b32 a120, v208
 v_accvgpr_write_b32 a121, v209
 v_accvgpr_write_b32 a122, v232
 v_accvgpr_write_b32 a123, v233
 v_mul_f32 v212, s48, v212
 v_mul_f32 v213, s48, v213
 v_mul_f32 v214, s48, v214
 v_mul_f32 v215, s48, v215
 v_mul_f32 v236, s48, v236
 v_mul_f32 v237, s48, v237
 v_mul_f32 v238, s48, v238
 v_mul_f32 v239, s48, v239
 v_cvt_pk_bf16_f32 v212, v212, v213
 v_cvt_pk_bf16_f32 v213, v214, v215
 v_cvt_pk_bf16_f32 v236, v236, v237
 v_cvt_pk_bf16_f32 v237, v238, v239
 s_nop 0
 v_permlane16_swap_b32 v212, v236
 v_permlane16_swap_b32 v213, v237
 v_accvgpr_write_b32 a124, v212
 v_accvgpr_write_b32 a125, v213
 v_accvgpr_write_b32 a126, v236
 v_accvgpr_write_b32 a127, v237
 s_waitcnt lgkmcnt(0)
M_w3x4:
 s_waitcnt vmcnt(63) lgkmcnt(0)
 s_barrier
 s_add_u32 s46, s15, 106496
 s_and_b32 s46, s46, 0x1ffff
 s_add_u32 s46, s46, s42
 s_mov_b32 m0, 81920
 s_add_u32 s46, s46, 0
 buffer_load_dwordx4 v24, s[16:19], s46 offen offset:0 nt lds
 buffer_load_dwordx4 v25, s[16:19], s46 offen offset:1024 nt lds
 buffer_load_dwordx4 v26, s[16:19], s46 offen offset:2048 nt lds
 buffer_load_dwordx4 v27, s[16:19], s46 offen offset:3072 nt lds
 s_add_u32 s46, s15, 106496
 s_and_b32 s46, s46, 0x1ffff
 s_add_u32 s46, s46, s42
 s_mov_b32 m0, 86016
 s_add_u32 s46, s46, 4096
 buffer_load_dwordx4 v24, s[16:19], s46 offen offset:0 nt lds
 buffer_load_dwordx4 v25, s[16:19], s46 offen offset:1024 nt lds
 buffer_load_dwordx4 v26, s[16:19], s46 offen offset:2048 nt lds
 buffer_load_dwordx4 v27, s[16:19], s46 offen offset:3072 nt lds
 s_add_u32 s46, s15, 90112
 s_and_b32 s46, s46, 0x1ffff
 s_add_u32 s46, s46, s42
 s_mov_b32 m0, 90112
 s_add_u32 s46, s46, 0
 buffer_load_dwordx4 v28, s[20:23], s46 offen offset:0 nt lds
 buffer_load_dwordx4 v3, s[20:23], s46 offen offset:1024 nt lds
 buffer_load_dwordx4 v28, s[20:23], s46 offen offset:2048 nt lds
 buffer_load_dwordx4 v3, s[20:23], s46 offen offset:3072 nt lds
 s_add_u32 s46, s15, 90112
 s_and_b32 s46, s46, 0x1ffff
 s_add_u32 s46, s46, s42
 s_mov_b32 m0, 94208
 s_add_u32 s46, s46, 4096
 buffer_load_dwordx4 v28, s[20:23], s46 offen offset:0 nt lds
 buffer_load_dwordx4 v3, s[20:23], s46 offen offset:1024 nt lds
 buffer_load_dwordx4 v28, s[20:23], s46 offen offset:2048 nt lds
 buffer_load_dwordx4 v3, s[20:23], s46 offen offset:3072 nt lds
 s_cmp_lg_u32 s47, 0
 s_cbranch_scc1 M_w3x5
 v_mul_f32 v216, s48, v216
 v_mul_f32 v217, s48, v217
 v_mul_f32 v218, s48, v218
 v_mul_f32 v219, s48, v219
 v_mul_f32 v240, s48, v240
 v_mul_f32 v241, s48, v241
 v_mul_f32 v242, s48, v242
 v_mul_f32 v243, s48, v243
 v_cvt_pk_bf16_f32 v216, v216, v217
 v_cvt_pk_bf16_f32 v217, v218, v219
 v_cvt_pk_bf16_f32 v240, v240, v241
 v_cvt_pk_bf16_f32 v241, v242, v243
 s_nop 0
 v_permlane16_swap_b32 v216, v240
 v_permlane16_swap_b32 v217, v241
 v_accvgpr_write_b32 a152, v216
 v_accvgpr_write_b32 a153, v217
 v_accvgpr_write_b32 a154, v240
 v_accvgpr_write_b32 a155, v241
 v_mul_f32 v220, s48, v220
 v_mul_f32 v221, s48, v221
 v_mul_f32 v222, s48, v222
 v_mul_f32 v223, s48, v223
 v_mul_f32 v244, s48, v244
 v_mul_f32 v245, s48, v245
 v_mul_f32 v246, s48, v246
 v_mul_f32 v247, s48, v247
 v_cvt_pk_bf16_f32 v220, v220, v221
 v_cvt_pk_bf16_f32 v221, v222, v223
 v_cvt_pk_bf16_f32 v244, v244, v245
 v_cvt_pk_bf16_f32 v245, v246, v247
 s_nop 0
 v_permlane16_swap_b32 v220, v244
 v_permlane16_swap_b32 v221, v245
 v_accvgpr_write_b32 a156, v220
 v_accvgpr_write_b32 a157, v221
 v_accvgpr_write_b32 a158, v244
 v_accvgpr_write_b32 a159, v245
 v_mul_f32 v224, s48, v224
 v_mul_f32 v225, s48, v225
 v_mul_f32 v226, s48, v226
 v_mul_f32 v227, s48, v227
 v_mul_f32 v248, s48, v248
 v_mul_f32 v249, s48, v249
 v_mul_f32 v250, s48, v250
 v_mul_f32 v251, s48, v251
 v_cvt_pk_bf16_f32 v224, v224, v225
 v_cvt_pk_bf16_f32 v225, v226, v227
 v_cvt_pk_bf16_f32 v248, v248, v249
 v_cvt_pk_bf16_f32 v249, v250, v251
 s_nop 0
 v_permlane16_swap_b32 v224, v248
 v_permlane16_swap_b32 v225, v249
 v_accvgpr_write_b32 a184, v224
 v_accvgpr_write_b32 a185, v225
 v_accvgpr_write_b32 a186, v248
 v_accvgpr_write_b32 a187, v249
 v_mul_f32 v228, s48, v228
 v_mul_f32 v229, s48, v229
 v_mul_f32 v230, s48, v230
 v_mul_f32 v231, s48, v231
 v_mul_f32 v252, s48, v252
 v_mul_f32 v253, s48, v253
 v_mul_f32 v254, s48, v254
 v_mul_f32 v255, s48, v255
 v_cvt_pk_bf16_f32 v228, v228, v229
 v_cvt_pk_bf16_f32 v229, v230, v231
 v_cvt_pk_bf16_f32 v252, v252, v253
 v_cvt_pk_bf16_f32 v253, v254, v255
 s_nop 0
 v_permlane16_swap_b32 v228, v252
 v_permlane16_swap_b32 v229, v253
 v_accvgpr_write_b32 a188, v228
 v_accvgpr_write_b32 a189, v229
 v_accvgpr_write_b32 a190, v252
 v_accvgpr_write_b32 a191, v253
 s_waitcnt lgkmcnt(0)
M_w3x5:
 s_waitcnt vmcnt(63) lgkmcnt(0)
 s_barrier
 s_add_u32 s91, s45, s80
 s_mov_b32 m0, 49152
 s_add_u32 s46, s91, 0
 buffer_load_dwordx4 v60, s[28:31], s46 offen offset:0 lds
 buffer_load_dwordx4 v61, s[28:31], s46 offen offset:1024 lds
 buffer_load_dwordx4 v62, s[28:31], s46 offen offset:2048 lds
 buffer_load_dwordx4 v63, s[28:31], s46 offen offset:3072 lds
 s_mov_b32 m0, 53248
 s_add_u32 s46, s91, 36864
 buffer_load_dwordx4 v60, s[28:31], s46 offen offset:0 lds
 buffer_load_dwordx4 v61, s[28:31], s46 offen offset:1024 lds
 buffer_load_dwordx4 v62, s[28:31], s46 offen offset:2048 lds
 buffer_load_dwordx4 v63, s[28:31], s46 offen offset:3072 lds
 s_mov_b32 m0, 57344
 s_add_u32 s46, s91, 73728
 buffer_load_dwordx4 v60, s[28:31], s46 offen offset:0 lds
 buffer_load_dwordx4 v61, s[28:31], s46 offen offset:1024 lds
 buffer_load_dwordx4 v62, s[28:31], s46 offen offset:2048 lds
 buffer_load_dwordx4 v63, s[28:31], s46 offen offset:3072 lds
 s_mov_b32 m0, 61440
 s_add_u32 s46, s91, 110592
 buffer_load_dwordx4 v60, s[28:31], s46 offen offset:0 lds
 buffer_load_dwordx4 v61, s[28:31], s46 offen offset:1024 lds
 buffer_load_dwordx4 v62, s[28:31], s46 offen offset:2048 lds
 buffer_load_dwordx4 v63, s[28:31], s46 offen offset:3072 lds
 s_waitcnt vmcnt(63) lgkmcnt(0)
 s_barrier
 s_add_u32 s46, s15, 114688
 s_and_b32 s46, s46, 0x1ffff
 s_add_u32 s46, s46, s42
 s_mov_b32 m0, 114688
 s_add_u32 s46, s46, 0
 buffer_load_dwordx4 v24, s[16:19], s46 offen offset:0 nt lds
 buffer_load_dwordx4 v25, s[16:19], s46 offen offset:1024 nt lds
 buffer_load_dwordx4 v26, s[16:19], s46 offen offset:2048 nt lds
 buffer_load_dwordx4 v27, s[16:19], s46 offen offset:3072 nt lds
 s_add_u32 s46, s15, 114688
 s_and_b32 s46, s46, 0x1ffff
 s_add_u32 s46, s46, s42
 s_mov_b32 m0, 118784
 s_add_u32 s46, s46, 4096
 buffer_load_dwordx4 v24, s[16:19], s46 offen offset:0 nt lds
 buffer_load_dwordx4 v25, s[16:19], s46 offen offset:1024 nt lds
 buffer_load_dwordx4 v26, s[16:19], s46 offen offset:2048 nt lds
 buffer_load_dwordx4 v27, s[16:19], s46 offen offset:3072 nt lds
 s_add_u32 s46, s15, 98304
 s_and_b32 s46, s46, 0x1ffff
 s_add_u32 s46, s46, s42
 s_mov_b32 m0, 122880
 s_add_u32 s46, s46, 0
 buffer_load_dwordx4 v28, s[20:23], s46 offen offset:0 nt lds
 buffer_load_dwordx4 v3, s[20:23], s46 offen offset:1024 nt lds
 buffer_load_dwordx4 v28, s[20:23], s46 offen offset:2048 nt lds
 buffer_load_dwordx4 v3, s[20:23], s46 offen offset:3072 nt lds
 s_add_u32 s46, s15, 98304
 s_and_b32 s46, s46, 0x1ffff
 s_add_u32 s46, s46, s42
 s_mov_b32 m0, 126976
 s_add_u32 s46, s46, 4096
 buffer_load_dwordx4 v28, s[20:23], s46 offen offset:0 nt lds
 buffer_load_dwordx4 v3, s[20:23], s46 offen offset:1024 nt lds
 buffer_load_dwordx4 v28, s[20:23], s46 offen offset:2048 nt lds
 buffer_load_dwordx4 v3, s[20:23], s46 offen offset:3072 nt lds
 s_waitcnt vmcnt(63) lgkmcnt(0)
 s_barrier
 s_add_u32 s91, s45, s81
 s_mov_b32 m0, 65536
 s_add_u32 s46, s91, 0
 buffer_load_dwordx4 v60, s[28:31], s46 offen offset:0 lds
 buffer_load_dwordx4 v61, s[28:31], s46 offen offset:1024 lds
 buffer_load_dwordx4 v62, s[28:31], s46 offen offset:2048 lds
 buffer_load_dwordx4 v63, s[28:31], s46 offen offset:3072 lds
 s_mov_b32 m0, 69632
 s_add_u32 s46, s91, 36864
 buffer_load_dwordx4 v60, s[28:31], s46 offen offset:0 lds
 buffer_load_dwordx4 v61, s[28:31], s46 offen offset:1024 lds
 buffer_load_dwordx4 v62, s[28:31], s46 offen offset:2048 lds
 buffer_load_dwordx4 v63, s[28:31], s46 offen offset:3072 lds
 s_mov_b32 m0, 73728
 s_add_u32 s46, s91, 73728
 buffer_load_dwordx4 v60, s[28:31], s46 offen offset:0 lds
 buffer_load_dwordx4 v61, s[28:31], s46 offen offset:1024 lds
 buffer_load_dwordx4 v62, s[28:31], s46 offen offset:2048 lds
 buffer_load_dwordx4 v63, s[28:31], s46 offen offset:3072 lds
 s_mov_b32 m0, 77824
 s_add_u32 s46, s91, 110592
 buffer_load_dwordx4 v60, s[28:31], s46 offen offset:0 lds
 buffer_load_dwordx4 v61, s[28:31], s46 offen offset:1024 lds
 buffer_load_dwordx4 v62, s[28:31], s46 offen offset:2048 lds
 buffer_load_dwordx4 v63, s[28:31], s46 offen offset:3072 lds
 s_cmp_lg_u32 s47, 0
 s_cbranch_scc1 M_w3x8
 ds_read_b128 a[0:3], v31 offset:0
 ds_read_b128 a[4:7], v31 offset:1024
 ds_read_b128 a[8:11], v31 offset:2048
 ds_read_b128 a[12:15], v31 offset:3072
 ds_read_b128 a[32:35], v31 offset:4096
 ds_read_b128 a[36:39], v31 offset:5120
 ds_read_b128 a[40:43], v31 offset:6144
 ds_read_b128 a[44:47], v31 offset:7168
 ds_read_b128 a[64:67], v31 offset:8192
 ds_read_b128 a[68:71], v31 offset:9216
 ds_read_b128 a[72:75], v31 offset:10240
 ds_read_b128 a[76:79], v31 offset:11264
 s_waitcnt lgkmcnt(0)
M_w3x8:
 s_waitcnt vmcnt(63) lgkmcnt(0)
 s_barrier
 s_add_u32 s46, s15, 122880
 s_and_b32 s46, s46, 0x1ffff
 s_add_u32 s46, s46, s42
 s_mov_b32 m0, 131072
 s_add_u32 s46, s46, 0
 buffer_load_dwordx4 v24, s[16:19], s46 offen offset:0 nt lds
 buffer_load_dwordx4 v25, s[16:19], s46 offen offset:1024 nt lds
 buffer_load_dwordx4 v26, s[16:19], s46 offen offset:2048 nt lds
 buffer_load_dwordx4 v27, s[16:19], s46 offen offset:3072 nt lds
 s_add_u32 s46, s15, 122880
 s_and_b32 s46, s46, 0x1ffff
 s_add_u32 s46, s46, s42
 s_mov_b32 m0, 135168
 s_add_u32 s46, s46, 4096
 buffer_load_dwordx4 v24, s[16:19], s46 offen offset:0 nt lds
 buffer_load_dwordx4 v25, s[16:19], s46 offen offset:1024 nt lds
 buffer_load_dwordx4 v26, s[16:19], s46 offen offset:2048 nt lds
 buffer_load_dwordx4 v27, s[16:19], s46 offen offset:3072 nt lds
 s_add_u32 s46, s15, 106496
 s_and_b32 s46, s46, 0x1ffff
 s_add_u32 s46, s46, s42
 s_mov_b32 m0, 139264
 s_add_u32 s46, s46, 0
 buffer_load_dwordx4 v28, s[20:23], s46 offen offset:0 nt lds
 buffer_load_dwordx4 v3, s[20:23], s46 offen offset:1024 nt lds
 buffer_load_dwordx4 v28, s[20:23], s46 offen offset:2048 nt lds
 buffer_load_dwordx4 v3, s[20:23], s46 offen offset:3072 nt lds
 s_add_u32 s46, s15, 106496
 s_and_b32 s46, s46, 0x1ffff
 s_add_u32 s46, s46, s42
 s_mov_b32 m0, 143360
 s_add_u32 s46, s46, 4096
 buffer_load_dwordx4 v28, s[20:23], s46 offen offset:0 nt lds
 buffer_load_dwordx4 v3, s[20:23], s46 offen offset:1024 nt lds
 buffer_load_dwordx4 v28, s[20:23], s46 offen offset:2048 nt lds
 buffer_load_dwordx4 v3, s[20:23], s46 offen offset:3072 nt lds
 s_call_b64 s[40:41], M_warm_more
 s_waitcnt vmcnt(63) lgkmcnt(0)
 s_barrier
 s_add_u32 s91, s45, s82
 s_mov_b32 m0, 98304
 s_add_u32 s46, s91, 0
 buffer_load_dwordx4 v60, s[28:31], s46 offen offset:0 lds
 buffer_load_dwordx4 v61, s[28:31], s46 offen offset:1024 lds
 buffer_load_dwordx4 v62, s[28:31], s46 offen offset:2048 lds
 buffer_load_dwordx4 v63, s[28:31], s46 offen offset:3072 lds
 s_mov_b32 m0, 102400
 s_add_u32 s46, s91, 36864
 buffer_load_dwordx4 v60, s[28:31], s46 offen offset:0 lds
 buffer_load_dwordx4 v61, s[28:31], s46 offen offset:1024 lds
 buffer_load_dwordx4 v62, s[28:31], s46 offen offset:2048 lds
 buffer_load_dwordx4 v63, s[28:31], s46 offen offset:3072 lds
 s_mov_b32 m0, 106496
 s_add_u32 s46, s91, 73728
 buffer_load_dwordx4 v60, s[28:31], s46 offen offset:0 lds
 buffer_load_dwordx4 v61, s[28:31], s46 offen offset:1024 lds
 buffer_load_dwordx4 v62, s[28:31], s46 offen offset:2048 lds
 buffer_load_dwordx4 v63, s[28:31], s46 offen offset:3072 lds
 s_mov_b32 m0, 110592
 s_add_u32 s46, s91, 110592
 buffer_load_dwordx4 v60, s[28:31], s46 offen offset:0 lds
 buffer_load_dwordx4 v61, s[28:31], s46 offen offset:1024 lds
 buffer_load_dwordx4 v62, s[28:31], s46 offen offset:2048 lds
 buffer_load_dwordx4 v63, s[28:31], s46 offen offset:3072 lds
 s_waitcnt vmcnt(63) lgkmcnt(0)
 s_barrier
 s_add_u32 s46, s15, 114688
 s_and_b32 s46, s46, 0x1ffff
 s_add_u32 s46, s46, s42
 s_mov_b32 m0, 32768
 s_add_u32 s46, s46, 0
 buffer_load_dwordx4 v28, s[20:23], s46 offen offset:0 nt lds
 buffer_load_dwordx4 v3, s[20:23], s46 offen offset:1024 nt lds
 buffer_load_dwordx4 v28, s[20:23], s46 offen offset:2048 nt lds
 buffer_load_dwordx4 v3, s[20:23], s46 offen offset:3072 nt lds
 s_add_u32 s46, s15, 114688
 s_and_b32 s46, s46, 0x1ffff
 s_add_u32 s46, s46, s42
 s_mov_b32 m0, 36864
 s_add_u32 s46, s46, 4096
 buffer_load_dwordx4 v28, s[20:23], s46 offen offset:0 nt lds
 buffer_load_dwordx4 v3, s[20:23], s46 offen offset:1024 nt lds
 buffer_load_dwordx4 v28, s[20:23], s46 offen offset:2048 nt lds
 buffer_load_dwordx4 v3, s[20:23], s46 offen offset:3072 nt lds
 s_add_u32 s46, s15, 122880
 s_and_b32 s46, s46, 0x1ffff
 s_add_u32 s46, s46, s42
 s_mov_b32 m0, 40960
 s_add_u32 s46, s46, 0
 buffer_load_dwordx4 v28, s[20:23], s46 offen offset:0 nt lds
 buffer_load_dwordx4 v3, s[20:23], s46 offen offset:1024 nt lds
 buffer_load_dwordx4 v28, s[20:23], s46 offen offset:2048 nt lds
 buffer_load_dwordx4 v3, s[20:23], s46 offen offset:3072 nt lds
 s_add_u32 s46, s15, 122880
 s_and_b32 s46, s46, 0x1ffff
 s_add_u32 s46, s46, s42
 s_mov_b32 m0, 45056
 s_add_u32 s46, s46, 4096
 buffer_load_dwordx4 v28, s[20:23], s46 offen offset:0 nt lds
 buffer_load_dwordx4 v3, s[20:23], s46 offen offset:1024 nt lds
 buffer_load_dwordx4 v28, s[20:23], s46 offen offset:2048 nt lds
 buffer_load_dwordx4 v3, s[20:23], s46 offen offset:3072 nt lds
 s_cmp_lg_u32 s47, 0
 s_cbranch_scc1 M_w3x11
 ds_read_b128 a[16:19], v31 offset:0
 ds_read_b128 a[20:23], v31 offset:1024
 ds_read_b128 a[24:27], v31 offset:2048
 ds_read_b128 a[28:31], v31 offset:3072
 ds_read_b128 a[48:51], v31 offset:4096
 ds_read_b128 a[52:55], v31 offset:5120
 ds_read_b128 a[56:59], v31 offset:6144
 ds_read_b128 a[60:63], v31 offset:7168
 ds_read_b128 a[80:83], v31 offset:8192
 ds_read_b128 a[84:87], v31 offset:9216
 ds_read_b128 a[88:91], v31 offset:10240
 ds_read_b128 a[92:95], v31 offset:11264
 s_waitcnt lgkmcnt(0)
M_w3x11:
 s_waitcnt vmcnt(63) lgkmcnt(0)
 s_barrier
 s_waitcnt vmcnt(63) lgkmcnt(0)
 s_barrier
 s_add_u32 s91, s45, s83
 s_mov_b32 m0, 81920
 s_add_u32 s46, s91, 0
 buffer_load_dwordx4 v60, s[28:31], s46 offen offset:0 lds
 buffer_load_dwordx4 v61, s[28:31], s46 offen offset:1024 lds
 buffer_load_dwordx4 v62, s[28:31], s46 offen offset:2048 lds
 buffer_load_dwordx4 v63, s[28:31], s46 offen offset:3072 lds
 s_mov_b32 m0, 86016
 s_add_u32 s46, s91, 36864
 buffer_load_dwordx4 v60, s[28:31], s46 offen offset:0 lds
 buffer_load_dwordx4 v61, s[28:31], s46 offen offset:1024 lds
 buffer_load_dwordx4 v62, s[28:31], s46 offen offset:2048 lds
 buffer_load_dwordx4 v63, s[28:31], s46 offen offset:3072 lds
 s_mov_b32 m0, 90112
 s_add_u32 s46, s91, 73728
 buffer_load_dwordx4 v60, s[28:31], s46 offen offset:0 lds
 buffer_load_dwordx4 v61, s[28:31], s46 offen offset:1024 lds
 buffer_load_dwordx4 v62, s[28:31], s46 offen offset:2048 lds
 buffer_load_dwordx4 v63, s[28:31], s46 offen offset:3072 lds
 s_mov_b32 m0, 94208
 s_add_u32 s46, s91, 110592
 buffer_load_dwordx4 v60, s[28:31], s46 offen offset:0 lds
 buffer_load_dwordx4 v61, s[28:31], s46 offen offset:1024 lds
 buffer_load_dwordx4 v62, s[28:31], s46 offen offset:2048 lds
 buffer_load_dwordx4 v63, s[28:31], s46 offen offset:3072 lds
 s_add_u32 s42, s42, 0x20000
 s_add_u32 s46, s15, 0
 s_and_b32 s46, s46, 0x1ffff
 s_add_u32 s46, s46, s42
 s_mov_b32 m0, 0
 s_add_u32 s46, s46, 0
 buffer_load_dwordx4 v24, s[16:19], s46 offen offset:0 nt lds
 buffer_load_dwordx4 v25, s[16:19], s46 offen offset:1024 nt lds
 buffer_load_dwordx4 v26, s[16:19], s46 offen offset:2048 nt lds
 buffer_load_dwordx4 v27, s[16:19], s46 offen offset:3072 nt lds
 s_add_u32 s46, s15, 0
 s_and_b32 s46, s46, 0x1ffff
 s_add_u32 s46, s46, s42
 s_mov_b32 m0, 4096
 s_add_u32 s46, s46, 4096
 buffer_load_dwordx4 v24, s[16:19], s46 offen offset:0 nt lds
 buffer_load_dwordx4 v25, s[16:19], s46 offen offset:1024 nt lds
 buffer_load_dwordx4 v26, s[16:19], s46 offen offset:2048 nt lds
 buffer_load_dwordx4 v27, s[16:19], s46 offen offset:3072 nt lds
 s_add_u32 s46, s15, 8192
 s_and_b32 s46, s46, 0x1ffff
 s_add_u32 s46, s46, s42
 s_mov_b32 m0, 8192
 s_add_u32 s46, s46, 0
 buffer_load_dwordx4 v24, s[16:19], s46 offen offset:0 nt lds
 buffer_load_dwordx4 v25, s[16:19], s46 offen offset:1024 nt lds
 buffer_load_dwordx4 v26, s[16:19], s46 offen offset:2048 nt lds
 buffer_load_dwordx4 v27, s[16:19], s46 offen offset:3072 nt lds
 s_add_u32 s46, s15, 8192
 s_and_b32 s46, s46, 0x1ffff
 s_add_u32 s46, s46, s42
 s_mov_b32 m0, 12288
 s_add_u32 s46, s46, 4096
 buffer_load_dwordx4 v24, s[16:19], s46 offen offset:0 nt lds
 buffer_load_dwordx4 v25, s[16:19], s46 offen offset:1024 nt lds
 buffer_load_dwordx4 v26, s[16:19], s46 offen offset:2048 nt lds
 buffer_load_dwordx4 v27, s[16:19], s46 offen offset:3072 nt lds
 s_waitcnt vmcnt(63) lgkmcnt(0)
 s_barrier
 s_add_u32 s91, s45, s84
 s_mov_b32 m0, 114688
 s_add_u32 s46, s91, 0
 buffer_load_dwordx4 v60, s[28:31], s46 offen offset:0 lds
 buffer_load_dwordx4 v61, s[28:31], s46 offen offset:1024 lds
 buffer_load_dwordx4 v62, s[28:31], s46 offen offset:2048 lds
 buffer_load_dwordx4 v63, s[28:31], s46 offen offset:3072 lds
 s_mov_b32 m0, 118784
 s_add_u32 s46, s91, 36864
 buffer_load_dwordx4 v60, s[28:31], s46 offen offset:0 lds
 buffer_load_dwordx4 v61, s[28:31], s46 offen offset:1024 lds
 buffer_load_dwordx4 v62, s[28:31], s46 offen offset:2048 lds
 buffer_load_dwordx4 v63, s[28:31], s46 offen offset:3072 lds
 s_mov_b32 m0, 122880
 s_add_u32 s46, s91, 73728
 buffer_load_dwordx4 v60, s[28:31], s46 offen offset:0 lds
 buffer_load_dwordx4 v61, s[28:31], s46 offen offset:1024 lds
 buffer_load_dwordx4 v62, s[28:31], s46 offen offset:2048 lds
 buffer_load_dwordx4 v63, s[28:31], s46 offen offset:3072 lds
 s_mov_b32 m0, 126976
 s_add_u32 s46, s91, 110592
 buffer_load_dwordx4 v60, s[28:31], s46 offen offset:0 lds
 buffer_load_dwordx4 v61, s[28:31], s46 offen offset:1024 lds
 buffer_load_dwordx4 v62, s[28:31], s46 offen offset:2048 lds
 buffer_load_dwordx4 v63, s[28:31], s46 offen offset:3072 lds
 s_waitcnt vmcnt(48) lgkmcnt(0)
 s_barrier
 s_add_u32 s46, s15, 16384
 s_and_b32 s46, s46, 0x1ffff
 s_add_u32 s46, s46, s42
 s_mov_b32 m0, 16384
 s_add_u32 s46, s46, 0
 buffer_load_dwordx4 v24, s[16:19], s46 offen offset:0 nt lds
 buffer_load_dwordx4 v25, s[16:19], s46 offen offset:1024 nt lds
 buffer_load_dwordx4 v26, s[16:19], s46 offen offset:2048 nt lds
 buffer_load_dwordx4 v27, s[16:19], s46 offen offset:3072 nt lds
 s_add_u32 s46, s15, 16384
 s_and_b32 s46, s46, 0x1ffff
 s_add_u32 s46, s46, s42
 s_mov_b32 m0, 20480
 s_add_u32 s46, s46, 4096
 buffer_load_dwordx4 v24, s[16:19], s46 offen offset:0 nt lds
 buffer_load_dwordx4 v25, s[16:19], s46 offen offset:1024 nt lds
 buffer_load_dwordx4 v26, s[16:19], s46 offen offset:2048 nt lds
 buffer_load_dwordx4 v27, s[16:19], s46 offen offset:3072 nt lds
 s_add_u32 s46, s15, 0
 s_and_b32 s46, s46, 0x1ffff
 s_add_u32 s46, s46, s42
 s_mov_b32 m0, 24576
 s_add_u32 s46, s46, 0
 buffer_load_dwordx4 v28, s[20:23], s46 offen offset:0 nt lds
 buffer_load_dwordx4 v3, s[20:23], s46 offen offset:1024 nt lds
 buffer_load_dwordx4 v28, s[20:23], s46 offen offset:2048 nt lds
 buffer_load_dwordx4 v3, s[20:23], s46 offen offset:3072 nt lds
 s_add_u32 s46, s15, 0
 s_and_b32 s46, s46, 0x1ffff
 s_add_u32 s46, s46, s42
 s_mov_b32 m0, 28672
 s_add_u32 s46, s46, 4096
 buffer_load_dwordx4 v28, s[20:23], s46 offen offset:0 nt lds
 buffer_load_dwordx4 v3, s[20:23], s46 offen offset:1024 nt lds
 buffer_load_dwordx4 v28, s[20:23], s46 offen offset:2048 nt lds
 buffer_load_dwordx4 v3, s[20:23], s46 offen offset:3072 nt lds
 s_waitcnt vmcnt(63) lgkmcnt(0)
 s_barrier
 s_add_u32 s91, s45, s85
 s_mov_b32 m0, 131072
 s_add_u32 s46, s91, 0
 buffer_load_dwordx4 v60, s[28:31], s46 offen offset:0 lds
 buffer_load_dwordx4 v61, s[28:31], s46 offen offset:1024 lds
 buffer_load_dwordx4 v62, s[28:31], s46 offen offset:2048 lds
 buffer_load_dwordx4 v63, s[28:31], s46 offen offset:3072 lds
 s_mov_b32 m0, 135168
 s_add_u32 s46, s91, 36864
 buffer_load_dwordx4 v60, s[28:31], s46 offen offset:0 lds
 buffer_load_dwordx4 v61, s[28:31], s46 offen offset:1024 lds
 buffer_load_dwordx4 v62, s[28:31], s46 offen offset:2048 lds
 buffer_load_dwordx4 v63, s[28:31], s46 offen offset:3072 lds
 s_mov_b32 m0, 139264
 s_add_u32 s46, s91, 73728
 buffer_load_dwordx4 v60, s[28:31], s46 offen offset:0 lds
 buffer_load_dwordx4 v61, s[28:31], s46 offen offset:1024 lds
 buffer_load_dwordx4 v62, s[28:31], s46 offen offset:2048 lds
 buffer_load_dwordx4 v63, s[28:31], s46 offen offset:3072 lds
 s_mov_b32 m0, 143360
 s_add_u32 s46, s91, 110592
 buffer_load_dwordx4 v60, s[28:31], s46 offen offset:0 lds
 buffer_load_dwordx4 v61, s[28:31], s46 offen offset:1024 lds
 buffer_load_dwordx4 v62, s[28:31], s46 offen offset:2048 lds
 buffer_load_dwordx4 v63, s[28:31], s46 offen offset:3072 lds
 ds_write_b128 v31, a[0:3] offset:0
 ds_write_b128 v31, a[4:7] offset:1024
 ds_write_b128 v31, a[8:11] offset:2048
 ds_write_b128 v31, a[12:15] offset:3072
 ds_write_b128 v31, a[32:35] offset:4096
 ds_write_b128 v31, a[36:39] offset:5120
 ds_write_b128 v31, a[40:43] offset:6144
 ds_write_b128 v31, a[44:47] offset:7168
 ds_write_b128 v31, a[64:67] offset:8192
 ds_write_b128 v31, a[68:71] offset:9216
 ds_write_b128 v31, a[72:75] offset:10240
 ds_write_b128 v31, a[76:79] offset:11264
 s_waitcnt vmcnt(63) lgkmcnt(0)
 s_barrier
 s_add_u32 s46, s15, 24576
 s_and_b32 s46, s46, 0x1ffff
 s_add_u32 s46, s46, s42
 s_mov_b32 m0, 32768
 s_add_u32 s46, s46, 0
 buffer_load_dwordx4 v24, s[16:19], s46 offen offset:0 nt lds
 buffer_load_dwordx4 v25, s[16:19], s46 offen offset:1024 nt lds
 buffer_load_dwordx4 v26, s[16:19], s46 offen offset:2048 nt lds
 buffer_load_dwordx4 v27, s[16:19], s46 offen offset:3072 nt lds
 s_add_u32 s46, s15, 24576
 s_and_b32 s46, s46, 0x1ffff
 s_add_u32 s46, s46, s42
 s_mov_b32 m0, 36864
 s_add_u32 s46, s46, 4096
 buffer_load_dwordx4 v24, s[16:19], s46 offen offset:0 nt lds
 buffer_load_dwordx4 v25, s[16:19], s46 offen offset:1024 nt lds
 buffer_load_dwordx4 v26, s[16:19], s46 offen offset:2048 nt lds
 buffer_load_dwordx4 v27, s[16:19], s46 offen offset:3072 nt lds
 s_add_u32 s46, s15, 8192
 s_and_b32 s46, s46, 0x1ffff
 s_add_u32 s46, s46, s42
 s_mov_b32 m0, 40960
 s_add_u32 s46, s46, 0
 buffer_load_dwordx4 v28, s[20:23], s46 offen offset:0 nt lds
 buffer_load_dwordx4 v3, s[20:23], s46 offen offset:1024 nt lds
 buffer_load_dwordx4 v28, s[20:23], s46 offen offset:2048 nt lds
 buffer_load_dwordx4 v3, s[20:23], s46 offen offset:3072 nt lds
 s_add_u32 s46, s15, 8192
 s_and_b32 s46, s46, 0x1ffff
 s_add_u32 s46, s46, s42
 s_mov_b32 m0, 45056
 s_add_u32 s46, s46, 4096
 buffer_load_dwordx4 v28, s[20:23], s46 offen offset:0 nt lds
 buffer_load_dwordx4 v3, s[20:23], s46 offen offset:1024 nt lds
 buffer_load_dwordx4 v28, s[20:23], s46 offen offset:2048 nt lds
 buffer_load_dwordx4 v3, s[20:23], s46 offen offset:3072 nt lds
 s_waitcnt vmcnt(63) lgkmcnt(0)
 s_barrier
 s_add_u32 s91, s45, s86
 s_mov_b32 m0, 65536
 s_add_u32 s46, s91, 0
 buffer_load_dwordx4 v60, s[28:31], s46 offen offset:0 lds
 buffer_load_dwordx4 v61, s[28:31], s46 offen offset:1024 lds
 buffer_load_dwordx4 v62, s[28:31], s46 offen offset:2048 lds
 buffer_load_dwordx4 v63, s[28:31], s46 offen offset:3072 lds
 s_mov_b32 m0, 69632
 s_add_u32 s46, s91, 36864
 buffer_load_dwordx4 v60, s[28:31], s46 offen offset:0 lds
 buffer_load_dwordx4 v61, s[28:31], s46 offen offset:1024 lds
 buffer_load_dwordx4 v62, s[28:31], s46 offen offset:2048 lds
 buffer_load_dwordx4 v63, s[28:31], s46 offen offset:3072 lds
 s_mov_b32 m0, 73728
 s_add_u32 s46, s91, 73728
 buffer_load_dwordx4 v60, s[28:31], s46 offen offset:0 lds
 buffer_load_dwordx4 v61, s[28:31], s46 offen offset:1024 lds
 buffer_load_dwordx4 v62, s[28:31], s46 offen offset:2048 lds
 buffer_load_dwordx4 v63, s[28:31], s46 offen offset:3072 lds
 s_mov_b32 m0, 77824
 s_add_u32 s46, s91, 110592
 buffer_load_dwordx4 v60, s[28:31], s46 offen offset:0 lds
 buffer_load_dwordx4 v61, s[28:31], s46 offen offset:1024 lds
 buffer_load_dwordx4 v62, s[28:31], s46 offen offset:2048 lds
 buffer_load_dwordx4 v63, s[28:31], s46 offen offset:3072 lds
 s_waitcnt vmcnt(63) lgkmcnt(0)
 s_barrier
 s_add_u32 s46, s15, 32768
 s_and_b32 s46, s46, 0x1ffff
 s_add_u32 s46, s46, s42
 s_mov_b32 m0, 49152
 s_add_u32 s46, s46, 0
 buffer_load_dwordx4 v24, s[16:19], s46 offen offset:0 nt lds
 buffer_load_dwordx4 v25, s[16:19], s46 offen offset:1024 nt lds
 buffer_load_dwordx4 v26, s[16:19], s46 offen offset:2048 nt lds
 buffer_load_dwordx4 v27, s[16:19], s46 offen offset:3072 nt lds
 s_add_u32 s46, s15, 32768
 s_and_b32 s46, s46, 0x1ffff
 s_add_u32 s46, s46, s42
 s_mov_b32 m0, 53248
 s_add_u32 s46, s46, 4096
 buffer_load_dwordx4 v24, s[16:19], s46 offen offset:0 nt lds
 buffer_load_dwordx4 v25, s[16:19], s46 offen offset:1024 nt lds
 buffer_load_dwordx4 v26, s[16:19], s46 offen offset:2048 nt lds
 buffer_load_dwordx4 v27, s[16:19], s46 offen offset:3072 nt lds
 s_add_u32 s46, s15, 16384
 s_and_b32 s46, s46, 0x1ffff
 s_add_u32 s46, s46, s42
 s_mov_b32 m0, 57344
 s_add_u32 s46, s46, 0
 buffer_load_dwordx4 v28, s[20:23], s46 offen offset:0 nt lds
 buffer_load_dwordx4 v3, s[20:23], s46 offen offset:1024 nt lds
 buffer_load_dwordx4 v28, s[20:23], s46 offen offset:2048 nt lds
 buffer_load_dwordx4 v3, s[20:23], s46 offen offset:3072 nt lds
 s_add_u32 s46, s15, 16384
 s_and_b32 s46, s46, 0x1ffff
 s_add_u32 s46, s46, s42
 s_mov_b32 m0, 61440
 s_add_u32 s46, s46, 4096
 buffer_load_dwordx4 v28, s[20:23], s46 offen offset:0 nt lds
 buffer_load_dwordx4 v3, s[20:23], s46 offen offset:1024 nt lds
 buffer_load_dwordx4 v28, s[20:23], s46 offen offset:2048 nt lds
 buffer_load_dwordx4 v3, s[20:23], s46 offen offset:3072 nt lds
 s_add_u32 s46, s45, 147456
 buffer_load_dword v30, v29, s[28:31], s46 offen
 s_add_u32 s46, s45, 152064
 buffer_load_dword v30, v29, s[28:31], s46 offen
 s_waitcnt vmcnt(63) lgkmcnt(0)
 s_barrier
 s_add_u32 s91, s45, s87
 s_mov_b32 m0, 98304
 s_add_u32 s46, s91, 0
 buffer_load_dwordx4 v60, s[28:31], s46 offen offset:0 lds
 buffer_load_dwordx4 v61, s[28:31], s46 offen offset:1024 lds
 buffer_load_dwordx4 v62, s[28:31], s46 offen offset:2048 lds
 buffer_load_dwordx4 v63, s[28:31], s46 offen offset:3072 lds
 s_mov_b32 m0, 102400
 s_add_u32 s46, s91, 36864
 buffer_load_dwordx4 v60, s[28:31], s46 offen offset:0 lds
 buffer_load_dwordx4 v61, s[28:31], s46 offen offset:1024 lds
 buffer_load_dwordx4 v62, s[28:31], s46 offen offset:2048 lds
 buffer_load_dwordx4 v63, s[28:31], s46 offen offset:3072 lds
 s_mov_b32 m0, 106496
 s_add_u32 s46, s91, 73728
 buffer_load_dwordx4 v60, s[28:31], s46 offen offset:0 lds
 buffer_load_dwordx4 v61, s[28:31], s46 offen offset:1024 lds
 buffer_load_dwordx4 v62, s[28:31], s46 offen offset:2048 lds
 buffer_load_dwordx4 v63, s[28:31], s46 offen offset:3072 lds
 s_mov_b32 m0, 110592
 s_add_u32 s46, s91, 110592
 buffer_load_dwordx4 v60, s[28:31], s46 offen offset:0 lds
 buffer_load_dwordx4 v61, s[28:31], s46 offen offset:1024 lds
 buffer_load_dwordx4 v62, s[28:31], s46 offen offset:2048 lds
 buffer_load_dwordx4 v63, s[28:31], s46 offen offset:3072 lds
 ds_write_b128 v31, a[16:19] offset:0
 ds_write_b128 v31, a[20:23] offset:1024
 ds_write_b128 v31, a[24:27] offset:2048
 ds_write_b128 v31, a[28:31] offset:3072
 ds_write_b128 v31, a[48:51] offset:4096
 ds_write_b128 v31, a[52:55] offset:5120
 ds_write_b128 v31, a[56:59] offset:6144
 ds_write_b128 v31, a[60:63] offset:7168
 ds_write_b128 v31, a[80:83] offset:8192
 ds_write_b128 v31, a[84:87] offset:9216
 ds_write_b128 v31, a[88:91] offset:10240
 ds_write_b128 v31, a[92:95] offset:11264
 s_waitcnt vmcnt(63) lgkmcnt(0)
 s_barrier
 s_add_u32 s46, s15, 40960
 s_and_b32 s46, s46, 0x1ffff
 s_add_u32 s46, s46, s42
 s_mov_b32 m0, 81920
 s_add_u32 s46, s46, 0
 buffer_load_dwordx4 v24, s[16:19], s46 offen offset:0 nt lds
 buffer_load_dwordx4 v25, s[16:19], s46 offen offset:1024 nt lds
 buffer_load_dwordx4 v26, s[16:19], s46 offen offset:2048 nt lds
 buffer_load_dwordx4 v27, s[16:19], s46 offen offset:3072 nt lds
 s_add_u32 s46, s15, 40960
 s_and_b32 s46, s46, 0x1ffff
 s_add_u32 s46, s46, s42
 s_mov_b32 m0, 86016
 s_add_u32 s46, s46, 4096
 buffer_load_dwordx4 v24, s[16:19], s46 offen offset:0 nt lds
 buffer_load_dwordx4 v25, s[16:19], s46 offen offset:1024 nt lds
 buffer_load_dwordx4 v26, s[16:19], s46 offen offset:2048 nt lds
 buffer_load_dwordx4 v27, s[16:19], s46 offen offset:3072 nt lds
 s_add_u32 s46, s15, 24576
 s_and_b32 s46, s46, 0x1ffff
 s_add_u32 s46, s46, s42
 s_mov_b32 m0, 90112
 s_add_u32 s46, s46, 0
 buffer_load_dwordx4 v28, s[20:23], s46 offen offset:0 nt lds
 buffer_load_dwordx4 v3, s[20:23], s46 offen offset:1024 nt lds
 buffer_load_dwordx4 v28, s[20:23], s46 offen offset:2048 nt lds
 buffer_load_dwordx4 v3, s[20:23], s46 offen offset:3072 nt lds
 s_add_u32 s46, s15, 24576
 s_and_b32 s46, s46, 0x1ffff
 s_add_u32 s46, s46, s42
 s_mov_b32 m0, 94208
 s_add_u32 s46, s46, 4096
 buffer_load_dwordx4 v28, s[20:23], s46 offen offset:0 nt lds
 buffer_load_dwordx4 v3, s[20:23], s46 offen offset:1024 nt lds
 buffer_load_dwordx4 v28, s[20:23], s46 offen offset:2048 nt lds
 buffer_load_dwordx4 v3, s[20:23], s46 offen offset:3072 nt lds
 s_waitcnt vmcnt(50) lgkmcnt(0)
 s_barrier
 s_add_u32 s91, s45, s88
 s_mov_b32 m0, 131072
 s_add_u32 s46, s91, 0
 buffer_load_dwordx4 v60, s[28:31], s46 offen offset:0 lds
 buffer_load_dwordx4 v61, s[28:31], s46 offen offset:1024 lds
 buffer_load_dwordx4 v62, s[28:31], s46 offen offset:2048 lds
 buffer_load_dwordx4 v63, s[28:31], s46 offen offset:3072 lds
 s_mov_b32 m0, 135168
 s_add_u32 s46, s91, 36864
 buffer_load_dwordx4 v60, s[28:31], s46 offen offset:0 lds
 buffer_load_dwordx4 v61, s[28:31], s46 offen offset:1024 lds
 buffer_load_dwordx4 v62, s[28:31], s46 offen offset:2048 lds
 buffer_load_dwordx4 v63, s[28:31], s46 offen offset:3072 lds
 s_mov_b32 m0, 139264
 s_add_u32 s46, s91, 73728
 buffer_load_dwordx4 v60, s[28:31], s46 offen offset:0 lds
 buffer_load_dwordx4 v61, s[28:31], s46 offen offset:1024 lds
 buffer_load_dwordx4 v62, s[28:31], s46 offen offset:2048 lds
 buffer_load_dwordx4 v63, s[28:31], s46 offen offset:3072 lds
 s_mov_b32 m0, 143360
 s_add_u32 s46, s91, 110592
 buffer_load_dwordx4 v60, s[28:31], s46 offen offset:0 lds
 buffer_load_dwordx4 v61, s[28:31], s46 offen offset:1024 lds
 buffer_load_dwordx4 v62, s[28:31], s46 offen offset:2048 lds
 buffer_load_dwordx4 v63, s[28:31], s46 offen offset:3072 lds
 s_cmp_lg_u32 s47, 1
 s_cbranch_scc1 M_w3mv
 v_accvgpr_mov_b32 a0, a96
 v_accvgpr_mov_b32 a1, a97
 v_accvgpr_mov_b32 a2, a98
 v_accvgpr_mov_b32 a3, a99
 v_accvgpr_mov_b32 a4, a100
 v_accvgpr_mov_b32 a5, a101
 v_accvgpr_mov_b32 a6, a102
 v_accvgpr_mov_b32 a7, a103
 v_accvgpr_mov_b32 a8, a104
 v_accvgpr_mov_b32 a9, a105
 v_accvgpr_mov_b32 a10, a106
 v_accvgpr_mov_b32 a11, a107
 v_accvgpr_mov_b32 a12, a108
 v_accvgpr_mov_b32 a13, a109
 v_accvgpr_mov_b32 a14, a110
 v_accvgpr_mov_b32 a15, a111
 v_accvgpr_mov_b32 a16, a112
 v_accvgpr_mov_b32 a17, a113
 v_accvgpr_mov_b32 a18, a114
 v_accvgpr_mov_b32 a19, a115
 v_accvgpr_mov_b32 a20, a116
 v_accvgpr_mov_b32 a21, a117
 v_accvgpr_mov_b32 a22, a118
 v_accvgpr_mov_b32 a23, a119
 v_accvgpr_mov_b32 a24, a120
 v_accvgpr_mov_b32 a25, a121
 v_accvgpr_mov_b32 a26, a122
 v_accvgpr_mov_b32 a27, a123
 v_accvgpr_mov_b32 a28, a124
 v_accvgpr_mov_b32 a29, a125
 v_accvgpr_mov_b32 a30, a126
 v_accvgpr_mov_b32 a31, a127
 v_accvgpr_mov_b32 a32, a128
 v_accvgpr_mov_b32 a33, a129
 v_accvgpr_mov_b32 a34, a130
 v_accvgpr_mov_b32 a35, a131
 v_accvgpr_mov_b32 a36, a132
 v_accvgpr_mov_b32 a37, a133
 v_accvgpr_mov_b32 a38, a134
 v_accvgpr_mov_b32 a39, a135
 v_accvgpr_mov_b32 a40, a136
 v_accvgpr_mov_b32 a41, a137
 v_accvgpr_mov_b32 a42, a138
 v_accvgpr_mov_b32 a43, a139
 v_accvgpr_mov_b32 a44, a140
 v_accvgpr_mov_b32 a45, a141
 v_accvgpr_mov_b32 a46, a142
 v_accvgpr_mov_b32 a47, a143
 v_accvgpr_mov_b32 a48, a144
 v_accvgpr_mov_b32 a49, a145
 v_accvgpr_mov_b32 a50, a146
 v_accvgpr_mov_b32 a51, a147
 v_accvgpr_mov_b32 a52, a148
 v_accvgpr_mov_b32 a53, a149
 v_accvgpr_mov_b32 a54, a150
 v_accvgpr_mov_b32 a55, a151
 v_accvgpr_mov_b32 a56, a152
 v_accvgpr_mov_b32 a57, a153
 v_accvgpr_mov_b32 a58, a154
 v_accvgpr_mov_b32 a59, a155
 v_accvgpr_mov_b32 a60, a156
 v_accvgpr_mov_b32 a61, a157
 v_accvgpr_mov_b32 a62, a158
 v_accvgpr_mov_b32 a63, a159
 v_accvgpr_mov_b32 a64, a160
 v_accvgpr_mov_b32 a65, a161
 v_accvgpr_mov_b32 a66, a162
 v_accvgpr_mov_b32 a67, a163
 v_accvgpr_mov_b32 a68, a164
 v_accvgpr_mov_b32 a69, a165
 v_accvgpr_mov_b32 a70, a166
 v_accvgpr_mov_b32 a71, a167
 v_accvgpr_mov_b32 a72, a168
 v_accvgpr_mov_b32 a73, a169
 v_accvgpr_mov_b32 a74, a170
 v_accvgpr_mov_b32 a75, a171
 v_accvgpr_mov_b32 a76, a172
 v_accvgpr_mov_b32 a77, a173
 v_accvgpr_mov_b32 a78, a174
 v_accvgpr_mov_b32 a79, a175
 v_accvgpr_mov_b32 a80, a176
 v_accvgpr_mov_b32 a81, a177
 v_accvgpr_mov_b32 a82, a178
 v_accvgpr_mov_b32 a83, a179
 v_accvgpr_mov_b32 a84, a180
 v_accvgpr_mov_b32 a85, a181
 v_accvgpr_mov_b32 a86, a182
 v_accvgpr_mov_b32 a87, a183
 v_accvgpr_mov_b32 a88, a184
 v_accvgpr_mov_b32 a89, a185
 v_accvgpr_mov_b32 a90, a186
 v_accvgpr_mov_b32 a91, a187
 v_accvgpr_mov_b32 a92, a188
 v_accvgpr_mov_b32 a93, a189
 v_accvgpr_mov_b32 a94, a190
 v_accvgpr_mov_b32 a95, a191
M_w3mv:
 s_waitcnt vmcnt(32) lgkmcnt(0)
 s_barrier
 s_add_u32 s46, s15, 49152
 s_and_b32 s46, s46, 0x1ffff
 s_add_u32 s46, s46, s42
 s_mov_b32 m0, 65536
 s_add_u32 s46, s46, 0
 buffer_load_dwordx4 v24, s[16:19], s46 offen offset:0 nt lds
 buffer_load_dwordx4 v25, s[16:19], s46 offen offset:1024 nt lds
 buffer_load_dwordx4 v26, s[16:19], s46 offen offset:2048 nt lds
 buffer_load_dwordx4 v27, s[16:19], s46 offen offset:3072 nt lds
 s_add_u32 s46, s15, 49152
 s_and_b32 s46, s46, 0x1ffff
 s_add_u32 s46, s46, s42
 s_mov_b32 m0, 69632
 s_add_u32 s46, s46, 4096
 buffer_load_dwordx4 v24, s[16:19], s46 offen offset:0 nt lds
 buffer_load_dwordx4 v25, s[16:19], s46 offen offset:1024 nt lds
 buffer_load_dwordx4 v26, s[16:19], s46 offen offset:2048 nt lds
 buffer_load_dwordx4 v27, s[16:19], s46 offen offset:3072 nt lds
 s_add_u32 s46, s15, 32768
 s_and_b32 s46, s46, 0x1ffff
 s_add_u32 s46, s46, s42
 s_mov_b32 m0, 73728
 s_add_u32 s46, s46, 0
 buffer_load_dwordx4 v28, s[20:23], s46 offen offset:0 nt lds
 buffer_load_dwordx4 v3, s[20:23], s46 offen offset:1024 nt lds
 buffer_load_dwordx4 v28, s[20:23], s46 offen offset:2048 nt lds
 buffer_load_dwordx4 v3, s[20:23], s46 offen offset:3072 nt lds
 s_add_u32 s46, s15, 32768
 s_and_b32 s46, s46, 0x1ffff
 s_add_u32 s46, s46, s42
 s_mov_b32 m0, 77824
 s_add_u32 s46, s46, 4096
 buffer_load_dwordx4 v28, s[20:23], s46 offen offset:0 nt lds
 buffer_load_dwordx4 v3, s[20:23], s46 offen offset:1024 nt lds
 buffer_load_dwordx4 v28, s[20:23], s46 offen offset:2048 nt lds
 buffer_load_dwordx4 v3, s[20:23], s46 offen offset:3072 nt lds
 s_waitcnt vmcnt(16) lgkmcnt(0)
 s_barrier
 s_add_u32 s46, s15, 57344
 s_and_b32 s46, s46, 0x1ffff
 s_add_u32 s46, s46, s42
 s_mov_b32 m0, 114688
 s_add_u32 s46, s46, 0
 buffer_load_dwordx4 v24, s[16:19], s46 offen offset:0 nt lds
 buffer_load_dwordx4 v25, s[16:19], s46 offen offset:1024 nt lds
 buffer_load_dwordx4 v26, s[16:19], s46 offen offset:2048 nt lds
 buffer_load_dwordx4 v27, s[16:19], s46 offen offset:3072 nt lds
 s_add_u32 s46, s15, 57344
 s_and_b32 s46, s46, 0x1ffff
 s_add_u32 s46, s46, s42
 s_mov_b32 m0, 118784
 s_add_u32 s46, s46, 4096
 buffer_load_dwordx4 v24, s[16:19], s46 offen offset:0 nt lds
 buffer_load_dwordx4 v25, s[16:19], s46 offen offset:1024 nt lds
 buffer_load_dwordx4 v26, s[16:19], s46 offen offset:2048 nt lds
 buffer_load_dwordx4 v27, s[16:19], s46 offen offset:3072 nt lds
 s_add_u32 s46, s15, 40960
 s_and_b32 s46, s46, 0x1ffff
 s_add_u32 s46, s46, s42
 s_mov_b32 m0, 122880
 s_add_u32 s46, s46, 0
 buffer_load_dwordx4 v28, s[20:23], s46 offen offset:0 nt lds
 buffer_load_dwordx4 v3, s[20:23], s46 offen offset:1024 nt lds
 buffer_load_dwordx4 v28, s[20:23], s46 offen offset:2048 nt lds
 buffer_load_dwordx4 v3, s[20:23], s46 offen offset:3072 nt lds
 s_add_u32 s46, s15, 40960
 s_and_b32 s46, s46, 0x1ffff
 s_add_u32 s46, s46, s42
 s_mov_b32 m0, 126976
 s_add_u32 s46, s46, 4096
 buffer_load_dwordx4 v28, s[20:23], s46 offen offset:0 nt lds
 buffer_load_dwordx4 v3, s[20:23], s46 offen offset:1024 nt lds
 buffer_load_dwordx4 v28, s[20:23], s46 offen offset:2048 nt lds
 buffer_load_dwordx4 v3, s[20:23], s46 offen offset:3072 nt lds
 s_add_u32 s45, s45, 147456
 s_add_u32 s47, s47, 1
 s_cmp_lt_u32 s47, 3
 s_cbranch_scc1 M_w3loop
 s_waitcnt vmcnt(63) lgkmcnt(0)
 s_barrier
 s_add_u32 s46, s15, 65536
 s_and_b32 s46, s46, 0x1ffff
 s_add_u32 s46, s46, s42
 s_mov_b32 m0, 98304
 s_add_u32 s46, s46, 0
 buffer_load_dwordx4 v24, s[16:19], s46 offen offset:0 nt lds
 buffer_load_dwordx4 v25, s[16:19], s46 offen offset:1024 nt lds
 buffer_load_dwordx4 v26, s[16:19], s46 offen offset:2048 nt lds
 buffer_load_dwordx4 v27, s[16:19], s46 offen offset:3072 nt lds
 s_add_u32 s46, s15, 65536
 s_and_b32 s46, s46, 0x1ffff
 s_add_u32 s46, s46, s42
 s_mov_b32 m0, 102400
 s_add_u32 s46, s46, 4096
 buffer_load_dwordx4 v24, s[16:19], s46 offen offset:0 nt lds
 buffer_load_dwordx4 v25, s[16:19], s46 offen offset:1024 nt lds
 buffer_load_dwordx4 v26, s[16:19], s46 offen offset:2048 nt lds
 buffer_load_dwordx4 v27, s[16:19], s46 offen offset:3072 nt lds
 s_add_u32 s46, s15, 49152
 s_and_b32 s46, s46, 0x1ffff
 s_add_u32 s46, s46, s42
 s_mov_b32 m0, 106496
 s_add_u32 s46, s46, 0
 buffer_load_dwordx4 v28, s[20:23], s46 offen offset:0 nt lds
 buffer_load_dwordx4 v3, s[20:23], s46 offen offset:1024 nt lds
 buffer_load_dwordx4 v28, s[20:23], s46 offen offset:2048 nt lds
 buffer_load_dwordx4 v3, s[20:23], s46 offen offset:3072 nt lds
 s_add_u32 s46, s15, 49152
 s_and_b32 s46, s46, 0x1ffff
 s_add_u32 s46, s46, s42
 s_mov_b32 m0, 110592
 s_add_u32 s46, s46, 4096
 buffer_load_dwordx4 v28, s[20:23], s46 offen offset:0 nt lds
 buffer_load_dwordx4 v3, s[20:23], s46 offen offset:1024 nt lds
 buffer_load_dwordx4 v28, s[20:23], s46 offen offset:2048 nt lds
 buffer_load_dwordx4 v3, s[20:23], s46 offen offset:3072 nt lds
 s_waitcnt vmcnt(63) lgkmcnt(0)
 s_barrier
 s_add_u32 s46, s15, 73728
 s_and_b32 s46, s46, 0x1ffff
 s_add_u32 s46, s46, s42
 s_mov_b32 m0, 131072
 s_add_u32 s46, s46, 0
 buffer_load_dwordx4 v24, s[16:19], s46 offen offset:0 nt lds
 buffer_load_dwordx4 v25, s[16:19], s46 offen offset:1024 nt lds
 buffer_load_dwordx4 v26, s[16:19], s46 offen offset:2048 nt lds
 buffer_load_dwordx4 v27, s[16:19], s46 offen offset:3072 nt lds
 s_add_u32 s46, s15, 73728
 s_and_b32 s46, s46, 0x1ffff
 s_add_u32 s46, s46, s42
 s_mov_b32 m0, 135168
 s_add_u32 s46, s46, 4096
 buffer_load_dwordx4 v24, s[16:19], s46 offen offset:0 nt lds
 buffer_load_dwordx4 v25, s[16:19], s46 offen offset:1024 nt lds
 buffer_load_dwordx4 v26, s[16:19], s46 offen offset:2048 nt lds
 buffer_load_dwordx4 v27, s[16:19], s46 offen offset:3072 nt lds
 s_add_u32 s46, s15, 57344
 s_and_b32 s46, s46, 0x1ffff
 s_add_u32 s46, s46, s42
 s_mov_b32 m0, 139264
 s_add_u32 s46, s46, 0
 buffer_load_dwordx4 v28, s[20:23], s46 offen offset:0 nt lds
 buffer_load_dwordx4 v3, s[20:23], s46 offen offset:1024 nt lds
 buffer_load_dwordx4 v28, s[20:23], s46 offen offset:2048 nt lds
 buffer_load_dwordx4 v3, s[20:23], s46 offen offset:3072 nt lds
 s_add_u32 s46, s15, 57344
 s_and_b32 s46, s46, 0x1ffff
 s_add_u32 s46, s46, s42
 s_mov_b32 m0, 143360
 s_add_u32 s46, s46, 4096
 buffer_load_dwordx4 v28, s[20:23], s46 offen offset:0 nt lds
 buffer_load_dwordx4 v3, s[20:23], s46 offen offset:1024 nt lds
 buffer_load_dwordx4 v28, s[20:23], s46 offen offset:2048 nt lds
 buffer_load_dwordx4 v3, s[20:23], s46 offen offset:3072 nt lds
 s_waitcnt vmcnt(63) lgkmcnt(0)
 s_barrier
 s_add_u32 s46, s15, 81920
 s_and_b32 s46, s46, 0x1ffff
 s_add_u32 s46, s46, s42
 s_mov_b32 m0, 0
 s_add_u32 s46, s46, 0
 buffer_load_dwordx4 v24, s[16:19], s46 offen offset:0 nt lds
 buffer_load_dwordx4 v25, s[16:19], s46 offen offset:1024 nt lds
 buffer_load_dwordx4 v26, s[16:19], s46 offen offset:2048 nt lds
 buffer_load_dwordx4 v27, s[16:19], s46 offen offset:3072 nt lds
 s_add_u32 s46, s15, 81920
 s_and_b32 s46, s46, 0x1ffff
 s_add_u32 s46, s46, s42
 s_mov_b32 m0, 4096
 s_add_u32 s46, s46, 4096
 buffer_load_dwordx4 v24, s[16:19], s46 offen offset:0 nt lds
 buffer_load_dwordx4 v25, s[16:19], s46 offen offset:1024 nt lds
 buffer_load_dwordx4 v26, s[16:19], s46 offen offset:2048 nt lds
 buffer_load_dwordx4 v27, s[16:19], s46 offen offset:3072 nt lds
 s_add_u32 s46, s15, 65536
 s_and_b32 s46, s46, 0x1ffff
 s_add_u32 s46, s46, s42
 s_mov_b32 m0, 8192
 s_add_u32 s46, s46, 0
 buffer_load_dwordx4 v28, s[20:23], s46 offen offset:0 nt lds
 buffer_load_dwordx4 v3, s[20:23], s46 offen offset:1024 nt lds
 buffer_load_dwordx4 v28, s[20:23], s46 offen offset:2048 nt lds
 buffer_load_dwordx4 v3, s[20:23], s46 offen offset:3072 nt lds
 s_add_u32 s46, s15, 65536
 s_and_b32 s46, s46, 0x1ffff
 s_add_u32 s46, s46, s42
 s_mov_b32 m0, 12288
 s_add_u32 s46, s46, 4096
 buffer_load_dwordx4 v28, s[20:23], s46 offen offset:0 nt lds
 buffer_load_dwordx4 v3, s[20:23], s46 offen offset:1024 nt lds
 buffer_load_dwordx4 v28, s[20:23], s46 offen offset:2048 nt lds
 buffer_load_dwordx4 v3, s[20:23], s46 offen offset:3072 nt lds
 s_lshl_b32 s56, s53, 2
 v_mov_b32 v16, s56
 buffer_load_dword v17, v16, s[68:71], 0 offen offset:0 sc1
 s_waitcnt vmcnt(63) lgkmcnt(0)
 s_barrier
 s_add_u32 s46, s15, 90112
 s_and_b32 s46, s46, 0x1ffff
 s_add_u32 s46, s46, s42
 s_mov_b32 m0, 32768
 s_add_u32 s46, s46, 0
 buffer_load_dwordx4 v24, s[16:19], s46 offen offset:0 nt lds
 buffer_load_dwordx4 v25, s[16:19], s46 offen offset:1024 nt lds
 buffer_load_dwordx4 v26, s[16:19], s46 offen offset:2048 nt lds
 buffer_load_dwordx4 v27, s[16:19], s46 offen offset:3072 nt lds
 s_add_u32 s46, s15, 90112
 s_and_b32 s46, s46, 0x1ffff
 s_add_u32 s46, s46, s42
 s_mov_b32 m0, 36864
 s_add_u32 s46, s46, 4096
 buffer_load_dwordx4 v24, s[16:19], s46 offen offset:0 nt lds
 buffer_load_dwordx4 v25, s[16:19], s46 offen offset:1024 nt lds
 buffer_load_dwordx4 v26, s[16:19], s46 offen offset:2048 nt lds
 buffer_load_dwordx4 v27, s[16:19], s46 offen offset:3072 nt lds
 s_add_u32 s46, s15, 73728
 s_and_b32 s46, s46, 0x1ffff
 s_add_u32 s46, s46, s42
 s_mov_b32 m0, 40960
 s_add_u32 s46, s46, 0
 buffer_load_dwordx4 v28, s[20:23], s46 offen offset:0 nt lds
 buffer_load_dwordx4 v3, s[20:23], s46 offen offset:1024 nt lds
 buffer_load_dwordx4 v28, s[20:23], s46 offen offset:2048 nt lds
 buffer_load_dwordx4 v3, s[20:23], s46 offen offset:3072 nt lds
 s_add_u32 s46, s15, 73728
 s_and_b32 s46, s46, 0x1ffff
 s_add_u32 s46, s46, s42
 s_mov_b32 m0, 45056
 s_add_u32 s46, s46, 4096
 buffer_load_dwordx4 v28, s[20:23], s46 offen offset:0 nt lds
 buffer_load_dwordx4 v3, s[20:23], s46 offen offset:1024 nt lds
 buffer_load_dwordx4 v28, s[20:23], s46 offen offset:2048 nt lds
 buffer_load_dwordx4 v3, s[20:23], s46 offen offset:3072 nt lds
 s_waitcnt vmcnt(63) lgkmcnt(0)
 s_barrier
 s_add_u32 s46, s15, 98304
 s_and_b32 s46, s46, 0x1ffff
 s_add_u32 s46, s46, s42
 s_mov_b32 m0, 16384
 s_add_u32 s46, s46, 0
 buffer_load_dwordx4 v24, s[16:19], s46 offen offset:0 nt lds
 buffer_load_dwordx4 v25, s[16:19], s46 offen offset:1024 nt lds
 buffer_load_dwordx4 v26, s[16:19], s46 offen offset:2048 nt lds
 buffer_load_dwordx4 v27, s[16:19], s46 offen offset:3072 nt lds
 s_add_u32 s46, s15, 98304
 s_and_b32 s46, s46, 0x1ffff
 s_add_u32 s46, s46, s42
 s_mov_b32 m0, 20480
 s_add_u32 s46, s46, 4096
 buffer_load_dwordx4 v24, s[16:19], s46 offen offset:0 nt lds
 buffer_load_dwordx4 v25, s[16:19], s46 offen offset:1024 nt lds
 buffer_load_dwordx4 v26, s[16:19], s46 offen offset:2048 nt lds
 buffer_load_dwordx4 v27, s[16:19], s46 offen offset:3072 nt lds
 s_add_u32 s46, s15, 81920
 s_and_b32 s46, s46, 0x1ffff
 s_add_u32 s46, s46, s42
 s_mov_b32 m0, 24576
 s_add_u32 s46, s46, 0
 buffer_load_dwordx4 v28, s[20:23], s46 offen offset:0 nt lds
 buffer_load_dwordx4 v3, s[20:23], s46 offen offset:1024 nt lds
 buffer_load_dwordx4 v28, s[20:23], s46 offen offset:2048 nt lds
 buffer_load_dwordx4 v3, s[20:23], s46 offen offset:3072 nt lds
 s_add_u32 s46, s15, 81920
 s_and_b32 s46, s46, 0x1ffff
 s_add_u32 s46, s46, s42
 s_mov_b32 m0, 28672
 s_add_u32 s46, s46, 4096
 buffer_load_dwordx4 v28, s[20:23], s46 offen offset:0 nt lds
 buffer_load_dwordx4 v3, s[20:23], s46 offen offset:1024 nt lds
 buffer_load_dwordx4 v28, s[20:23], s46 offen offset:2048 nt lds
 buffer_load_dwordx4 v3, s[20:23], s46 offen offset:3072 nt lds
 s_waitcnt vmcnt(63) lgkmcnt(0)
 s_barrier
 s_add_u32 s46, s15, 106496
 s_and_b32 s46, s46, 0x1ffff
 s_add_u32 s46, s46, s42
 s_mov_b32 m0, 81920
 s_add_u32 s46, s46, 0
 buffer_load_dwordx4 v24, s[16:19], s46 offen offset:0 nt lds
 buffer_load_dwordx4 v25, s[16:19], s46 offen offset:1024 nt lds
 buffer_load_dwordx4 v26, s[16:19], s46 offen offset:2048 nt lds
 buffer_load_dwordx4 v27, s[16:19], s46 offen offset:3072 nt lds
 s_add_u32 s46, s15, 106496
 s_and_b32 s46, s46, 0x1ffff
 s_add_u32 s46, s46, s42
 s_mov_b32 m0, 86016
 s_add_u32 s46, s46, 4096
 buffer_load_dwordx4 v24, s[16:19], s46 offen offset:0 nt lds
 buffer_load_dwordx4 v25, s[16:19], s46 offen offset:1024 nt lds
 buffer_load_dwordx4 v26, s[16:19], s46 offen offset:2048 nt lds
 buffer_load_dwordx4 v27, s[16:19], s46 offen offset:3072 nt lds
 s_add_u32 s46, s15, 90112
 s_and_b32 s46, s46, 0x1ffff
 s_add_u32 s46, s46, s42
 s_mov_b32 m0, 90112
 s_add_u32 s46, s46, 0
 buffer_load_dwordx4 v28, s[20:23], s46 offen offset:0 nt lds
 buffer_load_dwordx4 v3, s[20:23], s46 offen offset:1024 nt lds
 buffer_load_dwordx4 v28, s[20:23], s46 offen offset:2048 nt lds
 buffer_load_dwordx4 v3, s[20:23], s46 offen offset:3072 nt lds
 s_add_u32 s46, s15, 90112
 s_and_b32 s46, s46, 0x1ffff
 s_add_u32 s46, s46, s42
 s_mov_b32 m0, 94208
 s_add_u32 s46, s46, 4096
 buffer_load_dwordx4 v28, s[20:23], s46 offen offset:0 nt lds
 buffer_load_dwordx4 v3, s[20:23], s46 offen offset:1024 nt lds
 buffer_load_dwordx4 v28, s[20:23], s46 offen offset:2048 nt lds
 buffer_load_dwordx4 v3, s[20:23], s46 offen offset:3072 nt lds
 s_waitcnt vmcnt(63) lgkmcnt(0)
 s_barrier
 s_add_u32 s91, s45, s80
 s_mov_b32 m0, 49152
 s_add_u32 s46, s91, 0
 buffer_load_dwordx4 v60, s[28:31], s46 offen offset:0 lds
 buffer_load_dwordx4 v61, s[28:31], s46 offen offset:1024 lds
 buffer_load_dwordx4 v62, s[28:31], s46 offen offset:2048 lds
 buffer_load_dwordx4 v63, s[28:31], s46 offen offset:3072 lds
 s_mov_b32 m0, 53248
 s_add_u32 s46, s91, 36864
 buffer_load_dwordx4 v60, s[28:31], s46 offen offset:0 lds
 buffer_load_dwordx4 v61, s[28:31], s46 offen offset:1024 lds
 buffer_load_dwordx4 v62, s[28:31], s46 offen offset:2048 lds
 buffer_load_dwordx4 v63, s[28:31], s46 offen offset:3072 lds
 s_mov_b32 m0, 57344
 s_add_u32 s46, s91, 73728
 buffer_load_dwordx4 v60, s[28:31], s46 offen offset:0 lds
 buffer_load_dwordx4 v61, s[28:31], s46 offen offset:1024 lds
 buffer_load_dwordx4 v62, s[28:31], s46 offen offset:2048 lds
 buffer_load_dwordx4 v63, s[28:31], s46 offen offset:3072 lds
 s_mov_b32 m0, 61440
 s_add_u32 s46, s91, 110592
 buffer_load_dwordx4 v60, s[28:31], s46 offen offset:0 lds
 buffer_load_dwordx4 v61, s[28:31], s46 offen offset:1024 lds
 buffer_load_dwordx4 v62, s[28:31], s46 offen offset:2048 lds
 buffer_load_dwordx4 v63, s[28:31], s46 offen offset:3072 lds
 s_waitcnt vmcnt(63) lgkmcnt(0)
 s_barrier
 s_add_u32 s46, s15, 114688
 s_and_b32 s46, s46, 0x1ffff
 s_add_u32 s46, s46, s42
 s_mov_b32 m0, 114688
 s_add_u32 s46, s46, 0
 buffer_load_dwordx4 v24, s[16:19], s46 offen offset:0 nt lds
 buffer_load_dwordx4 v25, s[16:19], s46 offen offset:1024 nt lds
 buffer_load_dwordx4 v26, s[16:19], s46 offen offset:2048 nt lds
 buffer_load_dwordx4 v27, s[16:19], s46 offen offset:3072 nt lds
 s_add_u32 s46, s15, 114688
 s_and_b32 s46, s46, 0x1ffff
 s_add_u32 s46, s46, s42
 s_mov_b32 m0, 118784
 s_add_u32 s46, s46, 4096
 buffer_load_dwordx4 v24, s[16:19], s46 offen offset:0 nt lds
 buffer_load_dwordx4 v25, s[16:19], s46 offen offset:1024 nt lds
 buffer_load_dwordx4 v26, s[16:19], s46 offen offset:2048 nt lds
 buffer_load_dwordx4 v27, s[16:19], s46 offen offset:3072 nt lds
 s_add_u32 s46, s15, 98304
 s_and_b32 s46, s46, 0x1ffff
 s_add_u32 s46, s46, s42
 s_mov_b32 m0, 122880
 s_add_u32 s46, s46, 0
 buffer_load_dwordx4 v28, s[20:23], s46 offen offset:0 nt lds
 buffer_load_dwordx4 v3, s[20:23], s46 offen offset:1024 nt lds
 buffer_load_dwordx4 v28, s[20:23], s46 offen offset:2048 nt lds
 buffer_load_dwordx4 v3, s[20:23], s46 offen offset:3072 nt lds
 s_add_u32 s46, s15, 98304
 s_and_b32 s46, s46, 0x1ffff
 s_add_u32 s46, s46, s42
 s_mov_b32 m0, 126976
 s_add_u32 s46, s46, 4096
 buffer_load_dwordx4 v28, s[20:23], s46 offen offset:0 nt lds
 buffer_load_dwordx4 v3, s[20:23], s46 offen offset:1024 nt lds
 buffer_load_dwordx4 v28, s[20:23], s46 offen offset:2048 nt lds
 buffer_load_dwordx4 v3, s[20:23], s46 offen offset:3072 nt lds
 s_waitcnt vmcnt(63) lgkmcnt(0)
 s_barrier
 s_add_u32 s91, s45, s81
 s_mov_b32 m0, 65536
 s_add_u32 s46, s91, 0
 buffer_load_dwordx4 v60, s[28:31], s46 offen offset:0 lds
 buffer_load_dwordx4 v61, s[28:31], s46 offen offset:1024 lds
 buffer_load_dwordx4 v62, s[28:31], s46 offen offset:2048 lds
 buffer_load_dwordx4 v63, s[28:31], s46 offen offset:3072 lds
 s_mov_b32 m0, 69632
 s_add_u32 s46, s91, 36864
 buffer_load_dwordx4 v60, s[28:31], s46 offen offset:0 lds
 buffer_load_dwordx4 v61, s[28:31], s46 offen offset:1024 lds
 buffer_load_dwordx4 v62, s[28:31], s46 offen offset:2048 lds
 buffer_load_dwordx4 v63, s[28:31], s46 offen offset:3072 lds
 s_mov_b32 m0, 73728
 s_add_u32 s46, s91, 73728
 buffer_load_dwordx4 v60, s[28:31], s46 offen offset:0 lds
 buffer_load_dwordx4 v61, s[28:31], s46 offen offset:1024 lds
 buffer_load_dwordx4 v62, s[28:31], s46 offen offset:2048 lds
 buffer_load_dwordx4 v63, s[28:31], s46 offen offset:3072 lds
 s_mov_b32 m0, 77824
 s_add_u32 s46, s91, 110592
 buffer_load_dwordx4 v60, s[28:31], s46 offen offset:0 lds
 buffer_load_dwordx4 v61, s[28:31], s46 offen offset:1024 lds
 buffer_load_dwordx4 v62, s[28:31], s46 offen offset:2048 lds
 buffer_load_dwordx4 v63, s[28:31], s46 offen offset:3072 lds
 s_waitcnt vmcnt(63) lgkmcnt(0)
 s_barrier
 s_add_u32 s46, s15, 122880
 s_and_b32 s46, s46, 0x1ffff
 s_add_u32 s46, s46, s42
 s_mov_b32 m0, 131072
 s_add_u32 s46, s46, 0
 buffer_load_dwordx4 v24, s[16:19], s46 offen offset:0 nt lds
 buffer_load_dwordx4 v25, s[16:19], s46 offen offset:1024 nt lds
 buffer_load_dwordx4 v26, s[16:19], s46 offen offset:2048 nt lds
 buffer_load_dwordx4 v27, s[16:19], s46 offen offset:3072 nt lds
 s_add_u32 s46, s15, 122880
 s_and_b32 s46, s46, 0x1ffff
 s_add_u32 s46, s46, s42
 s_mov_b32 m0, 135168
 s_add_u32 s46, s46, 4096
 buffer_load_dwordx4 v24, s[16:19], s46 offen offset:0 nt lds
 buffer_load_dwordx4 v25, s[16:19], s46 offen offset:1024 nt lds
 buffer_load_dwordx4 v26, s[16:19], s46 offen offset:2048 nt lds
 buffer_load_dwordx4 v27, s[16:19], s46 offen offset:3072 nt lds
 s_add_u32 s46, s15, 106496
 s_and_b32 s46, s46, 0x1ffff
 s_add_u32 s46, s46, s42
 s_mov_b32 m0, 139264
 s_add_u32 s46, s46, 0
 buffer_load_dwordx4 v28, s[20:23], s46 offen offset:0 nt lds
 buffer_load_dwordx4 v3, s[20:23], s46 offen offset:1024 nt lds
 buffer_load_dwordx4 v28, s[20:23], s46 offen offset:2048 nt lds
 buffer_load_dwordx4 v3, s[20:23], s46 offen offset:3072 nt lds
 s_add_u32 s46, s15, 106496
 s_and_b32 s46, s46, 0x1ffff
 s_add_u32 s46, s46, s42
 s_mov_b32 m0, 143360
 s_add_u32 s46, s46, 4096
 buffer_load_dwordx4 v28, s[20:23], s46 offen offset:0 nt lds
 buffer_load_dwordx4 v3, s[20:23], s46 offen offset:1024 nt lds
 buffer_load_dwordx4 v28, s[20:23], s46 offen offset:2048 nt lds
 buffer_load_dwordx4 v3, s[20:23], s46 offen offset:3072 nt lds
 s_waitcnt vmcnt(63) lgkmcnt(0)
 s_barrier
 s_add_u32 s91, s45, s82
 s_mov_b32 m0, 98304
 s_add_u32 s46, s91, 0
 buffer_load_dwordx4 v60, s[28:31], s46 offen offset:0 lds
 buffer_load_dwordx4 v61, s[28:31], s46 offen offset:1024 lds
 buffer_load_dwordx4 v62, s[28:31], s46 offen offset:2048 lds
 buffer_load_dwordx4 v63, s[28:31], s46 offen offset:3072 lds
 s_mov_b32 m0, 102400
 s_add_u32 s46, s91, 36864
 buffer_load_dwordx4 v60, s[28:31], s46 offen offset:0 lds
 buffer_load_dwordx4 v61, s[28:31], s46 offen offset:1024 lds
 buffer_load_dwordx4 v62, s[28:31], s46 offen offset:2048 lds
 buffer_load_dwordx4 v63, s[28:31], s46 offen offset:3072 lds
 s_mov_b32 m0, 106496
 s_add_u32 s46, s91, 73728
 buffer_load_dwordx4 v60, s[28:31], s46 offen offset:0 lds
 buffer_load_dwordx4 v61, s[28:31], s46 offen offset:1024 lds
 buffer_load_dwordx4 v62, s[28:31], s46 offen offset:2048 lds
 buffer_load_dwordx4 v63, s[28:31], s46 offen offset:3072 lds
 s_mov_b32 m0, 110592
 s_add_u32 s46, s91, 110592
 buffer_load_dwordx4 v60, s[28:31], s46 offen offset:0 lds
 buffer_load_dwordx4 v61, s[28:31], s46 offen offset:1024 lds
 buffer_load_dwordx4 v62, s[28:31], s46 offen offset:2048 lds
 buffer_load_dwordx4 v63, s[28:31], s46 offen offset:3072 lds
 s_waitcnt vmcnt(63) lgkmcnt(0)
 s_barrier
 s_add_u32 s46, s15, 114688
 s_and_b32 s46, s46, 0x1ffff
 s_add_u32 s46, s46, s42
 s_mov_b32 m0, 32768
 s_add_u32 s46, s46, 0
 buffer_load_dwordx4 v28, s[20:23], s46 offen offset:0 nt lds
 buffer_load_dwordx4 v3, s[20:23], s46 offen offset:1024 nt lds
 buffer_load_dwordx4 v28, s[20:23], s46 offen offset:2048 nt lds
 buffer_load_dwordx4 v3, s[20:23], s46 offen offset:3072 nt lds
 s_add_u32 s46, s15, 114688
 s_and_b32 s46, s46, 0x1ffff
 s_add_u32 s46, s46, s42
 s_mov_b32 m0, 36864
 s_add_u32 s46, s46, 4096
 buffer_load_dwordx4 v28, s[20:23], s46 offen offset:0 nt lds
 buffer_load_dwordx4 v3, s[20:23], s46 offen offset:1024 nt lds
 buffer_load_dwordx4 v28, s[20:23], s46 offen offset:2048 nt lds
 buffer_load_dwordx4 v3, s[20:23], s46 offen offset:3072 nt lds
 s_add_u32 s46, s15, 122880
 s_and_b32 s46, s46, 0x1ffff
 s_add_u32 s46, s46, s42
 s_mov_b32 m0, 40960
 s_add_u32 s46, s46, 0
 buffer_load_dwordx4 v28, s[20:23], s46 offen offset:0 nt lds
 buffer_load_dwordx4 v3, s[20:23], s46 offen offset:1024 nt lds
 buffer_load_dwordx4 v28, s[20:23], s46 offen offset:2048 nt lds
 buffer_load_dwordx4 v3, s[20:23], s46 offen offset:3072 nt lds
 s_add_u32 s46, s15, 122880
 s_and_b32 s46, s46, 0x1ffff
 s_add_u32 s46, s46, s42
 s_mov_b32 m0, 45056
 s_add_u32 s46, s46, 4096
 buffer_load_dwordx4 v28, s[20:23], s46 offen offset:0 nt lds
 buffer_load_dwordx4 v3, s[20:23], s46 offen offset:1024 nt lds
 buffer_load_dwordx4 v28, s[20:23], s46 offen offset:2048 nt lds
 buffer_load_dwordx4 v3, s[20:23], s46 offen offset:3072 nt lds
 s_waitcnt vmcnt(63) lgkmcnt(0)
 s_barrier
 s_waitcnt vmcnt(63) lgkmcnt(0)
 s_barrier
 s_add_u32 s91, s45, s83
 s_mov_b32 m0, 81920
 s_add_u32 s46, s91, 0
 buffer_load_dwordx4 v60, s[28:31], s46 offen offset:0 lds
 buffer_load_dwordx4 v61, s[28:31], s46 offen offset:1024 lds
 buffer_load_dwordx4 v62, s[28:31], s46 offen offset:2048 lds
 buffer_load_dwordx4 v63, s[28:31], s46 offen offset:3072 lds
 s_mov_b32 m0, 86016
 s_add_u32 s46, s91, 36864
 buffer_load_dwordx4 v60, s[28:31], s46 offen offset:0 lds
 buffer_load_dwordx4 v61, s[28:31], s46 offen offset:1024 lds
 buffer_load_dwordx4 v62, s[28:31], s46 offen offset:2048 lds
 buffer_load_dwordx4 v63, s[28:31], s46 offen offset:3072 lds
 s_mov_b32 m0, 90112
 s_add_u32 s46, s91, 73728
 buffer_load_dwordx4 v60, s[28:31], s46 offen offset:0 lds
 buffer_load_dwordx4 v61, s[28:31], s46 offen offset:1024 lds
 buffer_load_dwordx4 v62, s[28:31], s46 offen offset:2048 lds
 buffer_load_dwordx4 v63, s[28:31], s46 offen offset:3072 lds
 s_mov_b32 m0, 94208
 s_add_u32 s46, s91, 110592
 buffer_load_dwordx4 v60, s[28:31], s46 offen offset:0 lds
 buffer_load_dwordx4 v61, s[28:31], s46 offen offset:1024 lds
 buffer_load_dwordx4 v62, s[28:31], s46 offen offset:2048 lds
 buffer_load_dwordx4 v63, s[28:31], s46 offen offset:3072 lds
 s_add_u32 s42, s42, 0x20000
 s_waitcnt vmcnt(48) lgkmcnt(0)
 s_barrier
 s_add_u32 s91, s45, s84
 s_mov_b32 m0, 114688
 s_add_u32 s46, s91, 0
 buffer_load_dwordx4 v60, s[28:31], s46 offen offset:0 lds
 buffer_load_dwordx4 v61, s[28:31], s46 offen offset:1024 lds
 buffer_load_dwordx4 v62, s[28:31], s46 offen offset:2048 lds
 buffer_load_dwordx4 v63, s[28:31], s46 offen offset:3072 lds
 s_mov_b32 m0, 118784
 s_add_u32 s46, s91, 36864
 buffer_load_dwordx4 v60, s[28:31], s46 offen offset:0 lds
 buffer_load_dwordx4 v61, s[28:31], s46 offen offset:1024 lds
 buffer_load_dwordx4 v62, s[28:31], s46 offen offset:2048 lds
 buffer_load_dwordx4 v63, s[28:31], s46 offen offset:3072 lds
 s_mov_b32 m0, 122880
 s_add_u32 s46, s91, 73728
 buffer_load_dwordx4 v60, s[28:31], s46 offen offset:0 lds
 buffer_load_dwordx4 v61, s[28:31], s46 offen offset:1024 lds
 buffer_load_dwordx4 v62, s[28:31], s46 offen offset:2048 lds
 buffer_load_dwordx4 v63, s[28:31], s46 offen offset:3072 lds
 s_mov_b32 m0, 126976
 s_add_u32 s46, s91, 110592
 buffer_load_dwordx4 v60, s[28:31], s46 offen offset:0 lds
 buffer_load_dwordx4 v61, s[28:31], s46 offen offset:1024 lds
 buffer_load_dwordx4 v62, s[28:31], s46 offen offset:2048 lds
 buffer_load_dwordx4 v63, s[28:31], s46 offen offset:3072 lds
 s_waitcnt vmcnt(32) lgkmcnt(0)
 s_barrier
 s_waitcnt vmcnt(63) lgkmcnt(0)
 v_readfirstlane_b32 s57, v17
 s_mov_b32 s58, 0
M_chk:
 s_nop 2
 s_cmp_ge_u32 s57, 8
 s_cbranch_scc1 M_chkend
 buffer_load_dword v17, v16, s[68:71], 0 offen offset:0 sc1
 s_add_u32 s58, s58, 1
 s_waitcnt vmcnt(0)
 v_readfirstlane_b32 s57, v17
 s_cmp_lt_u32 s58, 0x80000
 s_cbranch_scc1 M_chk
M_chkend:
 s_barrier
 s_add_u32 s91, s45, s85
 s_mov_b32 m0, 131072
 s_add_u32 s46, s91, 0
 buffer_load_dwordx4 v60, s[28:31], s46 offen offset:0 lds
 buffer_load_dwordx4 v61, s[28:31], s46 offen offset:1024 lds
 buffer_load_dwordx4 v62, s[28:31], s46 offen offset:2048 lds
 buffer_load_dwordx4 v63, s[28:31], s46 offen offset:3072 lds
 s_mov_b32 m0, 135168
 s_add_u32 s46, s91, 36864
 buffer_load_dwordx4 v60, s[28:31], s46 offen offset:0 lds
 buffer_load_dwordx4 v61, s[28:31], s46 offen offset:1024 lds
 buffer_load_dwordx4 v62, s[28:31], s46 offen offset:2048 lds
 buffer_load_dwordx4 v63, s[28:31], s46 offen offset:3072 lds
 s_mov_b32 m0, 139264
 s_add_u32 s46, s91, 73728
 buffer_load_dwordx4 v60, s[28:31], s46 offen offset:0 lds
 buffer_load_dwordx4 v61, s[28:31], s46 offen offset:1024 lds
 buffer_load_dwordx4 v62, s[28:31], s46 offen offset:2048 lds
 buffer_load_dwordx4 v63, s[28:31], s46 offen offset:3072 lds
 s_mov_b32 m0, 143360
 s_add_u32 s46, s91, 110592
 buffer_load_dwordx4 v60, s[28:31], s46 offen offset:0 lds
 buffer_load_dwordx4 v61, s[28:31], s46 offen offset:1024 lds
 buffer_load_dwordx4 v62, s[28:31], s46 offen offset:2048 lds
 buffer_load_dwordx4 v63, s[28:31], s46 offen offset:3072 lds
 s_waitcnt vmcnt(63) lgkmcnt(0)
 s_barrier
 s_waitcnt vmcnt(63) lgkmcnt(0)
 s_barrier
 s_add_u32 s91, s45, s86
 s_mov_b32 m0, 65536
 s_add_u32 s46, s91, 0
 buffer_load_dwordx4 v60, s[28:31], s46 offen offset:0 lds
 buffer_load_dwordx4 v61, s[28:31], s46 offen offset:1024 lds
 buffer_load_dwordx4 v62, s[28:31], s46 offen offset:2048 lds
 buffer_load_dwordx4 v63, s[28:31], s46 offen offset:3072 lds
 s_mov_b32 m0, 69632
 s_add_u32 s46, s91, 36864
 buffer_load_dwordx4 v60, s[28:31], s46 offen offset:0 lds
 buffer_load_dwordx4 v61, s[28:31], s46 offen offset:1024 lds
 buffer_load_dwordx4 v62, s[28:31], s46 offen offset:2048 lds
 buffer_load_dwordx4 v63, s[28:31], s46 offen offset:3072 lds
 s_mov_b32 m0, 73728
 s_add_u32 s46, s91, 73728
 buffer_load_dwordx4 v60, s[28:31], s46 offen offset:0 lds
 buffer_load_dwordx4 v61, s[28:31], s46 offen offset:1024 lds
 buffer_load_dwordx4 v62, s[28:31], s46 offen offset:2048 lds
 buffer_load_dwordx4 v63, s[28:31], s46 offen offset:3072 lds
 s_mov_b32 m0, 77824
 s_add_u32 s46, s91, 110592
 buffer_load_dwordx4 v60, s[28:31], s46 offen offset:0 lds
 buffer_load_dwordx4 v61, s[28:31], s46 offen offset:1024 lds
 buffer_load_dwordx4 v62, s[28:31], s46 offen offset:2048 lds
 buffer_load_dwordx4 v63, s[28:31], s46 offen offset:3072 lds
 s_waitcnt vmcnt(48) lgkmcnt(0)
 s_barrier
 s_waitcnt vmcnt(32) lgkmcnt(0)
 s_barrier
 s_add_u32 s91, s45, s87
 s_mov_b32 m0, 98304
 s_add_u32 s46, s91, 0
 buffer_load_dwordx4 v60, s[28:31], s46 offen offset:0 lds
 buffer_load_dwordx4 v61, s[28:31], s46 offen offset:1024 lds
 buffer_load_dwordx4 v62, s[28:31], s46 offen offset:2048 lds
 buffer_load_dwordx4 v63, s[28:31], s46 offen offset:3072 lds
 s_mov_b32 m0, 102400
 s_add_u32 s46, s91, 36864
 buffer_load_dwordx4 v60, s[28:31], s46 offen offset:0 lds
 buffer_load_dwordx4 v61, s[28:31], s46 offen offset:1024 lds
 buffer_load_dwordx4 v62, s[28:31], s46 offen offset:2048 lds
 buffer_load_dwordx4 v63, s[28:31], s46 offen offset:3072 lds
 s_mov_b32 m0, 106496
 s_add_u32 s46, s91, 73728
 buffer_load_dwordx4 v60, s[28:31], s46 offen offset:0 lds
 buffer_load_dwordx4 v61, s[28:31], s46 offen offset:1024 lds
 buffer_load_dwordx4 v62, s[28:31], s46 offen offset:2048 lds
 buffer_load_dwordx4 v63, s[28:31], s46 offen offset:3072 lds
 s_mov_b32 m0, 110592
 s_add_u32 s46, s91, 110592
 buffer_load_dwordx4 v60, s[28:31], s46 offen offset:0 lds
 buffer_load_dwordx4 v61, s[28:31], s46 offen offset:1024 lds
 buffer_load_dwordx4 v62, s[28:31], s46 offen offset:2048 lds
 buffer_load_dwordx4 v63, s[28:31], s46 offen offset:3072 lds
 s_waitcnt vmcnt(32) lgkmcnt(0)
 s_barrier
 s_waitcnt vmcnt(16) lgkmcnt(0)
 s_barrier
 s_add_u32 s91, s45, s88
 s_mov_b32 m0, 131072
 s_add_u32 s46, s91, 0
 buffer_load_dwordx4 v60, s[28:31], s46 offen offset:0 lds
 buffer_load_dwordx4 v61, s[28:31], s46 offen offset:1024 lds
 buffer_load_dwordx4 v62, s[28:31], s46 offen offset:2048 lds
 buffer_load_dwordx4 v63, s[28:31], s46 offen offset:3072 lds
 s_mov_b32 m0, 135168
 s_add_u32 s46, s91, 36864
 buffer_load_dwordx4 v60, s[28:31], s46 offen offset:0 lds
 buffer_load_dwordx4 v61, s[28:31], s46 offen offset:1024 lds
 buffer_load_dwordx4 v62, s[28:31], s46 offen offset:2048 lds
 buffer_load_dwordx4 v63, s[28:31], s46 offen offset:3072 lds
 s_mov_b32 m0, 139264
 s_add_u32 s46, s91, 73728
 buffer_load_dwordx4 v60, s[28:31], s46 offen offset:0 lds
 buffer_load_dwordx4 v61, s[28:31], s46 offen offset:1024 lds
 buffer_load_dwordx4 v62, s[28:31], s46 offen offset:2048 lds
 buffer_load_dwordx4 v63, s[28:31], s46 offen offset:3072 lds
 s_mov_b32 m0, 143360
 s_add_u32 s46, s91, 110592
 buffer_load_dwordx4 v60, s[28:31], s46 offen offset:0 lds
 buffer_load_dwordx4 v61, s[28:31], s46 offen offset:1024 lds
 buffer_load_dwordx4 v62, s[28:31], s46 offen offset:2048 lds
 buffer_load_dwordx4 v63, s[28:31], s46 offen offset:3072 lds
 s_waitcnt vmcnt(16) lgkmcnt(0)
 s_barrier
 s_waitcnt vmcnt(0) lgkmcnt(0)
 s_barrier
 s_cmp_ge_u32 s59, 3
 s_cbranch_scc1 M_done
 s_mov_b32 s61, 8
 v_and_b32 v10, 7, v0
 v_lshlrev_b32 v1, 2, v10
 v_lshlrev_b32 v6, 4, v0
 buffer_load_dword v2, v1, s[36:39], s89 offen sc1
 s_mul_i32 s56, s53, 884736
 s_mul_i32 s57, s61, 3
 s_add_u32 s57, s57, s59
 s_lshl_b32 s57, s57, 15
 s_add_u32 s56, s56, s57
 s_mul_i32 s60, s4, 96
 s_lshl_b32 s58, s59, 5
 s_add_u32 s60, s60, s58
 s_mul_i32 s60, s60, 2304
 s_lshl_b32 s58, s61, 7
 s_add_u32 s60, s60, s58
 s_and_b32 s58, s2, 4
 s_mul_i32 s58, s58, 288
 s_add_u32 s60, s60, s58
 v_and_b32 v7, 15, v0
 v_mul_u32_u24 v7, 2304, v7
 v_lshrrev_b32 v3, 5, v0
 v_lshl_add_u32 v7, v3, 4, v7
 v_bfe_u32 v3, v0, 4, 1
 v_lshl_add_u32 v7, v3, 5, v7
 v_sub_u32 v10, s61, v10
 v_add_u32 v3, 9, v10
 v_cmp_gt_i32 vcc, 1, v10
 s_nop 1
 v_cndmask_b32 v10, v10, v3, vcc
 s_mov_b32 s62, 510
 s_mov_b32 s58, 0
 s_mov_b32 s64, 8
 v_mov_b32 v192, 0
 v_mov_b32 v193, 0
 v_mov_b32 v194, 0
 v_mov_b32 v195, 0
 v_mov_b32 v196, 0
 v_mov_b32 v197, 0
 v_mov_b32 v198, 0
 v_mov_b32 v199, 0
 v_mov_b32 v200, 0
 v_mov_b32 v201, 0
 v_mov_b32 v202, 0
 v_mov_b32 v203, 0
 v_mov_b32 v204, 0
 v_mov_b32 v205, 0
 v_mov_b32 v206, 0
 v_mov_b32 v207, 0
 v_mov_b32 v208, 0
 v_mov_b32 v209, 0
 v_mov_b32 v210, 0
 v_mov_b32 v211, 0
 v_mov_b32 v212, 0
 v_mov_b32 v213, 0
 v_mov_b32 v214, 0
 v_mov_b32 v215, 0
 v_mov_b32 v216, 0
 v_mov_b32 v217, 0
 v_mov_b32 v218, 0
 v_mov_b32 v219, 0
 v_mov_b32 v220, 0
 v_mov_b32 v221, 0
 v_mov_b32 v222, 0
 v_mov_b32 v223, 0
 v_and_b32 v4, 15, v0
 v_lshrrev_b32 v5, 4, v0
 v_lshlrev_b32 v5, 2, v5
 v_sub_u32 v4, v4, v5
 v_mov_b32 v8, 0x3f80
 v_mov_b32 v9, 0x3f800000
 v_cmp_eq_u32 vcc, 0, v4
 v_cmp_eq_u32 s[66:67], 1, v4
 v_mov_b32 v5, 0
 v_cndmask_b32 v5, v5, v8, vcc
 v_cndmask_b32 v24, v5, v9, s[66:67]
 v_cmp_eq_u32 vcc, 2, v4
 v_cmp_eq_u32 s[66:67], 3, v4
 v_mov_b32 v5, 0
 v_cndmask_b32 v5, v5, v8, vcc
 v_cndmask_b32 v25, v5, v9, s[66:67]
 v_mov_b32 v26, 0
 v_mov_b32 v27, 0
 v_mov_b32 v28, v24
 v_mov_b32 v29, v25
M_pollw3:
 s_waitcnt vmcnt(0)
M_chkw3:
 v_sub_u32 v3, v2, v23
 v_cmp_ge_u32 vcc, v3, v10
 s_nop 3
 s_and_b32 s63, vcc_lo, 0xffff
 s_lshr_b32 s63, s63, s59
 s_and_b32 s63, s63, s62
 s_cbranch_scc1 M_somew3
 s_add_u32 s58, s58, 1
 s_cmp_gt_u32 s58, 0x100000
 s_cbranch_scc1 M_outw3
 s_sleep 8
 buffer_load_dword v2, v1, s[36:39], s89 offen sc1
 s_branch M_pollw3
M_somew3:
 s_bitcmp1_b32 s63, 8
 s_cbranch_scc0 M_nlw38
 s_add_u32 s57, s59, 8
 s_and_b32 s57, s57, 7
 s_lshl_b32 s57, s57, 12
 s_add_u32 s57, s57, s56
 buffer_load_dwordx4 v[144:147], v6, s[36:39], s57 offen offset:0 sc1
 buffer_load_dwordx4 v[148:151], v6, s[36:39], s57 offen offset:1024 sc1
 buffer_load_dwordx4 v[152:155], v6, s[36:39], s57 offen offset:2048 sc1
 buffer_load_dwordx4 v[156:159], v6, s[36:39], s57 offen offset:3072 sc1
M_nlw38:
 s_bitcmp1_b32 s63, 7
 s_cbranch_scc0 M_nlw37
 s_add_u32 s57, s59, 7
 s_and_b32 s57, s57, 7
 s_lshl_b32 s57, s57, 12
 s_add_u32 s57, s57, s56
 buffer_load_dwordx4 v[128:131], v6, s[36:39], s57 offen offset:0 sc1
 buffer_load_dwordx4 v[132:135], v6, s[36:39], s57 offen offset:1024 sc1
 buffer_load_dwordx4 v[136:139], v6, s[36:39], s57 offen offset:2048 sc1
 buffer_load_dwordx4 v[140:143], v6, s[36:39], s57 offen offset:3072 sc1
M_nlw37:
 s_bitcmp1_b32 s63, 6
 s_cbranch_scc0 M_nlw36
 s_add_u32 s57, s59, 6
 s_and_b32 s57, s57, 7
 s_lshl_b32 s57, s57, 12
 s_add_u32 s57, s57, s56
 buffer_load_dwordx4 v[112:115], v6, s[36:39], s57 offen offset:0 sc1
 buffer_load_dwordx4 v[116:119], v6, s[36:39], s57 offen offset:1024 sc1
 buffer_load_dwordx4 v[120:123], v6, s[36:39], s57 offen offset:2048 sc1
 buffer_load_dwordx4 v[124:127], v6, s[36:39], s57 offen offset:3072 sc1
M_nlw36:
 s_bitcmp1_b32 s63, 5
 s_cbranch_scc0 M_nlw35
 s_add_u32 s57, s59, 5
 s_and_b32 s57, s57, 7
 s_lshl_b32 s57, s57, 12
 s_add_u32 s57, s57, s56
 buffer_load_dwordx4 v[96:99], v6, s[36:39], s57 offen offset:0 sc1
 buffer_load_dwordx4 v[100:103], v6, s[36:39], s57 offen offset:1024 sc1
 buffer_load_dwordx4 v[104:107], v6, s[36:39], s57 offen offset:2048 sc1
 buffer_load_dwordx4 v[108:111], v6, s[36:39], s57 offen offset:3072 sc1
M_nlw35:
 s_bitcmp1_b32 s63, 4
 s_cbranch_scc0 M_nlw34
 s_add_u32 s57, s59, 4
 s_and_b32 s57, s57, 7
 s_lshl_b32 s57, s57, 12
 s_add_u32 s57, s57, s56
 buffer_load_dwordx4 v[80:83], v6, s[36:39], s57 offen offset:0 sc1
 buffer_load_dwordx4 v[84:87], v6, s[36:39], s57 offen offset:1024 sc1
 buffer_load_dwordx4 v[88:91], v6, s[36:39], s57 offen offset:2048 sc1
 buffer_load_dwordx4 v[92:95], v6, s[36:39], s57 offen offset:3072 sc1
M_nlw34:
 s_bitcmp1_b32 s63, 3
 s_cbranch_scc0 M_nlw33
 s_add_u32 s57, s59, 3
 s_and_b32 s57, s57, 7
 s_lshl_b32 s57, s57, 12
 s_add_u32 s57, s57, s56
 buffer_load_dwordx4 v[64:67], v6, s[36:39], s57 offen offset:0 sc1
 buffer_load_dwordx4 v[68:71], v6, s[36:39], s57 offen offset:1024 sc1
 buffer_load_dwordx4 v[72:75], v6, s[36:39], s57 offen offset:2048 sc1
 buffer_load_dwordx4 v[76:79], v6, s[36:39], s57 offen offset:3072 sc1
M_nlw33:
 s_bitcmp1_b32 s63, 2
 s_cbranch_scc0 M_nlw32
 s_add_u32 s57, s59, 2
 s_and_b32 s57, s57, 7
 s_lshl_b32 s57, s57, 12
 s_add_u32 s57, s57, s56
 buffer_load_dwordx4 v[48:51], v6, s[36:39], s57 offen offset:0 sc1
 buffer_load_dwordx4 v[52:55], v6, s[36:39], s57 offen offset:1024 sc1
 buffer_load_dwordx4 v[56:59], v6, s[36:39], s57 offen offset:2048 sc1
 buffer_load_dwordx4 v[60:63], v6, s[36:39], s57 offen offset:3072 sc1
M_nlw32:
 s_bitcmp1_b32 s63, 1
 s_cbranch_scc0 M_nlw31
 s_add_u32 s57, s59, 1
 s_and_b32 s57, s57, 7
 s_lshl_b32 s57, s57, 12
 s_add_u32 s57, s57, s56
 buffer_load_dwordx4 v[32:35], v6, s[36:39], s57 offen offset:0 sc1
 buffer_load_dwordx4 v[36:39], v6, s[36:39], s57 offen offset:1024 sc1
 buffer_load_dwordx4 v[40:43], v6, s[36:39], s57 offen offset:2048 sc1
 buffer_load_dwordx4 v[44:47], v6, s[36:39], s57 offen offset:3072 sc1
M_nlw31:
 buffer_load_dword v2, v1, s[36:39], s89 offen sc1
 s_andn2_b32 s62, s62, s63
 s_waitcnt vmcnt(1)
 s_cmp_lg_u32 s64, 8
 s_cbranch_scc1 M_naw38
 s_bitcmp1_b32 s62, 8
 s_cbranch_scc1 M_pollw3
 v_mfma_f32_16x16x32_bf16 v[192:195], v[24:27], v[144:147], v[192:195]
 v_mfma_f32_16x16x32_bf16 v[196:199], v[24:27], v[148:151], v[196:199]
 v_mfma_f32_16x16x32_bf16 v[208:211], v[24:27], v[152:155], v[208:211]
 v_mfma_f32_16x16x32_bf16 v[212:215], v[24:27], v[156:159], v[212:215]
 v_mfma_f32_16x16x32_bf16 v[200:203], v[26:29], v[144:147], v[200:203]
 v_mfma_f32_16x16x32_bf16 v[204:207], v[26:29], v[148:151], v[204:207]
 v_mfma_f32_16x16x32_bf16 v[216:219], v[26:29], v[152:155], v[216:219]
 v_mfma_f32_16x16x32_bf16 v[220:223], v[26:29], v[156:159], v[220:223]
 s_mov_b32 s64, 7
M_naw38:
 s_cmp_lg_u32 s64, 7
 s_cbranch_scc1 M_naw37
 s_bitcmp1_b32 s62, 7
 s_cbranch_scc1 M_pollw3
 v_mfma_f32_16x16x32_bf16 v[192:195], v[24:27], v[128:131], v[192:195]
 v_mfma_f32_16x16x32_bf16 v[196:199], v[24:27], v[132:135], v[196:199]
 v_mfma_f32_16x16x32_bf16 v[208:211], v[24:27], v[136:139], v[208:211]
 v_mfma_f32_16x16x32_bf16 v[212:215], v[24:27], v[140:143], v[212:215]
 v_mfma_f32_16x16x32_bf16 v[200:203], v[26:29], v[128:131], v[200:203]
 v_mfma_f32_16x16x32_bf16 v[204:207], v[26:29], v[132:135], v[204:207]
 v_mfma_f32_16x16x32_bf16 v[216:219], v[26:29], v[136:139], v[216:219]
 v_mfma_f32_16x16x32_bf16 v[220:223], v[26:29], v[140:143], v[220:223]
 s_mov_b32 s64, 6
M_naw37:
 s_cmp_lg_u32 s64, 6
 s_cbranch_scc1 M_naw36
 s_bitcmp1_b32 s62, 6
 s_cbranch_scc1 M_pollw3
 v_mfma_f32_16x16x32_bf16 v[192:195], v[24:27], v[112:115], v[192:195]
 v_mfma_f32_16x16x32_bf16 v[196:199], v[24:27], v[116:119], v[196:199]
 v_mfma_f32_16x16x32_bf16 v[208:211], v[24:27], v[120:123], v[208:211]
 v_mfma_f32_16x16x32_bf16 v[212:215], v[24:27], v[124:127], v[212:215]
 v_mfma_f32_16x16x32_bf16 v[200:203], v[26:29], v[112:115], v[200:203]
 v_mfma_f32_16x16x32_bf16 v[204:207], v[26:29], v[116:119], v[204:207]
 v_mfma_f32_16x16x32_bf16 v[216:219], v[26:29], v[120:123], v[216:219]
 v_mfma_f32_16x16x32_bf16 v[220:223], v[26:29], v[124:127], v[220:223]
 s_mov_b32 s64, 5
M_naw36:
 s_cmp_lg_u32 s64, 5
 s_cbranch_scc1 M_naw35
 s_bitcmp1_b32 s62, 5
 s_cbranch_scc1 M_pollw3
 v_mfma_f32_16x16x32_bf16 v[192:195], v[24:27], v[96:99], v[192:195]
 v_mfma_f32_16x16x32_bf16 v[196:199], v[24:27], v[100:103], v[196:199]
 v_mfma_f32_16x16x32_bf16 v[208:211], v[24:27], v[104:107], v[208:211]
 v_mfma_f32_16x16x32_bf16 v[212:215], v[24:27], v[108:111], v[212:215]
 v_mfma_f32_16x16x32_bf16 v[200:203], v[26:29], v[96:99], v[200:203]
 v_mfma_f32_16x16x32_bf16 v[204:207], v[26:29], v[100:103], v[204:207]
 v_mfma_f32_16x16x32_bf16 v[216:219], v[26:29], v[104:107], v[216:219]
 v_mfma_f32_16x16x32_bf16 v[220:223], v[26:29], v[108:111], v[220:223]
 s_mov_b32 s64, 4
M_naw35:
 s_cmp_lg_u32 s64, 4
 s_cbranch_scc1 M_naw34
 s_bitcmp1_b32 s62, 4
 s_cbranch_scc1 M_pollw3
 v_mfma_f32_16x16x32_bf16 v[192:195], v[24:27], v[80:83], v[192:195]
 v_mfma_f32_16x16x32_bf16 v[196:199], v[24:27], v[84:87], v[196:199]
 v_mfma_f32_16x16x32_bf16 v[208:211], v[24:27], v[88:91], v[208:211]
 v_mfma_f32_16x16x32_bf16 v[212:215], v[24:27], v[92:95], v[212:215]
 v_mfma_f32_16x16x32_bf16 v[200:203], v[26:29], v[80:83], v[200:203]
 v_mfma_f32_16x16x32_bf16 v[204:207], v[26:29], v[84:87], v[204:207]
 v_mfma_f32_16x16x32_bf16 v[216:219], v[26:29], v[88:91], v[216:219]
 v_mfma_f32_16x16x32_bf16 v[220:223], v[26:29], v[92:95], v[220:223]
 s_mov_b32 s64, 3
M_naw34:
 s_cmp_lg_u32 s64, 3
 s_cbranch_scc1 M_naw33
 s_bitcmp1_b32 s62, 3
 s_cbranch_scc1 M_pollw3
 v_mfma_f32_16x16x32_bf16 v[192:195], v[24:27], v[64:67], v[192:195]
 v_mfma_f32_16x16x32_bf16 v[196:199], v[24:27], v[68:71], v[196:199]
 v_mfma_f32_16x16x32_bf16 v[208:211], v[24:27], v[72:75], v[208:211]
 v_mfma_f32_16x16x32_bf16 v[212:215], v[24:27], v[76:79], v[212:215]
 v_mfma_f32_16x16x32_bf16 v[200:203], v[26:29], v[64:67], v[200:203]
 v_mfma_f32_16x16x32_bf16 v[204:207], v[26:29], v[68:71], v[204:207]
 v_mfma_f32_16x16x32_bf16 v[216:219], v[26:29], v[72:75], v[216:219]
 v_mfma_f32_16x16x32_bf16 v[220:223], v[26:29], v[76:79], v[220:223]
 s_mov_b32 s64, 2
M_naw33:
 s_cmp_lg_u32 s64, 2
 s_cbranch_scc1 M_naw32
 s_bitcmp1_b32 s62, 2
 s_cbranch_scc1 M_pollw3
 v_mfma_f32_16x16x32_bf16 v[192:195], v[24:27], v[48:51], v[192:195]
 v_mfma_f32_16x16x32_bf16 v[196:199], v[24:27], v[52:55], v[196:199]
 v_mfma_f32_16x16x32_bf16 v[208:211], v[24:27], v[56:59], v[208:211]
 v_mfma_f32_16x16x32_bf16 v[212:215], v[24:27], v[60:63], v[212:215]
 v_mfma_f32_16x16x32_bf16 v[200:203], v[26:29], v[48:51], v[200:203]
 v_mfma_f32_16x16x32_bf16 v[204:207], v[26:29], v[52:55], v[204:207]
 v_mfma_f32_16x16x32_bf16 v[216:219], v[26:29], v[56:59], v[216:219]
 v_mfma_f32_16x16x32_bf16 v[220:223], v[26:29], v[60:63], v[220:223]
 s_mov_b32 s64, 1
M_naw32:
 s_cmp_lg_u32 s64, 1
 s_cbranch_scc1 M_naw31
 s_bitcmp1_b32 s62, 1
 s_cbranch_scc1 M_pollw3
 v_mfma_f32_16x16x32_bf16 v[192:195], v[24:27], v[32:35], v[192:195]
 v_mfma_f32_16x16x32_bf16 v[196:199], v[24:27], v[36:39], v[196:199]
 v_mfma_f32_16x16x32_bf16 v[208:211], v[24:27], v[40:43], v[208:211]
 v_mfma_f32_16x16x32_bf16 v[212:215], v[24:27], v[44:47], v[212:215]
 v_mfma_f32_16x16x32_bf16 v[200:203], v[26:29], v[32:35], v[200:203]
 v_mfma_f32_16x16x32_bf16 v[204:207], v[26:29], v[36:39], v[204:207]
 v_mfma_f32_16x16x32_bf16 v[216:219], v[26:29], v[40:43], v[216:219]
 v_mfma_f32_16x16x32_bf16 v[220:223], v[26:29], v[44:47], v[220:223]
 s_mov_b32 s64, 0
M_naw31:
M_outw3:
 s_nop 15
 v_cvt_pk_bf16_f32 v8, v192, v193
 v_cvt_pk_bf16_f32 v9, v194, v195
 v_cvt_pk_bf16_f32 v10, v200, v201
 v_cvt_pk_bf16_f32 v11, v202, v203
 v_cvt_pk_bf16_f32 v12, v196, v197
 v_cvt_pk_bf16_f32 v13, v198, v199
 v_cvt_pk_bf16_f32 v14, v204, v205
 v_cvt_pk_bf16_f32 v15, v206, v207
 v_cvt_pk_bf16_f32 v16, v208, v209
 v_cvt_pk_bf16_f32 v17, v210, v211
 v_cvt_pk_bf16_f32 v18, v216, v217
 v_cvt_pk_bf16_f32 v19, v218, v219
 v_cvt_pk_bf16_f32 v20, v212, v213
 v_cvt_pk_bf16_f32 v21, v214, v215
 v_cvt_pk_bf16_f32 v22, v220, v221
 v_cvt_pk_bf16_f32 v23, v222, v223
 s_add_u32 s57, s60, 36864
 v_permlane16_swap_b32 v8, v10
 v_permlane16_swap_b32 v9, v11
 buffer_store_dwordx4 v[8:11], v7, s[72:75], s60 offen offset:0
 v_permlane16_swap_b32 v12, v14
 v_permlane16_swap_b32 v13, v15
 buffer_store_dwordx4 v[12:15], v7, s[72:75], s57 offen offset:0
 v_permlane16_swap_b32 v16, v18
 v_permlane16_swap_b32 v17, v19
 buffer_store_dwordx4 v[16:19], v7, s[72:75], s60 offen offset:64
 v_permlane16_swap_b32 v20, v22
 v_permlane16_swap_b32 v21, v23
 buffer_store_dwordx4 v[20:23], v7, s[72:75], s57 offen offset:64
 s_endpgm
M_done:
    s_endpgm
.section .rodata,"a"
.p2align 6
.amdhsa_kernel concat_heads__mha_block_cached__gqa_block_cached__near_ridge_kernel
  .amdhsa_next_free_vgpr 512
  .amdhsa_next_free_sgpr 102
  .amdhsa_accum_offset 256
  .amdhsa_group_segment_fixed_size 0
  .amdhsa_kernarg_size 104
  .amdhsa_user_sgpr_count 2
  .amdhsa_user_sgpr_kernarg_segment_ptr 1
  .amdhsa_system_sgpr_workgroup_id_x 1
.end_amdhsa_kernel
```
